```python
import torch

def _softmax(x, axis=-1):
    return torch.softmax(x, dim=axis)

def _gelu(x):
    return torch.nn.functional.gelu(x, approximate='tanh')

def _silu(x):
    return torch.nn.functional.silu(x)

def _sigmoid(x):
    return torch.sigmoid(x)

def _layernorm(x, axis=-1, eps=1e-05):
    m = x.mean(dim=axis, keepdim=True)
    v = x.var(dim=axis, keepdim=True, unbiased=False)
    return (x - m) / torch.sqrt(v + eps)

def _scatter_add(tgt, idx, src, axis=0):
    return tgt.clone().index_add_(axis, idx, src)

def _segment_sum(src, seg, n):
    out = torch.zeros((n,) + src.shape[1:], dtype=src.dtype)
    return out.index_add_(0, seg, src)

def _pad(x, pw):
    flat = tuple((v for pair in reversed(pw) for v in pair))
    return torch.nn.functional.pad(x, flat)
kernel_name = 'interleave_layers__memory_aug_recurrent_mem_tr__ssm_conv_h3__prompt'

def setup_inputs():

    _w = lambda a: (lambda t: t.to(torch.bfloat16) if t.is_floating_point() else t)(torch.as_tensor(a))

    def _A_setup():
        B, S, Dm = (1, 2048, 640)
        H, Dh = (32, 128)
        M, seg = (8, 32)
        seg = min(seg, S)
        S = S // seg * seg
        return {'x': _w((lambda *s: torch.randn(*s, dtype=torch.bfloat16) * 0.05)(B, S, Dm)), 'mem0': _w((lambda *s: torch.randn(*s, dtype=torch.bfloat16) * 0.4)(B, M, Dm)), 'Wq': _w((lambda *s: torch.randn(*s, dtype=torch.bfloat16) * 1.6)(Dm, H, Dh) * Dm ** (-0.5)), 'Wk': _w((lambda *s: torch.randn(*s, dtype=torch.bfloat16) * 1.6)(Dm, H, Dh) * Dm ** (-0.5)), 'Wv': _w((lambda *s: torch.randn(*s, dtype=torch.bfloat16) * 0.4)(Dm, H, Dh) * Dm ** (-0.5)), 'Wo': _w((lambda *s: torch.randn(*s, dtype=torch.bfloat16) * 0.4)(H, Dh, Dm) * (H * Dh) ** (-0.5)), 'seg_len': seg}
    _A_in = _A_setup()

    def _B_setup():
        B, S, D = (1, 2048, 640)
        ks = 4
        return {'q': _w((lambda *s: torch.randn(*s, dtype=torch.bfloat16) * 0.05)(B, S, D)), 'k': _w((lambda *s: torch.randn(*s, dtype=torch.bfloat16) * 0.4)(B, S, D)), 'v': _w((lambda *s: torch.randn(*s, dtype=torch.bfloat16) * 0.4)(B, S, D)), 'shift_k': _w((lambda *s: torch.randn(*s, dtype=torch.bfloat16) * 0.4)(D, ks) * 0.5), 'ssm_k': _w((lambda *s: torch.randn(*s, dtype=torch.bfloat16) * 0.8)(D, S) * (1.0 / S ** 0.5)), 'ssm_D': _w((lambda *s: torch.randn(*s, dtype=torch.bfloat16) * 0.4)(D))}
    _B_in = _B_setup()
    return {'A_x': _A_in['x'], 'A_mem0': _A_in['mem0'], 'A_Wq': _A_in['Wq'], 'A_Wk': _A_in['Wk'], 'A_Wv': _A_in['Wv'], 'A_Wo': _A_in['Wo'], 'A_seg_len': _A_in['seg_len'], 'B_q': _B_in['q'], 'B_k': _B_in['k'], 'B_v': _B_in['v'], 'B_shift_k': _B_in['shift_k'], 'B_ssm_k': _B_in['ssm_k'], 'B_ssm_D': _B_in['ssm_D']}

def reference(A_x, A_mem0, A_Wq, A_Wk, A_Wv, A_Wo, A_seg_len, B_q, B_k, B_v, B_shift_k, B_ssm_k, B_ssm_D):

    def _A_ref(x, mem0, Wq, Wk, Wv, Wo, seg_len):
        B, S, Dm = x.shape
        H, Dh = (Wq.shape[1], Wq.shape[2])
        M = mem0.shape[1]
        scale = Dh ** (-0.5)
        n_seg = S // seg_len
        L = M + seg_len
        idx = torch.arange(L)
        mask = (idx[:, None] < M) | (idx[:, None] >= idx[None, :])
        mem = mem0
        outs = []
        for s in range(n_seg):
            xs = x[:, s * seg_len:(s + 1) * seg_len, :].clone()
            h = torch.concatenate([mem, xs], axis=1)
            q = torch.einsum('btd,dhe->bhte', h, Wq)
            k = torch.einsum('btd,dhe->bhte', h, Wk)
            v = torch.einsum('btd,dhe->bhte', h, Wv)
            scores = torch.einsum('bhqe,bhke->bhqk', q, k) * scale
            scores = torch.where(mask[None, None], scores, -1000000000.0)
            p = _softmax(scores, axis=-1)
            o = torch.einsum('bhqk,bhke->bhqe', p, v)
            o = torch.einsum('bhte,hed->btd', o, Wo)
            mem = o[:, :M, :].clone()
            outs.append(o[:, M:, :])
        return torch.concatenate(outs, axis=1)

    def _B_ref(q, k, v, shift_k, ssm_k, ssm_D):
        B, S, D = q.shape
        ks = shift_k.shape[-1]
        k_pad = _pad(k, ((0, 0), (ks - 1, 0), (0, 0)))
        k_shift = torch.zeros_like(k)
        for t in range(ks):
            k_shift = k_shift + k_pad[:, t:t + S, :] * shift_k[:, ks - 1 - t][None, None, :]
        kv = k_shift * v
        L = 2 * S
        kv_pad = _pad(kv, ((0, 0), (0, S), (0, 0)))
        kf_pad = _pad(ssm_k, ((0, 0), (0, S)))
        kv_f = (lambda x, axes=(-2, -1): torch.fft.rfft2(x.float(), dim=axes))(kv_pad[:, None, :, :], axes=(1, 2))
        kf_f = (lambda x, axes=(-2, -1): torch.fft.rfft2(x.float(), dim=axes))(kf_pad[:, None, :], axes=(1, 2))
        kf_f = (lambda x, *d: x.permute(*d))(kf_f, 1, 2, 0)
        y_f = kv_f * kf_f[None, :, :, :]
        y = (lambda x, s, axes=(-2, -1): torch.fft.irfft2(x, s=s, dim=axes).to(torch.bfloat16))(y_f, (1, L), axes=(1, 2))[:, 0, :S, :]
        y = y + kv * ssm_D[None, None, :]
        return q * y
    x = A_x
    x = x + _A_ref(_layernorm(x, axis=-1), A_mem0, A_Wq, A_Wk, A_Wv, A_Wo, A_seg_len)
    x = x + _B_ref(_layernorm(x, axis=-1), B_k, B_v, B_shift_k, B_ssm_k, B_ssm_D)
    x = x + _A_ref(_layernorm(x, axis=-1), A_mem0, A_Wq, A_Wk, A_Wv, A_Wo, A_seg_len)
    x = x + _B_ref(_layernorm(x, axis=-1), B_k, B_v, B_shift_k, B_ssm_k, B_ssm_D)
    return x
```

```asm
; @launch grid=(256,1,1) block=(256,1,1) lds=163840
.amdgcn_target "amdgcn-amd-amdhsa--gfx950"
.text
.globl interleave_layers__memory_aug_recurrent_mem_tr__ssm_conv_h3__prompt_kernel
.p2align 8
.type interleave_layers__memory_aug_recurrent_mem_tr__ssm_conv_h3__prompt_kernel,@function
interleave_layers__memory_aug_recurrent_mem_tr__ssm_conv_h3__prompt_kernel:
 s_cmp_ge_u32 s2, 256
 s_cbranch_scc1 L_bail
 s_load_dwordx16 s[16:31], s[0:1], 0
 s_load_dwordx16 s[32:47], s[0:1], 64
 s_getreg_b32 s48, hwreg(HW_REG_XCC_ID, 0, 3)
 v_lshrrev_b32 v1, 6, v0
 v_and_b32 v0, 63, v0
 s_nop 0
 v_readfirstlane_b32 s50, v1
 s_waitcnt lgkmcnt(0)
 s_mov_b32 s4, s46
 s_and_b32 s5, s47, 0xffff
 s_mov_b32 s6, 268435456
 s_mov_b32 s7, 0x00020000
 s_mov_b32 s8, s46
 s_and_b32 s9, s47, 0xffff
 s_mov_b32 s10, 268435456
 s_mov_b32 s11, 0x00020000
 s_mov_b32 s12, s46
 s_and_b32 s13, s47, 0xffff
 s_mov_b32 s14, 268435456
 s_mov_b32 s15, 0x00020000
 s_mov_b32 s96, s44
 s_and_b32 s97, s45, 0xffff
 s_mov_b32 s98, 256
 s_mov_b32 s99, 0x00020000
 s_cmp_lg_u32 s50, 0
 s_cbranch_scc1 L_tk_wait
 s_mov_b32 s96, s44
 s_and_b32 s97, s45, 0xffff
 s_mov_b32 s98, 256
 s_mov_b32 s99, 0x00020000
 s_lshl_b32 s3, s48, 5
 v_mov_b32 v1, 1
 v_mov_b32 v2, 0
 s_mov_b64 exec, 1
 buffer_atomic_add v1, off, s[96:99], s3 sc0
 s_waitcnt vmcnt(0)
 s_mov_b64 exec, -1
 v_readfirstlane_b32 s60, v1
 s_nop 3
 s_cmp_lt_u32 s60, 32
 s_cbranch_scc1 L_tk_ok
 v_lshlrev_b32 v3, 5, v0
 s_mov_b32 s51, 0
L_tk_lp:
 buffer_load_dword v4, v3, s[96:99], 0 offen sc1
 s_waitcnt vmcnt(0)
 s_mov_b32 s61, 0
 v_readlane_b32 s64, v4, 0
 s_nop 3
 s_add_u32 s61, s61, s64
 v_readlane_b32 s65, v4, 1
 s_nop 3
 s_add_u32 s61, s61, s65
 v_readlane_b32 s66, v4, 2
 s_nop 3
 s_add_u32 s61, s61, s66
 v_readlane_b32 s67, v4, 3
 s_nop 3
 s_add_u32 s61, s61, s67
 v_readlane_b32 s68, v4, 4
 s_nop 3
 s_add_u32 s61, s61, s68
 v_readlane_b32 s69, v4, 5
 s_nop 3
 s_add_u32 s61, s61, s69
 v_readlane_b32 s70, v4, 6
 s_nop 3
 s_add_u32 s61, s61, s70
 v_readlane_b32 s71, v4, 7
 s_nop 3
 s_add_u32 s61, s61, s71
 s_cmp_ge_u32 s61, 256
 s_cbranch_scc1 L_tk_all
 s_sleep 4
 s_add_u32 s51, s51, 1
 s_cmp_lt_u32 s51, 131072
 s_cbranch_scc1 L_tk_lp
 s_branch L_bail
L_tk_all:
 v_mov_b32 v1, 1
 s_mov_b64 exec, 1
 buffer_atomic_add v1, off, s[96:99], 0 offset:20 sc0
 s_waitcnt vmcnt(0)
 s_mov_b64 exec, -1
 v_readfirstlane_b32 s61, v1
 s_nop 3
 s_min_u32 s62, s64, 32
 s_add_u32 s60, s62, s61
 s_mov_b32 s48, 0
 s_cmp_lt_u32 s60, 32
 s_cbranch_scc1 L_tk_ok
 s_sub_u32 s61, s60, 32
 s_min_u32 s62, s65, 32
 s_add_u32 s60, s62, s61
 s_mov_b32 s48, 1
 s_cmp_lt_u32 s60, 32
 s_cbranch_scc1 L_tk_ok
 s_sub_u32 s61, s60, 32
 s_min_u32 s62, s66, 32
 s_add_u32 s60, s62, s61
 s_mov_b32 s48, 2
 s_cmp_lt_u32 s60, 32
 s_cbranch_scc1 L_tk_ok
 s_sub_u32 s61, s60, 32
 s_min_u32 s62, s67, 32
 s_add_u32 s60, s62, s61
 s_mov_b32 s48, 3
 s_cmp_lt_u32 s60, 32
 s_cbranch_scc1 L_tk_ok
 s_sub_u32 s61, s60, 32
 s_min_u32 s62, s68, 32
 s_add_u32 s60, s62, s61
 s_mov_b32 s48, 4
 s_cmp_lt_u32 s60, 32
 s_cbranch_scc1 L_tk_ok
 s_sub_u32 s61, s60, 32
 s_min_u32 s62, s69, 32
 s_add_u32 s60, s62, s61
 s_mov_b32 s48, 5
 s_cmp_lt_u32 s60, 32
 s_cbranch_scc1 L_tk_ok
 s_sub_u32 s61, s60, 32
 s_min_u32 s62, s70, 32
 s_add_u32 s60, s62, s61
 s_mov_b32 s48, 6
 s_cmp_lt_u32 s60, 32
 s_cbranch_scc1 L_tk_ok
 s_sub_u32 s61, s60, 32
 s_min_u32 s62, s71, 32
 s_add_u32 s60, s62, s61
 s_mov_b32 s48, 7
 s_cmp_lt_u32 s60, 32
 s_cbranch_scc1 L_tk_ok
 s_sub_u32 s61, s60, 32
 s_mov_b32 s48, 8
 s_mov_b32 s60, 0
L_tk_ok:
 s_lshl_b32 s3, s48, 5
 s_add_u32 s3, s3, s60
 v_mov_b32 v1, s3
 ds_write_b32 v2, v1
 s_waitcnt lgkmcnt(0)
L_tk_wait:
 s_barrier
 v_mov_b32 v2, 0
 ds_read_b32 v1, v2
 s_waitcnt lgkmcnt(0)
 v_readfirstlane_b32 s101, v1
 s_barrier
 s_mov_b32 s51, 0
 s_cmp_ge_u32 s101, 256
 s_cbranch_scc1 L_bail
 s_lshr_b32 s48, s101, 5
 s_and_b32 s48, s48, 7
 s_and_b32 s49, s101, 31
 s_cmp_ge_u32 s48, 4
 s_cbranch_scc1 L_hi
 s_cmp_ge_u32 s49, 24
 s_cbranch_scc1 L_lo2
 s_cmp_ge_u32 s48, 2
 s_cbranch_scc1 L_lo1
 s_cmp_lt_u32 s49, 16
 s_cbranch_scc1 L_ch_far
 s_branch L_vr_far
L_lo1:
 s_lshl_b32 s3, s48, 3
 s_add_u32 s3, s3, s49
 s_add_u32 s82, s3, 56
 s_mov_b32 s83, 4
 s_cmp_lt_u32 s49, 8
 s_cbranch_scc1 L_helper
 s_sub_u32 s82, s3, 24
 s_cmp_lt_u32 s49, 16
 s_cbranch_scc1 L_late
 s_sub_u32 s82, s3, 16
 s_mov_b32 s83, 2
 s_branch L_helper
L_lo2:
 s_lshl_b32 s82, s48, 1
 s_add_u32 s82, s82, s49
 s_add_u32 s82, s82, 58
 s_mov_b32 s83, 3
 s_cmp_ge_u32 s49, 30
 s_cbranch_scc1 L_helper
 s_lshl_b32 s52, s48, 2
 s_add_u32 s52, s52, s49
 s_sub_u32 s52, s52, 24
 s_mov_b32 s82, s52
 s_mov_b32 s83, 0
 s_cmp_lt_u32 s49, 28
 s_cbranch_scc1 L_helper
 s_lshl_b32 s3, s48, 1
 s_add_u32 s3, s3, s49
 s_add_u32 s3, s3, 4
 s_branch L_wo_idx
L_hi:
 s_mul_i32 s3, s48, 24
 s_add_u32 s3, s3, s49
 s_sub_u32 s3, s3, 96
 s_cmp_lt_u32 s49, 24
 s_cbranch_scc1 L_qkv_idx
 s_lshl_b32 s3, s48, 3
 s_add_u32 s3, s3, s49
 s_sub_u32 s3, s3, 56
L_wo_idx:
 s_mul_i32 s52, s3, 13108
 s_lshr_b32 s52, s52, 16
 s_mul_i32 s53, s52, 5
 s_sub_u32 s53, s3, s53
 s_add_u32 s82, s3, 32
 s_mov_b32 s83, 1
 s_branch L_helper
L_qkv_idx:
 s_mul_i32 s52, s3, 21846
 s_lshr_b32 s52, s52, 16
 s_mul_i32 s53, s52, 3
 s_sub_u32 s53, s3, s53
 s_mov_b32 s8, s24
 s_and_b32 s9, s25, 0xffff
 s_mov_b32 s10, 5242880
 s_mov_b32 s11, 0x00020000
 s_cmp_eq_u32 s53, 2
 s_cbranch_scc1 L_qkvv
 s_cmp_eq_u32 s53, 0
 s_cselect_b32 s8, s20, s22
 s_cselect_b32 s9, s21, s23
 s_and_b32 s9, s9, 0xffff
 s_branch L_qkvq
L_ch_far:
 s_branch L_ch
L_vr_far:
 s_branch L_vr
L_conv0:
 s_mov_b32 s8, s38
 s_and_b32 s9, s39, 0xffff
 s_mov_b32 s10, 2621440
 s_mov_b32 s11, 0x00020000
 s_mov_b32 s12, s40
 s_and_b32 s13, s41, 0xffff
 s_mov_b32 s14, 1280
 s_mov_b32 s15, 0x00020000
 v_lshlrev_b32 v130, 4, v0
 v_add_u32 v7, s71, v130
 v_mov_b32 v8, 0
 v_mov_b32 v9, 0
 v_mov_b32 v10, 0
 v_mov_b32 v11, 0
 s_mov_b32 exec_hi, 0
 ds_write_b128 v7, v[8:11] offset:0
 s_mov_b32 exec_lo, 3
 ds_write_b128 v7, v[8:11] offset:4608
 ds_write_b128 v7, v[8:11] offset:8768
 s_mov_b64 exec, -1
 v_and_b32 v8, 15, v0
 v_lshrrev_b32 v9, 5, v0
 v_sub_u32 v10, v8, v9
 v_lshlrev_b32 v10, 5, v10
 v_and_b32 v11, 16, v0
 v_add_u32 v10, v10, v11
 s_add_u32 s3, s71, 64
 v_add_u32 v14, s3, v10
 v_lshlrev_b32 v10, 5, v9
 v_lshl_add_u32 v10, v8, 1, v10
 v_sub_u32 v10, v10, v11
 v_and_b32 v11, 1, v0
 v_cmp_eq_u32 vcc, 1, v11
 v_mov_b32 v12, 8784
 v_mov_b32 v11, 4626
 s_nop 0
 v_cndmask_b32 v11, v12, v11, vcc
 v_add3_u32 v16, v10, v11, s71
 v_add_u32 v17, 512, v16
 v_add_u32 v18, 1024, v16
 v_add_u32 v19, 1536, v16
 v_lshlrev_b32 v10, 5, v8
 v_lshl_add_u32 v10, v9, 4, v10
 v_and_b32 v11, 16, v0
 v_lshrrev_b32 v11, 1, v11
 v_xor_b32 v11, 8, v11
 s_add_u32 s3, s71, 512
 v_add3_u32 v15, v10, v11, s3
 v_and_b32 v10, 1, v0
 v_lshlrev_b32 v10, 4, v10
 v_lshrrev_b32 v11, 4, v0
 v_lshl_add_u32 v10, v11, 2, v10
 s_mov_b32 s3, 40960
 v_mul_lo_u32 v13, v10, s3
 v_lshrrev_b32 v11, 1, v8
 v_lshl_add_u32 v13, v11, 3, v13
 s_cmp_lg_u32 s50, 0
 s_cbranch_scc1 L_ww_1
 s_mov_b32 s96, s44
 s_and_b32 s97, s45, 0xffff
 s_mov_b32 s98, 256
 s_mov_b32 s99, 0x00020000
 v_mov_b32 v24, 196
 s_mov_b32 s51, 0
 s_mov_b64 exec, 1
L_wb_2:
 buffer_load_dword v25, v24, s[96:99], 0 offen sc1
 s_waitcnt vmcnt(0)
 v_cmp_eq_u32 vcc, 0, v25
 s_cbranch_vccz L_wbd_3
 s_sleep 2
 s_add_u32 s51, s51, 1
 s_cmp_lt_u32 s51, 131072
 s_cbranch_scc1 L_wb_2
 s_branch L_bail
L_wbd_3:
 s_mov_b64 exec, -1
L_ww_1:
 s_barrier
 s_lshl_b32 s3, s70, 12
 s_add_u32 s3, s3, 198180864
 buffer_load_dwordx4 v[104:107], v130, s[4:7], s3 offen offset:0 sc1
 buffer_load_dwordx4 v[108:111], v130, s[4:7], s3 offen offset:1024 sc1
 s_waitcnt vmcnt(0)
L_cv_4:
 s_waitcnt vmcnt(4)
 ds_write_b128 v7, v[104:107] offset:512
 ds_write_b128 v7, v[96:99] offset:4640
 ds_write_b128 v7, v[112:115] offset:8800
 ds_write_b128 v7, v[108:111] offset:1536
 ds_write_b128 v7, v[100:103] offset:5664
 ds_write_b128 v7, v[116:119] offset:9824
 v_lshlrev_b32 v8, 16, v96
 v_lshlrev_b32 v12, 16, v128
 s_mov_b64 exec, 1
 ds_write_b32 v7, v8 offset:8796
 s_mov_b64 exec, -1
 s_lshl_b32 s72, s70, 6
 s_add_u32 s72, s72, 200802304
 s_add_u32 s70, s70, s69
 s_waitcnt lgkmcnt(0)
 s_lshl_b32 s73, s70, 12
 s_add_u32 s74, s73, 2
 buffer_load_dwordx4 v[96:99], v130, s[8:11], s73 offen offset:0
 buffer_load_dwordx4 v[100:103], v130, s[8:11], s73 offen offset:1024
 buffer_load_dwordx4 v[112:115], v130, s[8:11], s74 offen offset:0
 buffer_load_dwordx4 v[116:119], v130, s[8:11], s74 offen offset:1024
 s_lshl_b32 s3, s70, 1
 buffer_load_ushort v128, off, s[12:15], s3
 s_lshl_b32 s3, s70, 12
 s_add_u32 s3, s3, 198180864
 buffer_load_dwordx4 v[104:107], v130, s[4:7], s3 offen offset:0 sc1
 buffer_load_dwordx4 v[108:111], v130, s[4:7], s3 offen offset:1024 sc1
 ds_read_b128 v[32:35], v14 offset:448
 ds_read2_b32 v[64:65], v16 offset0:0 offset1:1
 ds_read2_b32 v[66:67], v16 offset0:2 offset1:3
 ds_read_b128 v[36:39], v14 offset:960
 ds_read2_b32 v[68:69], v17 offset0:0 offset1:1
 ds_read2_b32 v[70:71], v17 offset0:2 offset1:3
 ds_read_b128 v[40:43], v14 offset:1472
 ds_read2_b32 v[72:73], v18 offset0:0 offset1:1
 ds_read2_b32 v[74:75], v18 offset0:2 offset1:3
 ds_read_b128 v[44:47], v14 offset:1984
 ds_read2_b32 v[76:77], v19 offset0:0 offset1:1
 ds_read2_b32 v[78:79], v19 offset0:2 offset1:3
 s_waitcnt lgkmcnt(0)
 v_mfma_f32_16x16x32_bf16 v[144:147], v[64:67], v[32:35], 0
 ds_read_b128 v[176:179], v14 offset:384
 ds_read2_b32 v[208:209], v16 offset0:16 offset1:17
 v_mfma_f32_16x16x32_bf16 v[148:151], v[64:67], v[36:39], 0
 ds_read2_b32 v[210:211], v16 offset0:18 offset1:19
 ds_read_b128 v[180:183], v14 offset:896
 v_mfma_f32_16x16x32_bf16 v[152:155], v[64:67], v[40:43], 0
 ds_read2_b32 v[212:213], v17 offset0:16 offset1:17
 ds_read2_b32 v[214:215], v17 offset0:18 offset1:19
 v_mfma_f32_16x16x32_bf16 v[156:159], v[64:67], v[44:47], 0
 ds_read_b128 v[184:187], v14 offset:1408
 ds_read2_b32 v[216:217], v18 offset0:16 offset1:17
 v_mfma_f32_16x16x32_bf16 v[148:151], v[68:71], v[32:35], v[148:151]
 ds_read2_b32 v[218:219], v18 offset0:18 offset1:19
 ds_read_b128 v[188:191], v14 offset:1920
 v_mfma_f32_16x16x32_bf16 v[152:155], v[68:71], v[36:39], v[152:155]
 ds_read2_b32 v[220:221], v19 offset0:16 offset1:17
 ds_read2_b32 v[222:223], v19 offset0:18 offset1:19
 v_mfma_f32_16x16x32_bf16 v[156:159], v[68:71], v[40:43], v[156:159]
 v_mfma_f32_16x16x32_bf16 v[152:155], v[72:75], v[32:35], v[152:155]
 v_mfma_f32_16x16x32_bf16 v[156:159], v[72:75], v[36:39], v[156:159]
 v_mfma_f32_16x16x32_bf16 v[156:159], v[76:79], v[32:35], v[156:159]
 s_waitcnt lgkmcnt(0)
 v_mfma_f32_16x16x32_bf16 v[144:147], v[208:211], v[176:179], v[144:147]
 ds_read_b128 v[32:35], v14 offset:320
 ds_read2_b32 v[64:65], v16 offset0:32 offset1:33
 v_mfma_f32_16x16x32_bf16 v[148:151], v[208:211], v[180:183], v[148:151]
 ds_read2_b32 v[66:67], v16 offset0:34 offset1:35
 ds_read_b128 v[36:39], v14 offset:832
 v_mfma_f32_16x16x32_bf16 v[152:155], v[208:211], v[184:187], v[152:155]
 ds_read2_b32 v[68:69], v17 offset0:32 offset1:33
 ds_read2_b32 v[70:71], v17 offset0:34 offset1:35
 v_mfma_f32_16x16x32_bf16 v[156:159], v[208:211], v[188:191], v[156:159]
 ds_read_b128 v[40:43], v14 offset:1344
 ds_read2_b32 v[72:73], v18 offset0:32 offset1:33
 v_mfma_f32_16x16x32_bf16 v[148:151], v[212:215], v[176:179], v[148:151]
 ds_read2_b32 v[74:75], v18 offset0:34 offset1:35
 ds_read_b128 v[44:47], v14 offset:1856
 v_mfma_f32_16x16x32_bf16 v[152:155], v[212:215], v[180:183], v[152:155]
 ds_read2_b32 v[76:77], v19 offset0:32 offset1:33
 ds_read2_b32 v[78:79], v19 offset0:34 offset1:35
 v_mfma_f32_16x16x32_bf16 v[156:159], v[212:215], v[184:187], v[156:159]
 v_mfma_f32_16x16x32_bf16 v[152:155], v[216:219], v[176:179], v[152:155]
 v_mfma_f32_16x16x32_bf16 v[156:159], v[216:219], v[180:183], v[156:159]
 v_mfma_f32_16x16x32_bf16 v[156:159], v[220:223], v[176:179], v[156:159]
 s_waitcnt lgkmcnt(0)
 v_mfma_f32_16x16x32_bf16 v[144:147], v[64:67], v[32:35], v[144:147]
 ds_read_b128 v[176:179], v14 offset:256
 ds_read2_b32 v[208:209], v16 offset0:48 offset1:49
 v_mfma_f32_16x16x32_bf16 v[148:151], v[64:67], v[36:39], v[148:151]
 ds_read2_b32 v[210:211], v16 offset0:50 offset1:51
 ds_read_b128 v[180:183], v14 offset:768
 v_mfma_f32_16x16x32_bf16 v[152:155], v[64:67], v[40:43], v[152:155]
 ds_read2_b32 v[212:213], v17 offset0:48 offset1:49
 ds_read2_b32 v[214:215], v17 offset0:50 offset1:51
 v_mfma_f32_16x16x32_bf16 v[156:159], v[64:67], v[44:47], v[156:159]
 ds_read_b128 v[184:187], v14 offset:1280
 ds_read2_b32 v[216:217], v18 offset0:48 offset1:49
 v_mfma_f32_16x16x32_bf16 v[148:151], v[68:71], v[32:35], v[148:151]
 ds_read2_b32 v[218:219], v18 offset0:50 offset1:51
 ds_read_b128 v[188:191], v14 offset:1792
 v_mfma_f32_16x16x32_bf16 v[152:155], v[68:71], v[36:39], v[152:155]
 ds_read2_b32 v[220:221], v19 offset0:48 offset1:49
 ds_read2_b32 v[222:223], v19 offset0:50 offset1:51
 v_mfma_f32_16x16x32_bf16 v[156:159], v[68:71], v[40:43], v[156:159]
 v_mfma_f32_16x16x32_bf16 v[152:155], v[72:75], v[32:35], v[152:155]
 v_mfma_f32_16x16x32_bf16 v[156:159], v[72:75], v[36:39], v[156:159]
 v_mfma_f32_16x16x32_bf16 v[156:159], v[76:79], v[32:35], v[156:159]
 s_waitcnt lgkmcnt(0)
 v_mfma_f32_16x16x32_bf16 v[144:147], v[208:211], v[176:179], v[144:147]
 ds_read_b128 v[32:35], v14 offset:192
 ds_read2_b32 v[64:65], v16 offset0:64 offset1:65
 v_mfma_f32_16x16x32_bf16 v[148:151], v[208:211], v[180:183], v[148:151]
 ds_read2_b32 v[66:67], v16 offset0:66 offset1:67
 ds_read_b128 v[36:39], v14 offset:704
 v_mfma_f32_16x16x32_bf16 v[152:155], v[208:211], v[184:187], v[152:155]
 ds_read2_b32 v[68:69], v17 offset0:64 offset1:65
 ds_read2_b32 v[70:71], v17 offset0:66 offset1:67
 v_mfma_f32_16x16x32_bf16 v[156:159], v[208:211], v[188:191], v[156:159]
 ds_read_b128 v[40:43], v14 offset:1216
 ds_read2_b32 v[72:73], v18 offset0:64 offset1:65
 v_mfma_f32_16x16x32_bf16 v[148:151], v[212:215], v[176:179], v[148:151]
 ds_read2_b32 v[74:75], v18 offset0:66 offset1:67
 ds_read_b128 v[44:47], v14 offset:1728
 v_mfma_f32_16x16x32_bf16 v[152:155], v[212:215], v[180:183], v[152:155]
 ds_read2_b32 v[76:77], v19 offset0:64 offset1:65
 ds_read2_b32 v[78:79], v19 offset0:66 offset1:67
 v_mfma_f32_16x16x32_bf16 v[156:159], v[212:215], v[184:187], v[156:159]
 v_mfma_f32_16x16x32_bf16 v[152:155], v[216:219], v[176:179], v[152:155]
 v_mfma_f32_16x16x32_bf16 v[156:159], v[216:219], v[180:183], v[156:159]
 v_mfma_f32_16x16x32_bf16 v[156:159], v[220:223], v[176:179], v[156:159]
 s_waitcnt lgkmcnt(0)
 v_mfma_f32_16x16x32_bf16 v[144:147], v[64:67], v[32:35], v[144:147]
 ds_read_b128 v[176:179], v14 offset:128
 ds_read2_b32 v[208:209], v16 offset0:80 offset1:81
 v_mfma_f32_16x16x32_bf16 v[148:151], v[64:67], v[36:39], v[148:151]
 ds_read2_b32 v[210:211], v16 offset0:82 offset1:83
 ds_read_b128 v[180:183], v14 offset:640
 v_mfma_f32_16x16x32_bf16 v[152:155], v[64:67], v[40:43], v[152:155]
 ds_read2_b32 v[212:213], v17 offset0:80 offset1:81
 ds_read2_b32 v[214:215], v17 offset0:82 offset1:83
 v_mfma_f32_16x16x32_bf16 v[156:159], v[64:67], v[44:47], v[156:159]
 ds_read_b128 v[184:187], v14 offset:1152
 ds_read2_b32 v[216:217], v18 offset0:80 offset1:81
 v_mfma_f32_16x16x32_bf16 v[148:151], v[68:71], v[32:35], v[148:151]
 ds_read2_b32 v[218:219], v18 offset0:82 offset1:83
 ds_read_b128 v[188:191], v14 offset:1664
 v_mfma_f32_16x16x32_bf16 v[152:155], v[68:71], v[36:39], v[152:155]
 ds_read2_b32 v[220:221], v19 offset0:80 offset1:81
 ds_read2_b32 v[222:223], v19 offset0:82 offset1:83
 v_mfma_f32_16x16x32_bf16 v[156:159], v[68:71], v[40:43], v[156:159]
 v_mfma_f32_16x16x32_bf16 v[152:155], v[72:75], v[32:35], v[152:155]
 v_mfma_f32_16x16x32_bf16 v[156:159], v[72:75], v[36:39], v[156:159]
 v_mfma_f32_16x16x32_bf16 v[156:159], v[76:79], v[32:35], v[156:159]
 s_waitcnt lgkmcnt(0)
 v_mfma_f32_16x16x32_bf16 v[144:147], v[208:211], v[176:179], v[144:147]
 ds_read_b128 v[32:35], v14 offset:64
 ds_read2_b32 v[64:65], v16 offset0:96 offset1:97
 v_mfma_f32_16x16x32_bf16 v[148:151], v[208:211], v[180:183], v[148:151]
 ds_read2_b32 v[66:67], v16 offset0:98 offset1:99
 ds_read_b128 v[36:39], v14 offset:576
 v_mfma_f32_16x16x32_bf16 v[152:155], v[208:211], v[184:187], v[152:155]
 ds_read2_b32 v[68:69], v17 offset0:96 offset1:97
 ds_read2_b32 v[70:71], v17 offset0:98 offset1:99
 v_mfma_f32_16x16x32_bf16 v[156:159], v[208:211], v[188:191], v[156:159]
 ds_read_b128 v[40:43], v14 offset:1088
 ds_read2_b32 v[72:73], v18 offset0:96 offset1:97
 v_mfma_f32_16x16x32_bf16 v[148:151], v[212:215], v[176:179], v[148:151]
 ds_read2_b32 v[74:75], v18 offset0:98 offset1:99
 ds_read_b128 v[44:47], v14 offset:1600
 v_mfma_f32_16x16x32_bf16 v[152:155], v[212:215], v[180:183], v[152:155]
 ds_read2_b32 v[76:77], v19 offset0:96 offset1:97
 ds_read2_b32 v[78:79], v19 offset0:98 offset1:99
 v_mfma_f32_16x16x32_bf16 v[156:159], v[212:215], v[184:187], v[156:159]
 v_mfma_f32_16x16x32_bf16 v[152:155], v[216:219], v[176:179], v[152:155]
 v_mfma_f32_16x16x32_bf16 v[156:159], v[216:219], v[180:183], v[156:159]
 v_mfma_f32_16x16x32_bf16 v[156:159], v[220:223], v[176:179], v[156:159]
 s_waitcnt lgkmcnt(0)
 v_mfma_f32_16x16x32_bf16 v[144:147], v[64:67], v[32:35], v[144:147]
 ds_read_b128 v[176:179], v14 offset:0
 ds_read2_b32 v[208:209], v16 offset0:112 offset1:113
 v_mfma_f32_16x16x32_bf16 v[148:151], v[64:67], v[36:39], v[148:151]
 ds_read2_b32 v[210:211], v16 offset0:114 offset1:115
 ds_read_b128 v[180:183], v14 offset:512
 v_mfma_f32_16x16x32_bf16 v[152:155], v[64:67], v[40:43], v[152:155]
 ds_read2_b32 v[212:213], v17 offset0:112 offset1:113
 ds_read2_b32 v[214:215], v17 offset0:114 offset1:115
 v_mfma_f32_16x16x32_bf16 v[156:159], v[64:67], v[44:47], v[156:159]
 ds_read_b128 v[184:187], v14 offset:1024
 ds_read2_b32 v[216:217], v18 offset0:112 offset1:113
 v_mfma_f32_16x16x32_bf16 v[148:151], v[68:71], v[32:35], v[148:151]
 ds_read2_b32 v[218:219], v18 offset0:114 offset1:115
 ds_read_b128 v[188:191], v14 offset:1536
 v_mfma_f32_16x16x32_bf16 v[152:155], v[68:71], v[36:39], v[152:155]
 ds_read2_b32 v[220:221], v19 offset0:112 offset1:113
 ds_read2_b32 v[222:223], v19 offset0:114 offset1:115
 v_mfma_f32_16x16x32_bf16 v[156:159], v[68:71], v[40:43], v[156:159]
 v_mfma_f32_16x16x32_bf16 v[152:155], v[72:75], v[32:35], v[152:155]
 v_mfma_f32_16x16x32_bf16 v[156:159], v[72:75], v[36:39], v[156:159]
 v_mfma_f32_16x16x32_bf16 v[156:159], v[76:79], v[32:35], v[156:159]
 s_waitcnt lgkmcnt(0)
 v_mfma_f32_16x16x32_bf16 v[144:147], v[208:211], v[176:179], v[144:147]
 ds_read_b64 v[32:33], v15 offset:0
 ds_read_b64 v[34:35], v15 offset:512
 v_mfma_f32_16x16x32_bf16 v[148:151], v[208:211], v[180:183], v[148:151]
 ds_read_b64 v[36:37], v15 offset:1024
 ds_read_b64 v[38:39], v15 offset:1536
 v_mfma_f32_16x16x32_bf16 v[152:155], v[208:211], v[184:187], v[152:155]
 v_mfma_f32_16x16x32_bf16 v[156:159], v[208:211], v[188:191], v[156:159]
 v_mfma_f32_16x16x32_bf16 v[148:151], v[212:215], v[176:179], v[148:151]
 v_mfma_f32_16x16x32_bf16 v[152:155], v[212:215], v[180:183], v[152:155]
 v_mfma_f32_16x16x32_bf16 v[156:159], v[212:215], v[184:187], v[156:159]
 v_mfma_f32_16x16x32_bf16 v[152:155], v[216:219], v[176:179], v[152:155]
 v_mfma_f32_16x16x32_bf16 v[156:159], v[216:219], v[180:183], v[156:159]
 v_mfma_f32_16x16x32_bf16 v[156:159], v[220:223], v[176:179], v[156:159]
 s_waitcnt lgkmcnt(0)
 v_and_b32 v64, 0xffff0000, v33
 v_lshlrev_b32 v65, 16, v33
 v_and_b32 v66, 0xffff0000, v32
 v_lshlrev_b32 v67, 16, v32
 v_mul_f32 v64, v64, v12
 v_mul_f32 v65, v65, v12
 v_mul_f32 v66, v66, v12
 v_mul_f32 v67, v67, v12
 v_and_b32 v68, 0xffff0000, v35
 v_lshlrev_b32 v69, 16, v35
 v_and_b32 v70, 0xffff0000, v34
 v_lshlrev_b32 v71, 16, v34
 v_mul_f32 v68, v68, v12
 v_mul_f32 v69, v69, v12
 v_mul_f32 v70, v70, v12
 v_mul_f32 v71, v71, v12
 v_and_b32 v72, 0xffff0000, v37
 v_lshlrev_b32 v73, 16, v37
 v_and_b32 v74, 0xffff0000, v36
 v_lshlrev_b32 v75, 16, v36
 v_mul_f32 v72, v72, v12
 v_mul_f32 v73, v73, v12
 v_mul_f32 v74, v74, v12
 v_mul_f32 v75, v75, v12
 v_and_b32 v76, 0xffff0000, v39
 v_lshlrev_b32 v77, 16, v39
 v_and_b32 v78, 0xffff0000, v38
 v_lshlrev_b32 v79, 16, v38
 v_mul_f32 v76, v76, v12
 v_mul_f32 v77, v77, v12
 v_mul_f32 v78, v78, v12
 v_mul_f32 v79, v79, v12
 v_cvt_pk_bf16_f32 v8, v64, v65
 v_lshlrev_b32 v64, 16, v8
 v_and_b32 v65, 0xffff0000, v8
 v_cvt_pk_bf16_f32 v8, v66, v67
 v_lshlrev_b32 v66, 16, v8
 v_and_b32 v67, 0xffff0000, v8
 v_cvt_pk_bf16_f32 v8, v68, v69
 v_lshlrev_b32 v68, 16, v8
 v_and_b32 v69, 0xffff0000, v8
 v_cvt_pk_bf16_f32 v8, v70, v71
 v_lshlrev_b32 v70, 16, v8
 v_and_b32 v71, 0xffff0000, v8
 v_cvt_pk_bf16_f32 v8, v72, v73
 v_lshlrev_b32 v72, 16, v8
 v_and_b32 v73, 0xffff0000, v8
 v_cvt_pk_bf16_f32 v8, v74, v75
 v_lshlrev_b32 v74, 16, v8
 v_and_b32 v75, 0xffff0000, v8
 v_cvt_pk_bf16_f32 v8, v76, v77
 v_lshlrev_b32 v76, 16, v8
 v_and_b32 v77, 0xffff0000, v8
 v_cvt_pk_bf16_f32 v8, v78, v79
 v_lshlrev_b32 v78, 16, v8
 v_and_b32 v79, 0xffff0000, v8
 v_cvt_pk_bf16_f32 v8, v144, v145
 v_lshlrev_b32 v144, 16, v8
 v_and_b32 v145, 0xffff0000, v8
 v_cvt_pk_bf16_f32 v8, v146, v147
 v_lshlrev_b32 v146, 16, v8
 v_and_b32 v147, 0xffff0000, v8
 v_cvt_pk_bf16_f32 v8, v148, v149
 v_lshlrev_b32 v148, 16, v8
 v_and_b32 v149, 0xffff0000, v8
 v_cvt_pk_bf16_f32 v8, v150, v151
 v_lshlrev_b32 v150, 16, v8
 v_and_b32 v151, 0xffff0000, v8
 v_cvt_pk_bf16_f32 v8, v152, v153
 v_lshlrev_b32 v152, 16, v8
 v_and_b32 v153, 0xffff0000, v8
 v_cvt_pk_bf16_f32 v8, v154, v155
 v_lshlrev_b32 v154, 16, v8
 v_and_b32 v155, 0xffff0000, v8
 v_cvt_pk_bf16_f32 v8, v156, v157
 v_lshlrev_b32 v156, 16, v8
 v_and_b32 v157, 0xffff0000, v8
 v_cvt_pk_bf16_f32 v8, v158, v159
 v_lshlrev_b32 v158, 16, v8
 v_and_b32 v159, 0xffff0000, v8
 v_pk_add_f32 v[144:145], v[144:145], v[64:65]
 v_pk_add_f32 v[146:147], v[146:147], v[66:67]
 v_pk_add_f32 v[148:149], v[148:149], v[68:69]
 v_pk_add_f32 v[150:151], v[150:151], v[70:71]
 v_pk_add_f32 v[152:153], v[152:153], v[72:73]
 v_pk_add_f32 v[154:155], v[154:155], v[74:75]
 v_pk_add_f32 v[156:157], v[156:157], v[76:77]
 v_pk_add_f32 v[158:159], v[158:159], v[78:79]
 v_cvt_pk_bf16_f32 v160, v144, v148
 v_cvt_pk_bf16_f32 v161, v152, v156
 buffer_store_dwordx2 v[160:161], v13, s[4:7], s72 offen sc1
 s_add_u32 s72, s72, 40960
 v_cvt_pk_bf16_f32 v162, v145, v149
 v_cvt_pk_bf16_f32 v163, v153, v157
 buffer_store_dwordx2 v[162:163], v13, s[4:7], s72 offen sc1
 s_add_u32 s72, s72, 40960
 v_cvt_pk_bf16_f32 v164, v146, v150
 v_cvt_pk_bf16_f32 v165, v154, v158
 buffer_store_dwordx2 v[164:165], v13, s[4:7], s72 offen sc1
 s_add_u32 s72, s72, 40960
 v_cvt_pk_bf16_f32 v166, v147, v151
 v_cvt_pk_bf16_f32 v167, v155, v159
 buffer_store_dwordx2 v[166:167], v13, s[4:7], s72 offen sc1
 s_add_u32 s72, s72, 40960
 s_cmp_lt_u32 s70, 640
 s_cbranch_scc1 L_cv_4
 s_setpc_b64 s[76:77]
L_conv1:
 s_mov_b32 s8, s38
 s_and_b32 s9, s39, 0xffff
 s_mov_b32 s10, 2621440
 s_mov_b32 s11, 0x00020000
 s_mov_b32 s12, s40
 s_and_b32 s13, s41, 0xffff
 s_mov_b32 s14, 1280
 s_mov_b32 s15, 0x00020000
 v_lshlrev_b32 v130, 4, v0
 v_add_u32 v7, s71, v130
 v_mov_b32 v8, 0
 v_mov_b32 v9, 0
 v_mov_b32 v10, 0
 v_mov_b32 v11, 0
 s_mov_b32 exec_hi, 0
 ds_write_b128 v7, v[8:11] offset:0
 s_mov_b32 exec_lo, 3
 ds_write_b128 v7, v[8:11] offset:4608
 ds_write_b128 v7, v[8:11] offset:8768
 s_mov_b64 exec, -1
 v_and_b32 v8, 15, v0
 v_lshrrev_b32 v9, 5, v0
 v_sub_u32 v10, v8, v9
 v_lshlrev_b32 v10, 5, v10
 v_and_b32 v11, 16, v0
 v_add_u32 v10, v10, v11
 s_add_u32 s3, s71, 64
 v_add_u32 v14, s3, v10
 v_lshlrev_b32 v10, 5, v9
 v_lshl_add_u32 v10, v8, 1, v10
 v_sub_u32 v10, v10, v11
 v_and_b32 v11, 1, v0
 v_cmp_eq_u32 vcc, 1, v11
 v_mov_b32 v12, 8784
 v_mov_b32 v11, 4626
 s_nop 0
 v_cndmask_b32 v11, v12, v11, vcc
 v_add3_u32 v16, v10, v11, s71
 v_add_u32 v17, 512, v16
 v_add_u32 v18, 1024, v16
 v_add_u32 v19, 1536, v16
 v_add_u32 v20, 2048, v16
 v_add_u32 v21, 2560, v16
 v_add_u32 v22, 3072, v16
 v_add_u32 v23, 3584, v16
 v_lshlrev_b32 v10, 5, v8
 v_lshl_add_u32 v10, v9, 4, v10
 v_and_b32 v11, 16, v0
 v_lshrrev_b32 v11, 1, v11
 v_xor_b32 v11, 8, v11
 s_add_u32 s3, s71, 512
 v_add3_u32 v15, v10, v11, s3
 v_and_b32 v10, 1, v0
 v_lshlrev_b32 v10, 4, v10
 v_lshrrev_b32 v11, 4, v0
 v_lshl_add_u32 v10, v11, 2, v10
 s_mov_b32 s3, 40960
 v_mul_lo_u32 v13, v10, s3
 v_lshrrev_b32 v11, 1, v8
 v_lshl_add_u32 v13, v11, 3, v13
 s_waitcnt vmcnt(0)
L_cv_5:
 s_waitcnt vmcnt(4)
 ds_write_b128 v7, v[240:243] offset:512
 ds_write_b128 v7, v[96:99] offset:4640
 ds_write_b128 v7, v[112:115] offset:8800
 ds_write_b128 v7, v[244:247] offset:1536
 ds_write_b128 v7, v[100:103] offset:5664
 ds_write_b128 v7, v[116:119] offset:9824
 ds_write_b128 v7, v[248:251] offset:2560
 ds_write_b128 v7, v[104:107] offset:6688
 ds_write_b128 v7, v[120:123] offset:10848
 ds_write_b128 v7, v[252:255] offset:3584
 ds_write_b128 v7, v[108:111] offset:7712
 ds_write_b128 v7, v[124:127] offset:11872
 v_lshlrev_b32 v8, 16, v96
 v_lshlrev_b32 v12, 16, v128
 s_mov_b64 exec, 1
 ds_write_b32 v7, v8 offset:8796
 s_mov_b64 exec, -1
 s_lshl_b32 s72, s70, 6
 s_add_u32 s72, s72, 202113024
 s_add_u32 s70, s70, s69
 s_waitcnt lgkmcnt(0)
 s_lshl_b32 s73, s70, 12
 s_add_u32 s74, s73, 2
 buffer_load_dwordx4 v[96:99], v130, s[8:11], s73 offen offset:0
 buffer_load_dwordx4 v[100:103], v130, s[8:11], s73 offen offset:1024
 buffer_load_dwordx4 v[104:107], v130, s[8:11], s73 offen offset:2048
 buffer_load_dwordx4 v[108:111], v130, s[8:11], s73 offen offset:3072
 buffer_load_dwordx4 v[112:115], v130, s[8:11], s74 offen offset:0
 buffer_load_dwordx4 v[116:119], v130, s[8:11], s74 offen offset:1024
 buffer_load_dwordx4 v[120:123], v130, s[8:11], s74 offen offset:2048
 buffer_load_dwordx4 v[124:127], v130, s[8:11], s74 offen offset:3072
 s_lshl_b32 s3, s70, 1
 buffer_load_ushort v128, off, s[12:15], s3
 s_lshl_b32 s3, s70, 12
 s_add_u32 s3, s3, 198180864
 buffer_load_dwordx4 v[240:243], v130, s[4:7], s3 offen offset:0 sc1
 buffer_load_dwordx4 v[244:247], v130, s[4:7], s3 offen offset:1024 sc1
 buffer_load_dwordx4 v[248:251], v130, s[4:7], s3 offen offset:2048 sc1
 buffer_load_dwordx4 v[252:255], v130, s[4:7], s3 offen offset:3072 sc1
 ds_read_b128 v[32:35], v14 offset:448
 ds_read2_b32 v[64:65], v16 offset0:0 offset1:1
 ds_read2_b32 v[66:67], v16 offset0:2 offset1:3
 ds_read_b128 v[36:39], v14 offset:960
 ds_read2_b32 v[68:69], v17 offset0:0 offset1:1
 ds_read2_b32 v[70:71], v17 offset0:2 offset1:3
 ds_read_b128 v[40:43], v14 offset:1472
 ds_read2_b32 v[72:73], v18 offset0:0 offset1:1
 ds_read2_b32 v[74:75], v18 offset0:2 offset1:3
 ds_read_b128 v[44:47], v14 offset:1984
 ds_read2_b32 v[76:77], v19 offset0:0 offset1:1
 ds_read2_b32 v[78:79], v19 offset0:2 offset1:3
 ds_read_b128 v[48:51], v14 offset:2496
 ds_read2_b32 v[80:81], v20 offset0:0 offset1:1
 ds_read2_b32 v[82:83], v20 offset0:2 offset1:3
 ds_read_b128 v[52:55], v14 offset:3008
 ds_read2_b32 v[84:85], v21 offset0:0 offset1:1
 ds_read2_b32 v[86:87], v21 offset0:2 offset1:3
 ds_read_b128 v[56:59], v14 offset:3520
 ds_read2_b32 v[88:89], v22 offset0:0 offset1:1
 ds_read2_b32 v[90:91], v22 offset0:2 offset1:3
 ds_read_b128 v[60:63], v14 offset:4032
 ds_read2_b32 v[92:93], v23 offset0:0 offset1:1
 ds_read2_b32 v[94:95], v23 offset0:2 offset1:3
 s_waitcnt lgkmcnt(0)
 v_mfma_f32_16x16x32_bf16 v[144:147], v[64:67], v[48:51], 0
 ds_read_b128 v[176:179], v14 offset:384
 v_mfma_f32_16x16x32_bf16 v[148:151], v[64:67], v[52:55], 0
 ds_read2_b32 v[208:209], v16 offset0:16 offset1:17
 v_mfma_f32_16x16x32_bf16 v[152:155], v[64:67], v[56:59], 0
 ds_read2_b32 v[210:211], v16 offset0:18 offset1:19
 v_mfma_f32_16x16x32_bf16 v[156:159], v[64:67], v[60:63], 0
 ds_read_b128 v[180:183], v14 offset:896
 v_mfma_f32_16x16x32_bf16 v[144:147], v[68:71], v[44:47], v[144:147]
 ds_read2_b32 v[212:213], v17 offset0:16 offset1:17
 v_mfma_f32_16x16x32_bf16 v[148:151], v[68:71], v[48:51], v[148:151]
 ds_read2_b32 v[214:215], v17 offset0:18 offset1:19
 v_mfma_f32_16x16x32_bf16 v[152:155], v[68:71], v[52:55], v[152:155]
 ds_read_b128 v[184:187], v14 offset:1408
 v_mfma_f32_16x16x32_bf16 v[156:159], v[68:71], v[56:59], v[156:159]
 ds_read2_b32 v[216:217], v18 offset0:16 offset1:17
 v_mfma_f32_16x16x32_bf16 v[144:147], v[72:75], v[40:43], v[144:147]
 ds_read2_b32 v[218:219], v18 offset0:18 offset1:19
 v_mfma_f32_16x16x32_bf16 v[148:151], v[72:75], v[44:47], v[148:151]
 ds_read_b128 v[188:191], v14 offset:1920
 v_mfma_f32_16x16x32_bf16 v[152:155], v[72:75], v[48:51], v[152:155]
 ds_read2_b32 v[220:221], v19 offset0:16 offset1:17
 v_mfma_f32_16x16x32_bf16 v[156:159], v[72:75], v[52:55], v[156:159]
 ds_read2_b32 v[222:223], v19 offset0:18 offset1:19
 v_mfma_f32_16x16x32_bf16 v[144:147], v[76:79], v[36:39], v[144:147]
 ds_read_b128 v[192:195], v14 offset:2432
 v_mfma_f32_16x16x32_bf16 v[148:151], v[76:79], v[40:43], v[148:151]
 ds_read2_b32 v[224:225], v20 offset0:16 offset1:17
 v_mfma_f32_16x16x32_bf16 v[152:155], v[76:79], v[44:47], v[152:155]
 ds_read2_b32 v[226:227], v20 offset0:18 offset1:19
 v_mfma_f32_16x16x32_bf16 v[156:159], v[76:79], v[48:51], v[156:159]
 ds_read_b128 v[196:199], v14 offset:2944
 v_mfma_f32_16x16x32_bf16 v[144:147], v[80:83], v[32:35], v[144:147]
 ds_read2_b32 v[228:229], v21 offset0:16 offset1:17
 v_mfma_f32_16x16x32_bf16 v[148:151], v[80:83], v[36:39], v[148:151]
 ds_read2_b32 v[230:231], v21 offset0:18 offset1:19
 v_mfma_f32_16x16x32_bf16 v[152:155], v[80:83], v[40:43], v[152:155]
 ds_read_b128 v[200:203], v14 offset:3456
 v_mfma_f32_16x16x32_bf16 v[156:159], v[80:83], v[44:47], v[156:159]
 ds_read2_b32 v[232:233], v22 offset0:16 offset1:17
 v_mfma_f32_16x16x32_bf16 v[148:151], v[84:87], v[32:35], v[148:151]
 ds_read2_b32 v[234:235], v22 offset0:18 offset1:19
 v_mfma_f32_16x16x32_bf16 v[152:155], v[84:87], v[36:39], v[152:155]
 ds_read_b128 v[204:207], v14 offset:3968
 v_mfma_f32_16x16x32_bf16 v[156:159], v[84:87], v[40:43], v[156:159]
 ds_read2_b32 v[236:237], v23 offset0:16 offset1:17
 v_mfma_f32_16x16x32_bf16 v[152:155], v[88:91], v[32:35], v[152:155]
 ds_read2_b32 v[238:239], v23 offset0:18 offset1:19
 v_mfma_f32_16x16x32_bf16 v[156:159], v[88:91], v[36:39], v[156:159]
 v_mfma_f32_16x16x32_bf16 v[156:159], v[92:95], v[32:35], v[156:159]
 s_waitcnt lgkmcnt(0)
 v_mfma_f32_16x16x32_bf16 v[144:147], v[208:211], v[192:195], v[144:147]
 ds_read_b128 v[32:35], v14 offset:320
 v_mfma_f32_16x16x32_bf16 v[148:151], v[208:211], v[196:199], v[148:151]
 ds_read2_b32 v[64:65], v16 offset0:32 offset1:33
 v_mfma_f32_16x16x32_bf16 v[152:155], v[208:211], v[200:203], v[152:155]
 ds_read2_b32 v[66:67], v16 offset0:34 offset1:35
 v_mfma_f32_16x16x32_bf16 v[156:159], v[208:211], v[204:207], v[156:159]
 ds_read_b128 v[36:39], v14 offset:832
 v_mfma_f32_16x16x32_bf16 v[144:147], v[212:215], v[188:191], v[144:147]
 ds_read2_b32 v[68:69], v17 offset0:32 offset1:33
 v_mfma_f32_16x16x32_bf16 v[148:151], v[212:215], v[192:195], v[148:151]
 ds_read2_b32 v[70:71], v17 offset0:34 offset1:35
 v_mfma_f32_16x16x32_bf16 v[152:155], v[212:215], v[196:199], v[152:155]
 ds_read_b128 v[40:43], v14 offset:1344
 v_mfma_f32_16x16x32_bf16 v[156:159], v[212:215], v[200:203], v[156:159]
 ds_read2_b32 v[72:73], v18 offset0:32 offset1:33
 v_mfma_f32_16x16x32_bf16 v[144:147], v[216:219], v[184:187], v[144:147]
 ds_read2_b32 v[74:75], v18 offset0:34 offset1:35
 v_mfma_f32_16x16x32_bf16 v[148:151], v[216:219], v[188:191], v[148:151]
 ds_read_b128 v[44:47], v14 offset:1856
 v_mfma_f32_16x16x32_bf16 v[152:155], v[216:219], v[192:195], v[152:155]
 ds_read2_b32 v[76:77], v19 offset0:32 offset1:33
 v_mfma_f32_16x16x32_bf16 v[156:159], v[216:219], v[196:199], v[156:159]
 ds_read2_b32 v[78:79], v19 offset0:34 offset1:35
 v_mfma_f32_16x16x32_bf16 v[144:147], v[220:223], v[180:183], v[144:147]
 ds_read_b128 v[48:51], v14 offset:2368
 v_mfma_f32_16x16x32_bf16 v[148:151], v[220:223], v[184:187], v[148:151]
 ds_read2_b32 v[80:81], v20 offset0:32 offset1:33
 v_mfma_f32_16x16x32_bf16 v[152:155], v[220:223], v[188:191], v[152:155]
 ds_read2_b32 v[82:83], v20 offset0:34 offset1:35
 v_mfma_f32_16x16x32_bf16 v[156:159], v[220:223], v[192:195], v[156:159]
 ds_read_b128 v[52:55], v14 offset:2880
 v_mfma_f32_16x16x32_bf16 v[144:147], v[224:227], v[176:179], v[144:147]
 ds_read2_b32 v[84:85], v21 offset0:32 offset1:33
 v_mfma_f32_16x16x32_bf16 v[148:151], v[224:227], v[180:183], v[148:151]
 ds_read2_b32 v[86:87], v21 offset0:34 offset1:35
 v_mfma_f32_16x16x32_bf16 v[152:155], v[224:227], v[184:187], v[152:155]
 ds_read_b128 v[56:59], v14 offset:3392
 v_mfma_f32_16x16x32_bf16 v[156:159], v[224:227], v[188:191], v[156:159]
 ds_read2_b32 v[88:89], v22 offset0:32 offset1:33
 v_mfma_f32_16x16x32_bf16 v[148:151], v[228:231], v[176:179], v[148:151]
 ds_read2_b32 v[90:91], v22 offset0:34 offset1:35
 v_mfma_f32_16x16x32_bf16 v[152:155], v[228:231], v[180:183], v[152:155]
 ds_read_b128 v[60:63], v14 offset:3904
 v_mfma_f32_16x16x32_bf16 v[156:159], v[228:231], v[184:187], v[156:159]
 ds_read2_b32 v[92:93], v23 offset0:32 offset1:33
 v_mfma_f32_16x16x32_bf16 v[152:155], v[232:235], v[176:179], v[152:155]
 ds_read2_b32 v[94:95], v23 offset0:34 offset1:35
 v_mfma_f32_16x16x32_bf16 v[156:159], v[232:235], v[180:183], v[156:159]
 v_mfma_f32_16x16x32_bf16 v[156:159], v[236:239], v[176:179], v[156:159]
 s_waitcnt lgkmcnt(0)
 v_mfma_f32_16x16x32_bf16 v[144:147], v[64:67], v[48:51], v[144:147]
 ds_read_b128 v[176:179], v14 offset:256
 v_mfma_f32_16x16x32_bf16 v[148:151], v[64:67], v[52:55], v[148:151]
 ds_read2_b32 v[208:209], v16 offset0:48 offset1:49
 v_mfma_f32_16x16x32_bf16 v[152:155], v[64:67], v[56:59], v[152:155]
 ds_read2_b32 v[210:211], v16 offset0:50 offset1:51
 v_mfma_f32_16x16x32_bf16 v[156:159], v[64:67], v[60:63], v[156:159]
 ds_read_b128 v[180:183], v14 offset:768
 v_mfma_f32_16x16x32_bf16 v[144:147], v[68:71], v[44:47], v[144:147]
 ds_read2_b32 v[212:213], v17 offset0:48 offset1:49
 v_mfma_f32_16x16x32_bf16 v[148:151], v[68:71], v[48:51], v[148:151]
 ds_read2_b32 v[214:215], v17 offset0:50 offset1:51
 v_mfma_f32_16x16x32_bf16 v[152:155], v[68:71], v[52:55], v[152:155]
 ds_read_b128 v[184:187], v14 offset:1280
 v_mfma_f32_16x16x32_bf16 v[156:159], v[68:71], v[56:59], v[156:159]
 ds_read2_b32 v[216:217], v18 offset0:48 offset1:49
 v_mfma_f32_16x16x32_bf16 v[144:147], v[72:75], v[40:43], v[144:147]
 ds_read2_b32 v[218:219], v18 offset0:50 offset1:51
 v_mfma_f32_16x16x32_bf16 v[148:151], v[72:75], v[44:47], v[148:151]
 ds_read_b128 v[188:191], v14 offset:1792
 v_mfma_f32_16x16x32_bf16 v[152:155], v[72:75], v[48:51], v[152:155]
 ds_read2_b32 v[220:221], v19 offset0:48 offset1:49
 v_mfma_f32_16x16x32_bf16 v[156:159], v[72:75], v[52:55], v[156:159]
 ds_read2_b32 v[222:223], v19 offset0:50 offset1:51
 v_mfma_f32_16x16x32_bf16 v[144:147], v[76:79], v[36:39], v[144:147]
 ds_read_b128 v[192:195], v14 offset:2304
 v_mfma_f32_16x16x32_bf16 v[148:151], v[76:79], v[40:43], v[148:151]
 ds_read2_b32 v[224:225], v20 offset0:48 offset1:49
 v_mfma_f32_16x16x32_bf16 v[152:155], v[76:79], v[44:47], v[152:155]
 ds_read2_b32 v[226:227], v20 offset0:50 offset1:51
 v_mfma_f32_16x16x32_bf16 v[156:159], v[76:79], v[48:51], v[156:159]
 ds_read_b128 v[196:199], v14 offset:2816
 v_mfma_f32_16x16x32_bf16 v[144:147], v[80:83], v[32:35], v[144:147]
 ds_read2_b32 v[228:229], v21 offset0:48 offset1:49
 v_mfma_f32_16x16x32_bf16 v[148:151], v[80:83], v[36:39], v[148:151]
 ds_read2_b32 v[230:231], v21 offset0:50 offset1:51
 v_mfma_f32_16x16x32_bf16 v[152:155], v[80:83], v[40:43], v[152:155]
 ds_read_b128 v[200:203], v14 offset:3328
 v_mfma_f32_16x16x32_bf16 v[156:159], v[80:83], v[44:47], v[156:159]
 ds_read2_b32 v[232:233], v22 offset0:48 offset1:49
 v_mfma_f32_16x16x32_bf16 v[148:151], v[84:87], v[32:35], v[148:151]
 ds_read2_b32 v[234:235], v22 offset0:50 offset1:51
 v_mfma_f32_16x16x32_bf16 v[152:155], v[84:87], v[36:39], v[152:155]
 ds_read_b128 v[204:207], v14 offset:3840
 v_mfma_f32_16x16x32_bf16 v[156:159], v[84:87], v[40:43], v[156:159]
 ds_read2_b32 v[236:237], v23 offset0:48 offset1:49
 v_mfma_f32_16x16x32_bf16 v[152:155], v[88:91], v[32:35], v[152:155]
 ds_read2_b32 v[238:239], v23 offset0:50 offset1:51
 v_mfma_f32_16x16x32_bf16 v[156:159], v[88:91], v[36:39], v[156:159]
 v_mfma_f32_16x16x32_bf16 v[156:159], v[92:95], v[32:35], v[156:159]
 s_waitcnt lgkmcnt(0)
 v_mfma_f32_16x16x32_bf16 v[144:147], v[208:211], v[192:195], v[144:147]
 ds_read_b128 v[32:35], v14 offset:192
 v_mfma_f32_16x16x32_bf16 v[148:151], v[208:211], v[196:199], v[148:151]
 ds_read2_b32 v[64:65], v16 offset0:64 offset1:65
 v_mfma_f32_16x16x32_bf16 v[152:155], v[208:211], v[200:203], v[152:155]
 ds_read2_b32 v[66:67], v16 offset0:66 offset1:67
 v_mfma_f32_16x16x32_bf16 v[156:159], v[208:211], v[204:207], v[156:159]
 ds_read_b128 v[36:39], v14 offset:704
 v_mfma_f32_16x16x32_bf16 v[144:147], v[212:215], v[188:191], v[144:147]
 ds_read2_b32 v[68:69], v17 offset0:64 offset1:65
 v_mfma_f32_16x16x32_bf16 v[148:151], v[212:215], v[192:195], v[148:151]
 ds_read2_b32 v[70:71], v17 offset0:66 offset1:67
 v_mfma_f32_16x16x32_bf16 v[152:155], v[212:215], v[196:199], v[152:155]
 ds_read_b128 v[40:43], v14 offset:1216
 v_mfma_f32_16x16x32_bf16 v[156:159], v[212:215], v[200:203], v[156:159]
 ds_read2_b32 v[72:73], v18 offset0:64 offset1:65
 v_mfma_f32_16x16x32_bf16 v[144:147], v[216:219], v[184:187], v[144:147]
 ds_read2_b32 v[74:75], v18 offset0:66 offset1:67
 v_mfma_f32_16x16x32_bf16 v[148:151], v[216:219], v[188:191], v[148:151]
 ds_read_b128 v[44:47], v14 offset:1728
 v_mfma_f32_16x16x32_bf16 v[152:155], v[216:219], v[192:195], v[152:155]
 ds_read2_b32 v[76:77], v19 offset0:64 offset1:65
 v_mfma_f32_16x16x32_bf16 v[156:159], v[216:219], v[196:199], v[156:159]
 ds_read2_b32 v[78:79], v19 offset0:66 offset1:67
 v_mfma_f32_16x16x32_bf16 v[144:147], v[220:223], v[180:183], v[144:147]
 ds_read_b128 v[48:51], v14 offset:2240
 v_mfma_f32_16x16x32_bf16 v[148:151], v[220:223], v[184:187], v[148:151]
 ds_read2_b32 v[80:81], v20 offset0:64 offset1:65
 v_mfma_f32_16x16x32_bf16 v[152:155], v[220:223], v[188:191], v[152:155]
 ds_read2_b32 v[82:83], v20 offset0:66 offset1:67
 v_mfma_f32_16x16x32_bf16 v[156:159], v[220:223], v[192:195], v[156:159]
 ds_read_b128 v[52:55], v14 offset:2752
 v_mfma_f32_16x16x32_bf16 v[144:147], v[224:227], v[176:179], v[144:147]
 ds_read2_b32 v[84:85], v21 offset0:64 offset1:65
 v_mfma_f32_16x16x32_bf16 v[148:151], v[224:227], v[180:183], v[148:151]
 ds_read2_b32 v[86:87], v21 offset0:66 offset1:67
 v_mfma_f32_16x16x32_bf16 v[152:155], v[224:227], v[184:187], v[152:155]
 ds_read_b128 v[56:59], v14 offset:3264
 v_mfma_f32_16x16x32_bf16 v[156:159], v[224:227], v[188:191], v[156:159]
 ds_read2_b32 v[88:89], v22 offset0:64 offset1:65
 v_mfma_f32_16x16x32_bf16 v[148:151], v[228:231], v[176:179], v[148:151]
 ds_read2_b32 v[90:91], v22 offset0:66 offset1:67
 v_mfma_f32_16x16x32_bf16 v[152:155], v[228:231], v[180:183], v[152:155]
 ds_read_b128 v[60:63], v14 offset:3776
 v_mfma_f32_16x16x32_bf16 v[156:159], v[228:231], v[184:187], v[156:159]
 ds_read2_b32 v[92:93], v23 offset0:64 offset1:65
 v_mfma_f32_16x16x32_bf16 v[152:155], v[232:235], v[176:179], v[152:155]
 ds_read2_b32 v[94:95], v23 offset0:66 offset1:67
 v_mfma_f32_16x16x32_bf16 v[156:159], v[232:235], v[180:183], v[156:159]
 v_mfma_f32_16x16x32_bf16 v[156:159], v[236:239], v[176:179], v[156:159]
 s_waitcnt lgkmcnt(0)
 v_mfma_f32_16x16x32_bf16 v[144:147], v[64:67], v[48:51], v[144:147]
 ds_read_b128 v[176:179], v14 offset:128
 v_mfma_f32_16x16x32_bf16 v[148:151], v[64:67], v[52:55], v[148:151]
 ds_read2_b32 v[208:209], v16 offset0:80 offset1:81
 v_mfma_f32_16x16x32_bf16 v[152:155], v[64:67], v[56:59], v[152:155]
 ds_read2_b32 v[210:211], v16 offset0:82 offset1:83
 v_mfma_f32_16x16x32_bf16 v[156:159], v[64:67], v[60:63], v[156:159]
 ds_read_b128 v[180:183], v14 offset:640
 v_mfma_f32_16x16x32_bf16 v[144:147], v[68:71], v[44:47], v[144:147]
 ds_read2_b32 v[212:213], v17 offset0:80 offset1:81
 v_mfma_f32_16x16x32_bf16 v[148:151], v[68:71], v[48:51], v[148:151]
 ds_read2_b32 v[214:215], v17 offset0:82 offset1:83
 v_mfma_f32_16x16x32_bf16 v[152:155], v[68:71], v[52:55], v[152:155]
 ds_read_b128 v[184:187], v14 offset:1152
 v_mfma_f32_16x16x32_bf16 v[156:159], v[68:71], v[56:59], v[156:159]
 ds_read2_b32 v[216:217], v18 offset0:80 offset1:81
 v_mfma_f32_16x16x32_bf16 v[144:147], v[72:75], v[40:43], v[144:147]
 ds_read2_b32 v[218:219], v18 offset0:82 offset1:83
 v_mfma_f32_16x16x32_bf16 v[148:151], v[72:75], v[44:47], v[148:151]
 ds_read_b128 v[188:191], v14 offset:1664
 v_mfma_f32_16x16x32_bf16 v[152:155], v[72:75], v[48:51], v[152:155]
 ds_read2_b32 v[220:221], v19 offset0:80 offset1:81
 v_mfma_f32_16x16x32_bf16 v[156:159], v[72:75], v[52:55], v[156:159]
 ds_read2_b32 v[222:223], v19 offset0:82 offset1:83
 v_mfma_f32_16x16x32_bf16 v[144:147], v[76:79], v[36:39], v[144:147]
 ds_read_b128 v[192:195], v14 offset:2176
 v_mfma_f32_16x16x32_bf16 v[148:151], v[76:79], v[40:43], v[148:151]
 ds_read2_b32 v[224:225], v20 offset0:80 offset1:81
 v_mfma_f32_16x16x32_bf16 v[152:155], v[76:79], v[44:47], v[152:155]
 ds_read2_b32 v[226:227], v20 offset0:82 offset1:83
 v_mfma_f32_16x16x32_bf16 v[156:159], v[76:79], v[48:51], v[156:159]
 ds_read_b128 v[196:199], v14 offset:2688
 v_mfma_f32_16x16x32_bf16 v[144:147], v[80:83], v[32:35], v[144:147]
 ds_read2_b32 v[228:229], v21 offset0:80 offset1:81
 v_mfma_f32_16x16x32_bf16 v[148:151], v[80:83], v[36:39], v[148:151]
 ds_read2_b32 v[230:231], v21 offset0:82 offset1:83
 v_mfma_f32_16x16x32_bf16 v[152:155], v[80:83], v[40:43], v[152:155]
 ds_read_b128 v[200:203], v14 offset:3200
 v_mfma_f32_16x16x32_bf16 v[156:159], v[80:83], v[44:47], v[156:159]
 ds_read2_b32 v[232:233], v22 offset0:80 offset1:81
 v_mfma_f32_16x16x32_bf16 v[148:151], v[84:87], v[32:35], v[148:151]
 ds_read2_b32 v[234:235], v22 offset0:82 offset1:83
 v_mfma_f32_16x16x32_bf16 v[152:155], v[84:87], v[36:39], v[152:155]
 ds_read_b128 v[204:207], v14 offset:3712
 v_mfma_f32_16x16x32_bf16 v[156:159], v[84:87], v[40:43], v[156:159]
 ds_read2_b32 v[236:237], v23 offset0:80 offset1:81
 v_mfma_f32_16x16x32_bf16 v[152:155], v[88:91], v[32:35], v[152:155]
 ds_read2_b32 v[238:239], v23 offset0:82 offset1:83
 v_mfma_f32_16x16x32_bf16 v[156:159], v[88:91], v[36:39], v[156:159]
 v_mfma_f32_16x16x32_bf16 v[156:159], v[92:95], v[32:35], v[156:159]
 s_waitcnt lgkmcnt(0)
 v_mfma_f32_16x16x32_bf16 v[144:147], v[208:211], v[192:195], v[144:147]
 ds_read_b128 v[32:35], v14 offset:64
 v_mfma_f32_16x16x32_bf16 v[148:151], v[208:211], v[196:199], v[148:151]
 ds_read2_b32 v[64:65], v16 offset0:96 offset1:97
 v_mfma_f32_16x16x32_bf16 v[152:155], v[208:211], v[200:203], v[152:155]
 ds_read2_b32 v[66:67], v16 offset0:98 offset1:99
 v_mfma_f32_16x16x32_bf16 v[156:159], v[208:211], v[204:207], v[156:159]
 ds_read_b128 v[36:39], v14 offset:576
 v_mfma_f32_16x16x32_bf16 v[144:147], v[212:215], v[188:191], v[144:147]
 ds_read2_b32 v[68:69], v17 offset0:96 offset1:97
 v_mfma_f32_16x16x32_bf16 v[148:151], v[212:215], v[192:195], v[148:151]
 ds_read2_b32 v[70:71], v17 offset0:98 offset1:99
 v_mfma_f32_16x16x32_bf16 v[152:155], v[212:215], v[196:199], v[152:155]
 ds_read_b128 v[40:43], v14 offset:1088
 v_mfma_f32_16x16x32_bf16 v[156:159], v[212:215], v[200:203], v[156:159]
 ds_read2_b32 v[72:73], v18 offset0:96 offset1:97
 v_mfma_f32_16x16x32_bf16 v[144:147], v[216:219], v[184:187], v[144:147]
 ds_read2_b32 v[74:75], v18 offset0:98 offset1:99
 v_mfma_f32_16x16x32_bf16 v[148:151], v[216:219], v[188:191], v[148:151]
 ds_read_b128 v[44:47], v14 offset:1600
 v_mfma_f32_16x16x32_bf16 v[152:155], v[216:219], v[192:195], v[152:155]
 ds_read2_b32 v[76:77], v19 offset0:96 offset1:97
 v_mfma_f32_16x16x32_bf16 v[156:159], v[216:219], v[196:199], v[156:159]
 ds_read2_b32 v[78:79], v19 offset0:98 offset1:99
 v_mfma_f32_16x16x32_bf16 v[144:147], v[220:223], v[180:183], v[144:147]
 ds_read_b128 v[48:51], v14 offset:2112
 v_mfma_f32_16x16x32_bf16 v[148:151], v[220:223], v[184:187], v[148:151]
 ds_read2_b32 v[80:81], v20 offset0:96 offset1:97
 v_mfma_f32_16x16x32_bf16 v[152:155], v[220:223], v[188:191], v[152:155]
 ds_read2_b32 v[82:83], v20 offset0:98 offset1:99
 v_mfma_f32_16x16x32_bf16 v[156:159], v[220:223], v[192:195], v[156:159]
 ds_read_b128 v[52:55], v14 offset:2624
 v_mfma_f32_16x16x32_bf16 v[144:147], v[224:227], v[176:179], v[144:147]
 ds_read2_b32 v[84:85], v21 offset0:96 offset1:97
 v_mfma_f32_16x16x32_bf16 v[148:151], v[224:227], v[180:183], v[148:151]
 ds_read2_b32 v[86:87], v21 offset0:98 offset1:99
 v_mfma_f32_16x16x32_bf16 v[152:155], v[224:227], v[184:187], v[152:155]
 ds_read_b128 v[56:59], v14 offset:3136
 v_mfma_f32_16x16x32_bf16 v[156:159], v[224:227], v[188:191], v[156:159]
 ds_read2_b32 v[88:89], v22 offset0:96 offset1:97
 v_mfma_f32_16x16x32_bf16 v[148:151], v[228:231], v[176:179], v[148:151]
 ds_read2_b32 v[90:91], v22 offset0:98 offset1:99
 v_mfma_f32_16x16x32_bf16 v[152:155], v[228:231], v[180:183], v[152:155]
 ds_read_b128 v[60:63], v14 offset:3648
 v_mfma_f32_16x16x32_bf16 v[156:159], v[228:231], v[184:187], v[156:159]
 ds_read2_b32 v[92:93], v23 offset0:96 offset1:97
 v_mfma_f32_16x16x32_bf16 v[152:155], v[232:235], v[176:179], v[152:155]
 ds_read2_b32 v[94:95], v23 offset0:98 offset1:99
 v_mfma_f32_16x16x32_bf16 v[156:159], v[232:235], v[180:183], v[156:159]
 v_mfma_f32_16x16x32_bf16 v[156:159], v[236:239], v[176:179], v[156:159]
 s_waitcnt lgkmcnt(0)
 v_mfma_f32_16x16x32_bf16 v[144:147], v[64:67], v[48:51], v[144:147]
 ds_read_b128 v[176:179], v14 offset:0
 v_mfma_f32_16x16x32_bf16 v[148:151], v[64:67], v[52:55], v[148:151]
 ds_read2_b32 v[208:209], v16 offset0:112 offset1:113
 v_mfma_f32_16x16x32_bf16 v[152:155], v[64:67], v[56:59], v[152:155]
 ds_read2_b32 v[210:211], v16 offset0:114 offset1:115
 v_mfma_f32_16x16x32_bf16 v[156:159], v[64:67], v[60:63], v[156:159]
 ds_read_b128 v[180:183], v14 offset:512
 v_mfma_f32_16x16x32_bf16 v[144:147], v[68:71], v[44:47], v[144:147]
 ds_read2_b32 v[212:213], v17 offset0:112 offset1:113
 v_mfma_f32_16x16x32_bf16 v[148:151], v[68:71], v[48:51], v[148:151]
 ds_read2_b32 v[214:215], v17 offset0:114 offset1:115
 v_mfma_f32_16x16x32_bf16 v[152:155], v[68:71], v[52:55], v[152:155]
 ds_read_b128 v[184:187], v14 offset:1024
 v_mfma_f32_16x16x32_bf16 v[156:159], v[68:71], v[56:59], v[156:159]
 ds_read2_b32 v[216:217], v18 offset0:112 offset1:113
 v_mfma_f32_16x16x32_bf16 v[144:147], v[72:75], v[40:43], v[144:147]
 ds_read2_b32 v[218:219], v18 offset0:114 offset1:115
 v_mfma_f32_16x16x32_bf16 v[148:151], v[72:75], v[44:47], v[148:151]
 ds_read_b128 v[188:191], v14 offset:1536
 v_mfma_f32_16x16x32_bf16 v[152:155], v[72:75], v[48:51], v[152:155]
 ds_read2_b32 v[220:221], v19 offset0:112 offset1:113
 v_mfma_f32_16x16x32_bf16 v[156:159], v[72:75], v[52:55], v[156:159]
 ds_read2_b32 v[222:223], v19 offset0:114 offset1:115
 v_mfma_f32_16x16x32_bf16 v[144:147], v[76:79], v[36:39], v[144:147]
 ds_read_b128 v[192:195], v14 offset:2048
 v_mfma_f32_16x16x32_bf16 v[148:151], v[76:79], v[40:43], v[148:151]
 ds_read2_b32 v[224:225], v20 offset0:112 offset1:113
 v_mfma_f32_16x16x32_bf16 v[152:155], v[76:79], v[44:47], v[152:155]
 ds_read2_b32 v[226:227], v20 offset0:114 offset1:115
 v_mfma_f32_16x16x32_bf16 v[156:159], v[76:79], v[48:51], v[156:159]
 ds_read_b128 v[196:199], v14 offset:2560
 v_mfma_f32_16x16x32_bf16 v[144:147], v[80:83], v[32:35], v[144:147]
 ds_read2_b32 v[228:229], v21 offset0:112 offset1:113
 v_mfma_f32_16x16x32_bf16 v[148:151], v[80:83], v[36:39], v[148:151]
 ds_read2_b32 v[230:231], v21 offset0:114 offset1:115
 v_mfma_f32_16x16x32_bf16 v[152:155], v[80:83], v[40:43], v[152:155]
 ds_read_b128 v[200:203], v14 offset:3072
 v_mfma_f32_16x16x32_bf16 v[156:159], v[80:83], v[44:47], v[156:159]
 ds_read2_b32 v[232:233], v22 offset0:112 offset1:113
 v_mfma_f32_16x16x32_bf16 v[148:151], v[84:87], v[32:35], v[148:151]
 ds_read2_b32 v[234:235], v22 offset0:114 offset1:115
 v_mfma_f32_16x16x32_bf16 v[152:155], v[84:87], v[36:39], v[152:155]
 ds_read_b128 v[204:207], v14 offset:3584
 v_mfma_f32_16x16x32_bf16 v[156:159], v[84:87], v[40:43], v[156:159]
 ds_read2_b32 v[236:237], v23 offset0:112 offset1:113
 v_mfma_f32_16x16x32_bf16 v[152:155], v[88:91], v[32:35], v[152:155]
 ds_read2_b32 v[238:239], v23 offset0:114 offset1:115
 v_mfma_f32_16x16x32_bf16 v[156:159], v[88:91], v[36:39], v[156:159]
 v_mfma_f32_16x16x32_bf16 v[156:159], v[92:95], v[32:35], v[156:159]
 s_waitcnt lgkmcnt(0)
 v_mfma_f32_16x16x32_bf16 v[144:147], v[208:211], v[192:195], v[144:147]
 ds_read_b64 v[32:33], v15 offset:2048
 v_mfma_f32_16x16x32_bf16 v[148:151], v[208:211], v[196:199], v[148:151]
 ds_read_b64 v[34:35], v15 offset:2560
 v_mfma_f32_16x16x32_bf16 v[152:155], v[208:211], v[200:203], v[152:155]
 ds_read_b64 v[36:37], v15 offset:3072
 v_mfma_f32_16x16x32_bf16 v[156:159], v[208:211], v[204:207], v[156:159]
 ds_read_b64 v[38:39], v15 offset:3584
 v_mfma_f32_16x16x32_bf16 v[144:147], v[212:215], v[188:191], v[144:147]
 v_mfma_f32_16x16x32_bf16 v[148:151], v[212:215], v[192:195], v[148:151]
 v_mfma_f32_16x16x32_bf16 v[152:155], v[212:215], v[196:199], v[152:155]
 v_mfma_f32_16x16x32_bf16 v[156:159], v[212:215], v[200:203], v[156:159]
 v_mfma_f32_16x16x32_bf16 v[144:147], v[216:219], v[184:187], v[144:147]
 v_mfma_f32_16x16x32_bf16 v[148:151], v[216:219], v[188:191], v[148:151]
 v_mfma_f32_16x16x32_bf16 v[152:155], v[216:219], v[192:195], v[152:155]
 v_mfma_f32_16x16x32_bf16 v[156:159], v[216:219], v[196:199], v[156:159]
 v_mfma_f32_16x16x32_bf16 v[144:147], v[220:223], v[180:183], v[144:147]
 v_mfma_f32_16x16x32_bf16 v[148:151], v[220:223], v[184:187], v[148:151]
 v_mfma_f32_16x16x32_bf16 v[152:155], v[220:223], v[188:191], v[152:155]
 v_mfma_f32_16x16x32_bf16 v[156:159], v[220:223], v[192:195], v[156:159]
 v_mfma_f32_16x16x32_bf16 v[144:147], v[224:227], v[176:179], v[144:147]
 v_mfma_f32_16x16x32_bf16 v[148:151], v[224:227], v[180:183], v[148:151]
 v_mfma_f32_16x16x32_bf16 v[152:155], v[224:227], v[184:187], v[152:155]
 v_mfma_f32_16x16x32_bf16 v[156:159], v[224:227], v[188:191], v[156:159]
 v_mfma_f32_16x16x32_bf16 v[148:151], v[228:231], v[176:179], v[148:151]
 v_mfma_f32_16x16x32_bf16 v[152:155], v[228:231], v[180:183], v[152:155]
 v_mfma_f32_16x16x32_bf16 v[156:159], v[228:231], v[184:187], v[156:159]
 v_mfma_f32_16x16x32_bf16 v[152:155], v[232:235], v[176:179], v[152:155]
 v_mfma_f32_16x16x32_bf16 v[156:159], v[232:235], v[180:183], v[156:159]
 v_mfma_f32_16x16x32_bf16 v[156:159], v[236:239], v[176:179], v[156:159]
 s_waitcnt lgkmcnt(0)
 v_and_b32 v64, 0xffff0000, v33
 v_lshlrev_b32 v65, 16, v33
 v_and_b32 v66, 0xffff0000, v32
 v_lshlrev_b32 v67, 16, v32
 v_mul_f32 v64, v64, v12
 v_mul_f32 v65, v65, v12
 v_mul_f32 v66, v66, v12
 v_mul_f32 v67, v67, v12
 v_and_b32 v68, 0xffff0000, v35
 v_lshlrev_b32 v69, 16, v35
 v_and_b32 v70, 0xffff0000, v34
 v_lshlrev_b32 v71, 16, v34
 v_mul_f32 v68, v68, v12
 v_mul_f32 v69, v69, v12
 v_mul_f32 v70, v70, v12
 v_mul_f32 v71, v71, v12
 v_and_b32 v72, 0xffff0000, v37
 v_lshlrev_b32 v73, 16, v37
 v_and_b32 v74, 0xffff0000, v36
 v_lshlrev_b32 v75, 16, v36
 v_mul_f32 v72, v72, v12
 v_mul_f32 v73, v73, v12
 v_mul_f32 v74, v74, v12
 v_mul_f32 v75, v75, v12
 v_and_b32 v76, 0xffff0000, v39
 v_lshlrev_b32 v77, 16, v39
 v_and_b32 v78, 0xffff0000, v38
 v_lshlrev_b32 v79, 16, v38
 v_mul_f32 v76, v76, v12
 v_mul_f32 v77, v77, v12
 v_mul_f32 v78, v78, v12
 v_mul_f32 v79, v79, v12
 v_cvt_pk_bf16_f32 v8, v64, v65
 v_lshlrev_b32 v64, 16, v8
 v_and_b32 v65, 0xffff0000, v8
 v_cvt_pk_bf16_f32 v8, v66, v67
 v_lshlrev_b32 v66, 16, v8
 v_and_b32 v67, 0xffff0000, v8
 v_cvt_pk_bf16_f32 v8, v68, v69
 v_lshlrev_b32 v68, 16, v8
 v_and_b32 v69, 0xffff0000, v8
 v_cvt_pk_bf16_f32 v8, v70, v71
 v_lshlrev_b32 v70, 16, v8
 v_and_b32 v71, 0xffff0000, v8
 v_cvt_pk_bf16_f32 v8, v72, v73
 v_lshlrev_b32 v72, 16, v8
 v_and_b32 v73, 0xffff0000, v8
 v_cvt_pk_bf16_f32 v8, v74, v75
 v_lshlrev_b32 v74, 16, v8
 v_and_b32 v75, 0xffff0000, v8
 v_cvt_pk_bf16_f32 v8, v76, v77
 v_lshlrev_b32 v76, 16, v8
 v_and_b32 v77, 0xffff0000, v8
 v_cvt_pk_bf16_f32 v8, v78, v79
 v_lshlrev_b32 v78, 16, v8
 v_and_b32 v79, 0xffff0000, v8
 v_cvt_pk_bf16_f32 v8, v144, v145
 v_lshlrev_b32 v144, 16, v8
 v_and_b32 v145, 0xffff0000, v8
 v_cvt_pk_bf16_f32 v8, v146, v147
 v_lshlrev_b32 v146, 16, v8
 v_and_b32 v147, 0xffff0000, v8
 v_cvt_pk_bf16_f32 v8, v148, v149
 v_lshlrev_b32 v148, 16, v8
 v_and_b32 v149, 0xffff0000, v8
 v_cvt_pk_bf16_f32 v8, v150, v151
 v_lshlrev_b32 v150, 16, v8
 v_and_b32 v151, 0xffff0000, v8
 v_cvt_pk_bf16_f32 v8, v152, v153
 v_lshlrev_b32 v152, 16, v8
 v_and_b32 v153, 0xffff0000, v8
 v_cvt_pk_bf16_f32 v8, v154, v155
 v_lshlrev_b32 v154, 16, v8
 v_and_b32 v155, 0xffff0000, v8
 v_cvt_pk_bf16_f32 v8, v156, v157
 v_lshlrev_b32 v156, 16, v8
 v_and_b32 v157, 0xffff0000, v8
 v_cvt_pk_bf16_f32 v8, v158, v159
 v_lshlrev_b32 v158, 16, v8
 v_and_b32 v159, 0xffff0000, v8
 v_pk_add_f32 v[144:145], v[144:145], v[64:65]
 v_pk_add_f32 v[146:147], v[146:147], v[66:67]
 v_pk_add_f32 v[148:149], v[148:149], v[68:69]
 v_pk_add_f32 v[150:151], v[150:151], v[70:71]
 v_pk_add_f32 v[152:153], v[152:153], v[72:73]
 v_pk_add_f32 v[154:155], v[154:155], v[74:75]
 v_pk_add_f32 v[156:157], v[156:157], v[76:77]
 v_pk_add_f32 v[158:159], v[158:159], v[78:79]
 v_cvt_pk_bf16_f32 v160, v144, v148
 v_cvt_pk_bf16_f32 v161, v152, v156
 buffer_store_dwordx2 v[160:161], v13, s[4:7], s72 offen sc1
 s_add_u32 s72, s72, 40960
 v_cvt_pk_bf16_f32 v162, v145, v149
 v_cvt_pk_bf16_f32 v163, v153, v157
 buffer_store_dwordx2 v[162:163], v13, s[4:7], s72 offen sc1
 s_add_u32 s72, s72, 40960
 v_cvt_pk_bf16_f32 v164, v146, v150
 v_cvt_pk_bf16_f32 v165, v154, v158
 buffer_store_dwordx2 v[164:165], v13, s[4:7], s72 offen sc1
 s_add_u32 s72, s72, 40960
 v_cvt_pk_bf16_f32 v166, v147, v151
 v_cvt_pk_bf16_f32 v167, v155, v159
 buffer_store_dwordx2 v[166:167], v13, s[4:7], s72 offen sc1
 s_add_u32 s72, s72, 40960
 s_cmp_lt_u32 s70, 640
 s_cbranch_scc1 L_cv_5
 s_setpc_b64 s[76:77]
L_helper:
 s_and_b32 s3, s82, 0x78
 s_cmp_lg_u32 s3, 80
 s_cbranch_scc1 L_np_7
 s_cmp_lg_u32 s50, 0
 s_cbranch_scc1 L_np_6
 s_mov_b32 s64, 0xffff
 s_mov_b32 s65, 0xffff
 s_mov_b32 s62, 0
 s_getreg_b32 s70, hwreg(HW_REG_XCC_ID, 2, 1)
 s_lshl_b32 s70, s70, 13
 v_lshlrev_b32 v1, 8, v0
 v_mov_b32 v2, 0
 s_mov_b32 s96, s44
 s_and_b32 s97, s45, 0xffff
 s_mov_b32 s98, 256
 s_mov_b32 s99, 0x00020000
L_probe0:
 s_sub_u32 s61, s82, 80
 s_lshl_b32 s61, s61, 14
 s_add_u32 s61, s61, 12582912
 s_add_u32 s63, s61, 8192
 s_mov_b64 exec, -1
 buffer_store_dword v2, v1, s[4:7], s61 offen sc1
 s_waitcnt vmcnt(0)
 s_mov_b64 exec, 1
L_probe:
 s_add_u32 s60, s61, 0
 s_xor_b32 s60, s60, s70
 s_memtime s[66:67]
 s_waitcnt lgkmcnt(0)
 buffer_load_dword v3, off, s[4:7], s60 sc1
 s_waitcnt vmcnt(0)
 s_memtime s[68:69]
 s_waitcnt lgkmcnt(0)
 s_sub_u32 s68, s68, s66
 s_min_u32 s64, s64, s68
 s_add_u32 s60, s61, 8192
 s_xor_b32 s60, s60, s70
 s_memtime s[66:67]
 s_waitcnt lgkmcnt(0)
 buffer_load_dword v3, off, s[4:7], s60 sc1
 s_waitcnt vmcnt(0)
 s_memtime s[68:69]
 s_waitcnt lgkmcnt(0)
 s_sub_u32 s68, s68, s66
 s_min_u32 s65, s65, s68
 s_add_u32 s61, s61, 2048
 s_cmp_lt_u32 s61, s63
 s_cbranch_scc1 L_probe
 s_cmp_lg_u32 s62, 0
 s_cbranch_scc1 L_probe_dec
 s_sub_u32 s66, 0x10000, s64
 s_sub_u32 s67, 0x10000, s65
 v_mov_b32 v4, s66
 v_mov_b32 v5, s67
 v_mov_b32 v3, 1
 buffer_atomic_umax v4, off, s[96:99], 0 offset:24
 buffer_atomic_umax v5, off, s[96:99], 0 offset:28
 s_waitcnt vmcnt(0)
 buffer_atomic_add v3, off, s[96:99], 0 offset:16 sc0
 s_waitcnt vmcnt(0)
 v_cmp_eq_u32 vcc, 7, v3
 s_cbranch_vccz L_probe_done
 buffer_atomic_umax v4, off, s[96:99], 0 offset:24 sc0
 buffer_atomic_umax v5, off, s[96:99], 0 offset:28 sc0
 s_waitcnt vmcnt(0)
 v_readfirstlane_b32 s66, v4
 v_readfirstlane_b32 s67, v5
 s_nop 3
 s_sub_u32 s64, 0x10000, s66
 s_sub_u32 s65, 0x10000, s67
L_probe_dec:
 s_add_u32 s62, s62, 1
 s_absdiff_i32 s60, s64, s65
 s_cmp_ge_u32 s62, 5
 s_cselect_b32 s60, 0xffff, s60
 s_cmp_lt_u32 s60, 112
 s_cbranch_scc1 L_probe0
 s_cmp_gt_u32 s64, s65
 s_cselect_b32 s60, 2, 1
 v_mov_b32 v3, s60
 buffer_store_dword v3, off, s[96:99], 0 offset:144 sc1
 v_mov_b32 v4, s62
 buffer_store_dword v4, off, s[96:99], 0 offset:60 sc1
L_probe_done:
 s_mov_b64 exec, -1
L_np_6:
 s_barrier
 s_lshl_b32 s72, s82, 2
 s_add_u32 s72, s72, s50
 s_add_u32 s72, s72, 32
 s_mov_b32 s8, s16
 s_and_b32 s9, s17, 0xffff
 s_mov_b32 s10, 2621440
 s_mov_b32 s11, 0x00020000
 v_lshlrev_b32 v1, 4, v0
 v_lshlrev_b32 v2, 3, v0
 v_cmp_lt_u32 vcc, 31, v0
 v_mov_b32 v3, 268435456
 s_nop 1
 v_cndmask_b32 v7, v2, v3, vcc
 s_mov_b32 s63, 0x3acccccd
 s_mov_b32 s68, 0x3727c5ac
 s_add_u32 s3, s72, 0
 s_mul_i32 s3, s3, 1280
 buffer_load_dwordx2 v[48:49], v2, s[8:11], s3 offen offset:0
 buffer_load_dwordx2 v[50:51], v2, s[8:11], s3 offen offset:512
 buffer_load_dwordx2 v[52:53], v7, s[8:11], s3 offen offset:1024
 s_waitcnt vmcnt(0)
L_ln_8:
 v_lshlrev_b32 v12, 16, v48
 v_and_b32 v13, 0xffff0000, v48
 v_lshlrev_b32 v14, 16, v49
 v_and_b32 v15, 0xffff0000, v49
 v_lshlrev_b32 v16, 16, v50
 v_and_b32 v17, 0xffff0000, v50
 v_lshlrev_b32 v18, 16, v51
 v_and_b32 v19, 0xffff0000, v51
 v_lshlrev_b32 v20, 16, v52
 v_and_b32 v21, 0xffff0000, v52
 v_lshlrev_b32 v22, 16, v53
 v_and_b32 v23, 0xffff0000, v53
 s_add_u32 s3, s72, 32
 s_mul_i32 s3, s3, 1280
 buffer_load_dwordx2 v[48:49], v2, s[8:11], s3 offen offset:0
 buffer_load_dwordx2 v[50:51], v2, s[8:11], s3 offen offset:512
 buffer_load_dwordx2 v[52:53], v7, s[8:11], s3 offen offset:1024
 s_and_b32 s3, s72, 15
 v_lshrrev_b32 v4, 3, v0
 v_lshlrev_b32 v4, 2, v4
 v_and_b32 v9, 3, v0
 v_add_u32 v4, v4, v9
 v_xor_b32 v4, s3, v4
 v_lshlrev_b32 v4, 4, v4
 v_and_b32 v9, 4, v0
 v_lshl_add_u32 v4, v9, 1, v4
 v_cndmask_b32 v8, v4, v3, vcc
 v_readfirstlane_b32 s3, v12
 s_nop 1
 v_subrev_f32 v36, s3, v12
 v_subrev_f32 v37, s3, v13
 v_subrev_f32 v38, s3, v14
 v_subrev_f32 v39, s3, v15
 v_subrev_f32 v40, s3, v16
 v_subrev_f32 v41, s3, v17
 v_subrev_f32 v42, s3, v18
 v_subrev_f32 v43, s3, v19
 v_mov_b32 v44, 0
 v_mov_b32 v45, 0
 v_mov_b32 v46, 0
 v_mov_b32 v47, 0
 s_mov_b32 exec_hi, 0
 v_subrev_f32 v44, s3, v20
 v_subrev_f32 v45, s3, v21
 v_subrev_f32 v46, s3, v22
 v_subrev_f32 v47, s3, v23
 s_mov_b32 exec_hi, -1
 v_pk_mul_f32 v[10:11], v[36:37], v[36:37]
 v_pk_fma_f32 v[10:11], v[38:39], v[38:39], v[10:11]
 v_pk_fma_f32 v[10:11], v[40:41], v[40:41], v[10:11]
 v_pk_fma_f32 v[10:11], v[42:43], v[42:43], v[10:11]
 v_pk_fma_f32 v[10:11], v[44:45], v[44:45], v[10:11]
 v_pk_fma_f32 v[10:11], v[46:47], v[46:47], v[10:11]
 v_pk_add_f32 v[36:37], v[36:37], v[38:39]
 v_pk_add_f32 v[36:37], v[36:37], v[40:41]
 v_pk_add_f32 v[36:37], v[36:37], v[42:43]
 v_pk_add_f32 v[36:37], v[36:37], v[44:45]
 v_pk_add_f32 v[36:37], v[36:37], v[46:47]
 v_add_f32 v11, v10, v11
 v_add_f32 v10, v36, v37
 s_nop 0
 v_add_f32_dpp v11, v11, v11 quad_perm:[1,0,3,2] row_mask:0xf bank_mask:0xf
 v_add_f32_dpp v10, v10, v10 quad_perm:[1,0,3,2] row_mask:0xf bank_mask:0xf
 s_nop 0
 v_add_f32_dpp v11, v11, v11 quad_perm:[2,3,0,1] row_mask:0xf bank_mask:0xf
 v_add_f32_dpp v10, v10, v10 quad_perm:[2,3,0,1] row_mask:0xf bank_mask:0xf
 s_nop 0
 v_add_f32_dpp v11, v11, v11 row_half_mirror row_mask:0xf bank_mask:0xf
 v_add_f32_dpp v10, v10, v10 row_half_mirror row_mask:0xf bank_mask:0xf
 s_nop 0
 v_add_f32_dpp v11, v11, v11 row_mirror row_mask:0xf bank_mask:0xf
 v_add_f32_dpp v10, v10, v10 row_mirror row_mask:0xf bank_mask:0xf
 v_mov_b32 v37, v11
 v_mov_b32 v36, v10
 s_nop 0
 v_permlane16_swap_b32 v11, v37
 v_permlane16_swap_b32 v10, v36
 v_pk_add_f32 v[10:11], v[10:11], v[36:37]
 v_mov_b32 v37, v11
 v_mov_b32 v36, v10
 s_nop 0
 v_permlane32_swap_b32 v11, v37
 v_permlane32_swap_b32 v10, v36
 v_pk_add_f32 v[10:11], v[10:11], v[36:37]
 v_mul_f32 v10, s63, v10
 v_mul_f32 v11, s63, v11
 v_fma_f32 v11, -v10, v10, v11
 v_max_f32 v11, 0, v11
 v_add_f32 v10, s3, v10
 v_cvt_pk_bf16_f32 v9, v10, v11
 v_lshlrev_b32 v10, 16, v9
 v_and_b32 v11, 0xffff0000, v9
 v_add_f32 v11, s68, v11
 v_cvt_pk_bf16_f32 v11, v11, v11
 v_and_b32 v11, 0xffff0000, v11
 v_sqrt_f32 v11, v11
 s_nop 0
 v_pk_add_f32 v[36:37], v[12:13], v[10:11] op_sel_hi:[1,0] neg_lo:[0,1] neg_hi:[0,1]
 v_pk_add_f32 v[38:39], v[14:15], v[10:11] op_sel_hi:[1,0] neg_lo:[0,1] neg_hi:[0,1]
 v_pk_add_f32 v[40:41], v[16:17], v[10:11] op_sel_hi:[1,0] neg_lo:[0,1] neg_hi:[0,1]
 v_pk_add_f32 v[42:43], v[18:19], v[10:11] op_sel_hi:[1,0] neg_lo:[0,1] neg_hi:[0,1]
 v_pk_add_f32 v[44:45], v[20:21], v[10:11] op_sel_hi:[1,0] neg_lo:[0,1] neg_hi:[0,1]
 v_pk_add_f32 v[46:47], v[22:23], v[10:11] op_sel_hi:[1,0] neg_lo:[0,1] neg_hi:[0,1]
 v_cvt_pk_bf16_f32 v11, v11, v11
 v_and_b32 v11, 0xffff0000, v11
 v_rcp_f32 v11, v11
 v_cvt_pk_bf16_f32 v9, v36, v37
 v_lshlrev_b32 v36, 16, v9
 v_and_b32 v37, 0xffff0000, v9
 v_cvt_pk_bf16_f32 v9, v38, v39
 v_lshlrev_b32 v38, 16, v9
 v_and_b32 v39, 0xffff0000, v9
 v_cvt_pk_bf16_f32 v9, v40, v41
 v_lshlrev_b32 v40, 16, v9
 v_and_b32 v41, 0xffff0000, v9
 v_cvt_pk_bf16_f32 v9, v42, v43
 v_lshlrev_b32 v42, 16, v9
 v_and_b32 v43, 0xffff0000, v9
 v_cvt_pk_bf16_f32 v9, v44, v45
 v_lshlrev_b32 v44, 16, v9
 v_and_b32 v45, 0xffff0000, v9
 v_cvt_pk_bf16_f32 v9, v46, v47
 v_lshlrev_b32 v46, 16, v9
 v_and_b32 v47, 0xffff0000, v9
 v_pk_mul_f32 v[36:37], v[36:37], v[10:11] op_sel:[0,1] op_sel_hi:[1,1]
 v_pk_mul_f32 v[38:39], v[38:39], v[10:11] op_sel:[0,1] op_sel_hi:[1,1]
 v_pk_mul_f32 v[40:41], v[40:41], v[10:11] op_sel:[0,1] op_sel_hi:[1,1]
 v_pk_mul_f32 v[42:43], v[42:43], v[10:11] op_sel:[0,1] op_sel_hi:[1,1]
 v_pk_mul_f32 v[44:45], v[44:45], v[10:11] op_sel:[0,1] op_sel_hi:[1,1]
 v_pk_mul_f32 v[46:47], v[46:47], v[10:11] op_sel:[0,1] op_sel_hi:[1,1]
 v_cvt_pk_bf16_f32 v24, v36, v37
 v_cvt_pk_bf16_f32 v25, v38, v39
 v_cvt_pk_bf16_f32 v26, v40, v41
 v_cvt_pk_bf16_f32 v27, v42, v43
 v_cvt_pk_bf16_f32 v28, v44, v45
 v_cvt_pk_bf16_f32 v29, v46, v47
 s_mul_i32 s3, s72, 1280
 s_add_u32 s3, s3, 192937984
 buffer_store_dwordx2 v[24:25], v4, s[4:7], s3 offen offset:0 sc1
 buffer_store_dwordx2 v[26:27], v4, s[4:7], s3 offen offset:512 sc1
 buffer_store_dwordx2 v[28:29], v8, s[4:7], s3 offen offset:1024 sc1
 s_add_u32 s72, s72, 32
 s_waitcnt vmcnt(3)
 s_cmp_lt_u32 s72, 544
 s_cbranch_scc1 L_ln_8
 s_waitcnt vmcnt(0)
 s_barrier
 s_cmp_lg_u32 s50, 3
 s_cbranch_scc1 L_ar_9
 s_mov_b32 s96, s44
 s_and_b32 s97, s45, 0xffff
 s_mov_b32 s98, 256
 s_mov_b32 s99, 0x00020000
 v_mov_b32 v1, 1
 s_mov_b64 exec, 1
 buffer_atomic_add v1, off, s[96:99], 0 offset:72 sc0
 s_waitcnt vmcnt(0)
 v_cmp_eq_u32 vcc, 7, v1
 s_cbranch_vccz L_aw_10
 buffer_store_dword v1, off, s[96:99], 0 offset:200 sc1
L_aw_10:
 s_mov_b64 exec, -1
L_ar_9:
 s_branch L_help_done
L_np_7:
 s_lshl_b32 s60, s82, 2
 s_add_u32 s60, s60, s50
 s_sub_u32 s3, s60, 32
 s_cmp_ge_u32 s60, 320
 s_cselect_b32 s60, s3, s60
 s_mov_b32 s72, s60
 s_mov_b32 s8, s16
 s_and_b32 s9, s17, 0xffff
 s_mov_b32 s10, 2621440
 s_mov_b32 s11, 0x00020000
 v_lshlrev_b32 v1, 4, v0
 v_lshlrev_b32 v2, 3, v0
 v_cmp_lt_u32 vcc, 31, v0
 v_mov_b32 v3, 268435456
 s_nop 1
 v_cndmask_b32 v7, v2, v3, vcc
 s_mov_b32 s63, 0x3acccccd
 s_mov_b32 s68, 0x3727c5ac
 s_add_u32 s3, s72, 0
 s_mul_i32 s3, s3, 1280
 buffer_load_dwordx2 v[48:49], v2, s[8:11], s3 offen offset:0
 buffer_load_dwordx2 v[50:51], v2, s[8:11], s3 offen offset:512
 buffer_load_dwordx2 v[52:53], v7, s[8:11], s3 offen offset:1024
 v_mov_b32 v12, 0
 v_mov_b32 v13, 0
 v_mov_b32 v14, 0
 v_mov_b32 v15, 0
 s_lshl_b32 s73, s60, 10
 s_add_u32 s73, s73, 0
L_cl_11:
 s_cmp_ge_u32 s73, 1736704
 s_cbranch_scc1 L_cle_12
 buffer_store_dwordx4 v[12:15], v1, s[4:7], s73 offen sc1
 s_add_u32 s73, s73, 360448
 s_branch L_cl_11
L_cle_12:
 s_nop 1
 v_mov_b32 v12, -1
 v_mov_b32 v13, -1
 v_mov_b32 v14, -1
 v_mov_b32 v15, -1
 s_lshl_b32 s73, s60, 10
 s_add_u32 s73, s73, 1736704
L_cl_13:
 s_cmp_ge_u32 s73, 3309568
 s_cbranch_scc1 L_cle_14
 buffer_store_dwordx4 v[12:15], v1, s[4:7], s73 offen sc1
 s_add_u32 s73, s73, 360448
 s_branch L_cl_13
L_cle_14:
 s_nop 1
 v_mov_b32 v12, -1
 v_mov_b32 v13, -1
 v_mov_b32 v14, -1
 v_mov_b32 v15, -1
 s_lshl_b32 s73, s60, 10
 s_add_u32 s73, s73, 4194304
L_cl_15:
 s_cmp_ge_u32 s73, 4325376
 s_cbranch_scc1 L_cle_16
 buffer_store_dwordx4 v[12:15], v1, s[4:7], s73 offen sc1
 s_add_u32 s73, s73, 360448
 s_branch L_cl_15
L_cle_16:
 s_nop 1
 v_mov_b32 v12, -1
 v_mov_b32 v13, -1
 v_mov_b32 v14, -1
 v_mov_b32 v15, -1
 s_lshl_b32 s73, s60, 10
 s_add_u32 s73, s73, 6291456
L_cl_17:
 s_cmp_ge_u32 s73, 6422528
 s_cbranch_scc1 L_cle_18
 buffer_store_dwordx4 v[12:15], v1, s[4:7], s73 offen sc1
 s_add_u32 s73, s73, 360448
 s_branch L_cl_17
L_cle_18:
 s_nop 1
 v_mov_b32 v12, -1
 v_mov_b32 v13, -1
 v_mov_b32 v14, -1
 v_mov_b32 v15, -1
 s_lshl_b32 s73, s60, 10
 s_add_u32 s73, s73, 8388608
L_cl_19:
 s_cmp_ge_u32 s73, 8519680
 s_cbranch_scc1 L_cle_20
 buffer_store_dwordx4 v[12:15], v1, s[4:7], s73 offen sc1
 s_add_u32 s73, s73, 360448
 s_branch L_cl_19
L_cle_20:
 s_nop 1
 v_mov_b32 v12, -1
 v_mov_b32 v13, -1
 v_mov_b32 v14, -1
 v_mov_b32 v15, -1
 s_lshl_b32 s73, s60, 10
 s_add_u32 s73, s73, 10485760
L_cl_21:
 s_cmp_ge_u32 s73, 10616832
 s_cbranch_scc1 L_cle_22
 buffer_store_dwordx4 v[12:15], v1, s[4:7], s73 offen sc1
 s_add_u32 s73, s73, 360448
 s_branch L_cl_21
L_cle_22:
 s_nop 1
 s_waitcnt vmcnt(8)
L_ln_23:
 v_lshlrev_b32 v12, 16, v48
 v_and_b32 v13, 0xffff0000, v48
 v_lshlrev_b32 v14, 16, v49
 v_and_b32 v15, 0xffff0000, v49
 v_lshlrev_b32 v16, 16, v50
 v_and_b32 v17, 0xffff0000, v50
 v_lshlrev_b32 v18, 16, v51
 v_and_b32 v19, 0xffff0000, v51
 v_lshlrev_b32 v20, 16, v52
 v_and_b32 v21, 0xffff0000, v52
 v_lshlrev_b32 v22, 16, v53
 v_and_b32 v23, 0xffff0000, v53
 s_and_b32 s3, s72, 15
 v_lshrrev_b32 v4, 3, v0
 v_lshlrev_b32 v4, 2, v4
 v_and_b32 v9, 3, v0
 v_add_u32 v4, v4, v9
 v_xor_b32 v4, s3, v4
 v_lshlrev_b32 v4, 4, v4
 v_and_b32 v9, 4, v0
 v_lshl_add_u32 v4, v9, 1, v4
 v_cndmask_b32 v8, v4, v3, vcc
 v_readfirstlane_b32 s3, v12
 s_nop 1
 v_subrev_f32 v36, s3, v12
 v_subrev_f32 v37, s3, v13
 v_subrev_f32 v38, s3, v14
 v_subrev_f32 v39, s3, v15
 v_subrev_f32 v40, s3, v16
 v_subrev_f32 v41, s3, v17
 v_subrev_f32 v42, s3, v18
 v_subrev_f32 v43, s3, v19
 v_mov_b32 v44, 0
 v_mov_b32 v45, 0
 v_mov_b32 v46, 0
 v_mov_b32 v47, 0
 s_mov_b32 exec_hi, 0
 v_subrev_f32 v44, s3, v20
 v_subrev_f32 v45, s3, v21
 v_subrev_f32 v46, s3, v22
 v_subrev_f32 v47, s3, v23
 s_mov_b32 exec_hi, -1
 v_pk_mul_f32 v[10:11], v[36:37], v[36:37]
 v_pk_fma_f32 v[10:11], v[38:39], v[38:39], v[10:11]
 v_pk_fma_f32 v[10:11], v[40:41], v[40:41], v[10:11]
 v_pk_fma_f32 v[10:11], v[42:43], v[42:43], v[10:11]
 v_pk_fma_f32 v[10:11], v[44:45], v[44:45], v[10:11]
 v_pk_fma_f32 v[10:11], v[46:47], v[46:47], v[10:11]
 v_pk_add_f32 v[36:37], v[36:37], v[38:39]
 v_pk_add_f32 v[36:37], v[36:37], v[40:41]
 v_pk_add_f32 v[36:37], v[36:37], v[42:43]
 v_pk_add_f32 v[36:37], v[36:37], v[44:45]
 v_pk_add_f32 v[36:37], v[36:37], v[46:47]
 v_add_f32 v11, v10, v11
 v_add_f32 v10, v36, v37
 s_nop 0
 v_add_f32_dpp v11, v11, v11 quad_perm:[1,0,3,2] row_mask:0xf bank_mask:0xf
 v_add_f32_dpp v10, v10, v10 quad_perm:[1,0,3,2] row_mask:0xf bank_mask:0xf
 s_nop 0
 v_add_f32_dpp v11, v11, v11 quad_perm:[2,3,0,1] row_mask:0xf bank_mask:0xf
 v_add_f32_dpp v10, v10, v10 quad_perm:[2,3,0,1] row_mask:0xf bank_mask:0xf
 s_nop 0
 v_add_f32_dpp v11, v11, v11 row_half_mirror row_mask:0xf bank_mask:0xf
 v_add_f32_dpp v10, v10, v10 row_half_mirror row_mask:0xf bank_mask:0xf
 s_nop 0
 v_add_f32_dpp v11, v11, v11 row_mirror row_mask:0xf bank_mask:0xf
 v_add_f32_dpp v10, v10, v10 row_mirror row_mask:0xf bank_mask:0xf
 v_mov_b32 v37, v11
 v_mov_b32 v36, v10
 s_nop 0
 v_permlane16_swap_b32 v11, v37
 v_permlane16_swap_b32 v10, v36
 v_pk_add_f32 v[10:11], v[10:11], v[36:37]
 v_mov_b32 v37, v11
 v_mov_b32 v36, v10
 s_nop 0
 v_permlane32_swap_b32 v11, v37
 v_permlane32_swap_b32 v10, v36
 v_pk_add_f32 v[10:11], v[10:11], v[36:37]
 v_mul_f32 v10, s63, v10
 v_mul_f32 v11, s63, v11
 v_fma_f32 v11, -v10, v10, v11
 v_max_f32 v11, 0, v11
 v_add_f32 v10, s3, v10
 v_cvt_pk_bf16_f32 v9, v10, v11
 v_lshlrev_b32 v10, 16, v9
 v_and_b32 v11, 0xffff0000, v9
 v_add_f32 v11, s68, v11
 v_cvt_pk_bf16_f32 v11, v11, v11
 v_and_b32 v11, 0xffff0000, v11
 v_sqrt_f32 v11, v11
 s_nop 0
 v_pk_add_f32 v[36:37], v[12:13], v[10:11] op_sel_hi:[1,0] neg_lo:[0,1] neg_hi:[0,1]
 v_pk_add_f32 v[38:39], v[14:15], v[10:11] op_sel_hi:[1,0] neg_lo:[0,1] neg_hi:[0,1]
 v_pk_add_f32 v[40:41], v[16:17], v[10:11] op_sel_hi:[1,0] neg_lo:[0,1] neg_hi:[0,1]
 v_pk_add_f32 v[42:43], v[18:19], v[10:11] op_sel_hi:[1,0] neg_lo:[0,1] neg_hi:[0,1]
 v_pk_add_f32 v[44:45], v[20:21], v[10:11] op_sel_hi:[1,0] neg_lo:[0,1] neg_hi:[0,1]
 v_pk_add_f32 v[46:47], v[22:23], v[10:11] op_sel_hi:[1,0] neg_lo:[0,1] neg_hi:[0,1]
 v_cvt_pk_bf16_f32 v11, v11, v11
 v_and_b32 v11, 0xffff0000, v11
 v_rcp_f32 v11, v11
 v_cvt_pk_bf16_f32 v9, v36, v37
 v_lshlrev_b32 v36, 16, v9
 v_and_b32 v37, 0xffff0000, v9
 v_cvt_pk_bf16_f32 v9, v38, v39
 v_lshlrev_b32 v38, 16, v9
 v_and_b32 v39, 0xffff0000, v9
 v_cvt_pk_bf16_f32 v9, v40, v41
 v_lshlrev_b32 v40, 16, v9
 v_and_b32 v41, 0xffff0000, v9
 v_cvt_pk_bf16_f32 v9, v42, v43
 v_lshlrev_b32 v42, 16, v9
 v_and_b32 v43, 0xffff0000, v9
 v_cvt_pk_bf16_f32 v9, v44, v45
 v_lshlrev_b32 v44, 16, v9
 v_and_b32 v45, 0xffff0000, v9
 v_cvt_pk_bf16_f32 v9, v46, v47
 v_lshlrev_b32 v46, 16, v9
 v_and_b32 v47, 0xffff0000, v9
 v_pk_mul_f32 v[36:37], v[36:37], v[10:11] op_sel:[0,1] op_sel_hi:[1,1]
 v_pk_mul_f32 v[38:39], v[38:39], v[10:11] op_sel:[0,1] op_sel_hi:[1,1]
 v_pk_mul_f32 v[40:41], v[40:41], v[10:11] op_sel:[0,1] op_sel_hi:[1,1]
 v_pk_mul_f32 v[42:43], v[42:43], v[10:11] op_sel:[0,1] op_sel_hi:[1,1]
 v_pk_mul_f32 v[44:45], v[44:45], v[10:11] op_sel:[0,1] op_sel_hi:[1,1]
 v_pk_mul_f32 v[46:47], v[46:47], v[10:11] op_sel:[0,1] op_sel_hi:[1,1]
 v_cvt_pk_bf16_f32 v24, v36, v37
 v_cvt_pk_bf16_f32 v25, v38, v39
 v_cvt_pk_bf16_f32 v26, v40, v41
 v_cvt_pk_bf16_f32 v27, v42, v43
 v_cvt_pk_bf16_f32 v28, v44, v45
 v_cvt_pk_bf16_f32 v29, v46, v47
 s_mul_i32 s3, s72, 1280
 s_add_u32 s3, s3, 192937984
 buffer_store_dwordx2 v[24:25], v4, s[4:7], s3 offen offset:0 sc1
 buffer_store_dwordx2 v[26:27], v4, s[4:7], s3 offen offset:512 sc1
 buffer_store_dwordx2 v[28:29], v8, s[4:7], s3 offen offset:1024 sc1
 s_waitcnt vmcnt(0)
 s_barrier
 s_cmp_lg_u32 s50, 3
 s_cbranch_scc1 L_ar_24
 s_mov_b32 s96, s44
 s_and_b32 s97, s45, 0xffff
 s_mov_b32 s98, 256
 s_mov_b32 s99, 0x00020000
 v_mov_b32 v1, 1
 s_mov_b64 exec, 1
 buffer_atomic_add v1, off, s[96:99], 0 offset:4 sc0
 s_waitcnt vmcnt(0)
 v_cmp_eq_u32 vcc, 87, v1
 s_cbranch_vccz L_aw_25
 buffer_store_dword v1, off, s[96:99], 0 offset:132 sc1
L_aw_25:
 s_mov_b64 exec, -1
L_ar_24:
 s_cmp_eq_u32 s83, 3
 s_cbranch_scc1 L_help_done
 s_sub_u32 s60, s60, 128
 s_cmp_eq_u32 s83, 1
 s_cbranch_scc1 L_k2_26
 s_add_u32 s3, s60, 288
 s_add_u32 s60, s60, 128
 s_cmp_lt_u32 s82, 32
 s_cselect_b32 s60, s3, s60
L_k2_26:
 s_mov_b32 s8, s32
 s_and_b32 s9, s33, 0xffff
 s_mov_b32 s10, 2621440
 s_mov_b32 s11, 0x00020000
 s_mov_b32 s12, s34
 s_and_b32 s13, s35, 0xffff
 s_mov_b32 s14, 2621440
 s_mov_b32 s15, 0x00020000
 s_mul_i32 s73, s60, 6554
 s_lshr_b32 s73, s73, 16
 s_mul_i32 s3, s73, 10
 s_sub_u32 s74, s60, s3
 s_mul_i32 s69, s73, 81920
 s_lshl_b32 s3, s74, 7
 s_add_u32 s69, s69, s3
 v_lshrrev_b32 v90, 3, v0
 s_mov_b32 s3, 10240
 v_mul_lo_u32 v91, v90, s3
 v_and_b32 v92, 7, v0
 v_lshl_add_u32 v91, v92, 4, v91
 v_add_u32 v91, s69, v91
 v_subrev_u32 v93, 3840, v91
 v_cmp_gt_i32 vcc, 0, v93
 s_nop 1
 v_cndmask_b32 v93, v93, v3, vcc
 buffer_load_dwordx4 v[100:103], v93, s[8:11], 0 offen offset:0
 buffer_load_dwordx4 v[104:107], v93, s[8:11], 0 offen offset:1280
 buffer_load_dwordx4 v[108:111], v93, s[8:11], 0 offen offset:2560
 s_mov_b32 s3, 0
 buffer_load_dwordx4 v[112:115], v91, s[8:11], s3 offen
 buffer_load_dwordx4 v[144:147], v91, s[12:15], s3 offen
 s_mov_b32 s3, 1280
 buffer_load_dwordx4 v[116:119], v91, s[8:11], s3 offen
 buffer_load_dwordx4 v[148:151], v91, s[12:15], s3 offen
 s_mov_b32 s3, 2560
 buffer_load_dwordx4 v[120:123], v91, s[8:11], s3 offen
 buffer_load_dwordx4 v[152:155], v91, s[12:15], s3 offen
 s_mov_b32 s3, 3840
 buffer_load_dwordx4 v[124:127], v91, s[8:11], s3 offen
 buffer_load_dwordx4 v[156:159], v91, s[12:15], s3 offen
 s_mov_b32 s3, 5120
 buffer_load_dwordx4 v[128:131], v91, s[8:11], s3 offen
 buffer_load_dwordx4 v[160:163], v91, s[12:15], s3 offen
 s_mov_b32 s3, 6400
 buffer_load_dwordx4 v[132:135], v91, s[8:11], s3 offen
 buffer_load_dwordx4 v[164:167], v91, s[12:15], s3 offen
 s_mov_b32 s3, 7680
 buffer_load_dwordx4 v[136:139], v91, s[8:11], s3 offen
 buffer_load_dwordx4 v[168:171], v91, s[12:15], s3 offen
 s_mov_b32 s3, 8960
 buffer_load_dwordx4 v[140:143], v91, s[8:11], s3 offen
 buffer_load_dwordx4 v[172:175], v91, s[12:15], s3 offen
 s_mov_b32 s8, s36
 s_and_b32 s9, s37, 0xffff
 s_mov_b32 s10, 5120
 s_mov_b32 s11, 0x00020000
 v_lshlrev_b32 v93, 6, v92
 s_lshl_b32 s3, s74, 9
 buffer_load_dwordx4 v[176:179], v93, s[8:11], s3 offen offset:0
 buffer_load_dwordx4 v[180:183], v93, s[8:11], s3 offen offset:16
 buffer_load_dwordx4 v[184:187], v93, s[8:11], s3 offen offset:32
 buffer_load_dwordx4 v[188:191], v93, s[8:11], s3 offen offset:48
 v_lshlrev_b32 v94, 15, v92
 v_lshl_add_u32 v94, v90, 4, v94
 s_lshl_b32 s70, s74, 18
 s_lshl_b32 s3, s73, 7
 s_add_u32 s70, s70, s3
 s_add_u32 s70, s70, 198180864
 s_waitcnt vmcnt(0)
 v_lshlrev_b32 v12, 16, v100
 v_and_b32 v13, 0xffff0000, v100
 v_lshlrev_b32 v14, 16, v104
 v_and_b32 v15, 0xffff0000, v104
 v_lshlrev_b32 v16, 16, v108
 v_and_b32 v17, 0xffff0000, v108
 v_lshlrev_b32 v18, 16, v112
 v_and_b32 v19, 0xffff0000, v112
 v_lshlrev_b32 v20, 16, v116
 v_and_b32 v21, 0xffff0000, v116
 v_lshlrev_b32 v22, 16, v120
 v_and_b32 v23, 0xffff0000, v120
 v_lshlrev_b32 v24, 16, v124
 v_and_b32 v25, 0xffff0000, v124
 v_lshlrev_b32 v26, 16, v128
 v_and_b32 v27, 0xffff0000, v128
 v_lshlrev_b32 v28, 16, v132
 v_and_b32 v29, 0xffff0000, v132
 v_lshlrev_b32 v30, 16, v136
 v_and_b32 v31, 0xffff0000, v136
 v_lshlrev_b32 v32, 16, v140
 v_and_b32 v33, 0xffff0000, v140
 v_lshlrev_b32 v68, 16, v176
 v_lshlrev_b32 v69, 16, v178
 v_and_b32 v70, 0xffff0000, v176
 v_and_b32 v71, 0xffff0000, v178
 v_lshlrev_b32 v72, 16, v177
 v_lshlrev_b32 v73, 16, v179
 v_and_b32 v74, 0xffff0000, v177
 v_and_b32 v75, 0xffff0000, v179
 v_pk_mul_f32 v[36:37], v[12:13], v[74:75]
 v_pk_mul_f32 v[38:39], v[14:15], v[74:75]
 v_pk_mul_f32 v[40:41], v[16:17], v[74:75]
 v_pk_mul_f32 v[42:43], v[18:19], v[74:75]
 v_pk_mul_f32 v[44:45], v[20:21], v[74:75]
 v_pk_mul_f32 v[46:47], v[22:23], v[74:75]
 v_pk_mul_f32 v[48:49], v[24:25], v[74:75]
 v_pk_mul_f32 v[50:51], v[26:27], v[74:75]
 v_cvt_pk_bf16_f32 v84, v36, v37
 v_lshlrev_b32 v36, 16, v84
 v_and_b32 v37, 0xffff0000, v84
 v_cvt_pk_bf16_f32 v84, v38, v39
 v_lshlrev_b32 v38, 16, v84
 v_and_b32 v39, 0xffff0000, v84
 v_cvt_pk_bf16_f32 v84, v40, v41
 v_lshlrev_b32 v40, 16, v84
 v_and_b32 v41, 0xffff0000, v84
 v_cvt_pk_bf16_f32 v84, v42, v43
 v_lshlrev_b32 v42, 16, v84
 v_and_b32 v43, 0xffff0000, v84
 v_cvt_pk_bf16_f32 v84, v44, v45
 v_lshlrev_b32 v44, 16, v84
 v_and_b32 v45, 0xffff0000, v84
 v_cvt_pk_bf16_f32 v84, v46, v47
 v_lshlrev_b32 v46, 16, v84
 v_and_b32 v47, 0xffff0000, v84
 v_cvt_pk_bf16_f32 v84, v48, v49
 v_lshlrev_b32 v48, 16, v84
 v_and_b32 v49, 0xffff0000, v84
 v_cvt_pk_bf16_f32 v84, v50, v51
 v_lshlrev_b32 v50, 16, v84
 v_and_b32 v51, 0xffff0000, v84
 v_pk_mul_f32 v[52:53], v[14:15], v[72:73]
 v_pk_mul_f32 v[54:55], v[16:17], v[72:73]
 v_pk_mul_f32 v[56:57], v[18:19], v[72:73]
 v_pk_mul_f32 v[58:59], v[20:21], v[72:73]
 v_pk_mul_f32 v[60:61], v[22:23], v[72:73]
 v_pk_mul_f32 v[62:63], v[24:25], v[72:73]
 v_pk_mul_f32 v[64:65], v[26:27], v[72:73]
 v_pk_mul_f32 v[66:67], v[28:29], v[72:73]
 v_cvt_pk_bf16_f32 v84, v52, v53
 v_lshlrev_b32 v52, 16, v84
 v_and_b32 v53, 0xffff0000, v84
 v_cvt_pk_bf16_f32 v84, v54, v55
 v_lshlrev_b32 v54, 16, v84
 v_and_b32 v55, 0xffff0000, v84
 v_cvt_pk_bf16_f32 v84, v56, v57
 v_lshlrev_b32 v56, 16, v84
 v_and_b32 v57, 0xffff0000, v84
 v_cvt_pk_bf16_f32 v84, v58, v59
 v_lshlrev_b32 v58, 16, v84
 v_and_b32 v59, 0xffff0000, v84
 v_cvt_pk_bf16_f32 v84, v60, v61
 v_lshlrev_b32 v60, 16, v84
 v_and_b32 v61, 0xffff0000, v84
 v_cvt_pk_bf16_f32 v84, v62, v63
 v_lshlrev_b32 v62, 16, v84
 v_and_b32 v63, 0xffff0000, v84
 v_cvt_pk_bf16_f32 v84, v64, v65
 v_lshlrev_b32 v64, 16, v84
 v_and_b32 v65, 0xffff0000, v84
 v_cvt_pk_bf16_f32 v84, v66, v67
 v_lshlrev_b32 v66, 16, v84
 v_and_b32 v67, 0xffff0000, v84
 v_pk_add_f32 v[36:37], v[36:37], v[52:53]
 v_pk_add_f32 v[38:39], v[38:39], v[54:55]
 v_pk_add_f32 v[40:41], v[40:41], v[56:57]
 v_pk_add_f32 v[42:43], v[42:43], v[58:59]
 v_pk_add_f32 v[44:45], v[44:45], v[60:61]
 v_pk_add_f32 v[46:47], v[46:47], v[62:63]
 v_pk_add_f32 v[48:49], v[48:49], v[64:65]
 v_pk_add_f32 v[50:51], v[50:51], v[66:67]
 v_cvt_pk_bf16_f32 v84, v36, v37
 v_lshlrev_b32 v36, 16, v84
 v_and_b32 v37, 0xffff0000, v84
 v_cvt_pk_bf16_f32 v84, v38, v39
 v_lshlrev_b32 v38, 16, v84
 v_and_b32 v39, 0xffff0000, v84
 v_cvt_pk_bf16_f32 v84, v40, v41
 v_lshlrev_b32 v40, 16, v84
 v_and_b32 v41, 0xffff0000, v84
 v_cvt_pk_bf16_f32 v84, v42, v43
 v_lshlrev_b32 v42, 16, v84
 v_and_b32 v43, 0xffff0000, v84
 v_cvt_pk_bf16_f32 v84, v44, v45
 v_lshlrev_b32 v44, 16, v84
 v_and_b32 v45, 0xffff0000, v84
 v_cvt_pk_bf16_f32 v84, v46, v47
 v_lshlrev_b32 v46, 16, v84
 v_and_b32 v47, 0xffff0000, v84
 v_cvt_pk_bf16_f32 v84, v48, v49
 v_lshlrev_b32 v48, 16, v84
 v_and_b32 v49, 0xffff0000, v84
 v_cvt_pk_bf16_f32 v84, v50, v51
 v_lshlrev_b32 v50, 16, v84
 v_and_b32 v51, 0xffff0000, v84
 v_pk_mul_f32 v[52:53], v[16:17], v[70:71]
 v_pk_mul_f32 v[54:55], v[18:19], v[70:71]
 v_pk_mul_f32 v[56:57], v[20:21], v[70:71]
 v_pk_mul_f32 v[58:59], v[22:23], v[70:71]
 v_pk_mul_f32 v[60:61], v[24:25], v[70:71]
 v_pk_mul_f32 v[62:63], v[26:27], v[70:71]
 v_pk_mul_f32 v[64:65], v[28:29], v[70:71]
 v_pk_mul_f32 v[66:67], v[30:31], v[70:71]
 v_cvt_pk_bf16_f32 v84, v52, v53
 v_lshlrev_b32 v52, 16, v84
 v_and_b32 v53, 0xffff0000, v84
 v_cvt_pk_bf16_f32 v84, v54, v55
 v_lshlrev_b32 v54, 16, v84
 v_and_b32 v55, 0xffff0000, v84
 v_cvt_pk_bf16_f32 v84, v56, v57
 v_lshlrev_b32 v56, 16, v84
 v_and_b32 v57, 0xffff0000, v84
 v_cvt_pk_bf16_f32 v84, v58, v59
 v_lshlrev_b32 v58, 16, v84
 v_and_b32 v59, 0xffff0000, v84
 v_cvt_pk_bf16_f32 v84, v60, v61
 v_lshlrev_b32 v60, 16, v84
 v_and_b32 v61, 0xffff0000, v84
 v_cvt_pk_bf16_f32 v84, v62, v63
 v_lshlrev_b32 v62, 16, v84
 v_and_b32 v63, 0xffff0000, v84
 v_cvt_pk_bf16_f32 v84, v64, v65
 v_lshlrev_b32 v64, 16, v84
 v_and_b32 v65, 0xffff0000, v84
 v_cvt_pk_bf16_f32 v84, v66, v67
 v_lshlrev_b32 v66, 16, v84
 v_and_b32 v67, 0xffff0000, v84
 v_pk_add_f32 v[36:37], v[36:37], v[52:53]
 v_pk_add_f32 v[38:39], v[38:39], v[54:55]
 v_pk_add_f32 v[40:41], v[40:41], v[56:57]
 v_pk_add_f32 v[42:43], v[42:43], v[58:59]
 v_pk_add_f32 v[44:45], v[44:45], v[60:61]
 v_pk_add_f32 v[46:47], v[46:47], v[62:63]
 v_pk_add_f32 v[48:49], v[48:49], v[64:65]
 v_pk_add_f32 v[50:51], v[50:51], v[66:67]
 v_cvt_pk_bf16_f32 v84, v36, v37
 v_lshlrev_b32 v36, 16, v84
 v_and_b32 v37, 0xffff0000, v84
 v_cvt_pk_bf16_f32 v84, v38, v39
 v_lshlrev_b32 v38, 16, v84
 v_and_b32 v39, 0xffff0000, v84
 v_cvt_pk_bf16_f32 v84, v40, v41
 v_lshlrev_b32 v40, 16, v84
 v_and_b32 v41, 0xffff0000, v84
 v_cvt_pk_bf16_f32 v84, v42, v43
 v_lshlrev_b32 v42, 16, v84
 v_and_b32 v43, 0xffff0000, v84
 v_cvt_pk_bf16_f32 v84, v44, v45
 v_lshlrev_b32 v44, 16, v84
 v_and_b32 v45, 0xffff0000, v84
 v_cvt_pk_bf16_f32 v84, v46, v47
 v_lshlrev_b32 v46, 16, v84
 v_and_b32 v47, 0xffff0000, v84
 v_cvt_pk_bf16_f32 v84, v48, v49
 v_lshlrev_b32 v48, 16, v84
 v_and_b32 v49, 0xffff0000, v84
 v_cvt_pk_bf16_f32 v84, v50, v51
 v_lshlrev_b32 v50, 16, v84
 v_and_b32 v51, 0xffff0000, v84
 v_pk_mul_f32 v[52:53], v[18:19], v[68:69]
 v_pk_mul_f32 v[54:55], v[20:21], v[68:69]
 v_pk_mul_f32 v[56:57], v[22:23], v[68:69]
 v_pk_mul_f32 v[58:59], v[24:25], v[68:69]
 v_pk_mul_f32 v[60:61], v[26:27], v[68:69]
 v_pk_mul_f32 v[62:63], v[28:29], v[68:69]
 v_pk_mul_f32 v[64:65], v[30:31], v[68:69]
 v_pk_mul_f32 v[66:67], v[32:33], v[68:69]
 v_cvt_pk_bf16_f32 v84, v52, v53
 v_lshlrev_b32 v52, 16, v84
 v_and_b32 v53, 0xffff0000, v84
 v_cvt_pk_bf16_f32 v84, v54, v55
 v_lshlrev_b32 v54, 16, v84
 v_and_b32 v55, 0xffff0000, v84
 v_cvt_pk_bf16_f32 v84, v56, v57
 v_lshlrev_b32 v56, 16, v84
 v_and_b32 v57, 0xffff0000, v84
 v_cvt_pk_bf16_f32 v84, v58, v59
 v_lshlrev_b32 v58, 16, v84
 v_and_b32 v59, 0xffff0000, v84
 v_cvt_pk_bf16_f32 v84, v60, v61
 v_lshlrev_b32 v60, 16, v84
 v_and_b32 v61, 0xffff0000, v84
 v_cvt_pk_bf16_f32 v84, v62, v63
 v_lshlrev_b32 v62, 16, v84
 v_and_b32 v63, 0xffff0000, v84
 v_cvt_pk_bf16_f32 v84, v64, v65
 v_lshlrev_b32 v64, 16, v84
 v_and_b32 v65, 0xffff0000, v84
 v_cvt_pk_bf16_f32 v84, v66, v67
 v_lshlrev_b32 v66, 16, v84
 v_and_b32 v67, 0xffff0000, v84
 v_pk_add_f32 v[36:37], v[36:37], v[52:53]
 v_pk_add_f32 v[38:39], v[38:39], v[54:55]
 v_pk_add_f32 v[40:41], v[40:41], v[56:57]
 v_pk_add_f32 v[42:43], v[42:43], v[58:59]
 v_pk_add_f32 v[44:45], v[44:45], v[60:61]
 v_pk_add_f32 v[46:47], v[46:47], v[62:63]
 v_pk_add_f32 v[48:49], v[48:49], v[64:65]
 v_pk_add_f32 v[50:51], v[50:51], v[66:67]
 v_cvt_pk_bf16_f32 v84, v36, v37
 v_lshlrev_b32 v36, 16, v84
 v_and_b32 v37, 0xffff0000, v84
 v_cvt_pk_bf16_f32 v84, v38, v39
 v_lshlrev_b32 v38, 16, v84
 v_and_b32 v39, 0xffff0000, v84
 v_cvt_pk_bf16_f32 v84, v40, v41
 v_lshlrev_b32 v40, 16, v84
 v_and_b32 v41, 0xffff0000, v84
 v_cvt_pk_bf16_f32 v84, v42, v43
 v_lshlrev_b32 v42, 16, v84
 v_and_b32 v43, 0xffff0000, v84
 v_cvt_pk_bf16_f32 v84, v44, v45
 v_lshlrev_b32 v44, 16, v84
 v_and_b32 v45, 0xffff0000, v84
 v_cvt_pk_bf16_f32 v84, v46, v47
 v_lshlrev_b32 v46, 16, v84
 v_and_b32 v47, 0xffff0000, v84
 v_cvt_pk_bf16_f32 v84, v48, v49
 v_lshlrev_b32 v48, 16, v84
 v_and_b32 v49, 0xffff0000, v84
 v_cvt_pk_bf16_f32 v84, v50, v51
 v_lshlrev_b32 v50, 16, v84
 v_and_b32 v51, 0xffff0000, v84
 v_lshlrev_b32 v12, 16, v144
 v_and_b32 v13, 0xffff0000, v144
 v_lshlrev_b32 v14, 16, v148
 v_and_b32 v15, 0xffff0000, v148
 v_lshlrev_b32 v16, 16, v152
 v_and_b32 v17, 0xffff0000, v152
 v_lshlrev_b32 v18, 16, v156
 v_and_b32 v19, 0xffff0000, v156
 v_lshlrev_b32 v20, 16, v160
 v_and_b32 v21, 0xffff0000, v160
 v_lshlrev_b32 v22, 16, v164
 v_and_b32 v23, 0xffff0000, v164
 v_lshlrev_b32 v24, 16, v168
 v_and_b32 v25, 0xffff0000, v168
 v_lshlrev_b32 v26, 16, v172
 v_and_b32 v27, 0xffff0000, v172
 v_pk_mul_f32 v[36:37], v[36:37], v[12:13]
 v_pk_mul_f32 v[38:39], v[38:39], v[14:15]
 v_pk_mul_f32 v[40:41], v[40:41], v[16:17]
 v_pk_mul_f32 v[42:43], v[42:43], v[18:19]
 v_pk_mul_f32 v[44:45], v[44:45], v[20:21]
 v_pk_mul_f32 v[46:47], v[46:47], v[22:23]
 v_pk_mul_f32 v[48:49], v[48:49], v[24:25]
 v_pk_mul_f32 v[50:51], v[50:51], v[26:27]
 v_cvt_pk_bf16_f32 v76, v50, v48
 v_cvt_pk_bf16_f32 v77, v46, v44
 v_cvt_pk_bf16_f32 v78, v42, v40
 v_cvt_pk_bf16_f32 v79, v38, v36
 s_add_u32 s3, s70, 0
 buffer_store_dwordx4 v[76:79], v94, s[4:7], s3 offen sc1
 v_cvt_pk_bf16_f32 v80, v51, v49
 v_cvt_pk_bf16_f32 v81, v47, v45
 v_cvt_pk_bf16_f32 v82, v43, v41
 v_cvt_pk_bf16_f32 v83, v39, v37
 s_add_u32 s3, s70, 4096
 buffer_store_dwordx4 v[80:83], v94, s[4:7], s3 offen sc1
 v_lshlrev_b32 v12, 16, v101
 v_and_b32 v13, 0xffff0000, v101
 v_lshlrev_b32 v14, 16, v105
 v_and_b32 v15, 0xffff0000, v105
 v_lshlrev_b32 v16, 16, v109
 v_and_b32 v17, 0xffff0000, v109
 v_lshlrev_b32 v18, 16, v113
 v_and_b32 v19, 0xffff0000, v113
 v_lshlrev_b32 v20, 16, v117
 v_and_b32 v21, 0xffff0000, v117
 v_lshlrev_b32 v22, 16, v121
 v_and_b32 v23, 0xffff0000, v121
 v_lshlrev_b32 v24, 16, v125
 v_and_b32 v25, 0xffff0000, v125
 v_lshlrev_b32 v26, 16, v129
 v_and_b32 v27, 0xffff0000, v129
 v_lshlrev_b32 v28, 16, v133
 v_and_b32 v29, 0xffff0000, v133
 v_lshlrev_b32 v30, 16, v137
 v_and_b32 v31, 0xffff0000, v137
 v_lshlrev_b32 v32, 16, v141
 v_and_b32 v33, 0xffff0000, v141
 v_lshlrev_b32 v68, 16, v180
 v_lshlrev_b32 v69, 16, v182
 v_and_b32 v70, 0xffff0000, v180
 v_and_b32 v71, 0xffff0000, v182
 v_lshlrev_b32 v72, 16, v181
 v_lshlrev_b32 v73, 16, v183
 v_and_b32 v74, 0xffff0000, v181
 v_and_b32 v75, 0xffff0000, v183
 v_pk_mul_f32 v[36:37], v[12:13], v[74:75]
 v_pk_mul_f32 v[38:39], v[14:15], v[74:75]
 v_pk_mul_f32 v[40:41], v[16:17], v[74:75]
 v_pk_mul_f32 v[42:43], v[18:19], v[74:75]
 v_pk_mul_f32 v[44:45], v[20:21], v[74:75]
 v_pk_mul_f32 v[46:47], v[22:23], v[74:75]
 v_pk_mul_f32 v[48:49], v[24:25], v[74:75]
 v_pk_mul_f32 v[50:51], v[26:27], v[74:75]
 v_cvt_pk_bf16_f32 v84, v36, v37
 v_lshlrev_b32 v36, 16, v84
 v_and_b32 v37, 0xffff0000, v84
 v_cvt_pk_bf16_f32 v84, v38, v39
 v_lshlrev_b32 v38, 16, v84
 v_and_b32 v39, 0xffff0000, v84
 v_cvt_pk_bf16_f32 v84, v40, v41
 v_lshlrev_b32 v40, 16, v84
 v_and_b32 v41, 0xffff0000, v84
 v_cvt_pk_bf16_f32 v84, v42, v43
 v_lshlrev_b32 v42, 16, v84
 v_and_b32 v43, 0xffff0000, v84
 v_cvt_pk_bf16_f32 v84, v44, v45
 v_lshlrev_b32 v44, 16, v84
 v_and_b32 v45, 0xffff0000, v84
 v_cvt_pk_bf16_f32 v84, v46, v47
 v_lshlrev_b32 v46, 16, v84
 v_and_b32 v47, 0xffff0000, v84
 v_cvt_pk_bf16_f32 v84, v48, v49
 v_lshlrev_b32 v48, 16, v84
 v_and_b32 v49, 0xffff0000, v84
 v_cvt_pk_bf16_f32 v84, v50, v51
 v_lshlrev_b32 v50, 16, v84
 v_and_b32 v51, 0xffff0000, v84
 v_pk_mul_f32 v[52:53], v[14:15], v[72:73]
 v_pk_mul_f32 v[54:55], v[16:17], v[72:73]
 v_pk_mul_f32 v[56:57], v[18:19], v[72:73]
 v_pk_mul_f32 v[58:59], v[20:21], v[72:73]
 v_pk_mul_f32 v[60:61], v[22:23], v[72:73]
 v_pk_mul_f32 v[62:63], v[24:25], v[72:73]
 v_pk_mul_f32 v[64:65], v[26:27], v[72:73]
 v_pk_mul_f32 v[66:67], v[28:29], v[72:73]
 v_cvt_pk_bf16_f32 v84, v52, v53
 v_lshlrev_b32 v52, 16, v84
 v_and_b32 v53, 0xffff0000, v84
 v_cvt_pk_bf16_f32 v84, v54, v55
 v_lshlrev_b32 v54, 16, v84
 v_and_b32 v55, 0xffff0000, v84
 v_cvt_pk_bf16_f32 v84, v56, v57
 v_lshlrev_b32 v56, 16, v84
 v_and_b32 v57, 0xffff0000, v84
 v_cvt_pk_bf16_f32 v84, v58, v59
 v_lshlrev_b32 v58, 16, v84
 v_and_b32 v59, 0xffff0000, v84
 v_cvt_pk_bf16_f32 v84, v60, v61
 v_lshlrev_b32 v60, 16, v84
 v_and_b32 v61, 0xffff0000, v84
 v_cvt_pk_bf16_f32 v84, v62, v63
 v_lshlrev_b32 v62, 16, v84
 v_and_b32 v63, 0xffff0000, v84
 v_cvt_pk_bf16_f32 v84, v64, v65
 v_lshlrev_b32 v64, 16, v84
 v_and_b32 v65, 0xffff0000, v84
 v_cvt_pk_bf16_f32 v84, v66, v67
 v_lshlrev_b32 v66, 16, v84
 v_and_b32 v67, 0xffff0000, v84
 v_pk_add_f32 v[36:37], v[36:37], v[52:53]
 v_pk_add_f32 v[38:39], v[38:39], v[54:55]
 v_pk_add_f32 v[40:41], v[40:41], v[56:57]
 v_pk_add_f32 v[42:43], v[42:43], v[58:59]
 v_pk_add_f32 v[44:45], v[44:45], v[60:61]
 v_pk_add_f32 v[46:47], v[46:47], v[62:63]
 v_pk_add_f32 v[48:49], v[48:49], v[64:65]
 v_pk_add_f32 v[50:51], v[50:51], v[66:67]
 v_cvt_pk_bf16_f32 v84, v36, v37
 v_lshlrev_b32 v36, 16, v84
 v_and_b32 v37, 0xffff0000, v84
 v_cvt_pk_bf16_f32 v84, v38, v39
 v_lshlrev_b32 v38, 16, v84
 v_and_b32 v39, 0xffff0000, v84
 v_cvt_pk_bf16_f32 v84, v40, v41
 v_lshlrev_b32 v40, 16, v84
 v_and_b32 v41, 0xffff0000, v84
 v_cvt_pk_bf16_f32 v84, v42, v43
 v_lshlrev_b32 v42, 16, v84
 v_and_b32 v43, 0xffff0000, v84
 v_cvt_pk_bf16_f32 v84, v44, v45
 v_lshlrev_b32 v44, 16, v84
 v_and_b32 v45, 0xffff0000, v84
 v_cvt_pk_bf16_f32 v84, v46, v47
 v_lshlrev_b32 v46, 16, v84
 v_and_b32 v47, 0xffff0000, v84
 v_cvt_pk_bf16_f32 v84, v48, v49
 v_lshlrev_b32 v48, 16, v84
 v_and_b32 v49, 0xffff0000, v84
 v_cvt_pk_bf16_f32 v84, v50, v51
 v_lshlrev_b32 v50, 16, v84
 v_and_b32 v51, 0xffff0000, v84
 v_pk_mul_f32 v[52:53], v[16:17], v[70:71]
 v_pk_mul_f32 v[54:55], v[18:19], v[70:71]
 v_pk_mul_f32 v[56:57], v[20:21], v[70:71]
 v_pk_mul_f32 v[58:59], v[22:23], v[70:71]
 v_pk_mul_f32 v[60:61], v[24:25], v[70:71]
 v_pk_mul_f32 v[62:63], v[26:27], v[70:71]
 v_pk_mul_f32 v[64:65], v[28:29], v[70:71]
 v_pk_mul_f32 v[66:67], v[30:31], v[70:71]
 v_cvt_pk_bf16_f32 v84, v52, v53
 v_lshlrev_b32 v52, 16, v84
 v_and_b32 v53, 0xffff0000, v84
 v_cvt_pk_bf16_f32 v84, v54, v55
 v_lshlrev_b32 v54, 16, v84
 v_and_b32 v55, 0xffff0000, v84
 v_cvt_pk_bf16_f32 v84, v56, v57
 v_lshlrev_b32 v56, 16, v84
 v_and_b32 v57, 0xffff0000, v84
 v_cvt_pk_bf16_f32 v84, v58, v59
 v_lshlrev_b32 v58, 16, v84
 v_and_b32 v59, 0xffff0000, v84
 v_cvt_pk_bf16_f32 v84, v60, v61
 v_lshlrev_b32 v60, 16, v84
 v_and_b32 v61, 0xffff0000, v84
 v_cvt_pk_bf16_f32 v84, v62, v63
 v_lshlrev_b32 v62, 16, v84
 v_and_b32 v63, 0xffff0000, v84
 v_cvt_pk_bf16_f32 v84, v64, v65
 v_lshlrev_b32 v64, 16, v84
 v_and_b32 v65, 0xffff0000, v84
 v_cvt_pk_bf16_f32 v84, v66, v67
 v_lshlrev_b32 v66, 16, v84
 v_and_b32 v67, 0xffff0000, v84
 v_pk_add_f32 v[36:37], v[36:37], v[52:53]
 v_pk_add_f32 v[38:39], v[38:39], v[54:55]
 v_pk_add_f32 v[40:41], v[40:41], v[56:57]
 v_pk_add_f32 v[42:43], v[42:43], v[58:59]
 v_pk_add_f32 v[44:45], v[44:45], v[60:61]
 v_pk_add_f32 v[46:47], v[46:47], v[62:63]
 v_pk_add_f32 v[48:49], v[48:49], v[64:65]
 v_pk_add_f32 v[50:51], v[50:51], v[66:67]
 v_cvt_pk_bf16_f32 v84, v36, v37
 v_lshlrev_b32 v36, 16, v84
 v_and_b32 v37, 0xffff0000, v84
 v_cvt_pk_bf16_f32 v84, v38, v39
 v_lshlrev_b32 v38, 16, v84
 v_and_b32 v39, 0xffff0000, v84
 v_cvt_pk_bf16_f32 v84, v40, v41
 v_lshlrev_b32 v40, 16, v84
 v_and_b32 v41, 0xffff0000, v84
 v_cvt_pk_bf16_f32 v84, v42, v43
 v_lshlrev_b32 v42, 16, v84
 v_and_b32 v43, 0xffff0000, v84
 v_cvt_pk_bf16_f32 v84, v44, v45
 v_lshlrev_b32 v44, 16, v84
 v_and_b32 v45, 0xffff0000, v84
 v_cvt_pk_bf16_f32 v84, v46, v47
 v_lshlrev_b32 v46, 16, v84
 v_and_b32 v47, 0xffff0000, v84
 v_cvt_pk_bf16_f32 v84, v48, v49
 v_lshlrev_b32 v48, 16, v84
 v_and_b32 v49, 0xffff0000, v84
 v_cvt_pk_bf16_f32 v84, v50, v51
 v_lshlrev_b32 v50, 16, v84
 v_and_b32 v51, 0xffff0000, v84
 v_pk_mul_f32 v[52:53], v[18:19], v[68:69]
 v_pk_mul_f32 v[54:55], v[20:21], v[68:69]
 v_pk_mul_f32 v[56:57], v[22:23], v[68:69]
 v_pk_mul_f32 v[58:59], v[24:25], v[68:69]
 v_pk_mul_f32 v[60:61], v[26:27], v[68:69]
 v_pk_mul_f32 v[62:63], v[28:29], v[68:69]
 v_pk_mul_f32 v[64:65], v[30:31], v[68:69]
 v_pk_mul_f32 v[66:67], v[32:33], v[68:69]
 v_cvt_pk_bf16_f32 v84, v52, v53
 v_lshlrev_b32 v52, 16, v84
 v_and_b32 v53, 0xffff0000, v84
 v_cvt_pk_bf16_f32 v84, v54, v55
 v_lshlrev_b32 v54, 16, v84
 v_and_b32 v55, 0xffff0000, v84
 v_cvt_pk_bf16_f32 v84, v56, v57
 v_lshlrev_b32 v56, 16, v84
 v_and_b32 v57, 0xffff0000, v84
 v_cvt_pk_bf16_f32 v84, v58, v59
 v_lshlrev_b32 v58, 16, v84
 v_and_b32 v59, 0xffff0000, v84
 v_cvt_pk_bf16_f32 v84, v60, v61
 v_lshlrev_b32 v60, 16, v84
 v_and_b32 v61, 0xffff0000, v84
 v_cvt_pk_bf16_f32 v84, v62, v63
 v_lshlrev_b32 v62, 16, v84
 v_and_b32 v63, 0xffff0000, v84
 v_cvt_pk_bf16_f32 v84, v64, v65
 v_lshlrev_b32 v64, 16, v84
 v_and_b32 v65, 0xffff0000, v84
 v_cvt_pk_bf16_f32 v84, v66, v67
 v_lshlrev_b32 v66, 16, v84
 v_and_b32 v67, 0xffff0000, v84
 v_pk_add_f32 v[36:37], v[36:37], v[52:53]
 v_pk_add_f32 v[38:39], v[38:39], v[54:55]
 v_pk_add_f32 v[40:41], v[40:41], v[56:57]
 v_pk_add_f32 v[42:43], v[42:43], v[58:59]
 v_pk_add_f32 v[44:45], v[44:45], v[60:61]
 v_pk_add_f32 v[46:47], v[46:47], v[62:63]
 v_pk_add_f32 v[48:49], v[48:49], v[64:65]
 v_pk_add_f32 v[50:51], v[50:51], v[66:67]
 v_cvt_pk_bf16_f32 v84, v36, v37
 v_lshlrev_b32 v36, 16, v84
 v_and_b32 v37, 0xffff0000, v84
 v_cvt_pk_bf16_f32 v84, v38, v39
 v_lshlrev_b32 v38, 16, v84
 v_and_b32 v39, 0xffff0000, v84
 v_cvt_pk_bf16_f32 v84, v40, v41
 v_lshlrev_b32 v40, 16, v84
 v_and_b32 v41, 0xffff0000, v84
 v_cvt_pk_bf16_f32 v84, v42, v43
 v_lshlrev_b32 v42, 16, v84
 v_and_b32 v43, 0xffff0000, v84
 v_cvt_pk_bf16_f32 v84, v44, v45
 v_lshlrev_b32 v44, 16, v84
 v_and_b32 v45, 0xffff0000, v84
 v_cvt_pk_bf16_f32 v84, v46, v47
 v_lshlrev_b32 v46, 16, v84
 v_and_b32 v47, 0xffff0000, v84
 v_cvt_pk_bf16_f32 v84, v48, v49
 v_lshlrev_b32 v48, 16, v84
 v_and_b32 v49, 0xffff0000, v84
 v_cvt_pk_bf16_f32 v84, v50, v51
 v_lshlrev_b32 v50, 16, v84
 v_and_b32 v51, 0xffff0000, v84
 v_lshlrev_b32 v12, 16, v145
 v_and_b32 v13, 0xffff0000, v145
 v_lshlrev_b32 v14, 16, v149
 v_and_b32 v15, 0xffff0000, v149
 v_lshlrev_b32 v16, 16, v153
 v_and_b32 v17, 0xffff0000, v153
 v_lshlrev_b32 v18, 16, v157
 v_and_b32 v19, 0xffff0000, v157
 v_lshlrev_b32 v20, 16, v161
 v_and_b32 v21, 0xffff0000, v161
 v_lshlrev_b32 v22, 16, v165
 v_and_b32 v23, 0xffff0000, v165
 v_lshlrev_b32 v24, 16, v169
 v_and_b32 v25, 0xffff0000, v169
 v_lshlrev_b32 v26, 16, v173
 v_and_b32 v27, 0xffff0000, v173
 v_pk_mul_f32 v[36:37], v[36:37], v[12:13]
 v_pk_mul_f32 v[38:39], v[38:39], v[14:15]
 v_pk_mul_f32 v[40:41], v[40:41], v[16:17]
 v_pk_mul_f32 v[42:43], v[42:43], v[18:19]
 v_pk_mul_f32 v[44:45], v[44:45], v[20:21]
 v_pk_mul_f32 v[46:47], v[46:47], v[22:23]
 v_pk_mul_f32 v[48:49], v[48:49], v[24:25]
 v_pk_mul_f32 v[50:51], v[50:51], v[26:27]
 v_cvt_pk_bf16_f32 v76, v50, v48
 v_cvt_pk_bf16_f32 v77, v46, v44
 v_cvt_pk_bf16_f32 v78, v42, v40
 v_cvt_pk_bf16_f32 v79, v38, v36
 s_add_u32 s3, s70, 8192
 buffer_store_dwordx4 v[76:79], v94, s[4:7], s3 offen sc1
 v_cvt_pk_bf16_f32 v80, v51, v49
 v_cvt_pk_bf16_f32 v81, v47, v45
 v_cvt_pk_bf16_f32 v82, v43, v41
 v_cvt_pk_bf16_f32 v83, v39, v37
 s_add_u32 s3, s70, 12288
 buffer_store_dwordx4 v[80:83], v94, s[4:7], s3 offen sc1
 v_lshlrev_b32 v12, 16, v102
 v_and_b32 v13, 0xffff0000, v102
 v_lshlrev_b32 v14, 16, v106
 v_and_b32 v15, 0xffff0000, v106
 v_lshlrev_b32 v16, 16, v110
 v_and_b32 v17, 0xffff0000, v110
 v_lshlrev_b32 v18, 16, v114
 v_and_b32 v19, 0xffff0000, v114
 v_lshlrev_b32 v20, 16, v118
 v_and_b32 v21, 0xffff0000, v118
 v_lshlrev_b32 v22, 16, v122
 v_and_b32 v23, 0xffff0000, v122
 v_lshlrev_b32 v24, 16, v126
 v_and_b32 v25, 0xffff0000, v126
 v_lshlrev_b32 v26, 16, v130
 v_and_b32 v27, 0xffff0000, v130
 v_lshlrev_b32 v28, 16, v134
 v_and_b32 v29, 0xffff0000, v134
 v_lshlrev_b32 v30, 16, v138
 v_and_b32 v31, 0xffff0000, v138
 v_lshlrev_b32 v32, 16, v142
 v_and_b32 v33, 0xffff0000, v142
 v_lshlrev_b32 v68, 16, v184
 v_lshlrev_b32 v69, 16, v186
 v_and_b32 v70, 0xffff0000, v184
 v_and_b32 v71, 0xffff0000, v186
 v_lshlrev_b32 v72, 16, v185
 v_lshlrev_b32 v73, 16, v187
 v_and_b32 v74, 0xffff0000, v185
 v_and_b32 v75, 0xffff0000, v187
 v_pk_mul_f32 v[36:37], v[12:13], v[74:75]
 v_pk_mul_f32 v[38:39], v[14:15], v[74:75]
 v_pk_mul_f32 v[40:41], v[16:17], v[74:75]
 v_pk_mul_f32 v[42:43], v[18:19], v[74:75]
 v_pk_mul_f32 v[44:45], v[20:21], v[74:75]
 v_pk_mul_f32 v[46:47], v[22:23], v[74:75]
 v_pk_mul_f32 v[48:49], v[24:25], v[74:75]
 v_pk_mul_f32 v[50:51], v[26:27], v[74:75]
 v_cvt_pk_bf16_f32 v84, v36, v37
 v_lshlrev_b32 v36, 16, v84
 v_and_b32 v37, 0xffff0000, v84
 v_cvt_pk_bf16_f32 v84, v38, v39
 v_lshlrev_b32 v38, 16, v84
 v_and_b32 v39, 0xffff0000, v84
 v_cvt_pk_bf16_f32 v84, v40, v41
 v_lshlrev_b32 v40, 16, v84
 v_and_b32 v41, 0xffff0000, v84
 v_cvt_pk_bf16_f32 v84, v42, v43
 v_lshlrev_b32 v42, 16, v84
 v_and_b32 v43, 0xffff0000, v84
 v_cvt_pk_bf16_f32 v84, v44, v45
 v_lshlrev_b32 v44, 16, v84
 v_and_b32 v45, 0xffff0000, v84
 v_cvt_pk_bf16_f32 v84, v46, v47
 v_lshlrev_b32 v46, 16, v84
 v_and_b32 v47, 0xffff0000, v84
 v_cvt_pk_bf16_f32 v84, v48, v49
 v_lshlrev_b32 v48, 16, v84
 v_and_b32 v49, 0xffff0000, v84
 v_cvt_pk_bf16_f32 v84, v50, v51
 v_lshlrev_b32 v50, 16, v84
 v_and_b32 v51, 0xffff0000, v84
 v_pk_mul_f32 v[52:53], v[14:15], v[72:73]
 v_pk_mul_f32 v[54:55], v[16:17], v[72:73]
 v_pk_mul_f32 v[56:57], v[18:19], v[72:73]
 v_pk_mul_f32 v[58:59], v[20:21], v[72:73]
 v_pk_mul_f32 v[60:61], v[22:23], v[72:73]
 v_pk_mul_f32 v[62:63], v[24:25], v[72:73]
 v_pk_mul_f32 v[64:65], v[26:27], v[72:73]
 v_pk_mul_f32 v[66:67], v[28:29], v[72:73]
 v_cvt_pk_bf16_f32 v84, v52, v53
 v_lshlrev_b32 v52, 16, v84
 v_and_b32 v53, 0xffff0000, v84
 v_cvt_pk_bf16_f32 v84, v54, v55
 v_lshlrev_b32 v54, 16, v84
 v_and_b32 v55, 0xffff0000, v84
 v_cvt_pk_bf16_f32 v84, v56, v57
 v_lshlrev_b32 v56, 16, v84
 v_and_b32 v57, 0xffff0000, v84
 v_cvt_pk_bf16_f32 v84, v58, v59
 v_lshlrev_b32 v58, 16, v84
 v_and_b32 v59, 0xffff0000, v84
 v_cvt_pk_bf16_f32 v84, v60, v61
 v_lshlrev_b32 v60, 16, v84
 v_and_b32 v61, 0xffff0000, v84
 v_cvt_pk_bf16_f32 v84, v62, v63
 v_lshlrev_b32 v62, 16, v84
 v_and_b32 v63, 0xffff0000, v84
 v_cvt_pk_bf16_f32 v84, v64, v65
 v_lshlrev_b32 v64, 16, v84
 v_and_b32 v65, 0xffff0000, v84
 v_cvt_pk_bf16_f32 v84, v66, v67
 v_lshlrev_b32 v66, 16, v84
 v_and_b32 v67, 0xffff0000, v84
 v_pk_add_f32 v[36:37], v[36:37], v[52:53]
 v_pk_add_f32 v[38:39], v[38:39], v[54:55]
 v_pk_add_f32 v[40:41], v[40:41], v[56:57]
 v_pk_add_f32 v[42:43], v[42:43], v[58:59]
 v_pk_add_f32 v[44:45], v[44:45], v[60:61]
 v_pk_add_f32 v[46:47], v[46:47], v[62:63]
 v_pk_add_f32 v[48:49], v[48:49], v[64:65]
 v_pk_add_f32 v[50:51], v[50:51], v[66:67]
 v_cvt_pk_bf16_f32 v84, v36, v37
 v_lshlrev_b32 v36, 16, v84
 v_and_b32 v37, 0xffff0000, v84
 v_cvt_pk_bf16_f32 v84, v38, v39
 v_lshlrev_b32 v38, 16, v84
 v_and_b32 v39, 0xffff0000, v84
 v_cvt_pk_bf16_f32 v84, v40, v41
 v_lshlrev_b32 v40, 16, v84
 v_and_b32 v41, 0xffff0000, v84
 v_cvt_pk_bf16_f32 v84, v42, v43
 v_lshlrev_b32 v42, 16, v84
 v_and_b32 v43, 0xffff0000, v84
 v_cvt_pk_bf16_f32 v84, v44, v45
 v_lshlrev_b32 v44, 16, v84
 v_and_b32 v45, 0xffff0000, v84
 v_cvt_pk_bf16_f32 v84, v46, v47
 v_lshlrev_b32 v46, 16, v84
 v_and_b32 v47, 0xffff0000, v84
 v_cvt_pk_bf16_f32 v84, v48, v49
 v_lshlrev_b32 v48, 16, v84
 v_and_b32 v49, 0xffff0000, v84
 v_cvt_pk_bf16_f32 v84, v50, v51
 v_lshlrev_b32 v50, 16, v84
 v_and_b32 v51, 0xffff0000, v84
 v_pk_mul_f32 v[52:53], v[16:17], v[70:71]
 v_pk_mul_f32 v[54:55], v[18:19], v[70:71]
 v_pk_mul_f32 v[56:57], v[20:21], v[70:71]
 v_pk_mul_f32 v[58:59], v[22:23], v[70:71]
 v_pk_mul_f32 v[60:61], v[24:25], v[70:71]
 v_pk_mul_f32 v[62:63], v[26:27], v[70:71]
 v_pk_mul_f32 v[64:65], v[28:29], v[70:71]
 v_pk_mul_f32 v[66:67], v[30:31], v[70:71]
 v_cvt_pk_bf16_f32 v84, v52, v53
 v_lshlrev_b32 v52, 16, v84
 v_and_b32 v53, 0xffff0000, v84
 v_cvt_pk_bf16_f32 v84, v54, v55
 v_lshlrev_b32 v54, 16, v84
 v_and_b32 v55, 0xffff0000, v84
 v_cvt_pk_bf16_f32 v84, v56, v57
 v_lshlrev_b32 v56, 16, v84
 v_and_b32 v57, 0xffff0000, v84
 v_cvt_pk_bf16_f32 v84, v58, v59
 v_lshlrev_b32 v58, 16, v84
 v_and_b32 v59, 0xffff0000, v84
 v_cvt_pk_bf16_f32 v84, v60, v61
 v_lshlrev_b32 v60, 16, v84
 v_and_b32 v61, 0xffff0000, v84
 v_cvt_pk_bf16_f32 v84, v62, v63
 v_lshlrev_b32 v62, 16, v84
 v_and_b32 v63, 0xffff0000, v84
 v_cvt_pk_bf16_f32 v84, v64, v65
 v_lshlrev_b32 v64, 16, v84
 v_and_b32 v65, 0xffff0000, v84
 v_cvt_pk_bf16_f32 v84, v66, v67
 v_lshlrev_b32 v66, 16, v84
 v_and_b32 v67, 0xffff0000, v84
 v_pk_add_f32 v[36:37], v[36:37], v[52:53]
 v_pk_add_f32 v[38:39], v[38:39], v[54:55]
 v_pk_add_f32 v[40:41], v[40:41], v[56:57]
 v_pk_add_f32 v[42:43], v[42:43], v[58:59]
 v_pk_add_f32 v[44:45], v[44:45], v[60:61]
 v_pk_add_f32 v[46:47], v[46:47], v[62:63]
 v_pk_add_f32 v[48:49], v[48:49], v[64:65]
 v_pk_add_f32 v[50:51], v[50:51], v[66:67]
 v_cvt_pk_bf16_f32 v84, v36, v37
 v_lshlrev_b32 v36, 16, v84
 v_and_b32 v37, 0xffff0000, v84
 v_cvt_pk_bf16_f32 v84, v38, v39
 v_lshlrev_b32 v38, 16, v84
 v_and_b32 v39, 0xffff0000, v84
 v_cvt_pk_bf16_f32 v84, v40, v41
 v_lshlrev_b32 v40, 16, v84
 v_and_b32 v41, 0xffff0000, v84
 v_cvt_pk_bf16_f32 v84, v42, v43
 v_lshlrev_b32 v42, 16, v84
 v_and_b32 v43, 0xffff0000, v84
 v_cvt_pk_bf16_f32 v84, v44, v45
 v_lshlrev_b32 v44, 16, v84
 v_and_b32 v45, 0xffff0000, v84
 v_cvt_pk_bf16_f32 v84, v46, v47
 v_lshlrev_b32 v46, 16, v84
 v_and_b32 v47, 0xffff0000, v84
 v_cvt_pk_bf16_f32 v84, v48, v49
 v_lshlrev_b32 v48, 16, v84
 v_and_b32 v49, 0xffff0000, v84
 v_cvt_pk_bf16_f32 v84, v50, v51
 v_lshlrev_b32 v50, 16, v84
 v_and_b32 v51, 0xffff0000, v84
 v_pk_mul_f32 v[52:53], v[18:19], v[68:69]
 v_pk_mul_f32 v[54:55], v[20:21], v[68:69]
 v_pk_mul_f32 v[56:57], v[22:23], v[68:69]
 v_pk_mul_f32 v[58:59], v[24:25], v[68:69]
 v_pk_mul_f32 v[60:61], v[26:27], v[68:69]
 v_pk_mul_f32 v[62:63], v[28:29], v[68:69]
 v_pk_mul_f32 v[64:65], v[30:31], v[68:69]
 v_pk_mul_f32 v[66:67], v[32:33], v[68:69]
 v_cvt_pk_bf16_f32 v84, v52, v53
 v_lshlrev_b32 v52, 16, v84
 v_and_b32 v53, 0xffff0000, v84
 v_cvt_pk_bf16_f32 v84, v54, v55
 v_lshlrev_b32 v54, 16, v84
 v_and_b32 v55, 0xffff0000, v84
 v_cvt_pk_bf16_f32 v84, v56, v57
 v_lshlrev_b32 v56, 16, v84
 v_and_b32 v57, 0xffff0000, v84
 v_cvt_pk_bf16_f32 v84, v58, v59
 v_lshlrev_b32 v58, 16, v84
 v_and_b32 v59, 0xffff0000, v84
 v_cvt_pk_bf16_f32 v84, v60, v61
 v_lshlrev_b32 v60, 16, v84
 v_and_b32 v61, 0xffff0000, v84
 v_cvt_pk_bf16_f32 v84, v62, v63
 v_lshlrev_b32 v62, 16, v84
 v_and_b32 v63, 0xffff0000, v84
 v_cvt_pk_bf16_f32 v84, v64, v65
 v_lshlrev_b32 v64, 16, v84
 v_and_b32 v65, 0xffff0000, v84
 v_cvt_pk_bf16_f32 v84, v66, v67
 v_lshlrev_b32 v66, 16, v84
 v_and_b32 v67, 0xffff0000, v84
 v_pk_add_f32 v[36:37], v[36:37], v[52:53]
 v_pk_add_f32 v[38:39], v[38:39], v[54:55]
 v_pk_add_f32 v[40:41], v[40:41], v[56:57]
 v_pk_add_f32 v[42:43], v[42:43], v[58:59]
 v_pk_add_f32 v[44:45], v[44:45], v[60:61]
 v_pk_add_f32 v[46:47], v[46:47], v[62:63]
 v_pk_add_f32 v[48:49], v[48:49], v[64:65]
 v_pk_add_f32 v[50:51], v[50:51], v[66:67]
 v_cvt_pk_bf16_f32 v84, v36, v37
 v_lshlrev_b32 v36, 16, v84
 v_and_b32 v37, 0xffff0000, v84
 v_cvt_pk_bf16_f32 v84, v38, v39
 v_lshlrev_b32 v38, 16, v84
 v_and_b32 v39, 0xffff0000, v84
 v_cvt_pk_bf16_f32 v84, v40, v41
 v_lshlrev_b32 v40, 16, v84
 v_and_b32 v41, 0xffff0000, v84
 v_cvt_pk_bf16_f32 v84, v42, v43
 v_lshlrev_b32 v42, 16, v84
 v_and_b32 v43, 0xffff0000, v84
 v_cvt_pk_bf16_f32 v84, v44, v45
 v_lshlrev_b32 v44, 16, v84
 v_and_b32 v45, 0xffff0000, v84
 v_cvt_pk_bf16_f32 v84, v46, v47
 v_lshlrev_b32 v46, 16, v84
 v_and_b32 v47, 0xffff0000, v84
 v_cvt_pk_bf16_f32 v84, v48, v49
 v_lshlrev_b32 v48, 16, v84
 v_and_b32 v49, 0xffff0000, v84
 v_cvt_pk_bf16_f32 v84, v50, v51
 v_lshlrev_b32 v50, 16, v84
 v_and_b32 v51, 0xffff0000, v84
 v_lshlrev_b32 v12, 16, v146
 v_and_b32 v13, 0xffff0000, v146
 v_lshlrev_b32 v14, 16, v150
 v_and_b32 v15, 0xffff0000, v150
 v_lshlrev_b32 v16, 16, v154
 v_and_b32 v17, 0xffff0000, v154
 v_lshlrev_b32 v18, 16, v158
 v_and_b32 v19, 0xffff0000, v158
 v_lshlrev_b32 v20, 16, v162
 v_and_b32 v21, 0xffff0000, v162
 v_lshlrev_b32 v22, 16, v166
 v_and_b32 v23, 0xffff0000, v166
 v_lshlrev_b32 v24, 16, v170
 v_and_b32 v25, 0xffff0000, v170
 v_lshlrev_b32 v26, 16, v174
 v_and_b32 v27, 0xffff0000, v174
 v_pk_mul_f32 v[36:37], v[36:37], v[12:13]
 v_pk_mul_f32 v[38:39], v[38:39], v[14:15]
 v_pk_mul_f32 v[40:41], v[40:41], v[16:17]
 v_pk_mul_f32 v[42:43], v[42:43], v[18:19]
 v_pk_mul_f32 v[44:45], v[44:45], v[20:21]
 v_pk_mul_f32 v[46:47], v[46:47], v[22:23]
 v_pk_mul_f32 v[48:49], v[48:49], v[24:25]
 v_pk_mul_f32 v[50:51], v[50:51], v[26:27]
 v_cvt_pk_bf16_f32 v76, v50, v48
 v_cvt_pk_bf16_f32 v77, v46, v44
 v_cvt_pk_bf16_f32 v78, v42, v40
 v_cvt_pk_bf16_f32 v79, v38, v36
 s_add_u32 s3, s70, 16384
 buffer_store_dwordx4 v[76:79], v94, s[4:7], s3 offen sc1
 v_cvt_pk_bf16_f32 v80, v51, v49
 v_cvt_pk_bf16_f32 v81, v47, v45
 v_cvt_pk_bf16_f32 v82, v43, v41
 v_cvt_pk_bf16_f32 v83, v39, v37
 s_add_u32 s3, s70, 20480
 buffer_store_dwordx4 v[80:83], v94, s[4:7], s3 offen sc1
 v_lshlrev_b32 v12, 16, v103
 v_and_b32 v13, 0xffff0000, v103
 v_lshlrev_b32 v14, 16, v107
 v_and_b32 v15, 0xffff0000, v107
 v_lshlrev_b32 v16, 16, v111
 v_and_b32 v17, 0xffff0000, v111
 v_lshlrev_b32 v18, 16, v115
 v_and_b32 v19, 0xffff0000, v115
 v_lshlrev_b32 v20, 16, v119
 v_and_b32 v21, 0xffff0000, v119
 v_lshlrev_b32 v22, 16, v123
 v_and_b32 v23, 0xffff0000, v123
 v_lshlrev_b32 v24, 16, v127
 v_and_b32 v25, 0xffff0000, v127
 v_lshlrev_b32 v26, 16, v131
 v_and_b32 v27, 0xffff0000, v131
 v_lshlrev_b32 v28, 16, v135
 v_and_b32 v29, 0xffff0000, v135
 v_lshlrev_b32 v30, 16, v139
 v_and_b32 v31, 0xffff0000, v139
 v_lshlrev_b32 v32, 16, v143
 v_and_b32 v33, 0xffff0000, v143
 v_lshlrev_b32 v68, 16, v188
 v_lshlrev_b32 v69, 16, v190
 v_and_b32 v70, 0xffff0000, v188
 v_and_b32 v71, 0xffff0000, v190
 v_lshlrev_b32 v72, 16, v189
 v_lshlrev_b32 v73, 16, v191
 v_and_b32 v74, 0xffff0000, v189
 v_and_b32 v75, 0xffff0000, v191
 v_pk_mul_f32 v[36:37], v[12:13], v[74:75]
 v_pk_mul_f32 v[38:39], v[14:15], v[74:75]
 v_pk_mul_f32 v[40:41], v[16:17], v[74:75]
 v_pk_mul_f32 v[42:43], v[18:19], v[74:75]
 v_pk_mul_f32 v[44:45], v[20:21], v[74:75]
 v_pk_mul_f32 v[46:47], v[22:23], v[74:75]
 v_pk_mul_f32 v[48:49], v[24:25], v[74:75]
 v_pk_mul_f32 v[50:51], v[26:27], v[74:75]
 v_cvt_pk_bf16_f32 v84, v36, v37
 v_lshlrev_b32 v36, 16, v84
 v_and_b32 v37, 0xffff0000, v84
 v_cvt_pk_bf16_f32 v84, v38, v39
 v_lshlrev_b32 v38, 16, v84
 v_and_b32 v39, 0xffff0000, v84
 v_cvt_pk_bf16_f32 v84, v40, v41
 v_lshlrev_b32 v40, 16, v84
 v_and_b32 v41, 0xffff0000, v84
 v_cvt_pk_bf16_f32 v84, v42, v43
 v_lshlrev_b32 v42, 16, v84
 v_and_b32 v43, 0xffff0000, v84
 v_cvt_pk_bf16_f32 v84, v44, v45
 v_lshlrev_b32 v44, 16, v84
 v_and_b32 v45, 0xffff0000, v84
 v_cvt_pk_bf16_f32 v84, v46, v47
 v_lshlrev_b32 v46, 16, v84
 v_and_b32 v47, 0xffff0000, v84
 v_cvt_pk_bf16_f32 v84, v48, v49
 v_lshlrev_b32 v48, 16, v84
 v_and_b32 v49, 0xffff0000, v84
 v_cvt_pk_bf16_f32 v84, v50, v51
 v_lshlrev_b32 v50, 16, v84
 v_and_b32 v51, 0xffff0000, v84
 v_pk_mul_f32 v[52:53], v[14:15], v[72:73]
 v_pk_mul_f32 v[54:55], v[16:17], v[72:73]
 v_pk_mul_f32 v[56:57], v[18:19], v[72:73]
 v_pk_mul_f32 v[58:59], v[20:21], v[72:73]
 v_pk_mul_f32 v[60:61], v[22:23], v[72:73]
 v_pk_mul_f32 v[62:63], v[24:25], v[72:73]
 v_pk_mul_f32 v[64:65], v[26:27], v[72:73]
 v_pk_mul_f32 v[66:67], v[28:29], v[72:73]
 v_cvt_pk_bf16_f32 v84, v52, v53
 v_lshlrev_b32 v52, 16, v84
 v_and_b32 v53, 0xffff0000, v84
 v_cvt_pk_bf16_f32 v84, v54, v55
 v_lshlrev_b32 v54, 16, v84
 v_and_b32 v55, 0xffff0000, v84
 v_cvt_pk_bf16_f32 v84, v56, v57
 v_lshlrev_b32 v56, 16, v84
 v_and_b32 v57, 0xffff0000, v84
 v_cvt_pk_bf16_f32 v84, v58, v59
 v_lshlrev_b32 v58, 16, v84
 v_and_b32 v59, 0xffff0000, v84
 v_cvt_pk_bf16_f32 v84, v60, v61
 v_lshlrev_b32 v60, 16, v84
 v_and_b32 v61, 0xffff0000, v84
 v_cvt_pk_bf16_f32 v84, v62, v63
 v_lshlrev_b32 v62, 16, v84
 v_and_b32 v63, 0xffff0000, v84
 v_cvt_pk_bf16_f32 v84, v64, v65
 v_lshlrev_b32 v64, 16, v84
 v_and_b32 v65, 0xffff0000, v84
 v_cvt_pk_bf16_f32 v84, v66, v67
 v_lshlrev_b32 v66, 16, v84
 v_and_b32 v67, 0xffff0000, v84
 v_pk_add_f32 v[36:37], v[36:37], v[52:53]
 v_pk_add_f32 v[38:39], v[38:39], v[54:55]
 v_pk_add_f32 v[40:41], v[40:41], v[56:57]
 v_pk_add_f32 v[42:43], v[42:43], v[58:59]
 v_pk_add_f32 v[44:45], v[44:45], v[60:61]
 v_pk_add_f32 v[46:47], v[46:47], v[62:63]
 v_pk_add_f32 v[48:49], v[48:49], v[64:65]
 v_pk_add_f32 v[50:51], v[50:51], v[66:67]
 v_cvt_pk_bf16_f32 v84, v36, v37
 v_lshlrev_b32 v36, 16, v84
 v_and_b32 v37, 0xffff0000, v84
 v_cvt_pk_bf16_f32 v84, v38, v39
 v_lshlrev_b32 v38, 16, v84
 v_and_b32 v39, 0xffff0000, v84
 v_cvt_pk_bf16_f32 v84, v40, v41
 v_lshlrev_b32 v40, 16, v84
 v_and_b32 v41, 0xffff0000, v84
 v_cvt_pk_bf16_f32 v84, v42, v43
 v_lshlrev_b32 v42, 16, v84
 v_and_b32 v43, 0xffff0000, v84
 v_cvt_pk_bf16_f32 v84, v44, v45
 v_lshlrev_b32 v44, 16, v84
 v_and_b32 v45, 0xffff0000, v84
 v_cvt_pk_bf16_f32 v84, v46, v47
 v_lshlrev_b32 v46, 16, v84
 v_and_b32 v47, 0xffff0000, v84
 v_cvt_pk_bf16_f32 v84, v48, v49
 v_lshlrev_b32 v48, 16, v84
 v_and_b32 v49, 0xffff0000, v84
 v_cvt_pk_bf16_f32 v84, v50, v51
 v_lshlrev_b32 v50, 16, v84
 v_and_b32 v51, 0xffff0000, v84
 v_pk_mul_f32 v[52:53], v[16:17], v[70:71]
 v_pk_mul_f32 v[54:55], v[18:19], v[70:71]
 v_pk_mul_f32 v[56:57], v[20:21], v[70:71]
 v_pk_mul_f32 v[58:59], v[22:23], v[70:71]
 v_pk_mul_f32 v[60:61], v[24:25], v[70:71]
 v_pk_mul_f32 v[62:63], v[26:27], v[70:71]
 v_pk_mul_f32 v[64:65], v[28:29], v[70:71]
 v_pk_mul_f32 v[66:67], v[30:31], v[70:71]
 v_cvt_pk_bf16_f32 v84, v52, v53
 v_lshlrev_b32 v52, 16, v84
 v_and_b32 v53, 0xffff0000, v84
 v_cvt_pk_bf16_f32 v84, v54, v55
 v_lshlrev_b32 v54, 16, v84
 v_and_b32 v55, 0xffff0000, v84
 v_cvt_pk_bf16_f32 v84, v56, v57
 v_lshlrev_b32 v56, 16, v84
 v_and_b32 v57, 0xffff0000, v84
 v_cvt_pk_bf16_f32 v84, v58, v59
 v_lshlrev_b32 v58, 16, v84
 v_and_b32 v59, 0xffff0000, v84
 v_cvt_pk_bf16_f32 v84, v60, v61
 v_lshlrev_b32 v60, 16, v84
 v_and_b32 v61, 0xffff0000, v84
 v_cvt_pk_bf16_f32 v84, v62, v63
 v_lshlrev_b32 v62, 16, v84
 v_and_b32 v63, 0xffff0000, v84
 v_cvt_pk_bf16_f32 v84, v64, v65
 v_lshlrev_b32 v64, 16, v84
 v_and_b32 v65, 0xffff0000, v84
 v_cvt_pk_bf16_f32 v84, v66, v67
 v_lshlrev_b32 v66, 16, v84
 v_and_b32 v67, 0xffff0000, v84
 v_pk_add_f32 v[36:37], v[36:37], v[52:53]
 v_pk_add_f32 v[38:39], v[38:39], v[54:55]
 v_pk_add_f32 v[40:41], v[40:41], v[56:57]
 v_pk_add_f32 v[42:43], v[42:43], v[58:59]
 v_pk_add_f32 v[44:45], v[44:45], v[60:61]
 v_pk_add_f32 v[46:47], v[46:47], v[62:63]
 v_pk_add_f32 v[48:49], v[48:49], v[64:65]
 v_pk_add_f32 v[50:51], v[50:51], v[66:67]
 v_cvt_pk_bf16_f32 v84, v36, v37
 v_lshlrev_b32 v36, 16, v84
 v_and_b32 v37, 0xffff0000, v84
 v_cvt_pk_bf16_f32 v84, v38, v39
 v_lshlrev_b32 v38, 16, v84
 v_and_b32 v39, 0xffff0000, v84
 v_cvt_pk_bf16_f32 v84, v40, v41
 v_lshlrev_b32 v40, 16, v84
 v_and_b32 v41, 0xffff0000, v84
 v_cvt_pk_bf16_f32 v84, v42, v43
 v_lshlrev_b32 v42, 16, v84
 v_and_b32 v43, 0xffff0000, v84
 v_cvt_pk_bf16_f32 v84, v44, v45
 v_lshlrev_b32 v44, 16, v84
 v_and_b32 v45, 0xffff0000, v84
 v_cvt_pk_bf16_f32 v84, v46, v47
 v_lshlrev_b32 v46, 16, v84
 v_and_b32 v47, 0xffff0000, v84
 v_cvt_pk_bf16_f32 v84, v48, v49
 v_lshlrev_b32 v48, 16, v84
 v_and_b32 v49, 0xffff0000, v84
 v_cvt_pk_bf16_f32 v84, v50, v51
 v_lshlrev_b32 v50, 16, v84
 v_and_b32 v51, 0xffff0000, v84
 v_pk_mul_f32 v[52:53], v[18:19], v[68:69]
 v_pk_mul_f32 v[54:55], v[20:21], v[68:69]
 v_pk_mul_f32 v[56:57], v[22:23], v[68:69]
 v_pk_mul_f32 v[58:59], v[24:25], v[68:69]
 v_pk_mul_f32 v[60:61], v[26:27], v[68:69]
 v_pk_mul_f32 v[62:63], v[28:29], v[68:69]
 v_pk_mul_f32 v[64:65], v[30:31], v[68:69]
 v_pk_mul_f32 v[66:67], v[32:33], v[68:69]
 v_cvt_pk_bf16_f32 v84, v52, v53
 v_lshlrev_b32 v52, 16, v84
 v_and_b32 v53, 0xffff0000, v84
 v_cvt_pk_bf16_f32 v84, v54, v55
 v_lshlrev_b32 v54, 16, v84
 v_and_b32 v55, 0xffff0000, v84
 v_cvt_pk_bf16_f32 v84, v56, v57
 v_lshlrev_b32 v56, 16, v84
 v_and_b32 v57, 0xffff0000, v84
 v_cvt_pk_bf16_f32 v84, v58, v59
 v_lshlrev_b32 v58, 16, v84
 v_and_b32 v59, 0xffff0000, v84
 v_cvt_pk_bf16_f32 v84, v60, v61
 v_lshlrev_b32 v60, 16, v84
 v_and_b32 v61, 0xffff0000, v84
 v_cvt_pk_bf16_f32 v84, v62, v63
 v_lshlrev_b32 v62, 16, v84
 v_and_b32 v63, 0xffff0000, v84
 v_cvt_pk_bf16_f32 v84, v64, v65
 v_lshlrev_b32 v64, 16, v84
 v_and_b32 v65, 0xffff0000, v84
 v_cvt_pk_bf16_f32 v84, v66, v67
 v_lshlrev_b32 v66, 16, v84
 v_and_b32 v67, 0xffff0000, v84
 v_pk_add_f32 v[36:37], v[36:37], v[52:53]
 v_pk_add_f32 v[38:39], v[38:39], v[54:55]
 v_pk_add_f32 v[40:41], v[40:41], v[56:57]
 v_pk_add_f32 v[42:43], v[42:43], v[58:59]
 v_pk_add_f32 v[44:45], v[44:45], v[60:61]
 v_pk_add_f32 v[46:47], v[46:47], v[62:63]
 v_pk_add_f32 v[48:49], v[48:49], v[64:65]
 v_pk_add_f32 v[50:51], v[50:51], v[66:67]
 v_cvt_pk_bf16_f32 v84, v36, v37
 v_lshlrev_b32 v36, 16, v84
 v_and_b32 v37, 0xffff0000, v84
 v_cvt_pk_bf16_f32 v84, v38, v39
 v_lshlrev_b32 v38, 16, v84
 v_and_b32 v39, 0xffff0000, v84
 v_cvt_pk_bf16_f32 v84, v40, v41
 v_lshlrev_b32 v40, 16, v84
 v_and_b32 v41, 0xffff0000, v84
 v_cvt_pk_bf16_f32 v84, v42, v43
 v_lshlrev_b32 v42, 16, v84
 v_and_b32 v43, 0xffff0000, v84
 v_cvt_pk_bf16_f32 v84, v44, v45
 v_lshlrev_b32 v44, 16, v84
 v_and_b32 v45, 0xffff0000, v84
 v_cvt_pk_bf16_f32 v84, v46, v47
 v_lshlrev_b32 v46, 16, v84
 v_and_b32 v47, 0xffff0000, v84
 v_cvt_pk_bf16_f32 v84, v48, v49
 v_lshlrev_b32 v48, 16, v84
 v_and_b32 v49, 0xffff0000, v84
 v_cvt_pk_bf16_f32 v84, v50, v51
 v_lshlrev_b32 v50, 16, v84
 v_and_b32 v51, 0xffff0000, v84
 v_lshlrev_b32 v12, 16, v147
 v_and_b32 v13, 0xffff0000, v147
 v_lshlrev_b32 v14, 16, v151
 v_and_b32 v15, 0xffff0000, v151
 v_lshlrev_b32 v16, 16, v155
 v_and_b32 v17, 0xffff0000, v155
 v_lshlrev_b32 v18, 16, v159
 v_and_b32 v19, 0xffff0000, v159
 v_lshlrev_b32 v20, 16, v163
 v_and_b32 v21, 0xffff0000, v163
 v_lshlrev_b32 v22, 16, v167
 v_and_b32 v23, 0xffff0000, v167
 v_lshlrev_b32 v24, 16, v171
 v_and_b32 v25, 0xffff0000, v171
 v_lshlrev_b32 v26, 16, v175
 v_and_b32 v27, 0xffff0000, v175
 v_pk_mul_f32 v[36:37], v[36:37], v[12:13]
 v_pk_mul_f32 v[38:39], v[38:39], v[14:15]
 v_pk_mul_f32 v[40:41], v[40:41], v[16:17]
 v_pk_mul_f32 v[42:43], v[42:43], v[18:19]
 v_pk_mul_f32 v[44:45], v[44:45], v[20:21]
 v_pk_mul_f32 v[46:47], v[46:47], v[22:23]
 v_pk_mul_f32 v[48:49], v[48:49], v[24:25]
 v_pk_mul_f32 v[50:51], v[50:51], v[26:27]
 v_cvt_pk_bf16_f32 v76, v50, v48
 v_cvt_pk_bf16_f32 v77, v46, v44
 v_cvt_pk_bf16_f32 v78, v42, v40
 v_cvt_pk_bf16_f32 v79, v38, v36
 s_add_u32 s3, s70, 24576
 buffer_store_dwordx4 v[76:79], v94, s[4:7], s3 offen sc1
 v_cvt_pk_bf16_f32 v80, v51, v49
 v_cvt_pk_bf16_f32 v81, v47, v45
 v_cvt_pk_bf16_f32 v82, v43, v41
 v_cvt_pk_bf16_f32 v83, v39, v37
 s_add_u32 s3, s70, 28672
 buffer_store_dwordx4 v[80:83], v94, s[4:7], s3 offen sc1
 s_cmp_eq_u32 s83, 1
 s_cbranch_scc1 L_k3_27
 s_waitcnt vmcnt(0)
 s_barrier
 s_cmp_lg_u32 s50, 3
 s_cbranch_scc1 L_ar_28
 s_mov_b32 s96, s44
 s_and_b32 s97, s45, 0xffff
 s_mov_b32 s98, 256
 s_mov_b32 s99, 0x00020000
 v_mov_b32 v1, 1
 s_mov_b64 exec, 1
 buffer_atomic_add v1, off, s[96:99], 0 offset:80 sc0
 s_waitcnt vmcnt(0)
 v_cmp_eq_u32 vcc, 39, v1
 s_cbranch_vccz L_aw_29
 buffer_store_dword v1, off, s[96:99], 0 offset:208 sc1
L_aw_29:
 s_mov_b64 exec, -1
L_ar_28:
 s_branch L_help_conv
L_k3_27:
 s_waitcnt vmcnt(0)
 s_barrier
 s_cmp_lg_u32 s50, 3
 s_cbranch_scc1 L_ar_30
 s_mov_b32 s96, s44
 s_and_b32 s97, s45, 0xffff
 s_mov_b32 s98, 256
 s_mov_b32 s99, 0x00020000
 v_mov_b32 v1, 1
 s_mov_b64 exec, 1
 buffer_atomic_add v1, off, s[96:99], 0 offset:68 sc0
 s_waitcnt vmcnt(0)
 v_cmp_eq_u32 vcc, 39, v1
 s_cbranch_vccz L_aw_31
 buffer_store_dword v1, off, s[96:99], 0 offset:196 sc1
L_aw_31:
 s_mov_b64 exec, -1
L_ar_30:
 s_mov_b32 s8, s26
 s_and_b32 s9, s27, 0xffff
 s_mov_b32 s10, 5242880
 s_mov_b32 s11, 0x00020000
 s_mul_i32 s57, s50, 40960
 s_and_b32 s55, s53, 3
 s_add_u32 s64, s55, 0
 s_sub_u32 s3, s64, 4
 s_cmp_ge_u32 s64, 4
 s_cselect_b32 s64, s3, s64
 s_add_u32 s65, s55, 1
 s_sub_u32 s3, s65, 4
 s_cmp_ge_u32 s65, 4
 s_cselect_b32 s65, s3, s65
 s_add_u32 s66, s55, 2
 s_sub_u32 s3, s66, 4
 s_cmp_ge_u32 s66, 4
 s_cselect_b32 s66, s3, s66
 s_add_u32 s67, s55, 3
 s_sub_u32 s3, s67, 4
 s_cmp_ge_u32 s67, 4
 s_cselect_b32 s67, s3, s67
 s_mul_i32 s55, s52, 655360
 s_lshl_b32 s3, s53, 8
 s_add_u32 s55, s55, s3
 v_lshrrev_b32 v4, 4, v0
 s_mov_b32 s3, 1280
 v_mul_lo_u32 v4, v4, s3
 v_lshrrev_b32 v3, 3, v0
 v_and_b32 v3, 6, v3
 v_xor_b32 v3, v3, v0
 v_and_b32 v3, 15, v3
 v_lshl_add_u32 v4, v3, 4, v4
 v_xor_b32 v5, 128, v4
 s_lshl_b32 s57, s50, 13
 s_mul_i32 s3, s50, 40960
 s_add_u32 s55, s55, s3
 s_mul_i32 s51, s64, 163840
 s_add_u32 s51, s51, s55
 s_add_u32 m0, s57, 0
 s_nop 0
 buffer_load_dwordx4 v4, s[8:11], s51 offen lds
 s_add_u32 s51, s51, 5120
 s_add_u32 m0, s57, 1024
 s_nop 0
 buffer_load_dwordx4 v5, s[8:11], s51 offen lds
 s_add_u32 s51, s51, 5120
 s_add_u32 m0, s57, 2048
 s_nop 0
 buffer_load_dwordx4 v4, s[8:11], s51 offen lds
 s_add_u32 s51, s51, 5120
 s_add_u32 m0, s57, 3072
 s_nop 0
 buffer_load_dwordx4 v5, s[8:11], s51 offen lds
 s_add_u32 s51, s51, 5120
 s_add_u32 m0, s57, 4096
 s_nop 0
 buffer_load_dwordx4 v4, s[8:11], s51 offen lds
 s_add_u32 s51, s51, 5120
 s_add_u32 m0, s57, 5120
 s_nop 0
 buffer_load_dwordx4 v5, s[8:11], s51 offen lds
 s_add_u32 s51, s51, 5120
 s_add_u32 m0, s57, 6144
 s_nop 0
 buffer_load_dwordx4 v4, s[8:11], s51 offen lds
 s_add_u32 s51, s51, 5120
 s_add_u32 m0, s57, 7168
 s_nop 0
 buffer_load_dwordx4 v5, s[8:11], s51 offen lds
 s_add_u32 s51, s51, 5120
 s_mul_i32 s51, s65, 163840
 s_add_u32 s51, s51, s55
 s_add_u32 m0, s57, 32768
 s_nop 0
 buffer_load_dwordx4 v4, s[8:11], s51 offen lds
 s_add_u32 s51, s51, 5120
 s_add_u32 m0, s57, 33792
 s_nop 0
 buffer_load_dwordx4 v5, s[8:11], s51 offen lds
 s_add_u32 s51, s51, 5120
 s_add_u32 m0, s57, 34816
 s_nop 0
 buffer_load_dwordx4 v4, s[8:11], s51 offen lds
 s_add_u32 s51, s51, 5120
 s_add_u32 m0, s57, 35840
 s_nop 0
 buffer_load_dwordx4 v5, s[8:11], s51 offen lds
 s_add_u32 s51, s51, 5120
 s_add_u32 m0, s57, 36864
 s_nop 0
 buffer_load_dwordx4 v4, s[8:11], s51 offen lds
 s_add_u32 s51, s51, 5120
 s_add_u32 m0, s57, 37888
 s_nop 0
 buffer_load_dwordx4 v5, s[8:11], s51 offen lds
 s_add_u32 s51, s51, 5120
 s_add_u32 m0, s57, 38912
 s_nop 0
 buffer_load_dwordx4 v4, s[8:11], s51 offen lds
 s_add_u32 s51, s51, 5120
 s_add_u32 m0, s57, 39936
 s_nop 0
 buffer_load_dwordx4 v5, s[8:11], s51 offen lds
 s_add_u32 s51, s51, 5120
 s_mul_i32 s51, s66, 163840
 s_add_u32 s51, s51, s55
 s_add_u32 m0, s57, 65536
 s_nop 0
 buffer_load_dwordx4 v4, s[8:11], s51 offen lds
 s_add_u32 s51, s51, 5120
 s_add_u32 m0, s57, 66560
 s_nop 0
 buffer_load_dwordx4 v5, s[8:11], s51 offen lds
 s_add_u32 s51, s51, 5120
 s_add_u32 m0, s57, 67584
 s_nop 0
 buffer_load_dwordx4 v4, s[8:11], s51 offen lds
 s_add_u32 s51, s51, 5120
 s_add_u32 m0, s57, 68608
 s_nop 0
 buffer_load_dwordx4 v5, s[8:11], s51 offen lds
 s_add_u32 s51, s51, 5120
 s_add_u32 m0, s57, 69632
 s_nop 0
 buffer_load_dwordx4 v4, s[8:11], s51 offen lds
 s_add_u32 s51, s51, 5120
 s_add_u32 m0, s57, 70656
 s_nop 0
 buffer_load_dwordx4 v5, s[8:11], s51 offen lds
 s_add_u32 s51, s51, 5120
 s_add_u32 m0, s57, 71680
 s_nop 0
 buffer_load_dwordx4 v4, s[8:11], s51 offen lds
 s_add_u32 s51, s51, 5120
 s_add_u32 m0, s57, 72704
 s_nop 0
 buffer_load_dwordx4 v5, s[8:11], s51 offen lds
 s_add_u32 s51, s51, 5120
 s_mul_i32 s51, s67, 163840
 s_add_u32 s51, s51, s55
 s_add_u32 m0, s57, 98304
 s_nop 0
 buffer_load_dwordx4 v4, s[8:11], s51 offen lds
 s_add_u32 s51, s51, 5120
 s_add_u32 m0, s57, 99328
 s_nop 0
 buffer_load_dwordx4 v5, s[8:11], s51 offen lds
 s_add_u32 s51, s51, 5120
 s_add_u32 m0, s57, 100352
 s_nop 0
 buffer_load_dwordx4 v4, s[8:11], s51 offen lds
 s_add_u32 s51, s51, 5120
 s_add_u32 m0, s57, 101376
 s_nop 0
 buffer_load_dwordx4 v5, s[8:11], s51 offen lds
 s_add_u32 s51, s51, 5120
 s_add_u32 m0, s57, 102400
 s_nop 0
 buffer_load_dwordx4 v4, s[8:11], s51 offen lds
 s_add_u32 s51, s51, 5120
 s_add_u32 m0, s57, 103424
 s_nop 0
 buffer_load_dwordx4 v5, s[8:11], s51 offen lds
 s_add_u32 s51, s51, 5120
 s_add_u32 m0, s57, 104448
 s_nop 0
 buffer_load_dwordx4 v4, s[8:11], s51 offen lds
 s_add_u32 s51, s51, 5120
 s_add_u32 m0, s57, 105472
 s_nop 0
 buffer_load_dwordx4 v5, s[8:11], s51 offen lds
 s_add_u32 s51, s51, 5120
 v_lshrrev_b32 v2, 3, v0
 v_and_b32 v2, 4, v2
 v_bfe_u32 v3, v0, 2, 2
 v_or_b32 v2, v2, v3
 v_bfe_u32 v3, v0, 4, 1
 v_xor_b32 v3, v3, v2
 s_lshl_b32 s3, s50, 1
 v_xor_b32 v3, s3, v3
 v_lshlrev_b32 v2, 8, v2
 v_lshl_add_u32 v2, v3, 5, v2
 v_and_b32 v3, 3, v0
 v_lshl_add_u32 v2, v3, 3, v2
 s_waitcnt vmcnt(24)
 s_barrier
 ds_read_b64_tr_b16 a[0:1], v2 offset:0
 ds_read_b64_tr_b16 a[2:3], v2 offset:4096
 ds_read_b64_tr_b16 a[4:5], v2 offset:2048
 ds_read_b64_tr_b16 a[6:7], v2 offset:6144
 ds_read_b64_tr_b16 a[8:9], v2 offset:8192
 ds_read_b64_tr_b16 a[10:11], v2 offset:12288
 ds_read_b64_tr_b16 a[12:13], v2 offset:10240
 ds_read_b64_tr_b16 a[14:15], v2 offset:14336
 ds_read_b64_tr_b16 a[16:17], v2 offset:16384
 ds_read_b64_tr_b16 a[18:19], v2 offset:20480
 ds_read_b64_tr_b16 a[20:21], v2 offset:18432
 ds_read_b64_tr_b16 a[22:23], v2 offset:22528
 ds_read_b64_tr_b16 a[24:25], v2 offset:24576
 ds_read_b64_tr_b16 a[26:27], v2 offset:28672
 ds_read_b64_tr_b16 a[28:29], v2 offset:26624
 ds_read_b64_tr_b16 a[30:31], v2 offset:30720
 v_add_u32 v2, 0x8000, v2
 s_waitcnt vmcnt(16)
 s_barrier
 ds_read_b64_tr_b16 a[32:33], v2 offset:0
 ds_read_b64_tr_b16 a[34:35], v2 offset:4096
 ds_read_b64_tr_b16 a[36:37], v2 offset:2048
 ds_read_b64_tr_b16 a[38:39], v2 offset:6144
 ds_read_b64_tr_b16 a[40:41], v2 offset:8192
 ds_read_b64_tr_b16 a[42:43], v2 offset:12288
 ds_read_b64_tr_b16 a[44:45], v2 offset:10240
 ds_read_b64_tr_b16 a[46:47], v2 offset:14336
 ds_read_b64_tr_b16 a[48:49], v2 offset:16384
 ds_read_b64_tr_b16 a[50:51], v2 offset:20480
 ds_read_b64_tr_b16 a[52:53], v2 offset:18432
 ds_read_b64_tr_b16 a[54:55], v2 offset:22528
 ds_read_b64_tr_b16 a[56:57], v2 offset:24576
 ds_read_b64_tr_b16 a[58:59], v2 offset:28672
 ds_read_b64_tr_b16 a[60:61], v2 offset:26624
 ds_read_b64_tr_b16 a[62:63], v2 offset:30720
 v_add_u32 v2, 0x8000, v2
 s_waitcnt vmcnt(8)
 s_barrier
 ds_read_b64_tr_b16 a[64:65], v2 offset:0
 ds_read_b64_tr_b16 a[66:67], v2 offset:4096
 ds_read_b64_tr_b16 a[68:69], v2 offset:2048
 ds_read_b64_tr_b16 a[70:71], v2 offset:6144
 ds_read_b64_tr_b16 a[72:73], v2 offset:8192
 ds_read_b64_tr_b16 a[74:75], v2 offset:12288
 ds_read_b64_tr_b16 a[76:77], v2 offset:10240
 ds_read_b64_tr_b16 a[78:79], v2 offset:14336
 ds_read_b64_tr_b16 a[80:81], v2 offset:16384
 ds_read_b64_tr_b16 a[82:83], v2 offset:20480
 ds_read_b64_tr_b16 a[84:85], v2 offset:18432
 ds_read_b64_tr_b16 a[86:87], v2 offset:22528
 ds_read_b64_tr_b16 a[88:89], v2 offset:24576
 ds_read_b64_tr_b16 a[90:91], v2 offset:28672
 ds_read_b64_tr_b16 a[92:93], v2 offset:26624
 ds_read_b64_tr_b16 a[94:95], v2 offset:30720
 v_add_u32 v2, 0x8000, v2
 s_waitcnt vmcnt(0)
 s_barrier
 ds_read_b64_tr_b16 a[96:97], v2 offset:0
 ds_read_b64_tr_b16 a[98:99], v2 offset:4096
 ds_read_b64_tr_b16 a[100:101], v2 offset:2048
 ds_read_b64_tr_b16 a[102:103], v2 offset:6144
 ds_read_b64_tr_b16 a[104:105], v2 offset:8192
 ds_read_b64_tr_b16 a[106:107], v2 offset:12288
 ds_read_b64_tr_b16 a[108:109], v2 offset:10240
 ds_read_b64_tr_b16 a[110:111], v2 offset:14336
 ds_read_b64_tr_b16 a[112:113], v2 offset:16384
 ds_read_b64_tr_b16 a[114:115], v2 offset:20480
 ds_read_b64_tr_b16 a[116:117], v2 offset:18432
 ds_read_b64_tr_b16 a[118:119], v2 offset:22528
 ds_read_b64_tr_b16 a[120:121], v2 offset:24576
 ds_read_b64_tr_b16 a[122:123], v2 offset:28672
 ds_read_b64_tr_b16 a[124:125], v2 offset:26624
 ds_read_b64_tr_b16 a[126:127], v2 offset:30720
 v_add_u32 v2, 0x8000, v2
 s_waitcnt lgkmcnt(0)
 s_barrier
L_help_conv:
 s_cmp_ge_u32 s82, 64
 s_cbranch_scc1 L_help_done
 s_lshl_b32 s70, s82, 2
 s_add_u32 s70, s70, s50
 s_add_u32 s70, s70, 384
 s_mul_i32 s71, s50, 13312
 s_mov_b32 s69, 640
 s_mov_b32 s8, s38
 s_and_b32 s9, s39, 0xffff
 s_mov_b32 s10, 2621440
 s_mov_b32 s11, 0x00020000
 s_mov_b32 s12, s40
 s_and_b32 s13, s41, 0xffff
 s_mov_b32 s14, 1280
 s_mov_b32 s15, 0x00020000
 v_lshlrev_b32 v130, 4, v0
 s_lshl_b32 s73, s70, 12
 s_add_u32 s74, s73, 2
 buffer_load_dwordx4 v[96:99], v130, s[8:11], s73 offen offset:0
 buffer_load_dwordx4 v[100:103], v130, s[8:11], s73 offen offset:1024
 buffer_load_dwordx4 v[112:115], v130, s[8:11], s74 offen offset:0
 buffer_load_dwordx4 v[116:119], v130, s[8:11], s74 offen offset:1024
 s_lshl_b32 s3, s70, 1
 buffer_load_ushort v128, off, s[12:15], s3
 s_getpc_b64 s[76:77]
L_ca_32:
 s_add_u32 s76, s76, L_conv0-L_ca_32
 s_addc_u32 s77, s77, -1
 s_swappc_b64 s[76:77], s[76:77]
 s_waitcnt vmcnt(0)
 s_barrier
 s_cmp_lg_u32 s50, 3
 s_cbranch_scc1 L_ar_33
 s_mov_b32 s96, s44
 s_and_b32 s97, s45, 0xffff
 s_mov_b32 s98, 256
 s_mov_b32 s99, 0x00020000
 v_mov_b32 v1, 1
 s_mov_b64 exec, 1
 buffer_atomic_add v1, off, s[96:99], 0 offset:8 sc0
 s_waitcnt vmcnt(0)
 v_cmp_eq_u32 vcc, 159, v1
 s_cbranch_vccz L_aw_34
 buffer_store_dword v1, off, s[96:99], 0 offset:136 sc1
L_aw_34:
 s_mov_b64 exec, -1
L_ar_33:
L_help_done:
 s_cmp_lg_u32 s50, 0
 s_cbranch_scc1 L_ww_35
 s_mov_b32 s96, s44
 s_and_b32 s97, s45, 0xffff
 s_mov_b32 s98, 256
 s_mov_b32 s99, 0x00020000
 v_mov_b32 v1, 132
 s_mov_b32 s51, 0
 s_mov_b64 exec, 1
L_wb_36:
 buffer_load_dword v2, v1, s[96:99], 0 offen sc1
 s_waitcnt vmcnt(0)
 v_cmp_eq_u32 vcc, 0, v2
 s_cbranch_vccz L_wbd_37
 s_sleep 2
 s_add_u32 s51, s51, 1
 s_cmp_lt_u32 s51, 131072
 s_cbranch_scc1 L_wb_36
 s_branch L_bail
L_wbd_37:
 s_mov_b64 exec, -1
L_ww_35:
 s_barrier
 s_cmp_eq_u32 s83, 0
 s_cbranch_scc1 L_t4
 s_cmp_eq_u32 s83, 1
 s_cbranch_scc1 L_wo
 s_cmp_eq_u32 s83, 2
 s_cbranch_scc1 L_vr_far
 s_cmp_eq_u32 s83, 4
 s_cbranch_scc1 L_ch_far
 s_branch L_wm
L_late:
 s_lshl_b32 s60, s82, 2
 s_add_u32 s60, s60, s50
 s_mul_i32 s71, s50, 13312
 s_add_u32 s72, s60, 544
 s_mov_b32 s8, s16
 s_and_b32 s9, s17, 0xffff
 s_mov_b32 s10, 2621440
 s_mov_b32 s11, 0x00020000
 v_lshlrev_b32 v1, 4, v0
 v_lshlrev_b32 v2, 3, v0
 v_cmp_lt_u32 vcc, 31, v0
 v_mov_b32 v3, 268435456
 s_nop 1
 v_cndmask_b32 v7, v2, v3, vcc
 s_mov_b32 s63, 0x3acccccd
 s_mov_b32 s68, 0x3727c5ac
 s_add_u32 s3, s72, 0
 s_mul_i32 s3, s3, 1280
 buffer_load_dwordx2 v[48:49], v2, s[8:11], s3 offen offset:0
 buffer_load_dwordx2 v[50:51], v2, s[8:11], s3 offen offset:512
 buffer_load_dwordx2 v[52:53], v7, s[8:11], s3 offen offset:1024
 s_waitcnt vmcnt(0)
L_ln_38:
 v_lshlrev_b32 v12, 16, v48
 v_and_b32 v13, 0xffff0000, v48
 v_lshlrev_b32 v14, 16, v49
 v_and_b32 v15, 0xffff0000, v49
 v_lshlrev_b32 v16, 16, v50
 v_and_b32 v17, 0xffff0000, v50
 v_lshlrev_b32 v18, 16, v51
 v_and_b32 v19, 0xffff0000, v51
 v_lshlrev_b32 v20, 16, v52
 v_and_b32 v21, 0xffff0000, v52
 v_lshlrev_b32 v22, 16, v53
 v_and_b32 v23, 0xffff0000, v53
 s_add_u32 s3, s72, 64
 s_mul_i32 s3, s3, 1280
 buffer_load_dwordx2 v[48:49], v2, s[8:11], s3 offen offset:0
 buffer_load_dwordx2 v[50:51], v2, s[8:11], s3 offen offset:512
 buffer_load_dwordx2 v[52:53], v7, s[8:11], s3 offen offset:1024
 s_and_b32 s3, s72, 15
 v_lshrrev_b32 v4, 3, v0
 v_lshlrev_b32 v4, 2, v4
 v_and_b32 v9, 3, v0
 v_add_u32 v4, v4, v9
 v_xor_b32 v4, s3, v4
 v_lshlrev_b32 v4, 4, v4
 v_and_b32 v9, 4, v0
 v_lshl_add_u32 v4, v9, 1, v4
 v_cndmask_b32 v8, v4, v3, vcc
 v_readfirstlane_b32 s3, v12
 s_nop 1
 v_subrev_f32 v36, s3, v12
 v_subrev_f32 v37, s3, v13
 v_subrev_f32 v38, s3, v14
 v_subrev_f32 v39, s3, v15
 v_subrev_f32 v40, s3, v16
 v_subrev_f32 v41, s3, v17
 v_subrev_f32 v42, s3, v18
 v_subrev_f32 v43, s3, v19
 v_mov_b32 v44, 0
 v_mov_b32 v45, 0
 v_mov_b32 v46, 0
 v_mov_b32 v47, 0
 s_mov_b32 exec_hi, 0
 v_subrev_f32 v44, s3, v20
 v_subrev_f32 v45, s3, v21
 v_subrev_f32 v46, s3, v22
 v_subrev_f32 v47, s3, v23
 s_mov_b32 exec_hi, -1
 v_pk_mul_f32 v[10:11], v[36:37], v[36:37]
 v_pk_fma_f32 v[10:11], v[38:39], v[38:39], v[10:11]
 v_pk_fma_f32 v[10:11], v[40:41], v[40:41], v[10:11]
 v_pk_fma_f32 v[10:11], v[42:43], v[42:43], v[10:11]
 v_pk_fma_f32 v[10:11], v[44:45], v[44:45], v[10:11]
 v_pk_fma_f32 v[10:11], v[46:47], v[46:47], v[10:11]
 v_pk_add_f32 v[36:37], v[36:37], v[38:39]
 v_pk_add_f32 v[36:37], v[36:37], v[40:41]
 v_pk_add_f32 v[36:37], v[36:37], v[42:43]
 v_pk_add_f32 v[36:37], v[36:37], v[44:45]
 v_pk_add_f32 v[36:37], v[36:37], v[46:47]
 v_add_f32 v11, v10, v11
 v_add_f32 v10, v36, v37
 s_nop 0
 v_add_f32_dpp v11, v11, v11 quad_perm:[1,0,3,2] row_mask:0xf bank_mask:0xf
 v_add_f32_dpp v10, v10, v10 quad_perm:[1,0,3,2] row_mask:0xf bank_mask:0xf
 s_nop 0
 v_add_f32_dpp v11, v11, v11 quad_perm:[2,3,0,1] row_mask:0xf bank_mask:0xf
 v_add_f32_dpp v10, v10, v10 quad_perm:[2,3,0,1] row_mask:0xf bank_mask:0xf
 s_nop 0
 v_add_f32_dpp v11, v11, v11 row_half_mirror row_mask:0xf bank_mask:0xf
 v_add_f32_dpp v10, v10, v10 row_half_mirror row_mask:0xf bank_mask:0xf
 s_nop 0
 v_add_f32_dpp v11, v11, v11 row_mirror row_mask:0xf bank_mask:0xf
 v_add_f32_dpp v10, v10, v10 row_mirror row_mask:0xf bank_mask:0xf
 v_mov_b32 v37, v11
 v_mov_b32 v36, v10
 s_nop 0
 v_permlane16_swap_b32 v11, v37
 v_permlane16_swap_b32 v10, v36
 v_pk_add_f32 v[10:11], v[10:11], v[36:37]
 v_mov_b32 v37, v11
 v_mov_b32 v36, v10
 s_nop 0
 v_permlane32_swap_b32 v11, v37
 v_permlane32_swap_b32 v10, v36
 v_pk_add_f32 v[10:11], v[10:11], v[36:37]
 v_mul_f32 v10, s63, v10
 v_mul_f32 v11, s63, v11
 v_fma_f32 v11, -v10, v10, v11
 v_max_f32 v11, 0, v11
 v_add_f32 v10, s3, v10
 v_cvt_pk_bf16_f32 v9, v10, v11
 v_lshlrev_b32 v10, 16, v9
 v_and_b32 v11, 0xffff0000, v9
 v_add_f32 v11, s68, v11
 v_cvt_pk_bf16_f32 v11, v11, v11
 v_and_b32 v11, 0xffff0000, v11
 v_sqrt_f32 v11, v11
 s_nop 0
 v_pk_add_f32 v[36:37], v[12:13], v[10:11] op_sel_hi:[1,0] neg_lo:[0,1] neg_hi:[0,1]
 v_pk_add_f32 v[38:39], v[14:15], v[10:11] op_sel_hi:[1,0] neg_lo:[0,1] neg_hi:[0,1]
 v_pk_add_f32 v[40:41], v[16:17], v[10:11] op_sel_hi:[1,0] neg_lo:[0,1] neg_hi:[0,1]
 v_pk_add_f32 v[42:43], v[18:19], v[10:11] op_sel_hi:[1,0] neg_lo:[0,1] neg_hi:[0,1]
 v_pk_add_f32 v[44:45], v[20:21], v[10:11] op_sel_hi:[1,0] neg_lo:[0,1] neg_hi:[0,1]
 v_pk_add_f32 v[46:47], v[22:23], v[10:11] op_sel_hi:[1,0] neg_lo:[0,1] neg_hi:[0,1]
 v_cvt_pk_bf16_f32 v11, v11, v11
 v_and_b32 v11, 0xffff0000, v11
 v_rcp_f32 v11, v11
 v_cvt_pk_bf16_f32 v9, v36, v37
 v_lshlrev_b32 v36, 16, v9
 v_and_b32 v37, 0xffff0000, v9
 v_cvt_pk_bf16_f32 v9, v38, v39
 v_lshlrev_b32 v38, 16, v9
 v_and_b32 v39, 0xffff0000, v9
 v_cvt_pk_bf16_f32 v9, v40, v41
 v_lshlrev_b32 v40, 16, v9
 v_and_b32 v41, 0xffff0000, v9
 v_cvt_pk_bf16_f32 v9, v42, v43
 v_lshlrev_b32 v42, 16, v9
 v_and_b32 v43, 0xffff0000, v9
 v_cvt_pk_bf16_f32 v9, v44, v45
 v_lshlrev_b32 v44, 16, v9
 v_and_b32 v45, 0xffff0000, v9
 v_cvt_pk_bf16_f32 v9, v46, v47
 v_lshlrev_b32 v46, 16, v9
 v_and_b32 v47, 0xffff0000, v9
 v_pk_mul_f32 v[36:37], v[36:37], v[10:11] op_sel:[0,1] op_sel_hi:[1,1]
 v_pk_mul_f32 v[38:39], v[38:39], v[10:11] op_sel:[0,1] op_sel_hi:[1,1]
 v_pk_mul_f32 v[40:41], v[40:41], v[10:11] op_sel:[0,1] op_sel_hi:[1,1]
 v_pk_mul_f32 v[42:43], v[42:43], v[10:11] op_sel:[0,1] op_sel_hi:[1,1]
 v_pk_mul_f32 v[44:45], v[44:45], v[10:11] op_sel:[0,1] op_sel_hi:[1,1]
 v_pk_mul_f32 v[46:47], v[46:47], v[10:11] op_sel:[0,1] op_sel_hi:[1,1]
 v_cvt_pk_bf16_f32 v24, v36, v37
 v_cvt_pk_bf16_f32 v25, v38, v39
 v_cvt_pk_bf16_f32 v26, v40, v41
 v_cvt_pk_bf16_f32 v27, v42, v43
 v_cvt_pk_bf16_f32 v28, v44, v45
 v_cvt_pk_bf16_f32 v29, v46, v47
 s_mul_i32 s3, s72, 1280
 s_add_u32 s3, s3, 192937984
 buffer_store_dwordx2 v[24:25], v4, s[4:7], s3 offen offset:0 sc1
 buffer_store_dwordx2 v[26:27], v4, s[4:7], s3 offen offset:512 sc1
 buffer_store_dwordx2 v[28:29], v8, s[4:7], s3 offen offset:1024 sc1
 s_add_u32 s72, s72, 64
 s_waitcnt vmcnt(3)
 s_cmp_lt_u32 s72, 2048
 s_cbranch_scc1 L_ln_38
 s_waitcnt vmcnt(0)
 s_mov_b32 s96, s44
 s_and_b32 s97, s45, 0xffff
 s_mov_b32 s98, 256
 s_mov_b32 s99, 0x00020000
 v_mov_b32 v1, 1
 s_mov_b64 exec, 1
 buffer_atomic_add v1, off, s[96:99], 0 offset:12 sc0
 s_waitcnt vmcnt(0)
 v_cmp_eq_u32 vcc, 63, v1
 s_cbranch_vccz L_aw_39
 buffer_store_dword v1, off, s[96:99], 0 offset:140 sc1
L_aw_39:
 s_mov_b64 exec, -1
 s_branch L_ch_far
L_qkvq:
 s_mul_i32 s57, s50, 40960
 s_mul_i32 s62, s52, 3
 s_add_u32 s62, s62, s53
 s_mul_i32 s3, s62, 13108
 s_lshr_b32 s3, s3, 16
 s_mul_i32 s3, s3, 5
 s_sub_u32 s55, s62, s3
 s_add_u32 s64, s55, 0
 s_sub_u32 s3, s64, 5
 s_cmp_ge_u32 s64, 5
 s_cselect_b32 s64, s3, s64
 s_add_u32 s65, s55, 1
 s_sub_u32 s3, s65, 5
 s_cmp_ge_u32 s65, 5
 s_cselect_b32 s65, s3, s65
 s_add_u32 s66, s55, 2
 s_sub_u32 s3, s66, 5
 s_cmp_ge_u32 s66, 5
 s_cselect_b32 s66, s3, s66
 s_add_u32 s67, s55, 3
 s_sub_u32 s3, s67, 5
 s_cmp_ge_u32 s67, 5
 s_cselect_b32 s67, s3, s67
 s_add_u32 s68, s55, 4
 s_sub_u32 s3, s68, 5
 s_cmp_ge_u32 s68, 5
 s_cselect_b32 s68, s3, s68
 s_lshl_b32 s55, s52, 8
 v_lshrrev_b32 v4, 4, v0
 s_mov_b32 s3, 8192
 v_mul_lo_u32 v4, v4, s3
 v_lshrrev_b32 v3, 3, v0
 v_and_b32 v3, 6, v3
 v_xor_b32 v3, v3, v0
 v_and_b32 v3, 15, v3
 v_lshl_add_u32 v4, v3, 4, v4
 v_xor_b32 v5, 128, v4
 s_lshl_b32 s57, s50, 13
 s_mul_i32 s3, s50, 262144
 s_add_u32 s55, s55, s3
 s_mul_i32 s51, s64, 1048576
 s_add_u32 s51, s51, s55
 s_add_u32 m0, s57, 0
 s_nop 0
 buffer_load_dwordx4 v4, s[8:11], s51 offen lds
 s_add_u32 s51, s51, 32768
 s_add_u32 m0, s57, 1024
 s_nop 0
 buffer_load_dwordx4 v5, s[8:11], s51 offen lds
 s_add_u32 s51, s51, 32768
 s_add_u32 m0, s57, 2048
 s_nop 0
 buffer_load_dwordx4 v4, s[8:11], s51 offen lds
 s_add_u32 s51, s51, 32768
 s_add_u32 m0, s57, 3072
 s_nop 0
 buffer_load_dwordx4 v5, s[8:11], s51 offen lds
 s_add_u32 s51, s51, 32768
 s_add_u32 m0, s57, 4096
 s_nop 0
 buffer_load_dwordx4 v4, s[8:11], s51 offen lds
 s_add_u32 s51, s51, 32768
 s_add_u32 m0, s57, 5120
 s_nop 0
 buffer_load_dwordx4 v5, s[8:11], s51 offen lds
 s_add_u32 s51, s51, 32768
 s_add_u32 m0, s57, 6144
 s_nop 0
 buffer_load_dwordx4 v4, s[8:11], s51 offen lds
 s_add_u32 s51, s51, 32768
 s_add_u32 m0, s57, 7168
 s_nop 0
 buffer_load_dwordx4 v5, s[8:11], s51 offen lds
 s_add_u32 s51, s51, 32768
 s_mul_i32 s51, s65, 1048576
 s_add_u32 s51, s51, s55
 s_add_u32 m0, s57, 32768
 s_nop 0
 buffer_load_dwordx4 v4, s[8:11], s51 offen lds
 s_add_u32 s51, s51, 32768
 s_add_u32 m0, s57, 33792
 s_nop 0
 buffer_load_dwordx4 v5, s[8:11], s51 offen lds
 s_add_u32 s51, s51, 32768
 s_add_u32 m0, s57, 34816
 s_nop 0
 buffer_load_dwordx4 v4, s[8:11], s51 offen lds
 s_add_u32 s51, s51, 32768
 s_add_u32 m0, s57, 35840
 s_nop 0
 buffer_load_dwordx4 v5, s[8:11], s51 offen lds
 s_add_u32 s51, s51, 32768
 s_add_u32 m0, s57, 36864
 s_nop 0
 buffer_load_dwordx4 v4, s[8:11], s51 offen lds
 s_add_u32 s51, s51, 32768
 s_add_u32 m0, s57, 37888
 s_nop 0
 buffer_load_dwordx4 v5, s[8:11], s51 offen lds
 s_add_u32 s51, s51, 32768
 s_add_u32 m0, s57, 38912
 s_nop 0
 buffer_load_dwordx4 v4, s[8:11], s51 offen lds
 s_add_u32 s51, s51, 32768
 s_add_u32 m0, s57, 39936
 s_nop 0
 buffer_load_dwordx4 v5, s[8:11], s51 offen lds
 s_add_u32 s51, s51, 32768
 s_mul_i32 s51, s66, 1048576
 s_add_u32 s51, s51, s55
 s_add_u32 m0, s57, 65536
 s_nop 0
 buffer_load_dwordx4 v4, s[8:11], s51 offen lds
 s_add_u32 s51, s51, 32768
 s_add_u32 m0, s57, 66560
 s_nop 0
 buffer_load_dwordx4 v5, s[8:11], s51 offen lds
 s_add_u32 s51, s51, 32768
 s_add_u32 m0, s57, 67584
 s_nop 0
 buffer_load_dwordx4 v4, s[8:11], s51 offen lds
 s_add_u32 s51, s51, 32768
 s_add_u32 m0, s57, 68608
 s_nop 0
 buffer_load_dwordx4 v5, s[8:11], s51 offen lds
 s_add_u32 s51, s51, 32768
 s_add_u32 m0, s57, 69632
 s_nop 0
 buffer_load_dwordx4 v4, s[8:11], s51 offen lds
 s_add_u32 s51, s51, 32768
 s_add_u32 m0, s57, 70656
 s_nop 0
 buffer_load_dwordx4 v5, s[8:11], s51 offen lds
 s_add_u32 s51, s51, 32768
 s_add_u32 m0, s57, 71680
 s_nop 0
 buffer_load_dwordx4 v4, s[8:11], s51 offen lds
 s_add_u32 s51, s51, 32768
 s_add_u32 m0, s57, 72704
 s_nop 0
 buffer_load_dwordx4 v5, s[8:11], s51 offen lds
 s_add_u32 s51, s51, 32768
 s_mul_i32 s51, s67, 1048576
 s_add_u32 s51, s51, s55
 s_add_u32 m0, s57, 98304
 s_nop 0
 buffer_load_dwordx4 v4, s[8:11], s51 offen lds
 s_add_u32 s51, s51, 32768
 s_add_u32 m0, s57, 99328
 s_nop 0
 buffer_load_dwordx4 v5, s[8:11], s51 offen lds
 s_add_u32 s51, s51, 32768
 s_add_u32 m0, s57, 100352
 s_nop 0
 buffer_load_dwordx4 v4, s[8:11], s51 offen lds
 s_add_u32 s51, s51, 32768
 s_add_u32 m0, s57, 101376
 s_nop 0
 buffer_load_dwordx4 v5, s[8:11], s51 offen lds
 s_add_u32 s51, s51, 32768
 s_add_u32 m0, s57, 102400
 s_nop 0
 buffer_load_dwordx4 v4, s[8:11], s51 offen lds
 s_add_u32 s51, s51, 32768
 s_add_u32 m0, s57, 103424
 s_nop 0
 buffer_load_dwordx4 v5, s[8:11], s51 offen lds
 s_add_u32 s51, s51, 32768
 s_add_u32 m0, s57, 104448
 s_nop 0
 buffer_load_dwordx4 v4, s[8:11], s51 offen lds
 s_add_u32 s51, s51, 32768
 s_add_u32 m0, s57, 105472
 s_nop 0
 buffer_load_dwordx4 v5, s[8:11], s51 offen lds
 s_add_u32 s51, s51, 32768
 s_mul_i32 s51, s68, 1048576
 s_add_u32 s51, s51, s55
 s_add_u32 m0, s57, 131072
 s_nop 0
 buffer_load_dwordx4 v4, s[8:11], s51 offen lds
 s_add_u32 s51, s51, 32768
 s_add_u32 m0, s57, 132096
 s_nop 0
 buffer_load_dwordx4 v5, s[8:11], s51 offen lds
 s_add_u32 s51, s51, 32768
 s_add_u32 m0, s57, 133120
 s_nop 0
 buffer_load_dwordx4 v4, s[8:11], s51 offen lds
 s_add_u32 s51, s51, 32768
 s_add_u32 m0, s57, 134144
 s_nop 0
 buffer_load_dwordx4 v5, s[8:11], s51 offen lds
 s_add_u32 s51, s51, 32768
 s_add_u32 m0, s57, 135168
 s_nop 0
 buffer_load_dwordx4 v4, s[8:11], s51 offen lds
 s_add_u32 s51, s51, 32768
 s_add_u32 m0, s57, 136192
 s_nop 0
 buffer_load_dwordx4 v5, s[8:11], s51 offen lds
 s_add_u32 s51, s51, 32768
 s_add_u32 m0, s57, 137216
 s_nop 0
 buffer_load_dwordx4 v4, s[8:11], s51 offen lds
 s_add_u32 s51, s51, 32768
 s_add_u32 m0, s57, 138240
 s_nop 0
 buffer_load_dwordx4 v5, s[8:11], s51 offen lds
 s_add_u32 s51, s51, 32768
 s_mov_b32 s96, s44
 s_and_b32 s97, s45, 0xffff
 s_mov_b32 s98, 256
 s_mov_b32 s99, 0x00020000
 buffer_load_dword v30, off, s[96:99], 0 offset:132 sc1
 v_lshrrev_b32 v2, 3, v0
 v_and_b32 v2, 4, v2
 v_bfe_u32 v3, v0, 2, 2
 v_or_b32 v2, v2, v3
 v_bfe_u32 v3, v0, 4, 1
 v_xor_b32 v3, v3, v2
 s_lshl_b32 s3, s50, 1
 v_xor_b32 v3, s3, v3
 v_lshlrev_b32 v2, 8, v2
 v_lshl_add_u32 v2, v3, 5, v2
 v_and_b32 v3, 3, v0
 v_lshl_add_u32 v2, v3, 3, v2
 s_waitcnt vmcnt(32)
 s_barrier
 ds_read_b64_tr_b16 a[0:1], v2 offset:0
 ds_read_b64_tr_b16 a[2:3], v2 offset:4096
 ds_read_b64_tr_b16 a[4:5], v2 offset:2048
 ds_read_b64_tr_b16 a[6:7], v2 offset:6144
 ds_read_b64_tr_b16 a[8:9], v2 offset:8192
 ds_read_b64_tr_b16 a[10:11], v2 offset:12288
 ds_read_b64_tr_b16 a[12:13], v2 offset:10240
 ds_read_b64_tr_b16 a[14:15], v2 offset:14336
 ds_read_b64_tr_b16 a[16:17], v2 offset:16384
 ds_read_b64_tr_b16 a[18:19], v2 offset:20480
 ds_read_b64_tr_b16 a[20:21], v2 offset:18432
 ds_read_b64_tr_b16 a[22:23], v2 offset:22528
 ds_read_b64_tr_b16 a[24:25], v2 offset:24576
 ds_read_b64_tr_b16 a[26:27], v2 offset:28672
 ds_read_b64_tr_b16 a[28:29], v2 offset:26624
 ds_read_b64_tr_b16 a[30:31], v2 offset:30720
 v_add_u32 v2, 0x8000, v2
 s_waitcnt vmcnt(24)
 s_barrier
 ds_read_b64_tr_b16 a[32:33], v2 offset:0
 ds_read_b64_tr_b16 a[34:35], v2 offset:4096
 ds_read_b64_tr_b16 a[36:37], v2 offset:2048
 ds_read_b64_tr_b16 a[38:39], v2 offset:6144
 ds_read_b64_tr_b16 a[40:41], v2 offset:8192
 ds_read_b64_tr_b16 a[42:43], v2 offset:12288
 ds_read_b64_tr_b16 a[44:45], v2 offset:10240
 ds_read_b64_tr_b16 a[46:47], v2 offset:14336
 ds_read_b64_tr_b16 a[48:49], v2 offset:16384
 ds_read_b64_tr_b16 a[50:51], v2 offset:20480
 ds_read_b64_tr_b16 a[52:53], v2 offset:18432
 ds_read_b64_tr_b16 a[54:55], v2 offset:22528
 ds_read_b64_tr_b16 a[56:57], v2 offset:24576
 ds_read_b64_tr_b16 a[58:59], v2 offset:28672
 ds_read_b64_tr_b16 a[60:61], v2 offset:26624
 ds_read_b64_tr_b16 a[62:63], v2 offset:30720
 v_add_u32 v2, 0x8000, v2
 s_waitcnt vmcnt(16)
 s_barrier
 ds_read_b64_tr_b16 a[64:65], v2 offset:0
 ds_read_b64_tr_b16 a[66:67], v2 offset:4096
 ds_read_b64_tr_b16 a[68:69], v2 offset:2048
 ds_read_b64_tr_b16 a[70:71], v2 offset:6144
 ds_read_b64_tr_b16 a[72:73], v2 offset:8192
 ds_read_b64_tr_b16 a[74:75], v2 offset:12288
 ds_read_b64_tr_b16 a[76:77], v2 offset:10240
 ds_read_b64_tr_b16 a[78:79], v2 offset:14336
 ds_read_b64_tr_b16 a[80:81], v2 offset:16384
 ds_read_b64_tr_b16 a[82:83], v2 offset:20480
 ds_read_b64_tr_b16 a[84:85], v2 offset:18432
 ds_read_b64_tr_b16 a[86:87], v2 offset:22528
 ds_read_b64_tr_b16 a[88:89], v2 offset:24576
 ds_read_b64_tr_b16 a[90:91], v2 offset:28672
 ds_read_b64_tr_b16 a[92:93], v2 offset:26624
 ds_read_b64_tr_b16 a[94:95], v2 offset:30720
 v_add_u32 v2, 0x8000, v2
 s_waitcnt vmcnt(8)
 s_barrier
 ds_read_b64_tr_b16 a[96:97], v2 offset:0
 ds_read_b64_tr_b16 a[98:99], v2 offset:4096
 ds_read_b64_tr_b16 a[100:101], v2 offset:2048
 ds_read_b64_tr_b16 a[102:103], v2 offset:6144
 ds_read_b64_tr_b16 a[104:105], v2 offset:8192
 ds_read_b64_tr_b16 a[106:107], v2 offset:12288
 ds_read_b64_tr_b16 a[108:109], v2 offset:10240
 ds_read_b64_tr_b16 a[110:111], v2 offset:14336
 ds_read_b64_tr_b16 a[112:113], v2 offset:16384
 ds_read_b64_tr_b16 a[114:115], v2 offset:20480
 ds_read_b64_tr_b16 a[116:117], v2 offset:18432
 ds_read_b64_tr_b16 a[118:119], v2 offset:22528
 ds_read_b64_tr_b16 a[120:121], v2 offset:24576
 ds_read_b64_tr_b16 a[122:123], v2 offset:28672
 ds_read_b64_tr_b16 a[124:125], v2 offset:26624
 ds_read_b64_tr_b16 a[126:127], v2 offset:30720
 v_add_u32 v2, 0x8000, v2
 s_waitcnt vmcnt(0)
 s_barrier
 ds_read_b64_tr_b16 a[128:129], v2 offset:0
 ds_read_b64_tr_b16 a[130:131], v2 offset:4096
 ds_read_b64_tr_b16 a[132:133], v2 offset:2048
 ds_read_b64_tr_b16 a[134:135], v2 offset:6144
 ds_read_b64_tr_b16 a[136:137], v2 offset:8192
 ds_read_b64_tr_b16 a[138:139], v2 offset:12288
 ds_read_b64_tr_b16 a[140:141], v2 offset:10240
 ds_read_b64_tr_b16 a[142:143], v2 offset:14336
 ds_read_b64_tr_b16 a[144:145], v2 offset:16384
 ds_read_b64_tr_b16 a[146:147], v2 offset:20480
 ds_read_b64_tr_b16 a[148:149], v2 offset:18432
 ds_read_b64_tr_b16 a[150:151], v2 offset:22528
 ds_read_b64_tr_b16 a[152:153], v2 offset:24576
 ds_read_b64_tr_b16 a[154:155], v2 offset:28672
 ds_read_b64_tr_b16 a[156:157], v2 offset:26624
 ds_read_b64_tr_b16 a[158:159], v2 offset:30720
 v_add_u32 v2, 0x8000, v2
 s_waitcnt lgkmcnt(0)
 s_barrier
 v_cmp_eq_u32 vcc, 0, v30
 s_cbranch_vccz L_qa_40
 s_mov_b32 s96, s44
 s_and_b32 s97, s45, 0xffff
 s_mov_b32 s98, 256
 s_mov_b32 s99, 0x00020000
 v_mov_b32 v1, 132
 s_mov_b32 s51, 0
 s_mov_b64 exec, 1
L_wb_41:
 buffer_load_dword v2, v1, s[96:99], 0 offen sc1
 s_waitcnt vmcnt(0)
 v_cmp_eq_u32 vcc, 0, v2
 s_cbranch_vccz L_wbd_42
 s_sleep 2
 s_add_u32 s51, s51, 1
 s_cmp_lt_u32 s51, 131072
 s_cbranch_scc1 L_wb_41
 s_branch L_bail
L_wbd_42:
 s_mov_b64 exec, -1
L_qa_40:
 s_lshl_b32 s64, s64, 8
 s_lshl_b32 s65, s65, 8
 s_lshl_b32 s66, s66, 8
 s_lshl_b32 s67, s67, 8
 s_lshl_b32 s68, s68, 8
 v_lshrrev_b32 v1, 4, v0
 s_mov_b32 s3, 1280
 v_mul_lo_u32 v1, v1, s3
 v_and_b32 v3, 15, v0
 v_lshl_add_u32 v1, v3, 4, v1
 v_add_u32 v6, 5120, v1
 v_mov_b32 v24, v6
 v_and_b32 v2, 31, v0
 v_lshlrev_b32 v2, 8, v2
 v_lshrrev_b32 v4, 5, v0
 v_xor_b32 v4, v4, v3
 v_xor_b32 v8, 0, v4
 v_lshl_add_u32 v8, v8, 4, v2
 v_add_u32 v16, 40960, v8
 v_xor_b32 v9, 2, v4
 v_lshl_add_u32 v9, v9, 4, v2
 v_add_u32 v17, 40960, v9
 v_xor_b32 v10, 4, v4
 v_lshl_add_u32 v10, v10, 4, v2
 v_add_u32 v18, 40960, v10
 v_xor_b32 v11, 6, v4
 v_lshl_add_u32 v11, v11, 4, v2
 v_add_u32 v19, 40960, v11
 v_xor_b32 v12, 8, v4
 v_lshl_add_u32 v12, v12, 4, v2
 v_add_u32 v20, 40960, v12
 v_xor_b32 v13, 10, v4
 v_lshl_add_u32 v13, v13, 4, v2
 v_add_u32 v21, 40960, v13
 v_xor_b32 v14, 12, v4
 v_lshl_add_u32 v14, v14, 4, v2
 v_add_u32 v22, 40960, v14
 v_xor_b32 v15, 14, v4
 v_lshl_add_u32 v15, v15, 4, v2
 v_add_u32 v23, 40960, v15
 v_lshrrev_b32 v4, 5, v0
 v_lshlrev_b32 v4, 8, v4
 v_lshl_add_u32 v4, v3, 4, v4
 v_and_b32 v2, 16, v0
 v_lshl_add_u32 v4, v2, 8, v4
 s_lshl_b32 s3, s50, 10
 v_add_u32 v4, s3, v4
 v_mul_u32_u24 v5, 49152, v0
 v_mov_b32 v7, 163776
 s_lshl_b32 s75, s62, 2
 s_add_u32 s75, s75, s50
 s_and_b32 s100, s52, 1
 s_lshl_b32 s100, s100, 13
 s_lshl_b32 s58, s52, 14
 s_add_u32 s58, s58, s100
 s_add_u32 s58, s58, 16777216
 s_cmp_eq_u32 s53, 0
 s_cselect_b32 s82, 8192, 0
 s_lshl_b32 s59, s52, 8
 s_add_u32 s59, s59, 16384
 s_lshl_b32 s56, s50, 11
 s_mov_b32 s54, 0
 s_mov_b32 s61, 0
 s_mov_b32 s70, s75
 s_mul_i32 s55, s54, 40960
 s_mul_i32 s3, s50, 10240
 s_add_u32 s55, s55, s3
 s_add_u32 s55, s55, 192937984
 s_add_u32 m0, s56, 0
 s_add_u32 s3, s55, s64
 buffer_load_dwordx4 v1, s[4:7], s3 offen sc1 lds
 s_add_u32 m0, s56, 1024
 s_add_u32 s3, s55, s64
 buffer_load_dwordx4 v24, s[4:7], s3 offen sc1 lds
 s_add_u32 m0, s56, 8192
 s_add_u32 s3, s55, s65
 buffer_load_dwordx4 v1, s[4:7], s3 offen sc1 lds
 s_add_u32 m0, s56, 9216
 s_add_u32 s3, s55, s65
 buffer_load_dwordx4 v24, s[4:7], s3 offen sc1 lds
 s_add_u32 m0, s56, 16384
 s_add_u32 s3, s55, s66
 buffer_load_dwordx4 v1, s[4:7], s3 offen sc1 lds
 s_add_u32 m0, s56, 17408
 s_add_u32 s3, s55, s66
 buffer_load_dwordx4 v24, s[4:7], s3 offen sc1 lds
 s_add_u32 m0, s56, 24576
 s_add_u32 s3, s55, s67
 buffer_load_dwordx4 v1, s[4:7], s3 offen sc1 lds
 s_add_u32 m0, s56, 25600
 s_add_u32 s3, s55, s67
 buffer_load_dwordx4 v24, s[4:7], s3 offen sc1 lds
 s_add_u32 m0, s56, 32768
 s_add_u32 s3, s55, s68
 buffer_load_dwordx4 v1, s[4:7], s3 offen sc1 lds
 s_add_u32 m0, s56, 33792
 s_add_u32 s3, s55, s68
 buffer_load_dwordx4 v24, s[4:7], s3 offen sc1 lds
 s_waitcnt vmcnt(0)
L_qkvq_pre:
 s_barrier
 s_mov_b32 s60, s54
 s_add_u32 s54, s54, 1
 s_mul_i32 s55, s54, 40960
 s_mul_i32 s3, s50, 10240
 s_add_u32 s55, s55, s3
 s_add_u32 s55, s55, 192937984
 ds_read_b128 v[32:35], v8 offset:0
 ds_read_b128 v[36:39], v9 offset:0
 ds_read_b128 v[40:43], v10 offset:0
 ds_read_b128 v[44:47], v11 offset:0
 s_waitcnt lgkmcnt(3)
 v_mfma_f32_32x32x16_bf16 v[64:79], a[0:3], v[32:35], 0
 ds_read_b128 v[48:51], v12 offset:0
 s_add_u32 m0, s56, 40960
 s_add_u32 s3, s55, s64
 buffer_load_dwordx4 v1, s[4:7], s3 offen sc1 lds
 s_waitcnt lgkmcnt(3)
 v_mfma_f32_32x32x16_bf16 v[64:79], a[4:7], v[36:39], v[64:79]
 ds_read_b128 v[52:55], v13 offset:0
 s_waitcnt lgkmcnt(3)
 v_mfma_f32_32x32x16_bf16 v[64:79], a[8:11], v[40:43], v[64:79]
 ds_read_b128 v[56:59], v14 offset:0
 s_waitcnt lgkmcnt(3)
 v_mfma_f32_32x32x16_bf16 v[64:79], a[12:15], v[44:47], v[64:79]
 ds_read_b128 v[60:63], v15 offset:0
 s_add_u32 m0, s56, 41984
 s_add_u32 s3, s55, s64
 buffer_load_dwordx4 v24, s[4:7], s3 offen sc1 lds
 s_waitcnt lgkmcnt(3)
 v_mfma_f32_32x32x16_bf16 v[64:79], a[16:19], v[48:51], v[64:79]
 ds_read_b128 v[32:35], v8 offset:8192
 s_waitcnt lgkmcnt(3)
 v_mfma_f32_32x32x16_bf16 v[64:79], a[20:23], v[52:55], v[64:79]
 ds_read_b128 v[36:39], v9 offset:8192
 s_waitcnt lgkmcnt(3)
 v_mfma_f32_32x32x16_bf16 v[64:79], a[24:27], v[56:59], v[64:79]
 ds_read_b128 v[40:43], v10 offset:8192
 s_add_u32 m0, s56, 49152
 s_add_u32 s3, s55, s65
 buffer_load_dwordx4 v1, s[4:7], s3 offen sc1 lds
 s_waitcnt lgkmcnt(3)
 v_mfma_f32_32x32x16_bf16 v[64:79], a[28:31], v[60:63], v[64:79]
 ds_read_b128 v[44:47], v11 offset:8192
 s_waitcnt lgkmcnt(3)
 v_mfma_f32_32x32x16_bf16 v[64:79], a[32:35], v[32:35], v[64:79]
 ds_read_b128 v[48:51], v12 offset:8192
 s_waitcnt lgkmcnt(3)
 v_mfma_f32_32x32x16_bf16 v[64:79], a[36:39], v[36:39], v[64:79]
 ds_read_b128 v[52:55], v13 offset:8192
 s_add_u32 m0, s56, 50176
 s_add_u32 s3, s55, s65
 buffer_load_dwordx4 v24, s[4:7], s3 offen sc1 lds
 s_waitcnt lgkmcnt(3)
 v_mfma_f32_32x32x16_bf16 v[64:79], a[40:43], v[40:43], v[64:79]
 ds_read_b128 v[56:59], v14 offset:8192
 s_waitcnt lgkmcnt(3)
 v_mfma_f32_32x32x16_bf16 v[64:79], a[44:47], v[44:47], v[64:79]
 ds_read_b128 v[60:63], v15 offset:8192
 s_waitcnt lgkmcnt(3)
 v_mfma_f32_32x32x16_bf16 v[64:79], a[48:51], v[48:51], v[64:79]
 ds_read_b128 v[32:35], v8 offset:16384
 s_add_u32 m0, s56, 57344
 s_add_u32 s3, s55, s66
 buffer_load_dwordx4 v1, s[4:7], s3 offen sc1 lds
 s_waitcnt lgkmcnt(3)
 v_mfma_f32_32x32x16_bf16 v[64:79], a[52:55], v[52:55], v[64:79]
 ds_read_b128 v[36:39], v9 offset:16384
 s_waitcnt lgkmcnt(3)
 v_mfma_f32_32x32x16_bf16 v[64:79], a[56:59], v[56:59], v[64:79]
 ds_read_b128 v[40:43], v10 offset:16384
 s_waitcnt lgkmcnt(3)
 v_mfma_f32_32x32x16_bf16 v[64:79], a[60:63], v[60:63], v[64:79]
 ds_read_b128 v[44:47], v11 offset:16384
 s_add_u32 m0, s56, 58368
 s_add_u32 s3, s55, s66
 buffer_load_dwordx4 v24, s[4:7], s3 offen sc1 lds
 s_waitcnt lgkmcnt(3)
 v_mfma_f32_32x32x16_bf16 v[64:79], a[64:67], v[32:35], v[64:79]
 ds_read_b128 v[48:51], v12 offset:16384
 s_waitcnt lgkmcnt(3)
 v_mfma_f32_32x32x16_bf16 v[64:79], a[68:71], v[36:39], v[64:79]
 ds_read_b128 v[52:55], v13 offset:16384
 s_waitcnt lgkmcnt(3)
 v_mfma_f32_32x32x16_bf16 v[64:79], a[72:75], v[40:43], v[64:79]
 ds_read_b128 v[56:59], v14 offset:16384
 s_add_u32 m0, s56, 65536
 s_add_u32 s3, s55, s67
 buffer_load_dwordx4 v1, s[4:7], s3 offen sc1 lds
 s_waitcnt lgkmcnt(3)
 v_mfma_f32_32x32x16_bf16 v[64:79], a[76:79], v[44:47], v[64:79]
 ds_read_b128 v[60:63], v15 offset:16384
 s_waitcnt vmcnt(7)
 s_cmp_eq_u32 s61, 0
 s_cbranch_scc1 L_pf_43
 s_lshl_b32 s3, s61, 2
 s_add_u32 s3, s3, s59
 s_sub_u32 s3, s3, 4
 v_mov_b32 v3, 1
 s_mov_b64 exec, 1
 buffer_atomic_add v3, v5, s[4:7], s3 offen
 s_mov_b64 exec, -1
 s_mov_b32 s61, 0
L_pf_43:
 s_waitcnt lgkmcnt(3)
 v_mfma_f32_32x32x16_bf16 v[64:79], a[80:83], v[48:51], v[64:79]
 ds_read_b128 v[32:35], v8 offset:24576
 s_waitcnt lgkmcnt(3)
 v_mfma_f32_32x32x16_bf16 v[64:79], a[84:87], v[52:55], v[64:79]
 ds_read_b128 v[36:39], v9 offset:24576
 s_add_u32 m0, s56, 66560
 s_add_u32 s3, s55, s67
 buffer_load_dwordx4 v24, s[4:7], s3 offen sc1 lds
 s_waitcnt lgkmcnt(3)
 v_mfma_f32_32x32x16_bf16 v[64:79], a[88:91], v[56:59], v[64:79]
 ds_read_b128 v[40:43], v10 offset:24576
 s_waitcnt lgkmcnt(3)
 v_mfma_f32_32x32x16_bf16 v[64:79], a[92:95], v[60:63], v[64:79]
 ds_read_b128 v[44:47], v11 offset:24576
 s_waitcnt lgkmcnt(3)
 v_mfma_f32_32x32x16_bf16 v[64:79], a[96:99], v[32:35], v[64:79]
 ds_read_b128 v[48:51], v12 offset:24576
 s_add_u32 m0, s56, 73728
 s_add_u32 s3, s55, s68
 buffer_load_dwordx4 v1, s[4:7], s3 offen sc1 lds
 s_waitcnt lgkmcnt(3)
 v_mfma_f32_32x32x16_bf16 v[64:79], a[100:103], v[36:39], v[64:79]
 ds_read_b128 v[52:55], v13 offset:24576
 s_waitcnt lgkmcnt(3)
 v_mfma_f32_32x32x16_bf16 v[64:79], a[104:107], v[40:43], v[64:79]
 ds_read_b128 v[56:59], v14 offset:24576
 s_waitcnt lgkmcnt(3)
 v_mfma_f32_32x32x16_bf16 v[64:79], a[108:111], v[44:47], v[64:79]
 ds_read_b128 v[60:63], v15 offset:24576
 s_add_u32 m0, s56, 74752
 s_add_u32 s3, s55, s68
 buffer_load_dwordx4 v24, s[4:7], s3 offen sc1 lds
 s_waitcnt lgkmcnt(3)
 v_mfma_f32_32x32x16_bf16 v[64:79], a[112:115], v[48:51], v[64:79]
 ds_read_b128 v[32:35], v8 offset:32768
 s_waitcnt lgkmcnt(3)
 v_mfma_f32_32x32x16_bf16 v[64:79], a[116:119], v[52:55], v[64:79]
 ds_read_b128 v[36:39], v9 offset:32768
 s_waitcnt lgkmcnt(3)
 v_mfma_f32_32x32x16_bf16 v[64:79], a[120:123], v[56:59], v[64:79]
 ds_read_b128 v[40:43], v10 offset:32768
 s_waitcnt lgkmcnt(3)
 v_mfma_f32_32x32x16_bf16 v[64:79], a[124:127], v[60:63], v[64:79]
 ds_read_b128 v[44:47], v11 offset:32768
 s_waitcnt lgkmcnt(3)
 v_mfma_f32_32x32x16_bf16 v[64:79], a[128:131], v[32:35], v[64:79]
 ds_read_b128 v[48:51], v12 offset:32768
 s_waitcnt lgkmcnt(3)
 v_mfma_f32_32x32x16_bf16 v[64:79], a[132:135], v[36:39], v[64:79]
 ds_read_b128 v[52:55], v13 offset:32768
 s_waitcnt lgkmcnt(3)
 v_mfma_f32_32x32x16_bf16 v[64:79], a[136:139], v[40:43], v[64:79]
 ds_read_b128 v[56:59], v14 offset:32768
 s_waitcnt lgkmcnt(3)
 v_mfma_f32_32x32x16_bf16 v[64:79], a[140:143], v[44:47], v[64:79]
 ds_read_b128 v[60:63], v15 offset:32768
 s_waitcnt lgkmcnt(3)
 v_mfma_f32_32x32x16_bf16 v[64:79], a[144:147], v[48:51], v[64:79]
 s_waitcnt lgkmcnt(2)
 v_mfma_f32_32x32x16_bf16 v[64:79], a[148:151], v[52:55], v[64:79]
 s_waitcnt lgkmcnt(1)
 v_mfma_f32_32x32x16_bf16 v[64:79], a[152:155], v[56:59], v[64:79]
 s_waitcnt lgkmcnt(0)
 v_mfma_f32_32x32x16_bf16 v[64:79], a[156:159], v[60:63], v[64:79]
 s_lshl_b32 s3, s60, 19
 s_add_u32 s3, s3, s58
 s_xor_b32 s3, s3, s82
 s_nop 8
 v_cvt_pk_bf16_f32 v80, v64, v65
 v_cvt_pk_bf16_f32 v81, v66, v67
 v_cvt_pk_bf16_f32 v82, v72, v73
 v_cvt_pk_bf16_f32 v83, v74, v75
 buffer_store_dwordx4 v[80:83], v4, s[4:7], s3 offen offset:0 sc1
 v_cvt_pk_bf16_f32 v84, v68, v69
 v_cvt_pk_bf16_f32 v85, v70, v71
 v_cvt_pk_bf16_f32 v86, v76, v77
 v_cvt_pk_bf16_f32 v87, v78, v79
 buffer_store_dwordx4 v[84:87], v4, s[4:7], s3 offen offset:512 sc1
 s_mov_b32 s61, s54
 s_cmp_lg_u32 s54, 1
 s_cbranch_scc1 L_f1_44
 s_waitcnt vmcnt(0)
 s_cmp_eq_u32 s61, 0
 s_cbranch_scc1 L_pf_45
 s_lshl_b32 s3, s61, 2
 s_add_u32 s3, s3, s59
 s_sub_u32 s3, s3, 4
 v_mov_b32 v3, 1
 s_mov_b64 exec, 1
 buffer_atomic_add v3, v5, s[4:7], s3 offen
 s_mov_b64 exec, -1
 s_mov_b32 s61, 0
L_pf_45:
 s_mov_b32 s8, s38
 s_and_b32 s9, s39, 0xffff
 s_mov_b32 s10, 2621440
 s_mov_b32 s11, 0x00020000
 s_mov_b32 s12, s40
 s_and_b32 s13, s41, 0xffff
 s_mov_b32 s14, 1280
 s_mov_b32 s15, 0x00020000
 v_lshlrev_b32 v130, 4, v0
 s_lshl_b32 s73, s70, 12
 s_add_u32 s74, s73, 2
 buffer_load_dwordx4 v[96:99], v130, s[8:11], s73 offen offset:0
 buffer_load_dwordx4 v[100:103], v130, s[8:11], s73 offen offset:1024
 buffer_load_dwordx4 v[112:115], v130, s[8:11], s74 offen offset:0
 buffer_load_dwordx4 v[116:119], v130, s[8:11], s74 offen offset:1024
 s_lshl_b32 s3, s70, 1
 buffer_load_ushort v128, off, s[12:15], s3
 s_branch L_f2_46
L_f1_44:
 s_waitcnt vmcnt(2)
L_f2_46:
 s_barrier
 s_mov_b32 s60, s54
 s_add_u32 s54, s54, 1
 s_mul_i32 s55, s54, 40960
 s_mul_i32 s3, s50, 10240
 s_add_u32 s55, s55, s3
 s_add_u32 s55, s55, 192937984
 ds_read_b128 v[32:35], v16 offset:0
 ds_read_b128 v[36:39], v17 offset:0
 ds_read_b128 v[40:43], v18 offset:0
 ds_read_b128 v[44:47], v19 offset:0
 s_waitcnt lgkmcnt(3)
 v_mfma_f32_32x32x16_bf16 v[64:79], a[0:3], v[32:35], 0
 ds_read_b128 v[48:51], v20 offset:0
 s_add_u32 m0, s56, 0
 s_add_u32 s3, s55, s64
 buffer_load_dwordx4 v1, s[4:7], s3 offen sc1 lds
 s_waitcnt lgkmcnt(3)
 v_mfma_f32_32x32x16_bf16 v[64:79], a[4:7], v[36:39], v[64:79]
 ds_read_b128 v[52:55], v21 offset:0
 s_waitcnt lgkmcnt(3)
 v_mfma_f32_32x32x16_bf16 v[64:79], a[8:11], v[40:43], v[64:79]
 ds_read_b128 v[56:59], v22 offset:0
 s_waitcnt lgkmcnt(3)
 v_mfma_f32_32x32x16_bf16 v[64:79], a[12:15], v[44:47], v[64:79]
 ds_read_b128 v[60:63], v23 offset:0
 s_add_u32 m0, s56, 1024
 s_add_u32 s3, s55, s64
 buffer_load_dwordx4 v24, s[4:7], s3 offen sc1 lds
 s_waitcnt lgkmcnt(3)
 v_mfma_f32_32x32x16_bf16 v[64:79], a[16:19], v[48:51], v[64:79]
 ds_read_b128 v[32:35], v16 offset:8192
 s_waitcnt lgkmcnt(3)
 v_mfma_f32_32x32x16_bf16 v[64:79], a[20:23], v[52:55], v[64:79]
 ds_read_b128 v[36:39], v17 offset:8192
 s_waitcnt lgkmcnt(3)
 v_mfma_f32_32x32x16_bf16 v[64:79], a[24:27], v[56:59], v[64:79]
 ds_read_b128 v[40:43], v18 offset:8192
 s_add_u32 m0, s56, 8192
 s_add_u32 s3, s55, s65
 buffer_load_dwordx4 v1, s[4:7], s3 offen sc1 lds
 s_waitcnt lgkmcnt(3)
 v_mfma_f32_32x32x16_bf16 v[64:79], a[28:31], v[60:63], v[64:79]
 ds_read_b128 v[44:47], v19 offset:8192
 s_waitcnt lgkmcnt(3)
 v_mfma_f32_32x32x16_bf16 v[64:79], a[32:35], v[32:35], v[64:79]
 ds_read_b128 v[48:51], v20 offset:8192
 s_waitcnt lgkmcnt(3)
 v_mfma_f32_32x32x16_bf16 v[64:79], a[36:39], v[36:39], v[64:79]
 ds_read_b128 v[52:55], v21 offset:8192
 s_add_u32 m0, s56, 9216
 s_add_u32 s3, s55, s65
 buffer_load_dwordx4 v24, s[4:7], s3 offen sc1 lds
 s_waitcnt lgkmcnt(3)
 v_mfma_f32_32x32x16_bf16 v[64:79], a[40:43], v[40:43], v[64:79]
 ds_read_b128 v[56:59], v22 offset:8192
 s_waitcnt lgkmcnt(3)
 v_mfma_f32_32x32x16_bf16 v[64:79], a[44:47], v[44:47], v[64:79]
 ds_read_b128 v[60:63], v23 offset:8192
 s_waitcnt lgkmcnt(3)
 v_mfma_f32_32x32x16_bf16 v[64:79], a[48:51], v[48:51], v[64:79]
 ds_read_b128 v[32:35], v16 offset:16384
 s_add_u32 m0, s56, 16384
 s_add_u32 s3, s55, s66
 buffer_load_dwordx4 v1, s[4:7], s3 offen sc1 lds
 s_waitcnt lgkmcnt(3)
 v_mfma_f32_32x32x16_bf16 v[64:79], a[52:55], v[52:55], v[64:79]
 ds_read_b128 v[36:39], v17 offset:16384
 s_waitcnt lgkmcnt(3)
 v_mfma_f32_32x32x16_bf16 v[64:79], a[56:59], v[56:59], v[64:79]
 ds_read_b128 v[40:43], v18 offset:16384
 s_waitcnt lgkmcnt(3)
 v_mfma_f32_32x32x16_bf16 v[64:79], a[60:63], v[60:63], v[64:79]
 ds_read_b128 v[44:47], v19 offset:16384
 s_add_u32 m0, s56, 17408
 s_add_u32 s3, s55, s66
 buffer_load_dwordx4 v24, s[4:7], s3 offen sc1 lds
 s_waitcnt lgkmcnt(3)
 v_mfma_f32_32x32x16_bf16 v[64:79], a[64:67], v[32:35], v[64:79]
 ds_read_b128 v[48:51], v20 offset:16384
 s_waitcnt lgkmcnt(3)
 v_mfma_f32_32x32x16_bf16 v[64:79], a[68:71], v[36:39], v[64:79]
 ds_read_b128 v[52:55], v21 offset:16384
 s_waitcnt lgkmcnt(3)
 v_mfma_f32_32x32x16_bf16 v[64:79], a[72:75], v[40:43], v[64:79]
 ds_read_b128 v[56:59], v22 offset:16384
 s_add_u32 m0, s56, 24576
 s_add_u32 s3, s55, s67
 buffer_load_dwordx4 v1, s[4:7], s3 offen sc1 lds
 s_waitcnt lgkmcnt(3)
 v_mfma_f32_32x32x16_bf16 v[64:79], a[76:79], v[44:47], v[64:79]
 ds_read_b128 v[60:63], v23 offset:16384
 s_waitcnt vmcnt(7)
 s_cmp_eq_u32 s61, 0
 s_cbranch_scc1 L_pf_47
 s_lshl_b32 s3, s61, 2
 s_add_u32 s3, s3, s59
 s_sub_u32 s3, s3, 4
 v_mov_b32 v3, 1
 s_mov_b64 exec, 1
 buffer_atomic_add v3, v5, s[4:7], s3 offen
 s_mov_b64 exec, -1
 s_mov_b32 s61, 0
L_pf_47:
 s_waitcnt lgkmcnt(3)
 v_mfma_f32_32x32x16_bf16 v[64:79], a[80:83], v[48:51], v[64:79]
 ds_read_b128 v[32:35], v16 offset:24576
 s_waitcnt lgkmcnt(3)
 v_mfma_f32_32x32x16_bf16 v[64:79], a[84:87], v[52:55], v[64:79]
 ds_read_b128 v[36:39], v17 offset:24576
 s_add_u32 m0, s56, 25600
 s_add_u32 s3, s55, s67
 buffer_load_dwordx4 v24, s[4:7], s3 offen sc1 lds
 s_waitcnt lgkmcnt(3)
 v_mfma_f32_32x32x16_bf16 v[64:79], a[88:91], v[56:59], v[64:79]
 ds_read_b128 v[40:43], v18 offset:24576
 s_waitcnt lgkmcnt(3)
 v_mfma_f32_32x32x16_bf16 v[64:79], a[92:95], v[60:63], v[64:79]
 ds_read_b128 v[44:47], v19 offset:24576
 s_waitcnt lgkmcnt(3)
 v_mfma_f32_32x32x16_bf16 v[64:79], a[96:99], v[32:35], v[64:79]
 ds_read_b128 v[48:51], v20 offset:24576
 s_add_u32 m0, s56, 32768
 s_add_u32 s3, s55, s68
 buffer_load_dwordx4 v1, s[4:7], s3 offen sc1 lds
 s_waitcnt lgkmcnt(3)
 v_mfma_f32_32x32x16_bf16 v[64:79], a[100:103], v[36:39], v[64:79]
 ds_read_b128 v[52:55], v21 offset:24576
 s_waitcnt lgkmcnt(3)
 v_mfma_f32_32x32x16_bf16 v[64:79], a[104:107], v[40:43], v[64:79]
 ds_read_b128 v[56:59], v22 offset:24576
 s_waitcnt lgkmcnt(3)
 v_mfma_f32_32x32x16_bf16 v[64:79], a[108:111], v[44:47], v[64:79]
 ds_read_b128 v[60:63], v23 offset:24576
 s_add_u32 m0, s56, 33792
 s_add_u32 s3, s55, s68
 buffer_load_dwordx4 v24, s[4:7], s3 offen sc1 lds
 s_waitcnt lgkmcnt(3)
 v_mfma_f32_32x32x16_bf16 v[64:79], a[112:115], v[48:51], v[64:79]
 ds_read_b128 v[32:35], v16 offset:32768
 s_waitcnt lgkmcnt(3)
 v_mfma_f32_32x32x16_bf16 v[64:79], a[116:119], v[52:55], v[64:79]
 ds_read_b128 v[36:39], v17 offset:32768
 s_waitcnt lgkmcnt(3)
 v_mfma_f32_32x32x16_bf16 v[64:79], a[120:123], v[56:59], v[64:79]
 ds_read_b128 v[40:43], v18 offset:32768
 s_waitcnt lgkmcnt(3)
 v_mfma_f32_32x32x16_bf16 v[64:79], a[124:127], v[60:63], v[64:79]
 ds_read_b128 v[44:47], v19 offset:32768
 s_waitcnt lgkmcnt(3)
 v_mfma_f32_32x32x16_bf16 v[64:79], a[128:131], v[32:35], v[64:79]
 ds_read_b128 v[48:51], v20 offset:32768
 s_waitcnt lgkmcnt(3)
 v_mfma_f32_32x32x16_bf16 v[64:79], a[132:135], v[36:39], v[64:79]
 ds_read_b128 v[52:55], v21 offset:32768
 s_waitcnt lgkmcnt(3)
 v_mfma_f32_32x32x16_bf16 v[64:79], a[136:139], v[40:43], v[64:79]
 ds_read_b128 v[56:59], v22 offset:32768
 s_waitcnt lgkmcnt(3)
 v_mfma_f32_32x32x16_bf16 v[64:79], a[140:143], v[44:47], v[64:79]
 ds_read_b128 v[60:63], v23 offset:32768
 s_waitcnt lgkmcnt(3)
 v_mfma_f32_32x32x16_bf16 v[64:79], a[144:147], v[48:51], v[64:79]
 s_waitcnt lgkmcnt(2)
 v_mfma_f32_32x32x16_bf16 v[64:79], a[148:151], v[52:55], v[64:79]
 s_waitcnt lgkmcnt(1)
 v_mfma_f32_32x32x16_bf16 v[64:79], a[152:155], v[56:59], v[64:79]
 s_waitcnt lgkmcnt(0)
 v_mfma_f32_32x32x16_bf16 v[64:79], a[156:159], v[60:63], v[64:79]
 s_lshl_b32 s3, s60, 19
 s_add_u32 s3, s3, s58
 s_xor_b32 s3, s3, s82
 s_nop 8
 v_cvt_pk_bf16_f32 v88, v64, v65
 v_cvt_pk_bf16_f32 v89, v66, v67
 v_cvt_pk_bf16_f32 v90, v72, v73
 v_cvt_pk_bf16_f32 v91, v74, v75
 buffer_store_dwordx4 v[88:91], v4, s[4:7], s3 offen offset:0 sc1
 v_cvt_pk_bf16_f32 v92, v68, v69
 v_cvt_pk_bf16_f32 v93, v70, v71
 v_cvt_pk_bf16_f32 v94, v76, v77
 v_cvt_pk_bf16_f32 v95, v78, v79
 buffer_store_dwordx4 v[92:95], v4, s[4:7], s3 offen offset:512 sc1
 s_mov_b32 s61, s54
 s_waitcnt vmcnt(2)
 s_cmp_lg_u32 s54, 4
 s_cbranch_scc1 L_cv_48
 s_waitcnt vmcnt(0)
 s_cmp_eq_u32 s61, 0
 s_cbranch_scc1 L_pf_49
 s_lshl_b32 s3, s61, 2
 s_add_u32 s3, s3, s59
 s_sub_u32 s3, s3, 4
 v_mov_b32 v3, 1
 s_mov_b64 exec, 1
 buffer_atomic_add v3, v5, s[4:7], s3 offen
 s_mov_b64 exec, -1
 s_mov_b32 s61, 0
L_pf_49:
 s_mul_i32 s71, s50, 13312
 s_add_u32 s71, s71, 81920
 s_mov_b32 s70, s75
 s_mov_b32 s69, 640
 s_getpc_b64 s[76:77]
L_ca_50:
 s_add_u32 s76, s76, L_conv0-L_ca_50
 s_addc_u32 s77, s77, -1
 s_swappc_b64 s[76:77], s[76:77]
 s_waitcnt vmcnt(0)
 s_barrier
 s_cmp_lg_u32 s50, 3
 s_cbranch_scc1 L_ar_51
 s_mov_b32 s96, s44
 s_and_b32 s97, s45, 0xffff
 s_mov_b32 s98, 256
 s_mov_b32 s99, 0x00020000
 v_mov_b32 v1, 1
 s_mov_b64 exec, 1
 buffer_atomic_add v1, off, s[96:99], 0 offset:8 sc0
 s_waitcnt vmcnt(0)
 v_cmp_eq_u32 vcc, 159, v1
 s_cbranch_vccz L_aw_52
 buffer_store_dword v1, off, s[96:99], 0 offset:136 sc1
L_aw_52:
 s_mov_b64 exec, -1
L_ar_51:
 s_cmp_lg_u32 s50, 0
 s_cbranch_scc1 L_ww_53
 s_mov_b32 s96, s44
 s_and_b32 s97, s45, 0xffff
 s_mov_b32 s98, 256
 s_mov_b32 s99, 0x00020000
 v_mov_b32 v24, 208
 s_mov_b32 s51, 0
 s_mov_b64 exec, 1
L_wb_54:
 buffer_load_dword v25, v24, s[96:99], 0 offen sc1
 s_waitcnt vmcnt(0)
 v_cmp_eq_u32 vcc, 0, v25
 s_cbranch_vccz L_wbd_55
 s_sleep 2
 s_add_u32 s51, s51, 1
 s_cmp_lt_u32 s51, 131072
 s_cbranch_scc1 L_wb_54
 s_branch L_bail
L_wbd_55:
 s_mov_b64 exec, -1
L_ww_53:
 s_barrier
 s_mov_b32 s70, s75
 s_mov_b32 s8, s38
 s_and_b32 s9, s39, 0xffff
 s_mov_b32 s10, 2621440
 s_mov_b32 s11, 0x00020000
 s_mov_b32 s12, s40
 s_and_b32 s13, s41, 0xffff
 s_mov_b32 s14, 1280
 s_mov_b32 s15, 0x00020000
 v_lshlrev_b32 v130, 4, v0
 s_lshl_b32 s73, s70, 12
 s_add_u32 s74, s73, 2
 buffer_load_dwordx4 v[96:99], v130, s[8:11], s73 offen offset:0
 buffer_load_dwordx4 v[100:103], v130, s[8:11], s73 offen offset:1024
 buffer_load_dwordx4 v[104:107], v130, s[8:11], s73 offen offset:2048
 buffer_load_dwordx4 v[108:111], v130, s[8:11], s73 offen offset:3072
 buffer_load_dwordx4 v[112:115], v130, s[8:11], s74 offen offset:0
 buffer_load_dwordx4 v[116:119], v130, s[8:11], s74 offen offset:1024
 buffer_load_dwordx4 v[120:123], v130, s[8:11], s74 offen offset:2048
 buffer_load_dwordx4 v[124:127], v130, s[8:11], s74 offen offset:3072
 s_lshl_b32 s3, s70, 1
 buffer_load_ushort v128, off, s[12:15], s3
 s_lshl_b32 s3, s70, 12
 s_add_u32 s3, s3, 198180864
 buffer_load_dwordx4 v[240:243], v130, s[4:7], s3 offen offset:0 sc1
 buffer_load_dwordx4 v[244:247], v130, s[4:7], s3 offen offset:1024 sc1
 buffer_load_dwordx4 v[248:251], v130, s[4:7], s3 offen offset:2048 sc1
 buffer_load_dwordx4 v[252:255], v130, s[4:7], s3 offen offset:3072 sc1
 v_lshrrev_b32 v1, 4, v0
 s_mov_b32 s3, 1280
 v_mul_lo_u32 v1, v1, s3
 v_and_b32 v3, 15, v0
 v_lshl_add_u32 v1, v3, 4, v1
 v_add_u32 v6, 5120, v1
 v_mov_b32 v24, v6
 v_and_b32 v2, 31, v0
 v_lshlrev_b32 v2, 8, v2
 v_lshrrev_b32 v4, 5, v0
 v_xor_b32 v4, v4, v3
 v_xor_b32 v8, 0, v4
 v_lshl_add_u32 v8, v8, 4, v2
 v_add_u32 v16, 40960, v8
 v_xor_b32 v9, 2, v4
 v_lshl_add_u32 v9, v9, 4, v2
 v_add_u32 v17, 40960, v9
 v_xor_b32 v10, 4, v4
 v_lshl_add_u32 v10, v10, 4, v2
 v_add_u32 v18, 40960, v10
 v_xor_b32 v11, 6, v4
 v_lshl_add_u32 v11, v11, 4, v2
 v_add_u32 v19, 40960, v11
 v_xor_b32 v12, 8, v4
 v_lshl_add_u32 v12, v12, 4, v2
 v_add_u32 v20, 40960, v12
 v_xor_b32 v13, 10, v4
 v_lshl_add_u32 v13, v13, 4, v2
 v_add_u32 v21, 40960, v13
 v_xor_b32 v14, 12, v4
 v_lshl_add_u32 v14, v14, 4, v2
 v_add_u32 v22, 40960, v14
 v_xor_b32 v15, 14, v4
 v_lshl_add_u32 v15, v15, 4, v2
 v_add_u32 v23, 40960, v15
 v_lshrrev_b32 v4, 5, v0
 v_lshlrev_b32 v4, 8, v4
 v_lshl_add_u32 v4, v3, 4, v4
 v_and_b32 v2, 16, v0
 v_lshl_add_u32 v4, v2, 8, v4
 s_lshl_b32 s3, s50, 10
 v_add_u32 v4, s3, v4
 v_mul_u32_u24 v5, 49152, v0
 v_mov_b32 v7, 163776
L_cv_48:
 s_cmp_lt_u32 s54, 8
 s_cbranch_scc1 L_qkvq_pre
 s_waitcnt vmcnt(0)
 s_cmp_eq_u32 s61, 0
 s_cbranch_scc1 L_pf_56
 s_lshl_b32 s3, s61, 2
 s_add_u32 s3, s3, s59
 s_sub_u32 s3, s3, 4
 v_mov_b32 v3, 1
 s_mov_b64 exec, 1
 buffer_atomic_add v3, v5, s[4:7], s3 offen
 s_mov_b64 exec, -1
 s_mov_b32 s61, 0
L_pf_56:
 s_mul_i32 s71, s50, 13312
 s_add_u32 s71, s71, 81920
 s_mov_b32 s70, s75
 s_mov_b32 s69, 640
 s_getpc_b64 s[76:77]
L_ca_57:
 s_add_u32 s76, s76, L_conv1-L_ca_57
 s_addc_u32 s77, s77, -1
 s_swappc_b64 s[76:77], s[76:77]
 s_waitcnt vmcnt(0)
 s_barrier
 s_cmp_lg_u32 s50, 3
 s_cbranch_scc1 L_ar_58
 s_mov_b32 s96, s44
 s_and_b32 s97, s45, 0xffff
 s_mov_b32 s98, 256
 s_mov_b32 s99, 0x00020000
 v_mov_b32 v1, 1
 s_mov_b64 exec, 1
 buffer_atomic_add v1, off, s[96:99], 0 offset:76 sc0
 s_waitcnt vmcnt(0)
 v_cmp_eq_u32 vcc, 127, v1
 s_cbranch_vccz L_aw_59
 buffer_store_dword v1, off, s[96:99], 0 offset:204 sc1
L_aw_59:
 s_mov_b64 exec, -1
L_ar_58:
 v_lshrrev_b32 v1, 4, v0
 s_mov_b32 s3, 1280
 v_mul_lo_u32 v1, v1, s3
 v_and_b32 v3, 15, v0
 v_lshl_add_u32 v1, v3, 4, v1
 v_add_u32 v6, 5120, v1
 v_mov_b32 v24, v6
 v_and_b32 v2, 31, v0
 v_lshlrev_b32 v2, 8, v2
 v_lshrrev_b32 v4, 5, v0
 v_xor_b32 v4, v4, v3
 v_xor_b32 v8, 0, v4
 v_lshl_add_u32 v8, v8, 4, v2
 v_add_u32 v16, 40960, v8
 v_xor_b32 v9, 2, v4
 v_lshl_add_u32 v9, v9, 4, v2
 v_add_u32 v17, 40960, v9
 v_xor_b32 v10, 4, v4
 v_lshl_add_u32 v10, v10, 4, v2
 v_add_u32 v18, 40960, v10
 v_xor_b32 v11, 6, v4
 v_lshl_add_u32 v11, v11, 4, v2
 v_add_u32 v19, 40960, v11
 v_xor_b32 v12, 8, v4
 v_lshl_add_u32 v12, v12, 4, v2
 v_add_u32 v20, 40960, v12
 v_xor_b32 v13, 10, v4
 v_lshl_add_u32 v13, v13, 4, v2
 v_add_u32 v21, 40960, v13
 v_xor_b32 v14, 12, v4
 v_lshl_add_u32 v14, v14, 4, v2
 v_add_u32 v22, 40960, v14
 v_xor_b32 v15, 14, v4
 v_lshl_add_u32 v15, v15, 4, v2
 v_add_u32 v23, 40960, v15
 v_lshrrev_b32 v4, 5, v0
 v_lshlrev_b32 v4, 8, v4
 v_lshl_add_u32 v4, v3, 4, v4
 v_and_b32 v2, 16, v0
 v_lshl_add_u32 v4, v2, 8, v4
 s_lshl_b32 s3, s50, 10
 v_add_u32 v4, s3, v4
 v_mul_u32_u24 v5, 49152, v0
 v_mov_b32 v7, 163776
 s_cmp_lg_u32 s50, 0
 s_cbranch_scc1 L_ww_60
 s_mov_b32 s96, s44
 s_and_b32 s97, s45, 0xffff
 s_mov_b32 s98, 256
 s_mov_b32 s99, 0x00020000
 v_mov_b32 v25, 200
 s_mov_b32 s51, 0
 s_mov_b64 exec, 1
L_wb_61:
 buffer_load_dword v26, v25, s[96:99], 0 offen sc1
 s_waitcnt vmcnt(0)
 v_cmp_eq_u32 vcc, 0, v26
 s_cbranch_vccz L_wbd_62
 s_sleep 2
 s_add_u32 s51, s51, 1
 s_cmp_lt_u32 s51, 131072
 s_cbranch_scc1 L_wb_61
 s_branch L_bail
L_wbd_62:
 s_mov_b64 exec, -1
L_ww_60:
 s_barrier
 s_mov_b32 s96, s44
 s_and_b32 s97, s45, 0xffff
 s_mov_b32 s98, 256
 s_mov_b32 s99, 0x00020000
 v_mov_b32 v25, 132
 s_mov_b32 s3, 144
 v_writelane_b32 v25, s3, 1
 s_mov_b32 s51, 0
 s_mov_b64 exec, 3
L_wb_63:
 buffer_load_dword v26, v25, s[96:99], 0 offen sc1
 s_waitcnt vmcnt(0)
 v_cmp_eq_u32 vcc, 0, v26
 s_cbranch_vccz L_wbd_64
 s_sleep 2
 s_add_u32 s51, s51, 1
 s_cmp_lt_u32 s51, 131072
 s_cbranch_scc1 L_wb_63
 s_branch L_bail
L_wbd_64:
 s_mov_b64 exec, -1
 v_readlane_b32 s81, v26, 1
 s_nop 3
 s_sub_u32 s81, s81, 1
 s_xor_b32 s78, s81, 0
 s_lshl_b32 s78, s78, 13
 s_xor_b32 s79, s78, 8192
 s_cmp_lt_u32 s62, 96
 s_cselect_b32 s3, s79, s78
 s_lshl_b32 s62, s62, 8
 s_lshr_b32 s100, s62, 13
 s_lshl_b32 s100, s100, 13
 s_add_u32 s62, s62, s100
 s_add_u32 s62, s62, s3
 s_add_u32 s62, s62, 229376
 s_add_u32 s63, s59, s78
 s_add_u32 s63, s63, 16352
L_qkvq_block:
 s_lshl_b32 s55, s54, 2
 s_add_u32 s55, s55, s62
 s_sub_u32 s55, s55, 32
 s_cmp_lg_u32 s50, 0
 s_cselect_b32 s3, 268435456, s55
 v_mov_b32 v6, 8
 s_mov_b64 exec, 15
 v_mov_b32 v6, 0
 buffer_atomic_add v6, v5, s[4:7], s3 offen sc0
 s_mov_b64 exec, -1
 s_waitcnt vmcnt(0)
 s_cmp_eq_u32 s61, 0
 s_cbranch_scc1 L_pf_67
 s_lshl_b32 s3, s61, 2
 s_add_u32 s3, s3, s59
 s_sub_u32 s3, s3, 4
 v_mov_b32 v3, 1
 s_mov_b64 exec, 1
 buffer_atomic_add v3, v5, s[4:7], s3 offen
 s_mov_b64 exec, -1
 s_mov_b32 s61, 0
L_pf_67:
 s_cmp_lg_u32 s50, 0
 s_cbranch_scc1 L_w_65
 v_cmp_gt_u32 vcc, 8, v6
 s_cbranch_vccz L_w_65
 s_mov_b32 s51, 0
 s_mov_b64 exec, 15
 v_mov_b32 v28, 0
 buffer_atomic_add v28, v5, s[4:7], s55 offen sc0
 s_sleep 5
L_wc_68:
 v_mov_b32 v29, 0
 buffer_atomic_add v29, v5, s[4:7], s55 offen sc0
 s_waitcnt vmcnt(1)
 v_cmp_gt_u32 vcc, 8, v28
 s_cbranch_vccz L_wcd_69
 v_mov_b32 v28, 0
 buffer_atomic_add v28, v5, s[4:7], s55 offen sc0
 s_waitcnt vmcnt(1)
 v_cmp_gt_u32 vcc, 8, v29
 s_cbranch_vccz L_wcd_69
 s_add_u32 s51, s51, 1
 s_cmp_lt_u32 s51, 131072
 s_cbranch_scc1 L_wc_68
 s_branch L_bail
L_wcd_69:
 s_mov_b64 exec, -1
L_w_65:
 s_barrier
L_qkvq_loop:
 s_cmp_lg_u32 s54, 17
 s_cbranch_scc1 L_c2_70
 s_cmp_lg_u32 s50, 0
 s_cbranch_scc1 L_ww_71
 s_mov_b32 s96, s44
 s_and_b32 s97, s45, 0xffff
 s_mov_b32 s98, 256
 s_mov_b32 s99, 0x00020000
 v_mov_b32 v25, 140
 s_mov_b32 s51, 0
 s_mov_b64 exec, 1
L_wb_72:
 buffer_load_dword v26, v25, s[96:99], 0 offen sc1
 s_waitcnt vmcnt(0)
 v_cmp_eq_u32 vcc, 0, v26
 s_cbranch_vccz L_wbd_73
 s_sleep 2
 s_add_u32 s51, s51, 1
 s_cmp_lt_u32 s51, 131072
 s_cbranch_scc1 L_wb_72
 s_branch L_bail
L_wbd_73:
 s_mov_b64 exec, -1
L_ww_71:
 s_barrier
L_c2_70:
 s_sub_u32 s60, s54, 8
 s_mul_i32 s55, s60, 40960
 s_mul_i32 s3, s50, 10240
 s_add_u32 s55, s55, s3
 s_add_u32 s55, s55, 195559424
 s_add_u32 m0, s56, 40960
 s_add_u32 s3, s55, s64
 buffer_load_dwordx4 v1, s[4:7], s3 offen sc1 lds
 s_add_u32 m0, s56, 41984
 s_add_u32 s3, s55, s64
 buffer_load_dwordx4 v24, s[4:7], s3 offen sc1 lds
 s_add_u32 m0, s56, 49152
 s_add_u32 s3, s55, s65
 buffer_load_dwordx4 v1, s[4:7], s3 offen sc1 lds
 s_add_u32 m0, s56, 50176
 s_add_u32 s3, s55, s65
 buffer_load_dwordx4 v24, s[4:7], s3 offen sc1 lds
 s_add_u32 m0, s56, 57344
 s_add_u32 s3, s55, s66
 buffer_load_dwordx4 v1, s[4:7], s3 offen sc1 lds
 s_add_u32 m0, s56, 58368
 s_add_u32 s3, s55, s66
 buffer_load_dwordx4 v24, s[4:7], s3 offen sc1 lds
 s_add_u32 m0, s56, 65536
 s_add_u32 s3, s55, s67
 buffer_load_dwordx4 v1, s[4:7], s3 offen sc1 lds
 s_add_u32 m0, s56, 66560
 s_add_u32 s3, s55, s67
 buffer_load_dwordx4 v24, s[4:7], s3 offen sc1 lds
 s_add_u32 m0, s56, 73728
 s_add_u32 s3, s55, s68
 buffer_load_dwordx4 v1, s[4:7], s3 offen sc1 lds
 s_add_u32 m0, s56, 74752
 s_add_u32 s3, s55, s68
 buffer_load_dwordx4 v24, s[4:7], s3 offen sc1 lds
 s_min_u32 s51, s54, 63
 s_mul_i32 s55, s51, 40960
 s_mul_i32 s3, s50, 10240
 s_add_u32 s55, s55, s3
 s_add_u32 s55, s55, 192937984
 s_waitcnt vmcnt(8)
 s_barrier
 ds_read_b128 v[32:35], v16 offset:0
 ds_read_b128 v[36:39], v17 offset:0
 ds_read_b128 v[40:43], v18 offset:0
 ds_read_b128 v[44:47], v19 offset:0
 s_waitcnt lgkmcnt(3)
 v_mfma_f32_32x32x16_bf16 v[64:79], a[0:3], v[32:35], 0
 ds_read_b128 v[48:51], v20 offset:0
 s_add_u32 m0, s56, 0
 s_add_u32 s3, s55, s64
 buffer_load_dwordx4 v1, s[4:7], s3 offen sc1 lds
 s_waitcnt lgkmcnt(3)
 v_mfma_f32_32x32x16_bf16 v[64:79], a[4:7], v[36:39], v[64:79]
 ds_read_b128 v[52:55], v21 offset:0
 s_waitcnt lgkmcnt(3)
 v_mfma_f32_32x32x16_bf16 v[64:79], a[8:11], v[40:43], v[64:79]
 ds_read_b128 v[56:59], v22 offset:0
 s_waitcnt lgkmcnt(3)
 v_mfma_f32_32x32x16_bf16 v[64:79], a[12:15], v[44:47], v[64:79]
 ds_read_b128 v[60:63], v23 offset:0
 s_add_u32 m0, s56, 1024
 s_add_u32 s3, s55, s64
 buffer_load_dwordx4 v24, s[4:7], s3 offen sc1 lds
 s_waitcnt lgkmcnt(3)
 v_mfma_f32_32x32x16_bf16 v[64:79], a[16:19], v[48:51], v[64:79]
 s_waitcnt vmcnt(8)
 s_barrier
 ds_read_b128 v[32:35], v16 offset:8192
 s_waitcnt lgkmcnt(3)
 v_mfma_f32_32x32x16_bf16 v[64:79], a[20:23], v[52:55], v[64:79]
 ds_read_b128 v[36:39], v17 offset:8192
 s_waitcnt lgkmcnt(3)
 v_mfma_f32_32x32x16_bf16 v[64:79], a[24:27], v[56:59], v[64:79]
 ds_read_b128 v[40:43], v18 offset:8192
 s_add_u32 m0, s56, 8192
 s_add_u32 s3, s55, s65
 buffer_load_dwordx4 v1, s[4:7], s3 offen sc1 lds
 s_waitcnt lgkmcnt(3)
 v_mfma_f32_32x32x16_bf16 v[64:79], a[28:31], v[60:63], v[64:79]
 ds_read_b128 v[44:47], v19 offset:8192
 s_waitcnt lgkmcnt(3)
 v_mfma_f32_32x32x16_bf16 v[64:79], a[32:35], v[32:35], v[64:79]
 ds_read_b128 v[48:51], v20 offset:8192
 s_waitcnt lgkmcnt(3)
 v_mfma_f32_32x32x16_bf16 v[64:79], a[36:39], v[36:39], v[64:79]
 ds_read_b128 v[52:55], v21 offset:8192
 s_add_u32 m0, s56, 9216
 s_add_u32 s3, s55, s65
 buffer_load_dwordx4 v24, s[4:7], s3 offen sc1 lds
 s_waitcnt lgkmcnt(3)
 v_mfma_f32_32x32x16_bf16 v[64:79], a[40:43], v[40:43], v[64:79]
 ds_read_b128 v[56:59], v22 offset:8192
 s_waitcnt lgkmcnt(3)
 v_mfma_f32_32x32x16_bf16 v[64:79], a[44:47], v[44:47], v[64:79]
 ds_read_b128 v[60:63], v23 offset:8192
 s_waitcnt lgkmcnt(3)
 v_mfma_f32_32x32x16_bf16 v[64:79], a[48:51], v[48:51], v[64:79]
 s_waitcnt vmcnt(8)
 s_barrier
 ds_read_b128 v[32:35], v16 offset:16384
 s_add_u32 m0, s56, 16384
 s_add_u32 s3, s55, s66
 buffer_load_dwordx4 v1, s[4:7], s3 offen sc1 lds
 s_waitcnt lgkmcnt(3)
 v_mfma_f32_32x32x16_bf16 v[64:79], a[52:55], v[52:55], v[64:79]
 ds_read_b128 v[36:39], v17 offset:16384
 s_waitcnt lgkmcnt(3)
 v_mfma_f32_32x32x16_bf16 v[64:79], a[56:59], v[56:59], v[64:79]
 ds_read_b128 v[40:43], v18 offset:16384
 s_waitcnt lgkmcnt(3)
 v_mfma_f32_32x32x16_bf16 v[64:79], a[60:63], v[60:63], v[64:79]
 ds_read_b128 v[44:47], v19 offset:16384
 s_add_u32 m0, s56, 17408
 s_add_u32 s3, s55, s66
 buffer_load_dwordx4 v24, s[4:7], s3 offen sc1 lds
 s_waitcnt lgkmcnt(3)
 v_mfma_f32_32x32x16_bf16 v[64:79], a[64:67], v[32:35], v[64:79]
 ds_read_b128 v[48:51], v20 offset:16384
 s_waitcnt lgkmcnt(3)
 v_mfma_f32_32x32x16_bf16 v[64:79], a[68:71], v[36:39], v[64:79]
 ds_read_b128 v[52:55], v21 offset:16384
 s_waitcnt lgkmcnt(3)
 v_mfma_f32_32x32x16_bf16 v[64:79], a[72:75], v[40:43], v[64:79]
 ds_read_b128 v[56:59], v22 offset:16384
 s_add_u32 m0, s56, 24576
 s_add_u32 s3, s55, s67
 buffer_load_dwordx4 v1, s[4:7], s3 offen sc1 lds
 s_waitcnt lgkmcnt(3)
 v_mfma_f32_32x32x16_bf16 v[64:79], a[76:79], v[44:47], v[64:79]
 ds_read_b128 v[60:63], v23 offset:16384
 s_waitcnt lgkmcnt(3)
 v_mfma_f32_32x32x16_bf16 v[64:79], a[80:83], v[48:51], v[64:79]
 s_waitcnt vmcnt(9)
 s_barrier
 ds_read_b128 v[32:35], v16 offset:24576
 s_waitcnt lgkmcnt(3)
 v_mfma_f32_32x32x16_bf16 v[64:79], a[84:87], v[52:55], v[64:79]
 ds_read_b128 v[36:39], v17 offset:24576
 s_add_u32 m0, s56, 25600
 s_add_u32 s3, s55, s67
 buffer_load_dwordx4 v24, s[4:7], s3 offen sc1 lds
 s_waitcnt lgkmcnt(3)
 v_mfma_f32_32x32x16_bf16 v[64:79], a[88:91], v[56:59], v[64:79]
 ds_read_b128 v[40:43], v18 offset:24576
 s_waitcnt lgkmcnt(3)
 v_mfma_f32_32x32x16_bf16 v[64:79], a[92:95], v[60:63], v[64:79]
 ds_read_b128 v[44:47], v19 offset:24576
 s_waitcnt lgkmcnt(3)
 v_mfma_f32_32x32x16_bf16 v[64:79], a[96:99], v[32:35], v[64:79]
 ds_read_b128 v[48:51], v20 offset:24576
 s_add_u32 m0, s56, 32768
 s_add_u32 s3, s55, s68
 buffer_load_dwordx4 v1, s[4:7], s3 offen sc1 lds
 s_waitcnt lgkmcnt(3)
 v_mfma_f32_32x32x16_bf16 v[64:79], a[100:103], v[36:39], v[64:79]
 ds_read_b128 v[52:55], v21 offset:24576
 s_waitcnt lgkmcnt(3)
 v_mfma_f32_32x32x16_bf16 v[64:79], a[104:107], v[40:43], v[64:79]
 ds_read_b128 v[56:59], v22 offset:24576
 s_waitcnt lgkmcnt(3)
 v_mfma_f32_32x32x16_bf16 v[64:79], a[108:111], v[44:47], v[64:79]
 ds_read_b128 v[60:63], v23 offset:24576
 s_add_u32 m0, s56, 33792
 s_add_u32 s3, s55, s68
 buffer_load_dwordx4 v24, s[4:7], s3 offen sc1 lds
 s_waitcnt lgkmcnt(3)
 v_mfma_f32_32x32x16_bf16 v[64:79], a[112:115], v[48:51], v[64:79]
 s_waitcnt vmcnt(10)
 s_barrier
 ds_read_b128 v[32:35], v16 offset:32768
 s_waitcnt lgkmcnt(3)
 v_mfma_f32_32x32x16_bf16 v[64:79], a[116:119], v[52:55], v[64:79]
 ds_read_b128 v[36:39], v17 offset:32768
 s_waitcnt lgkmcnt(3)
 v_mfma_f32_32x32x16_bf16 v[64:79], a[120:123], v[56:59], v[64:79]
 ds_read_b128 v[40:43], v18 offset:32768
 s_waitcnt lgkmcnt(3)
 v_mfma_f32_32x32x16_bf16 v[64:79], a[124:127], v[60:63], v[64:79]
 ds_read_b128 v[44:47], v19 offset:32768
 s_waitcnt lgkmcnt(3)
 v_mfma_f32_32x32x16_bf16 v[64:79], a[128:131], v[32:35], v[64:79]
 ds_read_b128 v[48:51], v20 offset:32768
 s_waitcnt lgkmcnt(3)
 v_mfma_f32_32x32x16_bf16 v[64:79], a[132:135], v[36:39], v[64:79]
 ds_read_b128 v[52:55], v21 offset:32768
 s_waitcnt lgkmcnt(3)
 v_mfma_f32_32x32x16_bf16 v[64:79], a[136:139], v[40:43], v[64:79]
 ds_read_b128 v[56:59], v22 offset:32768
 s_waitcnt lgkmcnt(3)
 v_mfma_f32_32x32x16_bf16 v[64:79], a[140:143], v[44:47], v[64:79]
 ds_read_b128 v[60:63], v23 offset:32768
 s_waitcnt lgkmcnt(3)
 v_mfma_f32_32x32x16_bf16 v[64:79], a[144:147], v[48:51], v[64:79]
 s_waitcnt lgkmcnt(2)
 v_mfma_f32_32x32x16_bf16 v[64:79], a[148:151], v[52:55], v[64:79]
 s_waitcnt lgkmcnt(1)
 v_mfma_f32_32x32x16_bf16 v[64:79], a[152:155], v[56:59], v[64:79]
 s_waitcnt lgkmcnt(0)
 v_mfma_f32_32x32x16_bf16 v[64:79], a[156:159], v[60:63], v[64:79]
 s_lshl_b32 s3, s60, 19
 s_add_u32 s3, s3, s58
 s_xor_b32 s3, s3, s82
 s_add_u32 s3, s3, 33554432
 s_nop 8
 v_cvt_pk_bf16_f32 v88, v64, v65
 v_cvt_pk_bf16_f32 v89, v66, v67
 v_cvt_pk_bf16_f32 v90, v72, v73
 v_cvt_pk_bf16_f32 v91, v74, v75
 buffer_store_dwordx4 v[88:91], v4, s[4:7], s3 offen offset:0 sc1
 v_cvt_pk_bf16_f32 v92, v68, v69
 v_cvt_pk_bf16_f32 v93, v70, v71
 v_cvt_pk_bf16_f32 v94, v76, v77
 v_cvt_pk_bf16_f32 v95, v78, v79
 buffer_store_dwordx4 v[92:95], v4, s[4:7], s3 offen offset:512 sc1
 s_cmp_ge_u32 s54, 64
 s_cbranch_scc1 L_n0_74
 s_waitcnt vmcnt(2)
 s_barrier
 s_lshl_b32 s55, s54, 2
 s_add_u32 s55, s55, s62
 s_sub_u32 s55, s55, 28
 s_cmp_lg_u32 s50, 0
 s_cselect_b32 s55, 268435456, s55
 v_mov_b32 v6, 8
 s_mov_b32 s60, s54
 ds_read_b128 v[32:35], v8 offset:0
 ds_read_b128 v[36:39], v9 offset:0
 ds_read_b128 v[40:43], v10 offset:0
 ds_read_b128 v[44:47], v11 offset:0
 s_waitcnt lgkmcnt(3)
 v_mfma_f32_32x32x16_bf16 v[64:79], a[0:3], v[32:35], 0
 ds_read_b128 v[48:51], v12 offset:0
 s_waitcnt lgkmcnt(3)
 v_mfma_f32_32x32x16_bf16 v[64:79], a[4:7], v[36:39], v[64:79]
 ds_read_b128 v[52:55], v13 offset:0
 s_waitcnt lgkmcnt(3)
 v_mfma_f32_32x32x16_bf16 v[64:79], a[8:11], v[40:43], v[64:79]
 ds_read_b128 v[56:59], v14 offset:0
 s_waitcnt lgkmcnt(3)
 v_mfma_f32_32x32x16_bf16 v[64:79], a[12:15], v[44:47], v[64:79]
 ds_read_b128 v[60:63], v15 offset:0
 s_waitcnt lgkmcnt(3)
 v_mfma_f32_32x32x16_bf16 v[64:79], a[16:19], v[48:51], v[64:79]
 ds_read_b128 v[32:35], v8 offset:8192
 s_waitcnt lgkmcnt(3)
 v_mfma_f32_32x32x16_bf16 v[64:79], a[20:23], v[52:55], v[64:79]
 ds_read_b128 v[36:39], v9 offset:8192
 s_waitcnt lgkmcnt(3)
 v_mfma_f32_32x32x16_bf16 v[64:79], a[24:27], v[56:59], v[64:79]
 ds_read_b128 v[40:43], v10 offset:8192
 s_waitcnt lgkmcnt(3)
 v_mfma_f32_32x32x16_bf16 v[64:79], a[28:31], v[60:63], v[64:79]
 ds_read_b128 v[44:47], v11 offset:8192
 s_waitcnt lgkmcnt(3)
 v_mfma_f32_32x32x16_bf16 v[64:79], a[32:35], v[32:35], v[64:79]
 ds_read_b128 v[48:51], v12 offset:8192
 s_waitcnt lgkmcnt(3)
 v_mfma_f32_32x32x16_bf16 v[64:79], a[36:39], v[36:39], v[64:79]
 ds_read_b128 v[52:55], v13 offset:8192
 s_waitcnt lgkmcnt(3)
 v_mfma_f32_32x32x16_bf16 v[64:79], a[40:43], v[40:43], v[64:79]
 ds_read_b128 v[56:59], v14 offset:8192
 s_waitcnt lgkmcnt(3)
 v_mfma_f32_32x32x16_bf16 v[64:79], a[44:47], v[44:47], v[64:79]
 ds_read_b128 v[60:63], v15 offset:8192
 s_waitcnt lgkmcnt(3)
 v_mfma_f32_32x32x16_bf16 v[64:79], a[48:51], v[48:51], v[64:79]
 ds_read_b128 v[32:35], v8 offset:16384
 s_waitcnt lgkmcnt(3)
 v_mfma_f32_32x32x16_bf16 v[64:79], a[52:55], v[52:55], v[64:79]
 ds_read_b128 v[36:39], v9 offset:16384
 s_waitcnt lgkmcnt(3)
 v_mfma_f32_32x32x16_bf16 v[64:79], a[56:59], v[56:59], v[64:79]
 ds_read_b128 v[40:43], v10 offset:16384
 s_waitcnt lgkmcnt(3)
 v_mfma_f32_32x32x16_bf16 v[64:79], a[60:63], v[60:63], v[64:79]
 ds_read_b128 v[44:47], v11 offset:16384
 s_waitcnt lgkmcnt(3)
 v_mfma_f32_32x32x16_bf16 v[64:79], a[64:67], v[32:35], v[64:79]
 ds_read_b128 v[48:51], v12 offset:16384
 s_waitcnt lgkmcnt(3)
 v_mfma_f32_32x32x16_bf16 v[64:79], a[68:71], v[36:39], v[64:79]
 ds_read_b128 v[52:55], v13 offset:16384
 s_waitcnt vmcnt(0)
 s_lshl_b32 s3, s54, 2
 s_add_u32 s3, s3, s63
 v_mov_b32 v3, 1
 s_mov_b64 exec, 1
 buffer_atomic_add v3, v5, s[4:7], s3 offen
 s_mov_b64 exec, -1
 s_cmp_eq_u32 s61, 0
 s_cbranch_scc1 L_pf_75
 s_lshl_b32 s3, s61, 2
 s_add_u32 s3, s3, s59
 s_sub_u32 s3, s3, 4
 v_mov_b32 v3, 1
 s_mov_b64 exec, 1
 buffer_atomic_add v3, v5, s[4:7], s3 offen
 s_mov_b64 exec, -1
 s_mov_b32 s61, 0
L_pf_75:
 s_waitcnt lgkmcnt(3)
 v_mfma_f32_32x32x16_bf16 v[64:79], a[72:75], v[40:43], v[64:79]
 ds_read_b128 v[56:59], v14 offset:16384
 s_waitcnt lgkmcnt(3)
 v_mfma_f32_32x32x16_bf16 v[64:79], a[76:79], v[44:47], v[64:79]
 ds_read_b128 v[60:63], v15 offset:16384
 s_waitcnt lgkmcnt(3)
 v_mfma_f32_32x32x16_bf16 v[64:79], a[80:83], v[48:51], v[64:79]
 ds_read_b128 v[32:35], v8 offset:24576
 s_waitcnt lgkmcnt(3)
 v_mfma_f32_32x32x16_bf16 v[64:79], a[84:87], v[52:55], v[64:79]
 ds_read_b128 v[36:39], v9 offset:24576
 s_waitcnt lgkmcnt(3)
 v_mfma_f32_32x32x16_bf16 v[64:79], a[88:91], v[56:59], v[64:79]
 ds_read_b128 v[40:43], v10 offset:24576
 s_waitcnt lgkmcnt(3)
 v_mfma_f32_32x32x16_bf16 v[64:79], a[92:95], v[60:63], v[64:79]
 ds_read_b128 v[44:47], v11 offset:24576
 s_waitcnt lgkmcnt(3)
 v_mfma_f32_32x32x16_bf16 v[64:79], a[96:99], v[32:35], v[64:79]
 ds_read_b128 v[48:51], v12 offset:24576
 s_waitcnt lgkmcnt(3)
 v_mfma_f32_32x32x16_bf16 v[64:79], a[100:103], v[36:39], v[64:79]
 ds_read_b128 v[52:55], v13 offset:24576
 s_mov_b64 exec, 15
 v_mov_b32 v6, 0
 buffer_atomic_add v6, v5, s[4:7], s55 offen sc0
 s_mov_b64 exec, -1
 s_waitcnt lgkmcnt(3)
 v_mfma_f32_32x32x16_bf16 v[64:79], a[104:107], v[40:43], v[64:79]
 ds_read_b128 v[56:59], v14 offset:24576
 s_waitcnt lgkmcnt(3)
 v_mfma_f32_32x32x16_bf16 v[64:79], a[108:111], v[44:47], v[64:79]
 ds_read_b128 v[60:63], v15 offset:24576
 s_waitcnt lgkmcnt(3)
 v_mfma_f32_32x32x16_bf16 v[64:79], a[112:115], v[48:51], v[64:79]
 ds_read_b128 v[32:35], v8 offset:32768
 s_waitcnt lgkmcnt(3)
 v_mfma_f32_32x32x16_bf16 v[64:79], a[116:119], v[52:55], v[64:79]
 ds_read_b128 v[36:39], v9 offset:32768
 s_waitcnt lgkmcnt(3)
 v_mfma_f32_32x32x16_bf16 v[64:79], a[120:123], v[56:59], v[64:79]
 ds_read_b128 v[40:43], v10 offset:32768
 s_waitcnt lgkmcnt(3)
 v_mfma_f32_32x32x16_bf16 v[64:79], a[124:127], v[60:63], v[64:79]
 ds_read_b128 v[44:47], v11 offset:32768
 s_waitcnt lgkmcnt(3)
 v_mfma_f32_32x32x16_bf16 v[64:79], a[128:131], v[32:35], v[64:79]
 ds_read_b128 v[48:51], v12 offset:32768
 s_waitcnt lgkmcnt(3)
 v_mfma_f32_32x32x16_bf16 v[64:79], a[132:135], v[36:39], v[64:79]
 ds_read_b128 v[52:55], v13 offset:32768
 s_waitcnt lgkmcnt(3)
 v_mfma_f32_32x32x16_bf16 v[64:79], a[136:139], v[40:43], v[64:79]
 ds_read_b128 v[56:59], v14 offset:32768
 s_waitcnt lgkmcnt(3)
 v_mfma_f32_32x32x16_bf16 v[64:79], a[140:143], v[44:47], v[64:79]
 ds_read_b128 v[60:63], v15 offset:32768
 s_waitcnt lgkmcnt(3)
 v_mfma_f32_32x32x16_bf16 v[64:79], a[144:147], v[48:51], v[64:79]
 s_waitcnt lgkmcnt(2)
 v_mfma_f32_32x32x16_bf16 v[64:79], a[148:151], v[52:55], v[64:79]
 s_waitcnt lgkmcnt(1)
 v_mfma_f32_32x32x16_bf16 v[64:79], a[152:155], v[56:59], v[64:79]
 s_waitcnt lgkmcnt(0)
 v_mfma_f32_32x32x16_bf16 v[64:79], a[156:159], v[60:63], v[64:79]
 s_lshl_b32 s3, s60, 19
 s_add_u32 s3, s3, s58
 s_xor_b32 s3, s3, s82
 s_nop 8
 v_cvt_pk_bf16_f32 v80, v64, v65
 v_cvt_pk_bf16_f32 v81, v66, v67
 v_cvt_pk_bf16_f32 v82, v72, v73
 v_cvt_pk_bf16_f32 v83, v74, v75
 buffer_store_dwordx4 v[80:83], v4, s[4:7], s3 offen offset:0 sc1
 v_cvt_pk_bf16_f32 v84, v68, v69
 v_cvt_pk_bf16_f32 v85, v70, v71
 v_cvt_pk_bf16_f32 v86, v76, v77
 v_cvt_pk_bf16_f32 v87, v78, v79
 buffer_store_dwordx4 v[84:87], v4, s[4:7], s3 offen offset:512 sc1
 s_add_u32 s54, s54, 1
 s_mov_b32 s61, s54
 s_cmp_lg_u32 s50, 0
 s_cbranch_scc1 L_w_76
 s_waitcnt vmcnt(2)
 v_cmp_gt_u32 vcc, 8, v6
 s_nop 1
 v_mov_b32 v3, vcc_lo
 ds_write_b32 v7, v3
 s_waitcnt lgkmcnt(0)
L_w_76:
 s_barrier
 ds_read_b32 v3, v7
 s_waitcnt lgkmcnt(0)
 v_readfirstlane_b32 s3, v3
 s_cmp_eq_u32 s3, 0
 s_cbranch_scc1 L_qkvq_loop
 s_branch L_qkvq_block
L_n0_74:
 s_waitcnt vmcnt(0)
 s_lshl_b32 s3, s54, 2
 s_add_u32 s3, s3, s63
 v_mov_b32 v3, 1
 s_mov_b64 exec, 1
 buffer_atomic_add v3, v5, s[4:7], s3 offen
 s_mov_b64 exec, -1
 s_add_u32 s54, s54, 1
 s_cmp_lt_u32 s54, 72
 s_cbranch_scc1 L_qkvq_block
 s_endpgm
L_qkvv:
 s_mul_i32 s57, s50, 40960
 s_mul_i32 s62, s52, 3
 s_add_u32 s62, s62, s53
 s_mul_i32 s3, s62, 13108
 s_lshr_b32 s3, s3, 16
 s_mul_i32 s3, s3, 5
 s_sub_u32 s55, s62, s3
 s_add_u32 s64, s55, 0
 s_sub_u32 s3, s64, 5
 s_cmp_ge_u32 s64, 5
 s_cselect_b32 s64, s3, s64
 s_add_u32 s65, s55, 1
 s_sub_u32 s3, s65, 5
 s_cmp_ge_u32 s65, 5
 s_cselect_b32 s65, s3, s65
 s_add_u32 s66, s55, 2
 s_sub_u32 s3, s66, 5
 s_cmp_ge_u32 s66, 5
 s_cselect_b32 s66, s3, s66
 s_add_u32 s67, s55, 3
 s_sub_u32 s3, s67, 5
 s_cmp_ge_u32 s67, 5
 s_cselect_b32 s67, s3, s67
 s_add_u32 s68, s55, 4
 s_sub_u32 s3, s68, 5
 s_cmp_ge_u32 s68, 5
 s_cselect_b32 s68, s3, s68
 s_lshl_b32 s55, s52, 8
 v_lshrrev_b32 v4, 4, v0
 s_mov_b32 s3, 8192
 v_mul_lo_u32 v4, v4, s3
 v_lshrrev_b32 v3, 3, v0
 v_and_b32 v3, 6, v3
 v_xor_b32 v3, v3, v0
 v_and_b32 v3, 15, v3
 v_lshl_add_u32 v4, v3, 4, v4
 v_xor_b32 v5, 128, v4
 s_lshl_b32 s57, s50, 13
 s_mul_i32 s3, s50, 262144
 s_add_u32 s55, s55, s3
 s_mul_i32 s51, s64, 1048576
 s_add_u32 s51, s51, s55
 s_add_u32 m0, s57, 0
 s_nop 0
 buffer_load_dwordx4 v4, s[8:11], s51 offen lds
 s_add_u32 s51, s51, 32768
 s_add_u32 m0, s57, 1024
 s_nop 0
 buffer_load_dwordx4 v5, s[8:11], s51 offen lds
 s_add_u32 s51, s51, 32768
 s_add_u32 m0, s57, 2048
 s_nop 0
 buffer_load_dwordx4 v4, s[8:11], s51 offen lds
 s_add_u32 s51, s51, 32768
 s_add_u32 m0, s57, 3072
 s_nop 0
 buffer_load_dwordx4 v5, s[8:11], s51 offen lds
 s_add_u32 s51, s51, 32768
 s_add_u32 m0, s57, 4096
 s_nop 0
 buffer_load_dwordx4 v4, s[8:11], s51 offen lds
 s_add_u32 s51, s51, 32768
 s_add_u32 m0, s57, 5120
 s_nop 0
 buffer_load_dwordx4 v5, s[8:11], s51 offen lds
 s_add_u32 s51, s51, 32768
 s_add_u32 m0, s57, 6144
 s_nop 0
 buffer_load_dwordx4 v4, s[8:11], s51 offen lds
 s_add_u32 s51, s51, 32768
 s_add_u32 m0, s57, 7168
 s_nop 0
 buffer_load_dwordx4 v5, s[8:11], s51 offen lds
 s_add_u32 s51, s51, 32768
 s_mul_i32 s51, s65, 1048576
 s_add_u32 s51, s51, s55
 s_add_u32 m0, s57, 32768
 s_nop 0
 buffer_load_dwordx4 v4, s[8:11], s51 offen lds
 s_add_u32 s51, s51, 32768
 s_add_u32 m0, s57, 33792
 s_nop 0
 buffer_load_dwordx4 v5, s[8:11], s51 offen lds
 s_add_u32 s51, s51, 32768
 s_add_u32 m0, s57, 34816
 s_nop 0
 buffer_load_dwordx4 v4, s[8:11], s51 offen lds
 s_add_u32 s51, s51, 32768
 s_add_u32 m0, s57, 35840
 s_nop 0
 buffer_load_dwordx4 v5, s[8:11], s51 offen lds
 s_add_u32 s51, s51, 32768
 s_add_u32 m0, s57, 36864
 s_nop 0
 buffer_load_dwordx4 v4, s[8:11], s51 offen lds
 s_add_u32 s51, s51, 32768
 s_add_u32 m0, s57, 37888
 s_nop 0
 buffer_load_dwordx4 v5, s[8:11], s51 offen lds
 s_add_u32 s51, s51, 32768
 s_add_u32 m0, s57, 38912
 s_nop 0
 buffer_load_dwordx4 v4, s[8:11], s51 offen lds
 s_add_u32 s51, s51, 32768
 s_add_u32 m0, s57, 39936
 s_nop 0
 buffer_load_dwordx4 v5, s[8:11], s51 offen lds
 s_add_u32 s51, s51, 32768
 s_mul_i32 s51, s66, 1048576
 s_add_u32 s51, s51, s55
 s_add_u32 m0, s57, 65536
 s_nop 0
 buffer_load_dwordx4 v4, s[8:11], s51 offen lds
 s_add_u32 s51, s51, 32768
 s_add_u32 m0, s57, 66560
 s_nop 0
 buffer_load_dwordx4 v5, s[8:11], s51 offen lds
 s_add_u32 s51, s51, 32768
 s_add_u32 m0, s57, 67584
 s_nop 0
 buffer_load_dwordx4 v4, s[8:11], s51 offen lds
 s_add_u32 s51, s51, 32768
 s_add_u32 m0, s57, 68608
 s_nop 0
 buffer_load_dwordx4 v5, s[8:11], s51 offen lds
 s_add_u32 s51, s51, 32768
 s_add_u32 m0, s57, 69632
 s_nop 0
 buffer_load_dwordx4 v4, s[8:11], s51 offen lds
 s_add_u32 s51, s51, 32768
 s_add_u32 m0, s57, 70656
 s_nop 0
 buffer_load_dwordx4 v5, s[8:11], s51 offen lds
 s_add_u32 s51, s51, 32768
 s_add_u32 m0, s57, 71680
 s_nop 0
 buffer_load_dwordx4 v4, s[8:11], s51 offen lds
 s_add_u32 s51, s51, 32768
 s_add_u32 m0, s57, 72704
 s_nop 0
 buffer_load_dwordx4 v5, s[8:11], s51 offen lds
 s_add_u32 s51, s51, 32768
 s_mul_i32 s51, s67, 1048576
 s_add_u32 s51, s51, s55
 s_add_u32 m0, s57, 98304
 s_nop 0
 buffer_load_dwordx4 v4, s[8:11], s51 offen lds
 s_add_u32 s51, s51, 32768
 s_add_u32 m0, s57, 99328
 s_nop 0
 buffer_load_dwordx4 v5, s[8:11], s51 offen lds
 s_add_u32 s51, s51, 32768
 s_add_u32 m0, s57, 100352
 s_nop 0
 buffer_load_dwordx4 v4, s[8:11], s51 offen lds
 s_add_u32 s51, s51, 32768
 s_add_u32 m0, s57, 101376
 s_nop 0
 buffer_load_dwordx4 v5, s[8:11], s51 offen lds
 s_add_u32 s51, s51, 32768
 s_add_u32 m0, s57, 102400
 s_nop 0
 buffer_load_dwordx4 v4, s[8:11], s51 offen lds
 s_add_u32 s51, s51, 32768
 s_add_u32 m0, s57, 103424
 s_nop 0
 buffer_load_dwordx4 v5, s[8:11], s51 offen lds
 s_add_u32 s51, s51, 32768
 s_add_u32 m0, s57, 104448
 s_nop 0
 buffer_load_dwordx4 v4, s[8:11], s51 offen lds
 s_add_u32 s51, s51, 32768
 s_add_u32 m0, s57, 105472
 s_nop 0
 buffer_load_dwordx4 v5, s[8:11], s51 offen lds
 s_add_u32 s51, s51, 32768
 s_mul_i32 s51, s68, 1048576
 s_add_u32 s51, s51, s55
 s_add_u32 m0, s57, 131072
 s_nop 0
 buffer_load_dwordx4 v4, s[8:11], s51 offen lds
 s_add_u32 s51, s51, 32768
 s_add_u32 m0, s57, 132096
 s_nop 0
 buffer_load_dwordx4 v5, s[8:11], s51 offen lds
 s_add_u32 s51, s51, 32768
 s_add_u32 m0, s57, 133120
 s_nop 0
 buffer_load_dwordx4 v4, s[8:11], s51 offen lds
 s_add_u32 s51, s51, 32768
 s_add_u32 m0, s57, 134144
 s_nop 0
 buffer_load_dwordx4 v5, s[8:11], s51 offen lds
 s_add_u32 s51, s51, 32768
 s_add_u32 m0, s57, 135168
 s_nop 0
 buffer_load_dwordx4 v4, s[8:11], s51 offen lds
 s_add_u32 s51, s51, 32768
 s_add_u32 m0, s57, 136192
 s_nop 0
 buffer_load_dwordx4 v5, s[8:11], s51 offen lds
 s_add_u32 s51, s51, 32768
 s_add_u32 m0, s57, 137216
 s_nop 0
 buffer_load_dwordx4 v4, s[8:11], s51 offen lds
 s_add_u32 s51, s51, 32768
 s_add_u32 m0, s57, 138240
 s_nop 0
 buffer_load_dwordx4 v5, s[8:11], s51 offen lds
 s_add_u32 s51, s51, 32768
 s_mov_b32 s96, s44
 s_and_b32 s97, s45, 0xffff
 s_mov_b32 s98, 256
 s_mov_b32 s99, 0x00020000
 buffer_load_dword v30, off, s[96:99], 0 offset:132 sc1
 v_lshrrev_b32 v2, 3, v0
 v_and_b32 v2, 4, v2
 v_bfe_u32 v3, v0, 2, 2
 v_or_b32 v2, v2, v3
 v_bfe_u32 v3, v0, 4, 1
 v_xor_b32 v3, v3, v2
 s_lshl_b32 s3, s50, 1
 v_xor_b32 v3, s3, v3
 v_lshlrev_b32 v2, 8, v2
 v_lshl_add_u32 v2, v3, 5, v2
 v_and_b32 v3, 3, v0
 v_lshl_add_u32 v2, v3, 3, v2
 s_waitcnt vmcnt(32)
 s_barrier
 ds_read_b64_tr_b16 a[0:1], v2 offset:0
 ds_read_b64_tr_b16 a[2:3], v2 offset:4096
 ds_read_b64_tr_b16 a[4:5], v2 offset:2048
 ds_read_b64_tr_b16 a[6:7], v2 offset:6144
 ds_read_b64_tr_b16 a[8:9], v2 offset:8192
 ds_read_b64_tr_b16 a[10:11], v2 offset:12288
 ds_read_b64_tr_b16 a[12:13], v2 offset:10240
 ds_read_b64_tr_b16 a[14:15], v2 offset:14336
 ds_read_b64_tr_b16 a[16:17], v2 offset:16384
 ds_read_b64_tr_b16 a[18:19], v2 offset:20480
 ds_read_b64_tr_b16 a[20:21], v2 offset:18432
 ds_read_b64_tr_b16 a[22:23], v2 offset:22528
 ds_read_b64_tr_b16 a[24:25], v2 offset:24576
 ds_read_b64_tr_b16 a[26:27], v2 offset:28672
 ds_read_b64_tr_b16 a[28:29], v2 offset:26624
 ds_read_b64_tr_b16 a[30:31], v2 offset:30720
 v_add_u32 v2, 0x8000, v2
 s_waitcnt vmcnt(24)
 s_barrier
 ds_read_b64_tr_b16 a[32:33], v2 offset:0
 ds_read_b64_tr_b16 a[34:35], v2 offset:4096
 ds_read_b64_tr_b16 a[36:37], v2 offset:2048
 ds_read_b64_tr_b16 a[38:39], v2 offset:6144
 ds_read_b64_tr_b16 a[40:41], v2 offset:8192
 ds_read_b64_tr_b16 a[42:43], v2 offset:12288
 ds_read_b64_tr_b16 a[44:45], v2 offset:10240
 ds_read_b64_tr_b16 a[46:47], v2 offset:14336
 ds_read_b64_tr_b16 a[48:49], v2 offset:16384
 ds_read_b64_tr_b16 a[50:51], v2 offset:20480
 ds_read_b64_tr_b16 a[52:53], v2 offset:18432
 ds_read_b64_tr_b16 a[54:55], v2 offset:22528
 ds_read_b64_tr_b16 a[56:57], v2 offset:24576
 ds_read_b64_tr_b16 a[58:59], v2 offset:28672
 ds_read_b64_tr_b16 a[60:61], v2 offset:26624
 ds_read_b64_tr_b16 a[62:63], v2 offset:30720
 v_add_u32 v2, 0x8000, v2
 s_waitcnt vmcnt(16)
 s_barrier
 ds_read_b64_tr_b16 a[64:65], v2 offset:0
 ds_read_b64_tr_b16 a[66:67], v2 offset:4096
 ds_read_b64_tr_b16 a[68:69], v2 offset:2048
 ds_read_b64_tr_b16 a[70:71], v2 offset:6144
 ds_read_b64_tr_b16 a[72:73], v2 offset:8192
 ds_read_b64_tr_b16 a[74:75], v2 offset:12288
 ds_read_b64_tr_b16 a[76:77], v2 offset:10240
 ds_read_b64_tr_b16 a[78:79], v2 offset:14336
 ds_read_b64_tr_b16 a[80:81], v2 offset:16384
 ds_read_b64_tr_b16 a[82:83], v2 offset:20480
 ds_read_b64_tr_b16 a[84:85], v2 offset:18432
 ds_read_b64_tr_b16 a[86:87], v2 offset:22528
 ds_read_b64_tr_b16 a[88:89], v2 offset:24576
 ds_read_b64_tr_b16 a[90:91], v2 offset:28672
 ds_read_b64_tr_b16 a[92:93], v2 offset:26624
 ds_read_b64_tr_b16 a[94:95], v2 offset:30720
 v_add_u32 v2, 0x8000, v2
 s_waitcnt vmcnt(8)
 s_barrier
 ds_read_b64_tr_b16 a[96:97], v2 offset:0
 ds_read_b64_tr_b16 a[98:99], v2 offset:4096
 ds_read_b64_tr_b16 a[100:101], v2 offset:2048
 ds_read_b64_tr_b16 a[102:103], v2 offset:6144
 ds_read_b64_tr_b16 a[104:105], v2 offset:8192
 ds_read_b64_tr_b16 a[106:107], v2 offset:12288
 ds_read_b64_tr_b16 a[108:109], v2 offset:10240
 ds_read_b64_tr_b16 a[110:111], v2 offset:14336
 ds_read_b64_tr_b16 a[112:113], v2 offset:16384
 ds_read_b64_tr_b16 a[114:115], v2 offset:20480
 ds_read_b64_tr_b16 a[116:117], v2 offset:18432
 ds_read_b64_tr_b16 a[118:119], v2 offset:22528
 ds_read_b64_tr_b16 a[120:121], v2 offset:24576
 ds_read_b64_tr_b16 a[122:123], v2 offset:28672
 ds_read_b64_tr_b16 a[124:125], v2 offset:26624
 ds_read_b64_tr_b16 a[126:127], v2 offset:30720
 v_add_u32 v2, 0x8000, v2
 s_waitcnt vmcnt(0)
 s_barrier
 ds_read_b64_tr_b16 a[128:129], v2 offset:0
 ds_read_b64_tr_b16 a[130:131], v2 offset:4096
 ds_read_b64_tr_b16 a[132:133], v2 offset:2048
 ds_read_b64_tr_b16 a[134:135], v2 offset:6144
 ds_read_b64_tr_b16 a[136:137], v2 offset:8192
 ds_read_b64_tr_b16 a[138:139], v2 offset:12288
 ds_read_b64_tr_b16 a[140:141], v2 offset:10240
 ds_read_b64_tr_b16 a[142:143], v2 offset:14336
 ds_read_b64_tr_b16 a[144:145], v2 offset:16384
 ds_read_b64_tr_b16 a[146:147], v2 offset:20480
 ds_read_b64_tr_b16 a[148:149], v2 offset:18432
 ds_read_b64_tr_b16 a[150:151], v2 offset:22528
 ds_read_b64_tr_b16 a[152:153], v2 offset:24576
 ds_read_b64_tr_b16 a[154:155], v2 offset:28672
 ds_read_b64_tr_b16 a[156:157], v2 offset:26624
 ds_read_b64_tr_b16 a[158:159], v2 offset:30720
 v_add_u32 v2, 0x8000, v2
 s_waitcnt lgkmcnt(0)
 s_barrier
 v_cmp_eq_u32 vcc, 0, v30
 s_cbranch_vccz L_qa_77
 s_mov_b32 s96, s44
 s_and_b32 s97, s45, 0xffff
 s_mov_b32 s98, 256
 s_mov_b32 s99, 0x00020000
 v_mov_b32 v1, 132
 s_mov_b32 s51, 0
 s_mov_b64 exec, 1
L_wb_78:
 buffer_load_dword v2, v1, s[96:99], 0 offen sc1
 s_waitcnt vmcnt(0)
 v_cmp_eq_u32 vcc, 0, v2
 s_cbranch_vccz L_wbd_79
 s_sleep 2
 s_add_u32 s51, s51, 1
 s_cmp_lt_u32 s51, 131072
 s_cbranch_scc1 L_wb_78
 s_branch L_bail
L_wbd_79:
 s_mov_b64 exec, -1
L_qa_77:
 s_lshl_b32 s64, s64, 8
 s_lshl_b32 s65, s65, 8
 s_lshl_b32 s66, s66, 8
 s_lshl_b32 s67, s67, 8
 s_lshl_b32 s68, s68, 8
 v_lshrrev_b32 v1, 4, v0
 s_mov_b32 s3, 1280
 v_mul_lo_u32 v1, v1, s3
 v_and_b32 v3, 15, v0
 v_lshl_add_u32 v1, v3, 4, v1
 v_add_u32 v6, 5120, v1
 v_mov_b32 v24, v6
 v_and_b32 v2, 31, v0
 v_lshlrev_b32 v2, 8, v2
 v_lshrrev_b32 v4, 5, v0
 v_xor_b32 v4, v4, v3
 v_xor_b32 v8, 0, v4
 v_lshl_add_u32 v8, v8, 4, v2
 v_add_u32 v16, 40960, v8
 v_xor_b32 v9, 2, v4
 v_lshl_add_u32 v9, v9, 4, v2
 v_add_u32 v17, 40960, v9
 v_xor_b32 v10, 4, v4
 v_lshl_add_u32 v10, v10, 4, v2
 v_add_u32 v18, 40960, v10
 v_xor_b32 v11, 6, v4
 v_lshl_add_u32 v11, v11, 4, v2
 v_add_u32 v19, 40960, v11
 v_xor_b32 v12, 8, v4
 v_lshl_add_u32 v12, v12, 4, v2
 v_add_u32 v20, 40960, v12
 v_xor_b32 v13, 10, v4
 v_lshl_add_u32 v13, v13, 4, v2
 v_add_u32 v21, 40960, v13
 v_xor_b32 v14, 12, v4
 v_lshl_add_u32 v14, v14, 4, v2
 v_add_u32 v22, 40960, v14
 v_xor_b32 v15, 14, v4
 v_lshl_add_u32 v15, v15, 4, v2
 v_add_u32 v23, 40960, v15
 v_lshrrev_b32 v4, 5, v0
 v_lshlrev_b32 v4, 8, v4
 v_lshl_add_u32 v4, v3, 4, v4
 v_and_b32 v2, 16, v0
 v_lshl_add_u32 v4, v2, 6, v4
 s_lshl_b32 s3, s50, 11
 v_add_u32 v4, s3, v4
 v_mul_u32_u24 v5, 49152, v0
 v_mov_b32 v7, 163776
 s_lshl_b32 s75, s62, 2
 s_add_u32 s75, s75, s50
 s_and_b32 s100, s52, 1
 s_lshl_b32 s100, s100, 13
 s_lshl_b32 s58, s52, 14
 s_add_u32 s58, s58, s100
 s_add_u32 s58, s58, 83886080
 s_cmp_eq_u32 s53, 0
 s_cselect_b32 s82, 8192, 0
 s_lshl_b32 s59, s52, 8
 s_add_u32 s59, s59, 16384
 s_lshl_b32 s56, s50, 11
 s_mov_b32 s54, 0
 s_mov_b32 s61, 0
 s_mov_b32 s70, s75
 s_mul_i32 s55, s54, 40960
 s_mul_i32 s3, s50, 10240
 s_add_u32 s55, s55, s3
 s_add_u32 s55, s55, 192937984
 s_add_u32 m0, s56, 0
 s_add_u32 s3, s55, s64
 buffer_load_dwordx4 v1, s[4:7], s3 offen sc1 lds
 s_add_u32 m0, s56, 1024
 s_add_u32 s3, s55, s64
 buffer_load_dwordx4 v24, s[4:7], s3 offen sc1 lds
 s_add_u32 m0, s56, 8192
 s_add_u32 s3, s55, s65
 buffer_load_dwordx4 v1, s[4:7], s3 offen sc1 lds
 s_add_u32 m0, s56, 9216
 s_add_u32 s3, s55, s65
 buffer_load_dwordx4 v24, s[4:7], s3 offen sc1 lds
 s_add_u32 m0, s56, 16384
 s_add_u32 s3, s55, s66
 buffer_load_dwordx4 v1, s[4:7], s3 offen sc1 lds
 s_add_u32 m0, s56, 17408
 s_add_u32 s3, s55, s66
 buffer_load_dwordx4 v24, s[4:7], s3 offen sc1 lds
 s_add_u32 m0, s56, 24576
 s_add_u32 s3, s55, s67
 buffer_load_dwordx4 v1, s[4:7], s3 offen sc1 lds
 s_add_u32 m0, s56, 25600
 s_add_u32 s3, s55, s67
 buffer_load_dwordx4 v24, s[4:7], s3 offen sc1 lds
 s_add_u32 m0, s56, 32768
 s_add_u32 s3, s55, s68
 buffer_load_dwordx4 v1, s[4:7], s3 offen sc1 lds
 s_add_u32 m0, s56, 33792
 s_add_u32 s3, s55, s68
 buffer_load_dwordx4 v24, s[4:7], s3 offen sc1 lds
 s_waitcnt vmcnt(0)
L_qkvv_pre:
 s_barrier
 s_mov_b32 s60, s54
 s_add_u32 s54, s54, 1
 s_mul_i32 s55, s54, 40960
 s_mul_i32 s3, s50, 10240
 s_add_u32 s55, s55, s3
 s_add_u32 s55, s55, 192937984
 ds_read_b128 v[32:35], v8 offset:0
 ds_read_b128 v[36:39], v9 offset:0
 ds_read_b128 v[40:43], v10 offset:0
 ds_read_b128 v[44:47], v11 offset:0
 s_waitcnt lgkmcnt(3)
 v_mfma_f32_32x32x16_bf16 v[64:79], v[32:35], a[0:3], 0
 ds_read_b128 v[48:51], v12 offset:0
 s_add_u32 m0, s56, 40960
 s_add_u32 s3, s55, s64
 buffer_load_dwordx4 v1, s[4:7], s3 offen sc1 lds
 s_waitcnt lgkmcnt(3)
 v_mfma_f32_32x32x16_bf16 v[64:79], v[36:39], a[4:7], v[64:79]
 ds_read_b128 v[52:55], v13 offset:0
 s_waitcnt lgkmcnt(3)
 v_mfma_f32_32x32x16_bf16 v[64:79], v[40:43], a[8:11], v[64:79]
 ds_read_b128 v[56:59], v14 offset:0
 s_waitcnt lgkmcnt(3)
 v_mfma_f32_32x32x16_bf16 v[64:79], v[44:47], a[12:15], v[64:79]
 ds_read_b128 v[60:63], v15 offset:0
 s_add_u32 m0, s56, 41984
 s_add_u32 s3, s55, s64
 buffer_load_dwordx4 v24, s[4:7], s3 offen sc1 lds
 s_waitcnt lgkmcnt(3)
 v_mfma_f32_32x32x16_bf16 v[64:79], v[48:51], a[16:19], v[64:79]
 ds_read_b128 v[32:35], v8 offset:8192
 s_waitcnt lgkmcnt(3)
 v_mfma_f32_32x32x16_bf16 v[64:79], v[52:55], a[20:23], v[64:79]
 ds_read_b128 v[36:39], v9 offset:8192
 s_waitcnt lgkmcnt(3)
 v_mfma_f32_32x32x16_bf16 v[64:79], v[56:59], a[24:27], v[64:79]
 ds_read_b128 v[40:43], v10 offset:8192
 s_add_u32 m0, s56, 49152
 s_add_u32 s3, s55, s65
 buffer_load_dwordx4 v1, s[4:7], s3 offen sc1 lds
 s_waitcnt lgkmcnt(3)
 v_mfma_f32_32x32x16_bf16 v[64:79], v[60:63], a[28:31], v[64:79]
 ds_read_b128 v[44:47], v11 offset:8192
 s_waitcnt lgkmcnt(3)
 v_mfma_f32_32x32x16_bf16 v[64:79], v[32:35], a[32:35], v[64:79]
 ds_read_b128 v[48:51], v12 offset:8192
 s_waitcnt lgkmcnt(3)
 v_mfma_f32_32x32x16_bf16 v[64:79], v[36:39], a[36:39], v[64:79]
 ds_read_b128 v[52:55], v13 offset:8192
 s_add_u32 m0, s56, 50176
 s_add_u32 s3, s55, s65
 buffer_load_dwordx4 v24, s[4:7], s3 offen sc1 lds
 s_waitcnt lgkmcnt(3)
 v_mfma_f32_32x32x16_bf16 v[64:79], v[40:43], a[40:43], v[64:79]
 ds_read_b128 v[56:59], v14 offset:8192
 s_waitcnt lgkmcnt(3)
 v_mfma_f32_32x32x16_bf16 v[64:79], v[44:47], a[44:47], v[64:79]
 ds_read_b128 v[60:63], v15 offset:8192
 s_waitcnt lgkmcnt(3)
 v_mfma_f32_32x32x16_bf16 v[64:79], v[48:51], a[48:51], v[64:79]
 ds_read_b128 v[32:35], v8 offset:16384
 s_add_u32 m0, s56, 57344
 s_add_u32 s3, s55, s66
 buffer_load_dwordx4 v1, s[4:7], s3 offen sc1 lds
 s_waitcnt lgkmcnt(3)
 v_mfma_f32_32x32x16_bf16 v[64:79], v[52:55], a[52:55], v[64:79]
 ds_read_b128 v[36:39], v9 offset:16384
 s_waitcnt lgkmcnt(3)
 v_mfma_f32_32x32x16_bf16 v[64:79], v[56:59], a[56:59], v[64:79]
 ds_read_b128 v[40:43], v10 offset:16384
 s_waitcnt lgkmcnt(3)
 v_mfma_f32_32x32x16_bf16 v[64:79], v[60:63], a[60:63], v[64:79]
 ds_read_b128 v[44:47], v11 offset:16384
 s_add_u32 m0, s56, 58368
 s_add_u32 s3, s55, s66
 buffer_load_dwordx4 v24, s[4:7], s3 offen sc1 lds
 s_waitcnt lgkmcnt(3)
 v_mfma_f32_32x32x16_bf16 v[64:79], v[32:35], a[64:67], v[64:79]
 ds_read_b128 v[48:51], v12 offset:16384
 s_waitcnt lgkmcnt(3)
 v_mfma_f32_32x32x16_bf16 v[64:79], v[36:39], a[68:71], v[64:79]
 ds_read_b128 v[52:55], v13 offset:16384
 s_waitcnt lgkmcnt(3)
 v_mfma_f32_32x32x16_bf16 v[64:79], v[40:43], a[72:75], v[64:79]
 ds_read_b128 v[56:59], v14 offset:16384
 s_add_u32 m0, s56, 65536
 s_add_u32 s3, s55, s67
 buffer_load_dwordx4 v1, s[4:7], s3 offen sc1 lds
 s_waitcnt lgkmcnt(3)
 v_mfma_f32_32x32x16_bf16 v[64:79], v[44:47], a[76:79], v[64:79]
 ds_read_b128 v[60:63], v15 offset:16384
 s_waitcnt vmcnt(7)
 s_cmp_eq_u32 s61, 0
 s_cbranch_scc1 L_pf_80
 s_lshl_b32 s3, s61, 2
 s_add_u32 s3, s3, s59
 s_sub_u32 s3, s3, 4
 v_mov_b32 v3, 1
 s_mov_b64 exec, 1
 buffer_atomic_add v3, v5, s[4:7], s3 offen
 s_mov_b64 exec, -1
 s_mov_b32 s61, 0
L_pf_80:
 s_waitcnt lgkmcnt(3)
 v_mfma_f32_32x32x16_bf16 v[64:79], v[48:51], a[80:83], v[64:79]
 ds_read_b128 v[32:35], v8 offset:24576
 s_waitcnt lgkmcnt(3)
 v_mfma_f32_32x32x16_bf16 v[64:79], v[52:55], a[84:87], v[64:79]
 ds_read_b128 v[36:39], v9 offset:24576
 s_add_u32 m0, s56, 66560
 s_add_u32 s3, s55, s67
 buffer_load_dwordx4 v24, s[4:7], s3 offen sc1 lds
 s_waitcnt lgkmcnt(3)
 v_mfma_f32_32x32x16_bf16 v[64:79], v[56:59], a[88:91], v[64:79]
 ds_read_b128 v[40:43], v10 offset:24576
 s_waitcnt lgkmcnt(3)
 v_mfma_f32_32x32x16_bf16 v[64:79], v[60:63], a[92:95], v[64:79]
 ds_read_b128 v[44:47], v11 offset:24576
 s_waitcnt lgkmcnt(3)
 v_mfma_f32_32x32x16_bf16 v[64:79], v[32:35], a[96:99], v[64:79]
 ds_read_b128 v[48:51], v12 offset:24576
 s_add_u32 m0, s56, 73728
 s_add_u32 s3, s55, s68
 buffer_load_dwordx4 v1, s[4:7], s3 offen sc1 lds
 s_waitcnt lgkmcnt(3)
 v_mfma_f32_32x32x16_bf16 v[64:79], v[36:39], a[100:103], v[64:79]
 ds_read_b128 v[52:55], v13 offset:24576
 s_waitcnt lgkmcnt(3)
 v_mfma_f32_32x32x16_bf16 v[64:79], v[40:43], a[104:107], v[64:79]
 ds_read_b128 v[56:59], v14 offset:24576
 s_waitcnt lgkmcnt(3)
 v_mfma_f32_32x32x16_bf16 v[64:79], v[44:47], a[108:111], v[64:79]
 ds_read_b128 v[60:63], v15 offset:24576
 s_add_u32 m0, s56, 74752
 s_add_u32 s3, s55, s68
 buffer_load_dwordx4 v24, s[4:7], s3 offen sc1 lds
 s_waitcnt lgkmcnt(3)
 v_mfma_f32_32x32x16_bf16 v[64:79], v[48:51], a[112:115], v[64:79]
 ds_read_b128 v[32:35], v8 offset:32768
 s_waitcnt lgkmcnt(3)
 v_mfma_f32_32x32x16_bf16 v[64:79], v[52:55], a[116:119], v[64:79]
 ds_read_b128 v[36:39], v9 offset:32768
 s_waitcnt lgkmcnt(3)
 v_mfma_f32_32x32x16_bf16 v[64:79], v[56:59], a[120:123], v[64:79]
 ds_read_b128 v[40:43], v10 offset:32768
 s_waitcnt lgkmcnt(3)
 v_mfma_f32_32x32x16_bf16 v[64:79], v[60:63], a[124:127], v[64:79]
 ds_read_b128 v[44:47], v11 offset:32768
 s_waitcnt lgkmcnt(3)
 v_mfma_f32_32x32x16_bf16 v[64:79], v[32:35], a[128:131], v[64:79]
 ds_read_b128 v[48:51], v12 offset:32768
 s_waitcnt lgkmcnt(3)
 v_mfma_f32_32x32x16_bf16 v[64:79], v[36:39], a[132:135], v[64:79]
 ds_read_b128 v[52:55], v13 offset:32768
 s_waitcnt lgkmcnt(3)
 v_mfma_f32_32x32x16_bf16 v[64:79], v[40:43], a[136:139], v[64:79]
 ds_read_b128 v[56:59], v14 offset:32768
 s_waitcnt lgkmcnt(3)
 v_mfma_f32_32x32x16_bf16 v[64:79], v[44:47], a[140:143], v[64:79]
 ds_read_b128 v[60:63], v15 offset:32768
 s_waitcnt lgkmcnt(3)
 v_mfma_f32_32x32x16_bf16 v[64:79], v[48:51], a[144:147], v[64:79]
 s_waitcnt lgkmcnt(2)
 v_mfma_f32_32x32x16_bf16 v[64:79], v[52:55], a[148:151], v[64:79]
 s_waitcnt lgkmcnt(1)
 v_mfma_f32_32x32x16_bf16 v[64:79], v[56:59], a[152:155], v[64:79]
 s_waitcnt lgkmcnt(0)
 v_mfma_f32_32x32x16_bf16 v[64:79], v[60:63], a[156:159], v[64:79]
 s_lshl_b32 s3, s60, 19
 s_add_u32 s3, s3, s58
 s_xor_b32 s3, s3, s82
 s_nop 8
 v_cvt_pk_bf16_f32 v80, v64, v65
 v_cvt_pk_bf16_f32 v81, v66, v67
 v_cvt_pk_bf16_f32 v82, v72, v73
 v_cvt_pk_bf16_f32 v83, v74, v75
 buffer_store_dwordx4 v[80:83], v4, s[4:7], s3 offen offset:0 sc1
 v_cvt_pk_bf16_f32 v84, v68, v69
 v_cvt_pk_bf16_f32 v85, v70, v71
 v_cvt_pk_bf16_f32 v86, v76, v77
 v_cvt_pk_bf16_f32 v87, v78, v79
 buffer_store_dwordx4 v[84:87], v4, s[4:7], s3 offen offset:512 sc1
 s_mov_b32 s61, s54
 s_cmp_lg_u32 s54, 1
 s_cbranch_scc1 L_f1_81
 s_waitcnt vmcnt(0)
 s_cmp_eq_u32 s61, 0
 s_cbranch_scc1 L_pf_82
 s_lshl_b32 s3, s61, 2
 s_add_u32 s3, s3, s59
 s_sub_u32 s3, s3, 4
 v_mov_b32 v3, 1
 s_mov_b64 exec, 1
 buffer_atomic_add v3, v5, s[4:7], s3 offen
 s_mov_b64 exec, -1
 s_mov_b32 s61, 0
L_pf_82:
 s_mov_b32 s8, s38
 s_and_b32 s9, s39, 0xffff
 s_mov_b32 s10, 2621440
 s_mov_b32 s11, 0x00020000
 s_mov_b32 s12, s40
 s_and_b32 s13, s41, 0xffff
 s_mov_b32 s14, 1280
 s_mov_b32 s15, 0x00020000
 v_lshlrev_b32 v130, 4, v0
 s_lshl_b32 s73, s70, 12
 s_add_u32 s74, s73, 2
 buffer_load_dwordx4 v[96:99], v130, s[8:11], s73 offen offset:0
 buffer_load_dwordx4 v[100:103], v130, s[8:11], s73 offen offset:1024
 buffer_load_dwordx4 v[112:115], v130, s[8:11], s74 offen offset:0
 buffer_load_dwordx4 v[116:119], v130, s[8:11], s74 offen offset:1024
 s_lshl_b32 s3, s70, 1
 buffer_load_ushort v128, off, s[12:15], s3
 s_branch L_f2_83
L_f1_81:
 s_waitcnt vmcnt(2)
L_f2_83:
 s_barrier
 s_mov_b32 s60, s54
 s_add_u32 s54, s54, 1
 s_mul_i32 s55, s54, 40960
 s_mul_i32 s3, s50, 10240
 s_add_u32 s55, s55, s3
 s_add_u32 s55, s55, 192937984
 ds_read_b128 v[32:35], v16 offset:0
 ds_read_b128 v[36:39], v17 offset:0
 ds_read_b128 v[40:43], v18 offset:0
 ds_read_b128 v[44:47], v19 offset:0
 s_waitcnt lgkmcnt(3)
 v_mfma_f32_32x32x16_bf16 v[64:79], v[32:35], a[0:3], 0
 ds_read_b128 v[48:51], v20 offset:0
 s_add_u32 m0, s56, 0
 s_add_u32 s3, s55, s64
 buffer_load_dwordx4 v1, s[4:7], s3 offen sc1 lds
 s_waitcnt lgkmcnt(3)
 v_mfma_f32_32x32x16_bf16 v[64:79], v[36:39], a[4:7], v[64:79]
 ds_read_b128 v[52:55], v21 offset:0
 s_waitcnt lgkmcnt(3)
 v_mfma_f32_32x32x16_bf16 v[64:79], v[40:43], a[8:11], v[64:79]
 ds_read_b128 v[56:59], v22 offset:0
 s_waitcnt lgkmcnt(3)
 v_mfma_f32_32x32x16_bf16 v[64:79], v[44:47], a[12:15], v[64:79]
 ds_read_b128 v[60:63], v23 offset:0
 s_add_u32 m0, s56, 1024
 s_add_u32 s3, s55, s64
 buffer_load_dwordx4 v24, s[4:7], s3 offen sc1 lds
 s_waitcnt lgkmcnt(3)
 v_mfma_f32_32x32x16_bf16 v[64:79], v[48:51], a[16:19], v[64:79]
 ds_read_b128 v[32:35], v16 offset:8192
 s_waitcnt lgkmcnt(3)
 v_mfma_f32_32x32x16_bf16 v[64:79], v[52:55], a[20:23], v[64:79]
 ds_read_b128 v[36:39], v17 offset:8192
 s_waitcnt lgkmcnt(3)
 v_mfma_f32_32x32x16_bf16 v[64:79], v[56:59], a[24:27], v[64:79]
 ds_read_b128 v[40:43], v18 offset:8192
 s_add_u32 m0, s56, 8192
 s_add_u32 s3, s55, s65
 buffer_load_dwordx4 v1, s[4:7], s3 offen sc1 lds
 s_waitcnt lgkmcnt(3)
 v_mfma_f32_32x32x16_bf16 v[64:79], v[60:63], a[28:31], v[64:79]
 ds_read_b128 v[44:47], v19 offset:8192
 s_waitcnt lgkmcnt(3)
 v_mfma_f32_32x32x16_bf16 v[64:79], v[32:35], a[32:35], v[64:79]
 ds_read_b128 v[48:51], v20 offset:8192
 s_waitcnt lgkmcnt(3)
 v_mfma_f32_32x32x16_bf16 v[64:79], v[36:39], a[36:39], v[64:79]
 ds_read_b128 v[52:55], v21 offset:8192
 s_add_u32 m0, s56, 9216
 s_add_u32 s3, s55, s65
 buffer_load_dwordx4 v24, s[4:7], s3 offen sc1 lds
 s_waitcnt lgkmcnt(3)
 v_mfma_f32_32x32x16_bf16 v[64:79], v[40:43], a[40:43], v[64:79]
 ds_read_b128 v[56:59], v22 offset:8192
 s_waitcnt lgkmcnt(3)
 v_mfma_f32_32x32x16_bf16 v[64:79], v[44:47], a[44:47], v[64:79]
 ds_read_b128 v[60:63], v23 offset:8192
 s_waitcnt lgkmcnt(3)
 v_mfma_f32_32x32x16_bf16 v[64:79], v[48:51], a[48:51], v[64:79]
 ds_read_b128 v[32:35], v16 offset:16384
 s_add_u32 m0, s56, 16384
 s_add_u32 s3, s55, s66
 buffer_load_dwordx4 v1, s[4:7], s3 offen sc1 lds
 s_waitcnt lgkmcnt(3)
 v_mfma_f32_32x32x16_bf16 v[64:79], v[52:55], a[52:55], v[64:79]
 ds_read_b128 v[36:39], v17 offset:16384
 s_waitcnt lgkmcnt(3)
 v_mfma_f32_32x32x16_bf16 v[64:79], v[56:59], a[56:59], v[64:79]
 ds_read_b128 v[40:43], v18 offset:16384
 s_waitcnt lgkmcnt(3)
 v_mfma_f32_32x32x16_bf16 v[64:79], v[60:63], a[60:63], v[64:79]
 ds_read_b128 v[44:47], v19 offset:16384
 s_add_u32 m0, s56, 17408
 s_add_u32 s3, s55, s66
 buffer_load_dwordx4 v24, s[4:7], s3 offen sc1 lds
 s_waitcnt lgkmcnt(3)
 v_mfma_f32_32x32x16_bf16 v[64:79], v[32:35], a[64:67], v[64:79]
 ds_read_b128 v[48:51], v20 offset:16384
 s_waitcnt lgkmcnt(3)
 v_mfma_f32_32x32x16_bf16 v[64:79], v[36:39], a[68:71], v[64:79]
 ds_read_b128 v[52:55], v21 offset:16384
 s_waitcnt lgkmcnt(3)
 v_mfma_f32_32x32x16_bf16 v[64:79], v[40:43], a[72:75], v[64:79]
 ds_read_b128 v[56:59], v22 offset:16384
 s_add_u32 m0, s56, 24576
 s_add_u32 s3, s55, s67
 buffer_load_dwordx4 v1, s[4:7], s3 offen sc1 lds
 s_waitcnt lgkmcnt(3)
 v_mfma_f32_32x32x16_bf16 v[64:79], v[44:47], a[76:79], v[64:79]
 ds_read_b128 v[60:63], v23 offset:16384
 s_waitcnt vmcnt(7)
 s_cmp_eq_u32 s61, 0
 s_cbranch_scc1 L_pf_84
 s_lshl_b32 s3, s61, 2
 s_add_u32 s3, s3, s59
 s_sub_u32 s3, s3, 4
 v_mov_b32 v3, 1
 s_mov_b64 exec, 1
 buffer_atomic_add v3, v5, s[4:7], s3 offen
 s_mov_b64 exec, -1
 s_mov_b32 s61, 0
L_pf_84:
 s_waitcnt lgkmcnt(3)
 v_mfma_f32_32x32x16_bf16 v[64:79], v[48:51], a[80:83], v[64:79]
 ds_read_b128 v[32:35], v16 offset:24576
 s_waitcnt lgkmcnt(3)
 v_mfma_f32_32x32x16_bf16 v[64:79], v[52:55], a[84:87], v[64:79]
 ds_read_b128 v[36:39], v17 offset:24576
 s_add_u32 m0, s56, 25600
 s_add_u32 s3, s55, s67
 buffer_load_dwordx4 v24, s[4:7], s3 offen sc1 lds
 s_waitcnt lgkmcnt(3)
 v_mfma_f32_32x32x16_bf16 v[64:79], v[56:59], a[88:91], v[64:79]
 ds_read_b128 v[40:43], v18 offset:24576
 s_waitcnt lgkmcnt(3)
 v_mfma_f32_32x32x16_bf16 v[64:79], v[60:63], a[92:95], v[64:79]
 ds_read_b128 v[44:47], v19 offset:24576
 s_waitcnt lgkmcnt(3)
 v_mfma_f32_32x32x16_bf16 v[64:79], v[32:35], a[96:99], v[64:79]
 ds_read_b128 v[48:51], v20 offset:24576
 s_add_u32 m0, s56, 32768
 s_add_u32 s3, s55, s68
 buffer_load_dwordx4 v1, s[4:7], s3 offen sc1 lds
 s_waitcnt lgkmcnt(3)
 v_mfma_f32_32x32x16_bf16 v[64:79], v[36:39], a[100:103], v[64:79]
 ds_read_b128 v[52:55], v21 offset:24576
 s_waitcnt lgkmcnt(3)
 v_mfma_f32_32x32x16_bf16 v[64:79], v[40:43], a[104:107], v[64:79]
 ds_read_b128 v[56:59], v22 offset:24576
 s_waitcnt lgkmcnt(3)
 v_mfma_f32_32x32x16_bf16 v[64:79], v[44:47], a[108:111], v[64:79]
 ds_read_b128 v[60:63], v23 offset:24576
 s_add_u32 m0, s56, 33792
 s_add_u32 s3, s55, s68
 buffer_load_dwordx4 v24, s[4:7], s3 offen sc1 lds
 s_waitcnt lgkmcnt(3)
 v_mfma_f32_32x32x16_bf16 v[64:79], v[48:51], a[112:115], v[64:79]
 ds_read_b128 v[32:35], v16 offset:32768
 s_waitcnt lgkmcnt(3)
 v_mfma_f32_32x32x16_bf16 v[64:79], v[52:55], a[116:119], v[64:79]
 ds_read_b128 v[36:39], v17 offset:32768
 s_waitcnt lgkmcnt(3)
 v_mfma_f32_32x32x16_bf16 v[64:79], v[56:59], a[120:123], v[64:79]
 ds_read_b128 v[40:43], v18 offset:32768
 s_waitcnt lgkmcnt(3)
 v_mfma_f32_32x32x16_bf16 v[64:79], v[60:63], a[124:127], v[64:79]
 ds_read_b128 v[44:47], v19 offset:32768
 s_waitcnt lgkmcnt(3)
 v_mfma_f32_32x32x16_bf16 v[64:79], v[32:35], a[128:131], v[64:79]
 ds_read_b128 v[48:51], v20 offset:32768
 s_waitcnt lgkmcnt(3)
 v_mfma_f32_32x32x16_bf16 v[64:79], v[36:39], a[132:135], v[64:79]
 ds_read_b128 v[52:55], v21 offset:32768
 s_waitcnt lgkmcnt(3)
 v_mfma_f32_32x32x16_bf16 v[64:79], v[40:43], a[136:139], v[64:79]
 ds_read_b128 v[56:59], v22 offset:32768
 s_waitcnt lgkmcnt(3)
 v_mfma_f32_32x32x16_bf16 v[64:79], v[44:47], a[140:143], v[64:79]
 ds_read_b128 v[60:63], v23 offset:32768
 s_waitcnt lgkmcnt(3)
 v_mfma_f32_32x32x16_bf16 v[64:79], v[48:51], a[144:147], v[64:79]
 s_waitcnt lgkmcnt(2)
 v_mfma_f32_32x32x16_bf16 v[64:79], v[52:55], a[148:151], v[64:79]
 s_waitcnt lgkmcnt(1)
 v_mfma_f32_32x32x16_bf16 v[64:79], v[56:59], a[152:155], v[64:79]
 s_waitcnt lgkmcnt(0)
 v_mfma_f32_32x32x16_bf16 v[64:79], v[60:63], a[156:159], v[64:79]
 s_lshl_b32 s3, s60, 19
 s_add_u32 s3, s3, s58
 s_xor_b32 s3, s3, s82
 s_nop 8
 v_cvt_pk_bf16_f32 v88, v64, v65
 v_cvt_pk_bf16_f32 v89, v66, v67
 v_cvt_pk_bf16_f32 v90, v72, v73
 v_cvt_pk_bf16_f32 v91, v74, v75
 buffer_store_dwordx4 v[88:91], v4, s[4:7], s3 offen offset:0 sc1
 v_cvt_pk_bf16_f32 v92, v68, v69
 v_cvt_pk_bf16_f32 v93, v70, v71
 v_cvt_pk_bf16_f32 v94, v76, v77
 v_cvt_pk_bf16_f32 v95, v78, v79
 buffer_store_dwordx4 v[92:95], v4, s[4:7], s3 offen offset:512 sc1
 s_mov_b32 s61, s54
 s_waitcnt vmcnt(2)
 s_cmp_lg_u32 s54, 4
 s_cbranch_scc1 L_cv_85
 s_waitcnt vmcnt(0)
 s_cmp_eq_u32 s61, 0
 s_cbranch_scc1 L_pf_86
 s_lshl_b32 s3, s61, 2
 s_add_u32 s3, s3, s59
 s_sub_u32 s3, s3, 4
 v_mov_b32 v3, 1
 s_mov_b64 exec, 1
 buffer_atomic_add v3, v5, s[4:7], s3 offen
 s_mov_b64 exec, -1
 s_mov_b32 s61, 0
L_pf_86:
 s_mul_i32 s71, s50, 13312
 s_add_u32 s71, s71, 81920
 s_mov_b32 s70, s75
 s_mov_b32 s69, 640
 s_getpc_b64 s[76:77]
L_ca_87:
 s_add_u32 s76, s76, L_conv0-L_ca_87
 s_addc_u32 s77, s77, -1
 s_swappc_b64 s[76:77], s[76:77]
 s_waitcnt vmcnt(0)
 s_barrier
 s_cmp_lg_u32 s50, 3
 s_cbranch_scc1 L_ar_88
 s_mov_b32 s96, s44
 s_and_b32 s97, s45, 0xffff
 s_mov_b32 s98, 256
 s_mov_b32 s99, 0x00020000
 v_mov_b32 v1, 1
 s_mov_b64 exec, 1
 buffer_atomic_add v1, off, s[96:99], 0 offset:8 sc0
 s_waitcnt vmcnt(0)
 v_cmp_eq_u32 vcc, 159, v1
 s_cbranch_vccz L_aw_89
 buffer_store_dword v1, off, s[96:99], 0 offset:136 sc1
L_aw_89:
 s_mov_b64 exec, -1
L_ar_88:
 s_cmp_lg_u32 s50, 0
 s_cbranch_scc1 L_ww_90
 s_mov_b32 s96, s44
 s_and_b32 s97, s45, 0xffff
 s_mov_b32 s98, 256
 s_mov_b32 s99, 0x00020000
 v_mov_b32 v24, 208
 s_mov_b32 s51, 0
 s_mov_b64 exec, 1
L_wb_91:
 buffer_load_dword v25, v24, s[96:99], 0 offen sc1
 s_waitcnt vmcnt(0)
 v_cmp_eq_u32 vcc, 0, v25
 s_cbranch_vccz L_wbd_92
 s_sleep 2
 s_add_u32 s51, s51, 1
 s_cmp_lt_u32 s51, 131072
 s_cbranch_scc1 L_wb_91
 s_branch L_bail
L_wbd_92:
 s_mov_b64 exec, -1
L_ww_90:
 s_barrier
 s_mov_b32 s70, s75
 s_mov_b32 s8, s38
 s_and_b32 s9, s39, 0xffff
 s_mov_b32 s10, 2621440
 s_mov_b32 s11, 0x00020000
 s_mov_b32 s12, s40
 s_and_b32 s13, s41, 0xffff
 s_mov_b32 s14, 1280
 s_mov_b32 s15, 0x00020000
 v_lshlrev_b32 v130, 4, v0
 s_lshl_b32 s73, s70, 12
 s_add_u32 s74, s73, 2
 buffer_load_dwordx4 v[96:99], v130, s[8:11], s73 offen offset:0
 buffer_load_dwordx4 v[100:103], v130, s[8:11], s73 offen offset:1024
 buffer_load_dwordx4 v[104:107], v130, s[8:11], s73 offen offset:2048
 buffer_load_dwordx4 v[108:111], v130, s[8:11], s73 offen offset:3072
 buffer_load_dwordx4 v[112:115], v130, s[8:11], s74 offen offset:0
 buffer_load_dwordx4 v[116:119], v130, s[8:11], s74 offen offset:1024
 buffer_load_dwordx4 v[120:123], v130, s[8:11], s74 offen offset:2048
 buffer_load_dwordx4 v[124:127], v130, s[8:11], s74 offen offset:3072
 s_lshl_b32 s3, s70, 1
 buffer_load_ushort v128, off, s[12:15], s3
 s_lshl_b32 s3, s70, 12
 s_add_u32 s3, s3, 198180864
 buffer_load_dwordx4 v[240:243], v130, s[4:7], s3 offen offset:0 sc1
 buffer_load_dwordx4 v[244:247], v130, s[4:7], s3 offen offset:1024 sc1
 buffer_load_dwordx4 v[248:251], v130, s[4:7], s3 offen offset:2048 sc1
 buffer_load_dwordx4 v[252:255], v130, s[4:7], s3 offen offset:3072 sc1
 v_lshrrev_b32 v1, 4, v0
 s_mov_b32 s3, 1280
 v_mul_lo_u32 v1, v1, s3
 v_and_b32 v3, 15, v0
 v_lshl_add_u32 v1, v3, 4, v1
 v_add_u32 v6, 5120, v1
 v_mov_b32 v24, v6
 v_and_b32 v2, 31, v0
 v_lshlrev_b32 v2, 8, v2
 v_lshrrev_b32 v4, 5, v0
 v_xor_b32 v4, v4, v3
 v_xor_b32 v8, 0, v4
 v_lshl_add_u32 v8, v8, 4, v2
 v_add_u32 v16, 40960, v8
 v_xor_b32 v9, 2, v4
 v_lshl_add_u32 v9, v9, 4, v2
 v_add_u32 v17, 40960, v9
 v_xor_b32 v10, 4, v4
 v_lshl_add_u32 v10, v10, 4, v2
 v_add_u32 v18, 40960, v10
 v_xor_b32 v11, 6, v4
 v_lshl_add_u32 v11, v11, 4, v2
 v_add_u32 v19, 40960, v11
 v_xor_b32 v12, 8, v4
 v_lshl_add_u32 v12, v12, 4, v2
 v_add_u32 v20, 40960, v12
 v_xor_b32 v13, 10, v4
 v_lshl_add_u32 v13, v13, 4, v2
 v_add_u32 v21, 40960, v13
 v_xor_b32 v14, 12, v4
 v_lshl_add_u32 v14, v14, 4, v2
 v_add_u32 v22, 40960, v14
 v_xor_b32 v15, 14, v4
 v_lshl_add_u32 v15, v15, 4, v2
 v_add_u32 v23, 40960, v15
 v_lshrrev_b32 v4, 5, v0
 v_lshlrev_b32 v4, 8, v4
 v_lshl_add_u32 v4, v3, 4, v4
 v_and_b32 v2, 16, v0
 v_lshl_add_u32 v4, v2, 6, v4
 s_lshl_b32 s3, s50, 11
 v_add_u32 v4, s3, v4
 v_mul_u32_u24 v5, 49152, v0
 v_mov_b32 v7, 163776
L_cv_85:
 s_cmp_lt_u32 s54, 8
 s_cbranch_scc1 L_qkvv_pre
 s_waitcnt vmcnt(0)
 s_cmp_eq_u32 s61, 0
 s_cbranch_scc1 L_pf_93
 s_lshl_b32 s3, s61, 2
 s_add_u32 s3, s3, s59
 s_sub_u32 s3, s3, 4
 v_mov_b32 v3, 1
 s_mov_b64 exec, 1
 buffer_atomic_add v3, v5, s[4:7], s3 offen
 s_mov_b64 exec, -1
 s_mov_b32 s61, 0
L_pf_93:
 s_mul_i32 s71, s50, 13312
 s_add_u32 s71, s71, 81920
 s_mov_b32 s70, s75
 s_mov_b32 s69, 640
 s_getpc_b64 s[76:77]
L_ca_94:
 s_add_u32 s76, s76, L_conv1-L_ca_94
 s_addc_u32 s77, s77, -1
 s_swappc_b64 s[76:77], s[76:77]
 s_waitcnt vmcnt(0)
 s_barrier
 s_cmp_lg_u32 s50, 3
 s_cbranch_scc1 L_ar_95
 s_mov_b32 s96, s44
 s_and_b32 s97, s45, 0xffff
 s_mov_b32 s98, 256
 s_mov_b32 s99, 0x00020000
 v_mov_b32 v1, 1
 s_mov_b64 exec, 1
 buffer_atomic_add v1, off, s[96:99], 0 offset:76 sc0
 s_waitcnt vmcnt(0)
 v_cmp_eq_u32 vcc, 127, v1
 s_cbranch_vccz L_aw_96
 buffer_store_dword v1, off, s[96:99], 0 offset:204 sc1
L_aw_96:
 s_mov_b64 exec, -1
L_ar_95:
 v_lshrrev_b32 v1, 4, v0
 s_mov_b32 s3, 1280
 v_mul_lo_u32 v1, v1, s3
 v_and_b32 v3, 15, v0
 v_lshl_add_u32 v1, v3, 4, v1
 v_add_u32 v6, 5120, v1
 v_mov_b32 v24, v6
 v_and_b32 v2, 31, v0
 v_lshlrev_b32 v2, 8, v2
 v_lshrrev_b32 v4, 5, v0
 v_xor_b32 v4, v4, v3
 v_xor_b32 v8, 0, v4
 v_lshl_add_u32 v8, v8, 4, v2
 v_add_u32 v16, 40960, v8
 v_xor_b32 v9, 2, v4
 v_lshl_add_u32 v9, v9, 4, v2
 v_add_u32 v17, 40960, v9
 v_xor_b32 v10, 4, v4
 v_lshl_add_u32 v10, v10, 4, v2
 v_add_u32 v18, 40960, v10
 v_xor_b32 v11, 6, v4
 v_lshl_add_u32 v11, v11, 4, v2
 v_add_u32 v19, 40960, v11
 v_xor_b32 v12, 8, v4
 v_lshl_add_u32 v12, v12, 4, v2
 v_add_u32 v20, 40960, v12
 v_xor_b32 v13, 10, v4
 v_lshl_add_u32 v13, v13, 4, v2
 v_add_u32 v21, 40960, v13
 v_xor_b32 v14, 12, v4
 v_lshl_add_u32 v14, v14, 4, v2
 v_add_u32 v22, 40960, v14
 v_xor_b32 v15, 14, v4
 v_lshl_add_u32 v15, v15, 4, v2
 v_add_u32 v23, 40960, v15
 v_lshrrev_b32 v4, 5, v0
 v_lshlrev_b32 v4, 8, v4
 v_lshl_add_u32 v4, v3, 4, v4
 v_and_b32 v2, 16, v0
 v_lshl_add_u32 v4, v2, 6, v4
 s_lshl_b32 s3, s50, 11
 v_add_u32 v4, s3, v4
 v_mul_u32_u24 v5, 49152, v0
 v_mov_b32 v7, 163776
 s_cmp_lg_u32 s50, 0
 s_cbranch_scc1 L_ww_97
 s_mov_b32 s96, s44
 s_and_b32 s97, s45, 0xffff
 s_mov_b32 s98, 256
 s_mov_b32 s99, 0x00020000
 v_mov_b32 v25, 200
 s_mov_b32 s51, 0
 s_mov_b64 exec, 1
L_wb_98:
 buffer_load_dword v26, v25, s[96:99], 0 offen sc1
 s_waitcnt vmcnt(0)
 v_cmp_eq_u32 vcc, 0, v26
 s_cbranch_vccz L_wbd_99
 s_sleep 2
 s_add_u32 s51, s51, 1
 s_cmp_lt_u32 s51, 131072
 s_cbranch_scc1 L_wb_98
 s_branch L_bail
L_wbd_99:
 s_mov_b64 exec, -1
L_ww_97:
 s_barrier
 s_mov_b32 s96, s44
 s_and_b32 s97, s45, 0xffff
 s_mov_b32 s98, 256
 s_mov_b32 s99, 0x00020000
 v_mov_b32 v25, 132
 s_mov_b32 s3, 144
 v_writelane_b32 v25, s3, 1
 s_mov_b32 s51, 0
 s_mov_b64 exec, 3
L_wb_100:
 buffer_load_dword v26, v25, s[96:99], 0 offen sc1
 s_waitcnt vmcnt(0)
 v_cmp_eq_u32 vcc, 0, v26
 s_cbranch_vccz L_wbd_101
 s_sleep 2
 s_add_u32 s51, s51, 1
 s_cmp_lt_u32 s51, 131072
 s_cbranch_scc1 L_wb_100
 s_branch L_bail
L_wbd_101:
 s_mov_b64 exec, -1
 v_readlane_b32 s81, v26, 1
 s_nop 3
 s_sub_u32 s81, s81, 1
 s_xor_b32 s78, s81, 0
 s_lshl_b32 s78, s78, 13
 s_xor_b32 s79, s78, 8192
 s_cmp_lt_u32 s62, 96
 s_cselect_b32 s3, s79, s78
 s_lshl_b32 s62, s62, 8
 s_lshr_b32 s100, s62, 13
 s_lshl_b32 s100, s100, 13
 s_add_u32 s62, s62, s100
 s_add_u32 s62, s62, s3
 s_add_u32 s62, s62, 229376
 s_add_u32 s63, s59, s78
 s_add_u32 s63, s63, 16352
L_qkvv_block:
 s_lshl_b32 s55, s54, 2
 s_add_u32 s55, s55, s62
 s_sub_u32 s55, s55, 32
 s_cmp_lg_u32 s50, 0
 s_cselect_b32 s3, 268435456, s55
 v_mov_b32 v6, 8
 s_mov_b64 exec, 15
 v_mov_b32 v6, 0
 buffer_atomic_add v6, v5, s[4:7], s3 offen sc0
 s_mov_b64 exec, -1
 s_waitcnt vmcnt(0)
 s_cmp_eq_u32 s61, 0
 s_cbranch_scc1 L_pf_104
 s_lshl_b32 s3, s61, 2
 s_add_u32 s3, s3, s59
 s_sub_u32 s3, s3, 4
 v_mov_b32 v3, 1
 s_mov_b64 exec, 1
 buffer_atomic_add v3, v5, s[4:7], s3 offen
 s_mov_b64 exec, -1
 s_mov_b32 s61, 0
L_pf_104:
 s_cmp_lg_u32 s50, 0
 s_cbranch_scc1 L_w_102
 v_cmp_gt_u32 vcc, 8, v6
 s_cbranch_vccz L_w_102
 s_mov_b32 s51, 0
 s_mov_b64 exec, 15
 v_mov_b32 v28, 0
 buffer_atomic_add v28, v5, s[4:7], s55 offen sc0
 s_sleep 5
L_wc_105:
 v_mov_b32 v29, 0
 buffer_atomic_add v29, v5, s[4:7], s55 offen sc0
 s_waitcnt vmcnt(1)
 v_cmp_gt_u32 vcc, 8, v28
 s_cbranch_vccz L_wcd_106
 v_mov_b32 v28, 0
 buffer_atomic_add v28, v5, s[4:7], s55 offen sc0
 s_waitcnt vmcnt(1)
 v_cmp_gt_u32 vcc, 8, v29
 s_cbranch_vccz L_wcd_106
 s_add_u32 s51, s51, 1
 s_cmp_lt_u32 s51, 131072
 s_cbranch_scc1 L_wc_105
 s_branch L_bail
L_wcd_106:
 s_mov_b64 exec, -1
L_w_102:
 s_barrier
L_qkvv_loop:
 s_cmp_lg_u32 s54, 17
 s_cbranch_scc1 L_c2_107
 s_cmp_lg_u32 s50, 0
 s_cbranch_scc1 L_ww_108
 s_mov_b32 s96, s44
 s_and_b32 s97, s45, 0xffff
 s_mov_b32 s98, 256
 s_mov_b32 s99, 0x00020000
 v_mov_b32 v25, 140
 s_mov_b32 s51, 0
 s_mov_b64 exec, 1
L_wb_109:
 buffer_load_dword v26, v25, s[96:99], 0 offen sc1
 s_waitcnt vmcnt(0)
 v_cmp_eq_u32 vcc, 0, v26
 s_cbranch_vccz L_wbd_110
 s_sleep 2
 s_add_u32 s51, s51, 1
 s_cmp_lt_u32 s51, 131072
 s_cbranch_scc1 L_wb_109
 s_branch L_bail
L_wbd_110:
 s_mov_b64 exec, -1
L_ww_108:
 s_barrier
L_c2_107:
 s_sub_u32 s60, s54, 8
 s_mul_i32 s55, s60, 40960
 s_mul_i32 s3, s50, 10240
 s_add_u32 s55, s55, s3
 s_add_u32 s55, s55, 195559424
 s_add_u32 m0, s56, 40960
 s_add_u32 s3, s55, s64
 buffer_load_dwordx4 v1, s[4:7], s3 offen sc1 lds
 s_add_u32 m0, s56, 41984
 s_add_u32 s3, s55, s64
 buffer_load_dwordx4 v24, s[4:7], s3 offen sc1 lds
 s_add_u32 m0, s56, 49152
 s_add_u32 s3, s55, s65
 buffer_load_dwordx4 v1, s[4:7], s3 offen sc1 lds
 s_add_u32 m0, s56, 50176
 s_add_u32 s3, s55, s65
 buffer_load_dwordx4 v24, s[4:7], s3 offen sc1 lds
 s_add_u32 m0, s56, 57344
 s_add_u32 s3, s55, s66
 buffer_load_dwordx4 v1, s[4:7], s3 offen sc1 lds
 s_add_u32 m0, s56, 58368
 s_add_u32 s3, s55, s66
 buffer_load_dwordx4 v24, s[4:7], s3 offen sc1 lds
 s_add_u32 m0, s56, 65536
 s_add_u32 s3, s55, s67
 buffer_load_dwordx4 v1, s[4:7], s3 offen sc1 lds
 s_add_u32 m0, s56, 66560
 s_add_u32 s3, s55, s67
 buffer_load_dwordx4 v24, s[4:7], s3 offen sc1 lds
 s_add_u32 m0, s56, 73728
 s_add_u32 s3, s55, s68
 buffer_load_dwordx4 v1, s[4:7], s3 offen sc1 lds
 s_add_u32 m0, s56, 74752
 s_add_u32 s3, s55, s68
 buffer_load_dwordx4 v24, s[4:7], s3 offen sc1 lds
 s_min_u32 s51, s54, 63
 s_mul_i32 s55, s51, 40960
 s_mul_i32 s3, s50, 10240
 s_add_u32 s55, s55, s3
 s_add_u32 s55, s55, 192937984
 s_waitcnt vmcnt(8)
 s_barrier
 ds_read_b128 v[32:35], v16 offset:0
 ds_read_b128 v[36:39], v17 offset:0
 ds_read_b128 v[40:43], v18 offset:0
 ds_read_b128 v[44:47], v19 offset:0
 s_waitcnt lgkmcnt(3)
 v_mfma_f32_32x32x16_bf16 v[64:79], v[32:35], a[0:3], 0
 ds_read_b128 v[48:51], v20 offset:0
 s_add_u32 m0, s56, 0
 s_add_u32 s3, s55, s64
 buffer_load_dwordx4 v1, s[4:7], s3 offen sc1 lds
 s_waitcnt lgkmcnt(3)
 v_mfma_f32_32x32x16_bf16 v[64:79], v[36:39], a[4:7], v[64:79]
 ds_read_b128 v[52:55], v21 offset:0
 s_waitcnt lgkmcnt(3)
 v_mfma_f32_32x32x16_bf16 v[64:79], v[40:43], a[8:11], v[64:79]
 ds_read_b128 v[56:59], v22 offset:0
 s_waitcnt lgkmcnt(3)
 v_mfma_f32_32x32x16_bf16 v[64:79], v[44:47], a[12:15], v[64:79]
 ds_read_b128 v[60:63], v23 offset:0
 s_add_u32 m0, s56, 1024
 s_add_u32 s3, s55, s64
 buffer_load_dwordx4 v24, s[4:7], s3 offen sc1 lds
 s_waitcnt lgkmcnt(3)
 v_mfma_f32_32x32x16_bf16 v[64:79], v[48:51], a[16:19], v[64:79]
 s_waitcnt vmcnt(8)
 s_barrier
 ds_read_b128 v[32:35], v16 offset:8192
 s_waitcnt lgkmcnt(3)
 v_mfma_f32_32x32x16_bf16 v[64:79], v[52:55], a[20:23], v[64:79]
 ds_read_b128 v[36:39], v17 offset:8192
 s_waitcnt lgkmcnt(3)
 v_mfma_f32_32x32x16_bf16 v[64:79], v[56:59], a[24:27], v[64:79]
 ds_read_b128 v[40:43], v18 offset:8192
 s_add_u32 m0, s56, 8192
 s_add_u32 s3, s55, s65
 buffer_load_dwordx4 v1, s[4:7], s3 offen sc1 lds
 s_waitcnt lgkmcnt(3)
 v_mfma_f32_32x32x16_bf16 v[64:79], v[60:63], a[28:31], v[64:79]
 ds_read_b128 v[44:47], v19 offset:8192
 s_waitcnt lgkmcnt(3)
 v_mfma_f32_32x32x16_bf16 v[64:79], v[32:35], a[32:35], v[64:79]
 ds_read_b128 v[48:51], v20 offset:8192
 s_waitcnt lgkmcnt(3)
 v_mfma_f32_32x32x16_bf16 v[64:79], v[36:39], a[36:39], v[64:79]
 ds_read_b128 v[52:55], v21 offset:8192
 s_add_u32 m0, s56, 9216
 s_add_u32 s3, s55, s65
 buffer_load_dwordx4 v24, s[4:7], s3 offen sc1 lds
 s_waitcnt lgkmcnt(3)
 v_mfma_f32_32x32x16_bf16 v[64:79], v[40:43], a[40:43], v[64:79]
 ds_read_b128 v[56:59], v22 offset:8192
 s_waitcnt lgkmcnt(3)
 v_mfma_f32_32x32x16_bf16 v[64:79], v[44:47], a[44:47], v[64:79]
 ds_read_b128 v[60:63], v23 offset:8192
 s_waitcnt lgkmcnt(3)
 v_mfma_f32_32x32x16_bf16 v[64:79], v[48:51], a[48:51], v[64:79]
 s_waitcnt vmcnt(8)
 s_barrier
 ds_read_b128 v[32:35], v16 offset:16384
 s_add_u32 m0, s56, 16384
 s_add_u32 s3, s55, s66
 buffer_load_dwordx4 v1, s[4:7], s3 offen sc1 lds
 s_waitcnt lgkmcnt(3)
 v_mfma_f32_32x32x16_bf16 v[64:79], v[52:55], a[52:55], v[64:79]
 ds_read_b128 v[36:39], v17 offset:16384
 s_waitcnt lgkmcnt(3)
 v_mfma_f32_32x32x16_bf16 v[64:79], v[56:59], a[56:59], v[64:79]
 ds_read_b128 v[40:43], v18 offset:16384
 s_waitcnt lgkmcnt(3)
 v_mfma_f32_32x32x16_bf16 v[64:79], v[60:63], a[60:63], v[64:79]
 ds_read_b128 v[44:47], v19 offset:16384
 s_add_u32 m0, s56, 17408
 s_add_u32 s3, s55, s66
 buffer_load_dwordx4 v24, s[4:7], s3 offen sc1 lds
 s_waitcnt lgkmcnt(3)
 v_mfma_f32_32x32x16_bf16 v[64:79], v[32:35], a[64:67], v[64:79]
 ds_read_b128 v[48:51], v20 offset:16384
 s_waitcnt lgkmcnt(3)
 v_mfma_f32_32x32x16_bf16 v[64:79], v[36:39], a[68:71], v[64:79]
 ds_read_b128 v[52:55], v21 offset:16384
 s_waitcnt lgkmcnt(3)
 v_mfma_f32_32x32x16_bf16 v[64:79], v[40:43], a[72:75], v[64:79]
 ds_read_b128 v[56:59], v22 offset:16384
 s_add_u32 m0, s56, 24576
 s_add_u32 s3, s55, s67
 buffer_load_dwordx4 v1, s[4:7], s3 offen sc1 lds
 s_waitcnt lgkmcnt(3)
 v_mfma_f32_32x32x16_bf16 v[64:79], v[44:47], a[76:79], v[64:79]
 ds_read_b128 v[60:63], v23 offset:16384
 s_waitcnt lgkmcnt(3)
 v_mfma_f32_32x32x16_bf16 v[64:79], v[48:51], a[80:83], v[64:79]
 s_waitcnt vmcnt(9)
 s_barrier
 ds_read_b128 v[32:35], v16 offset:24576
 s_waitcnt lgkmcnt(3)
 v_mfma_f32_32x32x16_bf16 v[64:79], v[52:55], a[84:87], v[64:79]
 ds_read_b128 v[36:39], v17 offset:24576
 s_add_u32 m0, s56, 25600
 s_add_u32 s3, s55, s67
 buffer_load_dwordx4 v24, s[4:7], s3 offen sc1 lds
 s_waitcnt lgkmcnt(3)
 v_mfma_f32_32x32x16_bf16 v[64:79], v[56:59], a[88:91], v[64:79]
 ds_read_b128 v[40:43], v18 offset:24576
 s_waitcnt lgkmcnt(3)
 v_mfma_f32_32x32x16_bf16 v[64:79], v[60:63], a[92:95], v[64:79]
 ds_read_b128 v[44:47], v19 offset:24576
 s_waitcnt lgkmcnt(3)
 v_mfma_f32_32x32x16_bf16 v[64:79], v[32:35], a[96:99], v[64:79]
 ds_read_b128 v[48:51], v20 offset:24576
 s_add_u32 m0, s56, 32768
 s_add_u32 s3, s55, s68
 buffer_load_dwordx4 v1, s[4:7], s3 offen sc1 lds
 s_waitcnt lgkmcnt(3)
 v_mfma_f32_32x32x16_bf16 v[64:79], v[36:39], a[100:103], v[64:79]
 ds_read_b128 v[52:55], v21 offset:24576
 s_waitcnt lgkmcnt(3)
 v_mfma_f32_32x32x16_bf16 v[64:79], v[40:43], a[104:107], v[64:79]
 ds_read_b128 v[56:59], v22 offset:24576
 s_waitcnt lgkmcnt(3)
 v_mfma_f32_32x32x16_bf16 v[64:79], v[44:47], a[108:111], v[64:79]
 ds_read_b128 v[60:63], v23 offset:24576
 s_add_u32 m0, s56, 33792
 s_add_u32 s3, s55, s68
 buffer_load_dwordx4 v24, s[4:7], s3 offen sc1 lds
 s_waitcnt lgkmcnt(3)
 v_mfma_f32_32x32x16_bf16 v[64:79], v[48:51], a[112:115], v[64:79]
 s_waitcnt vmcnt(10)
 s_barrier
 ds_read_b128 v[32:35], v16 offset:32768
 s_waitcnt lgkmcnt(3)
 v_mfma_f32_32x32x16_bf16 v[64:79], v[52:55], a[116:119], v[64:79]
 ds_read_b128 v[36:39], v17 offset:32768
 s_waitcnt lgkmcnt(3)
 v_mfma_f32_32x32x16_bf16 v[64:79], v[56:59], a[120:123], v[64:79]
 ds_read_b128 v[40:43], v18 offset:32768
 s_waitcnt lgkmcnt(3)
 v_mfma_f32_32x32x16_bf16 v[64:79], v[60:63], a[124:127], v[64:79]
 ds_read_b128 v[44:47], v19 offset:32768
 s_waitcnt lgkmcnt(3)
 v_mfma_f32_32x32x16_bf16 v[64:79], v[32:35], a[128:131], v[64:79]
 ds_read_b128 v[48:51], v20 offset:32768
 s_waitcnt lgkmcnt(3)
 v_mfma_f32_32x32x16_bf16 v[64:79], v[36:39], a[132:135], v[64:79]
 ds_read_b128 v[52:55], v21 offset:32768
 s_waitcnt lgkmcnt(3)
 v_mfma_f32_32x32x16_bf16 v[64:79], v[40:43], a[136:139], v[64:79]
 ds_read_b128 v[56:59], v22 offset:32768
 s_waitcnt lgkmcnt(3)
 v_mfma_f32_32x32x16_bf16 v[64:79], v[44:47], a[140:143], v[64:79]
 ds_read_b128 v[60:63], v23 offset:32768
 s_waitcnt lgkmcnt(3)
 v_mfma_f32_32x32x16_bf16 v[64:79], v[48:51], a[144:147], v[64:79]
 s_waitcnt lgkmcnt(2)
 v_mfma_f32_32x32x16_bf16 v[64:79], v[52:55], a[148:151], v[64:79]
 s_waitcnt lgkmcnt(1)
 v_mfma_f32_32x32x16_bf16 v[64:79], v[56:59], a[152:155], v[64:79]
 s_waitcnt lgkmcnt(0)
 v_mfma_f32_32x32x16_bf16 v[64:79], v[60:63], a[156:159], v[64:79]
 s_lshl_b32 s3, s60, 19
 s_add_u32 s3, s3, s58
 s_xor_b32 s3, s3, s82
 s_add_u32 s3, s3, 33554432
 s_nop 8
 v_cvt_pk_bf16_f32 v88, v64, v65
 v_cvt_pk_bf16_f32 v89, v66, v67
 v_cvt_pk_bf16_f32 v90, v72, v73
 v_cvt_pk_bf16_f32 v91, v74, v75
 buffer_store_dwordx4 v[88:91], v4, s[4:7], s3 offen offset:0 sc1
 v_cvt_pk_bf16_f32 v92, v68, v69
 v_cvt_pk_bf16_f32 v93, v70, v71
 v_cvt_pk_bf16_f32 v94, v76, v77
 v_cvt_pk_bf16_f32 v95, v78, v79
 buffer_store_dwordx4 v[92:95], v4, s[4:7], s3 offen offset:512 sc1
 s_cmp_ge_u32 s54, 64
 s_cbranch_scc1 L_n0_111
 s_waitcnt vmcnt(2)
 s_barrier
 s_lshl_b32 s55, s54, 2
 s_add_u32 s55, s55, s62
 s_sub_u32 s55, s55, 28
 s_cmp_lg_u32 s50, 0
 s_cselect_b32 s55, 268435456, s55
 v_mov_b32 v6, 8
 s_mov_b32 s60, s54
 ds_read_b128 v[32:35], v8 offset:0
 ds_read_b128 v[36:39], v9 offset:0
 ds_read_b128 v[40:43], v10 offset:0
 ds_read_b128 v[44:47], v11 offset:0
 s_waitcnt lgkmcnt(3)
 v_mfma_f32_32x32x16_bf16 v[64:79], v[32:35], a[0:3], 0
 ds_read_b128 v[48:51], v12 offset:0
 s_waitcnt lgkmcnt(3)
 v_mfma_f32_32x32x16_bf16 v[64:79], v[36:39], a[4:7], v[64:79]
 ds_read_b128 v[52:55], v13 offset:0
 s_waitcnt lgkmcnt(3)
 v_mfma_f32_32x32x16_bf16 v[64:79], v[40:43], a[8:11], v[64:79]
 ds_read_b128 v[56:59], v14 offset:0
 s_waitcnt lgkmcnt(3)
 v_mfma_f32_32x32x16_bf16 v[64:79], v[44:47], a[12:15], v[64:79]
 ds_read_b128 v[60:63], v15 offset:0
 s_waitcnt lgkmcnt(3)
 v_mfma_f32_32x32x16_bf16 v[64:79], v[48:51], a[16:19], v[64:79]
 ds_read_b128 v[32:35], v8 offset:8192
 s_waitcnt lgkmcnt(3)
 v_mfma_f32_32x32x16_bf16 v[64:79], v[52:55], a[20:23], v[64:79]
 ds_read_b128 v[36:39], v9 offset:8192
 s_waitcnt lgkmcnt(3)
 v_mfma_f32_32x32x16_bf16 v[64:79], v[56:59], a[24:27], v[64:79]
 ds_read_b128 v[40:43], v10 offset:8192
 s_waitcnt lgkmcnt(3)
 v_mfma_f32_32x32x16_bf16 v[64:79], v[60:63], a[28:31], v[64:79]
 ds_read_b128 v[44:47], v11 offset:8192
 s_waitcnt lgkmcnt(3)
 v_mfma_f32_32x32x16_bf16 v[64:79], v[32:35], a[32:35], v[64:79]
 ds_read_b128 v[48:51], v12 offset:8192
 s_waitcnt lgkmcnt(3)
 v_mfma_f32_32x32x16_bf16 v[64:79], v[36:39], a[36:39], v[64:79]
 ds_read_b128 v[52:55], v13 offset:8192
 s_waitcnt lgkmcnt(3)
 v_mfma_f32_32x32x16_bf16 v[64:79], v[40:43], a[40:43], v[64:79]
 ds_read_b128 v[56:59], v14 offset:8192
 s_waitcnt lgkmcnt(3)
 v_mfma_f32_32x32x16_bf16 v[64:79], v[44:47], a[44:47], v[64:79]
 ds_read_b128 v[60:63], v15 offset:8192
 s_waitcnt lgkmcnt(3)
 v_mfma_f32_32x32x16_bf16 v[64:79], v[48:51], a[48:51], v[64:79]
 ds_read_b128 v[32:35], v8 offset:16384
 s_waitcnt lgkmcnt(3)
 v_mfma_f32_32x32x16_bf16 v[64:79], v[52:55], a[52:55], v[64:79]
 ds_read_b128 v[36:39], v9 offset:16384
 s_waitcnt lgkmcnt(3)
 v_mfma_f32_32x32x16_bf16 v[64:79], v[56:59], a[56:59], v[64:79]
 ds_read_b128 v[40:43], v10 offset:16384
 s_waitcnt lgkmcnt(3)
 v_mfma_f32_32x32x16_bf16 v[64:79], v[60:63], a[60:63], v[64:79]
 ds_read_b128 v[44:47], v11 offset:16384
 s_waitcnt lgkmcnt(3)
 v_mfma_f32_32x32x16_bf16 v[64:79], v[32:35], a[64:67], v[64:79]
 ds_read_b128 v[48:51], v12 offset:16384
 s_waitcnt lgkmcnt(3)
 v_mfma_f32_32x32x16_bf16 v[64:79], v[36:39], a[68:71], v[64:79]
 ds_read_b128 v[52:55], v13 offset:16384
 s_waitcnt vmcnt(0)
 s_lshl_b32 s3, s54, 2
 s_add_u32 s3, s3, s63
 v_mov_b32 v3, 1
 s_mov_b64 exec, 1
 buffer_atomic_add v3, v5, s[4:7], s3 offen
 s_mov_b64 exec, -1
 s_cmp_eq_u32 s61, 0
 s_cbranch_scc1 L_pf_112
 s_lshl_b32 s3, s61, 2
 s_add_u32 s3, s3, s59
 s_sub_u32 s3, s3, 4
 v_mov_b32 v3, 1
 s_mov_b64 exec, 1
 buffer_atomic_add v3, v5, s[4:7], s3 offen
 s_mov_b64 exec, -1
 s_mov_b32 s61, 0
L_pf_112:
 s_waitcnt lgkmcnt(3)
 v_mfma_f32_32x32x16_bf16 v[64:79], v[40:43], a[72:75], v[64:79]
 ds_read_b128 v[56:59], v14 offset:16384
 s_waitcnt lgkmcnt(3)
 v_mfma_f32_32x32x16_bf16 v[64:79], v[44:47], a[76:79], v[64:79]
 ds_read_b128 v[60:63], v15 offset:16384
 s_waitcnt lgkmcnt(3)
 v_mfma_f32_32x32x16_bf16 v[64:79], v[48:51], a[80:83], v[64:79]
 ds_read_b128 v[32:35], v8 offset:24576
 s_waitcnt lgkmcnt(3)
 v_mfma_f32_32x32x16_bf16 v[64:79], v[52:55], a[84:87], v[64:79]
 ds_read_b128 v[36:39], v9 offset:24576
 s_waitcnt lgkmcnt(3)
 v_mfma_f32_32x32x16_bf16 v[64:79], v[56:59], a[88:91], v[64:79]
 ds_read_b128 v[40:43], v10 offset:24576
 s_waitcnt lgkmcnt(3)
 v_mfma_f32_32x32x16_bf16 v[64:79], v[60:63], a[92:95], v[64:79]
 ds_read_b128 v[44:47], v11 offset:24576
 s_waitcnt lgkmcnt(3)
 v_mfma_f32_32x32x16_bf16 v[64:79], v[32:35], a[96:99], v[64:79]
 ds_read_b128 v[48:51], v12 offset:24576
 s_waitcnt lgkmcnt(3)
 v_mfma_f32_32x32x16_bf16 v[64:79], v[36:39], a[100:103], v[64:79]
 ds_read_b128 v[52:55], v13 offset:24576
 s_mov_b64 exec, 15
 v_mov_b32 v6, 0
 buffer_atomic_add v6, v5, s[4:7], s55 offen sc0
 s_mov_b64 exec, -1
 s_waitcnt lgkmcnt(3)
 v_mfma_f32_32x32x16_bf16 v[64:79], v[40:43], a[104:107], v[64:79]
 ds_read_b128 v[56:59], v14 offset:24576
 s_waitcnt lgkmcnt(3)
 v_mfma_f32_32x32x16_bf16 v[64:79], v[44:47], a[108:111], v[64:79]
 ds_read_b128 v[60:63], v15 offset:24576
 s_waitcnt lgkmcnt(3)
 v_mfma_f32_32x32x16_bf16 v[64:79], v[48:51], a[112:115], v[64:79]
 ds_read_b128 v[32:35], v8 offset:32768
 s_waitcnt lgkmcnt(3)
 v_mfma_f32_32x32x16_bf16 v[64:79], v[52:55], a[116:119], v[64:79]
 ds_read_b128 v[36:39], v9 offset:32768
 s_waitcnt lgkmcnt(3)
 v_mfma_f32_32x32x16_bf16 v[64:79], v[56:59], a[120:123], v[64:79]
 ds_read_b128 v[40:43], v10 offset:32768
 s_waitcnt lgkmcnt(3)
 v_mfma_f32_32x32x16_bf16 v[64:79], v[60:63], a[124:127], v[64:79]
 ds_read_b128 v[44:47], v11 offset:32768
 s_waitcnt lgkmcnt(3)
 v_mfma_f32_32x32x16_bf16 v[64:79], v[32:35], a[128:131], v[64:79]
 ds_read_b128 v[48:51], v12 offset:32768
 s_waitcnt lgkmcnt(3)
 v_mfma_f32_32x32x16_bf16 v[64:79], v[36:39], a[132:135], v[64:79]
 ds_read_b128 v[52:55], v13 offset:32768
 s_waitcnt lgkmcnt(3)
 v_mfma_f32_32x32x16_bf16 v[64:79], v[40:43], a[136:139], v[64:79]
 ds_read_b128 v[56:59], v14 offset:32768
 s_waitcnt lgkmcnt(3)
 v_mfma_f32_32x32x16_bf16 v[64:79], v[44:47], a[140:143], v[64:79]
 ds_read_b128 v[60:63], v15 offset:32768
 s_waitcnt lgkmcnt(3)
 v_mfma_f32_32x32x16_bf16 v[64:79], v[48:51], a[144:147], v[64:79]
 s_waitcnt lgkmcnt(2)
 v_mfma_f32_32x32x16_bf16 v[64:79], v[52:55], a[148:151], v[64:79]
 s_waitcnt lgkmcnt(1)
 v_mfma_f32_32x32x16_bf16 v[64:79], v[56:59], a[152:155], v[64:79]
 s_waitcnt lgkmcnt(0)
 v_mfma_f32_32x32x16_bf16 v[64:79], v[60:63], a[156:159], v[64:79]
 s_lshl_b32 s3, s60, 19
 s_add_u32 s3, s3, s58
 s_xor_b32 s3, s3, s82
 s_nop 8
 v_cvt_pk_bf16_f32 v80, v64, v65
 v_cvt_pk_bf16_f32 v81, v66, v67
 v_cvt_pk_bf16_f32 v82, v72, v73
 v_cvt_pk_bf16_f32 v83, v74, v75
 buffer_store_dwordx4 v[80:83], v4, s[4:7], s3 offen offset:0 sc1
 v_cvt_pk_bf16_f32 v84, v68, v69
 v_cvt_pk_bf16_f32 v85, v70, v71
 v_cvt_pk_bf16_f32 v86, v76, v77
 v_cvt_pk_bf16_f32 v87, v78, v79
 buffer_store_dwordx4 v[84:87], v4, s[4:7], s3 offen offset:512 sc1
 s_add_u32 s54, s54, 1
 s_mov_b32 s61, s54
 s_cmp_lg_u32 s50, 0
 s_cbranch_scc1 L_w_113
 s_waitcnt vmcnt(2)
 v_cmp_gt_u32 vcc, 8, v6
 s_nop 1
 v_mov_b32 v3, vcc_lo
 ds_write_b32 v7, v3
 s_waitcnt lgkmcnt(0)
L_w_113:
 s_barrier
 ds_read_b32 v3, v7
 s_waitcnt lgkmcnt(0)
 v_readfirstlane_b32 s3, v3
 s_cmp_eq_u32 s3, 0
 s_cbranch_scc1 L_qkvv_loop
 s_branch L_qkvv_block
L_n0_111:
 s_waitcnt vmcnt(0)
 s_lshl_b32 s3, s54, 2
 s_add_u32 s3, s3, s63
 v_mov_b32 v3, 1
 s_mov_b64 exec, 1
 buffer_atomic_add v3, v5, s[4:7], s3 offen
 s_mov_b64 exec, -1
 s_add_u32 s54, s54, 1
 s_cmp_lt_u32 s54, 72
 s_cbranch_scc1 L_qkvv_block
 s_endpgm
L_wm:
 s_mov_b32 s96, s44
 s_and_b32 s97, s45, 0xffff
 s_mov_b32 s98, 256
 s_mov_b32 s99, 0x00020000
 v_mov_b32 v1, 132
 s_mov_b32 s3, 144
 v_writelane_b32 v1, s3, 1
 s_mov_b32 s51, 0
 s_mov_b64 exec, 3
L_wb_114:
 buffer_load_dword v2, v1, s[96:99], 0 offen sc1
 s_waitcnt vmcnt(0)
 v_cmp_eq_u32 vcc, 0, v2
 s_cbranch_vccz L_wbd_115
 s_sleep 2
 s_add_u32 s51, s51, 1
 s_cmp_lt_u32 s51, 131072
 s_cbranch_scc1 L_wb_114
 s_branch L_bail
L_wbd_115:
 s_mov_b64 exec, -1
 v_readlane_b32 s81, v2, 1
 s_nop 3
 s_sub_u32 s81, s81, 1
 s_mov_b32 s96, s44
 s_and_b32 s97, s45, 0xffff
 s_mov_b32 s98, 256
 s_mov_b32 s99, 0x00020000
 v_lshlrev_b32 v1, 5, v0
 s_mov_b32 s51, 0
L_gl_116:
 buffer_load_dword v2, v1, s[96:99], 0 offen sc1
 s_waitcnt vmcnt(0)
 v_readlane_b32 s3, v2, s48
 s_mov_b32 s80, 0
 s_nop 2
 s_cmp_ge_u32 s3, 32
 s_cbranch_scc1 L_gld_117
 s_mov_b32 s80, 0
 v_readlane_b32 s3, v2, 0
 s_nop 3
 s_add_u32 s80, s80, s3
 v_readlane_b32 s3, v2, 1
 s_nop 3
 s_add_u32 s80, s80, s3
 v_readlane_b32 s3, v2, 2
 s_nop 3
 s_add_u32 s80, s80, s3
 v_readlane_b32 s3, v2, 3
 s_nop 3
 s_add_u32 s80, s80, s3
 v_readlane_b32 s3, v2, 4
 s_nop 3
 s_add_u32 s80, s80, s3
 v_readlane_b32 s3, v2, 5
 s_nop 3
 s_add_u32 s80, s80, s3
 v_readlane_b32 s3, v2, 6
 s_nop 3
 s_add_u32 s80, s80, s3
 v_readlane_b32 s3, v2, 7
 s_nop 3
 s_add_u32 s80, s80, s3
 s_cmp_ge_u32 s80, 256
 s_cbranch_scc1 L_gld_117
 s_sleep 4
 s_add_u32 s51, s51, 1
 s_cmp_lt_u32 s51, 131072
 s_cbranch_scc1 L_gl_116
 s_branch L_bail
L_gld_117:
 s_xor_b32 s78, s81, 0
 s_lshl_b32 s78, s78, 13
 s_xor_b32 s79, s78, 8192
 s_and_b32 s52, s48, 1
 s_lshl_b32 s52, s52, 1
 s_add_u32 s52, s52, s49
 s_sub_u32 s52, s52, 30
 s_lshl_b32 s52, s52, 2
 s_add_u32 s52, s52, s50
 s_lshl_b32 s52, s52, 1
 v_lshlrev_b32 v1, 7, v0
 v_lshlrev_b32 v6, 8, v0
 s_add_u32 s54, s78, 32768
 s_cmp_lt_u32 s48, 2
 s_cselect_b32 s54, 16384, s54
 s_cselect_b32 s57, 0, 33554432
 s_cselect_b32 s56, 0, 8192
 s_lshl_b32 s3, s52, 8
 s_add_u32 s54, s54, s3
 v_add_u32 v3, s54, v6
 s_add_u32 s56, s56, s3
 s_add_u32 s56, s56, 0
 s_lshl_b32 s3, s52, 14
 s_add_u32 s57, s57, s3
 s_add_u32 s57, s57, 16777216
 s_mov_b32 s53, 0
 v_mov_b32 v4, 0
 v_mov_b32 v5, 0
 v_mov_b32 v7, 0
L_wm_loop:
 s_sub_i32 s55, s53, 3
 s_max_i32 s55, s55, 0
 v_cmp_gt_u32 vcc, s55, v7
 s_cbranch_vccz L_wg_118
 s_add_u32 s54, s56, 8
 s_mov_b32 s51, 0
 s_mov_b64 exec, 1
L_pl_120:
 buffer_load_dword v2, v4, s[4:7], s54 offen sc1
 s_waitcnt vmcnt(0)
 v_cmp_gt_u32 vcc, s55, v2
 s_cbranch_vccz L_pld_121
 s_sleep 2
 s_add_u32 s51, s51, 1
 s_cmp_lt_u32 s51, 131072
 s_cbranch_scc1 L_pl_120
 s_branch L_bail
L_pld_121:
 s_mov_b64 exec, -1
L_wg_118:
 s_lshl_b32 s54, s53, 2
 v_cmp_gt_u32 vcc, 12, v5
 s_and_b32 s3, vcc_lo, 3
 s_cbranch_scc0 L_wh_119
 s_mov_b32 s51, 0
 s_mov_b64 exec, 3
L_wc_122:
 v_mov_b32 v5, 0
 buffer_atomic_add v5, v3, s[4:7], s54 offen sc0
 s_waitcnt vmcnt(0)
 v_cmp_gt_u32 vcc, 12, v5
 s_cbranch_vccz L_wcd_123
 s_sleep 1
 s_add_u32 s51, s51, 1
 s_cmp_lt_u32 s51, 131072
 s_cbranch_scc1 L_wc_122
 s_branch L_bail
L_wcd_123:
 s_mov_b64 exec, -1
L_wh_119:
 s_lshl_b32 s58, s53, 19
 s_add_u32 s58, s58, s57
 s_add_u32 s3, s58, 0
 buffer_load_dword v8, v1, s[4:7], s3 offen sc1
 s_add_u32 s3, s58, 24576
 buffer_load_dword v9, v1, s[4:7], s3 offen sc1
 s_add_u32 s3, s58, 67108864
 buffer_load_dword v10, v1, s[4:7], s3 offen sc1
 s_add_u32 s3, s58, 67133440
 buffer_load_dword v11, v1, s[4:7], s3 offen sc1
 v_mov_b32 v5, 0
 s_mov_b64 exec, 3
 buffer_atomic_add v5, v3, s[4:7], s54 offen offset:4 sc0
 s_mov_b64 exec, -1
 buffer_load_dword v7, off, s[4:7], s56 offset:8 sc1
 s_add_u32 s55, s53, 1
 v_mov_b32 v2, s55
 s_waitcnt vmcnt(2)
 s_mov_b64 exec, 3
 s_cmp_lg_u32 s80, 0
 s_cbranch_scc1 L_lf_124
 buffer_store_dword v2, v6, s[4:7], s56 offen
 s_branch L_lf_125
L_lf_124:
 buffer_store_dword v2, v6, s[4:7], s56 offen sc1
L_lf_125:
 s_mov_b64 exec, -1
 s_waitcnt vmcnt(1)
 s_add_u32 s53, s53, 1
 s_cmp_lt_u32 s53, 64
 s_cbranch_scc1 L_wm_loop
 s_endpgm
L_wo:
 s_and_b32 s100, s64, 1
 s_lshl_b32 s100, s100, 13
 s_lshl_b32 s64, s64, 14
 s_add_u32 s64, s64, s100
 s_xor_b32 s64, s64, 8192
 s_and_b32 s100, s65, 1
 s_lshl_b32 s100, s100, 13
 s_lshl_b32 s65, s65, 14
 s_add_u32 s65, s65, s100
 s_xor_b32 s65, s65, 8192
 s_and_b32 s100, s66, 1
 s_lshl_b32 s100, s100, 13
 s_lshl_b32 s66, s66, 14
 s_add_u32 s66, s66, s100
 s_xor_b32 s66, s66, 8192
 s_and_b32 s100, s67, 1
 s_lshl_b32 s100, s100, 13
 s_lshl_b32 s67, s67, 14
 s_add_u32 s67, s67, s100
 s_xor_b32 s67, s67, 8192
 v_lshlrev_b32 v7, 4, v0
 s_lshl_b32 s3, s50, 3
 v_lshrrev_b32 v4, 4, v0
 v_add_u32 v4, s3, v4
 v_mul_u32_u24 v15, 272, v4
 v_mul_u32_u24 v4, 1280, v4
 v_and_b32 v3, 15, v0
 v_lshl_add_u32 v4, v3, 4, v4
 v_lshl_add_u32 v15, v3, 4, v15
 v_and_b32 v14, 31, v0
 v_mul_u32_u24 v14, 272, v14
 v_lshrrev_b32 v3, 5, v0
 v_lshl_add_u32 v14, v3, 3, v14
 s_lshl_b32 s3, s50, 6
 s_add_u32 s3, s3, 65536
 v_add_u32 v14, s3, v14
 v_add_u32 v15, 0x10000, v15
 s_lshl_b32 s3, s53, 8
 v_add_u32 v4, s3, v4
 s_mul_i32 s58, s52, 40960
 s_add_u32 s58, s58, 150994944
 s_mov_b32 s96, s44
 s_and_b32 s97, s45, 0xffff
 s_mov_b32 s98, 256
 s_mov_b32 s99, 0x00020000
 v_mov_b32 v12, 132
 s_mov_b32 s3, 144
 v_writelane_b32 v12, s3, 1
 s_mov_b32 s51, 0
 s_mov_b64 exec, 3
L_wb_126:
 buffer_load_dword v13, v12, s[96:99], 0 offen sc1
 s_waitcnt vmcnt(0)
 v_cmp_eq_u32 vcc, 0, v13
 s_cbranch_vccz L_wbd_127
 s_sleep 2
 s_add_u32 s51, s51, 1
 s_cmp_lt_u32 s51, 131072
 s_cbranch_scc1 L_wb_126
 s_branch L_bail
L_wbd_127:
 s_mov_b64 exec, -1
 v_readlane_b32 s81, v13, 1
 s_nop 3
 s_sub_u32 s81, s81, 1
 s_xor_b32 s78, s81, 0
 s_lshl_b32 s78, s78, 13
 s_xor_b32 s79, s78, 8192
 v_lshlrev_b32 v8, 9, v0
 v_and_b32 v3, 0xffffe000, v8
 v_add_u32 v8, v8, v3
 v_add_u32 v8, s78, v8
 s_mul_i32 s3, s52, 5
 s_add_u32 s3, s3, s53
 s_and_b32 s55, s3, 3
 s_mul_i32 s55, s55, 32768
 v_add_u32 v8, s55, v8
 s_lshl_b32 s3, s3, 9
 s_lshr_b32 s100, s3, 13
 s_lshl_b32 s100, s100, 13
 s_add_u32 s3, s3, s100
 s_add_u32 s3, s3, s79
 s_add_u32 s3, s3, 49152
 v_lshlrev_b32 v5, 8, v0
 v_add_u32 v5, s3, v5
 v_mov_b32 v6, 0
 v_and_b32 v10, 1, v0
 v_lshlrev_b32 v10, 2, v10
 v_add_u32 v10, 163776, v10
 s_lshl_b32 s56, s50, 11
 s_mov_b32 s54, 0
 s_mov_b32 s61, -1
 s_mov_b32 s63, 268435456
 s_mov_b32 s59, 0
 s_cmp_lg_u32 s50, 0
 s_cselect_b32 s68, 268435456, 0
 v_mov_b32 v2, s59
 v_writelane_b32 v2, s54, 0
 v_lshl_add_u32 v2, v2, 2, v5
 s_cmp_lt_u32 s54, 64
 s_cselect_b32 s3, 8, 0
 v_writelane_b32 v6, s3, 0
 s_cselect_b32 s3, 13, 0
 s_add_u32 s3, s3, s59
 s_cmp_ge_u32 s54, s3
 s_cselect_b32 s3, 8, 0
 v_writelane_b32 v6, s3, 1
L_wo_block:
 s_cmp_lg_u32 s50, 0
 s_cbranch_scc1 L_w_128
 v_mov_b32 v13, 0
 s_mov_b32 s51, 0
 s_mov_b64 exec, 3
 v_mov_b32 v12, 0
 buffer_atomic_add v12, v2, s[4:7], 0 offen sc0
 s_sleep 5
L_wc_129:
 v_mov_b32 v13, 0
 buffer_atomic_add v13, v2, s[4:7], 0 offen sc0
 s_waitcnt vmcnt(1)
 v_cmp_gt_u32 vcc, v6, v12
 s_cbranch_vccz L_wcd_130
 v_mov_b32 v12, 0
 buffer_atomic_add v12, v2, s[4:7], 0 offen sc0
 s_waitcnt vmcnt(1)
 v_cmp_gt_u32 vcc, v6, v13
 s_cbranch_vccz L_wcd_130
 s_add_u32 s51, s51, 1
 s_cmp_lt_u32 s51, 131072
 s_cbranch_scc1 L_wc_129
 s_branch L_bail
L_wcd_130:
 s_mov_b64 exec, -1
 v_max_u32 v9, v12, v13
L_w_128:
 s_cmp_lg_u32 s50, 0
 s_cselect_b64 exec, 0, 3
 ds_write_b32 v10, v9 offset:8
 s_mov_b64 exec, -1
 s_waitcnt lgkmcnt(0)
 s_barrier
 ds_read_b32 v9, v10 offset:8
 s_waitcnt lgkmcnt(0)
L_wo_loop:
 s_lshl_b32 s3, s52, 16
 s_add_u32 s3, s3, s56
 s_add_u32 s3, s3, 83886080
 s_lshl_b32 s55, s54, 19
 s_add_u32 s55, s55, s3
 s_cmp_lt_u32 s54, 64
 s_cselect_b32 s55, s55, 268435456
 s_add_u32 m0, s56, 0
 s_add_u32 s3, s55, s64
 buffer_load_dwordx4 v7, s[4:7], s3 offen offset:0 sc1 lds
 s_add_u32 m0, s56, 0
 s_add_u32 s3, s55, s64
 buffer_load_dwordx4 v7, s[4:7], s3 offen offset:1024 sc1 lds
 s_add_u32 m0, s56, 8192
 s_add_u32 s3, s55, s65
 buffer_load_dwordx4 v7, s[4:7], s3 offen offset:0 sc1 lds
 s_add_u32 m0, s56, 8192
 s_add_u32 s3, s55, s65
 buffer_load_dwordx4 v7, s[4:7], s3 offen offset:1024 sc1 lds
 s_add_u32 m0, s56, 16384
 s_add_u32 s3, s55, s66
 buffer_load_dwordx4 v7, s[4:7], s3 offen offset:0 sc1 lds
 s_add_u32 m0, s56, 16384
 s_add_u32 s3, s55, s66
 buffer_load_dwordx4 v7, s[4:7], s3 offen offset:1024 sc1 lds
 s_add_u32 m0, s56, 24576
 s_add_u32 s3, s55, s67
 buffer_load_dwordx4 v7, s[4:7], s3 offen offset:0 sc1 lds
 s_add_u32 m0, s56, 24576
 s_add_u32 s3, s55, s67
 buffer_load_dwordx4 v7, s[4:7], s3 offen offset:1024 sc1 lds
 v_readlane_b32 s3, v9, 1
 s_nop 3
 s_cmp_ge_u32 s3, 8
 s_cselect_b32 s60, s59, -1
 s_addc_u32 s59, s59, 0
 s_lshl_b32 s3, s52, 16
 s_add_u32 s3, s3, s56
 s_add_u32 s3, s3, 117440512
 s_lshl_b32 s55, s60, 19
 s_add_u32 s55, s55, s3
 s_cmp_lt_u32 s60, 64
 s_cselect_b32 s55, s55, 268435456
 s_waitcnt vmcnt(6)
 s_barrier
 ds_read_b128 v[32:35], v7 offset:0
 ds_read_b128 v[36:39], v7 offset:1024
 ds_read_b128 v[40:43], v7 offset:2048
 ds_read_b128 v[44:47], v7 offset:3072
 s_waitcnt lgkmcnt(3)
 v_mfma_f32_32x32x16_bf16 v[64:79], a[0:3], v[32:35], 0
 ds_read_b128 v[48:51], v7 offset:4096
 s_add_u32 m0, s56, 32768
 s_add_u32 s3, s55, s64
 buffer_load_dwordx4 v7, s[4:7], s3 offen offset:0 sc1 lds
 s_waitcnt lgkmcnt(3)
 v_mfma_f32_32x32x16_bf16 v[64:79], a[4:7], v[36:39], v[64:79]
 ds_read_b128 v[52:55], v7 offset:5120
 s_waitcnt lgkmcnt(3)
 v_mfma_f32_32x32x16_bf16 v[64:79], a[8:11], v[40:43], v[64:79]
 ds_read_b128 v[56:59], v7 offset:6144
 s_add_u32 m0, s56, 32768
 s_add_u32 s3, s55, s64
 buffer_load_dwordx4 v7, s[4:7], s3 offen offset:1024 sc1 lds
 s_waitcnt lgkmcnt(3)
 v_mfma_f32_32x32x16_bf16 v[64:79], a[12:15], v[44:47], v[64:79]
 ds_read_b128 v[60:63], v7 offset:7168
 s_waitcnt lgkmcnt(3)
 v_mfma_f32_32x32x16_bf16 v[64:79], a[16:19], v[48:51], v[64:79]
 s_waitcnt vmcnt(6)
 s_barrier
 ds_read_b128 v[32:35], v7 offset:8192
 s_add_u32 m0, s56, 40960
 s_add_u32 s3, s55, s65
 buffer_load_dwordx4 v7, s[4:7], s3 offen offset:0 sc1 lds
 s_waitcnt lgkmcnt(3)
 v_mfma_f32_32x32x16_bf16 v[64:79], a[20:23], v[52:55], v[64:79]
 ds_read_b128 v[36:39], v7 offset:9216
 s_waitcnt lgkmcnt(3)
 v_mfma_f32_32x32x16_bf16 v[64:79], a[24:27], v[56:59], v[64:79]
 ds_read_b128 v[40:43], v7 offset:10240
 s_add_u32 m0, s56, 40960
 s_add_u32 s3, s55, s65
 buffer_load_dwordx4 v7, s[4:7], s3 offen offset:1024 sc1 lds
 s_waitcnt lgkmcnt(3)
 v_mfma_f32_32x32x16_bf16 v[64:79], a[28:31], v[60:63], v[64:79]
 ds_read_b128 v[44:47], v7 offset:11264
 s_waitcnt lgkmcnt(3)
 v_mfma_f32_32x32x16_bf16 v[64:79], a[32:35], v[32:35], v[64:79]
 ds_read_b128 v[48:51], v7 offset:12288
 s_add_u32 m0, s56, 49152
 s_add_u32 s3, s55, s66
 buffer_load_dwordx4 v7, s[4:7], s3 offen offset:0 sc1 lds
 s_waitcnt lgkmcnt(3)
 v_mfma_f32_32x32x16_bf16 v[64:79], a[36:39], v[36:39], v[64:79]
 ds_read_b128 v[52:55], v7 offset:13312
 s_waitcnt lgkmcnt(3)
 v_mfma_f32_32x32x16_bf16 v[64:79], a[40:43], v[40:43], v[64:79]
 ds_read_b128 v[56:59], v7 offset:14336
 s_add_u32 m0, s56, 49152
 s_add_u32 s3, s55, s66
 buffer_load_dwordx4 v7, s[4:7], s3 offen offset:1024 sc1 lds
 s_waitcnt lgkmcnt(3)
 v_mfma_f32_32x32x16_bf16 v[64:79], a[44:47], v[44:47], v[64:79]
 ds_read_b128 v[60:63], v7 offset:15360
 s_waitcnt lgkmcnt(3)
 v_mfma_f32_32x32x16_bf16 v[64:79], a[48:51], v[48:51], v[64:79]
 s_waitcnt vmcnt(8)
 s_barrier
 ds_read_b128 v[32:35], v7 offset:16384
 s_add_u32 m0, s56, 57344
 s_add_u32 s3, s55, s67
 buffer_load_dwordx4 v7, s[4:7], s3 offen offset:0 sc1 lds
 s_waitcnt lgkmcnt(3)
 v_mfma_f32_32x32x16_bf16 v[64:79], a[52:55], v[52:55], v[64:79]
 ds_read_b128 v[36:39], v7 offset:17408
 s_waitcnt lgkmcnt(3)
 v_mfma_f32_32x32x16_bf16 v[64:79], a[56:59], v[56:59], v[64:79]
 ds_read_b128 v[40:43], v7 offset:18432
 s_add_u32 m0, s56, 57344
 s_add_u32 s3, s55, s67
 buffer_load_dwordx4 v7, s[4:7], s3 offen offset:1024 sc1 lds
 s_waitcnt lgkmcnt(3)
 v_mfma_f32_32x32x16_bf16 v[64:79], a[60:63], v[60:63], v[64:79]
 ds_read_b128 v[44:47], v7 offset:19456
 s_waitcnt lgkmcnt(3)
 v_mfma_f32_32x32x16_bf16 v[64:79], a[64:67], v[32:35], v[64:79]
 ds_read_b128 v[48:51], v7 offset:20480
 s_add_u32 s3, s63, 0
 buffer_store_dwordx4 v[112:115], v4, s[4:7], s3 offen sc1
 s_waitcnt lgkmcnt(3)
 v_mfma_f32_32x32x16_bf16 v[64:79], a[68:71], v[36:39], v[64:79]
 ds_read_b128 v[52:55], v7 offset:21504
 s_waitcnt lgkmcnt(3)
 v_mfma_f32_32x32x16_bf16 v[64:79], a[72:75], v[40:43], v[64:79]
 ds_read_b128 v[56:59], v7 offset:22528
 s_waitcnt lgkmcnt(3)
 v_mfma_f32_32x32x16_bf16 v[64:79], a[76:79], v[44:47], v[64:79]
 ds_read_b128 v[60:63], v7 offset:23552
 s_waitcnt lgkmcnt(3)
 v_mfma_f32_32x32x16_bf16 v[64:79], a[80:83], v[48:51], v[64:79]
 s_waitcnt vmcnt(9)
 s_barrier
 ds_read_b128 v[32:35], v7 offset:24576
 s_add_u32 s3, s63, 5120
 buffer_store_dwordx4 v[116:119], v4, s[4:7], s3 offen sc1
 s_waitcnt lgkmcnt(3)
 v_mfma_f32_32x32x16_bf16 v[64:79], a[84:87], v[52:55], v[64:79]
 ds_read_b128 v[36:39], v7 offset:25600
 s_waitcnt lgkmcnt(3)
 v_mfma_f32_32x32x16_bf16 v[64:79], a[88:91], v[56:59], v[64:79]
 ds_read_b128 v[40:43], v7 offset:26624
 s_waitcnt lgkmcnt(3)
 v_mfma_f32_32x32x16_bf16 v[64:79], a[92:95], v[60:63], v[64:79]
 ds_read_b128 v[44:47], v7 offset:27648
 s_waitcnt lgkmcnt(3)
 v_mfma_f32_32x32x16_bf16 v[64:79], a[96:99], v[32:35], v[64:79]
 ds_read_b128 v[48:51], v7 offset:28672
 s_waitcnt lgkmcnt(3)
 v_mfma_f32_32x32x16_bf16 v[64:79], a[100:103], v[36:39], v[64:79]
 ds_read_b128 v[52:55], v7 offset:29696
 s_waitcnt lgkmcnt(3)
 v_mfma_f32_32x32x16_bf16 v[64:79], a[104:107], v[40:43], v[64:79]
 ds_read_b128 v[56:59], v7 offset:30720
 s_waitcnt lgkmcnt(3)
 v_mfma_f32_32x32x16_bf16 v[64:79], a[108:111], v[44:47], v[64:79]
 ds_read_b128 v[60:63], v7 offset:31744
 s_waitcnt lgkmcnt(3)
 v_mfma_f32_32x32x16_bf16 v[64:79], a[112:115], v[48:51], v[64:79]
 s_waitcnt lgkmcnt(2)
 v_mfma_f32_32x32x16_bf16 v[64:79], a[116:119], v[52:55], v[64:79]
 s_waitcnt lgkmcnt(1)
 v_mfma_f32_32x32x16_bf16 v[64:79], a[120:123], v[56:59], v[64:79]
 s_waitcnt lgkmcnt(0)
 v_mfma_f32_32x32x16_bf16 v[64:79], a[124:127], v[60:63], v[64:79]
 s_mul_i32 s62, s54, 327680
 s_add_u32 s62, s62, s58
 s_cmp_lt_u32 s54, 64
 s_cselect_b32 s62, s62, 268435456
 s_nop 8
 v_cvt_pk_bf16_f32 v64, v64, v65
 v_cvt_pk_bf16_f32 v65, v66, v67
 ds_write_b64 v14, v[64:65] offset:0
 v_cvt_pk_bf16_f32 v68, v68, v69
 v_cvt_pk_bf16_f32 v69, v70, v71
 ds_write_b64 v14, v[68:69] offset:16
 v_cvt_pk_bf16_f32 v72, v72, v73
 v_cvt_pk_bf16_f32 v73, v74, v75
 ds_write_b64 v14, v[72:73] offset:32
 v_cvt_pk_bf16_f32 v76, v76, v77
 v_cvt_pk_bf16_f32 v77, v78, v79
 ds_write_b64 v14, v[76:77] offset:48
 s_waitcnt vmcnt(2) lgkmcnt(0)
 s_barrier
 ds_read_b128 v[96:99], v15 offset:0
 ds_read_b128 v[100:103], v15 offset:1088
 s_add_u32 s54, s54, 1
 s_sub_u32 s57, s54, 1
 ds_read_b128 v[32:35], v7 offset:32768
 ds_read_b128 v[36:39], v7 offset:33792
 ds_read_b128 v[40:43], v7 offset:34816
 ds_read_b128 v[44:47], v7 offset:35840
 s_waitcnt lgkmcnt(3)
 v_mfma_f32_32x32x16_bf16 v[80:95], a[0:3], v[32:35], 0
 ds_read_b128 v[48:51], v7 offset:36864
 s_add_u32 s3, s62, 0
 buffer_store_dwordx4 v[96:99], v4, s[4:7], s3 offen sc1
 s_waitcnt lgkmcnt(3)
 v_mfma_f32_32x32x16_bf16 v[80:95], a[4:7], v[36:39], v[80:95]
 ds_read_b128 v[52:55], v7 offset:37888
 s_waitcnt lgkmcnt(3)
 v_mfma_f32_32x32x16_bf16 v[80:95], a[8:11], v[40:43], v[80:95]
 ds_read_b128 v[56:59], v7 offset:38912
 s_add_u32 s3, s62, 5120
 buffer_store_dwordx4 v[100:103], v4, s[4:7], s3 offen sc1
 s_waitcnt lgkmcnt(3)
 v_mfma_f32_32x32x16_bf16 v[80:95], a[12:15], v[44:47], v[80:95]
 ds_read_b128 v[60:63], v7 offset:39936
 s_waitcnt lgkmcnt(3)
 v_mfma_f32_32x32x16_bf16 v[80:95], a[16:19], v[48:51], v[80:95]
 ds_read_b128 v[32:35], v7 offset:40960
 s_waitcnt lgkmcnt(3)
 v_mfma_f32_32x32x16_bf16 v[80:95], a[20:23], v[52:55], v[80:95]
 ds_read_b128 v[36:39], v7 offset:41984
 s_waitcnt lgkmcnt(3)
 v_mfma_f32_32x32x16_bf16 v[80:95], a[24:27], v[56:59], v[80:95]
 ds_read_b128 v[40:43], v7 offset:43008
 s_waitcnt lgkmcnt(3)
 v_mfma_f32_32x32x16_bf16 v[80:95], a[28:31], v[60:63], v[80:95]
 ds_read_b128 v[44:47], v7 offset:44032
 s_waitcnt lgkmcnt(3)
 v_mfma_f32_32x32x16_bf16 v[80:95], a[32:35], v[32:35], v[80:95]
 ds_read_b128 v[48:51], v7 offset:45056
 s_waitcnt lgkmcnt(3)
 v_mfma_f32_32x32x16_bf16 v[80:95], a[36:39], v[36:39], v[80:95]
 ds_read_b128 v[52:55], v7 offset:46080
 s_waitcnt lgkmcnt(3)
 v_mfma_f32_32x32x16_bf16 v[80:95], a[40:43], v[40:43], v[80:95]
 ds_read_b128 v[56:59], v7 offset:47104
 s_waitcnt lgkmcnt(3)
 v_mfma_f32_32x32x16_bf16 v[80:95], a[44:47], v[44:47], v[80:95]
 ds_read_b128 v[60:63], v7 offset:48128
 s_waitcnt lgkmcnt(3)
 v_mfma_f32_32x32x16_bf16 v[80:95], a[48:51], v[48:51], v[80:95]
 ds_read_b128 v[32:35], v7 offset:49152
 s_waitcnt lgkmcnt(3)
 v_mfma_f32_32x32x16_bf16 v[80:95], a[52:55], v[52:55], v[80:95]
 ds_read_b128 v[36:39], v7 offset:50176
 v_mov_b32 v2, s59
 v_writelane_b32 v2, s54, 0
 v_lshl_add_u32 v2, v2, 2, v5
 s_cmp_lt_u32 s54, 64
 s_cselect_b32 s3, 8, 0
 v_writelane_b32 v6, s3, 0
 s_cselect_b32 s3, 13, 0
 s_add_u32 s3, s3, s59
 s_cmp_ge_u32 s54, s3
 s_cselect_b32 s3, 8, 0
 v_writelane_b32 v6, s3, 1
 v_mov_b32 v9, 0
 s_mov_b64 exec, 3
 buffer_atomic_add v9, v2, s[4:7], s68 offen sc0
 s_mov_b64 exec, -1
 s_waitcnt lgkmcnt(3)
 v_mfma_f32_32x32x16_bf16 v[80:95], a[56:59], v[56:59], v[80:95]
 ds_read_b128 v[40:43], v7 offset:51200
 s_waitcnt lgkmcnt(3)
 v_mfma_f32_32x32x16_bf16 v[80:95], a[60:63], v[60:63], v[80:95]
 ds_read_b128 v[44:47], v7 offset:52224
 s_waitcnt lgkmcnt(3)
 v_mfma_f32_32x32x16_bf16 v[80:95], a[64:67], v[32:35], v[80:95]
 ds_read_b128 v[48:51], v7 offset:53248
 s_waitcnt lgkmcnt(3)
 v_mfma_f32_32x32x16_bf16 v[80:95], a[68:71], v[36:39], v[80:95]
 ds_read_b128 v[52:55], v7 offset:54272
 s_waitcnt lgkmcnt(3)
 v_mfma_f32_32x32x16_bf16 v[80:95], a[72:75], v[40:43], v[80:95]
 ds_read_b128 v[56:59], v7 offset:55296
 s_waitcnt lgkmcnt(3)
 v_mfma_f32_32x32x16_bf16 v[80:95], a[76:79], v[44:47], v[80:95]
 ds_read_b128 v[60:63], v7 offset:56320
 s_waitcnt vmcnt(1)
 s_barrier
 s_cmp_lg_u32 s50, 1
 s_cbranch_scc1 L_sg_131
 s_cmp_ge_u32 s57, 64
 s_cbranch_scc1 L_sg_131
 s_lshl_b32 s3, s57, 2
 s_add_u32 s3, s3, 98304
 v_mov_b32 v3, 1
 s_mov_b32 exec_hi, 0
 buffer_atomic_add v3, v8, s[4:7], s3 offen
 s_mov_b64 exec, -1
L_sg_131:
 s_waitcnt lgkmcnt(3)
 v_mfma_f32_32x32x16_bf16 v[80:95], a[80:83], v[48:51], v[80:95]
 ds_read_b128 v[32:35], v7 offset:57344
 s_waitcnt lgkmcnt(3)
 v_mfma_f32_32x32x16_bf16 v[80:95], a[84:87], v[52:55], v[80:95]
 ds_read_b128 v[36:39], v7 offset:58368
 s_waitcnt lgkmcnt(3)
 v_mfma_f32_32x32x16_bf16 v[80:95], a[88:91], v[56:59], v[80:95]
 ds_read_b128 v[40:43], v7 offset:59392
 s_waitcnt lgkmcnt(3)
 v_mfma_f32_32x32x16_bf16 v[80:95], a[92:95], v[60:63], v[80:95]
 ds_read_b128 v[44:47], v7 offset:60416
 s_waitcnt lgkmcnt(3)
 v_mfma_f32_32x32x16_bf16 v[80:95], a[96:99], v[32:35], v[80:95]
 ds_read_b128 v[48:51], v7 offset:61440
 s_waitcnt lgkmcnt(3)
 v_mfma_f32_32x32x16_bf16 v[80:95], a[100:103], v[36:39], v[80:95]
 ds_read_b128 v[52:55], v7 offset:62464
 s_waitcnt lgkmcnt(3)
 v_mfma_f32_32x32x16_bf16 v[80:95], a[104:107], v[40:43], v[80:95]
 ds_read_b128 v[56:59], v7 offset:63488
 s_waitcnt lgkmcnt(3)
 v_mfma_f32_32x32x16_bf16 v[80:95], a[108:111], v[44:47], v[80:95]
 ds_read_b128 v[60:63], v7 offset:64512
 s_waitcnt lgkmcnt(3)
 v_mfma_f32_32x32x16_bf16 v[80:95], a[112:115], v[48:51], v[80:95]
 s_waitcnt lgkmcnt(2)
 v_mfma_f32_32x32x16_bf16 v[80:95], a[116:119], v[52:55], v[80:95]
 s_waitcnt lgkmcnt(1)
 v_mfma_f32_32x32x16_bf16 v[80:95], a[120:123], v[56:59], v[80:95]
 s_waitcnt lgkmcnt(0)
 v_mfma_f32_32x32x16_bf16 v[80:95], a[124:127], v[60:63], v[80:95]
 s_mul_i32 s63, s60, 327680
 s_add_u32 s63, s63, s58
 s_add_u32 s63, s63, 20971520
 s_cmp_lt_u32 s60, 64
 s_cselect_b32 s63, s63, 268435456
 s_nop 8
 v_cvt_pk_bf16_f32 v80, v80, v81
 v_cvt_pk_bf16_f32 v81, v82, v83
 ds_write_b64 v14, v[80:81] offset:8704
 v_cvt_pk_bf16_f32 v84, v84, v85
 v_cvt_pk_bf16_f32 v85, v86, v87
 ds_write_b64 v14, v[84:85] offset:8720
 v_cvt_pk_bf16_f32 v88, v88, v89
 v_cvt_pk_bf16_f32 v89, v90, v91
 ds_write_b64 v14, v[88:89] offset:8736
 v_cvt_pk_bf16_f32 v92, v92, v93
 v_cvt_pk_bf16_f32 v93, v94, v95
 ds_write_b64 v14, v[92:93] offset:8752
 s_cmp_lg_u32 s50, 0
 s_cbranch_scc1 L_w0_132
 s_waitcnt vmcnt(0)
L_w0_132:
 s_cmp_lg_u32 s50, 0
 s_cselect_b64 exec, 0, 3
 ds_write_b32 v10, v9 offset:0
 s_mov_b64 exec, -1
 s_waitcnt lgkmcnt(0)
 s_barrier
 ds_read_b32 v9, v10 offset:0
 ds_read_b128 v[112:115], v15 offset:8704
 ds_read_b128 v[116:119], v15 offset:9792
 s_cmp_lg_u32 s50, 2
 s_cbranch_scc1 L_sg_133
 s_cmp_ge_u32 s61, 64
 s_cbranch_scc1 L_sg_133
 s_lshl_b32 s3, s61, 2
 s_add_u32 s3, s3, 98560
 v_mov_b32 v3, 1
 s_mov_b32 exec_hi, 0
 buffer_atomic_add v3, v8, s[4:7], s3 offen
 s_mov_b64 exec, -1
L_sg_133:
 s_mov_b32 s61, s60
 s_waitcnt lgkmcnt(0)
 v_cmp_gt_u32 vcc, v6, v9
 s_cmp_ge_u32 s54, 64
 s_cbranch_scc1 L_wo_tail
 s_cbranch_vccz L_wo_loop
 s_branch L_wo_block
L_wo_tail:
 s_add_u32 s3, s63, 0
 buffer_store_dwordx4 v[112:115], v4, s[4:7], s3 offen sc1
 s_add_u32 s3, s63, 5120
 buffer_store_dwordx4 v[116:119], v4, s[4:7], s3 offen sc1
 v_mov_b32 v2, s59
 v_writelane_b32 v2, s54, 0
 v_lshl_add_u32 v2, v2, 2, v5
 s_cmp_lt_u32 s54, 64
 s_cselect_b32 s3, 8, 0
 v_writelane_b32 v6, s3, 0
 s_cselect_b32 s3, 13, 0
 s_add_u32 s3, s3, s59
 s_cmp_ge_u32 s54, s3
 s_cselect_b32 s3, 8, 0
 v_writelane_b32 v6, s3, 1
 v_mov_b32 v9, 0
 s_mov_b64 exec, 3
 buffer_atomic_add v9, v2, s[4:7], s68 offen sc0
 s_mov_b64 exec, -1
 s_waitcnt vmcnt(1)
 s_barrier
 s_cmp_lg_u32 s50, 1
 s_cbranch_scc1 L_sg_134
 s_cmp_ge_u32 s61, 64
 s_cbranch_scc1 L_sg_134
 s_lshl_b32 s3, s61, 2
 s_add_u32 s3, s3, 98560
 v_mov_b32 v3, 1
 s_mov_b32 exec_hi, 0
 buffer_atomic_add v3, v8, s[4:7], s3 offen
 s_mov_b64 exec, -1
L_sg_134:
 s_cmp_ge_u32 s59, 64
 s_cbranch_scc1 L_bail
 s_cmp_lg_u32 s50, 0
 s_cbranch_scc1 L_w_135
 s_waitcnt vmcnt(0)
 v_cmp_gt_u32 vcc, v6, v9
 s_cbranch_vccz L_w_135
 v_mov_b32 v13, 0
 s_mov_b32 s51, 0
 s_mov_b64 exec, 3
 v_mov_b32 v12, 0
 buffer_atomic_add v12, v2, s[4:7], 0 offen sc0
 s_sleep 5
L_wc_136:
 v_mov_b32 v13, 0
 buffer_atomic_add v13, v2, s[4:7], 0 offen sc0
 s_waitcnt vmcnt(1)
 v_cmp_gt_u32 vcc, v6, v12
 s_cbranch_vccz L_wcd_137
 v_mov_b32 v12, 0
 buffer_atomic_add v12, v2, s[4:7], 0 offen sc0
 s_waitcnt vmcnt(1)
 v_cmp_gt_u32 vcc, v6, v13
 s_cbranch_vccz L_wcd_137
 s_add_u32 s51, s51, 1
 s_cmp_lt_u32 s51, 131072
 s_cbranch_scc1 L_wc_136
 s_branch L_bail
L_wcd_137:
 s_mov_b64 exec, -1
 v_max_u32 v9, v12, v13
L_w_135:
 s_barrier
 s_mov_b32 s61, s59
 s_add_u32 s59, s59, 1
 s_lshl_b32 s3, s52, 16
 s_add_u32 s3, s3, s56
 s_add_u32 s3, s3, 117440512
 s_lshl_b32 s55, s61, 19
 s_add_u32 s55, s55, s3
 s_cmp_lt_u32 s61, 64
 s_cselect_b32 s55, s55, 268435456
 s_add_u32 m0, s56, 32768
 s_add_u32 s3, s55, s64
 buffer_load_dwordx4 v7, s[4:7], s3 offen offset:0 sc1 lds
 s_add_u32 m0, s56, 32768
 s_add_u32 s3, s55, s64
 buffer_load_dwordx4 v7, s[4:7], s3 offen offset:1024 sc1 lds
 s_add_u32 m0, s56, 40960
 s_add_u32 s3, s55, s65
 buffer_load_dwordx4 v7, s[4:7], s3 offen offset:0 sc1 lds
 s_add_u32 m0, s56, 40960
 s_add_u32 s3, s55, s65
 buffer_load_dwordx4 v7, s[4:7], s3 offen offset:1024 sc1 lds
 s_add_u32 m0, s56, 49152
 s_add_u32 s3, s55, s66
 buffer_load_dwordx4 v7, s[4:7], s3 offen offset:0 sc1 lds
 s_add_u32 m0, s56, 49152
 s_add_u32 s3, s55, s66
 buffer_load_dwordx4 v7, s[4:7], s3 offen offset:1024 sc1 lds
 s_add_u32 m0, s56, 57344
 s_add_u32 s3, s55, s67
 buffer_load_dwordx4 v7, s[4:7], s3 offen offset:0 sc1 lds
 s_add_u32 m0, s56, 57344
 s_add_u32 s3, s55, s67
 buffer_load_dwordx4 v7, s[4:7], s3 offen offset:1024 sc1 lds
 s_waitcnt vmcnt(6)
 s_barrier
 ds_read_b128 v[32:35], v7 offset:32768
 ds_read_b128 v[36:39], v7 offset:33792
 ds_read_b128 v[40:43], v7 offset:34816
 ds_read_b128 v[44:47], v7 offset:35840
 s_waitcnt lgkmcnt(3)
 v_mfma_f32_32x32x16_bf16 v[80:95], a[0:3], v[32:35], 0
 ds_read_b128 v[48:51], v7 offset:36864
 s_waitcnt lgkmcnt(3)
 v_mfma_f32_32x32x16_bf16 v[80:95], a[4:7], v[36:39], v[80:95]
 ds_read_b128 v[52:55], v7 offset:37888
 s_waitcnt lgkmcnt(3)
 v_mfma_f32_32x32x16_bf16 v[80:95], a[8:11], v[40:43], v[80:95]
 ds_read_b128 v[56:59], v7 offset:38912
 s_waitcnt lgkmcnt(3)
 v_mfma_f32_32x32x16_bf16 v[80:95], a[12:15], v[44:47], v[80:95]
 ds_read_b128 v[60:63], v7 offset:39936
 s_waitcnt lgkmcnt(3)
 v_mfma_f32_32x32x16_bf16 v[80:95], a[16:19], v[48:51], v[80:95]
 s_waitcnt vmcnt(4)
 s_barrier
 ds_read_b128 v[32:35], v7 offset:40960
 s_waitcnt lgkmcnt(3)
 v_mfma_f32_32x32x16_bf16 v[80:95], a[20:23], v[52:55], v[80:95]
 ds_read_b128 v[36:39], v7 offset:41984
 s_waitcnt lgkmcnt(3)
 v_mfma_f32_32x32x16_bf16 v[80:95], a[24:27], v[56:59], v[80:95]
 ds_read_b128 v[40:43], v7 offset:43008
 s_waitcnt lgkmcnt(3)
 v_mfma_f32_32x32x16_bf16 v[80:95], a[28:31], v[60:63], v[80:95]
 ds_read_b128 v[44:47], v7 offset:44032
 s_waitcnt lgkmcnt(3)
 v_mfma_f32_32x32x16_bf16 v[80:95], a[32:35], v[32:35], v[80:95]
 ds_read_b128 v[48:51], v7 offset:45056
 s_waitcnt lgkmcnt(3)
 v_mfma_f32_32x32x16_bf16 v[80:95], a[36:39], v[36:39], v[80:95]
 ds_read_b128 v[52:55], v7 offset:46080
 s_waitcnt lgkmcnt(3)
 v_mfma_f32_32x32x16_bf16 v[80:95], a[40:43], v[40:43], v[80:95]
 ds_read_b128 v[56:59], v7 offset:47104
 s_waitcnt lgkmcnt(3)
 v_mfma_f32_32x32x16_bf16 v[80:95], a[44:47], v[44:47], v[80:95]
 ds_read_b128 v[60:63], v7 offset:48128
 s_waitcnt lgkmcnt(3)
 v_mfma_f32_32x32x16_bf16 v[80:95], a[48:51], v[48:51], v[80:95]
 s_waitcnt vmcnt(2)
 s_barrier
 ds_read_b128 v[32:35], v7 offset:49152
 s_waitcnt lgkmcnt(3)
 v_mfma_f32_32x32x16_bf16 v[80:95], a[52:55], v[52:55], v[80:95]
 ds_read_b128 v[36:39], v7 offset:50176
 s_waitcnt lgkmcnt(3)
 v_mfma_f32_32x32x16_bf16 v[80:95], a[56:59], v[56:59], v[80:95]
 ds_read_b128 v[40:43], v7 offset:51200
 s_waitcnt lgkmcnt(3)
 v_mfma_f32_32x32x16_bf16 v[80:95], a[60:63], v[60:63], v[80:95]
 ds_read_b128 v[44:47], v7 offset:52224
 s_waitcnt lgkmcnt(3)
 v_mfma_f32_32x32x16_bf16 v[80:95], a[64:67], v[32:35], v[80:95]
 ds_read_b128 v[48:51], v7 offset:53248
 s_waitcnt lgkmcnt(3)
 v_mfma_f32_32x32x16_bf16 v[80:95], a[68:71], v[36:39], v[80:95]
 ds_read_b128 v[52:55], v7 offset:54272
 s_waitcnt lgkmcnt(3)
 v_mfma_f32_32x32x16_bf16 v[80:95], a[72:75], v[40:43], v[80:95]
 ds_read_b128 v[56:59], v7 offset:55296
 s_waitcnt lgkmcnt(3)
 v_mfma_f32_32x32x16_bf16 v[80:95], a[76:79], v[44:47], v[80:95]
 ds_read_b128 v[60:63], v7 offset:56320
 s_waitcnt lgkmcnt(3)
 v_mfma_f32_32x32x16_bf16 v[80:95], a[80:83], v[48:51], v[80:95]
 s_waitcnt vmcnt(0)
 s_barrier
 ds_read_b128 v[32:35], v7 offset:57344
 s_waitcnt lgkmcnt(3)
 v_mfma_f32_32x32x16_bf16 v[80:95], a[84:87], v[52:55], v[80:95]
 ds_read_b128 v[36:39], v7 offset:58368
 s_waitcnt lgkmcnt(3)
 v_mfma_f32_32x32x16_bf16 v[80:95], a[88:91], v[56:59], v[80:95]
 ds_read_b128 v[40:43], v7 offset:59392
 s_waitcnt lgkmcnt(3)
 v_mfma_f32_32x32x16_bf16 v[80:95], a[92:95], v[60:63], v[80:95]
 ds_read_b128 v[44:47], v7 offset:60416
 s_waitcnt lgkmcnt(3)
 v_mfma_f32_32x32x16_bf16 v[80:95], a[96:99], v[32:35], v[80:95]
 ds_read_b128 v[48:51], v7 offset:61440
 s_waitcnt lgkmcnt(3)
 v_mfma_f32_32x32x16_bf16 v[80:95], a[100:103], v[36:39], v[80:95]
 ds_read_b128 v[52:55], v7 offset:62464
 s_waitcnt lgkmcnt(3)
 v_mfma_f32_32x32x16_bf16 v[80:95], a[104:107], v[40:43], v[80:95]
 ds_read_b128 v[56:59], v7 offset:63488
 s_waitcnt lgkmcnt(3)
 v_mfma_f32_32x32x16_bf16 v[80:95], a[108:111], v[44:47], v[80:95]
 ds_read_b128 v[60:63], v7 offset:64512
 s_waitcnt lgkmcnt(3)
 v_mfma_f32_32x32x16_bf16 v[80:95], a[112:115], v[48:51], v[80:95]
 s_waitcnt lgkmcnt(2)
 v_mfma_f32_32x32x16_bf16 v[80:95], a[116:119], v[52:55], v[80:95]
 s_waitcnt lgkmcnt(1)
 v_mfma_f32_32x32x16_bf16 v[80:95], a[120:123], v[56:59], v[80:95]
 s_waitcnt lgkmcnt(0)
 v_mfma_f32_32x32x16_bf16 v[80:95], a[124:127], v[60:63], v[80:95]
 s_mul_i32 s63, s61, 327680
 s_add_u32 s63, s63, s58
 s_add_u32 s63, s63, 20971520
 s_cmp_lt_u32 s61, 64
 s_cselect_b32 s63, s63, 268435456
 s_nop 8
 v_cvt_pk_bf16_f32 v80, v80, v81
 v_cvt_pk_bf16_f32 v81, v82, v83
 ds_write_b64 v14, v[80:81] offset:8704
 v_cvt_pk_bf16_f32 v84, v84, v85
 v_cvt_pk_bf16_f32 v85, v86, v87
 ds_write_b64 v14, v[84:85] offset:8720
 v_cvt_pk_bf16_f32 v88, v88, v89
 v_cvt_pk_bf16_f32 v89, v90, v91
 ds_write_b64 v14, v[88:89] offset:8736
 v_cvt_pk_bf16_f32 v92, v92, v93
 v_cvt_pk_bf16_f32 v93, v94, v95
 ds_write_b64 v14, v[92:93] offset:8752
 s_waitcnt lgkmcnt(0)
 s_barrier
 ds_read_b128 v[112:115], v15 offset:8704
 ds_read_b128 v[116:119], v15 offset:9792
 s_waitcnt lgkmcnt(0)
 s_branch L_wo_tail
L_t4:
 s_lshr_b32 s53, s50, 1
 s_and_b32 s61, s50, 1
 s_lshl_b32 s52, s52, 1
 s_add_u32 s52, s52, s61
 s_mov_b32 s54, 0
 v_lshlrev_b32 v1, 4, v0
 v_mov_b32 v72, 0
 s_lshl_b32 s3, s50, 2
 s_add_u32 s3, s3, 163776
 v_mov_b32 v73, s3
 ds_write_b32 v73, v72
 s_cmp_lg_u32 s50, 0
 s_cbranch_scc1 L_ww_138
 s_mov_b32 s96, s44
 s_and_b32 s97, s45, 0xffff
 s_mov_b32 s98, 256
 s_mov_b32 s99, 0x00020000
 v_mov_b32 v12, 136
 s_mov_b32 s51, 0
 s_mov_b64 exec, 1
L_wb_139:
 buffer_load_dword v13, v12, s[96:99], 0 offen sc1
 s_waitcnt vmcnt(0)
 v_cmp_eq_u32 vcc, 0, v13
 s_cbranch_vccz L_wbd_140
 s_sleep 2
 s_add_u32 s51, s51, 1
 s_cmp_lt_u32 s51, 131072
 s_cbranch_scc1 L_wb_139
 s_branch L_bail
L_wbd_140:
 s_mov_b64 exec, -1
L_ww_138:
 s_barrier
 s_mul_i32 s55, s52, 40960
 s_mul_i32 s56, s53, 20480
 s_add_u32 s55, s55, s56
 s_add_u32 s55, s55, 200802304
 s_mul_i32 s59, s61, 40960
 s_add_u32 s56, s56, s59
 v_and_b32 v36, 48, v0
 v_xor_b32 v36, v36, v1
 v_xor_b32 v37, 64, v36
 v_xor_b32 v38, 128, v36
 v_xor_b32 v39, 192, v36
 s_add_u32 m0, s56, 0
 s_add_u32 s3, s55, 0
 buffer_load_dwordx4 v36, s[4:7], s3 offen offset:0 sc1 lds
 buffer_load_dwordx4 v37, s[4:7], s3 offen offset:1024 sc1 lds
 buffer_load_dwordx4 v38, s[4:7], s3 offen offset:2048 sc1 lds
 buffer_load_dwordx4 v39, s[4:7], s3 offen offset:3072 sc1 lds
 s_add_u32 m0, s56, 4096
 s_add_u32 s3, s55, 4096
 buffer_load_dwordx4 v36, s[4:7], s3 offen offset:0 sc1 lds
 buffer_load_dwordx4 v37, s[4:7], s3 offen offset:1024 sc1 lds
 buffer_load_dwordx4 v38, s[4:7], s3 offen offset:2048 sc1 lds
 buffer_load_dwordx4 v39, s[4:7], s3 offen offset:3072 sc1 lds
 s_add_u32 m0, s56, 8192
 s_add_u32 s3, s55, 8192
 buffer_load_dwordx4 v36, s[4:7], s3 offen offset:0 sc1 lds
 buffer_load_dwordx4 v37, s[4:7], s3 offen offset:1024 sc1 lds
 buffer_load_dwordx4 v38, s[4:7], s3 offen offset:2048 sc1 lds
 buffer_load_dwordx4 v39, s[4:7], s3 offen offset:3072 sc1 lds
 s_add_u32 m0, s56, 12288
 s_add_u32 s3, s55, 12288
 buffer_load_dwordx4 v36, s[4:7], s3 offen offset:0 sc1 lds
 buffer_load_dwordx4 v37, s[4:7], s3 offen offset:1024 sc1 lds
 buffer_load_dwordx4 v38, s[4:7], s3 offen offset:2048 sc1 lds
 buffer_load_dwordx4 v39, s[4:7], s3 offen offset:3072 sc1 lds
 s_add_u32 m0, s56, 16384
 s_add_u32 s3, s55, 16384
 buffer_load_dwordx4 v36, s[4:7], s3 offen offset:0 sc1 lds
 buffer_load_dwordx4 v37, s[4:7], s3 offen offset:1024 sc1 lds
 buffer_load_dwordx4 v38, s[4:7], s3 offen offset:2048 sc1 lds
 buffer_load_dwordx4 v39, s[4:7], s3 offen offset:3072 sc1 lds
 s_waitcnt vmcnt(0) lgkmcnt(0)
 s_barrier
 s_cmp_eq_u32 s53, 0
 s_cbranch_scc1 L_e0_141
 s_mul_i32 s71, s61, 13312
 s_add_u32 s71, s71, 131072
 s_add_u32 s70, s52, 384
 s_mov_b32 s69, 32
 s_mov_b32 s96, s44
 s_and_b32 s97, s45, 0xffff
 s_mov_b32 s98, 256
 s_mov_b32 s99, 0x00020000
 v_mov_b32 v1, 208
 s_mov_b32 s51, 0
 s_mov_b64 exec, 1
L_wb_142:
 buffer_load_dword v2, v1, s[96:99], 0 offen sc1
 s_waitcnt vmcnt(0)
 v_cmp_eq_u32 vcc, 0, v2
 s_cbranch_vccz L_wbd_143
 s_sleep 2
 s_add_u32 s51, s51, 1
 s_cmp_lt_u32 s51, 131072
 s_cbranch_scc1 L_wb_142
 s_branch L_bail
L_wbd_143:
 s_mov_b64 exec, -1
 s_mov_b32 s8, s38
 s_and_b32 s9, s39, 0xffff
 s_mov_b32 s10, 2621440
 s_mov_b32 s11, 0x00020000
 s_mov_b32 s12, s40
 s_and_b32 s13, s41, 0xffff
 s_mov_b32 s14, 1280
 s_mov_b32 s15, 0x00020000
 v_lshlrev_b32 v130, 4, v0
 s_lshl_b32 s73, s70, 12
 s_add_u32 s74, s73, 2
 buffer_load_dwordx4 v[96:99], v130, s[8:11], s73 offen offset:0
 buffer_load_dwordx4 v[100:103], v130, s[8:11], s73 offen offset:1024
 buffer_load_dwordx4 v[104:107], v130, s[8:11], s73 offen offset:2048
 buffer_load_dwordx4 v[108:111], v130, s[8:11], s73 offen offset:3072
 buffer_load_dwordx4 v[112:115], v130, s[8:11], s74 offen offset:0
 buffer_load_dwordx4 v[116:119], v130, s[8:11], s74 offen offset:1024
 buffer_load_dwordx4 v[120:123], v130, s[8:11], s74 offen offset:2048
 buffer_load_dwordx4 v[124:127], v130, s[8:11], s74 offen offset:3072
 s_lshl_b32 s3, s70, 1
 buffer_load_ushort v128, off, s[12:15], s3
 s_lshl_b32 s3, s70, 12
 s_add_u32 s3, s3, 198180864
 buffer_load_dwordx4 v[240:243], v130, s[4:7], s3 offen offset:0 sc1
 buffer_load_dwordx4 v[244:247], v130, s[4:7], s3 offen offset:1024 sc1
 buffer_load_dwordx4 v[248:251], v130, s[4:7], s3 offen offset:2048 sc1
 buffer_load_dwordx4 v[252:255], v130, s[4:7], s3 offen offset:3072 sc1
 s_getpc_b64 s[76:77]
L_ca_144:
 s_add_u32 s76, s76, L_conv1-L_ca_144
 s_addc_u32 s77, s77, -1
 s_swappc_b64 s[76:77], s[76:77]
 s_waitcnt vmcnt(0)
 s_mov_b32 s96, s44
 s_and_b32 s97, s45, 0xffff
 s_mov_b32 s98, 256
 s_mov_b32 s99, 0x00020000
 v_mov_b32 v1, 1
 s_mov_b64 exec, 1
 buffer_atomic_add v1, off, s[96:99], 0 offset:76 sc0
 s_waitcnt vmcnt(0)
 v_cmp_eq_u32 vcc, 127, v1
 s_cbranch_vccz L_aw_145
 buffer_store_dword v1, off, s[96:99], 0 offset:204 sc1
L_aw_145:
 s_mov_b64 exec, -1
 s_mov_b32 s96, s44
 s_and_b32 s97, s45, 0xffff
 s_mov_b32 s98, 256
 s_mov_b32 s99, 0x00020000
 v_mov_b32 v1, 204
 s_mov_b32 s51, 0
 s_mov_b64 exec, 1
L_wb_146:
 buffer_load_dword v2, v1, s[96:99], 0 offen sc1
 s_waitcnt vmcnt(0)
 v_cmp_eq_u32 vcc, 0, v2
 s_cbranch_vccz L_wbd_147
 s_sleep 16
 s_add_u32 s51, s51, 1
 s_cmp_lt_u32 s51, 131072
 s_cbranch_scc1 L_wb_146
 s_branch L_bail
L_wbd_147:
 s_mov_b64 exec, -1
 v_lshlrev_b32 v1, 4, v0
 v_and_b32 v36, 48, v0
 v_xor_b32 v36, v36, v1
 v_xor_b32 v37, 64, v36
 v_xor_b32 v38, 128, v36
 v_xor_b32 v39, 192, v36
 s_add_u32 s3, s55, 1290240
 buffer_load_dwordx4 a[0:3], v36, s[4:7], s3 offen offset:0 sc1
 buffer_load_dwordx4 a[4:7], v37, s[4:7], s3 offen offset:1024 sc1
 buffer_load_dwordx4 a[8:11], v38, s[4:7], s3 offen offset:2048 sc1
 buffer_load_dwordx4 a[12:15], v39, s[4:7], s3 offen offset:3072 sc1
 s_add_u32 s3, s55, 1294336
 buffer_load_dwordx4 a[16:19], v36, s[4:7], s3 offen offset:0 sc1
 buffer_load_dwordx4 a[20:23], v37, s[4:7], s3 offen offset:1024 sc1
 buffer_load_dwordx4 a[24:27], v38, s[4:7], s3 offen offset:2048 sc1
 buffer_load_dwordx4 a[28:31], v39, s[4:7], s3 offen offset:3072 sc1
 s_add_u32 s3, s55, 1298432
 buffer_load_dwordx4 a[32:35], v36, s[4:7], s3 offen offset:0 sc1
 buffer_load_dwordx4 a[36:39], v37, s[4:7], s3 offen offset:1024 sc1
 buffer_load_dwordx4 a[40:43], v38, s[4:7], s3 offen offset:2048 sc1
 buffer_load_dwordx4 a[44:47], v39, s[4:7], s3 offen offset:3072 sc1
 s_add_u32 s3, s55, 1302528
 buffer_load_dwordx4 a[48:51], v36, s[4:7], s3 offen offset:0 sc1
 buffer_load_dwordx4 a[52:55], v37, s[4:7], s3 offen offset:1024 sc1
 buffer_load_dwordx4 a[56:59], v38, s[4:7], s3 offen offset:2048 sc1
 buffer_load_dwordx4 a[60:63], v39, s[4:7], s3 offen offset:3072 sc1
 s_add_u32 s3, s55, 1306624
 buffer_load_dwordx4 a[64:67], v36, s[4:7], s3 offen offset:0 sc1
 buffer_load_dwordx4 a[68:71], v37, s[4:7], s3 offen offset:1024 sc1
 buffer_load_dwordx4 a[72:75], v38, s[4:7], s3 offen offset:2048 sc1
 buffer_load_dwordx4 a[76:79], v39, s[4:7], s3 offen offset:3072 sc1
 s_add_u32 s3, s55, 1310720
 buffer_load_dwordx4 a[80:83], v36, s[4:7], s3 offen offset:0 sc1
 buffer_load_dwordx4 a[84:87], v37, s[4:7], s3 offen offset:1024 sc1
 buffer_load_dwordx4 a[88:91], v38, s[4:7], s3 offen offset:2048 sc1
 buffer_load_dwordx4 a[92:95], v39, s[4:7], s3 offen offset:3072 sc1
 s_add_u32 s3, s55, 1314816
 buffer_load_dwordx4 a[96:99], v36, s[4:7], s3 offen offset:0 sc1
 buffer_load_dwordx4 a[100:103], v37, s[4:7], s3 offen offset:1024 sc1
 buffer_load_dwordx4 a[104:107], v38, s[4:7], s3 offen offset:2048 sc1
 buffer_load_dwordx4 a[108:111], v39, s[4:7], s3 offen offset:3072 sc1
 s_add_u32 s3, s55, 1318912
 buffer_load_dwordx4 a[112:115], v36, s[4:7], s3 offen offset:0 sc1
 buffer_load_dwordx4 a[116:119], v37, s[4:7], s3 offen offset:1024 sc1
 buffer_load_dwordx4 a[120:123], v38, s[4:7], s3 offen offset:2048 sc1
 buffer_load_dwordx4 a[124:127], v39, s[4:7], s3 offen offset:3072 sc1
 s_add_u32 s3, s55, 1323008
 buffer_load_dwordx4 a[128:131], v36, s[4:7], s3 offen offset:0 sc1
 buffer_load_dwordx4 a[132:135], v37, s[4:7], s3 offen offset:1024 sc1
 buffer_load_dwordx4 a[136:139], v38, s[4:7], s3 offen offset:2048 sc1
 buffer_load_dwordx4 a[140:143], v39, s[4:7], s3 offen offset:3072 sc1
 s_add_u32 s3, s55, 1327104
 buffer_load_dwordx4 a[144:147], v36, s[4:7], s3 offen offset:0 sc1
 buffer_load_dwordx4 a[148:151], v37, s[4:7], s3 offen offset:1024 sc1
 buffer_load_dwordx4 a[152:155], v38, s[4:7], s3 offen offset:2048 sc1
 buffer_load_dwordx4 a[156:159], v39, s[4:7], s3 offen offset:3072 sc1
 s_waitcnt vmcnt(0)
L_e0_141:
 v_add_u32 v74, s59, v1
 v_and_b32 v72, 0xf0, v1
 v_lshl_add_u32 v72, v0, 8, v72
 v_add_u32 v72, s59, v72
 s_lshl_b32 s3, s61, 2
 s_add_u32 s3, s3, 163776
 v_mov_b32 v73, s3
 s_mov_b32 s8, s16
 s_and_b32 s9, s17, 0xffff
 s_mov_b32 s10, 2621440
 s_mov_b32 s11, 0x00020000
 s_mov_b32 s12, s42
 s_and_b32 s13, s43, 0xffff
 s_mov_b32 s14, 2621440
 s_mov_b32 s15, 0x00020000
 v_lshlrev_b32 v1, 4, v0
 v_lshlrev_b32 v2, 3, v0
 v_cmp_lt_u32 vcc, 31, v0
 v_mov_b32 v3, 268435456
 s_nop 1
 v_cndmask_b32 v6, v1, v3, vcc
 v_cndmask_b32 v7, v2, v3, vcc
 s_and_b32 s3, s52, 15
 v_lshrrev_b32 v4, 3, v0
 v_lshlrev_b32 v4, 2, v4
 v_and_b32 v10, 3, v0
 v_add_u32 v4, v4, v10
 v_xor_b32 v4, s3, v4
 v_lshlrev_b32 v4, 4, v4
 v_and_b32 v10, 4, v0
 v_lshl_add_u32 v4, v10, 1, v4
 v_cndmask_b32 v8, v4, v3, vcc
 s_mov_b32 s96, s44
 s_and_b32 s97, s45, 0xffff
 s_mov_b32 s98, 256
 s_mov_b32 s99, 0x00020000
 v_mov_b32 v12, 132
 s_mov_b32 s3, 144
 v_writelane_b32 v12, s3, 1
 s_mov_b32 s51, 0
 s_mov_b64 exec, 3
L_wb_148:
 buffer_load_dword v13, v12, s[96:99], 0 offen sc1
 s_waitcnt vmcnt(0)
 v_cmp_eq_u32 vcc, 0, v13
 s_cbranch_vccz L_wbd_149
 s_sleep 2
 s_add_u32 s51, s51, 1
 s_cmp_lt_u32 s51, 131072
 s_cbranch_scc1 L_wb_148
 s_branch L_bail
L_wbd_149:
 s_mov_b64 exec, -1
 v_readlane_b32 s81, v13, 1
 s_nop 3
 s_sub_u32 s81, s81, 1
 s_xor_b32 s78, s81, 0
 s_lshl_b32 s78, s78, 13
 s_xor_b32 s79, s78, 8192
 s_lshl_b32 s3, s52, 9
 s_lshr_b32 s100, s3, 13
 s_lshl_b32 s100, s100, 13
 s_add_u32 s3, s3, s100
 s_lshl_b32 s55, s53, 8
 s_add_u32 s3, s3, s55
 s_add_u32 s3, s3, s78
 s_add_u32 s3, s3, 98304
 v_mul_u32_u24 v5, 32768, v0
 v_add_u32 v5, s3, v5
 v_lshlrev_b32 v68, 8, v0
 v_and_b32 v10, 0xffffe000, v68
 v_add_u32 v68, v68, v10
 v_add_u32 v69, s79, v68
 v_add_u32 v68, s79, v68
 v_cmp_lt_u32 vcc, 55, v0
 s_nop 1
 v_cndmask_b32 v68, v68, v69, vcc
 s_mov_b32 s57, 0x3acccccd
 s_mov_b32 s58, 0x3727c5ac
 s_mov_b32 s62, 0x3f80
 s_mov_b32 s63, 0x3f800000
 v_mov_b32 v24, 0
 v_mov_b32 v25, 0
 v_mov_b32 v26, 0
 v_mov_b32 v27, 0
 v_mov_b32 v28, 0
 v_mov_b32 v29, 0
 v_mov_b32 v30, 0
 v_mov_b32 v31, 0
 v_mov_b32 v32, 0
 v_mov_b32 v33, 0
 v_mov_b32 v34, 0
 v_mov_b32 v35, 0
 s_mul_i32 s60, s52, 1280
 s_add_u32 s3, s60, 0
 s_cmp_eq_u32 s53, 0
 s_cselect_b32 s3, s3, 268435456
 buffer_load_dwordx2 v[176:177], v2, s[8:11], s3 offen offset:0
 buffer_load_dwordx2 v[178:179], v2, s[8:11], s3 offen offset:512
 buffer_load_dwordx2 v[180:181], v7, s[8:11], s3 offen offset:1024
 s_lshl_b32 s55, s54, 2
 v_mov_b32 v75, 0
 s_mov_b64 exec, 15
 buffer_atomic_add v75, v5, s[4:7], s55 offen offset:0 sc0
 s_mov_b64 exec, -1
 s_waitcnt vmcnt(0)
L_t4_loop:
 s_mov_b32 s51, 0
L_tw_150:
 v_cmp_gt_u32 vcc, 10, v75
 s_and_b32 s3, vcc_lo, 15
 s_cbranch_scc0 L_twd_151
 s_sleep 2
 s_lshl_b32 s55, s54, 2
 v_mov_b32 v75, 0
 s_mov_b64 exec, 15
 buffer_atomic_add v75, v5, s[4:7], s55 offen offset:0 sc0
 s_mov_b64 exec, -1
 s_waitcnt vmcnt(0)
 s_add_u32 s51, s51, 1
 s_cmp_lt_u32 s51, 131072
 s_cbranch_scc1 L_tw_150
 s_branch L_bail
L_twd_151:
 s_lshl_b32 s55, s53, 6
 s_add_u32 s55, s55, s54
 s_mul_i32 s55, s55, 327680
 s_mul_i32 s3, s52, 1280
 s_add_u32 s55, s55, s3
 s_add_u32 s55, s55, 150994944
 buffer_load_dwordx2 v[92:93], v2, s[4:7], s55 offen offset:0 sc1 nt
 buffer_load_dwordx2 v[94:95], v2, s[4:7], s55 offen offset:512 sc1 nt
 buffer_load_dwordx2 v[96:97], v7, s[4:7], s55 offen offset:1024 sc1 nt
 s_add_u32 s55, s55, 40960
 buffer_load_dwordx2 v[98:99], v2, s[4:7], s55 offen offset:0 sc1 nt
 buffer_load_dwordx2 v[100:101], v2, s[4:7], s55 offen offset:512 sc1 nt
 buffer_load_dwordx2 v[102:103], v7, s[4:7], s55 offen offset:1024 sc1 nt
 s_add_u32 s55, s55, 40960
 buffer_load_dwordx2 v[104:105], v2, s[4:7], s55 offen offset:0 sc1 nt
 buffer_load_dwordx2 v[106:107], v2, s[4:7], s55 offen offset:512 sc1 nt
 buffer_load_dwordx2 v[108:109], v7, s[4:7], s55 offen offset:1024 sc1 nt
 s_add_u32 s55, s55, 40960
 buffer_load_dwordx2 v[110:111], v2, s[4:7], s55 offen offset:0 sc1 nt
 buffer_load_dwordx2 v[112:113], v2, s[4:7], s55 offen offset:512 sc1 nt
 buffer_load_dwordx2 v[114:115], v7, s[4:7], s55 offen offset:1024 sc1 nt
 s_add_u32 s55, s55, 40960
 buffer_load_dwordx2 v[116:117], v2, s[4:7], s55 offen offset:0 sc1 nt
 buffer_load_dwordx2 v[118:119], v2, s[4:7], s55 offen offset:512 sc1 nt
 buffer_load_dwordx2 v[120:121], v7, s[4:7], s55 offen offset:1024 sc1 nt
 s_add_u32 s55, s55, 40960
 buffer_load_dwordx2 v[122:123], v2, s[4:7], s55 offen offset:0 sc1 nt
 buffer_load_dwordx2 v[124:125], v2, s[4:7], s55 offen offset:512 sc1 nt
 buffer_load_dwordx2 v[126:127], v7, s[4:7], s55 offen offset:1024 sc1 nt
 s_add_u32 s55, s55, 40960
 buffer_load_dwordx2 v[128:129], v2, s[4:7], s55 offen offset:0 sc1 nt
 buffer_load_dwordx2 v[130:131], v2, s[4:7], s55 offen offset:512 sc1 nt
 buffer_load_dwordx2 v[132:133], v7, s[4:7], s55 offen offset:1024 sc1 nt
 s_add_u32 s55, s55, 40960
 buffer_load_dwordx2 v[134:135], v2, s[4:7], s55 offen offset:0 sc1 nt
 buffer_load_dwordx2 v[136:137], v2, s[4:7], s55 offen offset:512 sc1 nt
 buffer_load_dwordx2 v[138:139], v7, s[4:7], s55 offen offset:1024 sc1 nt
 s_add_u32 s55, s55, 40960
 s_and_b32 s3, s54, 39
 s_cmp_lg_u32 s3, 32
 s_cbranch_scc1 L_yhd_153
 s_bfe_u32 s55, s54, 0x20003
 s_mov_b32 s51, 0
L_yh_152:
 ds_read_b32 v36, v73 offset:8
 s_waitcnt lgkmcnt(0)
 v_cmp_ge_u32 vcc, s55, v36
 s_cbranch_vccz L_yhd_153
 s_sleep 8
 s_add_u32 s51, s51, 1
 s_cmp_lt_u32 s51, 131072
 s_cbranch_scc1 L_yh_152
 s_branch L_bail
L_yhd_153:
 s_and_b32 s3, s54, 7
 s_lshl_b32 s3, s3, 3
 s_bfe_u32 s55, s54, 0x20003
 s_lshl_b32 s55, s55, 1
 s_add_u32 s3, s3, s55
 v_xor_b32 v36, s3, v72
 v_xor_b32 v37, 64, v36
 v_xor_b32 v38, 128, v36
 v_xor_b32 v39, 192, v36
 ds_read_u16_d16_hi v24, v36 offset:0
 ds_read_u16_d16_hi v25, v37 offset:0
 ds_read_u16_d16_hi v26, v38 offset:0
 ds_read_u16_d16_hi v27, v39 offset:0
 ds_read_u16_d16_hi v28, v36 offset:16384
 ds_read_u16_d16_hi v29, v37 offset:16384
 ds_read_u16_d16_hi v30, v38 offset:16384
 ds_read_u16_d16_hi v31, v39 offset:16384
 s_mov_b32 exec_hi, 0
 ds_read_u16_d16_hi v32, v36 offset:32768
 ds_read_u16_d16_hi v33, v37 offset:32768
 ds_read_u16_d16_hi v34, v38 offset:32768
 ds_read_u16_d16_hi v35, v39 offset:32768
 s_mov_b32 exec_hi, -1
 v_lshlrev_b32 v12, 16, v176
 v_and_b32 v13, 0xffff0000, v176
 v_lshlrev_b32 v14, 16, v177
 v_and_b32 v15, 0xffff0000, v177
 v_lshlrev_b32 v16, 16, v178
 v_and_b32 v17, 0xffff0000, v178
 v_lshlrev_b32 v18, 16, v179
 v_and_b32 v19, 0xffff0000, v179
 v_lshlrev_b32 v20, 16, v180
 v_and_b32 v21, 0xffff0000, v180
 v_lshlrev_b32 v22, 16, v181
 v_and_b32 v23, 0xffff0000, v181
 s_add_u32 s3, s60, 40960
 s_cmp_eq_u32 s53, 0
 s_cselect_b32 s3, s3, 268435456
 buffer_load_dwordx2 v[176:177], v2, s[8:11], s3 offen offset:0
 buffer_load_dwordx2 v[178:179], v2, s[8:11], s3 offen offset:512
 buffer_load_dwordx2 v[180:181], v7, s[8:11], s3 offen offset:1024
 s_and_b32 s56, s54, 15
 s_lshl_b32 s3, s61, 4
 s_add_u32 s56, s56, s3
 s_mul_i32 s56, s56, 1536
 s_add_u32 s56, s56, 81920
 v_add_u32 v3, s56, v2
 s_cmp_eq_u32 s53, 0
 s_cbranch_scc1 L_l0_154
 ds_read_b64 v[48:49], v3 offset:0
 ds_read_b64 v[50:51], v3 offset:512
 ds_read_b64 v[52:53], v3 offset:1024
 s_waitcnt lgkmcnt(0)
 v_lshlrev_b32 v12, 16, v48
 v_and_b32 v13, 0xffff0000, v48
 v_lshlrev_b32 v14, 16, v49
 v_and_b32 v15, 0xffff0000, v49
 v_lshlrev_b32 v16, 16, v50
 v_and_b32 v17, 0xffff0000, v50
 v_lshlrev_b32 v18, 16, v51
 v_and_b32 v19, 0xffff0000, v51
 v_lshlrev_b32 v20, 16, v52
 v_and_b32 v21, 0xffff0000, v52
 v_lshlrev_b32 v22, 16, v53
 v_and_b32 v23, 0xffff0000, v53
 s_add_u32 s3, s54, 1
 v_mov_b32 v10, s3
 ds_write_b32 v73, v10
L_l0_154:
 s_waitcnt vmcnt(24)
 v_lshlrev_b32 v80, 16, v92
 v_and_b32 v81, 0xffff0000, v92
 v_lshlrev_b32 v82, 16, v93
 v_and_b32 v83, 0xffff0000, v93
 v_lshlrev_b32 v84, 16, v94
 v_and_b32 v85, 0xffff0000, v94
 v_lshlrev_b32 v86, 16, v95
 v_and_b32 v87, 0xffff0000, v95
 v_lshlrev_b32 v88, 16, v96
 v_and_b32 v89, 0xffff0000, v96
 v_lshlrev_b32 v90, 16, v97
 v_and_b32 v91, 0xffff0000, v97
 s_waitcnt vmcnt(21)
 v_dot2c_f32_bf16 v80, s62, v98
 v_dot2c_f32_bf16 v81, s63, v98
 v_dot2c_f32_bf16 v82, s62, v99
 v_dot2c_f32_bf16 v83, s63, v99
 v_dot2c_f32_bf16 v84, s62, v100
 v_dot2c_f32_bf16 v85, s63, v100
 v_dot2c_f32_bf16 v86, s62, v101
 v_dot2c_f32_bf16 v87, s63, v101
 v_dot2c_f32_bf16 v88, s62, v102
 v_dot2c_f32_bf16 v89, s63, v102
 v_dot2c_f32_bf16 v90, s62, v103
 v_dot2c_f32_bf16 v91, s63, v103
 s_waitcnt vmcnt(18)
 v_dot2c_f32_bf16 v80, s62, v104
 v_dot2c_f32_bf16 v81, s63, v104
 v_dot2c_f32_bf16 v82, s62, v105
 v_dot2c_f32_bf16 v83, s63, v105
 v_dot2c_f32_bf16 v84, s62, v106
 v_dot2c_f32_bf16 v85, s63, v106
 v_dot2c_f32_bf16 v86, s62, v107
 v_dot2c_f32_bf16 v87, s63, v107
 v_dot2c_f32_bf16 v88, s62, v108
 v_dot2c_f32_bf16 v89, s63, v108
 v_dot2c_f32_bf16 v90, s62, v109
 v_dot2c_f32_bf16 v91, s63, v109
 s_waitcnt vmcnt(15)
 v_dot2c_f32_bf16 v80, s62, v110
 v_dot2c_f32_bf16 v81, s63, v110
 v_dot2c_f32_bf16 v82, s62, v111
 v_dot2c_f32_bf16 v83, s63, v111
 v_dot2c_f32_bf16 v84, s62, v112
 v_dot2c_f32_bf16 v85, s63, v112
 v_dot2c_f32_bf16 v86, s62, v113
 v_dot2c_f32_bf16 v87, s63, v113
 v_dot2c_f32_bf16 v88, s62, v114
 v_dot2c_f32_bf16 v89, s63, v114
 v_dot2c_f32_bf16 v90, s62, v115
 v_dot2c_f32_bf16 v91, s63, v115
 s_waitcnt vmcnt(12)
 v_dot2c_f32_bf16 v80, s62, v116
 v_dot2c_f32_bf16 v81, s63, v116
 v_dot2c_f32_bf16 v82, s62, v117
 v_dot2c_f32_bf16 v83, s63, v117
 v_dot2c_f32_bf16 v84, s62, v118
 v_dot2c_f32_bf16 v85, s63, v118
 v_dot2c_f32_bf16 v86, s62, v119
 v_dot2c_f32_bf16 v87, s63, v119
 v_dot2c_f32_bf16 v88, s62, v120
 v_dot2c_f32_bf16 v89, s63, v120
 v_dot2c_f32_bf16 v90, s62, v121
 v_dot2c_f32_bf16 v91, s63, v121
 s_waitcnt vmcnt(9)
 v_dot2c_f32_bf16 v80, s62, v122
 v_dot2c_f32_bf16 v81, s63, v122
 v_dot2c_f32_bf16 v82, s62, v123
 v_dot2c_f32_bf16 v83, s63, v123
 v_dot2c_f32_bf16 v84, s62, v124
 v_dot2c_f32_bf16 v85, s63, v124
 v_dot2c_f32_bf16 v86, s62, v125
 v_dot2c_f32_bf16 v87, s63, v125
 v_dot2c_f32_bf16 v88, s62, v126
 v_dot2c_f32_bf16 v89, s63, v126
 v_dot2c_f32_bf16 v90, s62, v127
 v_dot2c_f32_bf16 v91, s63, v127
 s_waitcnt vmcnt(6)
 v_dot2c_f32_bf16 v80, s62, v128
 v_dot2c_f32_bf16 v81, s63, v128
 v_dot2c_f32_bf16 v82, s62, v129
 v_dot2c_f32_bf16 v83, s63, v129
 v_dot2c_f32_bf16 v84, s62, v130
 v_dot2c_f32_bf16 v85, s63, v130
 v_dot2c_f32_bf16 v86, s62, v131
 v_dot2c_f32_bf16 v87, s63, v131
 v_dot2c_f32_bf16 v88, s62, v132
 v_dot2c_f32_bf16 v89, s63, v132
 v_dot2c_f32_bf16 v90, s62, v133
 v_dot2c_f32_bf16 v91, s63, v133
 s_waitcnt vmcnt(3)
 v_dot2c_f32_bf16 v80, s62, v134
 v_dot2c_f32_bf16 v81, s63, v134
 v_dot2c_f32_bf16 v82, s62, v135
 v_dot2c_f32_bf16 v83, s63, v135
 v_dot2c_f32_bf16 v84, s62, v136
 v_dot2c_f32_bf16 v85, s63, v136
 v_dot2c_f32_bf16 v86, s62, v137
 v_dot2c_f32_bf16 v87, s63, v137
 v_dot2c_f32_bf16 v88, s62, v138
 v_dot2c_f32_bf16 v89, s63, v138
 v_dot2c_f32_bf16 v90, s62, v139
 v_dot2c_f32_bf16 v91, s63, v139
 s_waitcnt lgkmcnt(0)
 s_nop 1
 v_cvt_pk_bf16_f32 v9, v80, v81
 v_lshlrev_b32 v80, 16, v9
 v_and_b32 v81, 0xffff0000, v9
 v_cvt_pk_bf16_f32 v9, v82, v83
 v_lshlrev_b32 v82, 16, v9
 v_and_b32 v83, 0xffff0000, v9
 v_cvt_pk_bf16_f32 v9, v84, v85
 v_lshlrev_b32 v84, 16, v9
 v_and_b32 v85, 0xffff0000, v9
 v_cvt_pk_bf16_f32 v9, v86, v87
 v_lshlrev_b32 v86, 16, v9
 v_and_b32 v87, 0xffff0000, v9
 v_cvt_pk_bf16_f32 v9, v88, v89
 v_lshlrev_b32 v88, 16, v9
 v_and_b32 v89, 0xffff0000, v9
 v_cvt_pk_bf16_f32 v9, v90, v91
 v_lshlrev_b32 v90, 16, v9
 v_and_b32 v91, 0xffff0000, v9
 v_pk_add_f32 v[12:13], v[12:13], v[80:81]
 v_pk_add_f32 v[14:15], v[14:15], v[82:83]
 v_pk_add_f32 v[16:17], v[16:17], v[84:85]
 v_pk_add_f32 v[18:19], v[18:19], v[86:87]
 v_pk_add_f32 v[20:21], v[20:21], v[88:89]
 v_pk_add_f32 v[22:23], v[22:23], v[90:91]
 v_cvt_pk_bf16_f32 v9, v12, v13
 v_lshlrev_b32 v12, 16, v9
 v_and_b32 v13, 0xffff0000, v9
 v_cvt_pk_bf16_f32 v9, v14, v15
 v_lshlrev_b32 v14, 16, v9
 v_and_b32 v15, 0xffff0000, v9
 v_cvt_pk_bf16_f32 v9, v16, v17
 v_lshlrev_b32 v16, 16, v9
 v_and_b32 v17, 0xffff0000, v9
 v_cvt_pk_bf16_f32 v9, v18, v19
 v_lshlrev_b32 v18, 16, v9
 v_and_b32 v19, 0xffff0000, v9
 v_cvt_pk_bf16_f32 v9, v20, v21
 v_lshlrev_b32 v20, 16, v9
 v_and_b32 v21, 0xffff0000, v9
 v_cvt_pk_bf16_f32 v9, v22, v23
 v_lshlrev_b32 v22, 16, v9
 v_and_b32 v23, 0xffff0000, v9
 v_readfirstlane_b32 s3, v12
 s_nop 1
 v_subrev_f32 v36, s3, v12
 v_subrev_f32 v37, s3, v13
 v_subrev_f32 v38, s3, v14
 v_subrev_f32 v39, s3, v15
 v_subrev_f32 v40, s3, v16
 v_subrev_f32 v41, s3, v17
 v_subrev_f32 v42, s3, v18
 v_subrev_f32 v43, s3, v19
 v_mov_b32 v44, 0
 v_mov_b32 v45, 0
 v_mov_b32 v46, 0
 v_mov_b32 v47, 0
 s_mov_b32 exec_hi, 0
 v_subrev_f32 v44, s3, v20
 v_subrev_f32 v45, s3, v21
 v_subrev_f32 v46, s3, v22
 v_subrev_f32 v47, s3, v23
 s_mov_b32 exec_hi, -1
 v_pk_mul_f32 v[10:11], v[36:37], v[36:37]
 v_pk_fma_f32 v[10:11], v[38:39], v[38:39], v[10:11]
 v_pk_fma_f32 v[10:11], v[40:41], v[40:41], v[10:11]
 v_pk_fma_f32 v[10:11], v[42:43], v[42:43], v[10:11]
 v_pk_fma_f32 v[10:11], v[44:45], v[44:45], v[10:11]
 v_pk_fma_f32 v[10:11], v[46:47], v[46:47], v[10:11]
 v_pk_add_f32 v[36:37], v[36:37], v[38:39]
 v_pk_add_f32 v[36:37], v[36:37], v[40:41]
 v_pk_add_f32 v[36:37], v[36:37], v[42:43]
 v_pk_add_f32 v[36:37], v[36:37], v[44:45]
 v_pk_add_f32 v[36:37], v[36:37], v[46:47]
 v_add_f32 v11, v10, v11
 v_add_f32 v10, v36, v37
 s_nop 0
 v_add_f32_dpp v11, v11, v11 quad_perm:[1,0,3,2] row_mask:0xf bank_mask:0xf
 v_add_f32_dpp v10, v10, v10 quad_perm:[1,0,3,2] row_mask:0xf bank_mask:0xf
 s_nop 0
 v_add_f32_dpp v11, v11, v11 quad_perm:[2,3,0,1] row_mask:0xf bank_mask:0xf
 v_add_f32_dpp v10, v10, v10 quad_perm:[2,3,0,1] row_mask:0xf bank_mask:0xf
 s_nop 0
 v_add_f32_dpp v11, v11, v11 row_half_mirror row_mask:0xf bank_mask:0xf
 v_add_f32_dpp v10, v10, v10 row_half_mirror row_mask:0xf bank_mask:0xf
 s_nop 0
 v_add_f32_dpp v11, v11, v11 row_mirror row_mask:0xf bank_mask:0xf
 v_add_f32_dpp v10, v10, v10 row_mirror row_mask:0xf bank_mask:0xf
 v_mov_b32 v37, v11
 v_mov_b32 v36, v10
 s_nop 0
 v_permlane16_swap_b32 v11, v37
 v_permlane16_swap_b32 v10, v36
 v_pk_add_f32 v[10:11], v[10:11], v[36:37]
 v_mov_b32 v37, v11
 v_mov_b32 v36, v10
 s_nop 0
 v_permlane32_swap_b32 v11, v37
 v_permlane32_swap_b32 v10, v36
 v_pk_add_f32 v[10:11], v[10:11], v[36:37]
 v_mul_f32 v10, s57, v10
 v_mul_f32 v11, s57, v11
 v_fma_f32 v11, -v10, v10, v11
 v_max_f32 v11, 0, v11
 v_add_f32 v10, s3, v10
 v_cvt_pk_bf16_f32 v9, v10, v11
 v_lshlrev_b32 v10, 16, v9
 v_and_b32 v11, 0xffff0000, v9
 v_add_f32 v11, s58, v11
 v_cvt_pk_bf16_f32 v11, v11, v11
 v_and_b32 v11, 0xffff0000, v11
 v_sqrt_f32 v11, v11
 s_nop 0
 v_pk_add_f32 v[36:37], v[12:13], v[10:11] op_sel_hi:[1,0] neg_lo:[0,1] neg_hi:[0,1]
 v_pk_add_f32 v[38:39], v[14:15], v[10:11] op_sel_hi:[1,0] neg_lo:[0,1] neg_hi:[0,1]
 v_pk_add_f32 v[40:41], v[16:17], v[10:11] op_sel_hi:[1,0] neg_lo:[0,1] neg_hi:[0,1]
 v_pk_add_f32 v[42:43], v[18:19], v[10:11] op_sel_hi:[1,0] neg_lo:[0,1] neg_hi:[0,1]
 v_pk_add_f32 v[44:45], v[20:21], v[10:11] op_sel_hi:[1,0] neg_lo:[0,1] neg_hi:[0,1]
 v_pk_add_f32 v[46:47], v[22:23], v[10:11] op_sel_hi:[1,0] neg_lo:[0,1] neg_hi:[0,1]
 v_cvt_pk_bf16_f32 v11, v11, v11
 v_and_b32 v11, 0xffff0000, v11
 v_rcp_f32 v11, v11
 v_cvt_pk_bf16_f32 v9, v36, v37
 v_lshlrev_b32 v36, 16, v9
 v_and_b32 v37, 0xffff0000, v9
 v_cvt_pk_bf16_f32 v9, v38, v39
 v_lshlrev_b32 v38, 16, v9
 v_and_b32 v39, 0xffff0000, v9
 v_cvt_pk_bf16_f32 v9, v40, v41
 v_lshlrev_b32 v40, 16, v9
 v_and_b32 v41, 0xffff0000, v9
 v_cvt_pk_bf16_f32 v9, v42, v43
 v_lshlrev_b32 v42, 16, v9
 v_and_b32 v43, 0xffff0000, v9
 v_cvt_pk_bf16_f32 v9, v44, v45
 v_lshlrev_b32 v44, 16, v9
 v_and_b32 v45, 0xffff0000, v9
 v_cvt_pk_bf16_f32 v9, v46, v47
 v_lshlrev_b32 v46, 16, v9
 v_and_b32 v47, 0xffff0000, v9
 v_pk_mul_f32 v[36:37], v[36:37], v[10:11] op_sel:[0,1] op_sel_hi:[1,1]
 v_pk_mul_f32 v[38:39], v[38:39], v[10:11] op_sel:[0,1] op_sel_hi:[1,1]
 v_pk_mul_f32 v[40:41], v[40:41], v[10:11] op_sel:[0,1] op_sel_hi:[1,1]
 v_pk_mul_f32 v[42:43], v[42:43], v[10:11] op_sel:[0,1] op_sel_hi:[1,1]
 v_pk_mul_f32 v[44:45], v[44:45], v[10:11] op_sel:[0,1] op_sel_hi:[1,1]
 v_pk_mul_f32 v[46:47], v[46:47], v[10:11] op_sel:[0,1] op_sel_hi:[1,1]
 v_cvt_pk_bf16_f32 v9, v36, v37
 v_lshlrev_b32 v36, 16, v9
 v_and_b32 v37, 0xffff0000, v9
 v_cvt_pk_bf16_f32 v9, v38, v39
 v_lshlrev_b32 v38, 16, v9
 v_and_b32 v39, 0xffff0000, v9
 v_cvt_pk_bf16_f32 v9, v40, v41
 v_lshlrev_b32 v40, 16, v9
 v_and_b32 v41, 0xffff0000, v9
 v_cvt_pk_bf16_f32 v9, v42, v43
 v_lshlrev_b32 v42, 16, v9
 v_and_b32 v43, 0xffff0000, v9
 v_cvt_pk_bf16_f32 v9, v44, v45
 v_lshlrev_b32 v44, 16, v9
 v_and_b32 v45, 0xffff0000, v9
 v_cvt_pk_bf16_f32 v9, v46, v47
 v_lshlrev_b32 v46, 16, v9
 v_and_b32 v47, 0xffff0000, v9
 v_pk_mul_f32 v[36:37], v[36:37], v[24:25]
 v_pk_mul_f32 v[38:39], v[38:39], v[26:27]
 v_pk_mul_f32 v[40:41], v[40:41], v[28:29]
 v_pk_mul_f32 v[42:43], v[42:43], v[30:31]
 v_pk_mul_f32 v[44:45], v[44:45], v[32:33]
 v_pk_mul_f32 v[46:47], v[46:47], v[34:35]
 v_cvt_pk_bf16_f32 v9, v36, v37
 v_lshlrev_b32 v36, 16, v9
 v_and_b32 v37, 0xffff0000, v9
 v_cvt_pk_bf16_f32 v9, v38, v39
 v_lshlrev_b32 v38, 16, v9
 v_and_b32 v39, 0xffff0000, v9
 v_cvt_pk_bf16_f32 v9, v40, v41
 v_lshlrev_b32 v40, 16, v9
 v_and_b32 v41, 0xffff0000, v9
 v_cvt_pk_bf16_f32 v9, v42, v43
 v_lshlrev_b32 v42, 16, v9
 v_and_b32 v43, 0xffff0000, v9
 v_cvt_pk_bf16_f32 v9, v44, v45
 v_lshlrev_b32 v44, 16, v9
 v_and_b32 v45, 0xffff0000, v9
 v_cvt_pk_bf16_f32 v9, v46, v47
 v_lshlrev_b32 v46, 16, v9
 v_and_b32 v47, 0xffff0000, v9
 v_pk_add_f32 v[12:13], v[12:13], v[36:37]
 v_pk_add_f32 v[14:15], v[14:15], v[38:39]
 v_pk_add_f32 v[16:17], v[16:17], v[40:41]
 v_pk_add_f32 v[18:19], v[18:19], v[42:43]
 v_pk_add_f32 v[20:21], v[20:21], v[44:45]
 v_pk_add_f32 v[22:23], v[22:23], v[46:47]
 v_cvt_pk_bf16_f32 v60, v12, v13
 v_cvt_pk_bf16_f32 v61, v14, v15
 v_cvt_pk_bf16_f32 v62, v16, v17
 v_cvt_pk_bf16_f32 v63, v18, v19
 v_cvt_pk_bf16_f32 v64, v20, v21
 v_cvt_pk_bf16_f32 v65, v22, v23
 s_cmp_lg_u32 s53, 0
 s_cbranch_scc1 L_l1_155
 s_cmp_lt_u32 s54, 16
 s_cbranch_scc1 L_rgd_158
 s_sub_u32 s55, s54, 15
 s_mov_b32 s51, 0
L_rg_157:
 ds_read_b32 v10, v73
 s_waitcnt lgkmcnt(0)
 v_cmp_gt_u32 vcc, s55, v10
 s_cbranch_vccz L_rgd_158
 s_sleep 8
 s_add_u32 s51, s51, 1
 s_cmp_lt_u32 s51, 131072
 s_cbranch_scc1 L_rg_157
 s_branch L_bail
L_rgd_158:
 ds_write_b64 v3, v[60:61] offset:0
 ds_write_b64 v3, v[62:63] offset:512
 ds_write_b64 v3, v[64:65] offset:1024
 v_lshlrev_b32 v12, 16, v60
 v_and_b32 v13, 0xffff0000, v60
 v_lshlrev_b32 v14, 16, v61
 v_and_b32 v15, 0xffff0000, v61
 v_lshlrev_b32 v16, 16, v62
 v_and_b32 v17, 0xffff0000, v62
 v_lshlrev_b32 v18, 16, v63
 v_and_b32 v19, 0xffff0000, v63
 v_lshlrev_b32 v20, 16, v64
 v_and_b32 v21, 0xffff0000, v64
 v_lshlrev_b32 v22, 16, v65
 v_and_b32 v23, 0xffff0000, v65
 s_nop 0
 v_readfirstlane_b32 s3, v12
 s_nop 1
 v_subrev_f32 v36, s3, v12
 v_subrev_f32 v37, s3, v13
 v_subrev_f32 v38, s3, v14
 v_subrev_f32 v39, s3, v15
 v_subrev_f32 v40, s3, v16
 v_subrev_f32 v41, s3, v17
 v_subrev_f32 v42, s3, v18
 v_subrev_f32 v43, s3, v19
 v_mov_b32 v44, 0
 v_mov_b32 v45, 0
 v_mov_b32 v46, 0
 v_mov_b32 v47, 0
 s_mov_b32 exec_hi, 0
 v_subrev_f32 v44, s3, v20
 v_subrev_f32 v45, s3, v21
 v_subrev_f32 v46, s3, v22
 v_subrev_f32 v47, s3, v23
 s_mov_b32 exec_hi, -1
 v_pk_mul_f32 v[10:11], v[36:37], v[36:37]
 v_pk_fma_f32 v[10:11], v[38:39], v[38:39], v[10:11]
 v_pk_fma_f32 v[10:11], v[40:41], v[40:41], v[10:11]
 v_pk_fma_f32 v[10:11], v[42:43], v[42:43], v[10:11]
 v_pk_fma_f32 v[10:11], v[44:45], v[44:45], v[10:11]
 v_pk_fma_f32 v[10:11], v[46:47], v[46:47], v[10:11]
 v_pk_add_f32 v[36:37], v[36:37], v[38:39]
 v_pk_add_f32 v[36:37], v[36:37], v[40:41]
 v_pk_add_f32 v[36:37], v[36:37], v[42:43]
 v_pk_add_f32 v[36:37], v[36:37], v[44:45]
 v_pk_add_f32 v[36:37], v[36:37], v[46:47]
 v_add_f32 v11, v10, v11
 v_add_f32 v10, v36, v37
 s_nop 0
 v_add_f32_dpp v11, v11, v11 quad_perm:[1,0,3,2] row_mask:0xf bank_mask:0xf
 v_add_f32_dpp v10, v10, v10 quad_perm:[1,0,3,2] row_mask:0xf bank_mask:0xf
 s_nop 0
 v_add_f32_dpp v11, v11, v11 quad_perm:[2,3,0,1] row_mask:0xf bank_mask:0xf
 v_add_f32_dpp v10, v10, v10 quad_perm:[2,3,0,1] row_mask:0xf bank_mask:0xf
 s_nop 0
 v_add_f32_dpp v11, v11, v11 row_half_mirror row_mask:0xf bank_mask:0xf
 v_add_f32_dpp v10, v10, v10 row_half_mirror row_mask:0xf bank_mask:0xf
 s_nop 0
 v_add_f32_dpp v11, v11, v11 row_mirror row_mask:0xf bank_mask:0xf
 v_add_f32_dpp v10, v10, v10 row_mirror row_mask:0xf bank_mask:0xf
 v_mov_b32 v37, v11
 v_mov_b32 v36, v10
 s_nop 0
 v_permlane16_swap_b32 v11, v37
 v_permlane16_swap_b32 v10, v36
 v_pk_add_f32 v[10:11], v[10:11], v[36:37]
 v_mov_b32 v37, v11
 v_mov_b32 v36, v10
 s_nop 0
 v_permlane32_swap_b32 v11, v37
 v_permlane32_swap_b32 v10, v36
 v_pk_add_f32 v[10:11], v[10:11], v[36:37]
 v_mul_f32 v10, s57, v10
 v_mul_f32 v11, s57, v11
 v_fma_f32 v11, -v10, v10, v11
 v_max_f32 v11, 0, v11
 v_add_f32 v10, s3, v10
 v_cvt_pk_bf16_f32 v9, v10, v11
 v_lshlrev_b32 v10, 16, v9
 v_and_b32 v11, 0xffff0000, v9
 v_add_f32 v11, s58, v11
 v_cvt_pk_bf16_f32 v11, v11, v11
 v_and_b32 v11, 0xffff0000, v11
 v_sqrt_f32 v11, v11
 s_nop 0
 v_pk_add_f32 v[36:37], v[12:13], v[10:11] op_sel_hi:[1,0] neg_lo:[0,1] neg_hi:[0,1]
 v_pk_add_f32 v[38:39], v[14:15], v[10:11] op_sel_hi:[1,0] neg_lo:[0,1] neg_hi:[0,1]
 v_pk_add_f32 v[40:41], v[16:17], v[10:11] op_sel_hi:[1,0] neg_lo:[0,1] neg_hi:[0,1]
 v_pk_add_f32 v[42:43], v[18:19], v[10:11] op_sel_hi:[1,0] neg_lo:[0,1] neg_hi:[0,1]
 v_pk_add_f32 v[44:45], v[20:21], v[10:11] op_sel_hi:[1,0] neg_lo:[0,1] neg_hi:[0,1]
 v_pk_add_f32 v[46:47], v[22:23], v[10:11] op_sel_hi:[1,0] neg_lo:[0,1] neg_hi:[0,1]
 v_cvt_pk_bf16_f32 v11, v11, v11
 v_and_b32 v11, 0xffff0000, v11
 v_rcp_f32 v11, v11
 v_cvt_pk_bf16_f32 v9, v36, v37
 v_lshlrev_b32 v36, 16, v9
 v_and_b32 v37, 0xffff0000, v9
 v_cvt_pk_bf16_f32 v9, v38, v39
 v_lshlrev_b32 v38, 16, v9
 v_and_b32 v39, 0xffff0000, v9
 v_cvt_pk_bf16_f32 v9, v40, v41
 v_lshlrev_b32 v40, 16, v9
 v_and_b32 v41, 0xffff0000, v9
 v_cvt_pk_bf16_f32 v9, v42, v43
 v_lshlrev_b32 v42, 16, v9
 v_and_b32 v43, 0xffff0000, v9
 v_cvt_pk_bf16_f32 v9, v44, v45
 v_lshlrev_b32 v44, 16, v9
 v_and_b32 v45, 0xffff0000, v9
 v_cvt_pk_bf16_f32 v9, v46, v47
 v_lshlrev_b32 v46, 16, v9
 v_and_b32 v47, 0xffff0000, v9
 v_pk_mul_f32 v[36:37], v[36:37], v[10:11] op_sel:[0,1] op_sel_hi:[1,1]
 v_pk_mul_f32 v[38:39], v[38:39], v[10:11] op_sel:[0,1] op_sel_hi:[1,1]
 v_pk_mul_f32 v[40:41], v[40:41], v[10:11] op_sel:[0,1] op_sel_hi:[1,1]
 v_pk_mul_f32 v[42:43], v[42:43], v[10:11] op_sel:[0,1] op_sel_hi:[1,1]
 v_pk_mul_f32 v[44:45], v[44:45], v[10:11] op_sel:[0,1] op_sel_hi:[1,1]
 v_pk_mul_f32 v[46:47], v[46:47], v[10:11] op_sel:[0,1] op_sel_hi:[1,1]
 v_cvt_pk_bf16_f32 v48, v36, v37
 v_cvt_pk_bf16_f32 v49, v38, v39
 v_cvt_pk_bf16_f32 v50, v40, v41
 v_cvt_pk_bf16_f32 v51, v42, v43
 v_cvt_pk_bf16_f32 v52, v44, v45
 v_cvt_pk_bf16_f32 v53, v46, v47
 s_add_u32 s3, s60, 195559424
 buffer_store_dwordx2 v[48:49], v4, s[4:7], s3 offen offset:0 sc1
 buffer_store_dwordx2 v[50:51], v4, s[4:7], s3 offen offset:512 sc1
 buffer_store_dwordx2 v[52:53], v8, s[4:7], s3 offen offset:1024 sc1
 s_lshl_b32 s55, s54, 2
 v_mov_b32 v75, 0
 s_mov_b64 exec, 15
 buffer_atomic_add v75, v5, s[4:7], s55 offen offset:4 sc0
 s_mov_b64 exec, -1
 s_waitcnt vmcnt(1) lgkmcnt(0)
 s_and_b32 s55, s52, 3
 s_mul_i32 s55, s55, 49152
 s_lshl_b32 s3, s54, 2
 s_add_u32 s3, s3, s55
 s_add_u32 s3, s3, 229376
 v_mov_b32 v3, 1
 s_mov_b64 exec, -1
 buffer_atomic_add v3, v68, s[4:7], s3 offen
 s_mov_b64 exec, -1
 s_add_u32 s3, s3, 32768
 v_mov_b32 v3, 1
 s_mov_b32 exec_hi, 0
 buffer_atomic_add v3, v69, s[4:7], s3 offen
 s_mov_b64 exec, -1
 s_waitcnt vmcnt(2)
 s_branch L_le_156
L_l1_155:
 buffer_store_dwordx2 v[60:61], v2, s[12:15], s60 offen offset:0 nt
 buffer_store_dwordx2 v[62:63], v2, s[12:15], s60 offen offset:512 nt
 buffer_store_dwordx2 v[64:65], v7, s[12:15], s60 offen offset:1024 nt
 s_lshl_b32 s55, s54, 2
 v_mov_b32 v75, 0
 s_mov_b64 exec, 15
 buffer_atomic_add v75, v5, s[4:7], s55 offen offset:4 sc0
 s_mov_b64 exec, -1
 s_cmp_lg_u32 s54, 7
 s_cbranch_scc1 L_yn_160
 ds_write_b16 v74, a0 offset:0
 ds_write_b16 v74, a2 offset:8
 ds_write_b16 v74, a4 offset:1024
 ds_write_b16 v74, a6 offset:1032
 ds_write_b16 v74, a8 offset:2048
 ds_write_b16 v74, a10 offset:2056
 ds_write_b16 v74, a12 offset:3072
 ds_write_b16 v74, a14 offset:3080
 ds_write_b16 v74, a16 offset:4096
 ds_write_b16 v74, a18 offset:4104
 ds_write_b16 v74, a20 offset:5120
 ds_write_b16 v74, a22 offset:5128
 ds_write_b16 v74, a24 offset:6144
 ds_write_b16 v74, a26 offset:6152
 ds_write_b16 v74, a28 offset:7168
 ds_write_b16 v74, a30 offset:7176
 ds_write_b16 v74, a32 offset:8192
 ds_write_b16 v74, a34 offset:8200
 ds_write_b16 v74, a36 offset:9216
 ds_write_b16 v74, a38 offset:9224
 ds_write_b16 v74, a40 offset:10240
 ds_write_b16 v74, a42 offset:10248
 ds_write_b16 v74, a44 offset:11264
 ds_write_b16 v74, a46 offset:11272
 ds_write_b16 v74, a48 offset:12288
 ds_write_b16 v74, a50 offset:12296
 ds_write_b16 v74, a52 offset:13312
 ds_write_b16 v74, a54 offset:13320
 ds_write_b16 v74, a56 offset:14336
 ds_write_b16 v74, a58 offset:14344
 ds_write_b16 v74, a60 offset:15360
 ds_write_b16 v74, a62 offset:15368
 ds_write_b16 v74, a64 offset:16384
 ds_write_b16 v74, a66 offset:16392
 ds_write_b16 v74, a68 offset:17408
 ds_write_b16 v74, a70 offset:17416
 ds_write_b16 v74, a72 offset:18432
 ds_write_b16 v74, a74 offset:18440
 ds_write_b16 v74, a76 offset:19456
 ds_write_b16 v74, a78 offset:19464
 ds_write_b16 v74, a80 offset:20480
 ds_write_b16 v74, a82 offset:20488
 ds_write_b16 v74, a84 offset:21504
 ds_write_b16 v74, a86 offset:21512
 ds_write_b16 v74, a88 offset:22528
 ds_write_b16 v74, a90 offset:22536
 ds_write_b16 v74, a92 offset:23552
 ds_write_b16 v74, a94 offset:23560
 ds_write_b16 v74, a96 offset:24576
 ds_write_b16 v74, a98 offset:24584
 ds_write_b16 v74, a100 offset:25600
 ds_write_b16 v74, a102 offset:25608
 ds_write_b16 v74, a104 offset:26624
 ds_write_b16 v74, a106 offset:26632
 ds_write_b16 v74, a108 offset:27648
 ds_write_b16 v74, a110 offset:27656
 ds_write_b16 v74, a112 offset:28672
 ds_write_b16 v74, a114 offset:28680
 ds_write_b16 v74, a116 offset:29696
 ds_write_b16 v74, a118 offset:29704
 ds_write_b16 v74, a120 offset:30720
 ds_write_b16 v74, a122 offset:30728
 ds_write_b16 v74, a124 offset:31744
 ds_write_b16 v74, a126 offset:31752
 ds_write_b16 v74, a128 offset:32768
 ds_write_b16 v74, a130 offset:32776
 ds_write_b16 v74, a132 offset:33792
 ds_write_b16 v74, a134 offset:33800
 ds_write_b16 v74, a136 offset:34816
 ds_write_b16 v74, a138 offset:34824
 ds_write_b16 v74, a140 offset:35840
 ds_write_b16 v74, a142 offset:35848
 ds_write_b16 v74, a144 offset:36864
 ds_write_b16 v74, a146 offset:36872
 ds_write_b16 v74, a148 offset:37888
 ds_write_b16 v74, a150 offset:37896
 ds_write_b16 v74, a152 offset:38912
 ds_write_b16 v74, a154 offset:38920
 ds_write_b16 v74, a156 offset:39936
 ds_write_b16 v74, a158 offset:39944
 v_mov_b32 v10, 1
 ds_write_b32 v73, v10 offset:8
 s_branch L_yc_159
L_yn_160:
 s_cmp_lg_u32 s54, 15
 s_cbranch_scc1 L_yn_161
 ds_write_b16_d16_hi v74, a0 offset:2
 ds_write_b16_d16_hi v74, a2 offset:10
 ds_write_b16_d16_hi v74, a4 offset:1026
 ds_write_b16_d16_hi v74, a6 offset:1034
 ds_write_b16_d16_hi v74, a8 offset:2050
 ds_write_b16_d16_hi v74, a10 offset:2058
 ds_write_b16_d16_hi v74, a12 offset:3074
 ds_write_b16_d16_hi v74, a14 offset:3082
 ds_write_b16_d16_hi v74, a16 offset:4098
 ds_write_b16_d16_hi v74, a18 offset:4106
 ds_write_b16_d16_hi v74, a20 offset:5122
 ds_write_b16_d16_hi v74, a22 offset:5130
 ds_write_b16_d16_hi v74, a24 offset:6146
 ds_write_b16_d16_hi v74, a26 offset:6154
 ds_write_b16_d16_hi v74, a28 offset:7170
 ds_write_b16_d16_hi v74, a30 offset:7178
 ds_write_b16_d16_hi v74, a32 offset:8194
 ds_write_b16_d16_hi v74, a34 offset:8202
 ds_write_b16_d16_hi v74, a36 offset:9218
 ds_write_b16_d16_hi v74, a38 offset:9226
 ds_write_b16_d16_hi v74, a40 offset:10242
 ds_write_b16_d16_hi v74, a42 offset:10250
 ds_write_b16_d16_hi v74, a44 offset:11266
 ds_write_b16_d16_hi v74, a46 offset:11274
 ds_write_b16_d16_hi v74, a48 offset:12290
 ds_write_b16_d16_hi v74, a50 offset:12298
 ds_write_b16_d16_hi v74, a52 offset:13314
 ds_write_b16_d16_hi v74, a54 offset:13322
 ds_write_b16_d16_hi v74, a56 offset:14338
 ds_write_b16_d16_hi v74, a58 offset:14346
 ds_write_b16_d16_hi v74, a60 offset:15362
 ds_write_b16_d16_hi v74, a62 offset:15370
 ds_write_b16_d16_hi v74, a64 offset:16386
 ds_write_b16_d16_hi v74, a66 offset:16394
 ds_write_b16_d16_hi v74, a68 offset:17410
 ds_write_b16_d16_hi v74, a70 offset:17418
 ds_write_b16_d16_hi v74, a72 offset:18434
 ds_write_b16_d16_hi v74, a74 offset:18442
 ds_write_b16_d16_hi v74, a76 offset:19458
 ds_write_b16_d16_hi v74, a78 offset:19466
 ds_write_b16_d16_hi v74, a80 offset:20482
 ds_write_b16_d16_hi v74, a82 offset:20490
 ds_write_b16_d16_hi v74, a84 offset:21506
 ds_write_b16_d16_hi v74, a86 offset:21514
 ds_write_b16_d16_hi v74, a88 offset:22530
 ds_write_b16_d16_hi v74, a90 offset:22538
 ds_write_b16_d16_hi v74, a92 offset:23554
 ds_write_b16_d16_hi v74, a94 offset:23562
 ds_write_b16_d16_hi v74, a96 offset:24578
 ds_write_b16_d16_hi v74, a98 offset:24586
 ds_write_b16_d16_hi v74, a100 offset:25602
 ds_write_b16_d16_hi v74, a102 offset:25610
 ds_write_b16_d16_hi v74, a104 offset:26626
 ds_write_b16_d16_hi v74, a106 offset:26634
 ds_write_b16_d16_hi v74, a108 offset:27650
 ds_write_b16_d16_hi v74, a110 offset:27658
 ds_write_b16_d16_hi v74, a112 offset:28674
 ds_write_b16_d16_hi v74, a114 offset:28682
 ds_write_b16_d16_hi v74, a116 offset:29698
 ds_write_b16_d16_hi v74, a118 offset:29706
 ds_write_b16_d16_hi v74, a120 offset:30722
 ds_write_b16_d16_hi v74, a122 offset:30730
 ds_write_b16_d16_hi v74, a124 offset:31746
 ds_write_b16_d16_hi v74, a126 offset:31754
 ds_write_b16_d16_hi v74, a128 offset:32770
 ds_write_b16_d16_hi v74, a130 offset:32778
 ds_write_b16_d16_hi v74, a132 offset:33794
 ds_write_b16_d16_hi v74, a134 offset:33802
 ds_write_b16_d16_hi v74, a136 offset:34818
 ds_write_b16_d16_hi v74, a138 offset:34826
 ds_write_b16_d16_hi v74, a140 offset:35842
 ds_write_b16_d16_hi v74, a142 offset:35850
 ds_write_b16_d16_hi v74, a144 offset:36866
 ds_write_b16_d16_hi v74, a146 offset:36874
 ds_write_b16_d16_hi v74, a148 offset:37890
 ds_write_b16_d16_hi v74, a150 offset:37898
 ds_write_b16_d16_hi v74, a152 offset:38914
 ds_write_b16_d16_hi v74, a154 offset:38922
 ds_write_b16_d16_hi v74, a156 offset:39938
 ds_write_b16_d16_hi v74, a158 offset:39946
 v_mov_b32 v10, 2
 ds_write_b32 v73, v10 offset:8
 s_branch L_yc_159
L_yn_161:
 s_cmp_lg_u32 s54, 23
 s_cbranch_scc1 L_yn_162
 ds_write_b16 v74, a1 offset:4
 ds_write_b16 v74, a3 offset:12
 ds_write_b16 v74, a5 offset:1028
 ds_write_b16 v74, a7 offset:1036
 ds_write_b16 v74, a9 offset:2052
 ds_write_b16 v74, a11 offset:2060
 ds_write_b16 v74, a13 offset:3076
 ds_write_b16 v74, a15 offset:3084
 ds_write_b16 v74, a17 offset:4100
 ds_write_b16 v74, a19 offset:4108
 ds_write_b16 v74, a21 offset:5124
 ds_write_b16 v74, a23 offset:5132
 ds_write_b16 v74, a25 offset:6148
 ds_write_b16 v74, a27 offset:6156
 ds_write_b16 v74, a29 offset:7172
 ds_write_b16 v74, a31 offset:7180
 ds_write_b16 v74, a33 offset:8196
 ds_write_b16 v74, a35 offset:8204
 ds_write_b16 v74, a37 offset:9220
 ds_write_b16 v74, a39 offset:9228
 ds_write_b16 v74, a41 offset:10244
 ds_write_b16 v74, a43 offset:10252
 ds_write_b16 v74, a45 offset:11268
 ds_write_b16 v74, a47 offset:11276
 ds_write_b16 v74, a49 offset:12292
 ds_write_b16 v74, a51 offset:12300
 ds_write_b16 v74, a53 offset:13316
 ds_write_b16 v74, a55 offset:13324
 ds_write_b16 v74, a57 offset:14340
 ds_write_b16 v74, a59 offset:14348
 ds_write_b16 v74, a61 offset:15364
 ds_write_b16 v74, a63 offset:15372
 ds_write_b16 v74, a65 offset:16388
 ds_write_b16 v74, a67 offset:16396
 ds_write_b16 v74, a69 offset:17412
 ds_write_b16 v74, a71 offset:17420
 ds_write_b16 v74, a73 offset:18436
 ds_write_b16 v74, a75 offset:18444
 ds_write_b16 v74, a77 offset:19460
 ds_write_b16 v74, a79 offset:19468
 ds_write_b16 v74, a81 offset:20484
 ds_write_b16 v74, a83 offset:20492
 ds_write_b16 v74, a85 offset:21508
 ds_write_b16 v74, a87 offset:21516
 ds_write_b16 v74, a89 offset:22532
 ds_write_b16 v74, a91 offset:22540
 ds_write_b16 v74, a93 offset:23556
 ds_write_b16 v74, a95 offset:23564
 ds_write_b16 v74, a97 offset:24580
 ds_write_b16 v74, a99 offset:24588
 ds_write_b16 v74, a101 offset:25604
 ds_write_b16 v74, a103 offset:25612
 ds_write_b16 v74, a105 offset:26628
 ds_write_b16 v74, a107 offset:26636
 ds_write_b16 v74, a109 offset:27652
 ds_write_b16 v74, a111 offset:27660
 ds_write_b16 v74, a113 offset:28676
 ds_write_b16 v74, a115 offset:28684
 ds_write_b16 v74, a117 offset:29700
 ds_write_b16 v74, a119 offset:29708
 ds_write_b16 v74, a121 offset:30724
 ds_write_b16 v74, a123 offset:30732
 ds_write_b16 v74, a125 offset:31748
 ds_write_b16 v74, a127 offset:31756
 ds_write_b16 v74, a129 offset:32772
 ds_write_b16 v74, a131 offset:32780
 ds_write_b16 v74, a133 offset:33796
 ds_write_b16 v74, a135 offset:33804
 ds_write_b16 v74, a137 offset:34820
 ds_write_b16 v74, a139 offset:34828
 ds_write_b16 v74, a141 offset:35844
 ds_write_b16 v74, a143 offset:35852
 ds_write_b16 v74, a145 offset:36868
 ds_write_b16 v74, a147 offset:36876
 ds_write_b16 v74, a149 offset:37892
 ds_write_b16 v74, a151 offset:37900
 ds_write_b16 v74, a153 offset:38916
 ds_write_b16 v74, a155 offset:38924
 ds_write_b16 v74, a157 offset:39940
 ds_write_b16 v74, a159 offset:39948
 v_mov_b32 v10, 3
 ds_write_b32 v73, v10 offset:8
 s_branch L_yc_159
L_yn_162:
 s_cmp_lg_u32 s54, 31
 s_cbranch_scc1 L_yc_159
 ds_write_b16_d16_hi v74, a1 offset:6
 ds_write_b16_d16_hi v74, a3 offset:14
 ds_write_b16_d16_hi v74, a5 offset:1030
 ds_write_b16_d16_hi v74, a7 offset:1038
 ds_write_b16_d16_hi v74, a9 offset:2054
 ds_write_b16_d16_hi v74, a11 offset:2062
 ds_write_b16_d16_hi v74, a13 offset:3078
 ds_write_b16_d16_hi v74, a15 offset:3086
 ds_write_b16_d16_hi v74, a17 offset:4102
 ds_write_b16_d16_hi v74, a19 offset:4110
 ds_write_b16_d16_hi v74, a21 offset:5126
 ds_write_b16_d16_hi v74, a23 offset:5134
 ds_write_b16_d16_hi v74, a25 offset:6150
 ds_write_b16_d16_hi v74, a27 offset:6158
 ds_write_b16_d16_hi v74, a29 offset:7174
 ds_write_b16_d16_hi v74, a31 offset:7182
 ds_write_b16_d16_hi v74, a33 offset:8198
 ds_write_b16_d16_hi v74, a35 offset:8206
 ds_write_b16_d16_hi v74, a37 offset:9222
 ds_write_b16_d16_hi v74, a39 offset:9230
 ds_write_b16_d16_hi v74, a41 offset:10246
 ds_write_b16_d16_hi v74, a43 offset:10254
 ds_write_b16_d16_hi v74, a45 offset:11270
 ds_write_b16_d16_hi v74, a47 offset:11278
 ds_write_b16_d16_hi v74, a49 offset:12294
 ds_write_b16_d16_hi v74, a51 offset:12302
 ds_write_b16_d16_hi v74, a53 offset:13318
 ds_write_b16_d16_hi v74, a55 offset:13326
 ds_write_b16_d16_hi v74, a57 offset:14342
 ds_write_b16_d16_hi v74, a59 offset:14350
 ds_write_b16_d16_hi v74, a61 offset:15366
 ds_write_b16_d16_hi v74, a63 offset:15374
 ds_write_b16_d16_hi v74, a65 offset:16390
 ds_write_b16_d16_hi v74, a67 offset:16398
 ds_write_b16_d16_hi v74, a69 offset:17414
 ds_write_b16_d16_hi v74, a71 offset:17422
 ds_write_b16_d16_hi v74, a73 offset:18438
 ds_write_b16_d16_hi v74, a75 offset:18446
 ds_write_b16_d16_hi v74, a77 offset:19462
 ds_write_b16_d16_hi v74, a79 offset:19470
 ds_write_b16_d16_hi v74, a81 offset:20486
 ds_write_b16_d16_hi v74, a83 offset:20494
 ds_write_b16_d16_hi v74, a85 offset:21510
 ds_write_b16_d16_hi v74, a87 offset:21518
 ds_write_b16_d16_hi v74, a89 offset:22534
 ds_write_b16_d16_hi v74, a91 offset:22542
 ds_write_b16_d16_hi v74, a93 offset:23558
 ds_write_b16_d16_hi v74, a95 offset:23566
 ds_write_b16_d16_hi v74, a97 offset:24582
 ds_write_b16_d16_hi v74, a99 offset:24590
 ds_write_b16_d16_hi v74, a101 offset:25606
 ds_write_b16_d16_hi v74, a103 offset:25614
 ds_write_b16_d16_hi v74, a105 offset:26630
 ds_write_b16_d16_hi v74, a107 offset:26638
 ds_write_b16_d16_hi v74, a109 offset:27654
 ds_write_b16_d16_hi v74, a111 offset:27662
 ds_write_b16_d16_hi v74, a113 offset:28678
 ds_write_b16_d16_hi v74, a115 offset:28686
 ds_write_b16_d16_hi v74, a117 offset:29702
 ds_write_b16_d16_hi v74, a119 offset:29710
 ds_write_b16_d16_hi v74, a121 offset:30726
 ds_write_b16_d16_hi v74, a123 offset:30734
 ds_write_b16_d16_hi v74, a125 offset:31750
 ds_write_b16_d16_hi v74, a127 offset:31758
 ds_write_b16_d16_hi v74, a129 offset:32774
 ds_write_b16_d16_hi v74, a131 offset:32782
 ds_write_b16_d16_hi v74, a133 offset:33798
 ds_write_b16_d16_hi v74, a135 offset:33806
 ds_write_b16_d16_hi v74, a137 offset:34822
 ds_write_b16_d16_hi v74, a139 offset:34830
 ds_write_b16_d16_hi v74, a141 offset:35846
 ds_write_b16_d16_hi v74, a143 offset:35854
 ds_write_b16_d16_hi v74, a145 offset:36870
 ds_write_b16_d16_hi v74, a147 offset:36878
 ds_write_b16_d16_hi v74, a149 offset:37894
 ds_write_b16_d16_hi v74, a151 offset:37902
 ds_write_b16_d16_hi v74, a153 offset:38918
 ds_write_b16_d16_hi v74, a155 offset:38926
 ds_write_b16_d16_hi v74, a157 offset:39942
 ds_write_b16_d16_hi v74, a159 offset:39950
 v_mov_b32 v10, 4
 ds_write_b32 v73, v10 offset:8
L_yc_159:
 s_waitcnt vmcnt(0)
L_le_156:
 s_add_u32 s54, s54, 1
 s_add_u32 s60, s60, 40960
 s_cmp_lt_u32 s54, 64
 s_cbranch_scc1 L_t4_loop
 s_cmp_lg_u32 s50, 3
 s_cbranch_scc1 L_bail
 s_endpgm
L_bail:
 s_endpgm
L_ch:
 s_and_b32 s3, s48, 1
 s_lshl_b32 s3, s3, 4
 s_add_u32 s52, s3, s49
 s_mov_b32 s8, s20
 s_and_b32 s9, s21, 0xffff
 s_mov_b32 s10, 5242880
 s_mov_b32 s11, 0x00020000
 s_cmp_lt_u32 s50, 2
 s_cselect_b32 s8, s20, s22
 s_cselect_b32 s9, s21, s23
 s_and_b32 s9, s9, 0xffff
 v_lshrrev_b32 v2, 4, v0
 v_and_b32 v14, 1, v2
 v_lshlrev_b32 v14, 1, v14
 v_xor_b32 v14, v14, v0
 s_lshr_b32 s3, s50, 1
 s_lshl_b32 s3, s3, 3
 v_xor_b32 v14, s3, v14
 v_and_b32 v14, 15, v14
 s_mov_b32 s3, 8192
 v_mul_lo_u32 v2, v2, s3
 v_lshl_add_u32 v2, v14, 4, v2
 v_xor_b32 v3, 64, v2
 s_and_b32 s3, s50, 1
 s_mul_i32 s76, s3, 262144
 s_lshl_b32 s3, s52, 8
 s_add_u32 s76, s76, s3
 s_lshl_b32 s78, s50, 13
 s_add_u32 m0, s78, 0
 s_nop 0
 buffer_load_dwordx4 v2, s[8:11], s76 offen lds
 s_add_u32 s76, s76, 32768
 s_add_u32 m0, s78, 1024
 s_nop 0
 buffer_load_dwordx4 v2, s[8:11], s76 offen lds
 s_add_u32 s76, s76, 32768
 s_add_u32 m0, s78, 2048
 s_nop 0
 buffer_load_dwordx4 v3, s[8:11], s76 offen lds
 s_add_u32 s76, s76, 32768
 s_add_u32 m0, s78, 3072
 s_nop 0
 buffer_load_dwordx4 v3, s[8:11], s76 offen lds
 s_add_u32 s76, s76, 32768
 s_add_u32 m0, s78, 4096
 s_nop 0
 buffer_load_dwordx4 v2, s[8:11], s76 offen lds
 s_add_u32 s76, s76, 32768
 s_add_u32 m0, s78, 5120
 s_nop 0
 buffer_load_dwordx4 v2, s[8:11], s76 offen lds
 s_add_u32 s76, s76, 32768
 s_add_u32 m0, s78, 6144
 s_nop 0
 buffer_load_dwordx4 v3, s[8:11], s76 offen lds
 s_add_u32 s76, s76, 32768
 s_add_u32 m0, s78, 7168
 s_nop 0
 buffer_load_dwordx4 v3, s[8:11], s76 offen lds
 s_add_u32 s76, s76, 294912
 s_add_u32 m0, s78, 32768
 s_nop 0
 buffer_load_dwordx4 v2, s[8:11], s76 offen lds
 s_add_u32 s76, s76, 32768
 s_add_u32 m0, s78, 33792
 s_nop 0
 buffer_load_dwordx4 v2, s[8:11], s76 offen lds
 s_add_u32 s76, s76, 32768
 s_add_u32 m0, s78, 34816
 s_nop 0
 buffer_load_dwordx4 v3, s[8:11], s76 offen lds
 s_add_u32 s76, s76, 32768
 s_add_u32 m0, s78, 35840
 s_nop 0
 buffer_load_dwordx4 v3, s[8:11], s76 offen lds
 s_add_u32 s76, s76, 32768
 s_add_u32 m0, s78, 36864
 s_nop 0
 buffer_load_dwordx4 v2, s[8:11], s76 offen lds
 s_add_u32 s76, s76, 32768
 s_add_u32 m0, s78, 37888
 s_nop 0
 buffer_load_dwordx4 v2, s[8:11], s76 offen lds
 s_add_u32 s76, s76, 32768
 s_add_u32 m0, s78, 38912
 s_nop 0
 buffer_load_dwordx4 v3, s[8:11], s76 offen lds
 s_add_u32 s76, s76, 32768
 s_add_u32 m0, s78, 39936
 s_nop 0
 buffer_load_dwordx4 v3, s[8:11], s76 offen lds
 s_add_u32 s76, s76, 294912
 s_add_u32 m0, s78, 65536
 s_nop 0
 buffer_load_dwordx4 v2, s[8:11], s76 offen lds
 s_add_u32 s76, s76, 32768
 s_add_u32 m0, s78, 66560
 s_nop 0
 buffer_load_dwordx4 v2, s[8:11], s76 offen lds
 s_add_u32 s76, s76, 32768
 s_add_u32 m0, s78, 67584
 s_nop 0
 buffer_load_dwordx4 v3, s[8:11], s76 offen lds
 s_add_u32 s76, s76, 32768
 s_add_u32 m0, s78, 68608
 s_nop 0
 buffer_load_dwordx4 v3, s[8:11], s76 offen lds
 s_add_u32 s76, s76, 32768
 s_add_u32 m0, s78, 69632
 s_nop 0
 buffer_load_dwordx4 v2, s[8:11], s76 offen lds
 s_add_u32 s76, s76, 32768
 s_add_u32 m0, s78, 70656
 s_nop 0
 buffer_load_dwordx4 v2, s[8:11], s76 offen lds
 s_add_u32 s76, s76, 32768
 s_add_u32 m0, s78, 71680
 s_nop 0
 buffer_load_dwordx4 v3, s[8:11], s76 offen lds
 s_add_u32 s76, s76, 32768
 s_add_u32 m0, s78, 72704
 s_nop 0
 buffer_load_dwordx4 v3, s[8:11], s76 offen lds
 s_add_u32 s76, s76, 294912
 s_add_u32 m0, s78, 98304
 s_nop 0
 buffer_load_dwordx4 v2, s[8:11], s76 offen lds
 s_add_u32 s76, s76, 32768
 s_add_u32 m0, s78, 99328
 s_nop 0
 buffer_load_dwordx4 v2, s[8:11], s76 offen lds
 s_add_u32 s76, s76, 32768
 s_add_u32 m0, s78, 100352
 s_nop 0
 buffer_load_dwordx4 v3, s[8:11], s76 offen lds
 s_add_u32 s76, s76, 32768
 s_add_u32 m0, s78, 101376
 s_nop 0
 buffer_load_dwordx4 v3, s[8:11], s76 offen lds
 s_add_u32 s76, s76, 32768
 s_add_u32 m0, s78, 102400
 s_nop 0
 buffer_load_dwordx4 v2, s[8:11], s76 offen lds
 s_add_u32 s76, s76, 32768
 s_add_u32 m0, s78, 103424
 s_nop 0
 buffer_load_dwordx4 v2, s[8:11], s76 offen lds
 s_add_u32 s76, s76, 32768
 s_add_u32 m0, s78, 104448
 s_nop 0
 buffer_load_dwordx4 v3, s[8:11], s76 offen lds
 s_add_u32 s76, s76, 32768
 s_add_u32 m0, s78, 105472
 s_nop 0
 buffer_load_dwordx4 v3, s[8:11], s76 offen lds
 s_add_u32 s76, s76, 294912
 s_add_u32 m0, s78, 131072
 s_nop 0
 buffer_load_dwordx4 v2, s[8:11], s76 offen lds
 s_add_u32 s76, s76, 32768
 s_add_u32 m0, s78, 132096
 s_nop 0
 buffer_load_dwordx4 v2, s[8:11], s76 offen lds
 s_add_u32 s76, s76, 32768
 s_add_u32 m0, s78, 133120
 s_nop 0
 buffer_load_dwordx4 v3, s[8:11], s76 offen lds
 s_add_u32 s76, s76, 32768
 s_add_u32 m0, s78, 134144
 s_nop 0
 buffer_load_dwordx4 v3, s[8:11], s76 offen lds
 s_add_u32 s76, s76, 32768
 s_add_u32 m0, s78, 135168
 s_nop 0
 buffer_load_dwordx4 v2, s[8:11], s76 offen lds
 s_add_u32 s76, s76, 32768
 s_add_u32 m0, s78, 136192
 s_nop 0
 buffer_load_dwordx4 v2, s[8:11], s76 offen lds
 s_add_u32 s76, s76, 32768
 s_add_u32 m0, s78, 137216
 s_nop 0
 buffer_load_dwordx4 v3, s[8:11], s76 offen lds
 s_add_u32 s76, s76, 32768
 s_add_u32 m0, s78, 138240
 s_nop 0
 buffer_load_dwordx4 v3, s[8:11], s76 offen lds
 s_add_u32 s76, s76, 294912
 v_bfe_u32 v14, v0, 2, 1
 v_lshlrev_b32 v4, 8, v14
 v_lshl_add_u32 v4, v14, 5, v4
 v_bfe_u32 v14, v0, 4, 1
 v_lshl_add_u32 v4, v14, 11, v4
 v_lshl_add_u32 v4, v14, 6, v4
 v_bfe_u32 v14, v0, 5, 1
 v_lshl_add_u32 v4, v14, 12, v4
 v_and_b32 v14, 3, v0
 v_lshl_add_u32 v4, v14, 3, v4
 v_bfe_u32 v14, v0, 3, 1
 v_mul_u32_u24 v14, 16512, v14
 v_xor_b32 v4, v4, v14
 s_lshl_b32 s3, s50, 6
 v_xor_b32 v4, s3, v4
 v_xor_b32 v5, 32, v4
 s_waitcnt vmcnt(32)
 s_barrier
 v_add_u32 v6, 0, v4
 v_add_u32 v7, 0, v5
 ds_read_b64_tr_b16 v[224:225], v6 offset:0
 ds_read_b64_tr_b16 v[226:227], v6 offset:512
 ds_read_b64_tr_b16 v[228:229], v6 offset:1024
 ds_read_b64_tr_b16 v[230:231], v6 offset:1536
 ds_read_b64_tr_b16 v[232:233], v7 offset:0
 ds_read_b64_tr_b16 v[234:235], v7 offset:512
 ds_read_b64_tr_b16 v[236:237], v7 offset:1024
 ds_read_b64_tr_b16 v[238:239], v7 offset:1536
 ds_read_b64_tr_b16 v[240:241], v6 offset:8192
 ds_read_b64_tr_b16 v[242:243], v6 offset:8704
 ds_read_b64_tr_b16 v[244:245], v6 offset:9216
 ds_read_b64_tr_b16 v[246:247], v6 offset:9728
 ds_read_b64_tr_b16 v[248:249], v7 offset:8192
 ds_read_b64_tr_b16 v[250:251], v7 offset:8704
 ds_read_b64_tr_b16 v[252:253], v7 offset:9216
 ds_read_b64_tr_b16 v[254:255], v7 offset:9728
 s_waitcnt lgkmcnt(0)
 s_barrier
 s_add_u32 m0, s78, 0
 s_nop 0
 buffer_load_dwordx4 v2, s[8:11], s76 offen lds
 s_add_u32 s76, s76, 32768
 s_add_u32 m0, s78, 1024
 s_nop 0
 buffer_load_dwordx4 v2, s[8:11], s76 offen lds
 s_add_u32 s76, s76, 32768
 s_add_u32 m0, s78, 2048
 s_nop 0
 buffer_load_dwordx4 v3, s[8:11], s76 offen lds
 s_add_u32 s76, s76, 32768
 s_add_u32 m0, s78, 3072
 s_nop 0
 buffer_load_dwordx4 v3, s[8:11], s76 offen lds
 s_add_u32 s76, s76, 32768
 s_add_u32 m0, s78, 4096
 s_nop 0
 buffer_load_dwordx4 v2, s[8:11], s76 offen lds
 s_add_u32 s76, s76, 32768
 s_add_u32 m0, s78, 5120
 s_nop 0
 buffer_load_dwordx4 v2, s[8:11], s76 offen lds
 s_add_u32 s76, s76, 32768
 s_add_u32 m0, s78, 6144
 s_nop 0
 buffer_load_dwordx4 v3, s[8:11], s76 offen lds
 s_add_u32 s76, s76, 32768
 s_add_u32 m0, s78, 7168
 s_nop 0
 buffer_load_dwordx4 v3, s[8:11], s76 offen lds
 s_add_u32 s76, s76, 294912
 s_waitcnt vmcnt(32)
 s_barrier
 v_add_u32 v6, 32768, v4
 v_add_u32 v7, 32768, v5
 ds_read_b64_tr_b16 v[192:193], v6 offset:0
 ds_read_b64_tr_b16 v[194:195], v6 offset:512
 ds_read_b64_tr_b16 v[196:197], v6 offset:1024
 ds_read_b64_tr_b16 v[198:199], v6 offset:1536
 ds_read_b64_tr_b16 v[200:201], v7 offset:0
 ds_read_b64_tr_b16 v[202:203], v7 offset:512
 ds_read_b64_tr_b16 v[204:205], v7 offset:1024
 ds_read_b64_tr_b16 v[206:207], v7 offset:1536
 ds_read_b64_tr_b16 v[208:209], v6 offset:8192
 ds_read_b64_tr_b16 v[210:211], v6 offset:8704
 ds_read_b64_tr_b16 v[212:213], v6 offset:9216
 ds_read_b64_tr_b16 v[214:215], v6 offset:9728
 ds_read_b64_tr_b16 v[216:217], v7 offset:8192
 ds_read_b64_tr_b16 v[218:219], v7 offset:8704
 ds_read_b64_tr_b16 v[220:221], v7 offset:9216
 ds_read_b64_tr_b16 v[222:223], v7 offset:9728
 s_waitcnt lgkmcnt(0)
 s_barrier
 s_add_u32 m0, s78, 32768
 s_nop 0
 buffer_load_dwordx4 v2, s[8:11], s76 offen lds
 s_add_u32 s76, s76, 32768
 s_add_u32 m0, s78, 33792
 s_nop 0
 buffer_load_dwordx4 v2, s[8:11], s76 offen lds
 s_add_u32 s76, s76, 32768
 s_add_u32 m0, s78, 34816
 s_nop 0
 buffer_load_dwordx4 v3, s[8:11], s76 offen lds
 s_add_u32 s76, s76, 32768
 s_add_u32 m0, s78, 35840
 s_nop 0
 buffer_load_dwordx4 v3, s[8:11], s76 offen lds
 s_add_u32 s76, s76, 32768
 s_add_u32 m0, s78, 36864
 s_nop 0
 buffer_load_dwordx4 v2, s[8:11], s76 offen lds
 s_add_u32 s76, s76, 32768
 s_add_u32 m0, s78, 37888
 s_nop 0
 buffer_load_dwordx4 v2, s[8:11], s76 offen lds
 s_add_u32 s76, s76, 32768
 s_add_u32 m0, s78, 38912
 s_nop 0
 buffer_load_dwordx4 v3, s[8:11], s76 offen lds
 s_add_u32 s76, s76, 32768
 s_add_u32 m0, s78, 39936
 s_nop 0
 buffer_load_dwordx4 v3, s[8:11], s76 offen lds
 s_add_u32 s76, s76, 294912
 s_waitcnt vmcnt(32)
 s_barrier
 v_add_u32 v6, 65536, v4
 v_add_u32 v7, 65536, v5
 ds_read_b64_tr_b16 a[0:1], v6 offset:0
 ds_read_b64_tr_b16 a[2:3], v6 offset:512
 ds_read_b64_tr_b16 a[4:5], v6 offset:1024
 ds_read_b64_tr_b16 a[6:7], v6 offset:1536
 ds_read_b64_tr_b16 a[8:9], v7 offset:0
 ds_read_b64_tr_b16 a[10:11], v7 offset:512
 ds_read_b64_tr_b16 a[12:13], v7 offset:1024
 ds_read_b64_tr_b16 a[14:15], v7 offset:1536
 ds_read_b64_tr_b16 a[16:17], v6 offset:8192
 ds_read_b64_tr_b16 a[18:19], v6 offset:8704
 ds_read_b64_tr_b16 a[20:21], v6 offset:9216
 ds_read_b64_tr_b16 a[22:23], v6 offset:9728
 ds_read_b64_tr_b16 a[24:25], v7 offset:8192
 ds_read_b64_tr_b16 a[26:27], v7 offset:8704
 ds_read_b64_tr_b16 a[28:29], v7 offset:9216
 ds_read_b64_tr_b16 a[30:31], v7 offset:9728
 s_waitcnt lgkmcnt(0)
 s_barrier
 s_add_u32 m0, s78, 65536
 s_nop 0
 buffer_load_dwordx4 v2, s[8:11], s76 offen lds
 s_add_u32 s76, s76, 32768
 s_add_u32 m0, s78, 66560
 s_nop 0
 buffer_load_dwordx4 v2, s[8:11], s76 offen lds
 s_add_u32 s76, s76, 32768
 s_add_u32 m0, s78, 67584
 s_nop 0
 buffer_load_dwordx4 v3, s[8:11], s76 offen lds
 s_add_u32 s76, s76, 32768
 s_add_u32 m0, s78, 68608
 s_nop 0
 buffer_load_dwordx4 v3, s[8:11], s76 offen lds
 s_add_u32 s76, s76, 32768
 s_add_u32 m0, s78, 69632
 s_nop 0
 buffer_load_dwordx4 v2, s[8:11], s76 offen lds
 s_add_u32 s76, s76, 32768
 s_add_u32 m0, s78, 70656
 s_nop 0
 buffer_load_dwordx4 v2, s[8:11], s76 offen lds
 s_add_u32 s76, s76, 32768
 s_add_u32 m0, s78, 71680
 s_nop 0
 buffer_load_dwordx4 v3, s[8:11], s76 offen lds
 s_add_u32 s76, s76, 32768
 s_add_u32 m0, s78, 72704
 s_nop 0
 buffer_load_dwordx4 v3, s[8:11], s76 offen lds
 s_add_u32 s76, s76, 294912
 s_waitcnt vmcnt(32)
 s_barrier
 v_add_u32 v6, 98304, v4
 v_add_u32 v7, 98304, v5
 ds_read_b64_tr_b16 a[32:33], v6 offset:0
 ds_read_b64_tr_b16 a[34:35], v6 offset:512
 ds_read_b64_tr_b16 a[36:37], v6 offset:1024
 ds_read_b64_tr_b16 a[38:39], v6 offset:1536
 ds_read_b64_tr_b16 a[40:41], v7 offset:0
 ds_read_b64_tr_b16 a[42:43], v7 offset:512
 ds_read_b64_tr_b16 a[44:45], v7 offset:1024
 ds_read_b64_tr_b16 a[46:47], v7 offset:1536
 ds_read_b64_tr_b16 a[48:49], v6 offset:8192
 ds_read_b64_tr_b16 a[50:51], v6 offset:8704
 ds_read_b64_tr_b16 a[52:53], v6 offset:9216
 ds_read_b64_tr_b16 a[54:55], v6 offset:9728
 ds_read_b64_tr_b16 a[56:57], v7 offset:8192
 ds_read_b64_tr_b16 a[58:59], v7 offset:8704
 ds_read_b64_tr_b16 a[60:61], v7 offset:9216
 ds_read_b64_tr_b16 a[62:63], v7 offset:9728
 s_waitcnt lgkmcnt(0)
 s_barrier
 s_add_u32 m0, s78, 98304
 s_nop 0
 buffer_load_dwordx4 v2, s[8:11], s76 offen lds
 s_add_u32 s76, s76, 32768
 s_add_u32 m0, s78, 99328
 s_nop 0
 buffer_load_dwordx4 v2, s[8:11], s76 offen lds
 s_add_u32 s76, s76, 32768
 s_add_u32 m0, s78, 100352
 s_nop 0
 buffer_load_dwordx4 v3, s[8:11], s76 offen lds
 s_add_u32 s76, s76, 32768
 s_add_u32 m0, s78, 101376
 s_nop 0
 buffer_load_dwordx4 v3, s[8:11], s76 offen lds
 s_add_u32 s76, s76, 32768
 s_add_u32 m0, s78, 102400
 s_nop 0
 buffer_load_dwordx4 v2, s[8:11], s76 offen lds
 s_add_u32 s76, s76, 32768
 s_add_u32 m0, s78, 103424
 s_nop 0
 buffer_load_dwordx4 v2, s[8:11], s76 offen lds
 s_add_u32 s76, s76, 32768
 s_add_u32 m0, s78, 104448
 s_nop 0
 buffer_load_dwordx4 v3, s[8:11], s76 offen lds
 s_add_u32 s76, s76, 32768
 s_add_u32 m0, s78, 105472
 s_nop 0
 buffer_load_dwordx4 v3, s[8:11], s76 offen lds
 s_add_u32 s76, s76, 294912
 s_waitcnt vmcnt(32)
 s_barrier
 v_add_u32 v6, 131072, v4
 v_add_u32 v7, 131072, v5
 ds_read_b64_tr_b16 a[64:65], v6 offset:0
 ds_read_b64_tr_b16 a[66:67], v6 offset:512
 ds_read_b64_tr_b16 a[68:69], v6 offset:1024
 ds_read_b64_tr_b16 a[70:71], v6 offset:1536
 ds_read_b64_tr_b16 a[72:73], v7 offset:0
 ds_read_b64_tr_b16 a[74:75], v7 offset:512
 ds_read_b64_tr_b16 a[76:77], v7 offset:1024
 ds_read_b64_tr_b16 a[78:79], v7 offset:1536
 ds_read_b64_tr_b16 a[80:81], v6 offset:8192
 ds_read_b64_tr_b16 a[82:83], v6 offset:8704
 ds_read_b64_tr_b16 a[84:85], v6 offset:9216
 ds_read_b64_tr_b16 a[86:87], v6 offset:9728
 ds_read_b64_tr_b16 a[88:89], v7 offset:8192
 ds_read_b64_tr_b16 a[90:91], v7 offset:8704
 ds_read_b64_tr_b16 a[92:93], v7 offset:9216
 ds_read_b64_tr_b16 a[94:95], v7 offset:9728
 s_waitcnt lgkmcnt(0)
 s_barrier
 s_add_u32 m0, s78, 131072
 s_nop 0
 buffer_load_dwordx4 v2, s[8:11], s76 offen lds
 s_add_u32 s76, s76, 32768
 s_add_u32 m0, s78, 132096
 s_nop 0
 buffer_load_dwordx4 v2, s[8:11], s76 offen lds
 s_add_u32 s76, s76, 32768
 s_add_u32 m0, s78, 133120
 s_nop 0
 buffer_load_dwordx4 v3, s[8:11], s76 offen lds
 s_add_u32 s76, s76, 32768
 s_add_u32 m0, s78, 134144
 s_nop 0
 buffer_load_dwordx4 v3, s[8:11], s76 offen lds
 s_add_u32 s76, s76, 32768
 s_add_u32 m0, s78, 135168
 s_nop 0
 buffer_load_dwordx4 v2, s[8:11], s76 offen lds
 s_add_u32 s76, s76, 32768
 s_add_u32 m0, s78, 136192
 s_nop 0
 buffer_load_dwordx4 v2, s[8:11], s76 offen lds
 s_add_u32 s76, s76, 32768
 s_add_u32 m0, s78, 137216
 s_nop 0
 buffer_load_dwordx4 v3, s[8:11], s76 offen lds
 s_add_u32 s76, s76, 32768
 s_add_u32 m0, s78, 138240
 s_nop 0
 buffer_load_dwordx4 v3, s[8:11], s76 offen lds
 s_add_u32 s76, s76, 294912
 s_waitcnt vmcnt(32)
 s_barrier
 v_add_u32 v6, 0, v4
 v_add_u32 v7, 0, v5
 ds_read_b64_tr_b16 a[96:97], v6 offset:0
 ds_read_b64_tr_b16 a[98:99], v6 offset:512
 ds_read_b64_tr_b16 a[100:101], v6 offset:1024
 ds_read_b64_tr_b16 a[102:103], v6 offset:1536
 ds_read_b64_tr_b16 a[104:105], v7 offset:0
 ds_read_b64_tr_b16 a[106:107], v7 offset:512
 ds_read_b64_tr_b16 a[108:109], v7 offset:1024
 ds_read_b64_tr_b16 a[110:111], v7 offset:1536
 ds_read_b64_tr_b16 a[112:113], v6 offset:8192
 ds_read_b64_tr_b16 a[114:115], v6 offset:8704
 ds_read_b64_tr_b16 a[116:117], v6 offset:9216
 ds_read_b64_tr_b16 a[118:119], v6 offset:9728
 ds_read_b64_tr_b16 a[120:121], v7 offset:8192
 ds_read_b64_tr_b16 a[122:123], v7 offset:8704
 ds_read_b64_tr_b16 a[124:125], v7 offset:9216
 ds_read_b64_tr_b16 a[126:127], v7 offset:9728
 s_waitcnt lgkmcnt(0)
 s_barrier
 s_mov_b32 s8, s26
 s_and_b32 s9, s27, 0xffff
 s_mov_b32 s10, 5242880
 s_mov_b32 s11, 0x00020000
 v_lshrrev_b32 v2, 4, v0
 v_and_b32 v14, 1, v2
 v_lshlrev_b32 v14, 1, v14
 v_xor_b32 v14, v14, v0
 s_and_b32 s3, s50, 1
 s_lshl_b32 s3, s3, 3
 v_xor_b32 v14, s3, v14
 v_and_b32 v14, 15, v14
 s_mov_b32 s3, 1280
 v_mul_lo_u32 v2, v2, s3
 v_lshl_add_u32 v2, v14, 4, v2
 v_xor_b32 v3, 64, v2
 s_lshl_b32 s3, s52, 2
 s_add_u32 s3, s3, s50
 s_mul_i32 s76, s3, 40960
 s_add_u32 m0, s78, 0
 s_nop 0
 buffer_load_dwordx4 v2, s[8:11], s76 offen lds
 s_add_u32 s76, s76, 5120
 s_add_u32 m0, s78, 1024
 s_nop 0
 buffer_load_dwordx4 v2, s[8:11], s76 offen lds
 s_add_u32 s76, s76, 5120
 s_add_u32 m0, s78, 2048
 s_nop 0
 buffer_load_dwordx4 v2, s[8:11], s76 offen lds
 s_add_u32 s76, s76, 5120
 s_add_u32 m0, s78, 3072
 s_nop 0
 buffer_load_dwordx4 v2, s[8:11], s76 offen lds
 s_add_u32 s76, s76, 5120
 s_add_u32 m0, s78, 4096
 s_nop 0
 buffer_load_dwordx4 v3, s[8:11], s76 offen lds
 s_add_u32 s76, s76, 5120
 s_add_u32 m0, s78, 5120
 s_nop 0
 buffer_load_dwordx4 v3, s[8:11], s76 offen lds
 s_add_u32 s76, s76, 5120
 s_add_u32 m0, s78, 6144
 s_nop 0
 buffer_load_dwordx4 v3, s[8:11], s76 offen lds
 s_add_u32 s76, s76, 5120
 s_add_u32 m0, s78, 7168
 s_nop 0
 buffer_load_dwordx4 v3, s[8:11], s76 offen lds
 s_add_u32 s76, s76, 4294931712
 s_waitcnt vmcnt(32)
 s_barrier
 v_add_u32 v6, 32768, v4
 v_add_u32 v7, 32768, v5
 ds_read_b64_tr_b16 a[128:129], v6 offset:0
 ds_read_b64_tr_b16 a[130:131], v6 offset:512
 ds_read_b64_tr_b16 a[132:133], v6 offset:1024
 ds_read_b64_tr_b16 a[134:135], v6 offset:1536
 ds_read_b64_tr_b16 a[136:137], v7 offset:0
 ds_read_b64_tr_b16 a[138:139], v7 offset:512
 ds_read_b64_tr_b16 a[140:141], v7 offset:1024
 ds_read_b64_tr_b16 a[142:143], v7 offset:1536
 ds_read_b64_tr_b16 a[144:145], v6 offset:8192
 ds_read_b64_tr_b16 a[146:147], v6 offset:8704
 ds_read_b64_tr_b16 a[148:149], v6 offset:9216
 ds_read_b64_tr_b16 a[150:151], v6 offset:9728
 ds_read_b64_tr_b16 a[152:153], v7 offset:8192
 ds_read_b64_tr_b16 a[154:155], v7 offset:8704
 ds_read_b64_tr_b16 a[156:157], v7 offset:9216
 ds_read_b64_tr_b16 a[158:159], v7 offset:9728
 s_waitcnt lgkmcnt(0)
 s_barrier
 s_add_u32 m0, s78, 32768
 s_nop 0
 buffer_load_dwordx4 v2, s[8:11], s76 offen lds
 s_add_u32 s76, s76, 5120
 s_add_u32 m0, s78, 33792
 s_nop 0
 buffer_load_dwordx4 v2, s[8:11], s76 offen lds
 s_add_u32 s76, s76, 5120
 s_add_u32 m0, s78, 34816
 s_nop 0
 buffer_load_dwordx4 v2, s[8:11], s76 offen lds
 s_add_u32 s76, s76, 5120
 s_add_u32 m0, s78, 35840
 s_nop 0
 buffer_load_dwordx4 v2, s[8:11], s76 offen lds
 s_add_u32 s76, s76, 5120
 s_add_u32 m0, s78, 36864
 s_nop 0
 buffer_load_dwordx4 v3, s[8:11], s76 offen lds
 s_add_u32 s76, s76, 5120
 s_add_u32 m0, s78, 37888
 s_nop 0
 buffer_load_dwordx4 v3, s[8:11], s76 offen lds
 s_add_u32 s76, s76, 5120
 s_add_u32 m0, s78, 38912
 s_nop 0
 buffer_load_dwordx4 v3, s[8:11], s76 offen lds
 s_add_u32 s76, s76, 5120
 s_add_u32 m0, s78, 39936
 s_nop 0
 buffer_load_dwordx4 v3, s[8:11], s76 offen lds
 s_add_u32 s76, s76, 4294931712
 s_waitcnt vmcnt(32)
 s_barrier
 v_add_u32 v6, 65536, v4
 v_add_u32 v7, 65536, v5
 ds_read_b64_tr_b16 a[160:161], v6 offset:0
 ds_read_b64_tr_b16 a[162:163], v6 offset:512
 ds_read_b64_tr_b16 a[164:165], v6 offset:1024
 ds_read_b64_tr_b16 a[166:167], v6 offset:1536
 ds_read_b64_tr_b16 a[168:169], v7 offset:0
 ds_read_b64_tr_b16 a[170:171], v7 offset:512
 ds_read_b64_tr_b16 a[172:173], v7 offset:1024
 ds_read_b64_tr_b16 a[174:175], v7 offset:1536
 ds_read_b64_tr_b16 a[176:177], v6 offset:8192
 ds_read_b64_tr_b16 a[178:179], v6 offset:8704
 ds_read_b64_tr_b16 a[180:181], v6 offset:9216
 ds_read_b64_tr_b16 a[182:183], v6 offset:9728
 ds_read_b64_tr_b16 a[184:185], v7 offset:8192
 ds_read_b64_tr_b16 a[186:187], v7 offset:8704
 ds_read_b64_tr_b16 a[188:189], v7 offset:9216
 ds_read_b64_tr_b16 a[190:191], v7 offset:9728
 s_waitcnt lgkmcnt(0)
 s_barrier
 s_add_u32 m0, s78, 65536
 s_nop 0
 buffer_load_dwordx4 v2, s[8:11], s76 offen lds
 s_add_u32 s76, s76, 5120
 s_add_u32 m0, s78, 66560
 s_nop 0
 buffer_load_dwordx4 v2, s[8:11], s76 offen lds
 s_add_u32 s76, s76, 5120
 s_add_u32 m0, s78, 67584
 s_nop 0
 buffer_load_dwordx4 v2, s[8:11], s76 offen lds
 s_add_u32 s76, s76, 5120
 s_add_u32 m0, s78, 68608
 s_nop 0
 buffer_load_dwordx4 v2, s[8:11], s76 offen lds
 s_add_u32 s76, s76, 5120
 s_add_u32 m0, s78, 69632
 s_nop 0
 buffer_load_dwordx4 v3, s[8:11], s76 offen lds
 s_add_u32 s76, s76, 5120
 s_add_u32 m0, s78, 70656
 s_nop 0
 buffer_load_dwordx4 v3, s[8:11], s76 offen lds
 s_add_u32 s76, s76, 5120
 s_add_u32 m0, s78, 71680
 s_nop 0
 buffer_load_dwordx4 v3, s[8:11], s76 offen lds
 s_add_u32 s76, s76, 5120
 s_add_u32 m0, s78, 72704
 s_nop 0
 buffer_load_dwordx4 v3, s[8:11], s76 offen lds
 s_add_u32 s76, s76, 4294931712
 s_waitcnt vmcnt(32)
 s_barrier
 v_add_u32 v6, 98304, v4
 v_add_u32 v7, 98304, v5
 ds_read_b64_tr_b16 a[192:193], v6 offset:0
 ds_read_b64_tr_b16 a[194:195], v6 offset:512
 ds_read_b64_tr_b16 a[196:197], v6 offset:1024
 ds_read_b64_tr_b16 a[198:199], v6 offset:1536
 ds_read_b64_tr_b16 a[200:201], v7 offset:0
 ds_read_b64_tr_b16 a[202:203], v7 offset:512
 ds_read_b64_tr_b16 a[204:205], v7 offset:1024
 ds_read_b64_tr_b16 a[206:207], v7 offset:1536
 ds_read_b64_tr_b16 a[208:209], v6 offset:8192
 ds_read_b64_tr_b16 a[210:211], v6 offset:8704
 ds_read_b64_tr_b16 a[212:213], v6 offset:9216
 ds_read_b64_tr_b16 a[214:215], v6 offset:9728
 ds_read_b64_tr_b16 a[216:217], v7 offset:8192
 ds_read_b64_tr_b16 a[218:219], v7 offset:8704
 ds_read_b64_tr_b16 a[220:221], v7 offset:9216
 ds_read_b64_tr_b16 a[222:223], v7 offset:9728
 s_waitcnt lgkmcnt(0)
 s_barrier
 s_add_u32 m0, s78, 98304
 s_nop 0
 buffer_load_dwordx4 v2, s[8:11], s76 offen lds
 s_add_u32 s76, s76, 5120
 s_add_u32 m0, s78, 99328
 s_nop 0
 buffer_load_dwordx4 v2, s[8:11], s76 offen lds
 s_add_u32 s76, s76, 5120
 s_add_u32 m0, s78, 100352
 s_nop 0
 buffer_load_dwordx4 v2, s[8:11], s76 offen lds
 s_add_u32 s76, s76, 5120
 s_add_u32 m0, s78, 101376
 s_nop 0
 buffer_load_dwordx4 v2, s[8:11], s76 offen lds
 s_add_u32 s76, s76, 5120
 s_add_u32 m0, s78, 102400
 s_nop 0
 buffer_load_dwordx4 v3, s[8:11], s76 offen lds
 s_add_u32 s76, s76, 5120
 s_add_u32 m0, s78, 103424
 s_nop 0
 buffer_load_dwordx4 v3, s[8:11], s76 offen lds
 s_add_u32 s76, s76, 5120
 s_add_u32 m0, s78, 104448
 s_nop 0
 buffer_load_dwordx4 v3, s[8:11], s76 offen lds
 s_add_u32 s76, s76, 5120
 s_add_u32 m0, s78, 105472
 s_nop 0
 buffer_load_dwordx4 v3, s[8:11], s76 offen lds
 s_add_u32 s76, s76, 4294931712
 s_waitcnt vmcnt(32)
 s_barrier
 v_add_u32 v6, 131072, v4
 v_add_u32 v7, 131072, v5
 ds_read_b64_tr_b16 a[224:225], v6 offset:0
 ds_read_b64_tr_b16 a[226:227], v6 offset:512
 ds_read_b64_tr_b16 a[228:229], v6 offset:1024
 ds_read_b64_tr_b16 a[230:231], v6 offset:1536
 ds_read_b64_tr_b16 a[232:233], v7 offset:0
 ds_read_b64_tr_b16 a[234:235], v7 offset:512
 ds_read_b64_tr_b16 a[236:237], v7 offset:1024
 ds_read_b64_tr_b16 a[238:239], v7 offset:1536
 ds_read_b64_tr_b16 a[240:241], v6 offset:8192
 ds_read_b64_tr_b16 a[242:243], v6 offset:8704
 ds_read_b64_tr_b16 a[244:245], v6 offset:9216
 ds_read_b64_tr_b16 a[246:247], v6 offset:9728
 ds_read_b64_tr_b16 a[248:249], v7 offset:8192
 ds_read_b64_tr_b16 a[250:251], v7 offset:8704
 ds_read_b64_tr_b16 a[252:253], v7 offset:9216
 ds_read_b64_tr_b16 a[254:255], v7 offset:9728
 s_waitcnt lgkmcnt(0)
 s_barrier
 s_add_u32 m0, s78, 131072
 s_nop 0
 buffer_load_dwordx4 v2, s[8:11], s76 offen lds
 s_add_u32 s76, s76, 5120
 s_add_u32 m0, s78, 132096
 s_nop 0
 buffer_load_dwordx4 v2, s[8:11], s76 offen lds
 s_add_u32 s76, s76, 5120
 s_add_u32 m0, s78, 133120
 s_nop 0
 buffer_load_dwordx4 v2, s[8:11], s76 offen lds
 s_add_u32 s76, s76, 5120
 s_add_u32 m0, s78, 134144
 s_nop 0
 buffer_load_dwordx4 v2, s[8:11], s76 offen lds
 s_add_u32 s76, s76, 5120
 s_add_u32 m0, s78, 135168
 s_nop 0
 buffer_load_dwordx4 v3, s[8:11], s76 offen lds
 s_add_u32 s76, s76, 5120
 s_add_u32 m0, s78, 136192
 s_nop 0
 buffer_load_dwordx4 v3, s[8:11], s76 offen lds
 s_add_u32 s76, s76, 5120
 s_add_u32 m0, s78, 137216
 s_nop 0
 buffer_load_dwordx4 v3, s[8:11], s76 offen lds
 s_add_u32 s76, s76, 5120
 s_add_u32 m0, s78, 138240
 s_nop 0
 buffer_load_dwordx4 v3, s[8:11], s76 offen lds
 s_add_u32 s76, s76, 4294931712
 v_bfe_u32 v14, v0, 2, 1
 v_lshlrev_b32 v4, 8, v14
 v_lshl_add_u32 v4, v14, 5, v4
 v_bfe_u32 v14, v0, 4, 1
 v_lshl_add_u32 v4, v14, 12, v4
 v_lshl_add_u32 v4, v14, 6, v4
 v_bfe_u32 v14, v0, 5, 1
 v_lshl_add_u32 v4, v14, 10, v4
 v_and_b32 v14, 3, v0
 v_lshl_add_u32 v4, v14, 3, v4
 v_bfe_u32 v14, v0, 3, 1
 v_mul_u32_u24 v14, 32, v14
 v_xor_b32 v4, v4, v14
 s_mov_b32 s96, s44
 s_and_b32 s97, s45, 0xffff
 s_mov_b32 s98, 256
 s_mov_b32 s99, 0x00020000
 v_mov_b32 v8, 132
 s_mov_b32 s3, 144
 v_writelane_b32 v8, s3, 1
 s_mov_b32 s51, 0
 s_mov_b64 exec, 3
L_wb_164:
 buffer_load_dword v9, v8, s[96:99], 0 offen sc1
 s_waitcnt vmcnt(0)
 v_cmp_eq_u32 vcc, 0, v9
 s_cbranch_vccz L_wbd_165
 s_sleep 2
 s_add_u32 s51, s51, 1
 s_cmp_lt_u32 s51, 131072
 s_cbranch_scc1 L_wb_164
 s_branch L_bail
L_wbd_165:
 s_mov_b64 exec, -1
 v_readlane_b32 s81, v9, 1
 s_nop 3
 s_sub_u32 s81, s81, 1
 s_mov_b32 s96, s44
 s_and_b32 s97, s45, 0xffff
 s_mov_b32 s98, 256
 s_mov_b32 s99, 0x00020000
 v_lshlrev_b32 v8, 5, v0
 s_mov_b32 s51, 0
L_gl_166:
 buffer_load_dword v9, v8, s[96:99], 0 offen sc1
 s_waitcnt vmcnt(0)
 v_readlane_b32 s3, v9, s48
 s_mov_b32 s80, 0
 s_nop 2
 s_cmp_ge_u32 s3, 32
 s_cbranch_scc1 L_gld_167
 s_mov_b32 s80, 0
 v_readlane_b32 s3, v9, 0
 s_nop 3
 s_add_u32 s80, s80, s3
 v_readlane_b32 s3, v9, 1
 s_nop 3
 s_add_u32 s80, s80, s3
 v_readlane_b32 s3, v9, 2
 s_nop 3
 s_add_u32 s80, s80, s3
 v_readlane_b32 s3, v9, 3
 s_nop 3
 s_add_u32 s80, s80, s3
 v_readlane_b32 s3, v9, 4
 s_nop 3
 s_add_u32 s80, s80, s3
 v_readlane_b32 s3, v9, 5
 s_nop 3
 s_add_u32 s80, s80, s3
 v_readlane_b32 s3, v9, 6
 s_nop 3
 s_add_u32 s80, s80, s3
 v_readlane_b32 s3, v9, 7
 s_nop 3
 s_add_u32 s80, s80, s3
 s_cmp_ge_u32 s80, 256
 s_cbranch_scc1 L_gld_167
 s_sleep 4
 s_add_u32 s51, s51, 1
 s_cmp_lt_u32 s51, 131072
 s_cbranch_scc1 L_gl_166
 s_branch L_bail
L_gld_167:
 s_waitcnt vmcnt(0)
 s_barrier
 s_mul_i32 s76, s50, 10
 s_and_b32 s3, s50, 1
 s_mul_i32 s3, s3, 2
 s_add_u32 s76, s76, s3
 s_add_u32 s76, s76, 0
 s_and_b32 s3, s76, 7
 s_lshl_b32 s3, s3, 5
 v_xor_b32 v6, s3, v4
 s_lshr_b32 s3, s76, 3
 s_lshl_b32 s3, s3, 15
 v_add_u32 v6, s3, v6
 v_xor_b32 v7, 128, v6
 ds_read_b64_tr_b16 v[32:33], v6 offset:0
 ds_read_b64_tr_b16 v[34:35], v6 offset:512
 ds_read_b64_tr_b16 v[36:37], v6 offset:2048
 ds_read_b64_tr_b16 v[38:39], v6 offset:2560
 ds_read_b64_tr_b16 v[48:49], v7 offset:8192
 ds_read_b64_tr_b16 v[50:51], v7 offset:8704
 ds_read_b64_tr_b16 v[52:53], v7 offset:10240
 ds_read_b64_tr_b16 v[54:55], v7 offset:10752
 ds_read_b64_tr_b16 v[64:65], v6 offset:16384
 ds_read_b64_tr_b16 v[66:67], v6 offset:16896
 ds_read_b64_tr_b16 v[68:69], v6 offset:18432
 ds_read_b64_tr_b16 v[70:71], v6 offset:18944
 ds_read_b64_tr_b16 v[136:137], v7 offset:24576
 ds_read_b64_tr_b16 v[138:139], v7 offset:25088
 ds_read_b64_tr_b16 v[140:141], v7 offset:26624
 ds_read_b64_tr_b16 v[142:143], v7 offset:27136
 s_mul_i32 s76, s50, 10
 s_and_b32 s3, s50, 1
 s_mul_i32 s3, s3, 2
 s_add_u32 s76, s76, s3
 s_add_u32 s76, s76, 2
 s_and_b32 s3, s76, 7
 s_lshl_b32 s3, s3, 5
 v_xor_b32 v6, s3, v4
 s_lshr_b32 s3, s76, 3
 s_lshl_b32 s3, s3, 15
 v_add_u32 v6, s3, v6
 v_xor_b32 v7, 128, v6
 ds_read_b64_tr_b16 v[40:41], v6 offset:0
 ds_read_b64_tr_b16 v[42:43], v6 offset:512
 ds_read_b64_tr_b16 v[44:45], v6 offset:2048
 ds_read_b64_tr_b16 v[46:47], v6 offset:2560
 ds_read_b64_tr_b16 v[56:57], v7 offset:8192
 ds_read_b64_tr_b16 v[58:59], v7 offset:8704
 ds_read_b64_tr_b16 v[60:61], v7 offset:10240
 ds_read_b64_tr_b16 v[62:63], v7 offset:10752
 ds_read_b64_tr_b16 v[128:129], v6 offset:16384
 ds_read_b64_tr_b16 v[130:131], v6 offset:16896
 ds_read_b64_tr_b16 v[132:133], v6 offset:18432
 ds_read_b64_tr_b16 v[134:135], v6 offset:18944
 ds_read_b64_tr_b16 v[144:145], v7 offset:24576
 ds_read_b64_tr_b16 v[146:147], v7 offset:25088
 ds_read_b64_tr_b16 v[148:149], v7 offset:26624
 ds_read_b64_tr_b16 v[150:151], v7 offset:27136
 s_mul_i32 s76, s50, 10
 s_and_b32 s3, s50, 1
 s_mul_i32 s3, s3, 2
 s_add_u32 s76, s76, s3
 s_add_u32 s76, s76, 4
 s_and_b32 s3, s76, 7
 s_lshl_b32 s3, s3, 5
 v_xor_b32 v6, s3, v4
 s_lshr_b32 s3, s76, 3
 s_lshl_b32 s3, s3, 15
 v_add_u32 v6, s3, v6
 v_xor_b32 v7, 128, v6
 ds_read_b64_tr_b16 v[152:153], v6 offset:0
 ds_read_b64_tr_b16 v[154:155], v6 offset:512
 ds_read_b64_tr_b16 v[156:157], v6 offset:2048
 ds_read_b64_tr_b16 v[158:159], v6 offset:2560
 ds_read_b64_tr_b16 v[168:169], v7 offset:8192
 ds_read_b64_tr_b16 v[170:171], v7 offset:8704
 ds_read_b64_tr_b16 v[172:173], v7 offset:10240
 ds_read_b64_tr_b16 v[174:175], v7 offset:10752
 ds_read_b64_tr_b16 v[184:185], v6 offset:16384
 ds_read_b64_tr_b16 v[186:187], v6 offset:16896
 ds_read_b64_tr_b16 v[188:189], v6 offset:18432
 ds_read_b64_tr_b16 v[190:191], v6 offset:18944
 ds_read_b64_tr_b16 v[80:81], v7 offset:24576
 ds_read_b64_tr_b16 v[82:83], v7 offset:25088
 ds_read_b64_tr_b16 v[84:85], v7 offset:26624
 ds_read_b64_tr_b16 v[86:87], v7 offset:27136
 s_mul_i32 s76, s50, 10
 s_and_b32 s3, s50, 1
 s_mul_i32 s3, s3, 2
 s_add_u32 s76, s76, s3
 s_add_u32 s76, s76, 6
 s_and_b32 s3, s76, 7
 s_lshl_b32 s3, s3, 5
 v_xor_b32 v6, s3, v4
 s_lshr_b32 s3, s76, 3
 s_lshl_b32 s3, s3, 15
 v_add_u32 v6, s3, v6
 v_xor_b32 v7, 128, v6
 ds_read_b64_tr_b16 v[160:161], v6 offset:0
 ds_read_b64_tr_b16 v[162:163], v6 offset:512
 ds_read_b64_tr_b16 v[164:165], v6 offset:2048
 ds_read_b64_tr_b16 v[166:167], v6 offset:2560
 ds_read_b64_tr_b16 v[176:177], v7 offset:8192
 ds_read_b64_tr_b16 v[178:179], v7 offset:8704
 ds_read_b64_tr_b16 v[180:181], v7 offset:10240
 ds_read_b64_tr_b16 v[182:183], v7 offset:10752
 ds_read_b64_tr_b16 v[72:73], v6 offset:16384
 ds_read_b64_tr_b16 v[74:75], v6 offset:16896
 ds_read_b64_tr_b16 v[76:77], v6 offset:18432
 ds_read_b64_tr_b16 v[78:79], v6 offset:18944
 ds_read_b64_tr_b16 v[88:89], v7 offset:24576
 ds_read_b64_tr_b16 v[90:91], v7 offset:25088
 ds_read_b64_tr_b16 v[92:93], v7 offset:26624
 ds_read_b64_tr_b16 v[94:95], v7 offset:27136
 s_mul_i32 s76, s50, 10
 s_and_b32 s3, s50, 1
 s_mul_i32 s3, s3, -8
 s_add_u32 s76, s76, s3
 s_add_u32 s76, s76, 8
 s_and_b32 s3, s76, 7
 s_lshl_b32 s3, s3, 5
 v_xor_b32 v6, s3, v4
 s_lshr_b32 s3, s76, 3
 s_lshl_b32 s3, s3, 15
 v_add_u32 v6, s3, v6
 v_xor_b32 v7, 128, v6
 ds_read_b64_tr_b16 v[96:97], v6 offset:0
 ds_read_b64_tr_b16 v[98:99], v6 offset:512
 ds_read_b64_tr_b16 v[100:101], v6 offset:2048
 ds_read_b64_tr_b16 v[102:103], v6 offset:2560
 ds_read_b64_tr_b16 v[104:105], v7 offset:8192
 ds_read_b64_tr_b16 v[106:107], v7 offset:8704
 ds_read_b64_tr_b16 v[108:109], v7 offset:10240
 ds_read_b64_tr_b16 v[110:111], v7 offset:10752
 ds_read_b64_tr_b16 v[112:113], v6 offset:16384
 ds_read_b64_tr_b16 v[114:115], v6 offset:16896
 ds_read_b64_tr_b16 v[116:117], v6 offset:18432
 ds_read_b64_tr_b16 v[118:119], v6 offset:18944
 ds_read_b64_tr_b16 v[120:121], v7 offset:24576
 ds_read_b64_tr_b16 v[122:123], v7 offset:25088
 ds_read_b64_tr_b16 v[124:125], v7 offset:26624
 ds_read_b64_tr_b16 v[126:127], v7 offset:27136
 v_lshlrev_b32 v1, 4, v0
 s_lshl_b32 s3, s50, 15
 s_add_u32 s3, s3, 32768
 v_add_u32 v15, s3, v1
 s_waitcnt lgkmcnt(0)
 s_barrier
 ds_write_b128 v15, v[224:227] offset:0
 ds_write_b128 v15, v[228:231] offset:1024
 ds_write_b128 v15, v[232:235] offset:2048
 ds_write_b128 v15, v[236:239] offset:3072
 ds_write_b128 v15, v[240:243] offset:4096
 ds_write_b128 v15, v[244:247] offset:5120
 ds_write_b128 v15, v[248:251] offset:6144
 ds_write_b128 v15, v[252:255] offset:7168
 ds_write_b128 v15, v[32:35] offset:8192
 ds_write_b128 v15, v[36:39] offset:9216
 ds_write_b128 v15, v[40:43] offset:10240
 ds_write_b128 v15, v[44:47] offset:11264
 ds_write_b128 v15, v[48:51] offset:12288
 ds_write_b128 v15, v[52:55] offset:13312
 ds_write_b128 v15, v[56:59] offset:14336
 ds_write_b128 v15, v[60:63] offset:15360
 ds_write_b128 v15, v[64:67] offset:16384
 ds_write_b128 v15, v[68:71] offset:17408
 ds_write_b128 v15, v[72:75] offset:18432
 ds_write_b128 v15, v[76:79] offset:19456
 ds_write_b128 v15, v[80:83] offset:20480
 ds_write_b128 v15, v[84:87] offset:21504
 ds_write_b128 v15, v[88:91] offset:22528
 ds_write_b128 v15, v[92:95] offset:23552
 ds_write_b128 v15, v[96:99] offset:24576
 ds_write_b128 v15, v[100:103] offset:25600
 ds_write_b128 v15, v[104:107] offset:26624
 ds_write_b128 v15, v[108:111] offset:27648
 ds_write_b128 v15, v[112:115] offset:28672
 ds_write_b128 v15, v[116:119] offset:29696
 ds_write_b128 v15, v[120:123] offset:30720
 ds_write_b128 v15, v[124:127] offset:31744
 s_xor_b32 s3, s81, 0
 s_and_b32 s3, s3, 1
 s_lshl_b32 s3, s3, 13
 s_add_u32 s56, s3, 4194304
 s_and_b32 s3, s48, 2
 s_lshl_b32 s3, s3, 15
 s_add_u32 s56, s56, s3
 s_xor_b32 s3, s81, 1
 s_and_b32 s3, s3, 1
 s_lshl_b32 s3, s3, 13
 s_add_u32 s57, s3, 6291456
 s_and_b32 s3, s48, 2
 s_lshl_b32 s3, s3, 15
 s_add_u32 s57, s57, s3
 s_xor_b32 s3, s81, 0
 s_and_b32 s3, s3, 1
 s_lshl_b32 s3, s3, 13
 s_add_u32 s58, s3, 8388608
 s_and_b32 s3, s48, 2
 s_lshl_b32 s3, s3, 15
 s_add_u32 s58, s58, s3
 s_xor_b32 s3, s81, 1
 s_and_b32 s3, s3, 1
 s_lshl_b32 s3, s3, 13
 s_add_u32 s59, s3, 10485760
 s_and_b32 s3, s48, 2
 s_lshl_b32 s3, s3, 15
 s_add_u32 s59, s59, s3
 v_lshrrev_b32 v2, 5, v0
 v_lshlrev_b32 v2, 15, v2
 v_bfe_u32 v14, v0, 2, 2
 v_lshl_add_u32 v2, v14, 8, v2
 v_bfe_u32 v14, v0, 4, 1
 v_lshl_add_u32 v2, v14, 6, v2
 v_and_b32 v14, 3, v0
 v_lshl_add_u32 v2, v14, 4, v2
 s_lshr_b32 s76, s50, 1
 s_and_b32 s77, s50, 1
 s_lshl_b32 s3, s76, 14
 v_add_u32 v2, s3, v2
 s_lshl_b32 s3, s77, 7
 s_add_u32 s3, s3, 2048
 v_add_u32 v3, s3, v2
 s_mul_i32 s3, s77, 3072
 v_add_u32 v2, s3, v2
 s_mul_i32 s76, s76, 5120
 s_add_u32 s3, s3, s76
 v_add_u32 v4, s3, v1
 s_lshl_b32 s3, s77, 3
 s_add_u32 s3, s3, s76
 s_add_u32 s3, s3, 2048
 v_add_u32 v5, s3, v1
 v_and_b32 v14, 2, v0
 v_cmp_eq_u32 vcc, 0, v14
 v_mov_b32 v17, 0xeeee
 v_mov_b32 v14, 0x4444
 s_nop 0
 v_cndmask_b32 v17, v17, v14, vcc
 s_lshl_b32 s78, s48, 4
 s_add_u32 s78, s78, s49
 s_lshl_b32 s32, s78, 8
 s_add_u32 s32, s32, 0
 s_mul_i32 s76, s78, 24576
 s_lshl_b32 s3, s50, 10
 s_add_u32 s77, s76, s3
 s_add_u32 s60, s77, 1736704
 s_add_u32 s61, s77, 1742848
 s_add_u32 s62, s77, 1748992
 s_add_u32 s63, s77, 1755136
 s_lshr_b32 s3, s50, 1
 s_lshl_b32 s3, s3, 10
 s_add_u32 s76, s76, s3
 s_and_b32 s3, s50, 1
 s_lshl_b32 s3, s3, 3
 s_add_u32 s76, s76, s3
 s_add_u32 s64, s76, 1740800
 s_add_u32 s65, s76, 1746944
 s_add_u32 s66, s76, 1753088
 s_add_u32 s67, s76, 1759232
 s_mul_i32 s76, s48, 327680
 s_lshl_b32 s3, s49, 8
 s_add_u32 s77, s76, s3
 s_lshr_b32 s3, s50, 1
 s_mul_i32 s3, s3, 81920
 s_add_u32 s77, s77, s3
 s_and_b32 s3, s50, 1
 s_mul_i32 s3, s3, 49152
 s_add_u32 s3, s3, s77
 s_add_u32 s68, s3, 425984
 s_add_u32 s69, s3, 442368
 s_and_b32 s3, s50, 1
 s_lshl_b32 s3, s3, 3
 s_add_u32 s3, s3, s77
 s_add_u32 s70, s3, 458752
 s_and_b32 s3, s50, 1
 s_mul_i32 s3, s3, 49152
 s_add_u32 s3, s3, s77
 s_add_u32 s71, s3, 589824
 s_add_u32 s72, s3, 606208
 s_and_b32 s3, s50, 1
 s_lshl_b32 s3, s3, 3
 s_add_u32 s3, s3, s77
 s_add_u32 s73, s3, 622592
 s_lshl_b32 s78, s49, 1
 s_and_b32 s3, s50, 1
 s_add_u32 s78, s78, s3
 s_lshr_b32 s55, s50, 1
 s_and_b32 s77, s49, 1
 s_lshl_b32 s77, s77, 2
 s_add_u32 s77, s77, s50
 s_add_u32 s3, s32, 128
 s_cmp_eq_u32 s77, 2
 s_cselect_b32 s17, s3, 268435456
 s_lshr_b32 s3, s49, 1
 s_add_u32 s3, s3, 32
 s_cmp_eq_u32 s77, 1
 s_cselect_b32 s78, s3, s78
 s_cselect_b32 s55, 1, s55
 s_lshl_b32 s3, s78, 12
 s_add_u32 s3, s3, s76
 s_add_u32 s74, s3, 425984
 s_add_u32 s75, s3, 589824
 v_add_u32 v12, 4096, v1
 v_lshrrev_b32 v14, 4, v0
 v_and_b32 v10, 15, v0
 v_lshlrev_b32 v6, 5, v10
 v_lshl_add_u32 v6, v14, 3, v6
 s_lshl_b32 s3, s50, 10
 v_add_u32 v6, s3, v6
 v_lshlrev_b32 v10, 4, v10
 v_lshl_add_u32 v10, v14, 12, v10
 v_lshlrev_b32 v7, 3, v0
 v_add_u32 v8, s3, v7
 s_lshl_b32 s3, s50, 11
 v_add_u32 v16, s3, v1
 s_lshr_b32 s3, s50, 1
 s_lshl_b32 s3, s3, 10
 s_and_b32 s77, s50, 1
 s_lshl_b32 s77, s77, 5
 s_add_u32 s3, s3, s77
 v_add_u32 v9, s3, v1
 v_lshlrev_b32 v11, 6, v14
 v_bfe_u32 v13, v0, 2, 1
 v_lshl_add_u32 v11, v13, 5, v11
 v_and_b32 v18, 1, v0
 v_lshl_add_u32 v11, v18, 4, v11
 s_lshl_b32 s3, s78, 8
 s_cmp_ge_u32 s78, 20
 s_cselect_b32 s77, 11264, 0
 s_add_u32 s3, s3, s77
 s_and_b32 s77, s48, 1
 s_lshl_b32 s77, s77, 15
 s_add_u32 s3, s3, s77
 s_cmp_eq_u32 s55, 0
 s_cselect_b32 s3, 268435456, s3
 v_add_u32 v11, s3, v11
 s_mov_b32 s8, s18
 s_and_b32 s9, s19, 0xffff
 s_mov_b32 s10, 10240
 s_mov_b32 s11, 0x00020000
 v_mul_u32_u24 v18, 1280, v18
 v_lshl_add_u32 v18, v13, 6, v18
 v_lshl_add_u32 v18, v14, 3, v18
 s_and_b32 s3, s78, 3
 s_mul_i32 s3, s3, 2560
 s_lshr_b32 s76, s78, 2
 s_lshl_b32 s76, s76, 7
 s_add_u32 s3, s3, s76
 s_add_u32 s3, s3, s77
 v_add_u32 v18, s3, v18
 buffer_load_dwordx2 v[20:21], v18, s[8:11], 0 offen
 buffer_load_dwordx2 v[22:23], v18, s[8:11], 0 offen offset:32
 buffer_load_dword v14, off, s[4:7], s32 sc1
 s_mov_b32 s28, 0x33333333
 s_mov_b32 s29, 0x33333333
 s_mov_b32 s30, 0x00330033
 s_mov_b32 s31, 0x00330033
 s_mov_b32 s79, 0x3e0293ee
 s_and_b32 s100, s52, 1
 s_lshl_b32 s100, s100, 13
 s_lshl_b32 s54, s52, 14
 s_add_u32 s54, s54, s100
 s_lshr_b32 s3, s48, 1
 s_mul_i32 s3, s3, 33554432
 s_add_u32 s54, s54, s3
 s_add_u32 s54, s54, 16777216
 s_waitcnt vmcnt(0) lgkmcnt(0)
 s_mov_b64 exec, s[30:31]
 buffer_store_dwordx4 v[20:23], v11, s[4:7], s56 offen sc1
 s_mov_b64 exec, -1
 v_mov_b32 v32, -1
 v_mov_b32 v28, 0x3f803f80
 v_mov_b32 v36, 0
 v_mov_b32 v33, -1
 v_mov_b32 v29, 0x3f803f80
 v_mov_b32 v37, 0
 v_mov_b32 v34, -1
 v_mov_b32 v30, 0x3f803f80
 v_mov_b32 v38, 0
 v_mov_b32 v35, -1
 v_mov_b32 v31, 0x3f803f80
 v_mov_b32 v39, 0
 v_mov_b32 v88, 0
 v_mov_b32 v89, 0
 v_mov_b32 v90, 0
 v_mov_b32 v91, 0
 v_mov_b32 v92, 0
 v_mov_b32 v93, 0
 v_mov_b32 v94, 0
 v_mov_b32 v95, 0
 v_mov_b32 v96, 0
 v_mov_b32 v97, 0
 v_mov_b32 v98, 0
 v_mov_b32 v99, 0
 v_mov_b32 v100, 0
 v_mov_b32 v101, 0
 v_mov_b32 v102, 0
 v_mov_b32 v103, 0
 v_and_b32 v18, 7, v0
 v_lshrrev_b32 v13, 1, v0
 v_xor_b32 v13, v13, v0
 v_and_b32 v13, 8, v13
 v_or_b32 v18, v18, v13
 v_mov_b32 v24, 0
 v_cmp_eq_u32 vcc, 0, v18
 v_mov_b32 v13, 0x3f80
 s_nop 1
 v_cndmask_b32 v24, v24, v13, vcc
 v_cmp_eq_u32 vcc, 1, v18
 v_mov_b32 v13, 0x3f800000
 s_nop 1
 v_cndmask_b32 v24, v24, v13, vcc
 v_mov_b32 v25, 0
 v_cmp_eq_u32 vcc, 2, v18
 v_mov_b32 v13, 0x3f80
 s_nop 1
 v_cndmask_b32 v25, v25, v13, vcc
 v_cmp_eq_u32 vcc, 3, v18
 v_mov_b32 v13, 0x3f800000
 s_nop 1
 v_cndmask_b32 v25, v25, v13, vcc
 v_mov_b32 v26, 0
 v_cmp_eq_u32 vcc, 4, v18
 v_mov_b32 v13, 0x3f80
 s_nop 1
 v_cndmask_b32 v26, v26, v13, vcc
 v_cmp_eq_u32 vcc, 5, v18
 v_mov_b32 v13, 0x3f800000
 s_nop 1
 v_cndmask_b32 v26, v26, v13, vcc
 v_mov_b32 v27, 0
 v_cmp_eq_u32 vcc, 6, v18
 v_mov_b32 v13, 0x3f80
 s_nop 1
 v_cndmask_b32 v27, v27, v13, vcc
 v_cmp_eq_u32 vcc, 7, v18
 v_mov_b32 v13, 0x3f800000
 s_nop 1
 v_cndmask_b32 v27, v27, v13, vcc
 s_waitcnt vmcnt(0)
 v_and_b32 v18, 7, v0
 v_mov_b32 v20, 0
 v_cmp_eq_u32 vcc, 0, v18
 v_mov_b32 v13, 0x3f80
 s_nop 1
 v_cndmask_b32 v20, v20, v13, vcc
 v_cmp_eq_u32 vcc, 1, v18
 v_mov_b32 v13, 0x3f800000
 s_nop 1
 v_cndmask_b32 v20, v20, v13, vcc
 v_mov_b32 v21, 0
 v_cmp_eq_u32 vcc, 2, v18
 v_mov_b32 v13, 0x3f80
 s_nop 1
 v_cndmask_b32 v21, v21, v13, vcc
 v_cmp_eq_u32 vcc, 3, v18
 v_mov_b32 v13, 0x3f800000
 s_nop 1
 v_cndmask_b32 v21, v21, v13, vcc
 v_mov_b32 v22, 0
 v_cmp_eq_u32 vcc, 4, v18
 v_mov_b32 v13, 0x3f80
 s_nop 1
 v_cndmask_b32 v22, v22, v13, vcc
 v_cmp_eq_u32 vcc, 5, v18
 v_mov_b32 v13, 0x3f800000
 s_nop 1
 v_cndmask_b32 v22, v22, v13, vcc
 v_mov_b32 v23, 0
 v_cmp_eq_u32 vcc, 6, v18
 v_mov_b32 v13, 0x3f80
 s_nop 1
 v_cndmask_b32 v23, v23, v13, vcc
 v_cmp_eq_u32 vcc, 7, v18
 v_mov_b32 v13, 0x3f800000
 s_nop 1
 v_cndmask_b32 v23, v23, v13, vcc
 v_mov_b32 v18, 0
 v_mov_b32 v19, 0
 v_and_b32 v0, -33, v1
 v_mov_b32 v13, 1
 s_mov_b32 s53, -1
 s_mov_b32 s51, 0
 s_cmp_lg_u32 s50, 0
 s_cbranch_scc1 L_k0_168
 s_add_u32 s76, s53, 1
L_fl_169:
 v_cmp_ge_u32 vcc, s76, v14
 s_cbranch_vccz L_fld_170
 buffer_load_dword v14, off, s[4:7], s32 sc1
 s_waitcnt vmcnt(0)
 s_add_u32 s51, s51, 1
 s_cmp_lt_u32 s51, 131072
 s_cbranch_scc1 L_fl_169
 s_branch L_bail
L_fld_170:
 s_lshl_b32 s16, s76, 19
 s_add_u32 s16, s16, s54
 s_mov_b32 m0, 10240
 s_nop 0
 buffer_load_dwordx4 v1, s[4:7], s16 offen offset:0 sc1 lds
 buffer_load_dwordx4 v1, s[4:7], s16 offen offset:1024 sc1 lds
 buffer_load_dwordx4 v1, s[4:7], s16 offen offset:2048 sc1 lds
 buffer_load_dwordx4 v1, s[4:7], s16 offen offset:3072 sc1 lds
 s_mov_b32 m0, 14336
 s_nop 0
 buffer_load_dwordx4 v12, s[4:7], s16 offen offset:0 sc1 lds
 buffer_load_dwordx4 v12, s[4:7], s16 offen offset:1024 sc1 lds
 buffer_load_dwordx4 v12, s[4:7], s16 offen offset:2048 sc1 lds
 buffer_load_dwordx4 v12, s[4:7], s16 offen offset:3072 sc1 lds
 s_add_u32 s16, s16, 67108864
 s_mov_b32 m0, 18432
 s_nop 0
 buffer_load_dwordx4 v1, s[4:7], s16 offen offset:0 sc1 lds
 buffer_load_dwordx4 v1, s[4:7], s16 offen offset:1024 sc1 lds
 buffer_load_dwordx4 v1, s[4:7], s16 offen offset:2048 sc1 lds
 buffer_load_dwordx4 v1, s[4:7], s16 offen offset:3072 sc1 lds
 s_mov_b32 m0, 22528
 s_nop 0
 buffer_load_dwordx4 v12, s[4:7], s16 offen offset:0 sc1 lds
 buffer_load_dwordx4 v12, s[4:7], s16 offen offset:1024 sc1 lds
 buffer_load_dwordx4 v12, s[4:7], s16 offen offset:2048 sc1 lds
 buffer_load_dwordx4 v12, s[4:7], s16 offen offset:3072 sc1 lds
L_k0_168:
 s_mov_b32 s53, 0
 s_cmp_lg_u32 s80, 0
 s_cbranch_scc1 L_ch_loops
.p2align 8
L_ch_loopf:
 s_mov_b32 s51, 0
 buffer_load_dwordx4 v[40:43], v2, s[4:7], s56 offen offset:0 sc1
 buffer_load_dwordx4 v[44:47], v2, s[4:7], s56 offen offset:128 sc1
 buffer_load_dwordx4 v[48:51], v2, s[4:7], s56 offen offset:1024 sc1
 buffer_load_dwordx4 v[52:55], v2, s[4:7], s56 offen offset:1152 sc1
 buffer_load_dwordx4 v[56:59], v3, s[4:7], s56 offen offset:0 sc1
L_xm_171:
 s_waitcnt vmcnt(4)
 v_mfma_f32_16x16x32_bf16 v[60:63], v[24:27], v[40:43], 0
 s_waitcnt vmcnt(3)
 v_mfma_f32_16x16x32_bf16 v[64:67], v[24:27], v[44:47], 0
 s_waitcnt vmcnt(2)
 v_mfma_f32_16x16x32_bf16 v[68:71], v[24:27], v[48:51], 0
 v_max3_u32 v14, v40, v44, v48
 v_cvt_pk_bf16_f32 v60, v60, v61
 v_cvt_pk_bf16_f32 v61, v62, v63
 ds_write_b64 v4, v[60:61] offset:0
 s_waitcnt vmcnt(1)
 v_mfma_f32_16x16x32_bf16 v[72:75], v[24:27], v[52:55], 0
 v_cvt_pk_bf16_f32 v64, v64, v65
 v_cvt_pk_bf16_f32 v65, v66, v67
 ds_write_b64 v4, v[64:65] offset:8
 s_waitcnt vmcnt(0)
 v_mfma_f32_16x16x32_bf16 v[76:79], v[24:27], v[56:59], 0
 v_max3_u32 v14, v14, v52, v56
 v_cmp_eq_u32 vcc, -1, v14
 v_cvt_pk_bf16_f32 v68, v68, v69
 v_cvt_pk_bf16_f32 v69, v70, v71
 ds_write_b64 v4, v[68:69] offset:1024
 s_cbranch_vccnz L_rt_172
 v_cvt_pk_bf16_f32 v72, v72, v73
 v_cvt_pk_bf16_f32 v73, v74, v75
 ds_write_b64 v4, v[72:73] offset:1032
 s_nop 0
 v_cvt_pk_bf16_f32 v76, v76, v77
 v_cvt_pk_bf16_f32 v77, v78, v79
 ds_write_b64 v5, v[76:77] offset:0
 s_waitcnt lgkmcnt(0)
 s_barrier
 ds_read_b128 v[72:75], v0 offset:0
 ds_read_b128 v[76:79], v0 offset:32
 ds_read_b128 v[80:83], v0 offset:1024
 s_mov_b64 exec, s[30:31]
 buffer_store_dwordx4 v[32:35], v11, s[4:7], s59 offen sc1
 s_mov_b64 exec, -1
 buffer_store_dwordx4 v[32:35], v1, s[4:7], s62 offen
 s_waitcnt lgkmcnt(2)
 v_smfmac_f32_16x16x64_bf16 v[88:91], v[72:75], v[224:231], v17
 ds_read_b128 v[84:87], v0 offset:1056
 v_smfmac_f32_16x16x64_bf16 v[92:95], v[72:75], v[232:239], v17
 ds_read_b128 v[96:99], v0 offset:2048
 s_waitcnt lgkmcnt(3)
 v_smfmac_f32_16x16x64_bf16 v[88:91], v[76:79], v[240:247], v17
 ds_read_b128 v[100:103], v0 offset:2080
 v_smfmac_f32_16x16x64_bf16 v[92:95], v[76:79], v[248:255], v17
 ds_read_b128 v[112:115], v0 offset:3072
 s_waitcnt lgkmcnt(4)
 v_smfmac_f32_16x16x64_bf16 v[88:91], v[80:83], v[192:199], v17
 ds_read_b128 v[40:43], v1 offset:10240
 v_smfmac_f32_16x16x64_bf16 v[92:95], v[80:83], v[200:207], v17
 ds_read_b128 v[116:119], v0 offset:3104
 s_waitcnt lgkmcnt(5)
 v_smfmac_f32_16x16x64_bf16 v[88:91], v[84:87], v[208:215], v17
 ds_read_b128 v[44:47], v1 offset:11264
 v_smfmac_f32_16x16x64_bf16 v[92:95], v[84:87], v[216:223], v17
 ds_read_b128 v[72:75], v0 offset:4096
 s_waitcnt lgkmcnt(6)
 v_smfmac_f32_16x16x64_bf16 v[88:91], v[96:99], a[0:7], v17
 ds_read_b128 v[48:51], v1 offset:12288
 v_smfmac_f32_16x16x64_bf16 v[92:95], v[96:99], a[8:15], v17
 ds_read_b128 v[76:79], v0 offset:4128
 s_waitcnt lgkmcnt(7)
 v_smfmac_f32_16x16x64_bf16 v[88:91], v[100:103], a[16:23], v17
 ds_read_b128 v[52:55], v1 offset:13312
 v_smfmac_f32_16x16x64_bf16 v[92:95], v[100:103], a[24:31], v17
 ds_read_b128 v[80:83], v0 offset:5120
 s_waitcnt lgkmcnt(8)
 v_smfmac_f32_16x16x64_bf16 v[88:91], v[112:115], a[32:39], v17
 ds_read_b128 v[56:59], v1 offset:14336
 v_smfmac_f32_16x16x64_bf16 v[92:95], v[112:115], a[40:47], v17
 ds_read_b128 v[84:87], v0 offset:5152
 s_waitcnt lgkmcnt(8)
 v_smfmac_f32_16x16x64_bf16 v[88:91], v[116:119], a[48:55], v17
 ds_read_b128 v[60:63], v1 offset:15360
 v_smfmac_f32_16x16x64_bf16 v[92:95], v[116:119], a[56:63], v17
 ds_read_b128 v[96:99], v0 offset:6144
 s_waitcnt lgkmcnt(8)
 v_smfmac_f32_16x16x64_bf16 v[88:91], v[72:75], a[64:71], v17
 ds_read_b128 v[64:67], v1 offset:16384
 v_smfmac_f32_16x16x64_bf16 v[92:95], v[72:75], a[72:79], v17
 ds_read_b128 v[100:103], v0 offset:6176
 s_waitcnt lgkmcnt(8)
 v_smfmac_f32_16x16x64_bf16 v[88:91], v[76:79], a[80:87], v17
 ds_read_b128 v[68:71], v1 offset:17408
 v_smfmac_f32_16x16x64_bf16 v[92:95], v[76:79], a[88:95], v17
 ds_read_b128 v[112:115], v0 offset:7168
 s_waitcnt lgkmcnt(8)
 v_smfmac_f32_16x16x64_bf16 v[88:91], v[80:83], a[96:103], v17
 ds_read_b128 v[104:107], v16 offset:18432
 v_smfmac_f32_16x16x64_bf16 v[92:95], v[80:83], a[104:111], v17
 ds_read_b128 v[116:119], v0 offset:7200
 s_waitcnt lgkmcnt(8)
 v_smfmac_f32_16x16x64_bf16 v[88:91], v[84:87], a[112:119], v17
 ds_read_b128 v[108:111], v16 offset:19456
 v_smfmac_f32_16x16x64_bf16 v[92:95], v[84:87], a[120:127], v17
 ds_read_b128 v[72:75], v0 offset:8192
 s_waitcnt lgkmcnt(8)
 v_smfmac_f32_16x16x64_bf16 v[88:91], v[96:99], a[128:135], v17
 ds_read_b128 v[224:227], v15 offset:8192
 v_smfmac_f32_16x16x64_bf16 v[92:95], v[96:99], a[136:143], v17
 ds_read_b128 v[76:79], v0 offset:8224
 s_waitcnt lgkmcnt(8)
 v_smfmac_f32_16x16x64_bf16 v[88:91], v[100:103], a[144:151], v17
 ds_read_b128 v[228:231], v15 offset:9216
 v_smfmac_f32_16x16x64_bf16 v[92:95], v[100:103], a[152:159], v17
 ds_read_b128 v[80:83], v0 offset:9216
 s_waitcnt lgkmcnt(8)
 v_smfmac_f32_16x16x64_bf16 v[88:91], v[112:115], a[160:167], v17
 ds_read_b128 v[232:235], v15 offset:10240
 v_smfmac_f32_16x16x64_bf16 v[92:95], v[112:115], a[168:175], v17
 ds_read_b128 v[84:87], v0 offset:9248
 s_waitcnt lgkmcnt(8)
 v_smfmac_f32_16x16x64_bf16 v[88:91], v[116:119], a[176:183], v17
 ds_read_b128 v[236:239], v15 offset:11264
 v_smfmac_f32_16x16x64_bf16 v[92:95], v[116:119], a[184:191], v17
 ds_read_b128 v[240:243], v15 offset:12288
 s_waitcnt lgkmcnt(8)
 v_smfmac_f32_16x16x64_bf16 v[88:91], v[72:75], a[192:199], v17
 ds_read_b128 v[244:247], v15 offset:13312
 v_smfmac_f32_16x16x64_bf16 v[92:95], v[72:75], a[200:207], v17
 ds_read_b128 v[248:251], v15 offset:14336
 s_waitcnt lgkmcnt(8)
 v_smfmac_f32_16x16x64_bf16 v[88:91], v[76:79], a[208:215], v17
 ds_read_b128 v[252:255], v15 offset:15360
 v_smfmac_f32_16x16x64_bf16 v[92:95], v[76:79], a[216:223], v17
 s_waitcnt lgkmcnt(7)
 v_smfmac_f32_16x16x64_bf16 v[88:91], v[80:83], a[224:231], v17
 v_smfmac_f32_16x16x64_bf16 v[92:95], v[80:83], a[232:239], v17
 s_waitcnt lgkmcnt(5)
 v_smfmac_f32_16x16x64_bf16 v[88:91], v[84:87], a[240:247], v17
 v_smfmac_f32_16x16x64_bf16 v[92:95], v[84:87], a[248:255], v17
 s_nop 2
 v_cvt_pk_bf16_f32 v120, v88, v89
 v_cvt_pk_bf16_f32 v121, v90, v91
 ds_write_b64 v6, v[120:121] offset:26624
 s_nop 1
 v_cvt_pk_bf16_f32 v122, v92, v93
 v_cvt_pk_bf16_f32 v123, v94, v95
 ds_write_b64 v6, v[122:123] offset:27136
 s_waitcnt lgkmcnt(0)
 s_barrier
 ds_read_b64_tr_b16 v[72:73], v7 offset:26624
 ds_read_b64_tr_b16 v[74:75], v7 offset:27136
 ds_read_b64_tr_b16 v[76:77], v7 offset:27648
 ds_read_b64_tr_b16 v[78:79], v7 offset:28160
 ds_read_b64_tr_b16 v[80:81], v7 offset:28672
 ds_read_b64_tr_b16 v[82:83], v7 offset:29184
 ds_read_b64_tr_b16 v[84:85], v7 offset:29696
 ds_read_b64_tr_b16 v[86:87], v7 offset:30208
 ds_read_b64_tr_b16 v[112:113], v8 offset:26624
 ds_read_b64_tr_b16 v[114:115], v8 offset:27136
 s_waitcnt lgkmcnt(8)
 v_mfma_f32_16x16x32_bf16 v[92:95], v[40:43], v[72:75], 0
 v_mfma_f32_16x16x32_bf16 v[96:99], v[56:59], v[72:75], 0
 v_mfma_f32_16x16x32_bf16 v[88:91], v[72:75], v[72:75], 0
 s_waitcnt lgkmcnt(6)
 v_mfma_f32_16x16x32_bf16 v[92:95], v[44:47], v[76:79], v[92:95]
 v_mfma_f32_16x16x32_bf16 v[96:99], v[60:63], v[76:79], v[96:99]
 v_mfma_f32_16x16x32_bf16 v[88:91], v[76:79], v[76:79], v[88:91]
 s_waitcnt lgkmcnt(4)
 v_mfma_f32_16x16x32_bf16 v[92:95], v[48:51], v[80:83], v[92:95]
 buffer_load_dwordx2 v[124:125], v1, s[4:7], s64 offen sc1
 v_mfma_f32_16x16x32_bf16 v[96:99], v[64:67], v[80:83], v[96:99]
 v_mfma_f32_16x16x32_bf16 v[88:91], v[80:83], v[80:83], v[88:91]
 s_waitcnt lgkmcnt(0)
 buffer_store_dwordx4 v[112:115], v1, s[4:7], s60 offen
 s_waitcnt lgkmcnt(2)
 v_mfma_f32_16x16x32_bf16 v[92:95], v[52:55], v[84:87], v[92:95]
 v_mfma_f32_16x16x32_bf16 v[96:99], v[68:71], v[84:87], v[96:99]
 v_mfma_f32_16x16x32_bf16 v[88:91], v[84:87], v[84:87], v[88:91]
 v_mfma_f32_32x32x8_bf16 v[40:55], v[18:19], v[18:19], 0
 v_max3_f32 v126, v92, v93, v94
 ds_read_b128 v[80:83], v15 offset:16384
 ds_read_b128 v[84:87], v15 offset:17408
 v_max3_f32 v126, v126, v95, v96
 v_max3_f32 v126, v126, v97, v98
 v_max3_f32 v126, v126, v99, v90
 v_max_f32 v126, v126, v91
 v_mov_b32 v127, v126
 v_mov_b64 v[56:57], 0
 v_mov_b64 v[58:59], 0
 v_permlane16_swap_b32 v126, v127
 v_max_f32 v126, v126, v127
 v_mov_b32 v127, v126
 s_nop 1
 v_permlane32_swap_b32 v126, v127
 v_max_f32 v126, v126, v127
 v_mul_f32 v126, s79, v126
 v_fma_f32 v92, v92, s79, -v126
 v_fma_f32 v93, v93, s79, -v126
 v_fma_f32 v94, v94, s79, -v126
 v_fma_f32 v95, v95, s79, -v126
 v_fma_f32 v96, v96, s79, -v126
 v_fma_f32 v97, v97, s79, -v126
 v_fma_f32 v98, v98, s79, -v126
 v_fma_f32 v99, v99, s79, -v126
 v_exp_f32 v92, v92
 v_exp_f32 v93, v93
 v_exp_f32 v94, v94
 v_exp_f32 v95, v95
 v_exp_f32 v96, v96
 v_exp_f32 v97, v97
 v_exp_f32 v98, v98
 v_exp_f32 v99, v99
 v_fma_f32 v90, v90, s79, -v126
 v_cvt_pk_bf16_f32 v100, v92, v93
 v_cvt_pk_bf16_f32 v101, v94, v95
 v_cvt_pk_bf16_f32 v102, v96, v97
 v_cvt_pk_bf16_f32 v103, v98, v99
 v_fma_f32 v91, v91, s79, -v126
 v_exp_f32 v90, v90
 v_mfma_f32_16x16x32_bf16 v[120:123], v[28:31], v[100:103], 0
 v_exp_f32 v91, v91
 v_mfma_f32_16x16x32_bf16 v[112:115], v[104:107], v[100:103], 0
 v_cvt_pk_bf16_f32 v36, v90, v91
 v_cvt_pk_bf16_f32 v39, v90, v91
 v_mfma_f32_16x16x32_bf16 v[116:119], v[108:111], v[100:103], 0
 s_waitcnt vmcnt(0)
 v_mfma_f32_16x16x16_bf16 v[120:123], v[28:29], v[36:37], v[120:123]
L_pv_173:
 v_cmp_eq_u32 vcc, -1, v124
 s_cbranch_vccnz L_rt_174
 v_mfma_f32_16x16x16_bf16 v[112:115], v[124:125], v[36:37], v[112:115]
 v_mfma_f32_16x16x16_bf16 v[116:119], v[124:125], v[38:39], v[116:119]
 v_rcp_f32 v120, v120
 ds_read_b128 v[88:91], v15 offset:18432
 ds_read_b128 v[92:95], v15 offset:19456
 ds_read_b128 v[96:99], v15 offset:20480
 ds_read_b128 v[100:103], v15 offset:21504
 s_mov_b64 exec, s[28:29]
 v_pk_mul_f32 v[112:113], v[112:113], v[120:121] op_sel_hi:[1,0]
 v_pk_mul_f32 v[114:115], v[114:115], v[120:121] op_sel_hi:[1,0]
 v_cvt_pk_bf16_f32 v112, v112, v113
 v_cvt_pk_bf16_f32 v113, v114, v115
 v_pk_mul_f32 v[116:117], v[116:117], v[120:121] op_sel_hi:[1,0]
 v_pk_mul_f32 v[118:119], v[118:119], v[120:121] op_sel_hi:[1,0]
 v_cvt_pk_bf16_f32 v114, v116, v117
 v_cvt_pk_bf16_f32 v115, v118, v119
 ds_write_b128 v9, v[112:115] offset:30720
 s_mov_b64 exec, -1
 s_waitcnt lgkmcnt(0)
 s_barrier
 ds_read_b128 v[60:63], v0 offset:30720
 ds_read_b128 v[64:67], v0 offset:30752
 ds_read_b128 v[68:71], v0 offset:31744
 ds_read_b128 v[72:75], v0 offset:31776
 s_waitcnt lgkmcnt(3)
 v_smfmac_f32_16x16x64_bf16 v[40:43], v[60:63], v[224:231], v17
 ds_read_b128 v[224:227], v15 offset:22528
 v_smfmac_f32_16x16x64_bf16 v[44:47], v[60:63], v[232:239], v17
 ds_read_b128 v[228:231], v15 offset:23552
 s_waitcnt lgkmcnt(4)
 v_smfmac_f32_16x16x64_bf16 v[40:43], v[64:67], v[240:247], v17
 ds_read_b128 v[232:235], v15 offset:24576
 v_smfmac_f32_16x16x64_bf16 v[44:47], v[64:67], v[248:255], v17
 ds_read_b128 v[236:239], v15 offset:25600
 s_waitcnt lgkmcnt(5)
 v_smfmac_f32_16x16x64_bf16 v[40:43], v[68:71], v[80:87], v17
 ds_read_b128 v[240:243], v15 offset:26624
 v_smfmac_f32_16x16x64_bf16 v[44:47], v[68:71], v[128:135], v17
 ds_read_b128 v[244:247], v15 offset:27648
 s_waitcnt lgkmcnt(6)
 v_smfmac_f32_16x16x64_bf16 v[40:43], v[72:75], v[136:143], v17
 ds_read_b128 v[248:251], v15 offset:28672
 v_smfmac_f32_16x16x64_bf16 v[44:47], v[72:75], v[144:151], v17
 ds_read_b128 v[252:255], v15 offset:29696
 v_smfmac_f32_16x16x64_bf16 v[48:51], v[60:63], v[152:159], v17
 ds_read_b128 v[80:83], v15 offset:30720
 v_cvt_pk_bf16_f32 v116, v40, v41
 v_cvt_pk_bf16_f32 v117, v42, v43
 v_or_b32 v116, 1, v116
 v_smfmac_f32_16x16x64_bf16 v[52:55], v[60:63], v[160:167], v17
 ds_read_b128 v[84:87], v15 offset:31744
 v_cvt_pk_bf16_f32 v118, v44, v45
 v_cvt_pk_bf16_f32 v119, v46, v47
 v_or_b32 v118, 1, v118
 buffer_store_dwordx4 v[116:119], v10, s[4:7], s68 offen
 v_smfmac_f32_16x16x64_bf16 v[48:51], v[64:67], v[168:175], v17
 v_smfmac_f32_16x16x64_bf16 v[52:55], v[64:67], v[176:183], v17
 v_smfmac_f32_16x16x64_bf16 v[48:51], v[68:71], v[184:191], v17
 v_smfmac_f32_16x16x64_bf16 v[52:55], v[68:71], v[88:95], v17
 v_smfmac_f32_16x16x64_bf16 v[48:51], v[72:75], v[96:103], v17
 s_waitcnt lgkmcnt(8)
 v_smfmac_f32_16x16x64_bf16 v[52:55], v[72:75], v[224:231], v17
 s_waitcnt lgkmcnt(6)
 v_smfmac_f32_16x16x64_bf16 v[56:59], v[60:63], v[232:239], v17
 v_cvt_pk_bf16_f32 v120, v48, v49
 v_cvt_pk_bf16_f32 v121, v50, v51
 v_or_b32 v120, 1, v120
 s_waitcnt lgkmcnt(4)
 v_smfmac_f32_16x16x64_bf16 v[56:59], v[64:67], v[240:247], v17
 v_cvt_pk_bf16_f32 v122, v52, v53
 v_cvt_pk_bf16_f32 v123, v54, v55
 v_or_b32 v122, 1, v122
 buffer_store_dwordx4 v[120:123], v10, s[4:7], s69 offen
 s_waitcnt lgkmcnt(2)
 v_smfmac_f32_16x16x64_bf16 v[56:59], v[68:71], v[248:255], v17
 s_waitcnt lgkmcnt(0)
 v_smfmac_f32_16x16x64_bf16 v[56:59], v[72:75], v[80:87], v17
 s_nop 7
 v_cvt_pk_bf16_f32 v124, v56, v57
 v_cvt_pk_bf16_f32 v125, v58, v59
 v_or_b32 v124, 1, v124
 buffer_store_dwordx2 v[124:125], v10, s[4:7], s70 offen
 ds_read_b128 v[224:227], v15 offset:0
 ds_read_b128 v[228:231], v15 offset:1024
 ds_read_b128 v[232:235], v15 offset:2048
 ds_read_b128 v[236:239], v15 offset:3072
 ds_read_b128 v[240:243], v15 offset:4096
 ds_read_b128 v[244:247], v15 offset:5120
 ds_read_b128 v[248:251], v15 offset:6144
 ds_read_b128 v[252:255], v15 offset:7168
 v_mov_b64 v[88:89], 0
 v_mov_b64 v[90:91], 0
 v_mov_b64 v[92:93], 0
 v_mov_b64 v[94:95], 0
 s_cmp_eq_u32 s55, 0
 s_cbranch_scc1 L_nr_175
 s_nop 15
 s_nop 15
 s_nop 15
 s_nop 15
 s_nop 15
L_pp_177:
 buffer_load_dwordx4 v[40:43], v1, s[4:7], s74 offen offset:0 sc1
 buffer_load_dwordx4 v[44:47], v1, s[4:7], s74 offen offset:1024 sc1
 buffer_load_dwordx4 v[48:51], v1, s[4:7], s74 offen offset:2048 sc1
 buffer_load_dwordx4 v[52:55], v1, s[4:7], s74 offen offset:3072 sc1
 s_waitcnt vmcnt(3)
 v_mfma_f32_16x16x32_bf16 v[56:59], v[40:43], v[20:23], 0
 v_and_b32 v14, v40, v42
 s_waitcnt vmcnt(2)
 v_mfma_f32_16x16x32_bf16 v[56:59], v[44:47], v[20:23], v[56:59]
 v_bitop3_b32 v14, v14, v44, v46 bitop3:0x80
 s_waitcnt vmcnt(1)
 v_mfma_f32_16x16x32_bf16 v[56:59], v[48:51], v[20:23], v[56:59]
 v_bitop3_b32 v14, v14, v48, v50 bitop3:0x80
 s_waitcnt vmcnt(0)
 v_mfma_f32_16x16x32_bf16 v[56:59], v[52:55], v[20:23], v[56:59]
 v_bitop3_b32 v14, v14, v52, v54 bitop3:0x80
 v_and_b32 v14, 1, v14
 v_cmp_ne_u32 vcc, 1, v14
 s_cbranch_vccnz L_rt_178
 s_nop 2
 v_cvt_pk_bf16_f32 v60, v56, v57
 v_cvt_pk_bf16_f32 v61, v58, v59
 s_nop 0
 v_mov_b32_dpp v62, v60 quad_perm:[2,3,2,3] row_mask:0xf bank_mask:0xf
 v_mov_b32_dpp v63, v61 quad_perm:[2,3,2,3] row_mask:0xf bank_mask:0xf
 s_mov_b64 exec, s[30:31]
 buffer_store_dwordx4 v[60:63], v11, s[4:7], s57 offen sc1
 s_mov_b64 exec, 1
 buffer_store_dword v13, off, s[4:7], s17
 s_mov_b64 exec, -1
 s_barrier
 s_nop 15
 s_nop 15
 s_nop 15
 s_nop 15
 s_nop 15
 s_nop 15
 s_nop 15
 s_nop 15
 s_nop 15
L_rj_176:
 v_add_u32 v13, 1, v13
 s_add_u32 s53, s53, 1
.p2align 3
 s_mov_b32 s51, 0
 buffer_load_dwordx4 v[40:43], v2, s[4:7], s57 offen offset:0 sc1
 buffer_load_dwordx4 v[44:47], v2, s[4:7], s57 offen offset:128 sc1
 buffer_load_dwordx4 v[48:51], v2, s[4:7], s57 offen offset:1024 sc1
 buffer_load_dwordx4 v[52:55], v2, s[4:7], s57 offen offset:1152 sc1
 buffer_load_dwordx4 v[56:59], v3, s[4:7], s57 offen offset:0 sc1
L_xm_179:
 s_waitcnt vmcnt(4)
 v_mfma_f32_16x16x32_bf16 v[60:63], v[24:27], v[40:43], 0
 s_waitcnt vmcnt(3)
 v_mfma_f32_16x16x32_bf16 v[64:67], v[24:27], v[44:47], 0
 s_waitcnt vmcnt(2)
 v_mfma_f32_16x16x32_bf16 v[68:71], v[24:27], v[48:51], 0
 v_max3_u32 v14, v40, v44, v48
 v_cvt_pk_bf16_f32 v60, v60, v61
 v_cvt_pk_bf16_f32 v61, v62, v63
 ds_write_b64 v4, v[60:61] offset:0
 s_waitcnt vmcnt(1)
 v_mfma_f32_16x16x32_bf16 v[72:75], v[24:27], v[52:55], 0
 v_cvt_pk_bf16_f32 v64, v64, v65
 v_cvt_pk_bf16_f32 v65, v66, v67
 ds_write_b64 v4, v[64:65] offset:8
 s_waitcnt vmcnt(0)
 v_mfma_f32_16x16x32_bf16 v[76:79], v[24:27], v[56:59], 0
 v_max3_u32 v14, v14, v52, v56
 v_cmp_eq_u32 vcc, -1, v14
 v_cvt_pk_bf16_f32 v68, v68, v69
 v_cvt_pk_bf16_f32 v69, v70, v71
 ds_write_b64 v4, v[68:69] offset:1024
 s_cbranch_vccnz L_rt_180
 v_cvt_pk_bf16_f32 v72, v72, v73
 v_cvt_pk_bf16_f32 v73, v74, v75
 ds_write_b64 v4, v[72:73] offset:1032
 s_nop 0
 v_cvt_pk_bf16_f32 v76, v76, v77
 v_cvt_pk_bf16_f32 v77, v78, v79
 ds_write_b64 v5, v[76:77] offset:0
 s_waitcnt lgkmcnt(0)
 s_barrier
 ds_read_b128 v[72:75], v0 offset:0
 ds_read_b128 v[76:79], v0 offset:32
 ds_read_b128 v[80:83], v0 offset:1024
 s_mov_b64 exec, s[30:31]
 buffer_store_dwordx4 v[32:35], v11, s[4:7], s56 offen sc1
 s_mov_b64 exec, -1
 buffer_store_dwordx4 v[32:35], v1, s[4:7], s63 offen
 s_waitcnt lgkmcnt(2)
 v_smfmac_f32_16x16x64_bf16 v[88:91], v[72:75], v[224:231], v17
 ds_read_b128 v[84:87], v0 offset:1056
 v_smfmac_f32_16x16x64_bf16 v[92:95], v[72:75], v[232:239], v17
 ds_read_b128 v[96:99], v0 offset:2048
 s_waitcnt lgkmcnt(3)
 v_smfmac_f32_16x16x64_bf16 v[88:91], v[76:79], v[240:247], v17
 ds_read_b128 v[100:103], v0 offset:2080
 v_smfmac_f32_16x16x64_bf16 v[92:95], v[76:79], v[248:255], v17
 ds_read_b128 v[112:115], v0 offset:3072
 s_waitcnt lgkmcnt(4)
 v_smfmac_f32_16x16x64_bf16 v[88:91], v[80:83], v[192:199], v17
 ds_read_b128 v[40:43], v1 offset:10240
 v_smfmac_f32_16x16x64_bf16 v[92:95], v[80:83], v[200:207], v17
 ds_read_b128 v[116:119], v0 offset:3104
 s_waitcnt lgkmcnt(5)
 v_smfmac_f32_16x16x64_bf16 v[88:91], v[84:87], v[208:215], v17
 ds_read_b128 v[44:47], v1 offset:11264
 v_smfmac_f32_16x16x64_bf16 v[92:95], v[84:87], v[216:223], v17
 ds_read_b128 v[72:75], v0 offset:4096
 s_waitcnt lgkmcnt(6)
 v_smfmac_f32_16x16x64_bf16 v[88:91], v[96:99], a[0:7], v17
 ds_read_b128 v[48:51], v1 offset:12288
 v_smfmac_f32_16x16x64_bf16 v[92:95], v[96:99], a[8:15], v17
 ds_read_b128 v[76:79], v0 offset:4128
 s_waitcnt lgkmcnt(7)
 v_smfmac_f32_16x16x64_bf16 v[88:91], v[100:103], a[16:23], v17
 ds_read_b128 v[52:55], v1 offset:13312
 v_smfmac_f32_16x16x64_bf16 v[92:95], v[100:103], a[24:31], v17
 ds_read_b128 v[80:83], v0 offset:5120
 s_waitcnt lgkmcnt(8)
 v_smfmac_f32_16x16x64_bf16 v[88:91], v[112:115], a[32:39], v17
 ds_read_b128 v[56:59], v1 offset:14336
 v_smfmac_f32_16x16x64_bf16 v[92:95], v[112:115], a[40:47], v17
 ds_read_b128 v[84:87], v0 offset:5152
 s_waitcnt lgkmcnt(8)
 v_smfmac_f32_16x16x64_bf16 v[88:91], v[116:119], a[48:55], v17
 ds_read_b128 v[60:63], v1 offset:15360
 v_smfmac_f32_16x16x64_bf16 v[92:95], v[116:119], a[56:63], v17
 ds_read_b128 v[96:99], v0 offset:6144
 s_waitcnt lgkmcnt(8)
 v_smfmac_f32_16x16x64_bf16 v[88:91], v[72:75], a[64:71], v17
 ds_read_b128 v[64:67], v1 offset:16384
 v_smfmac_f32_16x16x64_bf16 v[92:95], v[72:75], a[72:79], v17
 ds_read_b128 v[100:103], v0 offset:6176
 s_waitcnt lgkmcnt(8)
 v_smfmac_f32_16x16x64_bf16 v[88:91], v[76:79], a[80:87], v17
 ds_read_b128 v[68:71], v1 offset:17408
 v_smfmac_f32_16x16x64_bf16 v[92:95], v[76:79], a[88:95], v17
 ds_read_b128 v[112:115], v0 offset:7168
 s_waitcnt lgkmcnt(8)
 v_smfmac_f32_16x16x64_bf16 v[88:91], v[80:83], a[96:103], v17
 ds_read_b128 v[104:107], v16 offset:18432
 v_smfmac_f32_16x16x64_bf16 v[92:95], v[80:83], a[104:111], v17
 ds_read_b128 v[116:119], v0 offset:7200
 s_waitcnt lgkmcnt(8)
 v_smfmac_f32_16x16x64_bf16 v[88:91], v[84:87], a[112:119], v17
 ds_read_b128 v[108:111], v16 offset:19456
 v_smfmac_f32_16x16x64_bf16 v[92:95], v[84:87], a[120:127], v17
 ds_read_b128 v[72:75], v0 offset:8192
 s_waitcnt lgkmcnt(8)
 v_smfmac_f32_16x16x64_bf16 v[88:91], v[96:99], a[128:135], v17
 ds_read_b128 v[224:227], v15 offset:8192
 v_smfmac_f32_16x16x64_bf16 v[92:95], v[96:99], a[136:143], v17
 ds_read_b128 v[76:79], v0 offset:8224
 s_waitcnt lgkmcnt(8)
 v_smfmac_f32_16x16x64_bf16 v[88:91], v[100:103], a[144:151], v17
 ds_read_b128 v[228:231], v15 offset:9216
 v_smfmac_f32_16x16x64_bf16 v[92:95], v[100:103], a[152:159], v17
 ds_read_b128 v[80:83], v0 offset:9216
 s_waitcnt lgkmcnt(8)
 v_smfmac_f32_16x16x64_bf16 v[88:91], v[112:115], a[160:167], v17
 ds_read_b128 v[232:235], v15 offset:10240
 v_smfmac_f32_16x16x64_bf16 v[92:95], v[112:115], a[168:175], v17
 ds_read_b128 v[84:87], v0 offset:9248
 s_waitcnt lgkmcnt(8)
 v_smfmac_f32_16x16x64_bf16 v[88:91], v[116:119], a[176:183], v17
 ds_read_b128 v[236:239], v15 offset:11264
 v_smfmac_f32_16x16x64_bf16 v[92:95], v[116:119], a[184:191], v17
 ds_read_b128 v[240:243], v15 offset:12288
 s_waitcnt lgkmcnt(8)
 v_smfmac_f32_16x16x64_bf16 v[88:91], v[72:75], a[192:199], v17
 ds_read_b128 v[244:247], v15 offset:13312
 v_smfmac_f32_16x16x64_bf16 v[92:95], v[72:75], a[200:207], v17
 ds_read_b128 v[248:251], v15 offset:14336
 s_waitcnt lgkmcnt(8)
 v_smfmac_f32_16x16x64_bf16 v[88:91], v[76:79], a[208:215], v17
 ds_read_b128 v[252:255], v15 offset:15360
 v_smfmac_f32_16x16x64_bf16 v[92:95], v[76:79], a[216:223], v17
 s_waitcnt lgkmcnt(7)
 v_smfmac_f32_16x16x64_bf16 v[88:91], v[80:83], a[224:231], v17
 v_smfmac_f32_16x16x64_bf16 v[92:95], v[80:83], a[232:239], v17
 s_waitcnt lgkmcnt(5)
 v_smfmac_f32_16x16x64_bf16 v[88:91], v[84:87], a[240:247], v17
 v_smfmac_f32_16x16x64_bf16 v[92:95], v[84:87], a[248:255], v17
 s_nop 2
 v_cvt_pk_bf16_f32 v120, v88, v89
 v_cvt_pk_bf16_f32 v121, v90, v91
 ds_write_b64 v6, v[120:121] offset:26624
 s_nop 1
 v_cvt_pk_bf16_f32 v122, v92, v93
 v_cvt_pk_bf16_f32 v123, v94, v95
 ds_write_b64 v6, v[122:123] offset:27136
 s_waitcnt lgkmcnt(0)
 s_barrier
 ds_read_b64_tr_b16 v[72:73], v7 offset:26624
 ds_read_b64_tr_b16 v[74:75], v7 offset:27136
 ds_read_b64_tr_b16 v[76:77], v7 offset:27648
 ds_read_b64_tr_b16 v[78:79], v7 offset:28160
 ds_read_b64_tr_b16 v[80:81], v7 offset:28672
 ds_read_b64_tr_b16 v[82:83], v7 offset:29184
 ds_read_b64_tr_b16 v[84:85], v7 offset:29696
 ds_read_b64_tr_b16 v[86:87], v7 offset:30208
 ds_read_b64_tr_b16 v[112:113], v8 offset:26624
 ds_read_b64_tr_b16 v[114:115], v8 offset:27136
 s_waitcnt lgkmcnt(8)
 v_mfma_f32_16x16x32_bf16 v[92:95], v[40:43], v[72:75], 0
 v_mfma_f32_16x16x32_bf16 v[96:99], v[56:59], v[72:75], 0
 v_mfma_f32_16x16x32_bf16 v[88:91], v[72:75], v[72:75], 0
 s_waitcnt lgkmcnt(6)
 v_mfma_f32_16x16x32_bf16 v[92:95], v[44:47], v[76:79], v[92:95]
 v_mfma_f32_16x16x32_bf16 v[96:99], v[60:63], v[76:79], v[96:99]
 v_mfma_f32_16x16x32_bf16 v[88:91], v[76:79], v[76:79], v[88:91]
 s_waitcnt lgkmcnt(4)
 v_mfma_f32_16x16x32_bf16 v[92:95], v[48:51], v[80:83], v[92:95]
 buffer_load_dwordx2 v[124:125], v1, s[4:7], s65 offen sc1
 v_mfma_f32_16x16x32_bf16 v[96:99], v[64:67], v[80:83], v[96:99]
 v_mfma_f32_16x16x32_bf16 v[88:91], v[80:83], v[80:83], v[88:91]
 s_waitcnt lgkmcnt(0)
 buffer_store_dwordx4 v[112:115], v1, s[4:7], s61 offen
 s_waitcnt lgkmcnt(2)
 v_mfma_f32_16x16x32_bf16 v[92:95], v[52:55], v[84:87], v[92:95]
 v_mfma_f32_16x16x32_bf16 v[96:99], v[68:71], v[84:87], v[96:99]
 v_mfma_f32_16x16x32_bf16 v[88:91], v[84:87], v[84:87], v[88:91]
 v_mfma_f32_32x32x8_bf16 v[40:55], v[18:19], v[18:19], 0
 v_max3_f32 v126, v92, v93, v94
 ds_read_b128 v[80:83], v15 offset:16384
 ds_read_b128 v[84:87], v15 offset:17408
 v_max3_f32 v126, v126, v95, v96
 v_max3_f32 v126, v126, v97, v98
 v_max3_f32 v126, v126, v99, v90
 v_max_f32 v126, v126, v91
 v_mov_b32 v127, v126
 v_mov_b64 v[56:57], 0
 v_mov_b64 v[58:59], 0
 v_permlane16_swap_b32 v126, v127
 v_max_f32 v126, v126, v127
 v_mov_b32 v127, v126
 s_nop 1
 v_permlane32_swap_b32 v126, v127
 v_max_f32 v126, v126, v127
 v_mul_f32 v126, s79, v126
 v_fma_f32 v92, v92, s79, -v126
 v_fma_f32 v93, v93, s79, -v126
 v_fma_f32 v94, v94, s79, -v126
 v_fma_f32 v95, v95, s79, -v126
 v_fma_f32 v96, v96, s79, -v126
 v_fma_f32 v97, v97, s79, -v126
 v_fma_f32 v98, v98, s79, -v126
 v_fma_f32 v99, v99, s79, -v126
 v_exp_f32 v92, v92
 v_exp_f32 v93, v93
 v_exp_f32 v94, v94
 v_exp_f32 v95, v95
 v_exp_f32 v96, v96
 v_exp_f32 v97, v97
 v_exp_f32 v98, v98
 v_exp_f32 v99, v99
 v_fma_f32 v90, v90, s79, -v126
 v_cvt_pk_bf16_f32 v100, v92, v93
 v_cvt_pk_bf16_f32 v101, v94, v95
 v_cvt_pk_bf16_f32 v102, v96, v97
 v_cvt_pk_bf16_f32 v103, v98, v99
 v_fma_f32 v91, v91, s79, -v126
 v_exp_f32 v90, v90
 v_mfma_f32_16x16x32_bf16 v[120:123], v[28:31], v[100:103], 0
 v_exp_f32 v91, v91
 v_mfma_f32_16x16x32_bf16 v[112:115], v[104:107], v[100:103], 0
 v_cvt_pk_bf16_f32 v36, v90, v91
 v_cvt_pk_bf16_f32 v39, v90, v91
 v_mfma_f32_16x16x32_bf16 v[116:119], v[108:111], v[100:103], 0
 s_waitcnt vmcnt(0)
 v_mfma_f32_16x16x16_bf16 v[120:123], v[28:29], v[36:37], v[120:123]
L_pv_181:
 v_cmp_eq_u32 vcc, -1, v124
 s_cbranch_vccnz L_rt_182
 v_mfma_f32_16x16x16_bf16 v[112:115], v[124:125], v[36:37], v[112:115]
 v_mfma_f32_16x16x16_bf16 v[116:119], v[124:125], v[38:39], v[116:119]
 v_rcp_f32 v120, v120
 ds_read_b128 v[88:91], v15 offset:18432
 ds_read_b128 v[92:95], v15 offset:19456
 ds_read_b128 v[96:99], v15 offset:20480
 ds_read_b128 v[100:103], v15 offset:21504
 s_mov_b64 exec, s[28:29]
 v_pk_mul_f32 v[112:113], v[112:113], v[120:121] op_sel_hi:[1,0]
 v_pk_mul_f32 v[114:115], v[114:115], v[120:121] op_sel_hi:[1,0]
 v_cvt_pk_bf16_f32 v112, v112, v113
 v_cvt_pk_bf16_f32 v113, v114, v115
 v_pk_mul_f32 v[116:117], v[116:117], v[120:121] op_sel_hi:[1,0]
 v_pk_mul_f32 v[118:119], v[118:119], v[120:121] op_sel_hi:[1,0]
 v_cvt_pk_bf16_f32 v114, v116, v117
 v_cvt_pk_bf16_f32 v115, v118, v119
 ds_write_b128 v9, v[112:115] offset:30720
 s_mov_b64 exec, -1
 s_waitcnt lgkmcnt(0)
 s_barrier
 ds_read_b128 v[60:63], v0 offset:30720
 ds_read_b128 v[64:67], v0 offset:30752
 ds_read_b128 v[68:71], v0 offset:31744
 ds_read_b128 v[72:75], v0 offset:31776
 s_waitcnt lgkmcnt(3)
 v_smfmac_f32_16x16x64_bf16 v[40:43], v[60:63], v[224:231], v17
 ds_read_b128 v[224:227], v15 offset:22528
 v_smfmac_f32_16x16x64_bf16 v[44:47], v[60:63], v[232:239], v17
 ds_read_b128 v[228:231], v15 offset:23552
 s_waitcnt lgkmcnt(4)
 v_smfmac_f32_16x16x64_bf16 v[40:43], v[64:67], v[240:247], v17
 ds_read_b128 v[232:235], v15 offset:24576
 v_smfmac_f32_16x16x64_bf16 v[44:47], v[64:67], v[248:255], v17
 ds_read_b128 v[236:239], v15 offset:25600
 s_waitcnt lgkmcnt(5)
 v_smfmac_f32_16x16x64_bf16 v[40:43], v[68:71], v[80:87], v17
 ds_read_b128 v[240:243], v15 offset:26624
 v_smfmac_f32_16x16x64_bf16 v[44:47], v[68:71], v[128:135], v17
 ds_read_b128 v[244:247], v15 offset:27648
 s_waitcnt lgkmcnt(6)
 v_smfmac_f32_16x16x64_bf16 v[40:43], v[72:75], v[136:143], v17
 ds_read_b128 v[248:251], v15 offset:28672
 v_smfmac_f32_16x16x64_bf16 v[44:47], v[72:75], v[144:151], v17
 ds_read_b128 v[252:255], v15 offset:29696
 v_smfmac_f32_16x16x64_bf16 v[48:51], v[60:63], v[152:159], v17
 ds_read_b128 v[80:83], v15 offset:30720
 v_cvt_pk_bf16_f32 v116, v40, v41
 v_cvt_pk_bf16_f32 v117, v42, v43
 v_or_b32 v116, 1, v116
 v_smfmac_f32_16x16x64_bf16 v[52:55], v[60:63], v[160:167], v17
 ds_read_b128 v[84:87], v15 offset:31744
 v_cvt_pk_bf16_f32 v118, v44, v45
 v_cvt_pk_bf16_f32 v119, v46, v47
 v_or_b32 v118, 1, v118
 buffer_store_dwordx4 v[116:119], v10, s[4:7], s71 offen
 v_smfmac_f32_16x16x64_bf16 v[48:51], v[64:67], v[168:175], v17
 v_smfmac_f32_16x16x64_bf16 v[52:55], v[64:67], v[176:183], v17
 v_smfmac_f32_16x16x64_bf16 v[48:51], v[68:71], v[184:191], v17
 v_smfmac_f32_16x16x64_bf16 v[52:55], v[68:71], v[88:95], v17
 v_smfmac_f32_16x16x64_bf16 v[48:51], v[72:75], v[96:103], v17
 s_waitcnt lgkmcnt(8)
 v_smfmac_f32_16x16x64_bf16 v[52:55], v[72:75], v[224:231], v17
 s_waitcnt lgkmcnt(6)
 v_smfmac_f32_16x16x64_bf16 v[56:59], v[60:63], v[232:239], v17
 v_cvt_pk_bf16_f32 v120, v48, v49
 v_cvt_pk_bf16_f32 v121, v50, v51
 v_or_b32 v120, 1, v120
 s_waitcnt lgkmcnt(4)
 v_smfmac_f32_16x16x64_bf16 v[56:59], v[64:67], v[240:247], v17
 v_cvt_pk_bf16_f32 v122, v52, v53
 v_cvt_pk_bf16_f32 v123, v54, v55
 v_or_b32 v122, 1, v122
 buffer_store_dwordx4 v[120:123], v10, s[4:7], s72 offen
 s_waitcnt lgkmcnt(2)
 v_smfmac_f32_16x16x64_bf16 v[56:59], v[68:71], v[248:255], v17
 s_waitcnt lgkmcnt(0)
 v_smfmac_f32_16x16x64_bf16 v[56:59], v[72:75], v[80:87], v17
 s_nop 7
 v_cvt_pk_bf16_f32 v124, v56, v57
 v_cvt_pk_bf16_f32 v125, v58, v59
 v_or_b32 v124, 1, v124
 buffer_store_dwordx2 v[124:125], v10, s[4:7], s73 offen
 ds_read_b128 v[224:227], v15 offset:0
 ds_read_b128 v[228:231], v15 offset:1024
 ds_read_b128 v[232:235], v15 offset:2048
 ds_read_b128 v[236:239], v15 offset:3072
 ds_read_b128 v[240:243], v15 offset:4096
 ds_read_b128 v[244:247], v15 offset:5120
 ds_read_b128 v[248:251], v15 offset:6144
 ds_read_b128 v[252:255], v15 offset:7168
 v_mov_b64 v[88:89], 0
 v_mov_b64 v[90:91], 0
 v_mov_b64 v[92:93], 0
 v_mov_b64 v[94:95], 0
 s_cmp_eq_u32 s55, 0
 s_cbranch_scc1 L_nr_183
 s_nop 15
 s_nop 15
 s_nop 15
 s_nop 15
 s_nop 15
L_pp_185:
 buffer_load_dwordx4 v[40:43], v1, s[4:7], s75 offen offset:0 sc1
 buffer_load_dwordx4 v[44:47], v1, s[4:7], s75 offen offset:1024 sc1
 buffer_load_dwordx4 v[48:51], v1, s[4:7], s75 offen offset:2048 sc1
 buffer_load_dwordx4 v[52:55], v1, s[4:7], s75 offen offset:3072 sc1
 s_waitcnt vmcnt(3)
 v_mfma_f32_16x16x32_bf16 v[56:59], v[40:43], v[20:23], 0
 v_and_b32 v14, v40, v42
 s_waitcnt vmcnt(2)
 v_mfma_f32_16x16x32_bf16 v[56:59], v[44:47], v[20:23], v[56:59]
 v_bitop3_b32 v14, v14, v44, v46 bitop3:0x80
 s_waitcnt vmcnt(1)
 v_mfma_f32_16x16x32_bf16 v[56:59], v[48:51], v[20:23], v[56:59]
 v_bitop3_b32 v14, v14, v48, v50 bitop3:0x80
 s_waitcnt vmcnt(0)
 v_mfma_f32_16x16x32_bf16 v[56:59], v[52:55], v[20:23], v[56:59]
 v_bitop3_b32 v14, v14, v52, v54 bitop3:0x80
 v_and_b32 v14, 1, v14
 v_cmp_ne_u32 vcc, 1, v14
 s_cbranch_vccnz L_rt_186
 s_nop 2
 v_cvt_pk_bf16_f32 v60, v56, v57
 v_cvt_pk_bf16_f32 v61, v58, v59
 s_nop 0
 v_mov_b32_dpp v62, v60 quad_perm:[2,3,2,3] row_mask:0xf bank_mask:0xf
 v_mov_b32_dpp v63, v61 quad_perm:[2,3,2,3] row_mask:0xf bank_mask:0xf
 s_mov_b64 exec, s[30:31]
 buffer_store_dwordx4 v[60:63], v11, s[4:7], s58 offen sc1
 s_mov_b64 exec, 1
 buffer_store_dword v13, off, s[4:7], s17
 s_mov_b64 exec, -1
 s_barrier
 s_nop 15
 s_nop 15
 s_nop 15
 s_nop 15
 s_nop 15
 s_nop 15
 s_nop 15
 s_nop 15
 s_nop 15
L_rj_184:
 v_add_u32 v13, 1, v13
 s_add_u32 s53, s53, 1
.p2align 3
 s_mov_b32 s51, 0
 buffer_load_dwordx4 v[40:43], v2, s[4:7], s58 offen offset:0 sc1
 buffer_load_dwordx4 v[44:47], v2, s[4:7], s58 offen offset:128 sc1
 buffer_load_dwordx4 v[48:51], v2, s[4:7], s58 offen offset:1024 sc1
 buffer_load_dwordx4 v[52:55], v2, s[4:7], s58 offen offset:1152 sc1
 buffer_load_dwordx4 v[56:59], v3, s[4:7], s58 offen offset:0 sc1
L_xm_187:
 s_waitcnt vmcnt(4)
 v_mfma_f32_16x16x32_bf16 v[60:63], v[24:27], v[40:43], 0
 s_waitcnt vmcnt(3)
 v_mfma_f32_16x16x32_bf16 v[64:67], v[24:27], v[44:47], 0
 s_waitcnt vmcnt(2)
 v_mfma_f32_16x16x32_bf16 v[68:71], v[24:27], v[48:51], 0
 v_max3_u32 v14, v40, v44, v48
 v_cvt_pk_bf16_f32 v60, v60, v61
 v_cvt_pk_bf16_f32 v61, v62, v63
 ds_write_b64 v4, v[60:61] offset:0
 s_waitcnt vmcnt(1)
 v_mfma_f32_16x16x32_bf16 v[72:75], v[24:27], v[52:55], 0
 v_cvt_pk_bf16_f32 v64, v64, v65
 v_cvt_pk_bf16_f32 v65, v66, v67
 ds_write_b64 v4, v[64:65] offset:8
 s_waitcnt vmcnt(0)
 v_mfma_f32_16x16x32_bf16 v[76:79], v[24:27], v[56:59], 0
 v_max3_u32 v14, v14, v52, v56
 v_cmp_eq_u32 vcc, -1, v14
 v_cvt_pk_bf16_f32 v68, v68, v69
 v_cvt_pk_bf16_f32 v69, v70, v71
 ds_write_b64 v4, v[68:69] offset:1024
 s_cbranch_vccnz L_rt_188
 v_cvt_pk_bf16_f32 v72, v72, v73
 v_cvt_pk_bf16_f32 v73, v74, v75
 ds_write_b64 v4, v[72:73] offset:1032
 s_nop 0
 v_cvt_pk_bf16_f32 v76, v76, v77
 v_cvt_pk_bf16_f32 v77, v78, v79
 ds_write_b64 v5, v[76:77] offset:0
 s_waitcnt lgkmcnt(0)
 s_barrier
 ds_read_b128 v[72:75], v0 offset:0
 ds_read_b128 v[76:79], v0 offset:32
 ds_read_b128 v[80:83], v0 offset:1024
 s_mov_b64 exec, s[30:31]
 buffer_store_dwordx4 v[32:35], v11, s[4:7], s57 offen sc1
 s_mov_b64 exec, -1
 buffer_store_dwordx4 v[32:35], v1, s[4:7], s60 offen
 s_waitcnt lgkmcnt(2)
 v_smfmac_f32_16x16x64_bf16 v[88:91], v[72:75], v[224:231], v17
 ds_read_b128 v[84:87], v0 offset:1056
 v_smfmac_f32_16x16x64_bf16 v[92:95], v[72:75], v[232:239], v17
 ds_read_b128 v[96:99], v0 offset:2048
 s_waitcnt lgkmcnt(3)
 v_smfmac_f32_16x16x64_bf16 v[88:91], v[76:79], v[240:247], v17
 ds_read_b128 v[100:103], v0 offset:2080
 v_smfmac_f32_16x16x64_bf16 v[92:95], v[76:79], v[248:255], v17
 ds_read_b128 v[112:115], v0 offset:3072
 s_waitcnt lgkmcnt(4)
 v_smfmac_f32_16x16x64_bf16 v[88:91], v[80:83], v[192:199], v17
 ds_read_b128 v[40:43], v1 offset:10240
 v_smfmac_f32_16x16x64_bf16 v[92:95], v[80:83], v[200:207], v17
 ds_read_b128 v[116:119], v0 offset:3104
 s_waitcnt lgkmcnt(5)
 v_smfmac_f32_16x16x64_bf16 v[88:91], v[84:87], v[208:215], v17
 ds_read_b128 v[44:47], v1 offset:11264
 v_smfmac_f32_16x16x64_bf16 v[92:95], v[84:87], v[216:223], v17
 ds_read_b128 v[72:75], v0 offset:4096
 s_waitcnt lgkmcnt(6)
 v_smfmac_f32_16x16x64_bf16 v[88:91], v[96:99], a[0:7], v17
 ds_read_b128 v[48:51], v1 offset:12288
 v_smfmac_f32_16x16x64_bf16 v[92:95], v[96:99], a[8:15], v17
 ds_read_b128 v[76:79], v0 offset:4128
 s_waitcnt lgkmcnt(7)
 v_smfmac_f32_16x16x64_bf16 v[88:91], v[100:103], a[16:23], v17
 ds_read_b128 v[52:55], v1 offset:13312
 v_smfmac_f32_16x16x64_bf16 v[92:95], v[100:103], a[24:31], v17
 ds_read_b128 v[80:83], v0 offset:5120
 s_waitcnt lgkmcnt(8)
 v_smfmac_f32_16x16x64_bf16 v[88:91], v[112:115], a[32:39], v17
 ds_read_b128 v[56:59], v1 offset:14336
 v_smfmac_f32_16x16x64_bf16 v[92:95], v[112:115], a[40:47], v17
 ds_read_b128 v[84:87], v0 offset:5152
 s_waitcnt lgkmcnt(8)
 v_smfmac_f32_16x16x64_bf16 v[88:91], v[116:119], a[48:55], v17
 ds_read_b128 v[60:63], v1 offset:15360
 v_smfmac_f32_16x16x64_bf16 v[92:95], v[116:119], a[56:63], v17
 ds_read_b128 v[96:99], v0 offset:6144
 s_waitcnt lgkmcnt(8)
 v_smfmac_f32_16x16x64_bf16 v[88:91], v[72:75], a[64:71], v17
 ds_read_b128 v[64:67], v1 offset:16384
 v_smfmac_f32_16x16x64_bf16 v[92:95], v[72:75], a[72:79], v17
 ds_read_b128 v[100:103], v0 offset:6176
 s_waitcnt lgkmcnt(8)
 v_smfmac_f32_16x16x64_bf16 v[88:91], v[76:79], a[80:87], v17
 ds_read_b128 v[68:71], v1 offset:17408
 v_smfmac_f32_16x16x64_bf16 v[92:95], v[76:79], a[88:95], v17
 ds_read_b128 v[112:115], v0 offset:7168
 s_waitcnt lgkmcnt(8)
 v_smfmac_f32_16x16x64_bf16 v[88:91], v[80:83], a[96:103], v17
 ds_read_b128 v[104:107], v16 offset:18432
 v_smfmac_f32_16x16x64_bf16 v[92:95], v[80:83], a[104:111], v17
 ds_read_b128 v[116:119], v0 offset:7200
 s_waitcnt lgkmcnt(8)
 v_smfmac_f32_16x16x64_bf16 v[88:91], v[84:87], a[112:119], v17
 ds_read_b128 v[108:111], v16 offset:19456
 v_smfmac_f32_16x16x64_bf16 v[92:95], v[84:87], a[120:127], v17
 ds_read_b128 v[72:75], v0 offset:8192
 s_waitcnt lgkmcnt(8)
 v_smfmac_f32_16x16x64_bf16 v[88:91], v[96:99], a[128:135], v17
 ds_read_b128 v[224:227], v15 offset:8192
 v_smfmac_f32_16x16x64_bf16 v[92:95], v[96:99], a[136:143], v17
 ds_read_b128 v[76:79], v0 offset:8224
 s_waitcnt lgkmcnt(8)
 v_smfmac_f32_16x16x64_bf16 v[88:91], v[100:103], a[144:151], v17
 ds_read_b128 v[228:231], v15 offset:9216
 v_smfmac_f32_16x16x64_bf16 v[92:95], v[100:103], a[152:159], v17
 ds_read_b128 v[80:83], v0 offset:9216
 s_waitcnt lgkmcnt(8)
 v_smfmac_f32_16x16x64_bf16 v[88:91], v[112:115], a[160:167], v17
 ds_read_b128 v[232:235], v15 offset:10240
 v_smfmac_f32_16x16x64_bf16 v[92:95], v[112:115], a[168:175], v17
 ds_read_b128 v[84:87], v0 offset:9248
 s_waitcnt lgkmcnt(8)
 v_smfmac_f32_16x16x64_bf16 v[88:91], v[116:119], a[176:183], v17
 ds_read_b128 v[236:239], v15 offset:11264
 v_smfmac_f32_16x16x64_bf16 v[92:95], v[116:119], a[184:191], v17
 ds_read_b128 v[240:243], v15 offset:12288
 s_waitcnt lgkmcnt(8)
 v_smfmac_f32_16x16x64_bf16 v[88:91], v[72:75], a[192:199], v17
 ds_read_b128 v[244:247], v15 offset:13312
 v_smfmac_f32_16x16x64_bf16 v[92:95], v[72:75], a[200:207], v17
 ds_read_b128 v[248:251], v15 offset:14336
 s_waitcnt lgkmcnt(8)
 v_smfmac_f32_16x16x64_bf16 v[88:91], v[76:79], a[208:215], v17
 ds_read_b128 v[252:255], v15 offset:15360
 v_smfmac_f32_16x16x64_bf16 v[92:95], v[76:79], a[216:223], v17
 s_waitcnt lgkmcnt(7)
 v_smfmac_f32_16x16x64_bf16 v[88:91], v[80:83], a[224:231], v17
 v_smfmac_f32_16x16x64_bf16 v[92:95], v[80:83], a[232:239], v17
 s_waitcnt lgkmcnt(5)
 v_smfmac_f32_16x16x64_bf16 v[88:91], v[84:87], a[240:247], v17
 v_smfmac_f32_16x16x64_bf16 v[92:95], v[84:87], a[248:255], v17
 s_nop 2
 v_cvt_pk_bf16_f32 v120, v88, v89
 v_cvt_pk_bf16_f32 v121, v90, v91
 ds_write_b64 v6, v[120:121] offset:26624
 s_nop 1
 v_cvt_pk_bf16_f32 v122, v92, v93
 v_cvt_pk_bf16_f32 v123, v94, v95
 ds_write_b64 v6, v[122:123] offset:27136
 s_waitcnt lgkmcnt(0)
 s_barrier
 ds_read_b64_tr_b16 v[72:73], v7 offset:26624
 ds_read_b64_tr_b16 v[74:75], v7 offset:27136
 ds_read_b64_tr_b16 v[76:77], v7 offset:27648
 ds_read_b64_tr_b16 v[78:79], v7 offset:28160
 ds_read_b64_tr_b16 v[80:81], v7 offset:28672
 ds_read_b64_tr_b16 v[82:83], v7 offset:29184
 ds_read_b64_tr_b16 v[84:85], v7 offset:29696
 ds_read_b64_tr_b16 v[86:87], v7 offset:30208
 ds_read_b64_tr_b16 v[112:113], v8 offset:26624
 ds_read_b64_tr_b16 v[114:115], v8 offset:27136
 s_waitcnt lgkmcnt(8)
 v_mfma_f32_16x16x32_bf16 v[92:95], v[40:43], v[72:75], 0
 v_mfma_f32_16x16x32_bf16 v[96:99], v[56:59], v[72:75], 0
 v_mfma_f32_16x16x32_bf16 v[88:91], v[72:75], v[72:75], 0
 s_waitcnt lgkmcnt(6)
 v_mfma_f32_16x16x32_bf16 v[92:95], v[44:47], v[76:79], v[92:95]
 v_mfma_f32_16x16x32_bf16 v[96:99], v[60:63], v[76:79], v[96:99]
 v_mfma_f32_16x16x32_bf16 v[88:91], v[76:79], v[76:79], v[88:91]
 s_waitcnt lgkmcnt(4)
 v_mfma_f32_16x16x32_bf16 v[92:95], v[48:51], v[80:83], v[92:95]
 buffer_load_dwordx2 v[124:125], v1, s[4:7], s66 offen sc1
 v_mfma_f32_16x16x32_bf16 v[96:99], v[64:67], v[80:83], v[96:99]
 v_mfma_f32_16x16x32_bf16 v[88:91], v[80:83], v[80:83], v[88:91]
 s_waitcnt lgkmcnt(0)
 buffer_store_dwordx4 v[112:115], v1, s[4:7], s62 offen
 s_waitcnt lgkmcnt(2)
 v_mfma_f32_16x16x32_bf16 v[92:95], v[52:55], v[84:87], v[92:95]
 v_mfma_f32_16x16x32_bf16 v[96:99], v[68:71], v[84:87], v[96:99]
 v_mfma_f32_16x16x32_bf16 v[88:91], v[84:87], v[84:87], v[88:91]
 v_mfma_f32_32x32x8_bf16 v[40:55], v[18:19], v[18:19], 0
 v_max3_f32 v126, v92, v93, v94
 ds_read_b128 v[80:83], v15 offset:16384
 ds_read_b128 v[84:87], v15 offset:17408
 v_max3_f32 v126, v126, v95, v96
 v_max3_f32 v126, v126, v97, v98
 v_max3_f32 v126, v126, v99, v90
 v_max_f32 v126, v126, v91
 v_mov_b32 v127, v126
 v_mov_b64 v[56:57], 0
 v_mov_b64 v[58:59], 0
 v_permlane16_swap_b32 v126, v127
 v_max_f32 v126, v126, v127
 v_mov_b32 v127, v126
 s_nop 1
 v_permlane32_swap_b32 v126, v127
 v_max_f32 v126, v126, v127
 v_mul_f32 v126, s79, v126
 v_fma_f32 v92, v92, s79, -v126
 v_fma_f32 v93, v93, s79, -v126
 v_fma_f32 v94, v94, s79, -v126
 v_fma_f32 v95, v95, s79, -v126
 v_fma_f32 v96, v96, s79, -v126
 v_fma_f32 v97, v97, s79, -v126
 v_fma_f32 v98, v98, s79, -v126
 v_fma_f32 v99, v99, s79, -v126
 v_exp_f32 v92, v92
 v_exp_f32 v93, v93
 v_exp_f32 v94, v94
 v_exp_f32 v95, v95
 v_exp_f32 v96, v96
 v_exp_f32 v97, v97
 v_exp_f32 v98, v98
 v_exp_f32 v99, v99
 v_fma_f32 v90, v90, s79, -v126
 v_cvt_pk_bf16_f32 v100, v92, v93
 v_cvt_pk_bf16_f32 v101, v94, v95
 v_cvt_pk_bf16_f32 v102, v96, v97
 v_cvt_pk_bf16_f32 v103, v98, v99
 v_fma_f32 v91, v91, s79, -v126
 v_exp_f32 v90, v90
 v_mfma_f32_16x16x32_bf16 v[120:123], v[28:31], v[100:103], 0
 v_exp_f32 v91, v91
 v_mfma_f32_16x16x32_bf16 v[112:115], v[104:107], v[100:103], 0
 v_cvt_pk_bf16_f32 v36, v90, v91
 v_cvt_pk_bf16_f32 v39, v90, v91
 v_mfma_f32_16x16x32_bf16 v[116:119], v[108:111], v[100:103], 0
 s_waitcnt vmcnt(0)
 v_mfma_f32_16x16x16_bf16 v[120:123], v[28:29], v[36:37], v[120:123]
L_pv_189:
 v_cmp_eq_u32 vcc, -1, v124
 s_cbranch_vccnz L_rt_190
 v_mfma_f32_16x16x16_bf16 v[112:115], v[124:125], v[36:37], v[112:115]
 v_mfma_f32_16x16x16_bf16 v[116:119], v[124:125], v[38:39], v[116:119]
 v_rcp_f32 v120, v120
 ds_read_b128 v[88:91], v15 offset:18432
 ds_read_b128 v[92:95], v15 offset:19456
 ds_read_b128 v[96:99], v15 offset:20480
 ds_read_b128 v[100:103], v15 offset:21504
 s_mov_b64 exec, s[28:29]
 v_pk_mul_f32 v[112:113], v[112:113], v[120:121] op_sel_hi:[1,0]
 v_pk_mul_f32 v[114:115], v[114:115], v[120:121] op_sel_hi:[1,0]
 v_cvt_pk_bf16_f32 v112, v112, v113
 v_cvt_pk_bf16_f32 v113, v114, v115
 v_pk_mul_f32 v[116:117], v[116:117], v[120:121] op_sel_hi:[1,0]
 v_pk_mul_f32 v[118:119], v[118:119], v[120:121] op_sel_hi:[1,0]
 v_cvt_pk_bf16_f32 v114, v116, v117
 v_cvt_pk_bf16_f32 v115, v118, v119
 ds_write_b128 v9, v[112:115] offset:30720
 s_mov_b64 exec, -1
 s_waitcnt lgkmcnt(0)
 s_barrier
 ds_read_b128 v[60:63], v0 offset:30720
 ds_read_b128 v[64:67], v0 offset:30752
 ds_read_b128 v[68:71], v0 offset:31744
 ds_read_b128 v[72:75], v0 offset:31776
 s_waitcnt lgkmcnt(3)
 v_smfmac_f32_16x16x64_bf16 v[40:43], v[60:63], v[224:231], v17
 ds_read_b128 v[224:227], v15 offset:22528
 v_smfmac_f32_16x16x64_bf16 v[44:47], v[60:63], v[232:239], v17
 ds_read_b128 v[228:231], v15 offset:23552
 s_waitcnt lgkmcnt(4)
 v_smfmac_f32_16x16x64_bf16 v[40:43], v[64:67], v[240:247], v17
 ds_read_b128 v[232:235], v15 offset:24576
 v_smfmac_f32_16x16x64_bf16 v[44:47], v[64:67], v[248:255], v17
 ds_read_b128 v[236:239], v15 offset:25600
 s_waitcnt lgkmcnt(5)
 v_smfmac_f32_16x16x64_bf16 v[40:43], v[68:71], v[80:87], v17
 ds_read_b128 v[240:243], v15 offset:26624
 v_smfmac_f32_16x16x64_bf16 v[44:47], v[68:71], v[128:135], v17
 ds_read_b128 v[244:247], v15 offset:27648
 s_waitcnt lgkmcnt(6)
 v_smfmac_f32_16x16x64_bf16 v[40:43], v[72:75], v[136:143], v17
 ds_read_b128 v[248:251], v15 offset:28672
 v_smfmac_f32_16x16x64_bf16 v[44:47], v[72:75], v[144:151], v17
 ds_read_b128 v[252:255], v15 offset:29696
 v_smfmac_f32_16x16x64_bf16 v[48:51], v[60:63], v[152:159], v17
 ds_read_b128 v[80:83], v15 offset:30720
 v_cvt_pk_bf16_f32 v116, v40, v41
 v_cvt_pk_bf16_f32 v117, v42, v43
 v_and_b32 v116, -2, v116
 v_smfmac_f32_16x16x64_bf16 v[52:55], v[60:63], v[160:167], v17
 ds_read_b128 v[84:87], v15 offset:31744
 v_cvt_pk_bf16_f32 v118, v44, v45
 v_cvt_pk_bf16_f32 v119, v46, v47
 v_and_b32 v118, -2, v118
 buffer_store_dwordx4 v[116:119], v10, s[4:7], s68 offen
 v_smfmac_f32_16x16x64_bf16 v[48:51], v[64:67], v[168:175], v17
 v_smfmac_f32_16x16x64_bf16 v[52:55], v[64:67], v[176:183], v17
 v_smfmac_f32_16x16x64_bf16 v[48:51], v[68:71], v[184:191], v17
 v_smfmac_f32_16x16x64_bf16 v[52:55], v[68:71], v[88:95], v17
 v_smfmac_f32_16x16x64_bf16 v[48:51], v[72:75], v[96:103], v17
 s_waitcnt lgkmcnt(8)
 v_smfmac_f32_16x16x64_bf16 v[52:55], v[72:75], v[224:231], v17
 s_waitcnt lgkmcnt(6)
 v_smfmac_f32_16x16x64_bf16 v[56:59], v[60:63], v[232:239], v17
 v_cvt_pk_bf16_f32 v120, v48, v49
 v_cvt_pk_bf16_f32 v121, v50, v51
 v_and_b32 v120, -2, v120
 s_waitcnt lgkmcnt(4)
 v_smfmac_f32_16x16x64_bf16 v[56:59], v[64:67], v[240:247], v17
 v_cvt_pk_bf16_f32 v122, v52, v53
 v_cvt_pk_bf16_f32 v123, v54, v55
 v_and_b32 v122, -2, v122
 buffer_store_dwordx4 v[120:123], v10, s[4:7], s69 offen
 s_waitcnt lgkmcnt(2)
 v_smfmac_f32_16x16x64_bf16 v[56:59], v[68:71], v[248:255], v17
 s_waitcnt lgkmcnt(0)
 v_smfmac_f32_16x16x64_bf16 v[56:59], v[72:75], v[80:87], v17
 s_nop 7
 v_cvt_pk_bf16_f32 v124, v56, v57
 v_cvt_pk_bf16_f32 v125, v58, v59
 v_and_b32 v124, -2, v124
 buffer_store_dwordx2 v[124:125], v10, s[4:7], s70 offen
 ds_read_b128 v[224:227], v15 offset:0
 ds_read_b128 v[228:231], v15 offset:1024
 ds_read_b128 v[232:235], v15 offset:2048
 ds_read_b128 v[236:239], v15 offset:3072
 ds_read_b128 v[240:243], v15 offset:4096
 ds_read_b128 v[244:247], v15 offset:5120
 ds_read_b128 v[248:251], v15 offset:6144
 ds_read_b128 v[252:255], v15 offset:7168
 v_mov_b64 v[88:89], 0
 v_mov_b64 v[90:91], 0
 v_mov_b64 v[92:93], 0
 v_mov_b64 v[94:95], 0
 s_cmp_eq_u32 s55, 0
 s_cbranch_scc1 L_nr_191
 s_nop 15
 s_nop 15
 s_nop 15
 s_nop 15
 s_nop 15
L_pp_193:
 buffer_load_dwordx4 v[40:43], v1, s[4:7], s74 offen offset:0 sc1
 buffer_load_dwordx4 v[44:47], v1, s[4:7], s74 offen offset:1024 sc1
 buffer_load_dwordx4 v[48:51], v1, s[4:7], s74 offen offset:2048 sc1
 buffer_load_dwordx4 v[52:55], v1, s[4:7], s74 offen offset:3072 sc1
 s_waitcnt vmcnt(3)
 v_mfma_f32_16x16x32_bf16 v[56:59], v[40:43], v[20:23], 0
 v_or_b32 v14, v40, v42
 s_waitcnt vmcnt(2)
 v_mfma_f32_16x16x32_bf16 v[56:59], v[44:47], v[20:23], v[56:59]
 v_or3_b32 v14, v14, v44, v46
 s_waitcnt vmcnt(1)
 v_mfma_f32_16x16x32_bf16 v[56:59], v[48:51], v[20:23], v[56:59]
 v_or3_b32 v14, v14, v48, v50
 s_waitcnt vmcnt(0)
 v_mfma_f32_16x16x32_bf16 v[56:59], v[52:55], v[20:23], v[56:59]
 v_or3_b32 v14, v14, v52, v54
 v_and_b32 v14, 1, v14
 v_cmp_ne_u32 vcc, 0, v14
 s_cbranch_vccnz L_rt_194
 s_nop 2
 v_cvt_pk_bf16_f32 v60, v56, v57
 v_cvt_pk_bf16_f32 v61, v58, v59
 s_nop 0
 v_mov_b32_dpp v62, v60 quad_perm:[2,3,2,3] row_mask:0xf bank_mask:0xf
 v_mov_b32_dpp v63, v61 quad_perm:[2,3,2,3] row_mask:0xf bank_mask:0xf
 s_mov_b64 exec, s[30:31]
 buffer_store_dwordx4 v[60:63], v11, s[4:7], s59 offen sc1
 s_mov_b64 exec, 1
 buffer_store_dword v13, off, s[4:7], s17
 s_mov_b64 exec, -1
 s_barrier
 s_nop 15
 s_nop 15
 s_nop 15
 s_nop 15
 s_nop 15
 s_nop 15
 s_nop 15
 s_nop 15
 s_nop 15
L_rj_192:
 v_add_u32 v13, 1, v13
 s_add_u32 s53, s53, 1
.p2align 3
 s_mov_b32 s51, 0
 buffer_load_dwordx4 v[40:43], v2, s[4:7], s59 offen offset:0 sc1
 buffer_load_dwordx4 v[44:47], v2, s[4:7], s59 offen offset:128 sc1
 buffer_load_dwordx4 v[48:51], v2, s[4:7], s59 offen offset:1024 sc1
 buffer_load_dwordx4 v[52:55], v2, s[4:7], s59 offen offset:1152 sc1
 buffer_load_dwordx4 v[56:59], v3, s[4:7], s59 offen offset:0 sc1
L_xm_195:
 s_waitcnt vmcnt(4)
 v_mfma_f32_16x16x32_bf16 v[60:63], v[24:27], v[40:43], 0
 s_waitcnt vmcnt(3)
 v_mfma_f32_16x16x32_bf16 v[64:67], v[24:27], v[44:47], 0
 s_waitcnt vmcnt(2)
 v_mfma_f32_16x16x32_bf16 v[68:71], v[24:27], v[48:51], 0
 v_max3_u32 v14, v40, v44, v48
 v_cvt_pk_bf16_f32 v60, v60, v61
 v_cvt_pk_bf16_f32 v61, v62, v63
 ds_write_b64 v4, v[60:61] offset:0
 s_waitcnt vmcnt(1)
 v_mfma_f32_16x16x32_bf16 v[72:75], v[24:27], v[52:55], 0
 v_cvt_pk_bf16_f32 v64, v64, v65
 v_cvt_pk_bf16_f32 v65, v66, v67
 ds_write_b64 v4, v[64:65] offset:8
 s_waitcnt vmcnt(0)
 v_mfma_f32_16x16x32_bf16 v[76:79], v[24:27], v[56:59], 0
 v_max3_u32 v14, v14, v52, v56
 v_cmp_eq_u32 vcc, -1, v14
 v_cvt_pk_bf16_f32 v68, v68, v69
 v_cvt_pk_bf16_f32 v69, v70, v71
 ds_write_b64 v4, v[68:69] offset:1024
 s_cbranch_vccnz L_rt_196
 v_cvt_pk_bf16_f32 v72, v72, v73
 v_cvt_pk_bf16_f32 v73, v74, v75
 ds_write_b64 v4, v[72:73] offset:1032
 s_nop 0
 v_cvt_pk_bf16_f32 v76, v76, v77
 v_cvt_pk_bf16_f32 v77, v78, v79
 ds_write_b64 v5, v[76:77] offset:0
 s_waitcnt lgkmcnt(0)
 s_barrier
 ds_read_b128 v[72:75], v0 offset:0
 ds_read_b128 v[76:79], v0 offset:32
 ds_read_b128 v[80:83], v0 offset:1024
 s_mov_b64 exec, s[30:31]
 buffer_store_dwordx4 v[32:35], v11, s[4:7], s58 offen sc1
 s_mov_b64 exec, -1
 buffer_store_dwordx4 v[32:35], v1, s[4:7], s61 offen
 s_waitcnt lgkmcnt(2)
 v_smfmac_f32_16x16x64_bf16 v[88:91], v[72:75], v[224:231], v17
 ds_read_b128 v[84:87], v0 offset:1056
 v_smfmac_f32_16x16x64_bf16 v[92:95], v[72:75], v[232:239], v17
 ds_read_b128 v[96:99], v0 offset:2048
 s_waitcnt lgkmcnt(3)
 v_smfmac_f32_16x16x64_bf16 v[88:91], v[76:79], v[240:247], v17
 ds_read_b128 v[100:103], v0 offset:2080
 v_smfmac_f32_16x16x64_bf16 v[92:95], v[76:79], v[248:255], v17
 ds_read_b128 v[112:115], v0 offset:3072
 s_waitcnt lgkmcnt(4)
 v_smfmac_f32_16x16x64_bf16 v[88:91], v[80:83], v[192:199], v17
 ds_read_b128 v[40:43], v1 offset:10240
 v_smfmac_f32_16x16x64_bf16 v[92:95], v[80:83], v[200:207], v17
 ds_read_b128 v[116:119], v0 offset:3104
 s_waitcnt lgkmcnt(5)
 v_smfmac_f32_16x16x64_bf16 v[88:91], v[84:87], v[208:215], v17
 ds_read_b128 v[44:47], v1 offset:11264
 v_smfmac_f32_16x16x64_bf16 v[92:95], v[84:87], v[216:223], v17
 ds_read_b128 v[72:75], v0 offset:4096
 s_waitcnt lgkmcnt(6)
 v_smfmac_f32_16x16x64_bf16 v[88:91], v[96:99], a[0:7], v17
 ds_read_b128 v[48:51], v1 offset:12288
 v_smfmac_f32_16x16x64_bf16 v[92:95], v[96:99], a[8:15], v17
 ds_read_b128 v[76:79], v0 offset:4128
 s_waitcnt lgkmcnt(7)
 v_smfmac_f32_16x16x64_bf16 v[88:91], v[100:103], a[16:23], v17
 ds_read_b128 v[52:55], v1 offset:13312
 v_smfmac_f32_16x16x64_bf16 v[92:95], v[100:103], a[24:31], v17
 ds_read_b128 v[80:83], v0 offset:5120
 s_waitcnt lgkmcnt(8)
 v_smfmac_f32_16x16x64_bf16 v[88:91], v[112:115], a[32:39], v17
 ds_read_b128 v[56:59], v1 offset:14336
 v_smfmac_f32_16x16x64_bf16 v[92:95], v[112:115], a[40:47], v17
 ds_read_b128 v[84:87], v0 offset:5152
 s_waitcnt lgkmcnt(8)
 v_smfmac_f32_16x16x64_bf16 v[88:91], v[116:119], a[48:55], v17
 ds_read_b128 v[60:63], v1 offset:15360
 v_smfmac_f32_16x16x64_bf16 v[92:95], v[116:119], a[56:63], v17
 ds_read_b128 v[96:99], v0 offset:6144
 s_waitcnt lgkmcnt(8)
 v_smfmac_f32_16x16x64_bf16 v[88:91], v[72:75], a[64:71], v17
 ds_read_b128 v[64:67], v1 offset:16384
 v_smfmac_f32_16x16x64_bf16 v[92:95], v[72:75], a[72:79], v17
 ds_read_b128 v[100:103], v0 offset:6176
 s_waitcnt lgkmcnt(8)
 v_smfmac_f32_16x16x64_bf16 v[88:91], v[76:79], a[80:87], v17
 ds_read_b128 v[68:71], v1 offset:17408
 v_smfmac_f32_16x16x64_bf16 v[92:95], v[76:79], a[88:95], v17
 ds_read_b128 v[112:115], v0 offset:7168
 s_waitcnt lgkmcnt(8)
 v_smfmac_f32_16x16x64_bf16 v[88:91], v[80:83], a[96:103], v17
 ds_read_b128 v[104:107], v16 offset:18432
 v_smfmac_f32_16x16x64_bf16 v[92:95], v[80:83], a[104:111], v17
 ds_read_b128 v[116:119], v0 offset:7200
 s_waitcnt lgkmcnt(8)
 v_smfmac_f32_16x16x64_bf16 v[88:91], v[84:87], a[112:119], v17
 ds_read_b128 v[108:111], v16 offset:19456
 v_smfmac_f32_16x16x64_bf16 v[92:95], v[84:87], a[120:127], v17
 ds_read_b128 v[72:75], v0 offset:8192
 s_waitcnt lgkmcnt(8)
 v_smfmac_f32_16x16x64_bf16 v[88:91], v[96:99], a[128:135], v17
 ds_read_b128 v[224:227], v15 offset:8192
 v_smfmac_f32_16x16x64_bf16 v[92:95], v[96:99], a[136:143], v17
 ds_read_b128 v[76:79], v0 offset:8224
 s_waitcnt lgkmcnt(8)
 v_smfmac_f32_16x16x64_bf16 v[88:91], v[100:103], a[144:151], v17
 ds_read_b128 v[228:231], v15 offset:9216
 v_smfmac_f32_16x16x64_bf16 v[92:95], v[100:103], a[152:159], v17
 ds_read_b128 v[80:83], v0 offset:9216
 s_waitcnt lgkmcnt(8)
 v_smfmac_f32_16x16x64_bf16 v[88:91], v[112:115], a[160:167], v17
 ds_read_b128 v[232:235], v15 offset:10240
 v_smfmac_f32_16x16x64_bf16 v[92:95], v[112:115], a[168:175], v17
 ds_read_b128 v[84:87], v0 offset:9248
 s_waitcnt lgkmcnt(8)
 v_smfmac_f32_16x16x64_bf16 v[88:91], v[116:119], a[176:183], v17
 ds_read_b128 v[236:239], v15 offset:11264
 v_smfmac_f32_16x16x64_bf16 v[92:95], v[116:119], a[184:191], v17
 ds_read_b128 v[240:243], v15 offset:12288
 s_waitcnt lgkmcnt(8)
 v_smfmac_f32_16x16x64_bf16 v[88:91], v[72:75], a[192:199], v17
 ds_read_b128 v[244:247], v15 offset:13312
 v_smfmac_f32_16x16x64_bf16 v[92:95], v[72:75], a[200:207], v17
 ds_read_b128 v[248:251], v15 offset:14336
 s_waitcnt lgkmcnt(8)
 v_smfmac_f32_16x16x64_bf16 v[88:91], v[76:79], a[208:215], v17
 ds_read_b128 v[252:255], v15 offset:15360
 v_smfmac_f32_16x16x64_bf16 v[92:95], v[76:79], a[216:223], v17
 s_waitcnt lgkmcnt(7)
 v_smfmac_f32_16x16x64_bf16 v[88:91], v[80:83], a[224:231], v17
 v_smfmac_f32_16x16x64_bf16 v[92:95], v[80:83], a[232:239], v17
 s_waitcnt lgkmcnt(5)
 v_smfmac_f32_16x16x64_bf16 v[88:91], v[84:87], a[240:247], v17
 v_smfmac_f32_16x16x64_bf16 v[92:95], v[84:87], a[248:255], v17
 s_nop 2
 v_cvt_pk_bf16_f32 v120, v88, v89
 v_cvt_pk_bf16_f32 v121, v90, v91
 ds_write_b64 v6, v[120:121] offset:26624
 s_nop 1
 v_cvt_pk_bf16_f32 v122, v92, v93
 v_cvt_pk_bf16_f32 v123, v94, v95
 ds_write_b64 v6, v[122:123] offset:27136
 s_waitcnt lgkmcnt(0)
 s_barrier
 ds_read_b64_tr_b16 v[72:73], v7 offset:26624
 ds_read_b64_tr_b16 v[74:75], v7 offset:27136
 ds_read_b64_tr_b16 v[76:77], v7 offset:27648
 ds_read_b64_tr_b16 v[78:79], v7 offset:28160
 ds_read_b64_tr_b16 v[80:81], v7 offset:28672
 ds_read_b64_tr_b16 v[82:83], v7 offset:29184
 ds_read_b64_tr_b16 v[84:85], v7 offset:29696
 ds_read_b64_tr_b16 v[86:87], v7 offset:30208
 ds_read_b64_tr_b16 v[112:113], v8 offset:26624
 ds_read_b64_tr_b16 v[114:115], v8 offset:27136
 s_waitcnt lgkmcnt(8)
 v_mfma_f32_16x16x32_bf16 v[92:95], v[40:43], v[72:75], 0
 v_mfma_f32_16x16x32_bf16 v[96:99], v[56:59], v[72:75], 0
 v_mfma_f32_16x16x32_bf16 v[88:91], v[72:75], v[72:75], 0
 s_waitcnt lgkmcnt(6)
 v_mfma_f32_16x16x32_bf16 v[92:95], v[44:47], v[76:79], v[92:95]
 v_mfma_f32_16x16x32_bf16 v[96:99], v[60:63], v[76:79], v[96:99]
 v_mfma_f32_16x16x32_bf16 v[88:91], v[76:79], v[76:79], v[88:91]
 s_waitcnt lgkmcnt(4)
 v_mfma_f32_16x16x32_bf16 v[92:95], v[48:51], v[80:83], v[92:95]
 buffer_load_dwordx2 v[124:125], v1, s[4:7], s67 offen sc1
 v_mfma_f32_16x16x32_bf16 v[96:99], v[64:67], v[80:83], v[96:99]
 v_mfma_f32_16x16x32_bf16 v[88:91], v[80:83], v[80:83], v[88:91]
 s_waitcnt lgkmcnt(0)
 buffer_store_dwordx4 v[112:115], v1, s[4:7], s63 offen
 s_waitcnt lgkmcnt(2)
 v_mfma_f32_16x16x32_bf16 v[92:95], v[52:55], v[84:87], v[92:95]
 v_mfma_f32_16x16x32_bf16 v[96:99], v[68:71], v[84:87], v[96:99]
 v_mfma_f32_16x16x32_bf16 v[88:91], v[84:87], v[84:87], v[88:91]
 s_cmp_eq_u32 s53, 63
 s_cbranch_scc1 L_ch_last
 v_mfma_f32_32x32x8_bf16 v[40:55], v[18:19], v[18:19], 0
 v_max3_f32 v126, v92, v93, v94
 ds_read_b128 v[80:83], v15 offset:16384
 ds_read_b128 v[84:87], v15 offset:17408
 v_max3_f32 v126, v126, v95, v96
 v_max3_f32 v126, v126, v97, v98
 v_max3_f32 v126, v126, v99, v90
 v_max_f32 v126, v126, v91
 v_mov_b32 v127, v126
 v_mov_b64 v[56:57], 0
 v_mov_b64 v[58:59], 0
 v_permlane16_swap_b32 v126, v127
 v_max_f32 v126, v126, v127
 v_mov_b32 v127, v126
 s_nop 1
 v_permlane32_swap_b32 v126, v127
 v_max_f32 v126, v126, v127
 v_mul_f32 v126, s79, v126
 v_fma_f32 v92, v92, s79, -v126
 v_fma_f32 v93, v93, s79, -v126
 v_fma_f32 v94, v94, s79, -v126
 v_fma_f32 v95, v95, s79, -v126
 v_fma_f32 v96, v96, s79, -v126
 v_fma_f32 v97, v97, s79, -v126
 v_fma_f32 v98, v98, s79, -v126
 v_fma_f32 v99, v99, s79, -v126
 v_exp_f32 v92, v92
 v_exp_f32 v93, v93
 v_exp_f32 v94, v94
 v_exp_f32 v95, v95
 v_exp_f32 v96, v96
 v_exp_f32 v97, v97
 v_exp_f32 v98, v98
 v_exp_f32 v99, v99
 v_fma_f32 v90, v90, s79, -v126
 v_cvt_pk_bf16_f32 v100, v92, v93
 v_cvt_pk_bf16_f32 v101, v94, v95
 v_cvt_pk_bf16_f32 v102, v96, v97
 v_cvt_pk_bf16_f32 v103, v98, v99
 v_fma_f32 v91, v91, s79, -v126
 v_exp_f32 v90, v90
 v_mfma_f32_16x16x32_bf16 v[120:123], v[28:31], v[100:103], 0
 v_exp_f32 v91, v91
 v_mfma_f32_16x16x32_bf16 v[112:115], v[104:107], v[100:103], 0
 v_cvt_pk_bf16_f32 v36, v90, v91
 v_cvt_pk_bf16_f32 v39, v90, v91
 v_mfma_f32_16x16x32_bf16 v[116:119], v[108:111], v[100:103], 0
 s_waitcnt vmcnt(0)
 v_mfma_f32_16x16x16_bf16 v[120:123], v[28:29], v[36:37], v[120:123]
L_pv_197:
 v_cmp_eq_u32 vcc, -1, v124
 s_cbranch_vccnz L_rt_198
 v_mfma_f32_16x16x16_bf16 v[112:115], v[124:125], v[36:37], v[112:115]
 v_mfma_f32_16x16x16_bf16 v[116:119], v[124:125], v[38:39], v[116:119]
 v_rcp_f32 v120, v120
 ds_read_b128 v[88:91], v15 offset:18432
 ds_read_b128 v[92:95], v15 offset:19456
 ds_read_b128 v[96:99], v15 offset:20480
 ds_read_b128 v[100:103], v15 offset:21504
 s_mov_b64 exec, s[28:29]
 v_pk_mul_f32 v[112:113], v[112:113], v[120:121] op_sel_hi:[1,0]
 v_pk_mul_f32 v[114:115], v[114:115], v[120:121] op_sel_hi:[1,0]
 v_cvt_pk_bf16_f32 v112, v112, v113
 v_cvt_pk_bf16_f32 v113, v114, v115
 v_pk_mul_f32 v[116:117], v[116:117], v[120:121] op_sel_hi:[1,0]
 v_pk_mul_f32 v[118:119], v[118:119], v[120:121] op_sel_hi:[1,0]
 v_cvt_pk_bf16_f32 v114, v116, v117
 v_cvt_pk_bf16_f32 v115, v118, v119
 ds_write_b128 v9, v[112:115] offset:30720
 s_mov_b64 exec, -1
 s_waitcnt lgkmcnt(0)
 s_barrier
 ds_read_b128 v[60:63], v0 offset:30720
 ds_read_b128 v[64:67], v0 offset:30752
 ds_read_b128 v[68:71], v0 offset:31744
 ds_read_b128 v[72:75], v0 offset:31776
 s_waitcnt lgkmcnt(3)
 v_smfmac_f32_16x16x64_bf16 v[40:43], v[60:63], v[224:231], v17
 ds_read_b128 v[224:227], v15 offset:22528
 v_smfmac_f32_16x16x64_bf16 v[44:47], v[60:63], v[232:239], v17
 ds_read_b128 v[228:231], v15 offset:23552
 s_waitcnt lgkmcnt(4)
 v_smfmac_f32_16x16x64_bf16 v[40:43], v[64:67], v[240:247], v17
 ds_read_b128 v[232:235], v15 offset:24576
 v_smfmac_f32_16x16x64_bf16 v[44:47], v[64:67], v[248:255], v17
 ds_read_b128 v[236:239], v15 offset:25600
 s_waitcnt lgkmcnt(5)
 v_smfmac_f32_16x16x64_bf16 v[40:43], v[68:71], v[80:87], v17
 ds_read_b128 v[240:243], v15 offset:26624
 v_smfmac_f32_16x16x64_bf16 v[44:47], v[68:71], v[128:135], v17
 ds_read_b128 v[244:247], v15 offset:27648
 s_waitcnt lgkmcnt(6)
 v_smfmac_f32_16x16x64_bf16 v[40:43], v[72:75], v[136:143], v17
 ds_read_b128 v[248:251], v15 offset:28672
 v_smfmac_f32_16x16x64_bf16 v[44:47], v[72:75], v[144:151], v17
 ds_read_b128 v[252:255], v15 offset:29696
 v_smfmac_f32_16x16x64_bf16 v[48:51], v[60:63], v[152:159], v17
 ds_read_b128 v[80:83], v15 offset:30720
 v_cvt_pk_bf16_f32 v116, v40, v41
 v_cvt_pk_bf16_f32 v117, v42, v43
 v_and_b32 v116, -2, v116
 v_smfmac_f32_16x16x64_bf16 v[52:55], v[60:63], v[160:167], v17
 ds_read_b128 v[84:87], v15 offset:31744
 v_cvt_pk_bf16_f32 v118, v44, v45
 v_cvt_pk_bf16_f32 v119, v46, v47
 v_and_b32 v118, -2, v118
 buffer_store_dwordx4 v[116:119], v10, s[4:7], s71 offen
 v_smfmac_f32_16x16x64_bf16 v[48:51], v[64:67], v[168:175], v17
 v_smfmac_f32_16x16x64_bf16 v[52:55], v[64:67], v[176:183], v17
 v_smfmac_f32_16x16x64_bf16 v[48:51], v[68:71], v[184:191], v17
 v_smfmac_f32_16x16x64_bf16 v[52:55], v[68:71], v[88:95], v17
 v_smfmac_f32_16x16x64_bf16 v[48:51], v[72:75], v[96:103], v17
 s_waitcnt lgkmcnt(8)
 v_smfmac_f32_16x16x64_bf16 v[52:55], v[72:75], v[224:231], v17
 s_waitcnt lgkmcnt(6)
 v_smfmac_f32_16x16x64_bf16 v[56:59], v[60:63], v[232:239], v17
 v_cvt_pk_bf16_f32 v120, v48, v49
 v_cvt_pk_bf16_f32 v121, v50, v51
 v_and_b32 v120, -2, v120
 s_waitcnt lgkmcnt(4)
 v_smfmac_f32_16x16x64_bf16 v[56:59], v[64:67], v[240:247], v17
 v_cvt_pk_bf16_f32 v122, v52, v53
 v_cvt_pk_bf16_f32 v123, v54, v55
 v_and_b32 v122, -2, v122
 buffer_store_dwordx4 v[120:123], v10, s[4:7], s72 offen
 s_waitcnt lgkmcnt(2)
 v_smfmac_f32_16x16x64_bf16 v[56:59], v[68:71], v[248:255], v17
 s_waitcnt lgkmcnt(0)
 v_smfmac_f32_16x16x64_bf16 v[56:59], v[72:75], v[80:87], v17
 s_nop 7
 v_cvt_pk_bf16_f32 v124, v56, v57
 v_cvt_pk_bf16_f32 v125, v58, v59
 v_and_b32 v124, -2, v124
 buffer_store_dwordx2 v[124:125], v10, s[4:7], s73 offen
 ds_read_b128 v[224:227], v15 offset:0
 ds_read_b128 v[228:231], v15 offset:1024
 ds_read_b128 v[232:235], v15 offset:2048
 ds_read_b128 v[236:239], v15 offset:3072
 ds_read_b128 v[240:243], v15 offset:4096
 ds_read_b128 v[244:247], v15 offset:5120
 ds_read_b128 v[248:251], v15 offset:6144
 ds_read_b128 v[252:255], v15 offset:7168
 v_mov_b64 v[88:89], 0
 v_mov_b64 v[90:91], 0
 v_mov_b64 v[92:93], 0
 v_mov_b64 v[94:95], 0
 s_cmp_eq_u32 s55, 0
 s_cbranch_scc1 L_nr_199
 s_nop 15
 s_nop 15
 s_nop 15
 s_nop 15
 s_nop 15
L_pp_201:
 buffer_load_dwordx4 v[40:43], v1, s[4:7], s75 offen offset:0 sc1
 buffer_load_dwordx4 v[44:47], v1, s[4:7], s75 offen offset:1024 sc1
 buffer_load_dwordx4 v[48:51], v1, s[4:7], s75 offen offset:2048 sc1
 buffer_load_dwordx4 v[52:55], v1, s[4:7], s75 offen offset:3072 sc1
 s_waitcnt vmcnt(3)
 v_mfma_f32_16x16x32_bf16 v[56:59], v[40:43], v[20:23], 0
 v_or_b32 v14, v40, v42
 s_waitcnt vmcnt(2)
 v_mfma_f32_16x16x32_bf16 v[56:59], v[44:47], v[20:23], v[56:59]
 v_or3_b32 v14, v14, v44, v46
 s_waitcnt vmcnt(1)
 v_mfma_f32_16x16x32_bf16 v[56:59], v[48:51], v[20:23], v[56:59]
 v_or3_b32 v14, v14, v48, v50
 s_waitcnt vmcnt(0)
 v_mfma_f32_16x16x32_bf16 v[56:59], v[52:55], v[20:23], v[56:59]
 v_or3_b32 v14, v14, v52, v54
 v_and_b32 v14, 1, v14
 v_cmp_ne_u32 vcc, 0, v14
 s_cbranch_vccnz L_rt_202
 s_nop 2
 v_cvt_pk_bf16_f32 v60, v56, v57
 v_cvt_pk_bf16_f32 v61, v58, v59
 s_nop 0
 v_mov_b32_dpp v62, v60 quad_perm:[2,3,2,3] row_mask:0xf bank_mask:0xf
 v_mov_b32_dpp v63, v61 quad_perm:[2,3,2,3] row_mask:0xf bank_mask:0xf
 s_mov_b64 exec, s[30:31]
 buffer_store_dwordx4 v[60:63], v11, s[4:7], s56 offen sc1
 s_mov_b64 exec, 1
 buffer_store_dword v13, off, s[4:7], s17
 s_mov_b64 exec, -1
 s_barrier
 s_nop 15
 s_nop 15
 s_nop 15
 s_nop 15
 s_nop 15
 s_nop 15
 s_nop 15
 s_nop 15
 s_nop 15
L_rj_200:
 v_add_u32 v13, 1, v13
 s_add_u32 s53, s53, 1
 s_branch L_ch_loopf
L_rt_172:
 s_nop 7
 buffer_load_dwordx4 v[40:43], v2, s[4:7], s56 offen offset:0 sc1
 buffer_load_dwordx4 v[44:47], v2, s[4:7], s56 offen offset:128 sc1
 buffer_load_dwordx4 v[48:51], v2, s[4:7], s56 offen offset:1024 sc1
 buffer_load_dwordx4 v[52:55], v2, s[4:7], s56 offen offset:1152 sc1
 buffer_load_dwordx4 v[56:59], v3, s[4:7], s56 offen offset:0 sc1
 s_add_u32 s51, s51, 1
 s_cmp_lt_u32 s51, 131072
 s_cbranch_scc1 L_xm_171
 s_branch L_bail
L_rt_174:
 buffer_load_dwordx2 v[124:125], v1, s[4:7], s64 offen sc1
 s_waitcnt vmcnt(0)
 s_add_u32 s51, s51, 1
 s_cmp_lt_u32 s51, 131072
 s_cbranch_scc1 L_pv_173
 s_branch L_bail
L_rt_178:
 s_add_u32 s51, s51, 1
 s_cmp_lt_u32 s51, 131072
 s_cbranch_scc1 L_pp_177
 s_branch L_bail
L_nr_175:
 s_cmp_lg_u32 s50, 0
 s_cbranch_scc1 L_id_203
 buffer_load_dword v14, off, s[4:7], s32 sc1
 s_waitcnt vmcnt(0)
 s_barrier
 s_add_u32 s76, s53, 1
L_fl_204:
 v_cmp_ge_u32 vcc, s76, v14
 s_cbranch_vccz L_fld_205
 buffer_load_dword v14, off, s[4:7], s32 sc1
 s_waitcnt vmcnt(0)
 s_add_u32 s51, s51, 1
 s_cmp_lt_u32 s51, 131072
 s_cbranch_scc1 L_fl_204
 s_branch L_bail
L_fld_205:
 s_lshl_b32 s16, s76, 19
 s_add_u32 s16, s16, s54
 s_mov_b32 m0, 10240
 s_nop 0
 buffer_load_dwordx4 v1, s[4:7], s16 offen offset:0 sc1 lds
 buffer_load_dwordx4 v1, s[4:7], s16 offen offset:1024 sc1 lds
 buffer_load_dwordx4 v1, s[4:7], s16 offen offset:2048 sc1 lds
 buffer_load_dwordx4 v1, s[4:7], s16 offen offset:3072 sc1 lds
 s_mov_b32 m0, 14336
 s_nop 0
 buffer_load_dwordx4 v12, s[4:7], s16 offen offset:0 sc1 lds
 buffer_load_dwordx4 v12, s[4:7], s16 offen offset:1024 sc1 lds
 buffer_load_dwordx4 v12, s[4:7], s16 offen offset:2048 sc1 lds
 buffer_load_dwordx4 v12, s[4:7], s16 offen offset:3072 sc1 lds
 s_add_u32 s16, s16, 67108864
 s_mov_b32 m0, 18432
 s_nop 0
 buffer_load_dwordx4 v1, s[4:7], s16 offen offset:0 sc1 lds
 buffer_load_dwordx4 v1, s[4:7], s16 offen offset:1024 sc1 lds
 buffer_load_dwordx4 v1, s[4:7], s16 offen offset:2048 sc1 lds
 buffer_load_dwordx4 v1, s[4:7], s16 offen offset:3072 sc1 lds
 s_mov_b32 m0, 22528
 s_nop 0
 buffer_load_dwordx4 v12, s[4:7], s16 offen offset:0 sc1 lds
 buffer_load_dwordx4 v12, s[4:7], s16 offen offset:1024 sc1 lds
 buffer_load_dwordx4 v12, s[4:7], s16 offen offset:2048 sc1 lds
 buffer_load_dwordx4 v12, s[4:7], s16 offen offset:3072 sc1 lds
 s_nop 15
 s_nop 15
 s_nop 15
 s_nop 15
 s_nop 15
 s_branch L_rj_176
L_id_203:
 s_barrier
 s_nop 15
 s_nop 15
 s_nop 15
 s_nop 15
 s_nop 15
 s_nop 15
 s_nop 15
 s_nop 15
 s_nop 15
 s_branch L_rj_176
L_rt_180:
 s_nop 7
 buffer_load_dwordx4 v[40:43], v2, s[4:7], s57 offen offset:0 sc1
 buffer_load_dwordx4 v[44:47], v2, s[4:7], s57 offen offset:128 sc1
 buffer_load_dwordx4 v[48:51], v2, s[4:7], s57 offen offset:1024 sc1
 buffer_load_dwordx4 v[52:55], v2, s[4:7], s57 offen offset:1152 sc1
 buffer_load_dwordx4 v[56:59], v3, s[4:7], s57 offen offset:0 sc1
 s_add_u32 s51, s51, 1
 s_cmp_lt_u32 s51, 131072
 s_cbranch_scc1 L_xm_179
 s_branch L_bail
L_rt_182:
 buffer_load_dwordx2 v[124:125], v1, s[4:7], s65 offen sc1
 s_waitcnt vmcnt(0)
 s_add_u32 s51, s51, 1
 s_cmp_lt_u32 s51, 131072
 s_cbranch_scc1 L_pv_181
 s_branch L_bail
L_rt_186:
 s_add_u32 s51, s51, 1
 s_cmp_lt_u32 s51, 131072
 s_cbranch_scc1 L_pp_185
 s_branch L_bail
L_nr_183:
 s_cmp_lg_u32 s50, 0
 s_cbranch_scc1 L_id_206
 buffer_load_dword v14, off, s[4:7], s32 sc1
 s_waitcnt vmcnt(0)
 s_barrier
 s_add_u32 s76, s53, 1
L_fl_207:
 v_cmp_ge_u32 vcc, s76, v14
 s_cbranch_vccz L_fld_208
 buffer_load_dword v14, off, s[4:7], s32 sc1
 s_waitcnt vmcnt(0)
 s_add_u32 s51, s51, 1
 s_cmp_lt_u32 s51, 131072
 s_cbranch_scc1 L_fl_207
 s_branch L_bail
L_fld_208:
 s_lshl_b32 s16, s76, 19
 s_add_u32 s16, s16, s54
 s_mov_b32 m0, 10240
 s_nop 0
 buffer_load_dwordx4 v1, s[4:7], s16 offen offset:0 sc1 lds
 buffer_load_dwordx4 v1, s[4:7], s16 offen offset:1024 sc1 lds
 buffer_load_dwordx4 v1, s[4:7], s16 offen offset:2048 sc1 lds
 buffer_load_dwordx4 v1, s[4:7], s16 offen offset:3072 sc1 lds
 s_mov_b32 m0, 14336
 s_nop 0
 buffer_load_dwordx4 v12, s[4:7], s16 offen offset:0 sc1 lds
 buffer_load_dwordx4 v12, s[4:7], s16 offen offset:1024 sc1 lds
 buffer_load_dwordx4 v12, s[4:7], s16 offen offset:2048 sc1 lds
 buffer_load_dwordx4 v12, s[4:7], s16 offen offset:3072 sc1 lds
 s_add_u32 s16, s16, 67108864
 s_mov_b32 m0, 18432
 s_nop 0
 buffer_load_dwordx4 v1, s[4:7], s16 offen offset:0 sc1 lds
 buffer_load_dwordx4 v1, s[4:7], s16 offen offset:1024 sc1 lds
 buffer_load_dwordx4 v1, s[4:7], s16 offen offset:2048 sc1 lds
 buffer_load_dwordx4 v1, s[4:7], s16 offen offset:3072 sc1 lds
 s_mov_b32 m0, 22528
 s_nop 0
 buffer_load_dwordx4 v12, s[4:7], s16 offen offset:0 sc1 lds
 buffer_load_dwordx4 v12, s[4:7], s16 offen offset:1024 sc1 lds
 buffer_load_dwordx4 v12, s[4:7], s16 offen offset:2048 sc1 lds
 buffer_load_dwordx4 v12, s[4:7], s16 offen offset:3072 sc1 lds
 s_nop 15
 s_nop 15
 s_nop 15
 s_nop 15
 s_nop 15
 s_branch L_rj_184
L_id_206:
 s_barrier
 s_nop 15
 s_nop 15
 s_nop 15
 s_nop 15
 s_nop 15
 s_nop 15
 s_nop 15
 s_nop 15
 s_nop 15
 s_branch L_rj_184
L_rt_188:
 s_nop 7
 buffer_load_dwordx4 v[40:43], v2, s[4:7], s58 offen offset:0 sc1
 buffer_load_dwordx4 v[44:47], v2, s[4:7], s58 offen offset:128 sc1
 buffer_load_dwordx4 v[48:51], v2, s[4:7], s58 offen offset:1024 sc1
 buffer_load_dwordx4 v[52:55], v2, s[4:7], s58 offen offset:1152 sc1
 buffer_load_dwordx4 v[56:59], v3, s[4:7], s58 offen offset:0 sc1
 s_add_u32 s51, s51, 1
 s_cmp_lt_u32 s51, 131072
 s_cbranch_scc1 L_xm_187
 s_branch L_bail
L_rt_190:
 buffer_load_dwordx2 v[124:125], v1, s[4:7], s66 offen sc1
 s_waitcnt vmcnt(0)
 s_add_u32 s51, s51, 1
 s_cmp_lt_u32 s51, 131072
 s_cbranch_scc1 L_pv_189
 s_branch L_bail
L_rt_194:
 s_add_u32 s51, s51, 1
 s_cmp_lt_u32 s51, 131072
 s_cbranch_scc1 L_pp_193
 s_branch L_bail
L_nr_191:
 s_cmp_lg_u32 s50, 0
 s_cbranch_scc1 L_id_209
 buffer_load_dword v14, off, s[4:7], s32 sc1
 s_waitcnt vmcnt(0)
 s_barrier
 s_add_u32 s76, s53, 1
L_fl_210:
 v_cmp_ge_u32 vcc, s76, v14
 s_cbranch_vccz L_fld_211
 buffer_load_dword v14, off, s[4:7], s32 sc1
 s_waitcnt vmcnt(0)
 s_add_u32 s51, s51, 1
 s_cmp_lt_u32 s51, 131072
 s_cbranch_scc1 L_fl_210
 s_branch L_bail
L_fld_211:
 s_lshl_b32 s16, s76, 19
 s_add_u32 s16, s16, s54
 s_mov_b32 m0, 10240
 s_nop 0
 buffer_load_dwordx4 v1, s[4:7], s16 offen offset:0 sc1 lds
 buffer_load_dwordx4 v1, s[4:7], s16 offen offset:1024 sc1 lds
 buffer_load_dwordx4 v1, s[4:7], s16 offen offset:2048 sc1 lds
 buffer_load_dwordx4 v1, s[4:7], s16 offen offset:3072 sc1 lds
 s_mov_b32 m0, 14336
 s_nop 0
 buffer_load_dwordx4 v12, s[4:7], s16 offen offset:0 sc1 lds
 buffer_load_dwordx4 v12, s[4:7], s16 offen offset:1024 sc1 lds
 buffer_load_dwordx4 v12, s[4:7], s16 offen offset:2048 sc1 lds
 buffer_load_dwordx4 v12, s[4:7], s16 offen offset:3072 sc1 lds
 s_add_u32 s16, s16, 67108864
 s_mov_b32 m0, 18432
 s_nop 0
 buffer_load_dwordx4 v1, s[4:7], s16 offen offset:0 sc1 lds
 buffer_load_dwordx4 v1, s[4:7], s16 offen offset:1024 sc1 lds
 buffer_load_dwordx4 v1, s[4:7], s16 offen offset:2048 sc1 lds
 buffer_load_dwordx4 v1, s[4:7], s16 offen offset:3072 sc1 lds
 s_mov_b32 m0, 22528
 s_nop 0
 buffer_load_dwordx4 v12, s[4:7], s16 offen offset:0 sc1 lds
 buffer_load_dwordx4 v12, s[4:7], s16 offen offset:1024 sc1 lds
 buffer_load_dwordx4 v12, s[4:7], s16 offen offset:2048 sc1 lds
 buffer_load_dwordx4 v12, s[4:7], s16 offen offset:3072 sc1 lds
 s_nop 15
 s_nop 15
 s_nop 15
 s_nop 15
 s_nop 15
 s_branch L_rj_192
L_id_209:
 s_barrier
 s_nop 15
 s_nop 15
 s_nop 15
 s_nop 15
 s_nop 15
 s_nop 15
 s_nop 15
 s_nop 15
 s_nop 15
 s_branch L_rj_192
L_rt_196:
 s_nop 7
 buffer_load_dwordx4 v[40:43], v2, s[4:7], s59 offen offset:0 sc1
 buffer_load_dwordx4 v[44:47], v2, s[4:7], s59 offen offset:128 sc1
 buffer_load_dwordx4 v[48:51], v2, s[4:7], s59 offen offset:1024 sc1
 buffer_load_dwordx4 v[52:55], v2, s[4:7], s59 offen offset:1152 sc1
 buffer_load_dwordx4 v[56:59], v3, s[4:7], s59 offen offset:0 sc1
 s_add_u32 s51, s51, 1
 s_cmp_lt_u32 s51, 131072
 s_cbranch_scc1 L_xm_195
 s_branch L_bail
L_rt_198:
 buffer_load_dwordx2 v[124:125], v1, s[4:7], s67 offen sc1
 s_waitcnt vmcnt(0)
 s_add_u32 s51, s51, 1
 s_cmp_lt_u32 s51, 131072
 s_cbranch_scc1 L_pv_197
 s_branch L_bail
L_rt_202:
 s_add_u32 s51, s51, 1
 s_cmp_lt_u32 s51, 131072
 s_cbranch_scc1 L_pp_201
 s_branch L_bail
L_nr_199:
 s_cmp_lg_u32 s50, 0
 s_cbranch_scc1 L_id_212
 buffer_load_dword v14, off, s[4:7], s32 sc1
 s_waitcnt vmcnt(0)
 s_barrier
 s_add_u32 s76, s53, 1
L_fl_213:
 v_cmp_ge_u32 vcc, s76, v14
 s_cbranch_vccz L_fld_214
 buffer_load_dword v14, off, s[4:7], s32 sc1
 s_waitcnt vmcnt(0)
 s_add_u32 s51, s51, 1
 s_cmp_lt_u32 s51, 131072
 s_cbranch_scc1 L_fl_213
 s_branch L_bail
L_fld_214:
 s_lshl_b32 s16, s76, 19
 s_add_u32 s16, s16, s54
 s_mov_b32 m0, 10240
 s_nop 0
 buffer_load_dwordx4 v1, s[4:7], s16 offen offset:0 sc1 lds
 buffer_load_dwordx4 v1, s[4:7], s16 offen offset:1024 sc1 lds
 buffer_load_dwordx4 v1, s[4:7], s16 offen offset:2048 sc1 lds
 buffer_load_dwordx4 v1, s[4:7], s16 offen offset:3072 sc1 lds
 s_mov_b32 m0, 14336
 s_nop 0
 buffer_load_dwordx4 v12, s[4:7], s16 offen offset:0 sc1 lds
 buffer_load_dwordx4 v12, s[4:7], s16 offen offset:1024 sc1 lds
 buffer_load_dwordx4 v12, s[4:7], s16 offen offset:2048 sc1 lds
 buffer_load_dwordx4 v12, s[4:7], s16 offen offset:3072 sc1 lds
 s_add_u32 s16, s16, 67108864
 s_mov_b32 m0, 18432
 s_nop 0
 buffer_load_dwordx4 v1, s[4:7], s16 offen offset:0 sc1 lds
 buffer_load_dwordx4 v1, s[4:7], s16 offen offset:1024 sc1 lds
 buffer_load_dwordx4 v1, s[4:7], s16 offen offset:2048 sc1 lds
 buffer_load_dwordx4 v1, s[4:7], s16 offen offset:3072 sc1 lds
 s_mov_b32 m0, 22528
 s_nop 0
 buffer_load_dwordx4 v12, s[4:7], s16 offen offset:0 sc1 lds
 buffer_load_dwordx4 v12, s[4:7], s16 offen offset:1024 sc1 lds
 buffer_load_dwordx4 v12, s[4:7], s16 offen offset:2048 sc1 lds
 buffer_load_dwordx4 v12, s[4:7], s16 offen offset:3072 sc1 lds
 s_nop 15
 s_nop 15
 s_nop 15
 s_nop 15
 s_nop 15
 s_branch L_rj_200
L_id_212:
 s_barrier
 s_nop 15
 s_nop 15
 s_nop 15
 s_nop 15
 s_nop 15
 s_nop 15
 s_nop 15
 s_nop 15
 s_nop 15
 s_branch L_rj_200
.p2align 8
L_ch_loops:
 s_mov_b32 s51, 0
 buffer_load_dwordx4 v[40:43], v2, s[4:7], s56 offen offset:0 sc1
 buffer_load_dwordx4 v[44:47], v2, s[4:7], s56 offen offset:128 sc1
 buffer_load_dwordx4 v[48:51], v2, s[4:7], s56 offen offset:1024 sc1
 buffer_load_dwordx4 v[52:55], v2, s[4:7], s56 offen offset:1152 sc1
 buffer_load_dwordx4 v[56:59], v3, s[4:7], s56 offen offset:0 sc1
L_xm_215:
 s_waitcnt vmcnt(4)
 v_mfma_f32_16x16x32_bf16 v[60:63], v[24:27], v[40:43], 0
 s_waitcnt vmcnt(3)
 v_mfma_f32_16x16x32_bf16 v[64:67], v[24:27], v[44:47], 0
 s_waitcnt vmcnt(2)
 v_mfma_f32_16x16x32_bf16 v[68:71], v[24:27], v[48:51], 0
 v_max3_u32 v14, v40, v44, v48
 v_cvt_pk_bf16_f32 v60, v60, v61
 v_cvt_pk_bf16_f32 v61, v62, v63
 ds_write_b64 v4, v[60:61] offset:0
 s_waitcnt vmcnt(1)
 v_mfma_f32_16x16x32_bf16 v[72:75], v[24:27], v[52:55], 0
 v_cvt_pk_bf16_f32 v64, v64, v65
 v_cvt_pk_bf16_f32 v65, v66, v67
 ds_write_b64 v4, v[64:65] offset:8
 s_waitcnt vmcnt(0)
 v_mfma_f32_16x16x32_bf16 v[76:79], v[24:27], v[56:59], 0
 v_max3_u32 v14, v14, v52, v56
 v_cmp_eq_u32 vcc, -1, v14
 v_cvt_pk_bf16_f32 v68, v68, v69
 v_cvt_pk_bf16_f32 v69, v70, v71
 ds_write_b64 v4, v[68:69] offset:1024
 s_cbranch_vccnz L_rt_216
 v_cvt_pk_bf16_f32 v72, v72, v73
 v_cvt_pk_bf16_f32 v73, v74, v75
 ds_write_b64 v4, v[72:73] offset:1032
 s_nop 0
 v_cvt_pk_bf16_f32 v76, v76, v77
 v_cvt_pk_bf16_f32 v77, v78, v79
 ds_write_b64 v5, v[76:77] offset:0
 s_waitcnt lgkmcnt(0)
 s_barrier
 ds_read_b128 v[72:75], v0 offset:0
 ds_read_b128 v[76:79], v0 offset:32
 ds_read_b128 v[80:83], v0 offset:1024
 s_mov_b64 exec, s[30:31]
 buffer_store_dwordx4 v[32:35], v11, s[4:7], s59 offen sc1
 s_mov_b64 exec, -1
 buffer_store_dwordx4 v[32:35], v1, s[4:7], s62 offen sc1
 s_waitcnt lgkmcnt(2)
 v_smfmac_f32_16x16x64_bf16 v[88:91], v[72:75], v[224:231], v17
 ds_read_b128 v[84:87], v0 offset:1056
 v_smfmac_f32_16x16x64_bf16 v[92:95], v[72:75], v[232:239], v17
 ds_read_b128 v[96:99], v0 offset:2048
 s_waitcnt lgkmcnt(3)
 v_smfmac_f32_16x16x64_bf16 v[88:91], v[76:79], v[240:247], v17
 ds_read_b128 v[100:103], v0 offset:2080
 v_smfmac_f32_16x16x64_bf16 v[92:95], v[76:79], v[248:255], v17
 ds_read_b128 v[112:115], v0 offset:3072
 s_waitcnt lgkmcnt(4)
 v_smfmac_f32_16x16x64_bf16 v[88:91], v[80:83], v[192:199], v17
 ds_read_b128 v[40:43], v1 offset:10240
 v_smfmac_f32_16x16x64_bf16 v[92:95], v[80:83], v[200:207], v17
 ds_read_b128 v[116:119], v0 offset:3104
 s_waitcnt lgkmcnt(5)
 v_smfmac_f32_16x16x64_bf16 v[88:91], v[84:87], v[208:215], v17
 ds_read_b128 v[44:47], v1 offset:11264
 v_smfmac_f32_16x16x64_bf16 v[92:95], v[84:87], v[216:223], v17
 ds_read_b128 v[72:75], v0 offset:4096
 s_waitcnt lgkmcnt(6)
 v_smfmac_f32_16x16x64_bf16 v[88:91], v[96:99], a[0:7], v17
 ds_read_b128 v[48:51], v1 offset:12288
 v_smfmac_f32_16x16x64_bf16 v[92:95], v[96:99], a[8:15], v17
 ds_read_b128 v[76:79], v0 offset:4128
 s_waitcnt lgkmcnt(7)
 v_smfmac_f32_16x16x64_bf16 v[88:91], v[100:103], a[16:23], v17
 ds_read_b128 v[52:55], v1 offset:13312
 v_smfmac_f32_16x16x64_bf16 v[92:95], v[100:103], a[24:31], v17
 ds_read_b128 v[80:83], v0 offset:5120
 s_waitcnt lgkmcnt(8)
 v_smfmac_f32_16x16x64_bf16 v[88:91], v[112:115], a[32:39], v17
 ds_read_b128 v[56:59], v1 offset:14336
 v_smfmac_f32_16x16x64_bf16 v[92:95], v[112:115], a[40:47], v17
 ds_read_b128 v[84:87], v0 offset:5152
 s_waitcnt lgkmcnt(8)
 v_smfmac_f32_16x16x64_bf16 v[88:91], v[116:119], a[48:55], v17
 ds_read_b128 v[60:63], v1 offset:15360
 v_smfmac_f32_16x16x64_bf16 v[92:95], v[116:119], a[56:63], v17
 ds_read_b128 v[96:99], v0 offset:6144
 s_waitcnt lgkmcnt(8)
 v_smfmac_f32_16x16x64_bf16 v[88:91], v[72:75], a[64:71], v17
 ds_read_b128 v[64:67], v1 offset:16384
 v_smfmac_f32_16x16x64_bf16 v[92:95], v[72:75], a[72:79], v17
 ds_read_b128 v[100:103], v0 offset:6176
 s_waitcnt lgkmcnt(8)
 v_smfmac_f32_16x16x64_bf16 v[88:91], v[76:79], a[80:87], v17
 ds_read_b128 v[68:71], v1 offset:17408
 v_smfmac_f32_16x16x64_bf16 v[92:95], v[76:79], a[88:95], v17
 ds_read_b128 v[112:115], v0 offset:7168
 s_waitcnt lgkmcnt(8)
 v_smfmac_f32_16x16x64_bf16 v[88:91], v[80:83], a[96:103], v17
 ds_read_b128 v[104:107], v16 offset:18432
 v_smfmac_f32_16x16x64_bf16 v[92:95], v[80:83], a[104:111], v17
 ds_read_b128 v[116:119], v0 offset:7200
 s_waitcnt lgkmcnt(8)
 v_smfmac_f32_16x16x64_bf16 v[88:91], v[84:87], a[112:119], v17
 ds_read_b128 v[108:111], v16 offset:19456
 v_smfmac_f32_16x16x64_bf16 v[92:95], v[84:87], a[120:127], v17
 ds_read_b128 v[72:75], v0 offset:8192
 s_waitcnt lgkmcnt(8)
 v_smfmac_f32_16x16x64_bf16 v[88:91], v[96:99], a[128:135], v17
 ds_read_b128 v[224:227], v15 offset:8192
 v_smfmac_f32_16x16x64_bf16 v[92:95], v[96:99], a[136:143], v17
 ds_read_b128 v[76:79], v0 offset:8224
 s_waitcnt lgkmcnt(8)
 v_smfmac_f32_16x16x64_bf16 v[88:91], v[100:103], a[144:151], v17
 ds_read_b128 v[228:231], v15 offset:9216
 v_smfmac_f32_16x16x64_bf16 v[92:95], v[100:103], a[152:159], v17
 ds_read_b128 v[80:83], v0 offset:9216
 s_waitcnt lgkmcnt(8)
 v_smfmac_f32_16x16x64_bf16 v[88:91], v[112:115], a[160:167], v17
 ds_read_b128 v[232:235], v15 offset:10240
 v_smfmac_f32_16x16x64_bf16 v[92:95], v[112:115], a[168:175], v17
 ds_read_b128 v[84:87], v0 offset:9248
 s_waitcnt lgkmcnt(8)
 v_smfmac_f32_16x16x64_bf16 v[88:91], v[116:119], a[176:183], v17
 ds_read_b128 v[236:239], v15 offset:11264
 v_smfmac_f32_16x16x64_bf16 v[92:95], v[116:119], a[184:191], v17
 ds_read_b128 v[240:243], v15 offset:12288
 s_waitcnt lgkmcnt(8)
 v_smfmac_f32_16x16x64_bf16 v[88:91], v[72:75], a[192:199], v17
 ds_read_b128 v[244:247], v15 offset:13312
 v_smfmac_f32_16x16x64_bf16 v[92:95], v[72:75], a[200:207], v17
 ds_read_b128 v[248:251], v15 offset:14336
 s_waitcnt lgkmcnt(8)
 v_smfmac_f32_16x16x64_bf16 v[88:91], v[76:79], a[208:215], v17
 ds_read_b128 v[252:255], v15 offset:15360
 v_smfmac_f32_16x16x64_bf16 v[92:95], v[76:79], a[216:223], v17
 s_waitcnt lgkmcnt(7)
 v_smfmac_f32_16x16x64_bf16 v[88:91], v[80:83], a[224:231], v17
 v_smfmac_f32_16x16x64_bf16 v[92:95], v[80:83], a[232:239], v17
 s_waitcnt lgkmcnt(5)
 v_smfmac_f32_16x16x64_bf16 v[88:91], v[84:87], a[240:247], v17
 v_smfmac_f32_16x16x64_bf16 v[92:95], v[84:87], a[248:255], v17
 s_nop 2
 v_cvt_pk_bf16_f32 v120, v88, v89
 v_cvt_pk_bf16_f32 v121, v90, v91
 ds_write_b64 v6, v[120:121] offset:26624
 s_nop 1
 v_cvt_pk_bf16_f32 v122, v92, v93
 v_cvt_pk_bf16_f32 v123, v94, v95
 ds_write_b64 v6, v[122:123] offset:27136
 s_waitcnt lgkmcnt(0)
 s_barrier
 ds_read_b64_tr_b16 v[72:73], v7 offset:26624
 ds_read_b64_tr_b16 v[74:75], v7 offset:27136
 ds_read_b64_tr_b16 v[76:77], v7 offset:27648
 ds_read_b64_tr_b16 v[78:79], v7 offset:28160
 ds_read_b64_tr_b16 v[80:81], v7 offset:28672
 ds_read_b64_tr_b16 v[82:83], v7 offset:29184
 ds_read_b64_tr_b16 v[84:85], v7 offset:29696
 ds_read_b64_tr_b16 v[86:87], v7 offset:30208
 ds_read_b64_tr_b16 v[112:113], v8 offset:26624
 ds_read_b64_tr_b16 v[114:115], v8 offset:27136
 s_waitcnt lgkmcnt(8)
 v_mfma_f32_16x16x32_bf16 v[92:95], v[40:43], v[72:75], 0
 v_mfma_f32_16x16x32_bf16 v[96:99], v[56:59], v[72:75], 0
 v_mfma_f32_16x16x32_bf16 v[88:91], v[72:75], v[72:75], 0
 s_waitcnt lgkmcnt(6)
 v_mfma_f32_16x16x32_bf16 v[92:95], v[44:47], v[76:79], v[92:95]
 v_mfma_f32_16x16x32_bf16 v[96:99], v[60:63], v[76:79], v[96:99]
 v_mfma_f32_16x16x32_bf16 v[88:91], v[76:79], v[76:79], v[88:91]
 s_waitcnt lgkmcnt(4)
 v_mfma_f32_16x16x32_bf16 v[92:95], v[48:51], v[80:83], v[92:95]
 buffer_load_dwordx2 v[124:125], v1, s[4:7], s64 offen sc1
 v_mfma_f32_16x16x32_bf16 v[96:99], v[64:67], v[80:83], v[96:99]
 v_mfma_f32_16x16x32_bf16 v[88:91], v[80:83], v[80:83], v[88:91]
 s_waitcnt lgkmcnt(0)
 buffer_store_dwordx4 v[112:115], v1, s[4:7], s60 offen sc1
 s_waitcnt lgkmcnt(2)
 v_mfma_f32_16x16x32_bf16 v[92:95], v[52:55], v[84:87], v[92:95]
 v_mfma_f32_16x16x32_bf16 v[96:99], v[68:71], v[84:87], v[96:99]
 v_mfma_f32_16x16x32_bf16 v[88:91], v[84:87], v[84:87], v[88:91]
 v_mfma_f32_32x32x8_bf16 v[40:55], v[18:19], v[18:19], 0
 v_max3_f32 v126, v92, v93, v94
 ds_read_b128 v[80:83], v15 offset:16384
 ds_read_b128 v[84:87], v15 offset:17408
 v_max3_f32 v126, v126, v95, v96
 v_max3_f32 v126, v126, v97, v98
 v_max3_f32 v126, v126, v99, v90
 v_max_f32 v126, v126, v91
 v_mov_b32 v127, v126
 v_mov_b64 v[56:57], 0
 v_mov_b64 v[58:59], 0
 v_permlane16_swap_b32 v126, v127
 v_max_f32 v126, v126, v127
 v_mov_b32 v127, v126
 s_nop 1
 v_permlane32_swap_b32 v126, v127
 v_max_f32 v126, v126, v127
 v_mul_f32 v126, s79, v126
 v_fma_f32 v92, v92, s79, -v126
 v_fma_f32 v93, v93, s79, -v126
 v_fma_f32 v94, v94, s79, -v126
 v_fma_f32 v95, v95, s79, -v126
 v_fma_f32 v96, v96, s79, -v126
 v_fma_f32 v97, v97, s79, -v126
 v_fma_f32 v98, v98, s79, -v126
 v_fma_f32 v99, v99, s79, -v126
 v_exp_f32 v92, v92
 v_exp_f32 v93, v93
 v_exp_f32 v94, v94
 v_exp_f32 v95, v95
 v_exp_f32 v96, v96
 v_exp_f32 v97, v97
 v_exp_f32 v98, v98
 v_exp_f32 v99, v99
 v_fma_f32 v90, v90, s79, -v126
 v_cvt_pk_bf16_f32 v100, v92, v93
 v_cvt_pk_bf16_f32 v101, v94, v95
 v_cvt_pk_bf16_f32 v102, v96, v97
 v_cvt_pk_bf16_f32 v103, v98, v99
 v_fma_f32 v91, v91, s79, -v126
 v_exp_f32 v90, v90
 v_mfma_f32_16x16x32_bf16 v[120:123], v[28:31], v[100:103], 0
 v_exp_f32 v91, v91
 v_mfma_f32_16x16x32_bf16 v[112:115], v[104:107], v[100:103], 0
 v_cvt_pk_bf16_f32 v36, v90, v91
 v_cvt_pk_bf16_f32 v39, v90, v91
 v_mfma_f32_16x16x32_bf16 v[116:119], v[108:111], v[100:103], 0
 s_waitcnt vmcnt(0)
 v_mfma_f32_16x16x16_bf16 v[120:123], v[28:29], v[36:37], v[120:123]
L_pv_217:
 v_cmp_eq_u32 vcc, -1, v124
 s_cbranch_vccnz L_rt_218
 v_mfma_f32_16x16x16_bf16 v[112:115], v[124:125], v[36:37], v[112:115]
 v_mfma_f32_16x16x16_bf16 v[116:119], v[124:125], v[38:39], v[116:119]
 v_rcp_f32 v120, v120
 ds_read_b128 v[88:91], v15 offset:18432
 ds_read_b128 v[92:95], v15 offset:19456
 ds_read_b128 v[96:99], v15 offset:20480
 ds_read_b128 v[100:103], v15 offset:21504
 s_mov_b64 exec, s[28:29]
 v_pk_mul_f32 v[112:113], v[112:113], v[120:121] op_sel_hi:[1,0]
 v_pk_mul_f32 v[114:115], v[114:115], v[120:121] op_sel_hi:[1,0]
 v_cvt_pk_bf16_f32 v112, v112, v113
 v_cvt_pk_bf16_f32 v113, v114, v115
 v_pk_mul_f32 v[116:117], v[116:117], v[120:121] op_sel_hi:[1,0]
 v_pk_mul_f32 v[118:119], v[118:119], v[120:121] op_sel_hi:[1,0]
 v_cvt_pk_bf16_f32 v114, v116, v117
 v_cvt_pk_bf16_f32 v115, v118, v119
 ds_write_b128 v9, v[112:115] offset:30720
 s_mov_b64 exec, -1
 s_waitcnt lgkmcnt(0)
 s_barrier
 ds_read_b128 v[60:63], v0 offset:30720
 ds_read_b128 v[64:67], v0 offset:30752
 ds_read_b128 v[68:71], v0 offset:31744
 ds_read_b128 v[72:75], v0 offset:31776
 s_waitcnt lgkmcnt(3)
 v_smfmac_f32_16x16x64_bf16 v[40:43], v[60:63], v[224:231], v17
 ds_read_b128 v[224:227], v15 offset:22528
 v_smfmac_f32_16x16x64_bf16 v[44:47], v[60:63], v[232:239], v17
 ds_read_b128 v[228:231], v15 offset:23552
 s_waitcnt lgkmcnt(4)
 v_smfmac_f32_16x16x64_bf16 v[40:43], v[64:67], v[240:247], v17
 ds_read_b128 v[232:235], v15 offset:24576
 v_smfmac_f32_16x16x64_bf16 v[44:47], v[64:67], v[248:255], v17
 ds_read_b128 v[236:239], v15 offset:25600
 s_waitcnt lgkmcnt(5)
 v_smfmac_f32_16x16x64_bf16 v[40:43], v[68:71], v[80:87], v17
 ds_read_b128 v[240:243], v15 offset:26624
 v_smfmac_f32_16x16x64_bf16 v[44:47], v[68:71], v[128:135], v17
 ds_read_b128 v[244:247], v15 offset:27648
 s_waitcnt lgkmcnt(6)
 v_smfmac_f32_16x16x64_bf16 v[40:43], v[72:75], v[136:143], v17
 ds_read_b128 v[248:251], v15 offset:28672
 v_smfmac_f32_16x16x64_bf16 v[44:47], v[72:75], v[144:151], v17
 ds_read_b128 v[252:255], v15 offset:29696
 v_smfmac_f32_16x16x64_bf16 v[48:51], v[60:63], v[152:159], v17
 ds_read_b128 v[80:83], v15 offset:30720
 v_cvt_pk_bf16_f32 v116, v40, v41
 v_cvt_pk_bf16_f32 v117, v42, v43
 v_or_b32 v116, 1, v116
 v_smfmac_f32_16x16x64_bf16 v[52:55], v[60:63], v[160:167], v17
 ds_read_b128 v[84:87], v15 offset:31744
 v_cvt_pk_bf16_f32 v118, v44, v45
 v_cvt_pk_bf16_f32 v119, v46, v47
 v_or_b32 v118, 1, v118
 buffer_store_dwordx4 v[116:119], v10, s[4:7], s68 offen sc1
 v_smfmac_f32_16x16x64_bf16 v[48:51], v[64:67], v[168:175], v17
 v_smfmac_f32_16x16x64_bf16 v[52:55], v[64:67], v[176:183], v17
 v_smfmac_f32_16x16x64_bf16 v[48:51], v[68:71], v[184:191], v17
 v_smfmac_f32_16x16x64_bf16 v[52:55], v[68:71], v[88:95], v17
 v_smfmac_f32_16x16x64_bf16 v[48:51], v[72:75], v[96:103], v17
 s_waitcnt lgkmcnt(8)
 v_smfmac_f32_16x16x64_bf16 v[52:55], v[72:75], v[224:231], v17
 s_waitcnt lgkmcnt(6)
 v_smfmac_f32_16x16x64_bf16 v[56:59], v[60:63], v[232:239], v17
 v_cvt_pk_bf16_f32 v120, v48, v49
 v_cvt_pk_bf16_f32 v121, v50, v51
 v_or_b32 v120, 1, v120
 s_waitcnt lgkmcnt(4)
 v_smfmac_f32_16x16x64_bf16 v[56:59], v[64:67], v[240:247], v17
 v_cvt_pk_bf16_f32 v122, v52, v53
 v_cvt_pk_bf16_f32 v123, v54, v55
 v_or_b32 v122, 1, v122
 buffer_store_dwordx4 v[120:123], v10, s[4:7], s69 offen sc1
 s_waitcnt lgkmcnt(2)
 v_smfmac_f32_16x16x64_bf16 v[56:59], v[68:71], v[248:255], v17
 s_waitcnt lgkmcnt(0)
 v_smfmac_f32_16x16x64_bf16 v[56:59], v[72:75], v[80:87], v17
 s_nop 7
 v_cvt_pk_bf16_f32 v124, v56, v57
 v_cvt_pk_bf16_f32 v125, v58, v59
 v_or_b32 v124, 1, v124
 buffer_store_dwordx2 v[124:125], v10, s[4:7], s70 offen sc1
 ds_read_b128 v[224:227], v15 offset:0
 ds_read_b128 v[228:231], v15 offset:1024
 ds_read_b128 v[232:235], v15 offset:2048
 ds_read_b128 v[236:239], v15 offset:3072
 ds_read_b128 v[240:243], v15 offset:4096
 ds_read_b128 v[244:247], v15 offset:5120
 ds_read_b128 v[248:251], v15 offset:6144
 ds_read_b128 v[252:255], v15 offset:7168
 v_mov_b64 v[88:89], 0
 v_mov_b64 v[90:91], 0
 v_mov_b64 v[92:93], 0
 v_mov_b64 v[94:95], 0
 s_cmp_eq_u32 s55, 0
 s_cbranch_scc1 L_nr_219
 s_nop 15
 s_nop 15
 s_nop 15
 s_nop 15
 s_nop 15
L_pp_221:
 buffer_load_dwordx4 v[40:43], v1, s[4:7], s74 offen offset:0 sc1
 buffer_load_dwordx4 v[44:47], v1, s[4:7], s74 offen offset:1024 sc1
 buffer_load_dwordx4 v[48:51], v1, s[4:7], s74 offen offset:2048 sc1
 buffer_load_dwordx4 v[52:55], v1, s[4:7], s74 offen offset:3072 sc1
 s_waitcnt vmcnt(3)
 v_mfma_f32_16x16x32_bf16 v[56:59], v[40:43], v[20:23], 0
 v_and_b32 v14, v40, v42
 s_waitcnt vmcnt(2)
 v_mfma_f32_16x16x32_bf16 v[56:59], v[44:47], v[20:23], v[56:59]
 v_bitop3_b32 v14, v14, v44, v46 bitop3:0x80
 s_waitcnt vmcnt(1)
 v_mfma_f32_16x16x32_bf16 v[56:59], v[48:51], v[20:23], v[56:59]
 v_bitop3_b32 v14, v14, v48, v50 bitop3:0x80
 s_waitcnt vmcnt(0)
 v_mfma_f32_16x16x32_bf16 v[56:59], v[52:55], v[20:23], v[56:59]
 v_bitop3_b32 v14, v14, v52, v54 bitop3:0x80
 v_and_b32 v14, 1, v14
 v_cmp_ne_u32 vcc, 1, v14
 s_cbranch_vccnz L_rt_222
 s_nop 2
 v_cvt_pk_bf16_f32 v60, v56, v57
 v_cvt_pk_bf16_f32 v61, v58, v59
 s_nop 0
 v_mov_b32_dpp v62, v60 quad_perm:[2,3,2,3] row_mask:0xf bank_mask:0xf
 v_mov_b32_dpp v63, v61 quad_perm:[2,3,2,3] row_mask:0xf bank_mask:0xf
 s_mov_b64 exec, s[30:31]
 buffer_store_dwordx4 v[60:63], v11, s[4:7], s57 offen sc1
 s_mov_b64 exec, 1
 buffer_store_dword v13, off, s[4:7], s17 sc1
 s_mov_b64 exec, -1
 s_barrier
 s_nop 15
 s_nop 15
 s_nop 15
 s_nop 15
 s_nop 15
 s_nop 15
 s_nop 15
 s_nop 15
 s_nop 15
L_rj_220:
 v_add_u32 v13, 1, v13
 s_add_u32 s53, s53, 1
.p2align 3
 s_mov_b32 s51, 0
 buffer_load_dwordx4 v[40:43], v2, s[4:7], s57 offen offset:0 sc1
 buffer_load_dwordx4 v[44:47], v2, s[4:7], s57 offen offset:128 sc1
 buffer_load_dwordx4 v[48:51], v2, s[4:7], s57 offen offset:1024 sc1
 buffer_load_dwordx4 v[52:55], v2, s[4:7], s57 offen offset:1152 sc1
 buffer_load_dwordx4 v[56:59], v3, s[4:7], s57 offen offset:0 sc1
L_xm_223:
 s_waitcnt vmcnt(4)
 v_mfma_f32_16x16x32_bf16 v[60:63], v[24:27], v[40:43], 0
 s_waitcnt vmcnt(3)
 v_mfma_f32_16x16x32_bf16 v[64:67], v[24:27], v[44:47], 0
 s_waitcnt vmcnt(2)
 v_mfma_f32_16x16x32_bf16 v[68:71], v[24:27], v[48:51], 0
 v_max3_u32 v14, v40, v44, v48
 v_cvt_pk_bf16_f32 v60, v60, v61
 v_cvt_pk_bf16_f32 v61, v62, v63
 ds_write_b64 v4, v[60:61] offset:0
 s_waitcnt vmcnt(1)
 v_mfma_f32_16x16x32_bf16 v[72:75], v[24:27], v[52:55], 0
 v_cvt_pk_bf16_f32 v64, v64, v65
 v_cvt_pk_bf16_f32 v65, v66, v67
 ds_write_b64 v4, v[64:65] offset:8
 s_waitcnt vmcnt(0)
 v_mfma_f32_16x16x32_bf16 v[76:79], v[24:27], v[56:59], 0
 v_max3_u32 v14, v14, v52, v56
 v_cmp_eq_u32 vcc, -1, v14
 v_cvt_pk_bf16_f32 v68, v68, v69
 v_cvt_pk_bf16_f32 v69, v70, v71
 ds_write_b64 v4, v[68:69] offset:1024
 s_cbranch_vccnz L_rt_224
 v_cvt_pk_bf16_f32 v72, v72, v73
 v_cvt_pk_bf16_f32 v73, v74, v75
 ds_write_b64 v4, v[72:73] offset:1032
 s_nop 0
 v_cvt_pk_bf16_f32 v76, v76, v77
 v_cvt_pk_bf16_f32 v77, v78, v79
 ds_write_b64 v5, v[76:77] offset:0
 s_waitcnt lgkmcnt(0)
 s_barrier
 ds_read_b128 v[72:75], v0 offset:0
 ds_read_b128 v[76:79], v0 offset:32
 ds_read_b128 v[80:83], v0 offset:1024
 s_mov_b64 exec, s[30:31]
 buffer_store_dwordx4 v[32:35], v11, s[4:7], s56 offen sc1
 s_mov_b64 exec, -1
 buffer_store_dwordx4 v[32:35], v1, s[4:7], s63 offen sc1
 s_waitcnt lgkmcnt(2)
 v_smfmac_f32_16x16x64_bf16 v[88:91], v[72:75], v[224:231], v17
 ds_read_b128 v[84:87], v0 offset:1056
 v_smfmac_f32_16x16x64_bf16 v[92:95], v[72:75], v[232:239], v17
 ds_read_b128 v[96:99], v0 offset:2048
 s_waitcnt lgkmcnt(3)
 v_smfmac_f32_16x16x64_bf16 v[88:91], v[76:79], v[240:247], v17
 ds_read_b128 v[100:103], v0 offset:2080
 v_smfmac_f32_16x16x64_bf16 v[92:95], v[76:79], v[248:255], v17
 ds_read_b128 v[112:115], v0 offset:3072
 s_waitcnt lgkmcnt(4)
 v_smfmac_f32_16x16x64_bf16 v[88:91], v[80:83], v[192:199], v17
 ds_read_b128 v[40:43], v1 offset:10240
 v_smfmac_f32_16x16x64_bf16 v[92:95], v[80:83], v[200:207], v17
 ds_read_b128 v[116:119], v0 offset:3104
 s_waitcnt lgkmcnt(5)
 v_smfmac_f32_16x16x64_bf16 v[88:91], v[84:87], v[208:215], v17
 ds_read_b128 v[44:47], v1 offset:11264
 v_smfmac_f32_16x16x64_bf16 v[92:95], v[84:87], v[216:223], v17
 ds_read_b128 v[72:75], v0 offset:4096
 s_waitcnt lgkmcnt(6)
 v_smfmac_f32_16x16x64_bf16 v[88:91], v[96:99], a[0:7], v17
 ds_read_b128 v[48:51], v1 offset:12288
 v_smfmac_f32_16x16x64_bf16 v[92:95], v[96:99], a[8:15], v17
 ds_read_b128 v[76:79], v0 offset:4128
 s_waitcnt lgkmcnt(7)
 v_smfmac_f32_16x16x64_bf16 v[88:91], v[100:103], a[16:23], v17
 ds_read_b128 v[52:55], v1 offset:13312
 v_smfmac_f32_16x16x64_bf16 v[92:95], v[100:103], a[24:31], v17
 ds_read_b128 v[80:83], v0 offset:5120
 s_waitcnt lgkmcnt(8)
 v_smfmac_f32_16x16x64_bf16 v[88:91], v[112:115], a[32:39], v17
 ds_read_b128 v[56:59], v1 offset:14336
 v_smfmac_f32_16x16x64_bf16 v[92:95], v[112:115], a[40:47], v17
 ds_read_b128 v[84:87], v0 offset:5152
 s_waitcnt lgkmcnt(8)
 v_smfmac_f32_16x16x64_bf16 v[88:91], v[116:119], a[48:55], v17
 ds_read_b128 v[60:63], v1 offset:15360
 v_smfmac_f32_16x16x64_bf16 v[92:95], v[116:119], a[56:63], v17
 ds_read_b128 v[96:99], v0 offset:6144
 s_waitcnt lgkmcnt(8)
 v_smfmac_f32_16x16x64_bf16 v[88:91], v[72:75], a[64:71], v17
 ds_read_b128 v[64:67], v1 offset:16384
 v_smfmac_f32_16x16x64_bf16 v[92:95], v[72:75], a[72:79], v17
 ds_read_b128 v[100:103], v0 offset:6176
 s_waitcnt lgkmcnt(8)
 v_smfmac_f32_16x16x64_bf16 v[88:91], v[76:79], a[80:87], v17
 ds_read_b128 v[68:71], v1 offset:17408
 v_smfmac_f32_16x16x64_bf16 v[92:95], v[76:79], a[88:95], v17
 ds_read_b128 v[112:115], v0 offset:7168
 s_waitcnt lgkmcnt(8)
 v_smfmac_f32_16x16x64_bf16 v[88:91], v[80:83], a[96:103], v17
 ds_read_b128 v[104:107], v16 offset:18432
 v_smfmac_f32_16x16x64_bf16 v[92:95], v[80:83], a[104:111], v17
 ds_read_b128 v[116:119], v0 offset:7200
 s_waitcnt lgkmcnt(8)
 v_smfmac_f32_16x16x64_bf16 v[88:91], v[84:87], a[112:119], v17
 ds_read_b128 v[108:111], v16 offset:19456
 v_smfmac_f32_16x16x64_bf16 v[92:95], v[84:87], a[120:127], v17
 ds_read_b128 v[72:75], v0 offset:8192
 s_waitcnt lgkmcnt(8)
 v_smfmac_f32_16x16x64_bf16 v[88:91], v[96:99], a[128:135], v17
 ds_read_b128 v[224:227], v15 offset:8192
 v_smfmac_f32_16x16x64_bf16 v[92:95], v[96:99], a[136:143], v17
 ds_read_b128 v[76:79], v0 offset:8224
 s_waitcnt lgkmcnt(8)
 v_smfmac_f32_16x16x64_bf16 v[88:91], v[100:103], a[144:151], v17
 ds_read_b128 v[228:231], v15 offset:9216
 v_smfmac_f32_16x16x64_bf16 v[92:95], v[100:103], a[152:159], v17
 ds_read_b128 v[80:83], v0 offset:9216
 s_waitcnt lgkmcnt(8)
 v_smfmac_f32_16x16x64_bf16 v[88:91], v[112:115], a[160:167], v17
 ds_read_b128 v[232:235], v15 offset:10240
 v_smfmac_f32_16x16x64_bf16 v[92:95], v[112:115], a[168:175], v17
 ds_read_b128 v[84:87], v0 offset:9248
 s_waitcnt lgkmcnt(8)
 v_smfmac_f32_16x16x64_bf16 v[88:91], v[116:119], a[176:183], v17
 ds_read_b128 v[236:239], v15 offset:11264
 v_smfmac_f32_16x16x64_bf16 v[92:95], v[116:119], a[184:191], v17
 ds_read_b128 v[240:243], v15 offset:12288
 s_waitcnt lgkmcnt(8)
 v_smfmac_f32_16x16x64_bf16 v[88:91], v[72:75], a[192:199], v17
 ds_read_b128 v[244:247], v15 offset:13312
 v_smfmac_f32_16x16x64_bf16 v[92:95], v[72:75], a[200:207], v17
 ds_read_b128 v[248:251], v15 offset:14336
 s_waitcnt lgkmcnt(8)
 v_smfmac_f32_16x16x64_bf16 v[88:91], v[76:79], a[208:215], v17
 ds_read_b128 v[252:255], v15 offset:15360
 v_smfmac_f32_16x16x64_bf16 v[92:95], v[76:79], a[216:223], v17
 s_waitcnt lgkmcnt(7)
 v_smfmac_f32_16x16x64_bf16 v[88:91], v[80:83], a[224:231], v17
 v_smfmac_f32_16x16x64_bf16 v[92:95], v[80:83], a[232:239], v17
 s_waitcnt lgkmcnt(5)
 v_smfmac_f32_16x16x64_bf16 v[88:91], v[84:87], a[240:247], v17
 v_smfmac_f32_16x16x64_bf16 v[92:95], v[84:87], a[248:255], v17
 s_nop 2
 v_cvt_pk_bf16_f32 v120, v88, v89
 v_cvt_pk_bf16_f32 v121, v90, v91
 ds_write_b64 v6, v[120:121] offset:26624
 s_nop 1
 v_cvt_pk_bf16_f32 v122, v92, v93
 v_cvt_pk_bf16_f32 v123, v94, v95
 ds_write_b64 v6, v[122:123] offset:27136
 s_waitcnt lgkmcnt(0)
 s_barrier
 ds_read_b64_tr_b16 v[72:73], v7 offset:26624
 ds_read_b64_tr_b16 v[74:75], v7 offset:27136
 ds_read_b64_tr_b16 v[76:77], v7 offset:27648
 ds_read_b64_tr_b16 v[78:79], v7 offset:28160
 ds_read_b64_tr_b16 v[80:81], v7 offset:28672
 ds_read_b64_tr_b16 v[82:83], v7 offset:29184
 ds_read_b64_tr_b16 v[84:85], v7 offset:29696
 ds_read_b64_tr_b16 v[86:87], v7 offset:30208
 ds_read_b64_tr_b16 v[112:113], v8 offset:26624
 ds_read_b64_tr_b16 v[114:115], v8 offset:27136
 s_waitcnt lgkmcnt(8)
 v_mfma_f32_16x16x32_bf16 v[92:95], v[40:43], v[72:75], 0
 v_mfma_f32_16x16x32_bf16 v[96:99], v[56:59], v[72:75], 0
 v_mfma_f32_16x16x32_bf16 v[88:91], v[72:75], v[72:75], 0
 s_waitcnt lgkmcnt(6)
 v_mfma_f32_16x16x32_bf16 v[92:95], v[44:47], v[76:79], v[92:95]
 v_mfma_f32_16x16x32_bf16 v[96:99], v[60:63], v[76:79], v[96:99]
 v_mfma_f32_16x16x32_bf16 v[88:91], v[76:79], v[76:79], v[88:91]
 s_waitcnt lgkmcnt(4)
 v_mfma_f32_16x16x32_bf16 v[92:95], v[48:51], v[80:83], v[92:95]
 buffer_load_dwordx2 v[124:125], v1, s[4:7], s65 offen sc1
 v_mfma_f32_16x16x32_bf16 v[96:99], v[64:67], v[80:83], v[96:99]
 v_mfma_f32_16x16x32_bf16 v[88:91], v[80:83], v[80:83], v[88:91]
 s_waitcnt lgkmcnt(0)
 buffer_store_dwordx4 v[112:115], v1, s[4:7], s61 offen sc1
 s_waitcnt lgkmcnt(2)
 v_mfma_f32_16x16x32_bf16 v[92:95], v[52:55], v[84:87], v[92:95]
 v_mfma_f32_16x16x32_bf16 v[96:99], v[68:71], v[84:87], v[96:99]
 v_mfma_f32_16x16x32_bf16 v[88:91], v[84:87], v[84:87], v[88:91]
 v_mfma_f32_32x32x8_bf16 v[40:55], v[18:19], v[18:19], 0
 v_max3_f32 v126, v92, v93, v94
 ds_read_b128 v[80:83], v15 offset:16384
 ds_read_b128 v[84:87], v15 offset:17408
 v_max3_f32 v126, v126, v95, v96
 v_max3_f32 v126, v126, v97, v98
 v_max3_f32 v126, v126, v99, v90
 v_max_f32 v126, v126, v91
 v_mov_b32 v127, v126
 v_mov_b64 v[56:57], 0
 v_mov_b64 v[58:59], 0
 v_permlane16_swap_b32 v126, v127
 v_max_f32 v126, v126, v127
 v_mov_b32 v127, v126
 s_nop 1
 v_permlane32_swap_b32 v126, v127
 v_max_f32 v126, v126, v127
 v_mul_f32 v126, s79, v126
 v_fma_f32 v92, v92, s79, -v126
 v_fma_f32 v93, v93, s79, -v126
 v_fma_f32 v94, v94, s79, -v126
 v_fma_f32 v95, v95, s79, -v126
 v_fma_f32 v96, v96, s79, -v126
 v_fma_f32 v97, v97, s79, -v126
 v_fma_f32 v98, v98, s79, -v126
 v_fma_f32 v99, v99, s79, -v126
 v_exp_f32 v92, v92
 v_exp_f32 v93, v93
 v_exp_f32 v94, v94
 v_exp_f32 v95, v95
 v_exp_f32 v96, v96
 v_exp_f32 v97, v97
 v_exp_f32 v98, v98
 v_exp_f32 v99, v99
 v_fma_f32 v90, v90, s79, -v126
 v_cvt_pk_bf16_f32 v100, v92, v93
 v_cvt_pk_bf16_f32 v101, v94, v95
 v_cvt_pk_bf16_f32 v102, v96, v97
 v_cvt_pk_bf16_f32 v103, v98, v99
 v_fma_f32 v91, v91, s79, -v126
 v_exp_f32 v90, v90
 v_mfma_f32_16x16x32_bf16 v[120:123], v[28:31], v[100:103], 0
 v_exp_f32 v91, v91
 v_mfma_f32_16x16x32_bf16 v[112:115], v[104:107], v[100:103], 0
 v_cvt_pk_bf16_f32 v36, v90, v91
 v_cvt_pk_bf16_f32 v39, v90, v91
 v_mfma_f32_16x16x32_bf16 v[116:119], v[108:111], v[100:103], 0
 s_waitcnt vmcnt(0)
 v_mfma_f32_16x16x16_bf16 v[120:123], v[28:29], v[36:37], v[120:123]
L_pv_225:
 v_cmp_eq_u32 vcc, -1, v124
 s_cbranch_vccnz L_rt_226
 v_mfma_f32_16x16x16_bf16 v[112:115], v[124:125], v[36:37], v[112:115]
 v_mfma_f32_16x16x16_bf16 v[116:119], v[124:125], v[38:39], v[116:119]
 v_rcp_f32 v120, v120
 ds_read_b128 v[88:91], v15 offset:18432
 ds_read_b128 v[92:95], v15 offset:19456
 ds_read_b128 v[96:99], v15 offset:20480
 ds_read_b128 v[100:103], v15 offset:21504
 s_mov_b64 exec, s[28:29]
 v_pk_mul_f32 v[112:113], v[112:113], v[120:121] op_sel_hi:[1,0]
 v_pk_mul_f32 v[114:115], v[114:115], v[120:121] op_sel_hi:[1,0]
 v_cvt_pk_bf16_f32 v112, v112, v113
 v_cvt_pk_bf16_f32 v113, v114, v115
 v_pk_mul_f32 v[116:117], v[116:117], v[120:121] op_sel_hi:[1,0]
 v_pk_mul_f32 v[118:119], v[118:119], v[120:121] op_sel_hi:[1,0]
 v_cvt_pk_bf16_f32 v114, v116, v117
 v_cvt_pk_bf16_f32 v115, v118, v119
 ds_write_b128 v9, v[112:115] offset:30720
 s_mov_b64 exec, -1
 s_waitcnt lgkmcnt(0)
 s_barrier
 ds_read_b128 v[60:63], v0 offset:30720
 ds_read_b128 v[64:67], v0 offset:30752
 ds_read_b128 v[68:71], v0 offset:31744
 ds_read_b128 v[72:75], v0 offset:31776
 s_waitcnt lgkmcnt(3)
 v_smfmac_f32_16x16x64_bf16 v[40:43], v[60:63], v[224:231], v17
 ds_read_b128 v[224:227], v15 offset:22528
 v_smfmac_f32_16x16x64_bf16 v[44:47], v[60:63], v[232:239], v17
 ds_read_b128 v[228:231], v15 offset:23552
 s_waitcnt lgkmcnt(4)
 v_smfmac_f32_16x16x64_bf16 v[40:43], v[64:67], v[240:247], v17
 ds_read_b128 v[232:235], v15 offset:24576
 v_smfmac_f32_16x16x64_bf16 v[44:47], v[64:67], v[248:255], v17
 ds_read_b128 v[236:239], v15 offset:25600
 s_waitcnt lgkmcnt(5)
 v_smfmac_f32_16x16x64_bf16 v[40:43], v[68:71], v[80:87], v17
 ds_read_b128 v[240:243], v15 offset:26624
 v_smfmac_f32_16x16x64_bf16 v[44:47], v[68:71], v[128:135], v17
 ds_read_b128 v[244:247], v15 offset:27648
 s_waitcnt lgkmcnt(6)
 v_smfmac_f32_16x16x64_bf16 v[40:43], v[72:75], v[136:143], v17
 ds_read_b128 v[248:251], v15 offset:28672
 v_smfmac_f32_16x16x64_bf16 v[44:47], v[72:75], v[144:151], v17
 ds_read_b128 v[252:255], v15 offset:29696
 v_smfmac_f32_16x16x64_bf16 v[48:51], v[60:63], v[152:159], v17
 ds_read_b128 v[80:83], v15 offset:30720
 v_cvt_pk_bf16_f32 v116, v40, v41
 v_cvt_pk_bf16_f32 v117, v42, v43
 v_or_b32 v116, 1, v116
 v_smfmac_f32_16x16x64_bf16 v[52:55], v[60:63], v[160:167], v17
 ds_read_b128 v[84:87], v15 offset:31744
 v_cvt_pk_bf16_f32 v118, v44, v45
 v_cvt_pk_bf16_f32 v119, v46, v47
 v_or_b32 v118, 1, v118
 buffer_store_dwordx4 v[116:119], v10, s[4:7], s71 offen sc1
 v_smfmac_f32_16x16x64_bf16 v[48:51], v[64:67], v[168:175], v17
 v_smfmac_f32_16x16x64_bf16 v[52:55], v[64:67], v[176:183], v17
 v_smfmac_f32_16x16x64_bf16 v[48:51], v[68:71], v[184:191], v17
 v_smfmac_f32_16x16x64_bf16 v[52:55], v[68:71], v[88:95], v17
 v_smfmac_f32_16x16x64_bf16 v[48:51], v[72:75], v[96:103], v17
 s_waitcnt lgkmcnt(8)
 v_smfmac_f32_16x16x64_bf16 v[52:55], v[72:75], v[224:231], v17
 s_waitcnt lgkmcnt(6)
 v_smfmac_f32_16x16x64_bf16 v[56:59], v[60:63], v[232:239], v17
 v_cvt_pk_bf16_f32 v120, v48, v49
 v_cvt_pk_bf16_f32 v121, v50, v51
 v_or_b32 v120, 1, v120
 s_waitcnt lgkmcnt(4)
 v_smfmac_f32_16x16x64_bf16 v[56:59], v[64:67], v[240:247], v17
 v_cvt_pk_bf16_f32 v122, v52, v53
 v_cvt_pk_bf16_f32 v123, v54, v55
 v_or_b32 v122, 1, v122
 buffer_store_dwordx4 v[120:123], v10, s[4:7], s72 offen sc1
 s_waitcnt lgkmcnt(2)
 v_smfmac_f32_16x16x64_bf16 v[56:59], v[68:71], v[248:255], v17
 s_waitcnt lgkmcnt(0)
 v_smfmac_f32_16x16x64_bf16 v[56:59], v[72:75], v[80:87], v17
 s_nop 7
 v_cvt_pk_bf16_f32 v124, v56, v57
 v_cvt_pk_bf16_f32 v125, v58, v59
 v_or_b32 v124, 1, v124
 buffer_store_dwordx2 v[124:125], v10, s[4:7], s73 offen sc1
 ds_read_b128 v[224:227], v15 offset:0
 ds_read_b128 v[228:231], v15 offset:1024
 ds_read_b128 v[232:235], v15 offset:2048
 ds_read_b128 v[236:239], v15 offset:3072
 ds_read_b128 v[240:243], v15 offset:4096
 ds_read_b128 v[244:247], v15 offset:5120
 ds_read_b128 v[248:251], v15 offset:6144
 ds_read_b128 v[252:255], v15 offset:7168
 v_mov_b64 v[88:89], 0
 v_mov_b64 v[90:91], 0
 v_mov_b64 v[92:93], 0
 v_mov_b64 v[94:95], 0
 s_cmp_eq_u32 s55, 0
 s_cbranch_scc1 L_nr_227
 s_nop 15
 s_nop 15
 s_nop 15
 s_nop 15
 s_nop 15
L_pp_229:
 buffer_load_dwordx4 v[40:43], v1, s[4:7], s75 offen offset:0 sc1
 buffer_load_dwordx4 v[44:47], v1, s[4:7], s75 offen offset:1024 sc1
 buffer_load_dwordx4 v[48:51], v1, s[4:7], s75 offen offset:2048 sc1
 buffer_load_dwordx4 v[52:55], v1, s[4:7], s75 offen offset:3072 sc1
 s_waitcnt vmcnt(3)
 v_mfma_f32_16x16x32_bf16 v[56:59], v[40:43], v[20:23], 0
 v_and_b32 v14, v40, v42
 s_waitcnt vmcnt(2)
 v_mfma_f32_16x16x32_bf16 v[56:59], v[44:47], v[20:23], v[56:59]
 v_bitop3_b32 v14, v14, v44, v46 bitop3:0x80
 s_waitcnt vmcnt(1)
 v_mfma_f32_16x16x32_bf16 v[56:59], v[48:51], v[20:23], v[56:59]
 v_bitop3_b32 v14, v14, v48, v50 bitop3:0x80
 s_waitcnt vmcnt(0)
 v_mfma_f32_16x16x32_bf16 v[56:59], v[52:55], v[20:23], v[56:59]
 v_bitop3_b32 v14, v14, v52, v54 bitop3:0x80
 v_and_b32 v14, 1, v14
 v_cmp_ne_u32 vcc, 1, v14
 s_cbranch_vccnz L_rt_230
 s_nop 2
 v_cvt_pk_bf16_f32 v60, v56, v57
 v_cvt_pk_bf16_f32 v61, v58, v59
 s_nop 0
 v_mov_b32_dpp v62, v60 quad_perm:[2,3,2,3] row_mask:0xf bank_mask:0xf
 v_mov_b32_dpp v63, v61 quad_perm:[2,3,2,3] row_mask:0xf bank_mask:0xf
 s_mov_b64 exec, s[30:31]
 buffer_store_dwordx4 v[60:63], v11, s[4:7], s58 offen sc1
 s_mov_b64 exec, 1
 buffer_store_dword v13, off, s[4:7], s17 sc1
 s_mov_b64 exec, -1
 s_barrier
 s_nop 15
 s_nop 15
 s_nop 15
 s_nop 15
 s_nop 15
 s_nop 15
 s_nop 15
 s_nop 15
 s_nop 15
L_rj_228:
 v_add_u32 v13, 1, v13
 s_add_u32 s53, s53, 1
.p2align 3
 s_mov_b32 s51, 0
 buffer_load_dwordx4 v[40:43], v2, s[4:7], s58 offen offset:0 sc1
 buffer_load_dwordx4 v[44:47], v2, s[4:7], s58 offen offset:128 sc1
 buffer_load_dwordx4 v[48:51], v2, s[4:7], s58 offen offset:1024 sc1
 buffer_load_dwordx4 v[52:55], v2, s[4:7], s58 offen offset:1152 sc1
 buffer_load_dwordx4 v[56:59], v3, s[4:7], s58 offen offset:0 sc1
L_xm_231:
 s_waitcnt vmcnt(4)
 v_mfma_f32_16x16x32_bf16 v[60:63], v[24:27], v[40:43], 0
 s_waitcnt vmcnt(3)
 v_mfma_f32_16x16x32_bf16 v[64:67], v[24:27], v[44:47], 0
 s_waitcnt vmcnt(2)
 v_mfma_f32_16x16x32_bf16 v[68:71], v[24:27], v[48:51], 0
 v_max3_u32 v14, v40, v44, v48
 v_cvt_pk_bf16_f32 v60, v60, v61
 v_cvt_pk_bf16_f32 v61, v62, v63
 ds_write_b64 v4, v[60:61] offset:0
 s_waitcnt vmcnt(1)
 v_mfma_f32_16x16x32_bf16 v[72:75], v[24:27], v[52:55], 0
 v_cvt_pk_bf16_f32 v64, v64, v65
 v_cvt_pk_bf16_f32 v65, v66, v67
 ds_write_b64 v4, v[64:65] offset:8
 s_waitcnt vmcnt(0)
 v_mfma_f32_16x16x32_bf16 v[76:79], v[24:27], v[56:59], 0
 v_max3_u32 v14, v14, v52, v56
 v_cmp_eq_u32 vcc, -1, v14
 v_cvt_pk_bf16_f32 v68, v68, v69
 v_cvt_pk_bf16_f32 v69, v70, v71
 ds_write_b64 v4, v[68:69] offset:1024
 s_cbranch_vccnz L_rt_232
 v_cvt_pk_bf16_f32 v72, v72, v73
 v_cvt_pk_bf16_f32 v73, v74, v75
 ds_write_b64 v4, v[72:73] offset:1032
 s_nop 0
 v_cvt_pk_bf16_f32 v76, v76, v77
 v_cvt_pk_bf16_f32 v77, v78, v79
 ds_write_b64 v5, v[76:77] offset:0
 s_waitcnt lgkmcnt(0)
 s_barrier
 ds_read_b128 v[72:75], v0 offset:0
 ds_read_b128 v[76:79], v0 offset:32
 ds_read_b128 v[80:83], v0 offset:1024
 s_mov_b64 exec, s[30:31]
 buffer_store_dwordx4 v[32:35], v11, s[4:7], s57 offen sc1
 s_mov_b64 exec, -1
 buffer_store_dwordx4 v[32:35], v1, s[4:7], s60 offen sc1
 s_waitcnt lgkmcnt(2)
 v_smfmac_f32_16x16x64_bf16 v[88:91], v[72:75], v[224:231], v17
 ds_read_b128 v[84:87], v0 offset:1056
 v_smfmac_f32_16x16x64_bf16 v[92:95], v[72:75], v[232:239], v17
 ds_read_b128 v[96:99], v0 offset:2048
 s_waitcnt lgkmcnt(3)
 v_smfmac_f32_16x16x64_bf16 v[88:91], v[76:79], v[240:247], v17
 ds_read_b128 v[100:103], v0 offset:2080
 v_smfmac_f32_16x16x64_bf16 v[92:95], v[76:79], v[248:255], v17
 ds_read_b128 v[112:115], v0 offset:3072
 s_waitcnt lgkmcnt(4)
 v_smfmac_f32_16x16x64_bf16 v[88:91], v[80:83], v[192:199], v17
 ds_read_b128 v[40:43], v1 offset:10240
 v_smfmac_f32_16x16x64_bf16 v[92:95], v[80:83], v[200:207], v17
 ds_read_b128 v[116:119], v0 offset:3104
 s_waitcnt lgkmcnt(5)
 v_smfmac_f32_16x16x64_bf16 v[88:91], v[84:87], v[208:215], v17
 ds_read_b128 v[44:47], v1 offset:11264
 v_smfmac_f32_16x16x64_bf16 v[92:95], v[84:87], v[216:223], v17
 ds_read_b128 v[72:75], v0 offset:4096
 s_waitcnt lgkmcnt(6)
 v_smfmac_f32_16x16x64_bf16 v[88:91], v[96:99], a[0:7], v17
 ds_read_b128 v[48:51], v1 offset:12288
 v_smfmac_f32_16x16x64_bf16 v[92:95], v[96:99], a[8:15], v17
 ds_read_b128 v[76:79], v0 offset:4128
 s_waitcnt lgkmcnt(7)
 v_smfmac_f32_16x16x64_bf16 v[88:91], v[100:103], a[16:23], v17
 ds_read_b128 v[52:55], v1 offset:13312
 v_smfmac_f32_16x16x64_bf16 v[92:95], v[100:103], a[24:31], v17
 ds_read_b128 v[80:83], v0 offset:5120
 s_waitcnt lgkmcnt(8)
 v_smfmac_f32_16x16x64_bf16 v[88:91], v[112:115], a[32:39], v17
 ds_read_b128 v[56:59], v1 offset:14336
 v_smfmac_f32_16x16x64_bf16 v[92:95], v[112:115], a[40:47], v17
 ds_read_b128 v[84:87], v0 offset:5152
 s_waitcnt lgkmcnt(8)
 v_smfmac_f32_16x16x64_bf16 v[88:91], v[116:119], a[48:55], v17
 ds_read_b128 v[60:63], v1 offset:15360
 v_smfmac_f32_16x16x64_bf16 v[92:95], v[116:119], a[56:63], v17
 ds_read_b128 v[96:99], v0 offset:6144
 s_waitcnt lgkmcnt(8)
 v_smfmac_f32_16x16x64_bf16 v[88:91], v[72:75], a[64:71], v17
 ds_read_b128 v[64:67], v1 offset:16384
 v_smfmac_f32_16x16x64_bf16 v[92:95], v[72:75], a[72:79], v17
 ds_read_b128 v[100:103], v0 offset:6176
 s_waitcnt lgkmcnt(8)
 v_smfmac_f32_16x16x64_bf16 v[88:91], v[76:79], a[80:87], v17
 ds_read_b128 v[68:71], v1 offset:17408
 v_smfmac_f32_16x16x64_bf16 v[92:95], v[76:79], a[88:95], v17
 ds_read_b128 v[112:115], v0 offset:7168
 s_waitcnt lgkmcnt(8)
 v_smfmac_f32_16x16x64_bf16 v[88:91], v[80:83], a[96:103], v17
 ds_read_b128 v[104:107], v16 offset:18432
 v_smfmac_f32_16x16x64_bf16 v[92:95], v[80:83], a[104:111], v17
 ds_read_b128 v[116:119], v0 offset:7200
 s_waitcnt lgkmcnt(8)
 v_smfmac_f32_16x16x64_bf16 v[88:91], v[84:87], a[112:119], v17
 ds_read_b128 v[108:111], v16 offset:19456
 v_smfmac_f32_16x16x64_bf16 v[92:95], v[84:87], a[120:127], v17
 ds_read_b128 v[72:75], v0 offset:8192
 s_waitcnt lgkmcnt(8)
 v_smfmac_f32_16x16x64_bf16 v[88:91], v[96:99], a[128:135], v17
 ds_read_b128 v[224:227], v15 offset:8192
 v_smfmac_f32_16x16x64_bf16 v[92:95], v[96:99], a[136:143], v17
 ds_read_b128 v[76:79], v0 offset:8224
 s_waitcnt lgkmcnt(8)
 v_smfmac_f32_16x16x64_bf16 v[88:91], v[100:103], a[144:151], v17
 ds_read_b128 v[228:231], v15 offset:9216
 v_smfmac_f32_16x16x64_bf16 v[92:95], v[100:103], a[152:159], v17
 ds_read_b128 v[80:83], v0 offset:9216
 s_waitcnt lgkmcnt(8)
 v_smfmac_f32_16x16x64_bf16 v[88:91], v[112:115], a[160:167], v17
 ds_read_b128 v[232:235], v15 offset:10240
 v_smfmac_f32_16x16x64_bf16 v[92:95], v[112:115], a[168:175], v17
 ds_read_b128 v[84:87], v0 offset:9248
 s_waitcnt lgkmcnt(8)
 v_smfmac_f32_16x16x64_bf16 v[88:91], v[116:119], a[176:183], v17
 ds_read_b128 v[236:239], v15 offset:11264
 v_smfmac_f32_16x16x64_bf16 v[92:95], v[116:119], a[184:191], v17
 ds_read_b128 v[240:243], v15 offset:12288
 s_waitcnt lgkmcnt(8)
 v_smfmac_f32_16x16x64_bf16 v[88:91], v[72:75], a[192:199], v17
 ds_read_b128 v[244:247], v15 offset:13312
 v_smfmac_f32_16x16x64_bf16 v[92:95], v[72:75], a[200:207], v17
 ds_read_b128 v[248:251], v15 offset:14336
 s_waitcnt lgkmcnt(8)
 v_smfmac_f32_16x16x64_bf16 v[88:91], v[76:79], a[208:215], v17
 ds_read_b128 v[252:255], v15 offset:15360
 v_smfmac_f32_16x16x64_bf16 v[92:95], v[76:79], a[216:223], v17
 s_waitcnt lgkmcnt(7)
 v_smfmac_f32_16x16x64_bf16 v[88:91], v[80:83], a[224:231], v17
 v_smfmac_f32_16x16x64_bf16 v[92:95], v[80:83], a[232:239], v17
 s_waitcnt lgkmcnt(5)
 v_smfmac_f32_16x16x64_bf16 v[88:91], v[84:87], a[240:247], v17
 v_smfmac_f32_16x16x64_bf16 v[92:95], v[84:87], a[248:255], v17
 s_nop 2
 v_cvt_pk_bf16_f32 v120, v88, v89
 v_cvt_pk_bf16_f32 v121, v90, v91
 ds_write_b64 v6, v[120:121] offset:26624
 s_nop 1
 v_cvt_pk_bf16_f32 v122, v92, v93
 v_cvt_pk_bf16_f32 v123, v94, v95
 ds_write_b64 v6, v[122:123] offset:27136
 s_waitcnt lgkmcnt(0)
 s_barrier
 ds_read_b64_tr_b16 v[72:73], v7 offset:26624
 ds_read_b64_tr_b16 v[74:75], v7 offset:27136
 ds_read_b64_tr_b16 v[76:77], v7 offset:27648
 ds_read_b64_tr_b16 v[78:79], v7 offset:28160
 ds_read_b64_tr_b16 v[80:81], v7 offset:28672
 ds_read_b64_tr_b16 v[82:83], v7 offset:29184
 ds_read_b64_tr_b16 v[84:85], v7 offset:29696
 ds_read_b64_tr_b16 v[86:87], v7 offset:30208
 ds_read_b64_tr_b16 v[112:113], v8 offset:26624
 ds_read_b64_tr_b16 v[114:115], v8 offset:27136
 s_waitcnt lgkmcnt(8)
 v_mfma_f32_16x16x32_bf16 v[92:95], v[40:43], v[72:75], 0
 v_mfma_f32_16x16x32_bf16 v[96:99], v[56:59], v[72:75], 0
 v_mfma_f32_16x16x32_bf16 v[88:91], v[72:75], v[72:75], 0
 s_waitcnt lgkmcnt(6)
 v_mfma_f32_16x16x32_bf16 v[92:95], v[44:47], v[76:79], v[92:95]
 v_mfma_f32_16x16x32_bf16 v[96:99], v[60:63], v[76:79], v[96:99]
 v_mfma_f32_16x16x32_bf16 v[88:91], v[76:79], v[76:79], v[88:91]
 s_waitcnt lgkmcnt(4)
 v_mfma_f32_16x16x32_bf16 v[92:95], v[48:51], v[80:83], v[92:95]
 buffer_load_dwordx2 v[124:125], v1, s[4:7], s66 offen sc1
 v_mfma_f32_16x16x32_bf16 v[96:99], v[64:67], v[80:83], v[96:99]
 v_mfma_f32_16x16x32_bf16 v[88:91], v[80:83], v[80:83], v[88:91]
 s_waitcnt lgkmcnt(0)
 buffer_store_dwordx4 v[112:115], v1, s[4:7], s62 offen sc1
 s_waitcnt lgkmcnt(2)
 v_mfma_f32_16x16x32_bf16 v[92:95], v[52:55], v[84:87], v[92:95]
 v_mfma_f32_16x16x32_bf16 v[96:99], v[68:71], v[84:87], v[96:99]
 v_mfma_f32_16x16x32_bf16 v[88:91], v[84:87], v[84:87], v[88:91]
 v_mfma_f32_32x32x8_bf16 v[40:55], v[18:19], v[18:19], 0
 v_max3_f32 v126, v92, v93, v94
 ds_read_b128 v[80:83], v15 offset:16384
 ds_read_b128 v[84:87], v15 offset:17408
 v_max3_f32 v126, v126, v95, v96
 v_max3_f32 v126, v126, v97, v98
 v_max3_f32 v126, v126, v99, v90
 v_max_f32 v126, v126, v91
 v_mov_b32 v127, v126
 v_mov_b64 v[56:57], 0
 v_mov_b64 v[58:59], 0
 v_permlane16_swap_b32 v126, v127
 v_max_f32 v126, v126, v127
 v_mov_b32 v127, v126
 s_nop 1
 v_permlane32_swap_b32 v126, v127
 v_max_f32 v126, v126, v127
 v_mul_f32 v126, s79, v126
 v_fma_f32 v92, v92, s79, -v126
 v_fma_f32 v93, v93, s79, -v126
 v_fma_f32 v94, v94, s79, -v126
 v_fma_f32 v95, v95, s79, -v126
 v_fma_f32 v96, v96, s79, -v126
 v_fma_f32 v97, v97, s79, -v126
 v_fma_f32 v98, v98, s79, -v126
 v_fma_f32 v99, v99, s79, -v126
 v_exp_f32 v92, v92
 v_exp_f32 v93, v93
 v_exp_f32 v94, v94
 v_exp_f32 v95, v95
 v_exp_f32 v96, v96
 v_exp_f32 v97, v97
 v_exp_f32 v98, v98
 v_exp_f32 v99, v99
 v_fma_f32 v90, v90, s79, -v126
 v_cvt_pk_bf16_f32 v100, v92, v93
 v_cvt_pk_bf16_f32 v101, v94, v95
 v_cvt_pk_bf16_f32 v102, v96, v97
 v_cvt_pk_bf16_f32 v103, v98, v99
 v_fma_f32 v91, v91, s79, -v126
 v_exp_f32 v90, v90
 v_mfma_f32_16x16x32_bf16 v[120:123], v[28:31], v[100:103], 0
 v_exp_f32 v91, v91
 v_mfma_f32_16x16x32_bf16 v[112:115], v[104:107], v[100:103], 0
 v_cvt_pk_bf16_f32 v36, v90, v91
 v_cvt_pk_bf16_f32 v39, v90, v91
 v_mfma_f32_16x16x32_bf16 v[116:119], v[108:111], v[100:103], 0
 s_waitcnt vmcnt(0)
 v_mfma_f32_16x16x16_bf16 v[120:123], v[28:29], v[36:37], v[120:123]
L_pv_233:
 v_cmp_eq_u32 vcc, -1, v124
 s_cbranch_vccnz L_rt_234
 v_mfma_f32_16x16x16_bf16 v[112:115], v[124:125], v[36:37], v[112:115]
 v_mfma_f32_16x16x16_bf16 v[116:119], v[124:125], v[38:39], v[116:119]
 v_rcp_f32 v120, v120
 ds_read_b128 v[88:91], v15 offset:18432
 ds_read_b128 v[92:95], v15 offset:19456
 ds_read_b128 v[96:99], v15 offset:20480
 ds_read_b128 v[100:103], v15 offset:21504
 s_mov_b64 exec, s[28:29]
 v_pk_mul_f32 v[112:113], v[112:113], v[120:121] op_sel_hi:[1,0]
 v_pk_mul_f32 v[114:115], v[114:115], v[120:121] op_sel_hi:[1,0]
 v_cvt_pk_bf16_f32 v112, v112, v113
 v_cvt_pk_bf16_f32 v113, v114, v115
 v_pk_mul_f32 v[116:117], v[116:117], v[120:121] op_sel_hi:[1,0]
 v_pk_mul_f32 v[118:119], v[118:119], v[120:121] op_sel_hi:[1,0]
 v_cvt_pk_bf16_f32 v114, v116, v117
 v_cvt_pk_bf16_f32 v115, v118, v119
 ds_write_b128 v9, v[112:115] offset:30720
 s_mov_b64 exec, -1
 s_waitcnt lgkmcnt(0)
 s_barrier
 ds_read_b128 v[60:63], v0 offset:30720
 ds_read_b128 v[64:67], v0 offset:30752
 ds_read_b128 v[68:71], v0 offset:31744
 ds_read_b128 v[72:75], v0 offset:31776
 s_waitcnt lgkmcnt(3)
 v_smfmac_f32_16x16x64_bf16 v[40:43], v[60:63], v[224:231], v17
 ds_read_b128 v[224:227], v15 offset:22528
 v_smfmac_f32_16x16x64_bf16 v[44:47], v[60:63], v[232:239], v17
 ds_read_b128 v[228:231], v15 offset:23552
 s_waitcnt lgkmcnt(4)
 v_smfmac_f32_16x16x64_bf16 v[40:43], v[64:67], v[240:247], v17
 ds_read_b128 v[232:235], v15 offset:24576
 v_smfmac_f32_16x16x64_bf16 v[44:47], v[64:67], v[248:255], v17
 ds_read_b128 v[236:239], v15 offset:25600
 s_waitcnt lgkmcnt(5)
 v_smfmac_f32_16x16x64_bf16 v[40:43], v[68:71], v[80:87], v17
 ds_read_b128 v[240:243], v15 offset:26624
 v_smfmac_f32_16x16x64_bf16 v[44:47], v[68:71], v[128:135], v17
 ds_read_b128 v[244:247], v15 offset:27648
 s_waitcnt lgkmcnt(6)
 v_smfmac_f32_16x16x64_bf16 v[40:43], v[72:75], v[136:143], v17
 ds_read_b128 v[248:251], v15 offset:28672
 v_smfmac_f32_16x16x64_bf16 v[44:47], v[72:75], v[144:151], v17
 ds_read_b128 v[252:255], v15 offset:29696
 v_smfmac_f32_16x16x64_bf16 v[48:51], v[60:63], v[152:159], v17
 ds_read_b128 v[80:83], v15 offset:30720
 v_cvt_pk_bf16_f32 v116, v40, v41
 v_cvt_pk_bf16_f32 v117, v42, v43
 v_and_b32 v116, -2, v116
 v_smfmac_f32_16x16x64_bf16 v[52:55], v[60:63], v[160:167], v17
 ds_read_b128 v[84:87], v15 offset:31744
 v_cvt_pk_bf16_f32 v118, v44, v45
 v_cvt_pk_bf16_f32 v119, v46, v47
 v_and_b32 v118, -2, v118
 buffer_store_dwordx4 v[116:119], v10, s[4:7], s68 offen sc1
 v_smfmac_f32_16x16x64_bf16 v[48:51], v[64:67], v[168:175], v17
 v_smfmac_f32_16x16x64_bf16 v[52:55], v[64:67], v[176:183], v17
 v_smfmac_f32_16x16x64_bf16 v[48:51], v[68:71], v[184:191], v17
 v_smfmac_f32_16x16x64_bf16 v[52:55], v[68:71], v[88:95], v17
 v_smfmac_f32_16x16x64_bf16 v[48:51], v[72:75], v[96:103], v17
 s_waitcnt lgkmcnt(8)
 v_smfmac_f32_16x16x64_bf16 v[52:55], v[72:75], v[224:231], v17
 s_waitcnt lgkmcnt(6)
 v_smfmac_f32_16x16x64_bf16 v[56:59], v[60:63], v[232:239], v17
 v_cvt_pk_bf16_f32 v120, v48, v49
 v_cvt_pk_bf16_f32 v121, v50, v51
 v_and_b32 v120, -2, v120
 s_waitcnt lgkmcnt(4)
 v_smfmac_f32_16x16x64_bf16 v[56:59], v[64:67], v[240:247], v17
 v_cvt_pk_bf16_f32 v122, v52, v53
 v_cvt_pk_bf16_f32 v123, v54, v55
 v_and_b32 v122, -2, v122
 buffer_store_dwordx4 v[120:123], v10, s[4:7], s69 offen sc1
 s_waitcnt lgkmcnt(2)
 v_smfmac_f32_16x16x64_bf16 v[56:59], v[68:71], v[248:255], v17
 s_waitcnt lgkmcnt(0)
 v_smfmac_f32_16x16x64_bf16 v[56:59], v[72:75], v[80:87], v17
 s_nop 7
 v_cvt_pk_bf16_f32 v124, v56, v57
 v_cvt_pk_bf16_f32 v125, v58, v59
 v_and_b32 v124, -2, v124
 buffer_store_dwordx2 v[124:125], v10, s[4:7], s70 offen sc1
 ds_read_b128 v[224:227], v15 offset:0
 ds_read_b128 v[228:231], v15 offset:1024
 ds_read_b128 v[232:235], v15 offset:2048
 ds_read_b128 v[236:239], v15 offset:3072
 ds_read_b128 v[240:243], v15 offset:4096
 ds_read_b128 v[244:247], v15 offset:5120
 ds_read_b128 v[248:251], v15 offset:6144
 ds_read_b128 v[252:255], v15 offset:7168
 v_mov_b64 v[88:89], 0
 v_mov_b64 v[90:91], 0
 v_mov_b64 v[92:93], 0
 v_mov_b64 v[94:95], 0
 s_cmp_eq_u32 s55, 0
 s_cbranch_scc1 L_nr_235
 s_nop 15
 s_nop 15
 s_nop 15
 s_nop 15
 s_nop 15
L_pp_237:
 buffer_load_dwordx4 v[40:43], v1, s[4:7], s74 offen offset:0 sc1
 buffer_load_dwordx4 v[44:47], v1, s[4:7], s74 offen offset:1024 sc1
 buffer_load_dwordx4 v[48:51], v1, s[4:7], s74 offen offset:2048 sc1
 buffer_load_dwordx4 v[52:55], v1, s[4:7], s74 offen offset:3072 sc1
 s_waitcnt vmcnt(3)
 v_mfma_f32_16x16x32_bf16 v[56:59], v[40:43], v[20:23], 0
 v_or_b32 v14, v40, v42
 s_waitcnt vmcnt(2)
 v_mfma_f32_16x16x32_bf16 v[56:59], v[44:47], v[20:23], v[56:59]
 v_or3_b32 v14, v14, v44, v46
 s_waitcnt vmcnt(1)
 v_mfma_f32_16x16x32_bf16 v[56:59], v[48:51], v[20:23], v[56:59]
 v_or3_b32 v14, v14, v48, v50
 s_waitcnt vmcnt(0)
 v_mfma_f32_16x16x32_bf16 v[56:59], v[52:55], v[20:23], v[56:59]
 v_or3_b32 v14, v14, v52, v54
 v_and_b32 v14, 1, v14
 v_cmp_ne_u32 vcc, 0, v14
 s_cbranch_vccnz L_rt_238
 s_nop 2
 v_cvt_pk_bf16_f32 v60, v56, v57
 v_cvt_pk_bf16_f32 v61, v58, v59
 s_nop 0
 v_mov_b32_dpp v62, v60 quad_perm:[2,3,2,3] row_mask:0xf bank_mask:0xf
 v_mov_b32_dpp v63, v61 quad_perm:[2,3,2,3] row_mask:0xf bank_mask:0xf
 s_mov_b64 exec, s[30:31]
 buffer_store_dwordx4 v[60:63], v11, s[4:7], s59 offen sc1
 s_mov_b64 exec, 1
 buffer_store_dword v13, off, s[4:7], s17 sc1
 s_mov_b64 exec, -1
 s_barrier
 s_nop 15
 s_nop 15
 s_nop 15
 s_nop 15
 s_nop 15
 s_nop 15
 s_nop 15
 s_nop 15
 s_nop 15
L_rj_236:
 v_add_u32 v13, 1, v13
 s_add_u32 s53, s53, 1
.p2align 3
 s_mov_b32 s51, 0
 buffer_load_dwordx4 v[40:43], v2, s[4:7], s59 offen offset:0 sc1
 buffer_load_dwordx4 v[44:47], v2, s[4:7], s59 offen offset:128 sc1
 buffer_load_dwordx4 v[48:51], v2, s[4:7], s59 offen offset:1024 sc1
 buffer_load_dwordx4 v[52:55], v2, s[4:7], s59 offen offset:1152 sc1
 buffer_load_dwordx4 v[56:59], v3, s[4:7], s59 offen offset:0 sc1
L_xm_239:
 s_waitcnt vmcnt(4)
 v_mfma_f32_16x16x32_bf16 v[60:63], v[24:27], v[40:43], 0
 s_waitcnt vmcnt(3)
 v_mfma_f32_16x16x32_bf16 v[64:67], v[24:27], v[44:47], 0
 s_waitcnt vmcnt(2)
 v_mfma_f32_16x16x32_bf16 v[68:71], v[24:27], v[48:51], 0
 v_max3_u32 v14, v40, v44, v48
 v_cvt_pk_bf16_f32 v60, v60, v61
 v_cvt_pk_bf16_f32 v61, v62, v63
 ds_write_b64 v4, v[60:61] offset:0
 s_waitcnt vmcnt(1)
 v_mfma_f32_16x16x32_bf16 v[72:75], v[24:27], v[52:55], 0
 v_cvt_pk_bf16_f32 v64, v64, v65
 v_cvt_pk_bf16_f32 v65, v66, v67
 ds_write_b64 v4, v[64:65] offset:8
 s_waitcnt vmcnt(0)
 v_mfma_f32_16x16x32_bf16 v[76:79], v[24:27], v[56:59], 0
 v_max3_u32 v14, v14, v52, v56
 v_cmp_eq_u32 vcc, -1, v14
 v_cvt_pk_bf16_f32 v68, v68, v69
 v_cvt_pk_bf16_f32 v69, v70, v71
 ds_write_b64 v4, v[68:69] offset:1024
 s_cbranch_vccnz L_rt_240
 v_cvt_pk_bf16_f32 v72, v72, v73
 v_cvt_pk_bf16_f32 v73, v74, v75
 ds_write_b64 v4, v[72:73] offset:1032
 s_nop 0
 v_cvt_pk_bf16_f32 v76, v76, v77
 v_cvt_pk_bf16_f32 v77, v78, v79
 ds_write_b64 v5, v[76:77] offset:0
 s_waitcnt lgkmcnt(0)
 s_barrier
 ds_read_b128 v[72:75], v0 offset:0
 ds_read_b128 v[76:79], v0 offset:32
 ds_read_b128 v[80:83], v0 offset:1024
 s_mov_b64 exec, s[30:31]
 buffer_store_dwordx4 v[32:35], v11, s[4:7], s58 offen sc1
 s_mov_b64 exec, -1
 buffer_store_dwordx4 v[32:35], v1, s[4:7], s61 offen sc1
 s_waitcnt lgkmcnt(2)
 v_smfmac_f32_16x16x64_bf16 v[88:91], v[72:75], v[224:231], v17
 ds_read_b128 v[84:87], v0 offset:1056
 v_smfmac_f32_16x16x64_bf16 v[92:95], v[72:75], v[232:239], v17
 ds_read_b128 v[96:99], v0 offset:2048
 s_waitcnt lgkmcnt(3)
 v_smfmac_f32_16x16x64_bf16 v[88:91], v[76:79], v[240:247], v17
 ds_read_b128 v[100:103], v0 offset:2080
 v_smfmac_f32_16x16x64_bf16 v[92:95], v[76:79], v[248:255], v17
 ds_read_b128 v[112:115], v0 offset:3072
 s_waitcnt lgkmcnt(4)
 v_smfmac_f32_16x16x64_bf16 v[88:91], v[80:83], v[192:199], v17
 ds_read_b128 v[40:43], v1 offset:10240
 v_smfmac_f32_16x16x64_bf16 v[92:95], v[80:83], v[200:207], v17
 ds_read_b128 v[116:119], v0 offset:3104
 s_waitcnt lgkmcnt(5)
 v_smfmac_f32_16x16x64_bf16 v[88:91], v[84:87], v[208:215], v17
 ds_read_b128 v[44:47], v1 offset:11264
 v_smfmac_f32_16x16x64_bf16 v[92:95], v[84:87], v[216:223], v17
 ds_read_b128 v[72:75], v0 offset:4096
 s_waitcnt lgkmcnt(6)
 v_smfmac_f32_16x16x64_bf16 v[88:91], v[96:99], a[0:7], v17
 ds_read_b128 v[48:51], v1 offset:12288
 v_smfmac_f32_16x16x64_bf16 v[92:95], v[96:99], a[8:15], v17
 ds_read_b128 v[76:79], v0 offset:4128
 s_waitcnt lgkmcnt(7)
 v_smfmac_f32_16x16x64_bf16 v[88:91], v[100:103], a[16:23], v17
 ds_read_b128 v[52:55], v1 offset:13312
 v_smfmac_f32_16x16x64_bf16 v[92:95], v[100:103], a[24:31], v17
 ds_read_b128 v[80:83], v0 offset:5120
 s_waitcnt lgkmcnt(8)
 v_smfmac_f32_16x16x64_bf16 v[88:91], v[112:115], a[32:39], v17
 ds_read_b128 v[56:59], v1 offset:14336
 v_smfmac_f32_16x16x64_bf16 v[92:95], v[112:115], a[40:47], v17
 ds_read_b128 v[84:87], v0 offset:5152
 s_waitcnt lgkmcnt(8)
 v_smfmac_f32_16x16x64_bf16 v[88:91], v[116:119], a[48:55], v17
 ds_read_b128 v[60:63], v1 offset:15360
 v_smfmac_f32_16x16x64_bf16 v[92:95], v[116:119], a[56:63], v17
 ds_read_b128 v[96:99], v0 offset:6144
 s_waitcnt lgkmcnt(8)
 v_smfmac_f32_16x16x64_bf16 v[88:91], v[72:75], a[64:71], v17
 ds_read_b128 v[64:67], v1 offset:16384
 v_smfmac_f32_16x16x64_bf16 v[92:95], v[72:75], a[72:79], v17
 ds_read_b128 v[100:103], v0 offset:6176
 s_waitcnt lgkmcnt(8)
 v_smfmac_f32_16x16x64_bf16 v[88:91], v[76:79], a[80:87], v17
 ds_read_b128 v[68:71], v1 offset:17408
 v_smfmac_f32_16x16x64_bf16 v[92:95], v[76:79], a[88:95], v17
 ds_read_b128 v[112:115], v0 offset:7168
 s_waitcnt lgkmcnt(8)
 v_smfmac_f32_16x16x64_bf16 v[88:91], v[80:83], a[96:103], v17
 ds_read_b128 v[104:107], v16 offset:18432
 v_smfmac_f32_16x16x64_bf16 v[92:95], v[80:83], a[104:111], v17
 ds_read_b128 v[116:119], v0 offset:7200
 s_waitcnt lgkmcnt(8)
 v_smfmac_f32_16x16x64_bf16 v[88:91], v[84:87], a[112:119], v17
 ds_read_b128 v[108:111], v16 offset:19456
 v_smfmac_f32_16x16x64_bf16 v[92:95], v[84:87], a[120:127], v17
 ds_read_b128 v[72:75], v0 offset:8192
 s_waitcnt lgkmcnt(8)
 v_smfmac_f32_16x16x64_bf16 v[88:91], v[96:99], a[128:135], v17
 ds_read_b128 v[224:227], v15 offset:8192
 v_smfmac_f32_16x16x64_bf16 v[92:95], v[96:99], a[136:143], v17
 ds_read_b128 v[76:79], v0 offset:8224
 s_waitcnt lgkmcnt(8)
 v_smfmac_f32_16x16x64_bf16 v[88:91], v[100:103], a[144:151], v17
 ds_read_b128 v[228:231], v15 offset:9216
 v_smfmac_f32_16x16x64_bf16 v[92:95], v[100:103], a[152:159], v17
 ds_read_b128 v[80:83], v0 offset:9216
 s_waitcnt lgkmcnt(8)
 v_smfmac_f32_16x16x64_bf16 v[88:91], v[112:115], a[160:167], v17
 ds_read_b128 v[232:235], v15 offset:10240
 v_smfmac_f32_16x16x64_bf16 v[92:95], v[112:115], a[168:175], v17
 ds_read_b128 v[84:87], v0 offset:9248
 s_waitcnt lgkmcnt(8)
 v_smfmac_f32_16x16x64_bf16 v[88:91], v[116:119], a[176:183], v17
 ds_read_b128 v[236:239], v15 offset:11264
 v_smfmac_f32_16x16x64_bf16 v[92:95], v[116:119], a[184:191], v17
 ds_read_b128 v[240:243], v15 offset:12288
 s_waitcnt lgkmcnt(8)
 v_smfmac_f32_16x16x64_bf16 v[88:91], v[72:75], a[192:199], v17
 ds_read_b128 v[244:247], v15 offset:13312
 v_smfmac_f32_16x16x64_bf16 v[92:95], v[72:75], a[200:207], v17
 ds_read_b128 v[248:251], v15 offset:14336
 s_waitcnt lgkmcnt(8)
 v_smfmac_f32_16x16x64_bf16 v[88:91], v[76:79], a[208:215], v17
 ds_read_b128 v[252:255], v15 offset:15360
 v_smfmac_f32_16x16x64_bf16 v[92:95], v[76:79], a[216:223], v17
 s_waitcnt lgkmcnt(7)
 v_smfmac_f32_16x16x64_bf16 v[88:91], v[80:83], a[224:231], v17
 v_smfmac_f32_16x16x64_bf16 v[92:95], v[80:83], a[232:239], v17
 s_waitcnt lgkmcnt(5)
 v_smfmac_f32_16x16x64_bf16 v[88:91], v[84:87], a[240:247], v17
 v_smfmac_f32_16x16x64_bf16 v[92:95], v[84:87], a[248:255], v17
 s_nop 2
 v_cvt_pk_bf16_f32 v120, v88, v89
 v_cvt_pk_bf16_f32 v121, v90, v91
 ds_write_b64 v6, v[120:121] offset:26624
 s_nop 1
 v_cvt_pk_bf16_f32 v122, v92, v93
 v_cvt_pk_bf16_f32 v123, v94, v95
 ds_write_b64 v6, v[122:123] offset:27136
 s_waitcnt lgkmcnt(0)
 s_barrier
 ds_read_b64_tr_b16 v[72:73], v7 offset:26624
 ds_read_b64_tr_b16 v[74:75], v7 offset:27136
 ds_read_b64_tr_b16 v[76:77], v7 offset:27648
 ds_read_b64_tr_b16 v[78:79], v7 offset:28160
 ds_read_b64_tr_b16 v[80:81], v7 offset:28672
 ds_read_b64_tr_b16 v[82:83], v7 offset:29184
 ds_read_b64_tr_b16 v[84:85], v7 offset:29696
 ds_read_b64_tr_b16 v[86:87], v7 offset:30208
 ds_read_b64_tr_b16 v[112:113], v8 offset:26624
 ds_read_b64_tr_b16 v[114:115], v8 offset:27136
 s_waitcnt lgkmcnt(8)
 v_mfma_f32_16x16x32_bf16 v[92:95], v[40:43], v[72:75], 0
 v_mfma_f32_16x16x32_bf16 v[96:99], v[56:59], v[72:75], 0
 v_mfma_f32_16x16x32_bf16 v[88:91], v[72:75], v[72:75], 0
 s_waitcnt lgkmcnt(6)
 v_mfma_f32_16x16x32_bf16 v[92:95], v[44:47], v[76:79], v[92:95]
 v_mfma_f32_16x16x32_bf16 v[96:99], v[60:63], v[76:79], v[96:99]
 v_mfma_f32_16x16x32_bf16 v[88:91], v[76:79], v[76:79], v[88:91]
 s_waitcnt lgkmcnt(4)
 v_mfma_f32_16x16x32_bf16 v[92:95], v[48:51], v[80:83], v[92:95]
 buffer_load_dwordx2 v[124:125], v1, s[4:7], s67 offen sc1
 v_mfma_f32_16x16x32_bf16 v[96:99], v[64:67], v[80:83], v[96:99]
 v_mfma_f32_16x16x32_bf16 v[88:91], v[80:83], v[80:83], v[88:91]
 s_waitcnt lgkmcnt(0)
 buffer_store_dwordx4 v[112:115], v1, s[4:7], s63 offen sc1
 s_waitcnt lgkmcnt(2)
 v_mfma_f32_16x16x32_bf16 v[92:95], v[52:55], v[84:87], v[92:95]
 v_mfma_f32_16x16x32_bf16 v[96:99], v[68:71], v[84:87], v[96:99]
 v_mfma_f32_16x16x32_bf16 v[88:91], v[84:87], v[84:87], v[88:91]
 s_cmp_eq_u32 s53, 63
 s_cbranch_scc1 L_ch_last
 v_mfma_f32_32x32x8_bf16 v[40:55], v[18:19], v[18:19], 0
 v_max3_f32 v126, v92, v93, v94
 ds_read_b128 v[80:83], v15 offset:16384
 ds_read_b128 v[84:87], v15 offset:17408
 v_max3_f32 v126, v126, v95, v96
 v_max3_f32 v126, v126, v97, v98
 v_max3_f32 v126, v126, v99, v90
 v_max_f32 v126, v126, v91
 v_mov_b32 v127, v126
 v_mov_b64 v[56:57], 0
 v_mov_b64 v[58:59], 0
 v_permlane16_swap_b32 v126, v127
 v_max_f32 v126, v126, v127
 v_mov_b32 v127, v126
 s_nop 1
 v_permlane32_swap_b32 v126, v127
 v_max_f32 v126, v126, v127
 v_mul_f32 v126, s79, v126
 v_fma_f32 v92, v92, s79, -v126
 v_fma_f32 v93, v93, s79, -v126
 v_fma_f32 v94, v94, s79, -v126
 v_fma_f32 v95, v95, s79, -v126
 v_fma_f32 v96, v96, s79, -v126
 v_fma_f32 v97, v97, s79, -v126
 v_fma_f32 v98, v98, s79, -v126
 v_fma_f32 v99, v99, s79, -v126
 v_exp_f32 v92, v92
 v_exp_f32 v93, v93
 v_exp_f32 v94, v94
 v_exp_f32 v95, v95
 v_exp_f32 v96, v96
 v_exp_f32 v97, v97
 v_exp_f32 v98, v98
 v_exp_f32 v99, v99
 v_fma_f32 v90, v90, s79, -v126
 v_cvt_pk_bf16_f32 v100, v92, v93
 v_cvt_pk_bf16_f32 v101, v94, v95
 v_cvt_pk_bf16_f32 v102, v96, v97
 v_cvt_pk_bf16_f32 v103, v98, v99
 v_fma_f32 v91, v91, s79, -v126
 v_exp_f32 v90, v90
 v_mfma_f32_16x16x32_bf16 v[120:123], v[28:31], v[100:103], 0
 v_exp_f32 v91, v91
 v_mfma_f32_16x16x32_bf16 v[112:115], v[104:107], v[100:103], 0
 v_cvt_pk_bf16_f32 v36, v90, v91
 v_cvt_pk_bf16_f32 v39, v90, v91
 v_mfma_f32_16x16x32_bf16 v[116:119], v[108:111], v[100:103], 0
 s_waitcnt vmcnt(0)
 v_mfma_f32_16x16x16_bf16 v[120:123], v[28:29], v[36:37], v[120:123]
L_pv_241:
 v_cmp_eq_u32 vcc, -1, v124
 s_cbranch_vccnz L_rt_242
 v_mfma_f32_16x16x16_bf16 v[112:115], v[124:125], v[36:37], v[112:115]
 v_mfma_f32_16x16x16_bf16 v[116:119], v[124:125], v[38:39], v[116:119]
 v_rcp_f32 v120, v120
 ds_read_b128 v[88:91], v15 offset:18432
 ds_read_b128 v[92:95], v15 offset:19456
 ds_read_b128 v[96:99], v15 offset:20480
 ds_read_b128 v[100:103], v15 offset:21504
 s_mov_b64 exec, s[28:29]
 v_pk_mul_f32 v[112:113], v[112:113], v[120:121] op_sel_hi:[1,0]
 v_pk_mul_f32 v[114:115], v[114:115], v[120:121] op_sel_hi:[1,0]
 v_cvt_pk_bf16_f32 v112, v112, v113
 v_cvt_pk_bf16_f32 v113, v114, v115
 v_pk_mul_f32 v[116:117], v[116:117], v[120:121] op_sel_hi:[1,0]
 v_pk_mul_f32 v[118:119], v[118:119], v[120:121] op_sel_hi:[1,0]
 v_cvt_pk_bf16_f32 v114, v116, v117
 v_cvt_pk_bf16_f32 v115, v118, v119
 ds_write_b128 v9, v[112:115] offset:30720
 s_mov_b64 exec, -1
 s_waitcnt lgkmcnt(0)
 s_barrier
 ds_read_b128 v[60:63], v0 offset:30720
 ds_read_b128 v[64:67], v0 offset:30752
 ds_read_b128 v[68:71], v0 offset:31744
 ds_read_b128 v[72:75], v0 offset:31776
 s_waitcnt lgkmcnt(3)
 v_smfmac_f32_16x16x64_bf16 v[40:43], v[60:63], v[224:231], v17
 ds_read_b128 v[224:227], v15 offset:22528
 v_smfmac_f32_16x16x64_bf16 v[44:47], v[60:63], v[232:239], v17
 ds_read_b128 v[228:231], v15 offset:23552
 s_waitcnt lgkmcnt(4)
 v_smfmac_f32_16x16x64_bf16 v[40:43], v[64:67], v[240:247], v17
 ds_read_b128 v[232:235], v15 offset:24576
 v_smfmac_f32_16x16x64_bf16 v[44:47], v[64:67], v[248:255], v17
 ds_read_b128 v[236:239], v15 offset:25600
 s_waitcnt lgkmcnt(5)
 v_smfmac_f32_16x16x64_bf16 v[40:43], v[68:71], v[80:87], v17
 ds_read_b128 v[240:243], v15 offset:26624
 v_smfmac_f32_16x16x64_bf16 v[44:47], v[68:71], v[128:135], v17
 ds_read_b128 v[244:247], v15 offset:27648
 s_waitcnt lgkmcnt(6)
 v_smfmac_f32_16x16x64_bf16 v[40:43], v[72:75], v[136:143], v17
 ds_read_b128 v[248:251], v15 offset:28672
 v_smfmac_f32_16x16x64_bf16 v[44:47], v[72:75], v[144:151], v17
 ds_read_b128 v[252:255], v15 offset:29696
 v_smfmac_f32_16x16x64_bf16 v[48:51], v[60:63], v[152:159], v17
 ds_read_b128 v[80:83], v15 offset:30720
 v_cvt_pk_bf16_f32 v116, v40, v41
 v_cvt_pk_bf16_f32 v117, v42, v43
 v_and_b32 v116, -2, v116
 v_smfmac_f32_16x16x64_bf16 v[52:55], v[60:63], v[160:167], v17
 ds_read_b128 v[84:87], v15 offset:31744
 v_cvt_pk_bf16_f32 v118, v44, v45
 v_cvt_pk_bf16_f32 v119, v46, v47
 v_and_b32 v118, -2, v118
 buffer_store_dwordx4 v[116:119], v10, s[4:7], s71 offen sc1
 v_smfmac_f32_16x16x64_bf16 v[48:51], v[64:67], v[168:175], v17
 v_smfmac_f32_16x16x64_bf16 v[52:55], v[64:67], v[176:183], v17
 v_smfmac_f32_16x16x64_bf16 v[48:51], v[68:71], v[184:191], v17
 v_smfmac_f32_16x16x64_bf16 v[52:55], v[68:71], v[88:95], v17
 v_smfmac_f32_16x16x64_bf16 v[48:51], v[72:75], v[96:103], v17
 s_waitcnt lgkmcnt(8)
 v_smfmac_f32_16x16x64_bf16 v[52:55], v[72:75], v[224:231], v17
 s_waitcnt lgkmcnt(6)
 v_smfmac_f32_16x16x64_bf16 v[56:59], v[60:63], v[232:239], v17
 v_cvt_pk_bf16_f32 v120, v48, v49
 v_cvt_pk_bf16_f32 v121, v50, v51
 v_and_b32 v120, -2, v120
 s_waitcnt lgkmcnt(4)
 v_smfmac_f32_16x16x64_bf16 v[56:59], v[64:67], v[240:247], v17
 v_cvt_pk_bf16_f32 v122, v52, v53
 v_cvt_pk_bf16_f32 v123, v54, v55
 v_and_b32 v122, -2, v122
 buffer_store_dwordx4 v[120:123], v10, s[4:7], s72 offen sc1
 s_waitcnt lgkmcnt(2)
 v_smfmac_f32_16x16x64_bf16 v[56:59], v[68:71], v[248:255], v17
 s_waitcnt lgkmcnt(0)
 v_smfmac_f32_16x16x64_bf16 v[56:59], v[72:75], v[80:87], v17
 s_nop 7
 v_cvt_pk_bf16_f32 v124, v56, v57
 v_cvt_pk_bf16_f32 v125, v58, v59
 v_and_b32 v124, -2, v124
 buffer_store_dwordx2 v[124:125], v10, s[4:7], s73 offen sc1
 ds_read_b128 v[224:227], v15 offset:0
 ds_read_b128 v[228:231], v15 offset:1024
 ds_read_b128 v[232:235], v15 offset:2048
 ds_read_b128 v[236:239], v15 offset:3072
 ds_read_b128 v[240:243], v15 offset:4096
 ds_read_b128 v[244:247], v15 offset:5120
 ds_read_b128 v[248:251], v15 offset:6144
 ds_read_b128 v[252:255], v15 offset:7168
 v_mov_b64 v[88:89], 0
 v_mov_b64 v[90:91], 0
 v_mov_b64 v[92:93], 0
 v_mov_b64 v[94:95], 0
 s_cmp_eq_u32 s55, 0
 s_cbranch_scc1 L_nr_243
 s_nop 15
 s_nop 15
 s_nop 15
 s_nop 15
 s_nop 15
L_pp_245:
 buffer_load_dwordx4 v[40:43], v1, s[4:7], s75 offen offset:0 sc1
 buffer_load_dwordx4 v[44:47], v1, s[4:7], s75 offen offset:1024 sc1
 buffer_load_dwordx4 v[48:51], v1, s[4:7], s75 offen offset:2048 sc1
 buffer_load_dwordx4 v[52:55], v1, s[4:7], s75 offen offset:3072 sc1
 s_waitcnt vmcnt(3)
 v_mfma_f32_16x16x32_bf16 v[56:59], v[40:43], v[20:23], 0
 v_or_b32 v14, v40, v42
 s_waitcnt vmcnt(2)
 v_mfma_f32_16x16x32_bf16 v[56:59], v[44:47], v[20:23], v[56:59]
 v_or3_b32 v14, v14, v44, v46
 s_waitcnt vmcnt(1)
 v_mfma_f32_16x16x32_bf16 v[56:59], v[48:51], v[20:23], v[56:59]
 v_or3_b32 v14, v14, v48, v50
 s_waitcnt vmcnt(0)
 v_mfma_f32_16x16x32_bf16 v[56:59], v[52:55], v[20:23], v[56:59]
 v_or3_b32 v14, v14, v52, v54
 v_and_b32 v14, 1, v14
 v_cmp_ne_u32 vcc, 0, v14
 s_cbranch_vccnz L_rt_246
 s_nop 2
 v_cvt_pk_bf16_f32 v60, v56, v57
 v_cvt_pk_bf16_f32 v61, v58, v59
 s_nop 0
 v_mov_b32_dpp v62, v60 quad_perm:[2,3,2,3] row_mask:0xf bank_mask:0xf
 v_mov_b32_dpp v63, v61 quad_perm:[2,3,2,3] row_mask:0xf bank_mask:0xf
 s_mov_b64 exec, s[30:31]
 buffer_store_dwordx4 v[60:63], v11, s[4:7], s56 offen sc1
 s_mov_b64 exec, 1
 buffer_store_dword v13, off, s[4:7], s17 sc1
 s_mov_b64 exec, -1
 s_barrier
 s_nop 15
 s_nop 15
 s_nop 15
 s_nop 15
 s_nop 15
 s_nop 15
 s_nop 15
 s_nop 15
 s_nop 15
L_rj_244:
 v_add_u32 v13, 1, v13
 s_add_u32 s53, s53, 1
 s_branch L_ch_loops
L_rt_216:
 s_nop 7
 buffer_load_dwordx4 v[40:43], v2, s[4:7], s56 offen offset:0 sc1
 buffer_load_dwordx4 v[44:47], v2, s[4:7], s56 offen offset:128 sc1
 buffer_load_dwordx4 v[48:51], v2, s[4:7], s56 offen offset:1024 sc1
 buffer_load_dwordx4 v[52:55], v2, s[4:7], s56 offen offset:1152 sc1
 buffer_load_dwordx4 v[56:59], v3, s[4:7], s56 offen offset:0 sc1
 s_add_u32 s51, s51, 1
 s_cmp_lt_u32 s51, 131072
 s_cbranch_scc1 L_xm_215
 s_branch L_bail
L_rt_218:
 buffer_load_dwordx2 v[124:125], v1, s[4:7], s64 offen sc1
 s_waitcnt vmcnt(0)
 s_add_u32 s51, s51, 1
 s_cmp_lt_u32 s51, 131072
 s_cbranch_scc1 L_pv_217
 s_branch L_bail
L_rt_222:
 s_add_u32 s51, s51, 1
 s_cmp_lt_u32 s51, 131072
 s_cbranch_scc1 L_pp_221
 s_branch L_bail
L_nr_219:
 s_cmp_lg_u32 s50, 0
 s_cbranch_scc1 L_id_247
 buffer_load_dword v14, off, s[4:7], s32 sc1
 s_waitcnt vmcnt(0)
 s_barrier
 s_add_u32 s76, s53, 1
L_fl_248:
 v_cmp_ge_u32 vcc, s76, v14
 s_cbranch_vccz L_fld_249
 buffer_load_dword v14, off, s[4:7], s32 sc1
 s_waitcnt vmcnt(0)
 s_add_u32 s51, s51, 1
 s_cmp_lt_u32 s51, 131072
 s_cbranch_scc1 L_fl_248
 s_branch L_bail
L_fld_249:
 s_lshl_b32 s16, s76, 19
 s_add_u32 s16, s16, s54
 s_mov_b32 m0, 10240
 s_nop 0
 buffer_load_dwordx4 v1, s[4:7], s16 offen offset:0 sc1 lds
 buffer_load_dwordx4 v1, s[4:7], s16 offen offset:1024 sc1 lds
 buffer_load_dwordx4 v1, s[4:7], s16 offen offset:2048 sc1 lds
 buffer_load_dwordx4 v1, s[4:7], s16 offen offset:3072 sc1 lds
 s_mov_b32 m0, 14336
 s_nop 0
 buffer_load_dwordx4 v12, s[4:7], s16 offen offset:0 sc1 lds
 buffer_load_dwordx4 v12, s[4:7], s16 offen offset:1024 sc1 lds
 buffer_load_dwordx4 v12, s[4:7], s16 offen offset:2048 sc1 lds
 buffer_load_dwordx4 v12, s[4:7], s16 offen offset:3072 sc1 lds
 s_add_u32 s16, s16, 67108864
 s_mov_b32 m0, 18432
 s_nop 0
 buffer_load_dwordx4 v1, s[4:7], s16 offen offset:0 sc1 lds
 buffer_load_dwordx4 v1, s[4:7], s16 offen offset:1024 sc1 lds
 buffer_load_dwordx4 v1, s[4:7], s16 offen offset:2048 sc1 lds
 buffer_load_dwordx4 v1, s[4:7], s16 offen offset:3072 sc1 lds
 s_mov_b32 m0, 22528
 s_nop 0
 buffer_load_dwordx4 v12, s[4:7], s16 offen offset:0 sc1 lds
 buffer_load_dwordx4 v12, s[4:7], s16 offen offset:1024 sc1 lds
 buffer_load_dwordx4 v12, s[4:7], s16 offen offset:2048 sc1 lds
 buffer_load_dwordx4 v12, s[4:7], s16 offen offset:3072 sc1 lds
 s_nop 15
 s_nop 15
 s_nop 15
 s_nop 15
 s_nop 15
 s_branch L_rj_220
L_id_247:
 s_barrier
 s_nop 15
 s_nop 15
 s_nop 15
 s_nop 15
 s_nop 15
 s_nop 15
 s_nop 15
 s_nop 15
 s_nop 15
 s_branch L_rj_220
L_rt_224:
 s_nop 7
 buffer_load_dwordx4 v[40:43], v2, s[4:7], s57 offen offset:0 sc1
 buffer_load_dwordx4 v[44:47], v2, s[4:7], s57 offen offset:128 sc1
 buffer_load_dwordx4 v[48:51], v2, s[4:7], s57 offen offset:1024 sc1
 buffer_load_dwordx4 v[52:55], v2, s[4:7], s57 offen offset:1152 sc1
 buffer_load_dwordx4 v[56:59], v3, s[4:7], s57 offen offset:0 sc1
 s_add_u32 s51, s51, 1
 s_cmp_lt_u32 s51, 131072
 s_cbranch_scc1 L_xm_223
 s_branch L_bail
L_rt_226:
 buffer_load_dwordx2 v[124:125], v1, s[4:7], s65 offen sc1
 s_waitcnt vmcnt(0)
 s_add_u32 s51, s51, 1
 s_cmp_lt_u32 s51, 131072
 s_cbranch_scc1 L_pv_225
 s_branch L_bail
L_rt_230:
 s_add_u32 s51, s51, 1
 s_cmp_lt_u32 s51, 131072
 s_cbranch_scc1 L_pp_229
 s_branch L_bail
L_nr_227:
 s_cmp_lg_u32 s50, 0
 s_cbranch_scc1 L_id_250
 buffer_load_dword v14, off, s[4:7], s32 sc1
 s_waitcnt vmcnt(0)
 s_barrier
 s_add_u32 s76, s53, 1
L_fl_251:
 v_cmp_ge_u32 vcc, s76, v14
 s_cbranch_vccz L_fld_252
 buffer_load_dword v14, off, s[4:7], s32 sc1
 s_waitcnt vmcnt(0)
 s_add_u32 s51, s51, 1
 s_cmp_lt_u32 s51, 131072
 s_cbranch_scc1 L_fl_251
 s_branch L_bail
L_fld_252:
 s_lshl_b32 s16, s76, 19
 s_add_u32 s16, s16, s54
 s_mov_b32 m0, 10240
 s_nop 0
 buffer_load_dwordx4 v1, s[4:7], s16 offen offset:0 sc1 lds
 buffer_load_dwordx4 v1, s[4:7], s16 offen offset:1024 sc1 lds
 buffer_load_dwordx4 v1, s[4:7], s16 offen offset:2048 sc1 lds
 buffer_load_dwordx4 v1, s[4:7], s16 offen offset:3072 sc1 lds
 s_mov_b32 m0, 14336
 s_nop 0
 buffer_load_dwordx4 v12, s[4:7], s16 offen offset:0 sc1 lds
 buffer_load_dwordx4 v12, s[4:7], s16 offen offset:1024 sc1 lds
 buffer_load_dwordx4 v12, s[4:7], s16 offen offset:2048 sc1 lds
 buffer_load_dwordx4 v12, s[4:7], s16 offen offset:3072 sc1 lds
 s_add_u32 s16, s16, 67108864
 s_mov_b32 m0, 18432
 s_nop 0
 buffer_load_dwordx4 v1, s[4:7], s16 offen offset:0 sc1 lds
 buffer_load_dwordx4 v1, s[4:7], s16 offen offset:1024 sc1 lds
 buffer_load_dwordx4 v1, s[4:7], s16 offen offset:2048 sc1 lds
 buffer_load_dwordx4 v1, s[4:7], s16 offen offset:3072 sc1 lds
 s_mov_b32 m0, 22528
 s_nop 0
 buffer_load_dwordx4 v12, s[4:7], s16 offen offset:0 sc1 lds
 buffer_load_dwordx4 v12, s[4:7], s16 offen offset:1024 sc1 lds
 buffer_load_dwordx4 v12, s[4:7], s16 offen offset:2048 sc1 lds
 buffer_load_dwordx4 v12, s[4:7], s16 offen offset:3072 sc1 lds
 s_nop 15
 s_nop 15
 s_nop 15
 s_nop 15
 s_nop 15
 s_branch L_rj_228
L_id_250:
 s_barrier
 s_nop 15
 s_nop 15
 s_nop 15
 s_nop 15
 s_nop 15
 s_nop 15
 s_nop 15
 s_nop 15
 s_nop 15
 s_branch L_rj_228
L_rt_232:
 s_nop 7
 buffer_load_dwordx4 v[40:43], v2, s[4:7], s58 offen offset:0 sc1
 buffer_load_dwordx4 v[44:47], v2, s[4:7], s58 offen offset:128 sc1
 buffer_load_dwordx4 v[48:51], v2, s[4:7], s58 offen offset:1024 sc1
 buffer_load_dwordx4 v[52:55], v2, s[4:7], s58 offen offset:1152 sc1
 buffer_load_dwordx4 v[56:59], v3, s[4:7], s58 offen offset:0 sc1
 s_add_u32 s51, s51, 1
 s_cmp_lt_u32 s51, 131072
 s_cbranch_scc1 L_xm_231
 s_branch L_bail
L_rt_234:
 buffer_load_dwordx2 v[124:125], v1, s[4:7], s66 offen sc1
 s_waitcnt vmcnt(0)
 s_add_u32 s51, s51, 1
 s_cmp_lt_u32 s51, 131072
 s_cbranch_scc1 L_pv_233
 s_branch L_bail
L_rt_238:
 s_add_u32 s51, s51, 1
 s_cmp_lt_u32 s51, 131072
 s_cbranch_scc1 L_pp_237
 s_branch L_bail
L_nr_235:
 s_cmp_lg_u32 s50, 0
 s_cbranch_scc1 L_id_253
 buffer_load_dword v14, off, s[4:7], s32 sc1
 s_waitcnt vmcnt(0)
 s_barrier
 s_add_u32 s76, s53, 1
L_fl_254:
 v_cmp_ge_u32 vcc, s76, v14
 s_cbranch_vccz L_fld_255
 buffer_load_dword v14, off, s[4:7], s32 sc1
 s_waitcnt vmcnt(0)
 s_add_u32 s51, s51, 1
 s_cmp_lt_u32 s51, 131072
 s_cbranch_scc1 L_fl_254
 s_branch L_bail
L_fld_255:
 s_lshl_b32 s16, s76, 19
 s_add_u32 s16, s16, s54
 s_mov_b32 m0, 10240
 s_nop 0
 buffer_load_dwordx4 v1, s[4:7], s16 offen offset:0 sc1 lds
 buffer_load_dwordx4 v1, s[4:7], s16 offen offset:1024 sc1 lds
 buffer_load_dwordx4 v1, s[4:7], s16 offen offset:2048 sc1 lds
 buffer_load_dwordx4 v1, s[4:7], s16 offen offset:3072 sc1 lds
 s_mov_b32 m0, 14336
 s_nop 0
 buffer_load_dwordx4 v12, s[4:7], s16 offen offset:0 sc1 lds
 buffer_load_dwordx4 v12, s[4:7], s16 offen offset:1024 sc1 lds
 buffer_load_dwordx4 v12, s[4:7], s16 offen offset:2048 sc1 lds
 buffer_load_dwordx4 v12, s[4:7], s16 offen offset:3072 sc1 lds
 s_add_u32 s16, s16, 67108864
 s_mov_b32 m0, 18432
 s_nop 0
 buffer_load_dwordx4 v1, s[4:7], s16 offen offset:0 sc1 lds
 buffer_load_dwordx4 v1, s[4:7], s16 offen offset:1024 sc1 lds
 buffer_load_dwordx4 v1, s[4:7], s16 offen offset:2048 sc1 lds
 buffer_load_dwordx4 v1, s[4:7], s16 offen offset:3072 sc1 lds
 s_mov_b32 m0, 22528
 s_nop 0
 buffer_load_dwordx4 v12, s[4:7], s16 offen offset:0 sc1 lds
 buffer_load_dwordx4 v12, s[4:7], s16 offen offset:1024 sc1 lds
 buffer_load_dwordx4 v12, s[4:7], s16 offen offset:2048 sc1 lds
 buffer_load_dwordx4 v12, s[4:7], s16 offen offset:3072 sc1 lds
 s_nop 15
 s_nop 15
 s_nop 15
 s_nop 15
 s_nop 15
 s_branch L_rj_236
L_id_253:
 s_barrier
 s_nop 15
 s_nop 15
 s_nop 15
 s_nop 15
 s_nop 15
 s_nop 15
 s_nop 15
 s_nop 15
 s_nop 15
 s_branch L_rj_236
L_rt_240:
 s_nop 7
 buffer_load_dwordx4 v[40:43], v2, s[4:7], s59 offen offset:0 sc1
 buffer_load_dwordx4 v[44:47], v2, s[4:7], s59 offen offset:128 sc1
 buffer_load_dwordx4 v[48:51], v2, s[4:7], s59 offen offset:1024 sc1
 buffer_load_dwordx4 v[52:55], v2, s[4:7], s59 offen offset:1152 sc1
 buffer_load_dwordx4 v[56:59], v3, s[4:7], s59 offen offset:0 sc1
 s_add_u32 s51, s51, 1
 s_cmp_lt_u32 s51, 131072
 s_cbranch_scc1 L_xm_239
 s_branch L_bail
L_rt_242:
 buffer_load_dwordx2 v[124:125], v1, s[4:7], s67 offen sc1
 s_waitcnt vmcnt(0)
 s_add_u32 s51, s51, 1
 s_cmp_lt_u32 s51, 131072
 s_cbranch_scc1 L_pv_241
 s_branch L_bail
L_rt_246:
 s_add_u32 s51, s51, 1
 s_cmp_lt_u32 s51, 131072
 s_cbranch_scc1 L_pp_245
 s_branch L_bail
L_nr_243:
 s_cmp_lg_u32 s50, 0
 s_cbranch_scc1 L_id_256
 buffer_load_dword v14, off, s[4:7], s32 sc1
 s_waitcnt vmcnt(0)
 s_barrier
 s_add_u32 s76, s53, 1
L_fl_257:
 v_cmp_ge_u32 vcc, s76, v14
 s_cbranch_vccz L_fld_258
 buffer_load_dword v14, off, s[4:7], s32 sc1
 s_waitcnt vmcnt(0)
 s_add_u32 s51, s51, 1
 s_cmp_lt_u32 s51, 131072
 s_cbranch_scc1 L_fl_257
 s_branch L_bail
L_fld_258:
 s_lshl_b32 s16, s76, 19
 s_add_u32 s16, s16, s54
 s_mov_b32 m0, 10240
 s_nop 0
 buffer_load_dwordx4 v1, s[4:7], s16 offen offset:0 sc1 lds
 buffer_load_dwordx4 v1, s[4:7], s16 offen offset:1024 sc1 lds
 buffer_load_dwordx4 v1, s[4:7], s16 offen offset:2048 sc1 lds
 buffer_load_dwordx4 v1, s[4:7], s16 offen offset:3072 sc1 lds
 s_mov_b32 m0, 14336
 s_nop 0
 buffer_load_dwordx4 v12, s[4:7], s16 offen offset:0 sc1 lds
 buffer_load_dwordx4 v12, s[4:7], s16 offen offset:1024 sc1 lds
 buffer_load_dwordx4 v12, s[4:7], s16 offen offset:2048 sc1 lds
 buffer_load_dwordx4 v12, s[4:7], s16 offen offset:3072 sc1 lds
 s_add_u32 s16, s16, 67108864
 s_mov_b32 m0, 18432
 s_nop 0
 buffer_load_dwordx4 v1, s[4:7], s16 offen offset:0 sc1 lds
 buffer_load_dwordx4 v1, s[4:7], s16 offen offset:1024 sc1 lds
 buffer_load_dwordx4 v1, s[4:7], s16 offen offset:2048 sc1 lds
 buffer_load_dwordx4 v1, s[4:7], s16 offen offset:3072 sc1 lds
 s_mov_b32 m0, 22528
 s_nop 0
 buffer_load_dwordx4 v12, s[4:7], s16 offen offset:0 sc1 lds
 buffer_load_dwordx4 v12, s[4:7], s16 offen offset:1024 sc1 lds
 buffer_load_dwordx4 v12, s[4:7], s16 offen offset:2048 sc1 lds
 buffer_load_dwordx4 v12, s[4:7], s16 offen offset:3072 sc1 lds
 s_nop 15
 s_nop 15
 s_nop 15
 s_nop 15
 s_nop 15
 s_branch L_rj_244
L_id_256:
 s_barrier
 s_nop 15
 s_nop 15
 s_nop 15
 s_nop 15
 s_nop 15
 s_nop 15
 s_nop 15
 s_nop 15
 s_nop 15
 s_branch L_rj_244
L_ch_last:
 s_endpgm
L_vr:
 s_and_b32 s3, s48, 1
 s_lshl_b32 s3, s3, 3
 s_add_u32 s52, s3, s49
 s_sub_u32 s52, s52, 16
 s_lshl_b32 s52, s52, 1
 s_lshr_b32 s3, s48, 1
 s_lshl_b32 s3, s3, 5
 s_add_u32 s17, s3, s52
 s_lshl_b32 s17, s17, 8
 s_add_u32 s17, s17, 128
 s_lshr_b32 s3, s50, 1
 s_add_u32 s52, s52, s3
 s_mov_b32 s8, s24
 s_and_b32 s9, s25, 0xffff
 s_mov_b32 s10, 5242880
 s_mov_b32 s11, 0x00020000
 v_lshrrev_b32 v2, 4, v0
 v_and_b32 v7, 1, v2
 v_lshlrev_b32 v7, 1, v7
 v_xor_b32 v7, v7, v0
 s_and_b32 s3, s50, 1
 s_lshl_b32 s3, s3, 3
 v_xor_b32 v7, s3, v7
 v_and_b32 v7, 15, v7
 s_mov_b32 s3, 8192
 v_mul_lo_u32 v2, v2, s3
 v_lshl_add_u32 v2, v7, 4, v2
 v_xor_b32 v3, 64, v2
 s_and_b32 s3, s50, 1
 s_mul_i32 s76, s3, 262144
 s_lshl_b32 s3, s52, 8
 s_add_u32 s76, s76, s3
 s_lshl_b32 s64, s50, 13
 s_add_u32 m0, s64, 0
 s_nop 0
 buffer_load_dwordx4 v2, s[8:11], s76 offen lds
 s_add_u32 s76, s76, 32768
 s_add_u32 m0, s64, 1024
 s_nop 0
 buffer_load_dwordx4 v2, s[8:11], s76 offen lds
 s_add_u32 s76, s76, 32768
 s_add_u32 m0, s64, 2048
 s_nop 0
 buffer_load_dwordx4 v3, s[8:11], s76 offen lds
 s_add_u32 s76, s76, 32768
 s_add_u32 m0, s64, 3072
 s_nop 0
 buffer_load_dwordx4 v3, s[8:11], s76 offen lds
 s_add_u32 s76, s76, 32768
 s_add_u32 m0, s64, 4096
 s_nop 0
 buffer_load_dwordx4 v2, s[8:11], s76 offen lds
 s_add_u32 s76, s76, 32768
 s_add_u32 m0, s64, 5120
 s_nop 0
 buffer_load_dwordx4 v2, s[8:11], s76 offen lds
 s_add_u32 s76, s76, 32768
 s_add_u32 m0, s64, 6144
 s_nop 0
 buffer_load_dwordx4 v3, s[8:11], s76 offen lds
 s_add_u32 s76, s76, 32768
 s_add_u32 m0, s64, 7168
 s_nop 0
 buffer_load_dwordx4 v3, s[8:11], s76 offen lds
 s_add_u32 s76, s76, 294912
 s_add_u32 m0, s64, 32768
 s_nop 0
 buffer_load_dwordx4 v2, s[8:11], s76 offen lds
 s_add_u32 s76, s76, 32768
 s_add_u32 m0, s64, 33792
 s_nop 0
 buffer_load_dwordx4 v2, s[8:11], s76 offen lds
 s_add_u32 s76, s76, 32768
 s_add_u32 m0, s64, 34816
 s_nop 0
 buffer_load_dwordx4 v3, s[8:11], s76 offen lds
 s_add_u32 s76, s76, 32768
 s_add_u32 m0, s64, 35840
 s_nop 0
 buffer_load_dwordx4 v3, s[8:11], s76 offen lds
 s_add_u32 s76, s76, 32768
 s_add_u32 m0, s64, 36864
 s_nop 0
 buffer_load_dwordx4 v2, s[8:11], s76 offen lds
 s_add_u32 s76, s76, 32768
 s_add_u32 m0, s64, 37888
 s_nop 0
 buffer_load_dwordx4 v2, s[8:11], s76 offen lds
 s_add_u32 s76, s76, 32768
 s_add_u32 m0, s64, 38912
 s_nop 0
 buffer_load_dwordx4 v3, s[8:11], s76 offen lds
 s_add_u32 s76, s76, 32768
 s_add_u32 m0, s64, 39936
 s_nop 0
 buffer_load_dwordx4 v3, s[8:11], s76 offen lds
 s_add_u32 s76, s76, 294912
 s_add_u32 m0, s64, 65536
 s_nop 0
 buffer_load_dwordx4 v2, s[8:11], s76 offen lds
 s_add_u32 s76, s76, 32768
 s_add_u32 m0, s64, 66560
 s_nop 0
 buffer_load_dwordx4 v2, s[8:11], s76 offen lds
 s_add_u32 s76, s76, 32768
 s_add_u32 m0, s64, 67584
 s_nop 0
 buffer_load_dwordx4 v3, s[8:11], s76 offen lds
 s_add_u32 s76, s76, 32768
 s_add_u32 m0, s64, 68608
 s_nop 0
 buffer_load_dwordx4 v3, s[8:11], s76 offen lds
 s_add_u32 s76, s76, 32768
 s_add_u32 m0, s64, 69632
 s_nop 0
 buffer_load_dwordx4 v2, s[8:11], s76 offen lds
 s_add_u32 s76, s76, 32768
 s_add_u32 m0, s64, 70656
 s_nop 0
 buffer_load_dwordx4 v2, s[8:11], s76 offen lds
 s_add_u32 s76, s76, 32768
 s_add_u32 m0, s64, 71680
 s_nop 0
 buffer_load_dwordx4 v3, s[8:11], s76 offen lds
 s_add_u32 s76, s76, 32768
 s_add_u32 m0, s64, 72704
 s_nop 0
 buffer_load_dwordx4 v3, s[8:11], s76 offen lds
 s_add_u32 s76, s76, 294912
 s_add_u32 m0, s64, 98304
 s_nop 0
 buffer_load_dwordx4 v2, s[8:11], s76 offen lds
 s_add_u32 s76, s76, 32768
 s_add_u32 m0, s64, 99328
 s_nop 0
 buffer_load_dwordx4 v2, s[8:11], s76 offen lds
 s_add_u32 s76, s76, 32768
 s_add_u32 m0, s64, 100352
 s_nop 0
 buffer_load_dwordx4 v3, s[8:11], s76 offen lds
 s_add_u32 s76, s76, 32768
 s_add_u32 m0, s64, 101376
 s_nop 0
 buffer_load_dwordx4 v3, s[8:11], s76 offen lds
 s_add_u32 s76, s76, 32768
 s_add_u32 m0, s64, 102400
 s_nop 0
 buffer_load_dwordx4 v2, s[8:11], s76 offen lds
 s_add_u32 s76, s76, 32768
 s_add_u32 m0, s64, 103424
 s_nop 0
 buffer_load_dwordx4 v2, s[8:11], s76 offen lds
 s_add_u32 s76, s76, 32768
 s_add_u32 m0, s64, 104448
 s_nop 0
 buffer_load_dwordx4 v3, s[8:11], s76 offen lds
 s_add_u32 s76, s76, 32768
 s_add_u32 m0, s64, 105472
 s_nop 0
 buffer_load_dwordx4 v3, s[8:11], s76 offen lds
 s_add_u32 s76, s76, 294912
 s_add_u32 m0, s64, 131072
 s_nop 0
 buffer_load_dwordx4 v2, s[8:11], s76 offen lds
 s_add_u32 s76, s76, 32768
 s_add_u32 m0, s64, 132096
 s_nop 0
 buffer_load_dwordx4 v2, s[8:11], s76 offen lds
 s_add_u32 s76, s76, 32768
 s_add_u32 m0, s64, 133120
 s_nop 0
 buffer_load_dwordx4 v3, s[8:11], s76 offen lds
 s_add_u32 s76, s76, 32768
 s_add_u32 m0, s64, 134144
 s_nop 0
 buffer_load_dwordx4 v3, s[8:11], s76 offen lds
 s_add_u32 s76, s76, 32768
 s_add_u32 m0, s64, 135168
 s_nop 0
 buffer_load_dwordx4 v2, s[8:11], s76 offen lds
 s_add_u32 s76, s76, 32768
 s_add_u32 m0, s64, 136192
 s_nop 0
 buffer_load_dwordx4 v2, s[8:11], s76 offen lds
 s_add_u32 s76, s76, 32768
 s_add_u32 m0, s64, 137216
 s_nop 0
 buffer_load_dwordx4 v3, s[8:11], s76 offen lds
 s_add_u32 s76, s76, 32768
 s_add_u32 m0, s64, 138240
 s_nop 0
 buffer_load_dwordx4 v3, s[8:11], s76 offen lds
 s_add_u32 s76, s76, 294912
 v_bfe_u32 v7, v0, 2, 1
 v_lshlrev_b32 v20, 8, v7
 v_lshl_add_u32 v20, v7, 5, v20
 v_bfe_u32 v7, v0, 4, 1
 v_lshl_add_u32 v20, v7, 11, v20
 v_lshl_add_u32 v20, v7, 6, v20
 v_bfe_u32 v7, v0, 5, 1
 v_lshl_add_u32 v20, v7, 12, v20
 v_and_b32 v7, 3, v0
 v_lshl_add_u32 v20, v7, 3, v20
 v_bfe_u32 v7, v0, 3, 1
 v_mul_u32_u24 v7, 32, v7
 v_xor_b32 v20, v20, v7
 s_and_b32 s3, s50, 1
 s_lshl_b32 s3, s3, 7
 v_xor_b32 v20, s3, v20
 s_lshr_b32 s3, s50, 1
 s_lshl_b32 s3, s3, 14
 v_add_u32 v20, s3, v20
 v_xor_b32 v21, 64, v20
 v_xor_b32 v22, 8320, v20
 v_xor_b32 v23, 8384, v20
 s_waitcnt vmcnt(32)
 s_barrier
 v_add_u32 v24, 0, v20
 v_add_u32 v25, 0, v21
 v_add_u32 v26, 0, v22
 v_add_u32 v27, 0, v23
 ds_read_b64_tr_b16 v[192:193], v24 offset:0
 ds_read_b64_tr_b16 v[194:195], v24 offset:512
 ds_read_b64_tr_b16 v[196:197], v24 offset:1024
 ds_read_b64_tr_b16 v[198:199], v24 offset:1536
 ds_read_b64_tr_b16 v[200:201], v25 offset:0
 ds_read_b64_tr_b16 v[202:203], v25 offset:512
 ds_read_b64_tr_b16 v[204:205], v25 offset:1024
 ds_read_b64_tr_b16 v[206:207], v25 offset:1536
 ds_read_b64_tr_b16 v[208:209], v26 offset:0
 ds_read_b64_tr_b16 v[210:211], v26 offset:512
 ds_read_b64_tr_b16 v[212:213], v26 offset:1024
 ds_read_b64_tr_b16 v[214:215], v26 offset:1536
 ds_read_b64_tr_b16 v[216:217], v27 offset:0
 ds_read_b64_tr_b16 v[218:219], v27 offset:512
 ds_read_b64_tr_b16 v[220:221], v27 offset:1024
 ds_read_b64_tr_b16 v[222:223], v27 offset:1536
 s_waitcnt lgkmcnt(0)
 s_barrier
 s_add_u32 m0, s64, 0
 s_nop 0
 buffer_load_dwordx4 v2, s[8:11], s76 offen lds
 s_add_u32 s76, s76, 32768
 s_add_u32 m0, s64, 1024
 s_nop 0
 buffer_load_dwordx4 v2, s[8:11], s76 offen lds
 s_add_u32 s76, s76, 32768
 s_add_u32 m0, s64, 2048
 s_nop 0
 buffer_load_dwordx4 v3, s[8:11], s76 offen lds
 s_add_u32 s76, s76, 32768
 s_add_u32 m0, s64, 3072
 s_nop 0
 buffer_load_dwordx4 v3, s[8:11], s76 offen lds
 s_add_u32 s76, s76, 32768
 s_add_u32 m0, s64, 4096
 s_nop 0
 buffer_load_dwordx4 v2, s[8:11], s76 offen lds
 s_add_u32 s76, s76, 32768
 s_add_u32 m0, s64, 5120
 s_nop 0
 buffer_load_dwordx4 v2, s[8:11], s76 offen lds
 s_add_u32 s76, s76, 32768
 s_add_u32 m0, s64, 6144
 s_nop 0
 buffer_load_dwordx4 v3, s[8:11], s76 offen lds
 s_add_u32 s76, s76, 32768
 s_add_u32 m0, s64, 7168
 s_nop 0
 buffer_load_dwordx4 v3, s[8:11], s76 offen lds
 s_add_u32 s76, s76, 294912
 s_waitcnt vmcnt(32)
 s_barrier
 v_add_u32 v24, 32768, v20
 v_add_u32 v25, 32768, v21
 v_add_u32 v26, 32768, v22
 v_add_u32 v27, 32768, v23
 ds_read_b64_tr_b16 v[224:225], v24 offset:0
 ds_read_b64_tr_b16 v[226:227], v24 offset:512
 ds_read_b64_tr_b16 v[228:229], v24 offset:1024
 ds_read_b64_tr_b16 v[230:231], v24 offset:1536
 ds_read_b64_tr_b16 v[232:233], v25 offset:0
 ds_read_b64_tr_b16 v[234:235], v25 offset:512
 ds_read_b64_tr_b16 v[236:237], v25 offset:1024
 ds_read_b64_tr_b16 v[238:239], v25 offset:1536
 ds_read_b64_tr_b16 v[240:241], v26 offset:0
 ds_read_b64_tr_b16 v[242:243], v26 offset:512
 ds_read_b64_tr_b16 v[244:245], v26 offset:1024
 ds_read_b64_tr_b16 v[246:247], v26 offset:1536
 ds_read_b64_tr_b16 v[248:249], v27 offset:0
 ds_read_b64_tr_b16 v[250:251], v27 offset:512
 ds_read_b64_tr_b16 v[252:253], v27 offset:1024
 ds_read_b64_tr_b16 v[254:255], v27 offset:1536
 s_waitcnt lgkmcnt(0)
 s_barrier
 s_add_u32 m0, s64, 32768
 s_nop 0
 buffer_load_dwordx4 v2, s[8:11], s76 offen lds
 s_add_u32 s76, s76, 32768
 s_add_u32 m0, s64, 33792
 s_nop 0
 buffer_load_dwordx4 v2, s[8:11], s76 offen lds
 s_add_u32 s76, s76, 32768
 s_add_u32 m0, s64, 34816
 s_nop 0
 buffer_load_dwordx4 v3, s[8:11], s76 offen lds
 s_add_u32 s76, s76, 32768
 s_add_u32 m0, s64, 35840
 s_nop 0
 buffer_load_dwordx4 v3, s[8:11], s76 offen lds
 s_add_u32 s76, s76, 32768
 s_add_u32 m0, s64, 36864
 s_nop 0
 buffer_load_dwordx4 v2, s[8:11], s76 offen lds
 s_add_u32 s76, s76, 32768
 s_add_u32 m0, s64, 37888
 s_nop 0
 buffer_load_dwordx4 v2, s[8:11], s76 offen lds
 s_add_u32 s76, s76, 32768
 s_add_u32 m0, s64, 38912
 s_nop 0
 buffer_load_dwordx4 v3, s[8:11], s76 offen lds
 s_add_u32 s76, s76, 32768
 s_add_u32 m0, s64, 39936
 s_nop 0
 buffer_load_dwordx4 v3, s[8:11], s76 offen lds
 s_add_u32 s76, s76, 294912
 s_waitcnt vmcnt(32)
 s_barrier
 v_add_u32 v24, 65536, v20
 v_add_u32 v25, 65536, v21
 v_add_u32 v26, 65536, v22
 v_add_u32 v27, 65536, v23
 ds_read_b64_tr_b16 a[0:1], v24 offset:0
 ds_read_b64_tr_b16 a[2:3], v24 offset:512
 ds_read_b64_tr_b16 a[4:5], v24 offset:1024
 ds_read_b64_tr_b16 a[6:7], v24 offset:1536
 ds_read_b64_tr_b16 a[8:9], v25 offset:0
 ds_read_b64_tr_b16 a[10:11], v25 offset:512
 ds_read_b64_tr_b16 a[12:13], v25 offset:1024
 ds_read_b64_tr_b16 a[14:15], v25 offset:1536
 ds_read_b64_tr_b16 a[16:17], v26 offset:0
 ds_read_b64_tr_b16 a[18:19], v26 offset:512
 ds_read_b64_tr_b16 a[20:21], v26 offset:1024
 ds_read_b64_tr_b16 a[22:23], v26 offset:1536
 ds_read_b64_tr_b16 a[24:25], v27 offset:0
 ds_read_b64_tr_b16 a[26:27], v27 offset:512
 ds_read_b64_tr_b16 a[28:29], v27 offset:1024
 ds_read_b64_tr_b16 a[30:31], v27 offset:1536
 s_waitcnt lgkmcnt(0)
 s_barrier
 s_add_u32 m0, s64, 65536
 s_nop 0
 buffer_load_dwordx4 v2, s[8:11], s76 offen lds
 s_add_u32 s76, s76, 32768
 s_add_u32 m0, s64, 66560
 s_nop 0
 buffer_load_dwordx4 v2, s[8:11], s76 offen lds
 s_add_u32 s76, s76, 32768
 s_add_u32 m0, s64, 67584
 s_nop 0
 buffer_load_dwordx4 v3, s[8:11], s76 offen lds
 s_add_u32 s76, s76, 32768
 s_add_u32 m0, s64, 68608
 s_nop 0
 buffer_load_dwordx4 v3, s[8:11], s76 offen lds
 s_add_u32 s76, s76, 32768
 s_add_u32 m0, s64, 69632
 s_nop 0
 buffer_load_dwordx4 v2, s[8:11], s76 offen lds
 s_add_u32 s76, s76, 32768
 s_add_u32 m0, s64, 70656
 s_nop 0
 buffer_load_dwordx4 v2, s[8:11], s76 offen lds
 s_add_u32 s76, s76, 32768
 s_add_u32 m0, s64, 71680
 s_nop 0
 buffer_load_dwordx4 v3, s[8:11], s76 offen lds
 s_add_u32 s76, s76, 32768
 s_add_u32 m0, s64, 72704
 s_nop 0
 buffer_load_dwordx4 v3, s[8:11], s76 offen lds
 s_add_u32 s76, s76, 294912
 s_waitcnt vmcnt(32)
 s_barrier
 v_add_u32 v24, 98304, v20
 v_add_u32 v25, 98304, v21
 v_add_u32 v26, 98304, v22
 v_add_u32 v27, 98304, v23
 ds_read_b64_tr_b16 a[32:33], v24 offset:0
 ds_read_b64_tr_b16 a[34:35], v24 offset:512
 ds_read_b64_tr_b16 a[36:37], v24 offset:1024
 ds_read_b64_tr_b16 a[38:39], v24 offset:1536
 ds_read_b64_tr_b16 a[40:41], v25 offset:0
 ds_read_b64_tr_b16 a[42:43], v25 offset:512
 ds_read_b64_tr_b16 a[44:45], v25 offset:1024
 ds_read_b64_tr_b16 a[46:47], v25 offset:1536
 ds_read_b64_tr_b16 a[48:49], v26 offset:0
 ds_read_b64_tr_b16 a[50:51], v26 offset:512
 ds_read_b64_tr_b16 a[52:53], v26 offset:1024
 ds_read_b64_tr_b16 a[54:55], v26 offset:1536
 ds_read_b64_tr_b16 a[56:57], v27 offset:0
 ds_read_b64_tr_b16 a[58:59], v27 offset:512
 ds_read_b64_tr_b16 a[60:61], v27 offset:1024
 ds_read_b64_tr_b16 a[62:63], v27 offset:1536
 s_waitcnt lgkmcnt(0)
 s_barrier
 s_add_u32 m0, s64, 98304
 s_nop 0
 buffer_load_dwordx4 v2, s[8:11], s76 offen lds
 s_add_u32 s76, s76, 32768
 s_add_u32 m0, s64, 99328
 s_nop 0
 buffer_load_dwordx4 v2, s[8:11], s76 offen lds
 s_add_u32 s76, s76, 32768
 s_add_u32 m0, s64, 100352
 s_nop 0
 buffer_load_dwordx4 v3, s[8:11], s76 offen lds
 s_add_u32 s76, s76, 32768
 s_add_u32 m0, s64, 101376
 s_nop 0
 buffer_load_dwordx4 v3, s[8:11], s76 offen lds
 s_add_u32 s76, s76, 32768
 s_add_u32 m0, s64, 102400
 s_nop 0
 buffer_load_dwordx4 v2, s[8:11], s76 offen lds
 s_add_u32 s76, s76, 32768
 s_add_u32 m0, s64, 103424
 s_nop 0
 buffer_load_dwordx4 v2, s[8:11], s76 offen lds
 s_add_u32 s76, s76, 32768
 s_add_u32 m0, s64, 104448
 s_nop 0
 buffer_load_dwordx4 v3, s[8:11], s76 offen lds
 s_add_u32 s76, s76, 32768
 s_add_u32 m0, s64, 105472
 s_nop 0
 buffer_load_dwordx4 v3, s[8:11], s76 offen lds
 s_add_u32 s76, s76, 294912
 s_waitcnt vmcnt(32)
 s_barrier
 v_add_u32 v24, 131072, v20
 v_add_u32 v25, 131072, v21
 v_add_u32 v26, 131072, v22
 v_add_u32 v27, 131072, v23
 ds_read_b64_tr_b16 a[64:65], v24 offset:0
 ds_read_b64_tr_b16 a[66:67], v24 offset:512
 ds_read_b64_tr_b16 a[68:69], v24 offset:1024
 ds_read_b64_tr_b16 a[70:71], v24 offset:1536
 ds_read_b64_tr_b16 a[72:73], v25 offset:0
 ds_read_b64_tr_b16 a[74:75], v25 offset:512
 ds_read_b64_tr_b16 a[76:77], v25 offset:1024
 ds_read_b64_tr_b16 a[78:79], v25 offset:1536
 ds_read_b64_tr_b16 a[80:81], v26 offset:0
 ds_read_b64_tr_b16 a[82:83], v26 offset:512
 ds_read_b64_tr_b16 a[84:85], v26 offset:1024
 ds_read_b64_tr_b16 a[86:87], v26 offset:1536
 ds_read_b64_tr_b16 a[88:89], v27 offset:0
 ds_read_b64_tr_b16 a[90:91], v27 offset:512
 ds_read_b64_tr_b16 a[92:93], v27 offset:1024
 ds_read_b64_tr_b16 a[94:95], v27 offset:1536
 s_waitcnt lgkmcnt(0)
 s_barrier
 s_add_u32 m0, s64, 131072
 s_nop 0
 buffer_load_dwordx4 v2, s[8:11], s76 offen lds
 s_add_u32 s76, s76, 32768
 s_add_u32 m0, s64, 132096
 s_nop 0
 buffer_load_dwordx4 v2, s[8:11], s76 offen lds
 s_add_u32 s76, s76, 32768
 s_add_u32 m0, s64, 133120
 s_nop 0
 buffer_load_dwordx4 v3, s[8:11], s76 offen lds
 s_add_u32 s76, s76, 32768
 s_add_u32 m0, s64, 134144
 s_nop 0
 buffer_load_dwordx4 v3, s[8:11], s76 offen lds
 s_add_u32 s76, s76, 32768
 s_add_u32 m0, s64, 135168
 s_nop 0
 buffer_load_dwordx4 v2, s[8:11], s76 offen lds
 s_add_u32 s76, s76, 32768
 s_add_u32 m0, s64, 136192
 s_nop 0
 buffer_load_dwordx4 v2, s[8:11], s76 offen lds
 s_add_u32 s76, s76, 32768
 s_add_u32 m0, s64, 137216
 s_nop 0
 buffer_load_dwordx4 v3, s[8:11], s76 offen lds
 s_add_u32 s76, s76, 32768
 s_add_u32 m0, s64, 138240
 s_nop 0
 buffer_load_dwordx4 v3, s[8:11], s76 offen lds
 s_add_u32 s76, s76, 294912
 s_waitcnt vmcnt(32)
 s_barrier
 v_add_u32 v24, 0, v20
 v_add_u32 v25, 0, v21
 v_add_u32 v26, 0, v22
 v_add_u32 v27, 0, v23
 ds_read_b64_tr_b16 a[96:97], v24 offset:0
 ds_read_b64_tr_b16 a[98:99], v24 offset:512
 ds_read_b64_tr_b16 a[100:101], v24 offset:1024
 ds_read_b64_tr_b16 a[102:103], v24 offset:1536
 ds_read_b64_tr_b16 a[104:105], v25 offset:0
 ds_read_b64_tr_b16 a[106:107], v25 offset:512
 ds_read_b64_tr_b16 a[108:109], v25 offset:1024
 ds_read_b64_tr_b16 a[110:111], v25 offset:1536
 ds_read_b64_tr_b16 a[112:113], v26 offset:0
 ds_read_b64_tr_b16 a[114:115], v26 offset:512
 ds_read_b64_tr_b16 a[116:117], v26 offset:1024
 ds_read_b64_tr_b16 a[118:119], v26 offset:1536
 ds_read_b64_tr_b16 a[120:121], v27 offset:0
 ds_read_b64_tr_b16 a[122:123], v27 offset:512
 ds_read_b64_tr_b16 a[124:125], v27 offset:1024
 ds_read_b64_tr_b16 a[126:127], v27 offset:1536
 s_waitcnt lgkmcnt(0)
 s_waitcnt vmcnt(24)
 s_barrier
 v_add_u32 v24, 32768, v20
 v_add_u32 v25, 32768, v21
 v_add_u32 v26, 32768, v22
 v_add_u32 v27, 32768, v23
 ds_read_b64_tr_b16 a[128:129], v24 offset:0
 ds_read_b64_tr_b16 a[130:131], v24 offset:512
 ds_read_b64_tr_b16 a[132:133], v24 offset:1024
 ds_read_b64_tr_b16 a[134:135], v24 offset:1536
 ds_read_b64_tr_b16 a[136:137], v25 offset:0
 ds_read_b64_tr_b16 a[138:139], v25 offset:512
 ds_read_b64_tr_b16 a[140:141], v25 offset:1024
 ds_read_b64_tr_b16 a[142:143], v25 offset:1536
 ds_read_b64_tr_b16 a[144:145], v26 offset:0
 ds_read_b64_tr_b16 a[146:147], v26 offset:512
 ds_read_b64_tr_b16 a[148:149], v26 offset:1024
 ds_read_b64_tr_b16 a[150:151], v26 offset:1536
 ds_read_b64_tr_b16 a[152:153], v27 offset:0
 ds_read_b64_tr_b16 a[154:155], v27 offset:512
 ds_read_b64_tr_b16 a[156:157], v27 offset:1024
 ds_read_b64_tr_b16 a[158:159], v27 offset:1536
 s_waitcnt lgkmcnt(0)
 s_waitcnt vmcnt(16)
 s_barrier
 v_add_u32 v24, 65536, v20
 v_add_u32 v25, 65536, v21
 v_add_u32 v26, 65536, v22
 v_add_u32 v27, 65536, v23
 ds_read_b64_tr_b16 a[160:161], v24 offset:0
 ds_read_b64_tr_b16 a[162:163], v24 offset:512
 ds_read_b64_tr_b16 a[164:165], v24 offset:1024
 ds_read_b64_tr_b16 a[166:167], v24 offset:1536
 ds_read_b64_tr_b16 a[168:169], v25 offset:0
 ds_read_b64_tr_b16 a[170:171], v25 offset:512
 ds_read_b64_tr_b16 a[172:173], v25 offset:1024
 ds_read_b64_tr_b16 a[174:175], v25 offset:1536
 ds_read_b64_tr_b16 a[176:177], v26 offset:0
 ds_read_b64_tr_b16 a[178:179], v26 offset:512
 ds_read_b64_tr_b16 a[180:181], v26 offset:1024
 ds_read_b64_tr_b16 a[182:183], v26 offset:1536
 ds_read_b64_tr_b16 a[184:185], v27 offset:0
 ds_read_b64_tr_b16 a[186:187], v27 offset:512
 ds_read_b64_tr_b16 a[188:189], v27 offset:1024
 ds_read_b64_tr_b16 a[190:191], v27 offset:1536
 s_waitcnt lgkmcnt(0)
 s_waitcnt vmcnt(8)
 s_barrier
 v_add_u32 v24, 98304, v20
 v_add_u32 v25, 98304, v21
 v_add_u32 v26, 98304, v22
 v_add_u32 v27, 98304, v23
 ds_read_b64_tr_b16 a[192:193], v24 offset:0
 ds_read_b64_tr_b16 a[194:195], v24 offset:512
 ds_read_b64_tr_b16 a[196:197], v24 offset:1024
 ds_read_b64_tr_b16 a[198:199], v24 offset:1536
 ds_read_b64_tr_b16 a[200:201], v25 offset:0
 ds_read_b64_tr_b16 a[202:203], v25 offset:512
 ds_read_b64_tr_b16 a[204:205], v25 offset:1024
 ds_read_b64_tr_b16 a[206:207], v25 offset:1536
 ds_read_b64_tr_b16 a[208:209], v26 offset:0
 ds_read_b64_tr_b16 a[210:211], v26 offset:512
 ds_read_b64_tr_b16 a[212:213], v26 offset:1024
 ds_read_b64_tr_b16 a[214:215], v26 offset:1536
 ds_read_b64_tr_b16 a[216:217], v27 offset:0
 ds_read_b64_tr_b16 a[218:219], v27 offset:512
 ds_read_b64_tr_b16 a[220:221], v27 offset:1024
 ds_read_b64_tr_b16 a[222:223], v27 offset:1536
 s_waitcnt lgkmcnt(0)
 s_waitcnt vmcnt(0)
 s_barrier
 v_add_u32 v24, 131072, v20
 v_add_u32 v25, 131072, v21
 v_add_u32 v26, 131072, v22
 v_add_u32 v27, 131072, v23
 ds_read_b64_tr_b16 a[224:225], v24 offset:0
 ds_read_b64_tr_b16 a[226:227], v24 offset:512
 ds_read_b64_tr_b16 a[228:229], v24 offset:1024
 ds_read_b64_tr_b16 a[230:231], v24 offset:1536
 ds_read_b64_tr_b16 a[232:233], v25 offset:0
 ds_read_b64_tr_b16 a[234:235], v25 offset:512
 ds_read_b64_tr_b16 a[236:237], v25 offset:1024
 ds_read_b64_tr_b16 a[238:239], v25 offset:1536
 ds_read_b64_tr_b16 a[240:241], v26 offset:0
 ds_read_b64_tr_b16 a[242:243], v26 offset:512
 ds_read_b64_tr_b16 a[244:245], v26 offset:1024
 ds_read_b64_tr_b16 a[246:247], v26 offset:1536
 ds_read_b64_tr_b16 a[248:249], v27 offset:0
 ds_read_b64_tr_b16 a[250:251], v27 offset:512
 ds_read_b64_tr_b16 a[252:253], v27 offset:1024
 ds_read_b64_tr_b16 a[254:255], v27 offset:1536
 s_waitcnt lgkmcnt(0)
 s_mov_b32 s96, s44
 s_and_b32 s97, s45, 0xffff
 s_mov_b32 s98, 256
 s_mov_b32 s99, 0x00020000
 v_mov_b32 v8, 132
 s_mov_b32 s3, 144
 v_writelane_b32 v8, s3, 1
 s_mov_b32 s51, 0
 s_mov_b64 exec, 3
L_wb_259:
 buffer_load_dword v9, v8, s[96:99], 0 offen sc1
 s_waitcnt vmcnt(0)
 v_cmp_eq_u32 vcc, 0, v9
 s_cbranch_vccz L_wbd_260
 s_sleep 2
 s_add_u32 s51, s51, 1
 s_cmp_lt_u32 s51, 131072
 s_cbranch_scc1 L_wb_259
 s_branch L_bail
L_wbd_260:
 s_mov_b64 exec, -1
 v_readlane_b32 s81, v9, 1
 s_nop 3
 s_sub_u32 s81, s81, 1
 s_mov_b32 s96, s44
 s_and_b32 s97, s45, 0xffff
 s_mov_b32 s98, 256
 s_mov_b32 s99, 0x00020000
 v_lshlrev_b32 v8, 5, v0
 s_mov_b32 s51, 0
L_gl_261:
 buffer_load_dword v9, v8, s[96:99], 0 offen sc1
 s_waitcnt vmcnt(0)
 v_readlane_b32 s3, v9, s48
 s_mov_b32 s80, 0
 s_nop 2
 s_cmp_ge_u32 s3, 32
 s_cbranch_scc1 L_gld_262
 s_mov_b32 s80, 0
 v_readlane_b32 s3, v9, 0
 s_nop 3
 s_add_u32 s80, s80, s3
 v_readlane_b32 s3, v9, 1
 s_nop 3
 s_add_u32 s80, s80, s3
 v_readlane_b32 s3, v9, 2
 s_nop 3
 s_add_u32 s80, s80, s3
 v_readlane_b32 s3, v9, 3
 s_nop 3
 s_add_u32 s80, s80, s3
 v_readlane_b32 s3, v9, 4
 s_nop 3
 s_add_u32 s80, s80, s3
 v_readlane_b32 s3, v9, 5
 s_nop 3
 s_add_u32 s80, s80, s3
 v_readlane_b32 s3, v9, 6
 s_nop 3
 s_add_u32 s80, s80, s3
 v_readlane_b32 s3, v9, 7
 s_nop 3
 s_add_u32 s80, s80, s3
 s_cmp_ge_u32 s80, 256
 s_cbranch_scc1 L_gld_262
 s_sleep 4
 s_add_u32 s51, s51, 1
 s_cmp_lt_u32 s51, 131072
 s_cbranch_scc1 L_gl_261
 s_branch L_bail
L_gld_262:
 s_barrier
 v_lshlrev_b32 v1, 4, v0
 v_add_u32 v6, 4096, v1
 s_xor_b32 s3, s81, 0
 s_and_b32 s3, s3, 1
 s_lshl_b32 s3, s3, 13
 s_add_u32 s56, s3, 4194304
 s_and_b32 s3, s48, 2
 s_lshl_b32 s3, s3, 15
 s_add_u32 s56, s56, s3
 s_xor_b32 s3, s81, 1
 s_and_b32 s3, s3, 1
 s_lshl_b32 s3, s3, 13
 s_add_u32 s57, s3, 6291456
 s_and_b32 s3, s48, 2
 s_lshl_b32 s3, s3, 15
 s_add_u32 s57, s57, s3
 s_xor_b32 s3, s81, 0
 s_and_b32 s3, s3, 1
 s_lshl_b32 s3, s3, 13
 s_add_u32 s58, s3, 8388608
 s_and_b32 s3, s48, 2
 s_lshl_b32 s3, s3, 15
 s_add_u32 s58, s58, s3
 s_xor_b32 s3, s81, 1
 s_and_b32 s3, s3, 1
 s_lshl_b32 s3, s3, 13
 s_add_u32 s59, s3, 10485760
 s_and_b32 s3, s48, 2
 s_lshl_b32 s3, s3, 15
 s_add_u32 s59, s59, s3
 v_lshrrev_b32 v2, 5, v0
 v_lshlrev_b32 v2, 15, v2
 v_bfe_u32 v7, v0, 2, 2
 v_lshl_add_u32 v2, v7, 8, v2
 v_bfe_u32 v7, v0, 4, 1
 v_lshl_add_u32 v2, v7, 6, v2
 v_and_b32 v7, 3, v0
 v_lshl_add_u32 v2, v7, 4, v2
 s_lshr_b32 s76, s50, 1
 s_and_b32 s77, s50, 1
 s_lshl_b32 s3, s76, 14
 v_add_u32 v2, s3, v2
 s_lshl_b32 s3, s77, 7
 s_add_u32 s3, s3, 2048
 v_add_u32 v3, s3, v2
 s_mul_i32 s3, s77, 3072
 v_add_u32 v2, s3, v2
 s_mul_i32 s76, s76, 5120
 s_add_u32 s3, s3, s76
 v_add_u32 v4, s3, v1
 s_lshl_b32 s3, s77, 3
 s_add_u32 s3, s3, s76
 s_add_u32 s3, s3, 2048
 v_add_u32 v5, s3, v1
 v_and_b32 v7, 2, v0
 v_cmp_eq_u32 vcc, 0, v7
 v_mov_b32 v8, 0xeeee
 v_mov_b32 v7, 0x4444
 s_nop 0
 v_cndmask_b32 v8, v8, v7, vcc
 s_lshr_b32 s3, s48, 1
 s_lshl_b32 s3, s3, 5
 s_add_u32 s64, s3, s52
 s_lshl_b32 s32, s64, 8
 s_add_u32 s32, s32, 0
 s_mul_i32 s76, s64, 24576
 s_add_u32 s60, s76, 1736704
 s_add_u32 s61, s76, 1742848
 s_add_u32 s62, s76, 1748992
 s_add_u32 s63, s76, 1755136
 s_and_b32 s77, s50, 1
 s_lshr_b32 s76, s50, 1
 s_lshl_b32 s3, s77, 10
 v_add_u32 v18, s3, v6
 s_lshl_b32 s3, s50, 10
 v_add_u32 v16, s3, v1
 s_lshl_b32 s3, s76, 11
 v_add_u32 v17, s3, v1
 s_mul_i32 s69, s76, 24576
 s_add_u32 s69, s69, 16384
 v_add_u32 v15, s69, v1
 v_add_u32 v19, 16384, v15
 s_lshl_b32 s71, s77, 12
 s_add_u32 s68, s69, s71
 s_add_u32 s68, s68, 8192
 v_add_u32 v14, s68, v1
 s_lshl_b32 s3, s77, 14
 s_add_u32 s69, s69, s3
 s_mul_i32 s70, s77, 67108864
 s_and_b32 s100, s52, 1
 s_lshl_b32 s100, s100, 13
 s_lshl_b32 s54, s52, 14
 s_add_u32 s54, s54, s100
 s_lshr_b32 s3, s48, 1
 s_mul_i32 s3, s3, 33554432
 s_add_u32 s54, s54, s3
 s_add_u32 s54, s54, 16777216
 s_xor_b32 s78, s81, 0
 s_lshl_b32 s78, s78, 13
 s_xor_b32 s79, s78, 8192
 s_lshr_b32 s3, s48, 1
 s_lshl_b32 s67, s3, 8
 s_add_u32 s67, s67, s79
 s_add_u32 s67, s67, 49152
 s_lshr_b32 s3, s52, 2
 s_mul_i32 s3, s3, 2560
 v_lshl_add_u32 v12, v0, 9, s3
 v_and_b32 v7, 0xffffe000, v12
 v_add_u32 v12, v12, v7
 v_lshrrev_b32 v7, 4, v0
 v_lshlrev_b32 v11, 9, v7
 v_and_b32 v10, 15, v0
 v_lshl_add_u32 v11, v10, 4, v11
 s_lshl_b32 s3, s77, 8
 v_add_u32 v11, s3, v11
 s_lshl_b32 s3, s77, 4
 v_add_u32 v10, s3, v10
 v_lshlrev_b32 v7, 2, v7
 v_mov_b32 v148, 0xff61b1e6
 v_add_u32 v149, 0, v7
 v_cmp_gt_u32 vcc, v149, v10
 s_nop 1
 v_cndmask_b32 v108, 0, v148, vcc
 v_add_u32 v149, 1, v7
 v_cmp_gt_u32 vcc, v149, v10
 s_nop 1
 v_cndmask_b32 v109, 0, v148, vcc
 v_add_u32 v149, 2, v7
 v_cmp_gt_u32 vcc, v149, v10
 s_nop 1
 v_cndmask_b32 v110, 0, v148, vcc
 v_add_u32 v149, 3, v7
 v_cmp_gt_u32 vcc, v149, v10
 s_nop 1
 v_cndmask_b32 v111, 0, v148, vcc
 v_add_u32 v149, 16, v7
 v_cmp_gt_u32 vcc, v149, v10
 s_nop 1
 v_cndmask_b32 v112, 0, v148, vcc
 v_add_u32 v149, 17, v7
 v_cmp_gt_u32 vcc, v149, v10
 s_nop 1
 v_cndmask_b32 v113, 0, v148, vcc
 v_add_u32 v149, 18, v7
 v_cmp_gt_u32 vcc, v149, v10
 s_nop 1
 v_cndmask_b32 v114, 0, v148, vcc
 v_add_u32 v149, 19, v7
 v_cmp_gt_u32 vcc, v149, v10
 s_nop 1
 v_cndmask_b32 v115, 0, v148, vcc
 v_mov_b32 v32, -1
 v_mov_b32 v120, 0
 v_mov_b32 v33, -1
 v_mov_b32 v121, 0
 v_mov_b32 v34, -1
 v_mov_b32 v122, 0
 v_mov_b32 v35, -1
 v_mov_b32 v123, 0
 v_mov_b32 v80, 0
 v_mov_b32 v81, 0
 v_mov_b32 v82, 0
 v_mov_b32 v83, 0
 v_mov_b32 v84, 0
 v_mov_b32 v85, 0
 v_mov_b32 v86, 0
 v_mov_b32 v87, 0
 v_mov_b32 v88, 0
 v_mov_b32 v89, 0
 v_mov_b32 v90, 0
 v_mov_b32 v91, 0
 v_mov_b32 v92, 0
 v_mov_b32 v93, 0
 v_mov_b32 v94, 0
 v_mov_b32 v95, 0
 v_and_b32 v9, 7, v0
 v_lshrrev_b32 v10, 1, v0
 v_xor_b32 v10, v10, v0
 v_and_b32 v10, 8, v10
 v_or_b32 v9, v9, v10
 v_mov_b32 v24, 0
 v_cmp_eq_u32 vcc, 0, v9
 v_mov_b32 v10, 0x3f80
 s_nop 1
 v_cndmask_b32 v24, v24, v10, vcc
 v_cmp_eq_u32 vcc, 1, v9
 v_mov_b32 v10, 0x3f800000
 s_nop 1
 v_cndmask_b32 v24, v24, v10, vcc
 v_mov_b32 v25, 0
 v_cmp_eq_u32 vcc, 2, v9
 v_mov_b32 v10, 0x3f80
 s_nop 1
 v_cndmask_b32 v25, v25, v10, vcc
 v_cmp_eq_u32 vcc, 3, v9
 v_mov_b32 v10, 0x3f800000
 s_nop 1
 v_cndmask_b32 v25, v25, v10, vcc
 v_mov_b32 v26, 0
 v_cmp_eq_u32 vcc, 4, v9
 v_mov_b32 v10, 0x3f80
 s_nop 1
 v_cndmask_b32 v26, v26, v10, vcc
 v_cmp_eq_u32 vcc, 5, v9
 v_mov_b32 v10, 0x3f800000
 s_nop 1
 v_cndmask_b32 v26, v26, v10, vcc
 v_mov_b32 v27, 0
 v_cmp_eq_u32 vcc, 6, v9
 v_mov_b32 v10, 0x3f80
 s_nop 1
 v_cndmask_b32 v27, v27, v10, vcc
 v_cmp_eq_u32 vcc, 7, v9
 v_mov_b32 v10, 0x3f800000
 s_nop 1
 v_cndmask_b32 v27, v27, v10, vcc
 v_mov_b32 v9, 0
 v_and_b32 v23, -33, v1
 s_mov_b32 s65, 0x3db504f3
 s_mov_b32 s66, 0x3fb8aa3b
 s_mov_b32 s53, 0
 s_mov_b32 s76, 0
 s_mov_b32 s51, 0
 s_mov_b64 exec, 1
L_pl_263:
 buffer_load_dword v7, v9, s[4:7], s32 offen sc1
 s_waitcnt vmcnt(0)
 v_cmp_gt_u32 vcc, 1, v7
 s_cbranch_vccz L_pld_264
 s_sleep 4
 s_add_u32 s51, s51, 1
 s_cmp_lt_u32 s51, 131072
 s_cbranch_scc1 L_pl_263
 s_branch L_bail
L_pld_264:
 s_mov_b64 exec, -1
 s_cmp_eq_u32 s3, s3
 s_cselect_b32 s76, s76, 512
 s_lshl_b32 s16, s76, 19
 s_add_u32 s16, s16, s54
 s_xor_b32 s72, s16, 8192
 s_add_u32 s72, s72, s71
 s_add_u32 s16, s16, s70
 s_add_u32 m0, s69, 0
 s_nop 0
 buffer_load_dwordx4 v1, s[4:7], s16 offen offset:0 sc1 lds
 buffer_load_dwordx4 v1, s[4:7], s16 offen offset:1024 sc1 lds
 buffer_load_dwordx4 v1, s[4:7], s16 offen offset:2048 sc1 lds
 buffer_load_dwordx4 v1, s[4:7], s16 offen offset:3072 sc1 lds
 s_add_u32 m0, s69, 4096
 s_nop 0
 buffer_load_dwordx4 v6, s[4:7], s16 offen offset:0 sc1 lds
 buffer_load_dwordx4 v6, s[4:7], s16 offen offset:1024 sc1 lds
 buffer_load_dwordx4 v6, s[4:7], s16 offen offset:2048 sc1 lds
 buffer_load_dwordx4 v6, s[4:7], s16 offen offset:3072 sc1 lds
 s_add_u32 m0, s68, 0
 s_nop 0
 buffer_load_dwordx4 v1, s[4:7], s72 offen offset:0 sc1 nt lds
 buffer_load_dwordx4 v1, s[4:7], s72 offen offset:1024 sc1 nt lds
 buffer_load_dwordx4 v1, s[4:7], s72 offen offset:2048 sc1 nt lds
 buffer_load_dwordx4 v1, s[4:7], s72 offen offset:3072 sc1 nt lds
 s_sub_u32 s67, s67, 4
 s_cmp_lg_u32 s80, 0
 s_cbranch_scc1 L_vr_ents
 s_branch L_vr_entf
.p2align 6
L_vr_loopf:
 s_mov_b32 s51, 0
 buffer_load_dword v7, off, s[4:7], s17 sc1
 s_waitcnt vmcnt(0)
L_go_265:
 v_cmp_gt_u32 vcc, s53, v7
 s_cbranch_vccnz L_rt_266
 v_mov_b32 v10, 1
 s_mov_b64 exec, 31
 buffer_atomic_add v10, v12, s[4:7], s34 offen
 s_mov_b64 exec, -1
L_vr_entf:
 s_mov_b32 s51, 0
 s_nop 15
 s_nop 15
 s_nop 15
 s_nop 15
 buffer_load_dwordx4 v[40:43], v2, s[4:7], s56 offen offset:0 sc1
 buffer_load_dwordx4 v[44:47], v2, s[4:7], s56 offen offset:128 sc1
 buffer_load_dwordx4 v[48:51], v2, s[4:7], s56 offen offset:1024 sc1
 buffer_load_dwordx4 v[52:55], v2, s[4:7], s56 offen offset:1152 sc1
 buffer_load_dwordx4 v[56:59], v3, s[4:7], s56 offen offset:0 sc1
L_xm_267:
 s_waitcnt vmcnt(4)
 v_mfma_f32_16x16x32_bf16 v[60:63], v[24:27], v[40:43], 0
 s_waitcnt vmcnt(3)
 v_mfma_f32_16x16x32_bf16 v[64:67], v[24:27], v[44:47], 0
 s_waitcnt vmcnt(2)
 v_mfma_f32_16x16x32_bf16 v[68:71], v[24:27], v[48:51], 0
 v_max3_u32 v7, v40, v44, v48
 v_cvt_pk_bf16_f32 v60, v60, v61
 v_cvt_pk_bf16_f32 v61, v62, v63
 ds_write_b64 v4, v[60:61] offset:0
 s_waitcnt vmcnt(1)
 v_mfma_f32_16x16x32_bf16 v[72:75], v[24:27], v[52:55], 0
 v_cvt_pk_bf16_f32 v64, v64, v65
 v_cvt_pk_bf16_f32 v65, v66, v67
 ds_write_b64 v4, v[64:65] offset:8
 s_waitcnt vmcnt(0)
 v_mfma_f32_16x16x32_bf16 v[76:79], v[24:27], v[56:59], 0
 v_max3_u32 v7, v7, v52, v56
 v_cmp_eq_u32 vcc, -1, v7
 v_cvt_pk_bf16_f32 v68, v68, v69
 v_cvt_pk_bf16_f32 v69, v70, v71
 ds_write_b64 v4, v[68:69] offset:1024
 s_cbranch_vccnz L_rt_268
 v_cvt_pk_bf16_f32 v72, v72, v73
 v_cvt_pk_bf16_f32 v73, v74, v75
 ds_write_b64 v4, v[72:73] offset:1032
 s_nop 0
 v_cvt_pk_bf16_f32 v76, v76, v77
 v_cvt_pk_bf16_f32 v77, v78, v79
 ds_write_b64 v5, v[76:77] offset:0
 s_waitcnt lgkmcnt(0)
 s_barrier
 ds_read_b128 v[56:59], v23 offset:0
 ds_read_b128 v[60:63], v23 offset:32
 ds_read_b128 v[64:67], v23 offset:1024
 buffer_load_dword v13, off, s[4:7], s32 sc1
 s_waitcnt lgkmcnt(2)
 v_smfmac_f32_16x16x64_bf16 v[80:83], v[56:59], v[192:199], v8
 ds_read_b128 v[68:71], v23 offset:1056
 v_smfmac_f32_16x16x64_bf16 v[84:87], v[56:59], v[200:207], v8
 ds_read_b128 v[72:75], v23 offset:2048
 s_waitcnt lgkmcnt(3)
 v_smfmac_f32_16x16x64_bf16 v[80:83], v[60:63], v[208:215], v8
 ds_read_b128 v[76:79], v23 offset:2080
 v_smfmac_f32_16x16x64_bf16 v[84:87], v[60:63], v[216:223], v8
 ds_read_b128 v[180:183], v23 offset:3072
 s_waitcnt lgkmcnt(4)
 v_smfmac_f32_16x16x64_bf16 v[80:83], v[64:67], v[224:231], v8
 ds_read_b128 v[148:151], v15 offset:0
 v_smfmac_f32_16x16x64_bf16 v[84:87], v[64:67], v[232:239], v8
 ds_read_b128 v[184:187], v23 offset:3104
 s_waitcnt lgkmcnt(5)
 v_smfmac_f32_16x16x64_bf16 v[80:83], v[68:71], v[240:247], v8
 ds_read_b128 v[152:155], v15 offset:1024
 v_smfmac_f32_16x16x64_bf16 v[84:87], v[68:71], v[248:255], v8
 ds_read_b128 v[56:59], v23 offset:4096
 s_waitcnt lgkmcnt(6)
 v_smfmac_f32_16x16x64_bf16 v[80:83], v[72:75], a[0:7], v8
 ds_read_b128 v[156:159], v15 offset:2048
 v_smfmac_f32_16x16x64_bf16 v[84:87], v[72:75], a[8:15], v8
 ds_read_b128 v[60:63], v23 offset:4128
 s_waitcnt lgkmcnt(7)
 v_smfmac_f32_16x16x64_bf16 v[80:83], v[76:79], a[16:23], v8
 ds_read_b128 v[160:163], v15 offset:3072
 v_smfmac_f32_16x16x64_bf16 v[84:87], v[76:79], a[24:31], v8
 ds_read_b128 v[64:67], v23 offset:5120
 s_waitcnt lgkmcnt(8)
 v_smfmac_f32_16x16x64_bf16 v[80:83], v[180:183], a[32:39], v8
 ds_read_b128 v[164:167], v15 offset:4096
 v_smfmac_f32_16x16x64_bf16 v[84:87], v[180:183], a[40:47], v8
 ds_read_b128 v[68:71], v23 offset:5152
 s_waitcnt lgkmcnt(8)
 v_smfmac_f32_16x16x64_bf16 v[80:83], v[184:187], a[48:55], v8
 ds_read_b128 v[168:171], v15 offset:5120
 v_smfmac_f32_16x16x64_bf16 v[84:87], v[184:187], a[56:63], v8
 ds_read_b128 v[72:75], v23 offset:6144
 s_waitcnt lgkmcnt(8)
 v_smfmac_f32_16x16x64_bf16 v[80:83], v[56:59], a[64:71], v8
 ds_read_b128 v[172:175], v15 offset:6144
 v_smfmac_f32_16x16x64_bf16 v[84:87], v[56:59], a[72:79], v8
 ds_read_b128 v[76:79], v23 offset:6176
 s_waitcnt lgkmcnt(8)
 v_smfmac_f32_16x16x64_bf16 v[80:83], v[60:63], a[80:87], v8
 ds_read_b128 v[176:179], v15 offset:7168
 v_smfmac_f32_16x16x64_bf16 v[84:87], v[60:63], a[88:95], v8
 ds_read_b128 v[180:183], v23 offset:7168
 s_waitcnt lgkmcnt(8)
 v_smfmac_f32_16x16x64_bf16 v[80:83], v[64:67], a[96:103], v8
 ds_read_b128 v[40:43], v14 offset:0
 v_smfmac_f32_16x16x64_bf16 v[84:87], v[64:67], a[104:111], v8
 ds_read_b128 v[184:187], v23 offset:7200
 s_waitcnt lgkmcnt(8)
 v_smfmac_f32_16x16x64_bf16 v[80:83], v[68:71], a[112:119], v8
 ds_read_b128 v[44:47], v14 offset:1024
 v_smfmac_f32_16x16x64_bf16 v[84:87], v[68:71], a[120:127], v8
 ds_read_b128 v[56:59], v23 offset:8192
 s_waitcnt lgkmcnt(8)
 v_smfmac_f32_16x16x64_bf16 v[80:83], v[72:75], a[128:135], v8
 ds_read_b128 v[48:51], v14 offset:2048
 v_smfmac_f32_16x16x64_bf16 v[84:87], v[72:75], a[136:143], v8
 ds_read_b128 v[60:63], v23 offset:8224
 s_waitcnt lgkmcnt(8)
 v_smfmac_f32_16x16x64_bf16 v[80:83], v[76:79], a[144:151], v8
 ds_read_b128 v[52:55], v14 offset:3072
 v_smfmac_f32_16x16x64_bf16 v[84:87], v[76:79], a[152:159], v8
 ds_read_b128 v[64:67], v23 offset:9216
 s_waitcnt lgkmcnt(8)
 v_smfmac_f32_16x16x64_bf16 v[80:83], v[180:183], a[160:167], v8
 v_smfmac_f32_16x16x64_bf16 v[84:87], v[180:183], a[168:175], v8
 ds_read_b128 v[68:71], v23 offset:9248
 s_waitcnt lgkmcnt(7)
 v_smfmac_f32_16x16x64_bf16 v[80:83], v[184:187], a[176:183], v8
 v_smfmac_f32_16x16x64_bf16 v[84:87], v[184:187], a[184:191], v8
 s_waitcnt lgkmcnt(5)
 v_smfmac_f32_16x16x64_bf16 v[80:83], v[56:59], a[192:199], v8
 v_smfmac_f32_16x16x64_bf16 v[84:87], v[56:59], a[200:207], v8
 s_waitcnt lgkmcnt(3)
 v_smfmac_f32_16x16x64_bf16 v[80:83], v[60:63], a[208:215], v8
 v_smfmac_f32_16x16x64_bf16 v[84:87], v[60:63], a[216:223], v8
 s_waitcnt lgkmcnt(1)
 v_smfmac_f32_16x16x64_bf16 v[80:83], v[64:67], a[224:231], v8
 v_smfmac_f32_16x16x64_bf16 v[84:87], v[64:67], a[232:239], v8
 s_waitcnt lgkmcnt(0)
 v_smfmac_f32_16x16x64_bf16 v[80:83], v[68:71], a[240:247], v8
 v_smfmac_f32_16x16x64_bf16 v[84:87], v[68:71], a[248:255], v8
 s_nop 2
 v_cvt_pk_bf16_f32 v116, v80, v81
 v_cvt_pk_bf16_f32 v117, v82, v83
 s_nop 2
 v_cvt_pk_bf16_f32 v118, v84, v85
 v_cvt_pk_bf16_f32 v119, v86, v87
 buffer_store_dwordx4 v[116:119], v18, s[4:7], s60 offen
 ds_write_b128 v16, v[116:119] offset:10240
 buffer_store_dwordx4 v[32:35], v18, s[4:7], s63 offen
 s_waitcnt vmcnt(2)
 v_readfirstlane_b32 s33, v13
 s_add_u32 s76, s53, 1
 s_waitcnt lgkmcnt(1)
 s_cmp_gt_u32 s33, s76
 s_cselect_b32 s33, 1, 0
 s_cselect_b32 s76, s76, 512
 s_lshl_b32 s16, s76, 19
 s_add_u32 s16, s16, s54
 s_xor_b32 s72, s16, 8192
 s_add_u32 s72, s72, s71
 s_add_u32 s16, s16, s70
 v_mfma_f32_16x16x32_bf16 v[100:103], v[148:151], v[40:43], v[108:111]
 s_add_u32 m0, s69, 49152
 s_nop 0
 buffer_load_dwordx4 v1, s[4:7], s16 offen offset:0 sc1 lds
 v_mov_b32 v80, 0
 ds_read_b128 v[56:59], v19 offset:0
 v_mfma_f32_16x16x32_bf16 v[104:107], v[164:167], v[40:43], v[112:115]
 v_mov_b32 v81, 0
 ds_read_b128 v[60:63], v19 offset:1024
 buffer_load_dwordx4 v1, s[4:7], s16 offen offset:1024 sc1 lds
 v_mfma_f32_16x16x32_bf16 v[100:103], v[152:155], v[44:47], v[100:103]
 v_mov_b32 v82, 0
 ds_read_b128 v[64:67], v19 offset:2048
 v_mfma_f32_16x16x32_bf16 v[104:107], v[168:171], v[44:47], v[104:107]
 v_mov_b32 v83, 0
 ds_read_b128 v[68:71], v19 offset:3072
 v_mfma_f32_16x16x32_bf16 v[100:103], v[156:159], v[48:51], v[100:103]
 v_mov_b32 v84, 0
 ds_read_b128 v[72:75], v19 offset:4096
 v_mfma_f32_16x16x32_bf16 v[104:107], v[172:175], v[48:51], v[104:107]
 buffer_load_dwordx4 v1, s[4:7], s16 offen offset:2048 sc1 lds
 v_mov_b32 v85, 0
 ds_read_b128 v[76:79], v19 offset:5120
 v_mfma_f32_16x16x32_bf16 v[100:103], v[160:163], v[52:55], v[100:103]
 v_mov_b32 v86, 0
 ds_read_b128 v[180:183], v19 offset:6144
 buffer_load_dwordx4 v1, s[4:7], s16 offen offset:3072 sc1 lds
 v_mfma_f32_16x16x32_bf16 v[104:107], v[176:179], v[52:55], v[104:107]
 v_mov_b32 v87, 0
 ds_read_b128 v[184:187], v19 offset:7168
 s_waitcnt lgkmcnt(8)
 s_barrier
 s_add_u32 m0, s69, 53248
 s_nop 0
 buffer_load_dwordx4 v6, s[4:7], s16 offen offset:0 sc1 lds
 ds_read_b128 v[140:143], v17 offset:10240
 ds_read_b128 v[144:147], v17 offset:11264
 s_nop 4
 v_cvt_pk_bf16_f32 v7, v100, v101
 v_lshlrev_b32 v100, 16, v7
 buffer_load_dwordx4 v6, s[4:7], s16 offen offset:1024 sc1 lds
 v_and_b32 v101, 0xffff0000, v7
 v_cvt_pk_bf16_f32 v7, v102, v103
 v_lshlrev_b32 v102, 16, v7
 v_and_b32 v103, 0xffff0000, v7
 v_cvt_pk_bf16_f32 v7, v104, v105
 buffer_load_dwordx4 v6, s[4:7], s16 offen offset:2048 sc1 lds
 v_lshlrev_b32 v104, 16, v7
 v_and_b32 v105, 0xffff0000, v7
 v_cvt_pk_bf16_f32 v7, v106, v107
 v_lshlrev_b32 v106, 16, v7
 v_and_b32 v107, 0xffff0000, v7
 buffer_load_dwordx4 v6, s[4:7], s16 offen offset:3072 sc1 lds
 v_pk_mul_f32 v[100:101], v[100:101], s[64:65] op_sel:[0,1] op_sel_hi:[1,1]
 v_pk_mul_f32 v[102:103], v[102:103], s[64:65] op_sel:[0,1] op_sel_hi:[1,1]
 v_pk_mul_f32 v[104:105], v[104:105], s[64:65] op_sel:[0,1] op_sel_hi:[1,1]
 v_pk_mul_f32 v[106:107], v[106:107], s[64:65] op_sel:[0,1] op_sel_hi:[1,1]
 v_cvt_pk_bf16_f32 v7, v100, v101
 v_lshlrev_b32 v100, 16, v7
 v_and_b32 v101, 0xffff0000, v7
 v_cvt_pk_bf16_f32 v7, v102, v103
 v_lshlrev_b32 v102, 16, v7
 v_and_b32 v103, 0xffff0000, v7
 v_cvt_pk_bf16_f32 v7, v104, v105
 v_lshlrev_b32 v104, 16, v7
 v_and_b32 v105, 0xffff0000, v7
 v_cvt_pk_bf16_f32 v7, v106, v107
 v_lshlrev_b32 v106, 16, v7
 v_and_b32 v107, 0xffff0000, v7
 v_max3_f32 v20, v100, v101, v102
 v_max3_f32 v20, v20, v103, v104
 v_max3_f32 v20, v20, v105, v106
 v_max_f32 v20, v20, v107
 v_mov_b32 v22, v20
 s_nop 1
 v_permlane16_swap_b32 v20, v22
 v_max_f32 v20, v20, v22
 v_mov_b32 v22, v20
 s_nop 1
 v_permlane32_swap_b32 v20, v22
 v_max_f32 v20, v20, v22
 v_mul_f32 v22, s66, v20
 v_fma_f32 v100, v100, s66, -v22
 v_fma_f32 v101, v101, s66, -v22
 v_fma_f32 v102, v102, s66, -v22
 v_fma_f32 v103, v103, s66, -v22
 v_fma_f32 v104, v104, s66, -v22
 v_fma_f32 v105, v105, s66, -v22
 v_fma_f32 v106, v106, s66, -v22
 v_fma_f32 v107, v107, s66, -v22
 v_exp_f32 v100, v100
 v_exp_f32 v101, v101
 v_exp_f32 v102, v102
 v_exp_f32 v103, v103
 v_exp_f32 v104, v104
 v_exp_f32 v105, v105
 v_exp_f32 v106, v106
 v_exp_f32 v107, v107
 buffer_load_dwordx4 v[124:127], v1, s[4:7], s60 offen offset:0 sc1
 buffer_load_dwordx4 v[128:131], v1, s[4:7], s60 offen offset:1024 sc1
 buffer_load_dwordx4 v[132:135], v1, s[4:7], s60 offen offset:2048 sc1
 buffer_load_dwordx4 v[136:139], v1, s[4:7], s60 offen offset:3072 sc1
 s_add_u32 m0, s68, 49152
 s_nop 0
 buffer_load_dwordx4 v1, s[4:7], s72 offen offset:0 sc1 nt lds
 buffer_load_dwordx4 v1, s[4:7], s72 offen offset:1024 sc1 nt lds
 buffer_load_dwordx4 v1, s[4:7], s72 offen offset:2048 sc1 nt lds
 buffer_load_dwordx4 v1, s[4:7], s72 offen offset:3072 sc1 nt lds
 v_add_f32 v21, v100, v101
 v_add_f32 v21, v21, v102
 v_add_f32 v21, v21, v103
 v_add_f32 v21, v21, v104
 v_add_f32 v21, v21, v105
 v_add_f32 v21, v21, v106
 v_add_f32 v21, v21, v107
 s_lshl_b32 s76, s53, 19
 s_add_u32 s76, s76, s54
 s_xor_b32 s76, s76, 8192
 s_add_u32 s76, s76, 67108864
 s_add_u32 s53, s53, 1
 s_add_u32 s67, s67, 4
 s_waitcnt vmcnt(4)
L_pk_269:
 v_max3_u32 v7, v124, v128, v132
 v_max_u32 v7, v7, v136
 v_cmp_eq_u32 vcc, -1, v7
 s_cbranch_vccnz L_rt_270
 v_mfma_f32_16x16x32_bf16 v[96:99], v[124:127], v[40:43], 0
 v_mfma_f32_16x16x32_bf16 v[96:99], v[128:131], v[44:47], v[96:99]
 v_mfma_f32_16x16x32_bf16 v[96:99], v[132:135], v[48:51], v[96:99]
 v_mfma_f32_16x16x32_bf16 v[96:99], v[136:139], v[52:55], v[96:99]
 s_nop 7
 v_cvt_pk_bf16_f32 v7, v98, v99
 v_lshlrev_b32 v98, 16, v7
 v_and_b32 v99, 0xffff0000, v7
 v_pk_mul_f32 v[98:99], v[98:99], s[64:65] op_sel:[0,1] op_sel_hi:[1,1]
 v_cvt_pk_bf16_f32 v7, v98, v99
 v_lshlrev_b32 v98, 16, v7
 v_and_b32 v99, 0xffff0000, v7
 v_max3_f32 v96, v98, v99, v20
 v_mov_b32 v22, v96
 s_nop 1
 v_permlane16_swap_b32 v96, v22
 v_max_f32 v96, v96, v22
 v_mov_b32 v22, v96
 s_nop 1
 v_permlane32_swap_b32 v96, v22
 v_max_f32 v96, v96, v22
 v_mul_f32 v96, s66, v96
 v_fma_f32 v28, v20, s66, -v96
 v_fma_f32 v98, v98, s66, -v96
 v_fma_f32 v99, v99, s66, -v96
 v_exp_f32 v28, v28
 v_exp_f32 v98, v98
 v_exp_f32 v99, v99
 s_nop 0
 v_fma_f32 v21, v21, v28, v98
 v_add_f32 v21, v21, v99
 v_mov_b32 v22, v21
 s_nop 1
 v_permlane16_swap_b32 v21, v22
 v_add_f32 v21, v21, v22
 v_mov_b32 v22, v21
 s_nop 1
 v_permlane32_swap_b32 v21, v22
 v_add_f32 v21, v21, v22
 v_rcp_f32 v21, v21
 s_nop 0
 v_mul_f32 v28, v28, v21
 v_pk_mul_f32 v[100:101], v[100:101], v[28:29] op_sel_hi:[1,0]
 v_cvt_pk_bf16_f32 v116, v100, v101
 v_pk_mul_f32 v[102:103], v[102:103], v[28:29] op_sel_hi:[1,0]
 v_cvt_pk_bf16_f32 v117, v102, v103
 v_pk_mul_f32 v[104:105], v[104:105], v[28:29] op_sel_hi:[1,0]
 v_cvt_pk_bf16_f32 v118, v104, v105
 v_pk_mul_f32 v[106:107], v[106:107], v[28:29] op_sel_hi:[1,0]
 v_cvt_pk_bf16_f32 v119, v106, v107
 v_pk_mul_f32 v[98:99], v[98:99], v[20:21] op_sel:[0,1] op_sel_hi:[1,1]
 s_waitcnt lgkmcnt(0)
 v_cvt_pk_bf16_f32 v120, v98, v99
 v_cvt_pk_bf16_f32 v123, v98, v99
 v_mfma_f32_16x16x32_bf16 v[148:151], v[56:59], v[116:119], 0
 v_mfma_f32_16x16x32_bf16 v[152:155], v[60:63], v[116:119], 0
 v_mfma_f32_16x16x16_bf16 v[148:151], v[140:141], v[120:121], v[148:151]
 v_mfma_f32_16x16x32_bf16 v[156:159], v[64:67], v[116:119], 0
 v_mfma_f32_16x16x16_bf16 v[152:155], v[140:141], v[122:123], v[152:155]
 v_mfma_f32_16x16x32_bf16 v[160:163], v[68:71], v[116:119], 0
 v_mfma_f32_16x16x16_bf16 v[156:159], v[142:143], v[120:121], v[156:159]
 v_mfma_f32_16x16x32_bf16 v[164:167], v[72:75], v[116:119], 0
 v_mfma_f32_16x16x16_bf16 v[160:163], v[142:143], v[122:123], v[160:163]
 v_cvt_pk_bf16_f32 v40, v148, v149
 v_cvt_pk_bf16_f32 v41, v150, v151
 v_cvt_pk_bf16_f32 v42, v152, v153
 v_cvt_pk_bf16_f32 v43, v154, v155
 buffer_store_dwordx4 v[40:43], v11, s[4:7], s76 offen offset:0 sc1
 v_mfma_f32_16x16x32_bf16 v[168:171], v[76:79], v[116:119], 0
 v_mfma_f32_16x16x16_bf16 v[164:167], v[144:145], v[120:121], v[164:167]
 v_mfma_f32_16x16x32_bf16 v[172:175], v[180:183], v[116:119], 0
 v_mfma_f32_16x16x16_bf16 v[168:171], v[144:145], v[122:123], v[168:171]
 v_cvt_pk_bf16_f32 v44, v156, v157
 v_cvt_pk_bf16_f32 v45, v158, v159
 v_cvt_pk_bf16_f32 v46, v160, v161
 v_cvt_pk_bf16_f32 v47, v162, v163
 buffer_store_dwordx4 v[44:47], v11, s[4:7], s76 offen offset:2048 sc1
 s_add_u32 s76, s76, 4096
 v_mfma_f32_16x16x32_bf16 v[176:179], v[184:187], v[116:119], 0
 v_mfma_f32_16x16x16_bf16 v[172:175], v[146:147], v[120:121], v[172:175]
 v_mfma_f32_16x16x16_bf16 v[176:179], v[146:147], v[122:123], v[176:179]
 v_cvt_pk_bf16_f32 v48, v164, v165
 v_cvt_pk_bf16_f32 v49, v166, v167
 v_cvt_pk_bf16_f32 v50, v168, v169
 v_cvt_pk_bf16_f32 v51, v170, v171
 buffer_store_dwordx4 v[48:51], v11, s[4:7], s76 offen offset:0 sc1
 v_mov_b32 v7, s53
 s_nop 2
 v_cvt_pk_bf16_f32 v52, v172, v173
 v_cvt_pk_bf16_f32 v53, v174, v175
 v_cvt_pk_bf16_f32 v54, v176, v177
 v_cvt_pk_bf16_f32 v55, v178, v179
 buffer_store_dwordx4 v[52:55], v11, s[4:7], s76 offen offset:2048 sc1
 s_mov_b64 exec, 1
 buffer_store_dword v7, off, s[4:7], s32 offset:8
 s_mov_b64 exec, -1
 s_mov_b32 s76, s53
 s_mov_b32 s34, s67
 s_cmp_eq_u32 s33, 0
 s_cbranch_scc1 L_nw_271
L_nj_272:
 s_mov_b32 s51, 0
 buffer_load_dword v7, off, s[4:7], s17 sc1
 s_waitcnt vmcnt(0)
L_go_273:
 v_cmp_gt_u32 vcc, s53, v7
 s_cbranch_vccnz L_rt_274
 v_mov_b32 v10, 1
 s_mov_b64 exec, 31
 buffer_atomic_add v10, v12, s[4:7], s34 offen
 s_mov_b64 exec, -1
 s_mov_b32 s51, 0
 s_nop 15
 s_nop 15
 s_nop 15
 s_nop 15
 buffer_load_dwordx4 v[40:43], v2, s[4:7], s57 offen offset:0 sc1
 buffer_load_dwordx4 v[44:47], v2, s[4:7], s57 offen offset:128 sc1
 buffer_load_dwordx4 v[48:51], v2, s[4:7], s57 offen offset:1024 sc1
 buffer_load_dwordx4 v[52:55], v2, s[4:7], s57 offen offset:1152 sc1
 buffer_load_dwordx4 v[56:59], v3, s[4:7], s57 offen offset:0 sc1
L_xm_275:
 s_waitcnt vmcnt(4)
 v_mfma_f32_16x16x32_bf16 v[60:63], v[24:27], v[40:43], 0
 s_waitcnt vmcnt(3)
 v_mfma_f32_16x16x32_bf16 v[64:67], v[24:27], v[44:47], 0
 s_waitcnt vmcnt(2)
 v_mfma_f32_16x16x32_bf16 v[68:71], v[24:27], v[48:51], 0
 v_max3_u32 v7, v40, v44, v48
 v_cvt_pk_bf16_f32 v60, v60, v61
 v_cvt_pk_bf16_f32 v61, v62, v63
 ds_write_b64 v4, v[60:61] offset:0
 s_waitcnt vmcnt(1)
 v_mfma_f32_16x16x32_bf16 v[72:75], v[24:27], v[52:55], 0
 v_cvt_pk_bf16_f32 v64, v64, v65
 v_cvt_pk_bf16_f32 v65, v66, v67
 ds_write_b64 v4, v[64:65] offset:8
 s_waitcnt vmcnt(0)
 v_mfma_f32_16x16x32_bf16 v[76:79], v[24:27], v[56:59], 0
 v_max3_u32 v7, v7, v52, v56
 v_cmp_eq_u32 vcc, -1, v7
 v_cvt_pk_bf16_f32 v68, v68, v69
 v_cvt_pk_bf16_f32 v69, v70, v71
 ds_write_b64 v4, v[68:69] offset:1024
 s_cbranch_vccnz L_rt_276
 v_cvt_pk_bf16_f32 v72, v72, v73
 v_cvt_pk_bf16_f32 v73, v74, v75
 ds_write_b64 v4, v[72:73] offset:1032
 s_nop 0
 v_cvt_pk_bf16_f32 v76, v76, v77
 v_cvt_pk_bf16_f32 v77, v78, v79
 ds_write_b64 v5, v[76:77] offset:0
 s_waitcnt lgkmcnt(0)
 s_barrier
 ds_read_b128 v[56:59], v23 offset:0
 ds_read_b128 v[60:63], v23 offset:32
 ds_read_b128 v[64:67], v23 offset:1024
 buffer_load_dword v13, off, s[4:7], s32 sc1
 s_waitcnt lgkmcnt(2)
 v_smfmac_f32_16x16x64_bf16 v[80:83], v[56:59], v[192:199], v8
 ds_read_b128 v[68:71], v23 offset:1056
 v_smfmac_f32_16x16x64_bf16 v[84:87], v[56:59], v[200:207], v8
 ds_read_b128 v[72:75], v23 offset:2048
 s_waitcnt lgkmcnt(3)
 v_smfmac_f32_16x16x64_bf16 v[80:83], v[60:63], v[208:215], v8
 ds_read_b128 v[76:79], v23 offset:2080
 v_smfmac_f32_16x16x64_bf16 v[84:87], v[60:63], v[216:223], v8
 ds_read_b128 v[180:183], v23 offset:3072
 s_waitcnt lgkmcnt(4)
 v_smfmac_f32_16x16x64_bf16 v[80:83], v[64:67], v[224:231], v8
 ds_read_b128 v[148:151], v15 offset:49152
 v_smfmac_f32_16x16x64_bf16 v[84:87], v[64:67], v[232:239], v8
 ds_read_b128 v[184:187], v23 offset:3104
 s_waitcnt lgkmcnt(5)
 v_smfmac_f32_16x16x64_bf16 v[80:83], v[68:71], v[240:247], v8
 ds_read_b128 v[152:155], v15 offset:50176
 v_smfmac_f32_16x16x64_bf16 v[84:87], v[68:71], v[248:255], v8
 ds_read_b128 v[56:59], v23 offset:4096
 s_waitcnt lgkmcnt(6)
 v_smfmac_f32_16x16x64_bf16 v[80:83], v[72:75], a[0:7], v8
 ds_read_b128 v[156:159], v15 offset:51200
 v_smfmac_f32_16x16x64_bf16 v[84:87], v[72:75], a[8:15], v8
 ds_read_b128 v[60:63], v23 offset:4128
 s_waitcnt lgkmcnt(7)
 v_smfmac_f32_16x16x64_bf16 v[80:83], v[76:79], a[16:23], v8
 ds_read_b128 v[160:163], v15 offset:52224
 v_smfmac_f32_16x16x64_bf16 v[84:87], v[76:79], a[24:31], v8
 ds_read_b128 v[64:67], v23 offset:5120
 s_waitcnt lgkmcnt(8)
 v_smfmac_f32_16x16x64_bf16 v[80:83], v[180:183], a[32:39], v8
 ds_read_b128 v[164:167], v15 offset:53248
 v_smfmac_f32_16x16x64_bf16 v[84:87], v[180:183], a[40:47], v8
 ds_read_b128 v[68:71], v23 offset:5152
 s_waitcnt lgkmcnt(8)
 v_smfmac_f32_16x16x64_bf16 v[80:83], v[184:187], a[48:55], v8
 ds_read_b128 v[168:171], v15 offset:54272
 v_smfmac_f32_16x16x64_bf16 v[84:87], v[184:187], a[56:63], v8
 ds_read_b128 v[72:75], v23 offset:6144
 s_waitcnt lgkmcnt(8)
 v_smfmac_f32_16x16x64_bf16 v[80:83], v[56:59], a[64:71], v8
 ds_read_b128 v[172:175], v15 offset:55296
 v_smfmac_f32_16x16x64_bf16 v[84:87], v[56:59], a[72:79], v8
 ds_read_b128 v[76:79], v23 offset:6176
 s_waitcnt lgkmcnt(8)
 v_smfmac_f32_16x16x64_bf16 v[80:83], v[60:63], a[80:87], v8
 ds_read_b128 v[176:179], v15 offset:56320
 v_smfmac_f32_16x16x64_bf16 v[84:87], v[60:63], a[88:95], v8
 ds_read_b128 v[180:183], v23 offset:7168
 s_waitcnt lgkmcnt(8)
 v_smfmac_f32_16x16x64_bf16 v[80:83], v[64:67], a[96:103], v8
 ds_read_b128 v[40:43], v14 offset:49152
 v_smfmac_f32_16x16x64_bf16 v[84:87], v[64:67], a[104:111], v8
 ds_read_b128 v[184:187], v23 offset:7200
 s_waitcnt lgkmcnt(8)
 v_smfmac_f32_16x16x64_bf16 v[80:83], v[68:71], a[112:119], v8
 ds_read_b128 v[44:47], v14 offset:50176
 v_smfmac_f32_16x16x64_bf16 v[84:87], v[68:71], a[120:127], v8
 ds_read_b128 v[56:59], v23 offset:8192
 s_waitcnt lgkmcnt(8)
 v_smfmac_f32_16x16x64_bf16 v[80:83], v[72:75], a[128:135], v8
 ds_read_b128 v[48:51], v14 offset:51200
 v_smfmac_f32_16x16x64_bf16 v[84:87], v[72:75], a[136:143], v8
 ds_read_b128 v[60:63], v23 offset:8224
 s_waitcnt lgkmcnt(8)
 v_smfmac_f32_16x16x64_bf16 v[80:83], v[76:79], a[144:151], v8
 ds_read_b128 v[52:55], v14 offset:52224
 v_smfmac_f32_16x16x64_bf16 v[84:87], v[76:79], a[152:159], v8
 ds_read_b128 v[64:67], v23 offset:9216
 s_waitcnt lgkmcnt(8)
 v_smfmac_f32_16x16x64_bf16 v[80:83], v[180:183], a[160:167], v8
 v_smfmac_f32_16x16x64_bf16 v[84:87], v[180:183], a[168:175], v8
 ds_read_b128 v[68:71], v23 offset:9248
 s_waitcnt lgkmcnt(7)
 v_smfmac_f32_16x16x64_bf16 v[80:83], v[184:187], a[176:183], v8
 v_smfmac_f32_16x16x64_bf16 v[84:87], v[184:187], a[184:191], v8
 s_waitcnt lgkmcnt(5)
 v_smfmac_f32_16x16x64_bf16 v[80:83], v[56:59], a[192:199], v8
 v_smfmac_f32_16x16x64_bf16 v[84:87], v[56:59], a[200:207], v8
 s_waitcnt lgkmcnt(3)
 v_smfmac_f32_16x16x64_bf16 v[80:83], v[60:63], a[208:215], v8
 v_smfmac_f32_16x16x64_bf16 v[84:87], v[60:63], a[216:223], v8
 s_waitcnt lgkmcnt(1)
 v_smfmac_f32_16x16x64_bf16 v[80:83], v[64:67], a[224:231], v8
 v_smfmac_f32_16x16x64_bf16 v[84:87], v[64:67], a[232:239], v8
 s_waitcnt lgkmcnt(0)
 v_smfmac_f32_16x16x64_bf16 v[80:83], v[68:71], a[240:247], v8
 v_smfmac_f32_16x16x64_bf16 v[84:87], v[68:71], a[248:255], v8
 s_nop 2
 v_cvt_pk_bf16_f32 v116, v80, v81
 v_cvt_pk_bf16_f32 v117, v82, v83
 s_nop 2
 v_cvt_pk_bf16_f32 v118, v84, v85
 v_cvt_pk_bf16_f32 v119, v86, v87
 buffer_store_dwordx4 v[116:119], v18, s[4:7], s61 offen
 ds_write_b128 v16, v[116:119] offset:10240
 buffer_store_dwordx4 v[32:35], v18, s[4:7], s60 offen
 s_waitcnt vmcnt(2)
 v_readfirstlane_b32 s33, v13
 s_add_u32 s76, s53, 1
 s_waitcnt lgkmcnt(1)
 s_cmp_gt_u32 s33, s76
 s_cselect_b32 s33, 1, 0
 s_cselect_b32 s76, s76, 512
 s_lshl_b32 s16, s76, 19
 s_add_u32 s16, s16, s54
 s_xor_b32 s72, s16, 8192
 s_add_u32 s72, s72, s71
 s_add_u32 s16, s16, s70
 v_mfma_f32_16x16x32_bf16 v[100:103], v[148:151], v[40:43], v[108:111]
 s_add_u32 m0, s69, 0
 s_nop 0
 buffer_load_dwordx4 v1, s[4:7], s16 offen offset:0 sc1 lds
 v_mov_b32 v80, 0
 ds_read_b128 v[56:59], v19 offset:49152
 v_mfma_f32_16x16x32_bf16 v[104:107], v[164:167], v[40:43], v[112:115]
 v_mov_b32 v81, 0
 ds_read_b128 v[60:63], v19 offset:50176
 buffer_load_dwordx4 v1, s[4:7], s16 offen offset:1024 sc1 lds
 v_mfma_f32_16x16x32_bf16 v[100:103], v[152:155], v[44:47], v[100:103]
 v_mov_b32 v82, 0
 ds_read_b128 v[64:67], v19 offset:51200
 v_mfma_f32_16x16x32_bf16 v[104:107], v[168:171], v[44:47], v[104:107]
 v_mov_b32 v83, 0
 ds_read_b128 v[68:71], v19 offset:52224
 v_mfma_f32_16x16x32_bf16 v[100:103], v[156:159], v[48:51], v[100:103]
 v_mov_b32 v84, 0
 ds_read_b128 v[72:75], v19 offset:53248
 v_mfma_f32_16x16x32_bf16 v[104:107], v[172:175], v[48:51], v[104:107]
 buffer_load_dwordx4 v1, s[4:7], s16 offen offset:2048 sc1 lds
 v_mov_b32 v85, 0
 ds_read_b128 v[76:79], v19 offset:54272
 v_mfma_f32_16x16x32_bf16 v[100:103], v[160:163], v[52:55], v[100:103]
 v_mov_b32 v86, 0
 ds_read_b128 v[180:183], v19 offset:55296
 buffer_load_dwordx4 v1, s[4:7], s16 offen offset:3072 sc1 lds
 v_mfma_f32_16x16x32_bf16 v[104:107], v[176:179], v[52:55], v[104:107]
 v_mov_b32 v87, 0
 ds_read_b128 v[184:187], v19 offset:56320
 s_waitcnt lgkmcnt(8)
 s_barrier
 s_add_u32 m0, s69, 4096
 s_nop 0
 buffer_load_dwordx4 v6, s[4:7], s16 offen offset:0 sc1 lds
 ds_read_b128 v[140:143], v17 offset:10240
 ds_read_b128 v[144:147], v17 offset:11264
 s_nop 4
 v_cvt_pk_bf16_f32 v7, v100, v101
 v_lshlrev_b32 v100, 16, v7
 buffer_load_dwordx4 v6, s[4:7], s16 offen offset:1024 sc1 lds
 v_and_b32 v101, 0xffff0000, v7
 v_cvt_pk_bf16_f32 v7, v102, v103
 v_lshlrev_b32 v102, 16, v7
 v_and_b32 v103, 0xffff0000, v7
 v_cvt_pk_bf16_f32 v7, v104, v105
 buffer_load_dwordx4 v6, s[4:7], s16 offen offset:2048 sc1 lds
 v_lshlrev_b32 v104, 16, v7
 v_and_b32 v105, 0xffff0000, v7
 v_cvt_pk_bf16_f32 v7, v106, v107
 v_lshlrev_b32 v106, 16, v7
 v_and_b32 v107, 0xffff0000, v7
 buffer_load_dwordx4 v6, s[4:7], s16 offen offset:3072 sc1 lds
 v_pk_mul_f32 v[100:101], v[100:101], s[64:65] op_sel:[0,1] op_sel_hi:[1,1]
 v_pk_mul_f32 v[102:103], v[102:103], s[64:65] op_sel:[0,1] op_sel_hi:[1,1]
 v_pk_mul_f32 v[104:105], v[104:105], s[64:65] op_sel:[0,1] op_sel_hi:[1,1]
 v_pk_mul_f32 v[106:107], v[106:107], s[64:65] op_sel:[0,1] op_sel_hi:[1,1]
 v_cvt_pk_bf16_f32 v7, v100, v101
 v_lshlrev_b32 v100, 16, v7
 v_and_b32 v101, 0xffff0000, v7
 v_cvt_pk_bf16_f32 v7, v102, v103
 v_lshlrev_b32 v102, 16, v7
 v_and_b32 v103, 0xffff0000, v7
 v_cvt_pk_bf16_f32 v7, v104, v105
 v_lshlrev_b32 v104, 16, v7
 v_and_b32 v105, 0xffff0000, v7
 v_cvt_pk_bf16_f32 v7, v106, v107
 v_lshlrev_b32 v106, 16, v7
 v_and_b32 v107, 0xffff0000, v7
 v_max3_f32 v20, v100, v101, v102
 v_max3_f32 v20, v20, v103, v104
 v_max3_f32 v20, v20, v105, v106
 v_max_f32 v20, v20, v107
 v_mov_b32 v22, v20
 s_nop 1
 v_permlane16_swap_b32 v20, v22
 v_max_f32 v20, v20, v22
 v_mov_b32 v22, v20
 s_nop 1
 v_permlane32_swap_b32 v20, v22
 v_max_f32 v20, v20, v22
 v_mul_f32 v22, s66, v20
 v_fma_f32 v100, v100, s66, -v22
 v_fma_f32 v101, v101, s66, -v22
 v_fma_f32 v102, v102, s66, -v22
 v_fma_f32 v103, v103, s66, -v22
 v_fma_f32 v104, v104, s66, -v22
 v_fma_f32 v105, v105, s66, -v22
 v_fma_f32 v106, v106, s66, -v22
 v_fma_f32 v107, v107, s66, -v22
 v_exp_f32 v100, v100
 v_exp_f32 v101, v101
 v_exp_f32 v102, v102
 v_exp_f32 v103, v103
 v_exp_f32 v104, v104
 v_exp_f32 v105, v105
 v_exp_f32 v106, v106
 v_exp_f32 v107, v107
 buffer_load_dwordx4 v[124:127], v1, s[4:7], s61 offen offset:0 sc1
 buffer_load_dwordx4 v[128:131], v1, s[4:7], s61 offen offset:1024 sc1
 buffer_load_dwordx4 v[132:135], v1, s[4:7], s61 offen offset:2048 sc1
 buffer_load_dwordx4 v[136:139], v1, s[4:7], s61 offen offset:3072 sc1
 s_add_u32 m0, s68, 0
 s_nop 0
 buffer_load_dwordx4 v1, s[4:7], s72 offen offset:0 sc1 nt lds
 buffer_load_dwordx4 v1, s[4:7], s72 offen offset:1024 sc1 nt lds
 buffer_load_dwordx4 v1, s[4:7], s72 offen offset:2048 sc1 nt lds
 buffer_load_dwordx4 v1, s[4:7], s72 offen offset:3072 sc1 nt lds
 v_add_f32 v21, v100, v101
 v_add_f32 v21, v21, v102
 v_add_f32 v21, v21, v103
 v_add_f32 v21, v21, v104
 v_add_f32 v21, v21, v105
 v_add_f32 v21, v21, v106
 v_add_f32 v21, v21, v107
 s_lshl_b32 s76, s53, 19
 s_add_u32 s76, s76, s54
 s_xor_b32 s76, s76, 8192
 s_add_u32 s76, s76, 67108864
 s_add_u32 s53, s53, 1
 s_add_u32 s67, s67, 4
 s_waitcnt vmcnt(4)
L_pk_277:
 v_max3_u32 v7, v124, v128, v132
 v_max_u32 v7, v7, v136
 v_cmp_eq_u32 vcc, -1, v7
 s_cbranch_vccnz L_rt_278
 v_mfma_f32_16x16x32_bf16 v[96:99], v[124:127], v[40:43], 0
 v_mfma_f32_16x16x32_bf16 v[96:99], v[128:131], v[44:47], v[96:99]
 v_mfma_f32_16x16x32_bf16 v[96:99], v[132:135], v[48:51], v[96:99]
 v_mfma_f32_16x16x32_bf16 v[96:99], v[136:139], v[52:55], v[96:99]
 s_nop 7
 v_cvt_pk_bf16_f32 v7, v98, v99
 v_lshlrev_b32 v98, 16, v7
 v_and_b32 v99, 0xffff0000, v7
 v_pk_mul_f32 v[98:99], v[98:99], s[64:65] op_sel:[0,1] op_sel_hi:[1,1]
 v_cvt_pk_bf16_f32 v7, v98, v99
 v_lshlrev_b32 v98, 16, v7
 v_and_b32 v99, 0xffff0000, v7
 v_max3_f32 v96, v98, v99, v20
 v_mov_b32 v22, v96
 s_nop 1
 v_permlane16_swap_b32 v96, v22
 v_max_f32 v96, v96, v22
 v_mov_b32 v22, v96
 s_nop 1
 v_permlane32_swap_b32 v96, v22
 v_max_f32 v96, v96, v22
 v_mul_f32 v96, s66, v96
 v_fma_f32 v28, v20, s66, -v96
 v_fma_f32 v98, v98, s66, -v96
 v_fma_f32 v99, v99, s66, -v96
 v_exp_f32 v28, v28
 v_exp_f32 v98, v98
 v_exp_f32 v99, v99
 s_nop 0
 v_fma_f32 v21, v21, v28, v98
 v_add_f32 v21, v21, v99
 v_mov_b32 v22, v21
 s_nop 1
 v_permlane16_swap_b32 v21, v22
 v_add_f32 v21, v21, v22
 v_mov_b32 v22, v21
 s_nop 1
 v_permlane32_swap_b32 v21, v22
 v_add_f32 v21, v21, v22
 v_rcp_f32 v21, v21
 s_nop 0
 v_mul_f32 v28, v28, v21
 v_pk_mul_f32 v[100:101], v[100:101], v[28:29] op_sel_hi:[1,0]
 v_cvt_pk_bf16_f32 v116, v100, v101
 v_pk_mul_f32 v[102:103], v[102:103], v[28:29] op_sel_hi:[1,0]
 v_cvt_pk_bf16_f32 v117, v102, v103
 v_pk_mul_f32 v[104:105], v[104:105], v[28:29] op_sel_hi:[1,0]
 v_cvt_pk_bf16_f32 v118, v104, v105
 v_pk_mul_f32 v[106:107], v[106:107], v[28:29] op_sel_hi:[1,0]
 v_cvt_pk_bf16_f32 v119, v106, v107
 v_pk_mul_f32 v[98:99], v[98:99], v[20:21] op_sel:[0,1] op_sel_hi:[1,1]
 s_waitcnt lgkmcnt(0)
 v_cvt_pk_bf16_f32 v120, v98, v99
 v_cvt_pk_bf16_f32 v123, v98, v99
 v_mfma_f32_16x16x32_bf16 v[148:151], v[56:59], v[116:119], 0
 v_mfma_f32_16x16x32_bf16 v[152:155], v[60:63], v[116:119], 0
 v_mfma_f32_16x16x16_bf16 v[148:151], v[140:141], v[120:121], v[148:151]
 v_mfma_f32_16x16x32_bf16 v[156:159], v[64:67], v[116:119], 0
 v_mfma_f32_16x16x16_bf16 v[152:155], v[140:141], v[122:123], v[152:155]
 v_mfma_f32_16x16x32_bf16 v[160:163], v[68:71], v[116:119], 0
 v_mfma_f32_16x16x16_bf16 v[156:159], v[142:143], v[120:121], v[156:159]
 v_mfma_f32_16x16x32_bf16 v[164:167], v[72:75], v[116:119], 0
 v_mfma_f32_16x16x16_bf16 v[160:163], v[142:143], v[122:123], v[160:163]
 v_cvt_pk_bf16_f32 v40, v148, v149
 v_cvt_pk_bf16_f32 v41, v150, v151
 v_cvt_pk_bf16_f32 v42, v152, v153
 v_cvt_pk_bf16_f32 v43, v154, v155
 buffer_store_dwordx4 v[40:43], v11, s[4:7], s76 offen offset:0 sc1
 v_mfma_f32_16x16x32_bf16 v[168:171], v[76:79], v[116:119], 0
 v_mfma_f32_16x16x16_bf16 v[164:167], v[144:145], v[120:121], v[164:167]
 v_mfma_f32_16x16x32_bf16 v[172:175], v[180:183], v[116:119], 0
 v_mfma_f32_16x16x16_bf16 v[168:171], v[144:145], v[122:123], v[168:171]
 v_cvt_pk_bf16_f32 v44, v156, v157
 v_cvt_pk_bf16_f32 v45, v158, v159
 v_cvt_pk_bf16_f32 v46, v160, v161
 v_cvt_pk_bf16_f32 v47, v162, v163
 buffer_store_dwordx4 v[44:47], v11, s[4:7], s76 offen offset:2048 sc1
 s_add_u32 s76, s76, 4096
 v_mfma_f32_16x16x32_bf16 v[176:179], v[184:187], v[116:119], 0
 v_mfma_f32_16x16x16_bf16 v[172:175], v[146:147], v[120:121], v[172:175]
 v_mfma_f32_16x16x16_bf16 v[176:179], v[146:147], v[122:123], v[176:179]
 v_cvt_pk_bf16_f32 v48, v164, v165
 v_cvt_pk_bf16_f32 v49, v166, v167
 v_cvt_pk_bf16_f32 v50, v168, v169
 v_cvt_pk_bf16_f32 v51, v170, v171
 buffer_store_dwordx4 v[48:51], v11, s[4:7], s76 offen offset:0 sc1
 v_mov_b32 v7, s53
 s_nop 2
 v_cvt_pk_bf16_f32 v52, v172, v173
 v_cvt_pk_bf16_f32 v53, v174, v175
 v_cvt_pk_bf16_f32 v54, v176, v177
 v_cvt_pk_bf16_f32 v55, v178, v179
 buffer_store_dwordx4 v[52:55], v11, s[4:7], s76 offen offset:2048 sc1
 s_mov_b64 exec, 1
 buffer_store_dword v7, off, s[4:7], s32 offset:8
 s_mov_b64 exec, -1
 s_mov_b32 s76, s53
 s_mov_b32 s34, s67
 s_cmp_eq_u32 s33, 0
 s_cbranch_scc1 L_nw_279
L_nj_280:
 s_mov_b32 s51, 0
 buffer_load_dword v7, off, s[4:7], s17 sc1
 s_waitcnt vmcnt(0)
L_go_281:
 v_cmp_gt_u32 vcc, s53, v7
 s_cbranch_vccnz L_rt_282
 v_mov_b32 v10, 1
 s_mov_b64 exec, 31
 buffer_atomic_add v10, v12, s[4:7], s34 offen
 s_mov_b64 exec, -1
 s_mov_b32 s51, 0
 s_nop 15
 s_nop 15
 s_nop 15
 s_nop 15
 buffer_load_dwordx4 v[40:43], v2, s[4:7], s58 offen offset:0 sc1
 buffer_load_dwordx4 v[44:47], v2, s[4:7], s58 offen offset:128 sc1
 buffer_load_dwordx4 v[48:51], v2, s[4:7], s58 offen offset:1024 sc1
 buffer_load_dwordx4 v[52:55], v2, s[4:7], s58 offen offset:1152 sc1
 buffer_load_dwordx4 v[56:59], v3, s[4:7], s58 offen offset:0 sc1
L_xm_283:
 s_waitcnt vmcnt(4)
 v_mfma_f32_16x16x32_bf16 v[60:63], v[24:27], v[40:43], 0
 s_waitcnt vmcnt(3)
 v_mfma_f32_16x16x32_bf16 v[64:67], v[24:27], v[44:47], 0
 s_waitcnt vmcnt(2)
 v_mfma_f32_16x16x32_bf16 v[68:71], v[24:27], v[48:51], 0
 v_max3_u32 v7, v40, v44, v48
 v_cvt_pk_bf16_f32 v60, v60, v61
 v_cvt_pk_bf16_f32 v61, v62, v63
 ds_write_b64 v4, v[60:61] offset:0
 s_waitcnt vmcnt(1)
 v_mfma_f32_16x16x32_bf16 v[72:75], v[24:27], v[52:55], 0
 v_cvt_pk_bf16_f32 v64, v64, v65
 v_cvt_pk_bf16_f32 v65, v66, v67
 ds_write_b64 v4, v[64:65] offset:8
 s_waitcnt vmcnt(0)
 v_mfma_f32_16x16x32_bf16 v[76:79], v[24:27], v[56:59], 0
 v_max3_u32 v7, v7, v52, v56
 v_cmp_eq_u32 vcc, -1, v7
 v_cvt_pk_bf16_f32 v68, v68, v69
 v_cvt_pk_bf16_f32 v69, v70, v71
 ds_write_b64 v4, v[68:69] offset:1024
 s_cbranch_vccnz L_rt_284
 v_cvt_pk_bf16_f32 v72, v72, v73
 v_cvt_pk_bf16_f32 v73, v74, v75
 ds_write_b64 v4, v[72:73] offset:1032
 s_nop 0
 v_cvt_pk_bf16_f32 v76, v76, v77
 v_cvt_pk_bf16_f32 v77, v78, v79
 ds_write_b64 v5, v[76:77] offset:0
 s_waitcnt lgkmcnt(0)
 s_barrier
 ds_read_b128 v[56:59], v23 offset:0
 ds_read_b128 v[60:63], v23 offset:32
 ds_read_b128 v[64:67], v23 offset:1024
 buffer_load_dword v13, off, s[4:7], s32 sc1
 s_waitcnt lgkmcnt(2)
 v_smfmac_f32_16x16x64_bf16 v[80:83], v[56:59], v[192:199], v8
 ds_read_b128 v[68:71], v23 offset:1056
 v_smfmac_f32_16x16x64_bf16 v[84:87], v[56:59], v[200:207], v8
 ds_read_b128 v[72:75], v23 offset:2048
 s_waitcnt lgkmcnt(3)
 v_smfmac_f32_16x16x64_bf16 v[80:83], v[60:63], v[208:215], v8
 ds_read_b128 v[76:79], v23 offset:2080
 v_smfmac_f32_16x16x64_bf16 v[84:87], v[60:63], v[216:223], v8
 ds_read_b128 v[180:183], v23 offset:3072
 s_waitcnt lgkmcnt(4)
 v_smfmac_f32_16x16x64_bf16 v[80:83], v[64:67], v[224:231], v8
 ds_read_b128 v[148:151], v15 offset:0
 v_smfmac_f32_16x16x64_bf16 v[84:87], v[64:67], v[232:239], v8
 ds_read_b128 v[184:187], v23 offset:3104
 s_waitcnt lgkmcnt(5)
 v_smfmac_f32_16x16x64_bf16 v[80:83], v[68:71], v[240:247], v8
 ds_read_b128 v[152:155], v15 offset:1024
 v_smfmac_f32_16x16x64_bf16 v[84:87], v[68:71], v[248:255], v8
 ds_read_b128 v[56:59], v23 offset:4096
 s_waitcnt lgkmcnt(6)
 v_smfmac_f32_16x16x64_bf16 v[80:83], v[72:75], a[0:7], v8
 ds_read_b128 v[156:159], v15 offset:2048
 v_smfmac_f32_16x16x64_bf16 v[84:87], v[72:75], a[8:15], v8
 ds_read_b128 v[60:63], v23 offset:4128
 s_waitcnt lgkmcnt(7)
 v_smfmac_f32_16x16x64_bf16 v[80:83], v[76:79], a[16:23], v8
 ds_read_b128 v[160:163], v15 offset:3072
 v_smfmac_f32_16x16x64_bf16 v[84:87], v[76:79], a[24:31], v8
 ds_read_b128 v[64:67], v23 offset:5120
 s_waitcnt lgkmcnt(8)
 v_smfmac_f32_16x16x64_bf16 v[80:83], v[180:183], a[32:39], v8
 ds_read_b128 v[164:167], v15 offset:4096
 v_smfmac_f32_16x16x64_bf16 v[84:87], v[180:183], a[40:47], v8
 ds_read_b128 v[68:71], v23 offset:5152
 s_waitcnt lgkmcnt(8)
 v_smfmac_f32_16x16x64_bf16 v[80:83], v[184:187], a[48:55], v8
 ds_read_b128 v[168:171], v15 offset:5120
 v_smfmac_f32_16x16x64_bf16 v[84:87], v[184:187], a[56:63], v8
 ds_read_b128 v[72:75], v23 offset:6144
 s_waitcnt lgkmcnt(8)
 v_smfmac_f32_16x16x64_bf16 v[80:83], v[56:59], a[64:71], v8
 ds_read_b128 v[172:175], v15 offset:6144
 v_smfmac_f32_16x16x64_bf16 v[84:87], v[56:59], a[72:79], v8
 ds_read_b128 v[76:79], v23 offset:6176
 s_waitcnt lgkmcnt(8)
 v_smfmac_f32_16x16x64_bf16 v[80:83], v[60:63], a[80:87], v8
 ds_read_b128 v[176:179], v15 offset:7168
 v_smfmac_f32_16x16x64_bf16 v[84:87], v[60:63], a[88:95], v8
 ds_read_b128 v[180:183], v23 offset:7168
 s_waitcnt lgkmcnt(8)
 v_smfmac_f32_16x16x64_bf16 v[80:83], v[64:67], a[96:103], v8
 ds_read_b128 v[40:43], v14 offset:0
 v_smfmac_f32_16x16x64_bf16 v[84:87], v[64:67], a[104:111], v8
 ds_read_b128 v[184:187], v23 offset:7200
 s_waitcnt lgkmcnt(8)
 v_smfmac_f32_16x16x64_bf16 v[80:83], v[68:71], a[112:119], v8
 ds_read_b128 v[44:47], v14 offset:1024
 v_smfmac_f32_16x16x64_bf16 v[84:87], v[68:71], a[120:127], v8
 ds_read_b128 v[56:59], v23 offset:8192
 s_waitcnt lgkmcnt(8)
 v_smfmac_f32_16x16x64_bf16 v[80:83], v[72:75], a[128:135], v8
 ds_read_b128 v[48:51], v14 offset:2048
 v_smfmac_f32_16x16x64_bf16 v[84:87], v[72:75], a[136:143], v8
 ds_read_b128 v[60:63], v23 offset:8224
 s_waitcnt lgkmcnt(8)
 v_smfmac_f32_16x16x64_bf16 v[80:83], v[76:79], a[144:151], v8
 ds_read_b128 v[52:55], v14 offset:3072
 v_smfmac_f32_16x16x64_bf16 v[84:87], v[76:79], a[152:159], v8
 ds_read_b128 v[64:67], v23 offset:9216
 s_waitcnt lgkmcnt(8)
 v_smfmac_f32_16x16x64_bf16 v[80:83], v[180:183], a[160:167], v8
 v_smfmac_f32_16x16x64_bf16 v[84:87], v[180:183], a[168:175], v8
 ds_read_b128 v[68:71], v23 offset:9248
 s_waitcnt lgkmcnt(7)
 v_smfmac_f32_16x16x64_bf16 v[80:83], v[184:187], a[176:183], v8
 v_smfmac_f32_16x16x64_bf16 v[84:87], v[184:187], a[184:191], v8
 s_waitcnt lgkmcnt(5)
 v_smfmac_f32_16x16x64_bf16 v[80:83], v[56:59], a[192:199], v8
 v_smfmac_f32_16x16x64_bf16 v[84:87], v[56:59], a[200:207], v8
 s_waitcnt lgkmcnt(3)
 v_smfmac_f32_16x16x64_bf16 v[80:83], v[60:63], a[208:215], v8
 v_smfmac_f32_16x16x64_bf16 v[84:87], v[60:63], a[216:223], v8
 s_waitcnt lgkmcnt(1)
 v_smfmac_f32_16x16x64_bf16 v[80:83], v[64:67], a[224:231], v8
 v_smfmac_f32_16x16x64_bf16 v[84:87], v[64:67], a[232:239], v8
 s_waitcnt lgkmcnt(0)
 v_smfmac_f32_16x16x64_bf16 v[80:83], v[68:71], a[240:247], v8
 v_smfmac_f32_16x16x64_bf16 v[84:87], v[68:71], a[248:255], v8
 s_nop 2
 v_cvt_pk_bf16_f32 v116, v80, v81
 v_cvt_pk_bf16_f32 v117, v82, v83
 s_nop 2
 v_cvt_pk_bf16_f32 v118, v84, v85
 v_cvt_pk_bf16_f32 v119, v86, v87
 buffer_store_dwordx4 v[116:119], v18, s[4:7], s62 offen
 ds_write_b128 v16, v[116:119] offset:10240
 buffer_store_dwordx4 v[32:35], v18, s[4:7], s61 offen
 s_waitcnt vmcnt(2)
 v_readfirstlane_b32 s33, v13
 s_add_u32 s76, s53, 1
 s_waitcnt lgkmcnt(1)
 s_cmp_gt_u32 s33, s76
 s_cselect_b32 s33, 1, 0
 s_cselect_b32 s76, s76, 512
 s_lshl_b32 s16, s76, 19
 s_add_u32 s16, s16, s54
 s_xor_b32 s72, s16, 8192
 s_add_u32 s72, s72, s71
 s_add_u32 s16, s16, s70
 v_mfma_f32_16x16x32_bf16 v[100:103], v[148:151], v[40:43], v[108:111]
 s_add_u32 m0, s69, 49152
 s_nop 0
 buffer_load_dwordx4 v1, s[4:7], s16 offen offset:0 sc1 lds
 v_mov_b32 v80, 0
 ds_read_b128 v[56:59], v19 offset:0
 v_mfma_f32_16x16x32_bf16 v[104:107], v[164:167], v[40:43], v[112:115]
 v_mov_b32 v81, 0
 ds_read_b128 v[60:63], v19 offset:1024
 buffer_load_dwordx4 v1, s[4:7], s16 offen offset:1024 sc1 lds
 v_mfma_f32_16x16x32_bf16 v[100:103], v[152:155], v[44:47], v[100:103]
 v_mov_b32 v82, 0
 ds_read_b128 v[64:67], v19 offset:2048
 v_mfma_f32_16x16x32_bf16 v[104:107], v[168:171], v[44:47], v[104:107]
 v_mov_b32 v83, 0
 ds_read_b128 v[68:71], v19 offset:3072
 v_mfma_f32_16x16x32_bf16 v[100:103], v[156:159], v[48:51], v[100:103]
 v_mov_b32 v84, 0
 ds_read_b128 v[72:75], v19 offset:4096
 v_mfma_f32_16x16x32_bf16 v[104:107], v[172:175], v[48:51], v[104:107]
 buffer_load_dwordx4 v1, s[4:7], s16 offen offset:2048 sc1 lds
 v_mov_b32 v85, 0
 ds_read_b128 v[76:79], v19 offset:5120
 v_mfma_f32_16x16x32_bf16 v[100:103], v[160:163], v[52:55], v[100:103]
 v_mov_b32 v86, 0
 ds_read_b128 v[180:183], v19 offset:6144
 buffer_load_dwordx4 v1, s[4:7], s16 offen offset:3072 sc1 lds
 v_mfma_f32_16x16x32_bf16 v[104:107], v[176:179], v[52:55], v[104:107]
 v_mov_b32 v87, 0
 ds_read_b128 v[184:187], v19 offset:7168
 s_waitcnt lgkmcnt(8)
 s_barrier
 s_add_u32 m0, s69, 53248
 s_nop 0
 buffer_load_dwordx4 v6, s[4:7], s16 offen offset:0 sc1 lds
 ds_read_b128 v[140:143], v17 offset:10240
 ds_read_b128 v[144:147], v17 offset:11264
 s_nop 4
 v_cvt_pk_bf16_f32 v7, v100, v101
 v_lshlrev_b32 v100, 16, v7
 buffer_load_dwordx4 v6, s[4:7], s16 offen offset:1024 sc1 lds
 v_and_b32 v101, 0xffff0000, v7
 v_cvt_pk_bf16_f32 v7, v102, v103
 v_lshlrev_b32 v102, 16, v7
 v_and_b32 v103, 0xffff0000, v7
 v_cvt_pk_bf16_f32 v7, v104, v105
 buffer_load_dwordx4 v6, s[4:7], s16 offen offset:2048 sc1 lds
 v_lshlrev_b32 v104, 16, v7
 v_and_b32 v105, 0xffff0000, v7
 v_cvt_pk_bf16_f32 v7, v106, v107
 v_lshlrev_b32 v106, 16, v7
 v_and_b32 v107, 0xffff0000, v7
 buffer_load_dwordx4 v6, s[4:7], s16 offen offset:3072 sc1 lds
 v_pk_mul_f32 v[100:101], v[100:101], s[64:65] op_sel:[0,1] op_sel_hi:[1,1]
 v_pk_mul_f32 v[102:103], v[102:103], s[64:65] op_sel:[0,1] op_sel_hi:[1,1]
 v_pk_mul_f32 v[104:105], v[104:105], s[64:65] op_sel:[0,1] op_sel_hi:[1,1]
 v_pk_mul_f32 v[106:107], v[106:107], s[64:65] op_sel:[0,1] op_sel_hi:[1,1]
 v_cvt_pk_bf16_f32 v7, v100, v101
 v_lshlrev_b32 v100, 16, v7
 v_and_b32 v101, 0xffff0000, v7
 v_cvt_pk_bf16_f32 v7, v102, v103
 v_lshlrev_b32 v102, 16, v7
 v_and_b32 v103, 0xffff0000, v7
 v_cvt_pk_bf16_f32 v7, v104, v105
 v_lshlrev_b32 v104, 16, v7
 v_and_b32 v105, 0xffff0000, v7
 v_cvt_pk_bf16_f32 v7, v106, v107
 v_lshlrev_b32 v106, 16, v7
 v_and_b32 v107, 0xffff0000, v7
 v_max3_f32 v20, v100, v101, v102
 v_max3_f32 v20, v20, v103, v104
 v_max3_f32 v20, v20, v105, v106
 v_max_f32 v20, v20, v107
 v_mov_b32 v22, v20
 s_nop 1
 v_permlane16_swap_b32 v20, v22
 v_max_f32 v20, v20, v22
 v_mov_b32 v22, v20
 s_nop 1
 v_permlane32_swap_b32 v20, v22
 v_max_f32 v20, v20, v22
 v_mul_f32 v22, s66, v20
 v_fma_f32 v100, v100, s66, -v22
 v_fma_f32 v101, v101, s66, -v22
 v_fma_f32 v102, v102, s66, -v22
 v_fma_f32 v103, v103, s66, -v22
 v_fma_f32 v104, v104, s66, -v22
 v_fma_f32 v105, v105, s66, -v22
 v_fma_f32 v106, v106, s66, -v22
 v_fma_f32 v107, v107, s66, -v22
 v_exp_f32 v100, v100
 v_exp_f32 v101, v101
 v_exp_f32 v102, v102
 v_exp_f32 v103, v103
 v_exp_f32 v104, v104
 v_exp_f32 v105, v105
 v_exp_f32 v106, v106
 v_exp_f32 v107, v107
 buffer_load_dwordx4 v[124:127], v1, s[4:7], s62 offen offset:0 sc1
 buffer_load_dwordx4 v[128:131], v1, s[4:7], s62 offen offset:1024 sc1
 buffer_load_dwordx4 v[132:135], v1, s[4:7], s62 offen offset:2048 sc1
 buffer_load_dwordx4 v[136:139], v1, s[4:7], s62 offen offset:3072 sc1
 s_add_u32 m0, s68, 49152
 s_nop 0
 buffer_load_dwordx4 v1, s[4:7], s72 offen offset:0 sc1 nt lds
 buffer_load_dwordx4 v1, s[4:7], s72 offen offset:1024 sc1 nt lds
 buffer_load_dwordx4 v1, s[4:7], s72 offen offset:2048 sc1 nt lds
 buffer_load_dwordx4 v1, s[4:7], s72 offen offset:3072 sc1 nt lds
 v_add_f32 v21, v100, v101
 v_add_f32 v21, v21, v102
 v_add_f32 v21, v21, v103
 v_add_f32 v21, v21, v104
 v_add_f32 v21, v21, v105
 v_add_f32 v21, v21, v106
 v_add_f32 v21, v21, v107
 s_lshl_b32 s76, s53, 19
 s_add_u32 s76, s76, s54
 s_xor_b32 s76, s76, 8192
 s_add_u32 s76, s76, 67108864
 s_add_u32 s53, s53, 1
 s_add_u32 s67, s67, 4
 s_waitcnt vmcnt(4)
L_pk_285:
 v_max3_u32 v7, v124, v128, v132
 v_max_u32 v7, v7, v136
 v_cmp_eq_u32 vcc, -1, v7
 s_cbranch_vccnz L_rt_286
 v_mfma_f32_16x16x32_bf16 v[96:99], v[124:127], v[40:43], 0
 v_mfma_f32_16x16x32_bf16 v[96:99], v[128:131], v[44:47], v[96:99]
 v_mfma_f32_16x16x32_bf16 v[96:99], v[132:135], v[48:51], v[96:99]
 v_mfma_f32_16x16x32_bf16 v[96:99], v[136:139], v[52:55], v[96:99]
 s_nop 7
 v_cvt_pk_bf16_f32 v7, v98, v99
 v_lshlrev_b32 v98, 16, v7
 v_and_b32 v99, 0xffff0000, v7
 v_pk_mul_f32 v[98:99], v[98:99], s[64:65] op_sel:[0,1] op_sel_hi:[1,1]
 v_cvt_pk_bf16_f32 v7, v98, v99
 v_lshlrev_b32 v98, 16, v7
 v_and_b32 v99, 0xffff0000, v7
 v_max3_f32 v96, v98, v99, v20
 v_mov_b32 v22, v96
 s_nop 1
 v_permlane16_swap_b32 v96, v22
 v_max_f32 v96, v96, v22
 v_mov_b32 v22, v96
 s_nop 1
 v_permlane32_swap_b32 v96, v22
 v_max_f32 v96, v96, v22
 v_mul_f32 v96, s66, v96
 v_fma_f32 v28, v20, s66, -v96
 v_fma_f32 v98, v98, s66, -v96
 v_fma_f32 v99, v99, s66, -v96
 v_exp_f32 v28, v28
 v_exp_f32 v98, v98
 v_exp_f32 v99, v99
 s_nop 0
 v_fma_f32 v21, v21, v28, v98
 v_add_f32 v21, v21, v99
 v_mov_b32 v22, v21
 s_nop 1
 v_permlane16_swap_b32 v21, v22
 v_add_f32 v21, v21, v22
 v_mov_b32 v22, v21
 s_nop 1
 v_permlane32_swap_b32 v21, v22
 v_add_f32 v21, v21, v22
 v_rcp_f32 v21, v21
 s_nop 0
 v_mul_f32 v28, v28, v21
 v_pk_mul_f32 v[100:101], v[100:101], v[28:29] op_sel_hi:[1,0]
 v_cvt_pk_bf16_f32 v116, v100, v101
 v_pk_mul_f32 v[102:103], v[102:103], v[28:29] op_sel_hi:[1,0]
 v_cvt_pk_bf16_f32 v117, v102, v103
 v_pk_mul_f32 v[104:105], v[104:105], v[28:29] op_sel_hi:[1,0]
 v_cvt_pk_bf16_f32 v118, v104, v105
 v_pk_mul_f32 v[106:107], v[106:107], v[28:29] op_sel_hi:[1,0]
 v_cvt_pk_bf16_f32 v119, v106, v107
 v_pk_mul_f32 v[98:99], v[98:99], v[20:21] op_sel:[0,1] op_sel_hi:[1,1]
 s_waitcnt lgkmcnt(0)
 v_cvt_pk_bf16_f32 v120, v98, v99
 v_cvt_pk_bf16_f32 v123, v98, v99
 v_mfma_f32_16x16x32_bf16 v[148:151], v[56:59], v[116:119], 0
 v_mfma_f32_16x16x32_bf16 v[152:155], v[60:63], v[116:119], 0
 v_mfma_f32_16x16x16_bf16 v[148:151], v[140:141], v[120:121], v[148:151]
 v_mfma_f32_16x16x32_bf16 v[156:159], v[64:67], v[116:119], 0
 v_mfma_f32_16x16x16_bf16 v[152:155], v[140:141], v[122:123], v[152:155]
 v_mfma_f32_16x16x32_bf16 v[160:163], v[68:71], v[116:119], 0
 v_mfma_f32_16x16x16_bf16 v[156:159], v[142:143], v[120:121], v[156:159]
 v_mfma_f32_16x16x32_bf16 v[164:167], v[72:75], v[116:119], 0
 v_mfma_f32_16x16x16_bf16 v[160:163], v[142:143], v[122:123], v[160:163]
 v_cvt_pk_bf16_f32 v40, v148, v149
 v_cvt_pk_bf16_f32 v41, v150, v151
 v_cvt_pk_bf16_f32 v42, v152, v153
 v_cvt_pk_bf16_f32 v43, v154, v155
 buffer_store_dwordx4 v[40:43], v11, s[4:7], s76 offen offset:0 sc1
 v_mfma_f32_16x16x32_bf16 v[168:171], v[76:79], v[116:119], 0
 v_mfma_f32_16x16x16_bf16 v[164:167], v[144:145], v[120:121], v[164:167]
 v_mfma_f32_16x16x32_bf16 v[172:175], v[180:183], v[116:119], 0
 v_mfma_f32_16x16x16_bf16 v[168:171], v[144:145], v[122:123], v[168:171]
 v_cvt_pk_bf16_f32 v44, v156, v157
 v_cvt_pk_bf16_f32 v45, v158, v159
 v_cvt_pk_bf16_f32 v46, v160, v161
 v_cvt_pk_bf16_f32 v47, v162, v163
 buffer_store_dwordx4 v[44:47], v11, s[4:7], s76 offen offset:2048 sc1
 s_add_u32 s76, s76, 4096
 v_mfma_f32_16x16x32_bf16 v[176:179], v[184:187], v[116:119], 0
 v_mfma_f32_16x16x16_bf16 v[172:175], v[146:147], v[120:121], v[172:175]
 v_mfma_f32_16x16x16_bf16 v[176:179], v[146:147], v[122:123], v[176:179]
 v_cvt_pk_bf16_f32 v48, v164, v165
 v_cvt_pk_bf16_f32 v49, v166, v167
 v_cvt_pk_bf16_f32 v50, v168, v169
 v_cvt_pk_bf16_f32 v51, v170, v171
 buffer_store_dwordx4 v[48:51], v11, s[4:7], s76 offen offset:0 sc1
 v_mov_b32 v7, s53
 s_nop 2
 v_cvt_pk_bf16_f32 v52, v172, v173
 v_cvt_pk_bf16_f32 v53, v174, v175
 v_cvt_pk_bf16_f32 v54, v176, v177
 v_cvt_pk_bf16_f32 v55, v178, v179
 buffer_store_dwordx4 v[52:55], v11, s[4:7], s76 offen offset:2048 sc1
 s_mov_b64 exec, 1
 buffer_store_dword v7, off, s[4:7], s32 offset:8
 s_mov_b64 exec, -1
 s_mov_b32 s76, s53
 s_mov_b32 s34, s67
 s_cmp_eq_u32 s33, 0
 s_cbranch_scc1 L_nw_287
L_nj_288:
 s_mov_b32 s51, 0
 buffer_load_dword v7, off, s[4:7], s17 sc1
 s_waitcnt vmcnt(0)
L_go_289:
 v_cmp_gt_u32 vcc, s53, v7
 s_cbranch_vccnz L_rt_290
 v_mov_b32 v10, 1
 s_mov_b64 exec, 31
 buffer_atomic_add v10, v12, s[4:7], s34 offen
 s_mov_b64 exec, -1
 s_mov_b32 s51, 0
 s_nop 15
 s_nop 15
 s_nop 15
 s_nop 15
 buffer_load_dwordx4 v[40:43], v2, s[4:7], s59 offen offset:0 sc1
 buffer_load_dwordx4 v[44:47], v2, s[4:7], s59 offen offset:128 sc1
 buffer_load_dwordx4 v[48:51], v2, s[4:7], s59 offen offset:1024 sc1
 buffer_load_dwordx4 v[52:55], v2, s[4:7], s59 offen offset:1152 sc1
 buffer_load_dwordx4 v[56:59], v3, s[4:7], s59 offen offset:0 sc1
L_xm_291:
 s_waitcnt vmcnt(4)
 v_mfma_f32_16x16x32_bf16 v[60:63], v[24:27], v[40:43], 0
 s_waitcnt vmcnt(3)
 v_mfma_f32_16x16x32_bf16 v[64:67], v[24:27], v[44:47], 0
 s_waitcnt vmcnt(2)
 v_mfma_f32_16x16x32_bf16 v[68:71], v[24:27], v[48:51], 0
 v_max3_u32 v7, v40, v44, v48
 v_cvt_pk_bf16_f32 v60, v60, v61
 v_cvt_pk_bf16_f32 v61, v62, v63
 ds_write_b64 v4, v[60:61] offset:0
 s_waitcnt vmcnt(1)
 v_mfma_f32_16x16x32_bf16 v[72:75], v[24:27], v[52:55], 0
 v_cvt_pk_bf16_f32 v64, v64, v65
 v_cvt_pk_bf16_f32 v65, v66, v67
 ds_write_b64 v4, v[64:65] offset:8
 s_waitcnt vmcnt(0)
 v_mfma_f32_16x16x32_bf16 v[76:79], v[24:27], v[56:59], 0
 v_max3_u32 v7, v7, v52, v56
 v_cmp_eq_u32 vcc, -1, v7
 v_cvt_pk_bf16_f32 v68, v68, v69
 v_cvt_pk_bf16_f32 v69, v70, v71
 ds_write_b64 v4, v[68:69] offset:1024
 s_cbranch_vccnz L_rt_292
 v_cvt_pk_bf16_f32 v72, v72, v73
 v_cvt_pk_bf16_f32 v73, v74, v75
 ds_write_b64 v4, v[72:73] offset:1032
 s_nop 0
 v_cvt_pk_bf16_f32 v76, v76, v77
 v_cvt_pk_bf16_f32 v77, v78, v79
 ds_write_b64 v5, v[76:77] offset:0
 s_waitcnt lgkmcnt(0)
 s_barrier
 ds_read_b128 v[56:59], v23 offset:0
 ds_read_b128 v[60:63], v23 offset:32
 ds_read_b128 v[64:67], v23 offset:1024
 buffer_load_dword v13, off, s[4:7], s32 sc1
 s_waitcnt lgkmcnt(2)
 v_smfmac_f32_16x16x64_bf16 v[80:83], v[56:59], v[192:199], v8
 ds_read_b128 v[68:71], v23 offset:1056
 v_smfmac_f32_16x16x64_bf16 v[84:87], v[56:59], v[200:207], v8
 ds_read_b128 v[72:75], v23 offset:2048
 s_waitcnt lgkmcnt(3)
 v_smfmac_f32_16x16x64_bf16 v[80:83], v[60:63], v[208:215], v8
 ds_read_b128 v[76:79], v23 offset:2080
 v_smfmac_f32_16x16x64_bf16 v[84:87], v[60:63], v[216:223], v8
 ds_read_b128 v[180:183], v23 offset:3072
 s_waitcnt lgkmcnt(4)
 v_smfmac_f32_16x16x64_bf16 v[80:83], v[64:67], v[224:231], v8
 ds_read_b128 v[148:151], v15 offset:49152
 v_smfmac_f32_16x16x64_bf16 v[84:87], v[64:67], v[232:239], v8
 ds_read_b128 v[184:187], v23 offset:3104
 s_waitcnt lgkmcnt(5)
 v_smfmac_f32_16x16x64_bf16 v[80:83], v[68:71], v[240:247], v8
 ds_read_b128 v[152:155], v15 offset:50176
 v_smfmac_f32_16x16x64_bf16 v[84:87], v[68:71], v[248:255], v8
 ds_read_b128 v[56:59], v23 offset:4096
 s_waitcnt lgkmcnt(6)
 v_smfmac_f32_16x16x64_bf16 v[80:83], v[72:75], a[0:7], v8
 ds_read_b128 v[156:159], v15 offset:51200
 v_smfmac_f32_16x16x64_bf16 v[84:87], v[72:75], a[8:15], v8
 ds_read_b128 v[60:63], v23 offset:4128
 s_waitcnt lgkmcnt(7)
 v_smfmac_f32_16x16x64_bf16 v[80:83], v[76:79], a[16:23], v8
 ds_read_b128 v[160:163], v15 offset:52224
 v_smfmac_f32_16x16x64_bf16 v[84:87], v[76:79], a[24:31], v8
 ds_read_b128 v[64:67], v23 offset:5120
 s_waitcnt lgkmcnt(8)
 v_smfmac_f32_16x16x64_bf16 v[80:83], v[180:183], a[32:39], v8
 ds_read_b128 v[164:167], v15 offset:53248
 v_smfmac_f32_16x16x64_bf16 v[84:87], v[180:183], a[40:47], v8
 ds_read_b128 v[68:71], v23 offset:5152
 s_waitcnt lgkmcnt(8)
 v_smfmac_f32_16x16x64_bf16 v[80:83], v[184:187], a[48:55], v8
 ds_read_b128 v[168:171], v15 offset:54272
 v_smfmac_f32_16x16x64_bf16 v[84:87], v[184:187], a[56:63], v8
 ds_read_b128 v[72:75], v23 offset:6144
 s_waitcnt lgkmcnt(8)
 v_smfmac_f32_16x16x64_bf16 v[80:83], v[56:59], a[64:71], v8
 ds_read_b128 v[172:175], v15 offset:55296
 v_smfmac_f32_16x16x64_bf16 v[84:87], v[56:59], a[72:79], v8
 ds_read_b128 v[76:79], v23 offset:6176
 s_waitcnt lgkmcnt(8)
 v_smfmac_f32_16x16x64_bf16 v[80:83], v[60:63], a[80:87], v8
 ds_read_b128 v[176:179], v15 offset:56320
 v_smfmac_f32_16x16x64_bf16 v[84:87], v[60:63], a[88:95], v8
 ds_read_b128 v[180:183], v23 offset:7168
 s_waitcnt lgkmcnt(8)
 v_smfmac_f32_16x16x64_bf16 v[80:83], v[64:67], a[96:103], v8
 ds_read_b128 v[40:43], v14 offset:49152
 v_smfmac_f32_16x16x64_bf16 v[84:87], v[64:67], a[104:111], v8
 ds_read_b128 v[184:187], v23 offset:7200
 s_waitcnt lgkmcnt(8)
 v_smfmac_f32_16x16x64_bf16 v[80:83], v[68:71], a[112:119], v8
 ds_read_b128 v[44:47], v14 offset:50176
 v_smfmac_f32_16x16x64_bf16 v[84:87], v[68:71], a[120:127], v8
 ds_read_b128 v[56:59], v23 offset:8192
 s_waitcnt lgkmcnt(8)
 v_smfmac_f32_16x16x64_bf16 v[80:83], v[72:75], a[128:135], v8
 ds_read_b128 v[48:51], v14 offset:51200
 v_smfmac_f32_16x16x64_bf16 v[84:87], v[72:75], a[136:143], v8
 ds_read_b128 v[60:63], v23 offset:8224
 s_waitcnt lgkmcnt(8)
 v_smfmac_f32_16x16x64_bf16 v[80:83], v[76:79], a[144:151], v8
 ds_read_b128 v[52:55], v14 offset:52224
 v_smfmac_f32_16x16x64_bf16 v[84:87], v[76:79], a[152:159], v8
 ds_read_b128 v[64:67], v23 offset:9216
 s_waitcnt lgkmcnt(8)
 v_smfmac_f32_16x16x64_bf16 v[80:83], v[180:183], a[160:167], v8
 v_smfmac_f32_16x16x64_bf16 v[84:87], v[180:183], a[168:175], v8
 ds_read_b128 v[68:71], v23 offset:9248
 s_waitcnt lgkmcnt(7)
 v_smfmac_f32_16x16x64_bf16 v[80:83], v[184:187], a[176:183], v8
 v_smfmac_f32_16x16x64_bf16 v[84:87], v[184:187], a[184:191], v8
 s_waitcnt lgkmcnt(5)
 v_smfmac_f32_16x16x64_bf16 v[80:83], v[56:59], a[192:199], v8
 v_smfmac_f32_16x16x64_bf16 v[84:87], v[56:59], a[200:207], v8
 s_waitcnt lgkmcnt(3)
 v_smfmac_f32_16x16x64_bf16 v[80:83], v[60:63], a[208:215], v8
 v_smfmac_f32_16x16x64_bf16 v[84:87], v[60:63], a[216:223], v8
 s_waitcnt lgkmcnt(1)
 v_smfmac_f32_16x16x64_bf16 v[80:83], v[64:67], a[224:231], v8
 v_smfmac_f32_16x16x64_bf16 v[84:87], v[64:67], a[232:239], v8
 s_waitcnt lgkmcnt(0)
 v_smfmac_f32_16x16x64_bf16 v[80:83], v[68:71], a[240:247], v8
 v_smfmac_f32_16x16x64_bf16 v[84:87], v[68:71], a[248:255], v8
 s_nop 2
 v_cvt_pk_bf16_f32 v116, v80, v81
 v_cvt_pk_bf16_f32 v117, v82, v83
 s_nop 2
 v_cvt_pk_bf16_f32 v118, v84, v85
 v_cvt_pk_bf16_f32 v119, v86, v87
 buffer_store_dwordx4 v[116:119], v18, s[4:7], s63 offen
 ds_write_b128 v16, v[116:119] offset:10240
 buffer_store_dwordx4 v[32:35], v18, s[4:7], s62 offen
 s_waitcnt vmcnt(2)
 v_readfirstlane_b32 s33, v13
 s_add_u32 s76, s53, 1
 s_waitcnt lgkmcnt(1)
 s_cmp_gt_u32 s33, s76
 s_cselect_b32 s33, 1, 0
 s_cselect_b32 s76, s76, 512
 s_lshl_b32 s16, s76, 19
 s_add_u32 s16, s16, s54
 s_xor_b32 s72, s16, 8192
 s_add_u32 s72, s72, s71
 s_add_u32 s16, s16, s70
 v_mfma_f32_16x16x32_bf16 v[100:103], v[148:151], v[40:43], v[108:111]
 s_add_u32 m0, s69, 0
 s_nop 0
 buffer_load_dwordx4 v1, s[4:7], s16 offen offset:0 sc1 lds
 v_mov_b32 v80, 0
 ds_read_b128 v[56:59], v19 offset:49152
 v_mfma_f32_16x16x32_bf16 v[104:107], v[164:167], v[40:43], v[112:115]
 v_mov_b32 v81, 0
 ds_read_b128 v[60:63], v19 offset:50176
 buffer_load_dwordx4 v1, s[4:7], s16 offen offset:1024 sc1 lds
 v_mfma_f32_16x16x32_bf16 v[100:103], v[152:155], v[44:47], v[100:103]
 v_mov_b32 v82, 0
 ds_read_b128 v[64:67], v19 offset:51200
 v_mfma_f32_16x16x32_bf16 v[104:107], v[168:171], v[44:47], v[104:107]
 v_mov_b32 v83, 0
 ds_read_b128 v[68:71], v19 offset:52224
 v_mfma_f32_16x16x32_bf16 v[100:103], v[156:159], v[48:51], v[100:103]
 v_mov_b32 v84, 0
 ds_read_b128 v[72:75], v19 offset:53248
 v_mfma_f32_16x16x32_bf16 v[104:107], v[172:175], v[48:51], v[104:107]
 buffer_load_dwordx4 v1, s[4:7], s16 offen offset:2048 sc1 lds
 v_mov_b32 v85, 0
 ds_read_b128 v[76:79], v19 offset:54272
 v_mfma_f32_16x16x32_bf16 v[100:103], v[160:163], v[52:55], v[100:103]
 v_mov_b32 v86, 0
 ds_read_b128 v[180:183], v19 offset:55296
 buffer_load_dwordx4 v1, s[4:7], s16 offen offset:3072 sc1 lds
 v_mfma_f32_16x16x32_bf16 v[104:107], v[176:179], v[52:55], v[104:107]
 v_mov_b32 v87, 0
 ds_read_b128 v[184:187], v19 offset:56320
 s_waitcnt lgkmcnt(8)
 s_barrier
 s_add_u32 m0, s69, 4096
 s_nop 0
 buffer_load_dwordx4 v6, s[4:7], s16 offen offset:0 sc1 lds
 ds_read_b128 v[140:143], v17 offset:10240
 ds_read_b128 v[144:147], v17 offset:11264
 s_nop 4
 v_cvt_pk_bf16_f32 v7, v100, v101
 v_lshlrev_b32 v100, 16, v7
 buffer_load_dwordx4 v6, s[4:7], s16 offen offset:1024 sc1 lds
 v_and_b32 v101, 0xffff0000, v7
 v_cvt_pk_bf16_f32 v7, v102, v103
 v_lshlrev_b32 v102, 16, v7
 v_and_b32 v103, 0xffff0000, v7
 v_cvt_pk_bf16_f32 v7, v104, v105
 buffer_load_dwordx4 v6, s[4:7], s16 offen offset:2048 sc1 lds
 v_lshlrev_b32 v104, 16, v7
 v_and_b32 v105, 0xffff0000, v7
 v_cvt_pk_bf16_f32 v7, v106, v107
 v_lshlrev_b32 v106, 16, v7
 v_and_b32 v107, 0xffff0000, v7
 buffer_load_dwordx4 v6, s[4:7], s16 offen offset:3072 sc1 lds
 v_pk_mul_f32 v[100:101], v[100:101], s[64:65] op_sel:[0,1] op_sel_hi:[1,1]
 v_pk_mul_f32 v[102:103], v[102:103], s[64:65] op_sel:[0,1] op_sel_hi:[1,1]
 v_pk_mul_f32 v[104:105], v[104:105], s[64:65] op_sel:[0,1] op_sel_hi:[1,1]
 v_pk_mul_f32 v[106:107], v[106:107], s[64:65] op_sel:[0,1] op_sel_hi:[1,1]
 v_cvt_pk_bf16_f32 v7, v100, v101
 v_lshlrev_b32 v100, 16, v7
 v_and_b32 v101, 0xffff0000, v7
 v_cvt_pk_bf16_f32 v7, v102, v103
 v_lshlrev_b32 v102, 16, v7
 v_and_b32 v103, 0xffff0000, v7
 v_cvt_pk_bf16_f32 v7, v104, v105
 v_lshlrev_b32 v104, 16, v7
 v_and_b32 v105, 0xffff0000, v7
 v_cvt_pk_bf16_f32 v7, v106, v107
 v_lshlrev_b32 v106, 16, v7
 v_and_b32 v107, 0xffff0000, v7
 v_max3_f32 v20, v100, v101, v102
 v_max3_f32 v20, v20, v103, v104
 v_max3_f32 v20, v20, v105, v106
 v_max_f32 v20, v20, v107
 v_mov_b32 v22, v20
 s_nop 1
 v_permlane16_swap_b32 v20, v22
 v_max_f32 v20, v20, v22
 v_mov_b32 v22, v20
 s_nop 1
 v_permlane32_swap_b32 v20, v22
 v_max_f32 v20, v20, v22
 v_mul_f32 v22, s66, v20
 v_fma_f32 v100, v100, s66, -v22
 v_fma_f32 v101, v101, s66, -v22
 v_fma_f32 v102, v102, s66, -v22
 v_fma_f32 v103, v103, s66, -v22
 v_fma_f32 v104, v104, s66, -v22
 v_fma_f32 v105, v105, s66, -v22
 v_fma_f32 v106, v106, s66, -v22
 v_fma_f32 v107, v107, s66, -v22
 v_exp_f32 v100, v100
 v_exp_f32 v101, v101
 v_exp_f32 v102, v102
 v_exp_f32 v103, v103
 v_exp_f32 v104, v104
 v_exp_f32 v105, v105
 v_exp_f32 v106, v106
 v_exp_f32 v107, v107
 buffer_load_dwordx4 v[124:127], v1, s[4:7], s63 offen offset:0 sc1
 buffer_load_dwordx4 v[128:131], v1, s[4:7], s63 offen offset:1024 sc1
 buffer_load_dwordx4 v[132:135], v1, s[4:7], s63 offen offset:2048 sc1
 buffer_load_dwordx4 v[136:139], v1, s[4:7], s63 offen offset:3072 sc1
 s_add_u32 m0, s68, 0
 s_nop 0
 buffer_load_dwordx4 v1, s[4:7], s72 offen offset:0 sc1 nt lds
 buffer_load_dwordx4 v1, s[4:7], s72 offen offset:1024 sc1 nt lds
 buffer_load_dwordx4 v1, s[4:7], s72 offen offset:2048 sc1 nt lds
 buffer_load_dwordx4 v1, s[4:7], s72 offen offset:3072 sc1 nt lds
 v_add_f32 v21, v100, v101
 v_add_f32 v21, v21, v102
 v_add_f32 v21, v21, v103
 v_add_f32 v21, v21, v104
 v_add_f32 v21, v21, v105
 v_add_f32 v21, v21, v106
 v_add_f32 v21, v21, v107
 s_lshl_b32 s76, s53, 19
 s_add_u32 s76, s76, s54
 s_xor_b32 s76, s76, 8192
 s_add_u32 s76, s76, 67108864
 s_add_u32 s53, s53, 1
 s_add_u32 s67, s67, 4
 s_waitcnt vmcnt(4)
L_pk_293:
 v_max3_u32 v7, v124, v128, v132
 v_max_u32 v7, v7, v136
 v_cmp_eq_u32 vcc, -1, v7
 s_cbranch_vccnz L_rt_294
 v_mfma_f32_16x16x32_bf16 v[96:99], v[124:127], v[40:43], 0
 v_mfma_f32_16x16x32_bf16 v[96:99], v[128:131], v[44:47], v[96:99]
 v_mfma_f32_16x16x32_bf16 v[96:99], v[132:135], v[48:51], v[96:99]
 v_mfma_f32_16x16x32_bf16 v[96:99], v[136:139], v[52:55], v[96:99]
 s_nop 7
 v_cvt_pk_bf16_f32 v7, v98, v99
 v_lshlrev_b32 v98, 16, v7
 v_and_b32 v99, 0xffff0000, v7
 v_pk_mul_f32 v[98:99], v[98:99], s[64:65] op_sel:[0,1] op_sel_hi:[1,1]
 v_cvt_pk_bf16_f32 v7, v98, v99
 v_lshlrev_b32 v98, 16, v7
 v_and_b32 v99, 0xffff0000, v7
 v_max3_f32 v96, v98, v99, v20
 v_mov_b32 v22, v96
 s_nop 1
 v_permlane16_swap_b32 v96, v22
 v_max_f32 v96, v96, v22
 v_mov_b32 v22, v96
 s_nop 1
 v_permlane32_swap_b32 v96, v22
 v_max_f32 v96, v96, v22
 v_mul_f32 v96, s66, v96
 v_fma_f32 v28, v20, s66, -v96
 v_fma_f32 v98, v98, s66, -v96
 v_fma_f32 v99, v99, s66, -v96
 v_exp_f32 v28, v28
 v_exp_f32 v98, v98
 v_exp_f32 v99, v99
 s_nop 0
 v_fma_f32 v21, v21, v28, v98
 v_add_f32 v21, v21, v99
 v_mov_b32 v22, v21
 s_nop 1
 v_permlane16_swap_b32 v21, v22
 v_add_f32 v21, v21, v22
 v_mov_b32 v22, v21
 s_nop 1
 v_permlane32_swap_b32 v21, v22
 v_add_f32 v21, v21, v22
 v_rcp_f32 v21, v21
 s_nop 0
 v_mul_f32 v28, v28, v21
 v_pk_mul_f32 v[100:101], v[100:101], v[28:29] op_sel_hi:[1,0]
 v_cvt_pk_bf16_f32 v116, v100, v101
 v_pk_mul_f32 v[102:103], v[102:103], v[28:29] op_sel_hi:[1,0]
 v_cvt_pk_bf16_f32 v117, v102, v103
 v_pk_mul_f32 v[104:105], v[104:105], v[28:29] op_sel_hi:[1,0]
 v_cvt_pk_bf16_f32 v118, v104, v105
 v_pk_mul_f32 v[106:107], v[106:107], v[28:29] op_sel_hi:[1,0]
 v_cvt_pk_bf16_f32 v119, v106, v107
 v_pk_mul_f32 v[98:99], v[98:99], v[20:21] op_sel:[0,1] op_sel_hi:[1,1]
 s_waitcnt lgkmcnt(0)
 v_cvt_pk_bf16_f32 v120, v98, v99
 v_cvt_pk_bf16_f32 v123, v98, v99
 v_mfma_f32_16x16x32_bf16 v[148:151], v[56:59], v[116:119], 0
 v_mfma_f32_16x16x32_bf16 v[152:155], v[60:63], v[116:119], 0
 v_mfma_f32_16x16x16_bf16 v[148:151], v[140:141], v[120:121], v[148:151]
 v_mfma_f32_16x16x32_bf16 v[156:159], v[64:67], v[116:119], 0
 v_mfma_f32_16x16x16_bf16 v[152:155], v[140:141], v[122:123], v[152:155]
 v_mfma_f32_16x16x32_bf16 v[160:163], v[68:71], v[116:119], 0
 v_mfma_f32_16x16x16_bf16 v[156:159], v[142:143], v[120:121], v[156:159]
 v_mfma_f32_16x16x32_bf16 v[164:167], v[72:75], v[116:119], 0
 v_mfma_f32_16x16x16_bf16 v[160:163], v[142:143], v[122:123], v[160:163]
 v_cvt_pk_bf16_f32 v40, v148, v149
 v_cvt_pk_bf16_f32 v41, v150, v151
 v_cvt_pk_bf16_f32 v42, v152, v153
 v_cvt_pk_bf16_f32 v43, v154, v155
 buffer_store_dwordx4 v[40:43], v11, s[4:7], s76 offen offset:0 sc1
 v_mfma_f32_16x16x32_bf16 v[168:171], v[76:79], v[116:119], 0
 v_mfma_f32_16x16x16_bf16 v[164:167], v[144:145], v[120:121], v[164:167]
 v_mfma_f32_16x16x32_bf16 v[172:175], v[180:183], v[116:119], 0
 v_mfma_f32_16x16x16_bf16 v[168:171], v[144:145], v[122:123], v[168:171]
 v_cvt_pk_bf16_f32 v44, v156, v157
 v_cvt_pk_bf16_f32 v45, v158, v159
 v_cvt_pk_bf16_f32 v46, v160, v161
 v_cvt_pk_bf16_f32 v47, v162, v163
 buffer_store_dwordx4 v[44:47], v11, s[4:7], s76 offen offset:2048 sc1
 s_add_u32 s76, s76, 4096
 v_mfma_f32_16x16x32_bf16 v[176:179], v[184:187], v[116:119], 0
 v_mfma_f32_16x16x16_bf16 v[172:175], v[146:147], v[120:121], v[172:175]
 v_mfma_f32_16x16x16_bf16 v[176:179], v[146:147], v[122:123], v[176:179]
 v_cvt_pk_bf16_f32 v48, v164, v165
 v_cvt_pk_bf16_f32 v49, v166, v167
 v_cvt_pk_bf16_f32 v50, v168, v169
 v_cvt_pk_bf16_f32 v51, v170, v171
 buffer_store_dwordx4 v[48:51], v11, s[4:7], s76 offen offset:0 sc1
 v_mov_b32 v7, s53
 s_nop 2
 v_cvt_pk_bf16_f32 v52, v172, v173
 v_cvt_pk_bf16_f32 v53, v174, v175
 v_cvt_pk_bf16_f32 v54, v176, v177
 v_cvt_pk_bf16_f32 v55, v178, v179
 buffer_store_dwordx4 v[52:55], v11, s[4:7], s76 offen offset:2048 sc1
 s_mov_b64 exec, 1
 buffer_store_dword v7, off, s[4:7], s32 offset:8
 s_mov_b64 exec, -1
 s_mov_b32 s76, s53
 s_cmp_eq_u32 s53, 64
 s_cbranch_scc1 L_vr_last
 s_mov_b32 s34, s67
 s_cmp_eq_u32 s33, 0
 s_cbranch_scc1 L_nw_295
L_nj_296:
 s_branch L_vr_loopf
L_rt_266:
 s_nop 7
 buffer_load_dword v7, off, s[4:7], s17 sc1
 s_waitcnt vmcnt(0)
 s_add_u32 s51, s51, 1
 s_cmp_lt_u32 s51, 131072
 s_cbranch_scc1 L_go_265
 s_branch L_bail
L_rt_268:
 s_nop 7
 buffer_load_dwordx4 v[40:43], v2, s[4:7], s56 offen offset:0 sc1
 buffer_load_dwordx4 v[44:47], v2, s[4:7], s56 offen offset:128 sc1
 buffer_load_dwordx4 v[48:51], v2, s[4:7], s56 offen offset:1024 sc1
 buffer_load_dwordx4 v[52:55], v2, s[4:7], s56 offen offset:1152 sc1
 buffer_load_dwordx4 v[56:59], v3, s[4:7], s56 offen offset:0 sc1
 s_add_u32 s51, s51, 1
 s_cmp_lt_u32 s51, 131072
 s_cbranch_scc1 L_xm_267
 s_branch L_bail
L_rt_270:
 s_nop 7
 buffer_load_dwordx4 v[124:127], v1, s[4:7], s60 offen offset:0 sc1
 buffer_load_dwordx4 v[128:131], v1, s[4:7], s60 offen offset:1024 sc1
 buffer_load_dwordx4 v[132:135], v1, s[4:7], s60 offen offset:2048 sc1
 buffer_load_dwordx4 v[136:139], v1, s[4:7], s60 offen offset:3072 sc1
 s_waitcnt vmcnt(0)
 s_add_u32 s51, s51, 1
 s_cmp_lt_u32 s51, 131072
 s_cbranch_scc1 L_pk_269
 s_branch L_bail
L_nw_271:
 s_waitcnt vmcnt(0)
 v_mov_b32 v10, 1
 s_mov_b64 exec, 31
 buffer_atomic_add v10, v12, s[4:7], s67 offen
 s_mov_b64 exec, -1
 s_mov_b32 s34, 268435456
 s_add_u32 s77, s53, 1
 s_mov_b32 s51, 0
 s_mov_b64 exec, 1
L_pl_297:
 buffer_load_dword v7, v9, s[4:7], s32 offen sc1
 s_waitcnt vmcnt(0)
 v_cmp_gt_u32 vcc, s77, v7
 s_cbranch_vccz L_pld_298
 s_sleep 1
 s_add_u32 s51, s51, 1
 s_cmp_lt_u32 s51, 131072
 s_cbranch_scc1 L_pl_297
 s_branch L_bail
L_pld_298:
 s_mov_b64 exec, -1
 s_cmp_eq_u32 s3, s3
 s_cselect_b32 s76, s76, 512
 s_lshl_b32 s16, s76, 19
 s_add_u32 s16, s16, s54
 s_xor_b32 s72, s16, 8192
 s_add_u32 s72, s72, s71
 s_add_u32 s16, s16, s70
 s_add_u32 m0, s69, 49152
 s_nop 0
 buffer_load_dwordx4 v1, s[4:7], s16 offen offset:0 sc1 lds
 buffer_load_dwordx4 v1, s[4:7], s16 offen offset:1024 sc1 lds
 buffer_load_dwordx4 v1, s[4:7], s16 offen offset:2048 sc1 lds
 buffer_load_dwordx4 v1, s[4:7], s16 offen offset:3072 sc1 lds
 s_add_u32 m0, s69, 53248
 s_nop 0
 buffer_load_dwordx4 v6, s[4:7], s16 offen offset:0 sc1 lds
 buffer_load_dwordx4 v6, s[4:7], s16 offen offset:1024 sc1 lds
 buffer_load_dwordx4 v6, s[4:7], s16 offen offset:2048 sc1 lds
 buffer_load_dwordx4 v6, s[4:7], s16 offen offset:3072 sc1 lds
 s_add_u32 m0, s68, 49152
 s_nop 0
 buffer_load_dwordx4 v1, s[4:7], s72 offen offset:0 sc1 nt lds
 buffer_load_dwordx4 v1, s[4:7], s72 offen offset:1024 sc1 nt lds
 buffer_load_dwordx4 v1, s[4:7], s72 offen offset:2048 sc1 nt lds
 buffer_load_dwordx4 v1, s[4:7], s72 offen offset:3072 sc1 nt lds
 s_branch L_nj_272
L_rt_274:
 s_nop 7
 buffer_load_dword v7, off, s[4:7], s17 sc1
 s_waitcnt vmcnt(0)
 s_add_u32 s51, s51, 1
 s_cmp_lt_u32 s51, 131072
 s_cbranch_scc1 L_go_273
 s_branch L_bail
L_rt_276:
 s_nop 7
 buffer_load_dwordx4 v[40:43], v2, s[4:7], s57 offen offset:0 sc1
 buffer_load_dwordx4 v[44:47], v2, s[4:7], s57 offen offset:128 sc1
 buffer_load_dwordx4 v[48:51], v2, s[4:7], s57 offen offset:1024 sc1
 buffer_load_dwordx4 v[52:55], v2, s[4:7], s57 offen offset:1152 sc1
 buffer_load_dwordx4 v[56:59], v3, s[4:7], s57 offen offset:0 sc1
 s_add_u32 s51, s51, 1
 s_cmp_lt_u32 s51, 131072
 s_cbranch_scc1 L_xm_275
 s_branch L_bail
L_rt_278:
 s_nop 7
 buffer_load_dwordx4 v[124:127], v1, s[4:7], s61 offen offset:0 sc1
 buffer_load_dwordx4 v[128:131], v1, s[4:7], s61 offen offset:1024 sc1
 buffer_load_dwordx4 v[132:135], v1, s[4:7], s61 offen offset:2048 sc1
 buffer_load_dwordx4 v[136:139], v1, s[4:7], s61 offen offset:3072 sc1
 s_waitcnt vmcnt(0)
 s_add_u32 s51, s51, 1
 s_cmp_lt_u32 s51, 131072
 s_cbranch_scc1 L_pk_277
 s_branch L_bail
L_nw_279:
 s_waitcnt vmcnt(0)
 v_mov_b32 v10, 1
 s_mov_b64 exec, 31
 buffer_atomic_add v10, v12, s[4:7], s67 offen
 s_mov_b64 exec, -1
 s_mov_b32 s34, 268435456
 s_add_u32 s77, s53, 1
 s_mov_b32 s51, 0
 s_mov_b64 exec, 1
L_pl_299:
 buffer_load_dword v7, v9, s[4:7], s32 offen sc1
 s_waitcnt vmcnt(0)
 v_cmp_gt_u32 vcc, s77, v7
 s_cbranch_vccz L_pld_300
 s_sleep 1
 s_add_u32 s51, s51, 1
 s_cmp_lt_u32 s51, 131072
 s_cbranch_scc1 L_pl_299
 s_branch L_bail
L_pld_300:
 s_mov_b64 exec, -1
 s_cmp_eq_u32 s3, s3
 s_cselect_b32 s76, s76, 512
 s_lshl_b32 s16, s76, 19
 s_add_u32 s16, s16, s54
 s_xor_b32 s72, s16, 8192
 s_add_u32 s72, s72, s71
 s_add_u32 s16, s16, s70
 s_add_u32 m0, s69, 0
 s_nop 0
 buffer_load_dwordx4 v1, s[4:7], s16 offen offset:0 sc1 lds
 buffer_load_dwordx4 v1, s[4:7], s16 offen offset:1024 sc1 lds
 buffer_load_dwordx4 v1, s[4:7], s16 offen offset:2048 sc1 lds
 buffer_load_dwordx4 v1, s[4:7], s16 offen offset:3072 sc1 lds
 s_add_u32 m0, s69, 4096
 s_nop 0
 buffer_load_dwordx4 v6, s[4:7], s16 offen offset:0 sc1 lds
 buffer_load_dwordx4 v6, s[4:7], s16 offen offset:1024 sc1 lds
 buffer_load_dwordx4 v6, s[4:7], s16 offen offset:2048 sc1 lds
 buffer_load_dwordx4 v6, s[4:7], s16 offen offset:3072 sc1 lds
 s_add_u32 m0, s68, 0
 s_nop 0
 buffer_load_dwordx4 v1, s[4:7], s72 offen offset:0 sc1 nt lds
 buffer_load_dwordx4 v1, s[4:7], s72 offen offset:1024 sc1 nt lds
 buffer_load_dwordx4 v1, s[4:7], s72 offen offset:2048 sc1 nt lds
 buffer_load_dwordx4 v1, s[4:7], s72 offen offset:3072 sc1 nt lds
 s_branch L_nj_280
L_rt_282:
 s_nop 7
 buffer_load_dword v7, off, s[4:7], s17 sc1
 s_waitcnt vmcnt(0)
 s_add_u32 s51, s51, 1
 s_cmp_lt_u32 s51, 131072
 s_cbranch_scc1 L_go_281
 s_branch L_bail
L_rt_284:
 s_nop 7
 buffer_load_dwordx4 v[40:43], v2, s[4:7], s58 offen offset:0 sc1
 buffer_load_dwordx4 v[44:47], v2, s[4:7], s58 offen offset:128 sc1
 buffer_load_dwordx4 v[48:51], v2, s[4:7], s58 offen offset:1024 sc1
 buffer_load_dwordx4 v[52:55], v2, s[4:7], s58 offen offset:1152 sc1
 buffer_load_dwordx4 v[56:59], v3, s[4:7], s58 offen offset:0 sc1
 s_add_u32 s51, s51, 1
 s_cmp_lt_u32 s51, 131072
 s_cbranch_scc1 L_xm_283
 s_branch L_bail
L_rt_286:
 s_nop 7
 buffer_load_dwordx4 v[124:127], v1, s[4:7], s62 offen offset:0 sc1
 buffer_load_dwordx4 v[128:131], v1, s[4:7], s62 offen offset:1024 sc1
 buffer_load_dwordx4 v[132:135], v1, s[4:7], s62 offen offset:2048 sc1
 buffer_load_dwordx4 v[136:139], v1, s[4:7], s62 offen offset:3072 sc1
 s_waitcnt vmcnt(0)
 s_add_u32 s51, s51, 1
 s_cmp_lt_u32 s51, 131072
 s_cbranch_scc1 L_pk_285
 s_branch L_bail
L_nw_287:
 s_waitcnt vmcnt(0)
 v_mov_b32 v10, 1
 s_mov_b64 exec, 31
 buffer_atomic_add v10, v12, s[4:7], s67 offen
 s_mov_b64 exec, -1
 s_mov_b32 s34, 268435456
 s_add_u32 s77, s53, 1
 s_mov_b32 s51, 0
 s_mov_b64 exec, 1
L_pl_301:
 buffer_load_dword v7, v9, s[4:7], s32 offen sc1
 s_waitcnt vmcnt(0)
 v_cmp_gt_u32 vcc, s77, v7
 s_cbranch_vccz L_pld_302
 s_sleep 1
 s_add_u32 s51, s51, 1
 s_cmp_lt_u32 s51, 131072
 s_cbranch_scc1 L_pl_301
 s_branch L_bail
L_pld_302:
 s_mov_b64 exec, -1
 s_cmp_eq_u32 s3, s3
 s_cselect_b32 s76, s76, 512
 s_lshl_b32 s16, s76, 19
 s_add_u32 s16, s16, s54
 s_xor_b32 s72, s16, 8192
 s_add_u32 s72, s72, s71
 s_add_u32 s16, s16, s70
 s_add_u32 m0, s69, 49152
 s_nop 0
 buffer_load_dwordx4 v1, s[4:7], s16 offen offset:0 sc1 lds
 buffer_load_dwordx4 v1, s[4:7], s16 offen offset:1024 sc1 lds
 buffer_load_dwordx4 v1, s[4:7], s16 offen offset:2048 sc1 lds
 buffer_load_dwordx4 v1, s[4:7], s16 offen offset:3072 sc1 lds
 s_add_u32 m0, s69, 53248
 s_nop 0
 buffer_load_dwordx4 v6, s[4:7], s16 offen offset:0 sc1 lds
 buffer_load_dwordx4 v6, s[4:7], s16 offen offset:1024 sc1 lds
 buffer_load_dwordx4 v6, s[4:7], s16 offen offset:2048 sc1 lds
 buffer_load_dwordx4 v6, s[4:7], s16 offen offset:3072 sc1 lds
 s_add_u32 m0, s68, 49152
 s_nop 0
 buffer_load_dwordx4 v1, s[4:7], s72 offen offset:0 sc1 nt lds
 buffer_load_dwordx4 v1, s[4:7], s72 offen offset:1024 sc1 nt lds
 buffer_load_dwordx4 v1, s[4:7], s72 offen offset:2048 sc1 nt lds
 buffer_load_dwordx4 v1, s[4:7], s72 offen offset:3072 sc1 nt lds
 s_branch L_nj_288
L_rt_290:
 s_nop 7
 buffer_load_dword v7, off, s[4:7], s17 sc1
 s_waitcnt vmcnt(0)
 s_add_u32 s51, s51, 1
 s_cmp_lt_u32 s51, 131072
 s_cbranch_scc1 L_go_289
 s_branch L_bail
L_rt_292:
 s_nop 7
 buffer_load_dwordx4 v[40:43], v2, s[4:7], s59 offen offset:0 sc1
 buffer_load_dwordx4 v[44:47], v2, s[4:7], s59 offen offset:128 sc1
 buffer_load_dwordx4 v[48:51], v2, s[4:7], s59 offen offset:1024 sc1
 buffer_load_dwordx4 v[52:55], v2, s[4:7], s59 offen offset:1152 sc1
 buffer_load_dwordx4 v[56:59], v3, s[4:7], s59 offen offset:0 sc1
 s_add_u32 s51, s51, 1
 s_cmp_lt_u32 s51, 131072
 s_cbranch_scc1 L_xm_291
 s_branch L_bail
L_rt_294:
 s_nop 7
 buffer_load_dwordx4 v[124:127], v1, s[4:7], s63 offen offset:0 sc1
 buffer_load_dwordx4 v[128:131], v1, s[4:7], s63 offen offset:1024 sc1
 buffer_load_dwordx4 v[132:135], v1, s[4:7], s63 offen offset:2048 sc1
 buffer_load_dwordx4 v[136:139], v1, s[4:7], s63 offen offset:3072 sc1
 s_waitcnt vmcnt(0)
 s_add_u32 s51, s51, 1
 s_cmp_lt_u32 s51, 131072
 s_cbranch_scc1 L_pk_293
 s_branch L_bail
L_nw_295:
 s_waitcnt vmcnt(0)
 v_mov_b32 v10, 1
 s_mov_b64 exec, 31
 buffer_atomic_add v10, v12, s[4:7], s67 offen
 s_mov_b64 exec, -1
 s_mov_b32 s34, 268435456
 s_add_u32 s77, s53, 1
 s_mov_b32 s51, 0
 s_mov_b64 exec, 1
L_pl_303:
 buffer_load_dword v7, v9, s[4:7], s32 offen sc1
 s_waitcnt vmcnt(0)
 v_cmp_gt_u32 vcc, s77, v7
 s_cbranch_vccz L_pld_304
 s_sleep 1
 s_add_u32 s51, s51, 1
 s_cmp_lt_u32 s51, 131072
 s_cbranch_scc1 L_pl_303
 s_branch L_bail
L_pld_304:
 s_mov_b64 exec, -1
 s_cmp_eq_u32 s3, s3
 s_cselect_b32 s76, s76, 512
 s_lshl_b32 s16, s76, 19
 s_add_u32 s16, s16, s54
 s_xor_b32 s72, s16, 8192
 s_add_u32 s72, s72, s71
 s_add_u32 s16, s16, s70
 s_add_u32 m0, s69, 0
 s_nop 0
 buffer_load_dwordx4 v1, s[4:7], s16 offen offset:0 sc1 lds
 buffer_load_dwordx4 v1, s[4:7], s16 offen offset:1024 sc1 lds
 buffer_load_dwordx4 v1, s[4:7], s16 offen offset:2048 sc1 lds
 buffer_load_dwordx4 v1, s[4:7], s16 offen offset:3072 sc1 lds
 s_add_u32 m0, s69, 4096
 s_nop 0
 buffer_load_dwordx4 v6, s[4:7], s16 offen offset:0 sc1 lds
 buffer_load_dwordx4 v6, s[4:7], s16 offen offset:1024 sc1 lds
 buffer_load_dwordx4 v6, s[4:7], s16 offen offset:2048 sc1 lds
 buffer_load_dwordx4 v6, s[4:7], s16 offen offset:3072 sc1 lds
 s_add_u32 m0, s68, 0
 s_nop 0
 buffer_load_dwordx4 v1, s[4:7], s72 offen offset:0 sc1 nt lds
 buffer_load_dwordx4 v1, s[4:7], s72 offen offset:1024 sc1 nt lds
 buffer_load_dwordx4 v1, s[4:7], s72 offen offset:2048 sc1 nt lds
 buffer_load_dwordx4 v1, s[4:7], s72 offen offset:3072 sc1 nt lds
 s_branch L_nj_296
.p2align 6
L_vr_loops:
 s_mov_b32 s51, 0
 buffer_load_dword v7, off, s[4:7], s17 sc1
 s_waitcnt vmcnt(0)
L_go_305:
 v_cmp_gt_u32 vcc, s53, v7
 s_cbranch_vccnz L_rt_306
 v_mov_b32 v10, 1
 s_mov_b64 exec, 31
 buffer_atomic_add v10, v12, s[4:7], s34 offen
 s_mov_b64 exec, -1
L_vr_ents:
 s_mov_b32 s51, 0
 s_nop 15
 s_nop 15
 s_nop 15
 s_nop 15
 buffer_load_dwordx4 v[40:43], v2, s[4:7], s56 offen offset:0 sc1
 buffer_load_dwordx4 v[44:47], v2, s[4:7], s56 offen offset:128 sc1
 buffer_load_dwordx4 v[48:51], v2, s[4:7], s56 offen offset:1024 sc1
 buffer_load_dwordx4 v[52:55], v2, s[4:7], s56 offen offset:1152 sc1
 buffer_load_dwordx4 v[56:59], v3, s[4:7], s56 offen offset:0 sc1
L_xm_307:
 s_waitcnt vmcnt(4)
 v_mfma_f32_16x16x32_bf16 v[60:63], v[24:27], v[40:43], 0
 s_waitcnt vmcnt(3)
 v_mfma_f32_16x16x32_bf16 v[64:67], v[24:27], v[44:47], 0
 s_waitcnt vmcnt(2)
 v_mfma_f32_16x16x32_bf16 v[68:71], v[24:27], v[48:51], 0
 v_max3_u32 v7, v40, v44, v48
 v_cvt_pk_bf16_f32 v60, v60, v61
 v_cvt_pk_bf16_f32 v61, v62, v63
 ds_write_b64 v4, v[60:61] offset:0
 s_waitcnt vmcnt(1)
 v_mfma_f32_16x16x32_bf16 v[72:75], v[24:27], v[52:55], 0
 v_cvt_pk_bf16_f32 v64, v64, v65
 v_cvt_pk_bf16_f32 v65, v66, v67
 ds_write_b64 v4, v[64:65] offset:8
 s_waitcnt vmcnt(0)
 v_mfma_f32_16x16x32_bf16 v[76:79], v[24:27], v[56:59], 0
 v_max3_u32 v7, v7, v52, v56
 v_cmp_eq_u32 vcc, -1, v7
 v_cvt_pk_bf16_f32 v68, v68, v69
 v_cvt_pk_bf16_f32 v69, v70, v71
 ds_write_b64 v4, v[68:69] offset:1024
 s_cbranch_vccnz L_rt_308
 v_cvt_pk_bf16_f32 v72, v72, v73
 v_cvt_pk_bf16_f32 v73, v74, v75
 ds_write_b64 v4, v[72:73] offset:1032
 s_nop 0
 v_cvt_pk_bf16_f32 v76, v76, v77
 v_cvt_pk_bf16_f32 v77, v78, v79
 ds_write_b64 v5, v[76:77] offset:0
 s_waitcnt lgkmcnt(0)
 s_barrier
 ds_read_b128 v[56:59], v23 offset:0
 ds_read_b128 v[60:63], v23 offset:32
 ds_read_b128 v[64:67], v23 offset:1024
 buffer_load_dword v13, off, s[4:7], s32 sc1
 s_waitcnt lgkmcnt(2)
 v_smfmac_f32_16x16x64_bf16 v[80:83], v[56:59], v[192:199], v8
 ds_read_b128 v[68:71], v23 offset:1056
 v_smfmac_f32_16x16x64_bf16 v[84:87], v[56:59], v[200:207], v8
 ds_read_b128 v[72:75], v23 offset:2048
 s_waitcnt lgkmcnt(3)
 v_smfmac_f32_16x16x64_bf16 v[80:83], v[60:63], v[208:215], v8
 ds_read_b128 v[76:79], v23 offset:2080
 v_smfmac_f32_16x16x64_bf16 v[84:87], v[60:63], v[216:223], v8
 ds_read_b128 v[180:183], v23 offset:3072
 s_waitcnt lgkmcnt(4)
 v_smfmac_f32_16x16x64_bf16 v[80:83], v[64:67], v[224:231], v8
 ds_read_b128 v[148:151], v15 offset:0
 v_smfmac_f32_16x16x64_bf16 v[84:87], v[64:67], v[232:239], v8
 ds_read_b128 v[184:187], v23 offset:3104
 s_waitcnt lgkmcnt(5)
 v_smfmac_f32_16x16x64_bf16 v[80:83], v[68:71], v[240:247], v8
 ds_read_b128 v[152:155], v15 offset:1024
 v_smfmac_f32_16x16x64_bf16 v[84:87], v[68:71], v[248:255], v8
 ds_read_b128 v[56:59], v23 offset:4096
 s_waitcnt lgkmcnt(6)
 v_smfmac_f32_16x16x64_bf16 v[80:83], v[72:75], a[0:7], v8
 ds_read_b128 v[156:159], v15 offset:2048
 v_smfmac_f32_16x16x64_bf16 v[84:87], v[72:75], a[8:15], v8
 ds_read_b128 v[60:63], v23 offset:4128
 s_waitcnt lgkmcnt(7)
 v_smfmac_f32_16x16x64_bf16 v[80:83], v[76:79], a[16:23], v8
 ds_read_b128 v[160:163], v15 offset:3072
 v_smfmac_f32_16x16x64_bf16 v[84:87], v[76:79], a[24:31], v8
 ds_read_b128 v[64:67], v23 offset:5120
 s_waitcnt lgkmcnt(8)
 v_smfmac_f32_16x16x64_bf16 v[80:83], v[180:183], a[32:39], v8
 ds_read_b128 v[164:167], v15 offset:4096
 v_smfmac_f32_16x16x64_bf16 v[84:87], v[180:183], a[40:47], v8
 ds_read_b128 v[68:71], v23 offset:5152
 s_waitcnt lgkmcnt(8)
 v_smfmac_f32_16x16x64_bf16 v[80:83], v[184:187], a[48:55], v8
 ds_read_b128 v[168:171], v15 offset:5120
 v_smfmac_f32_16x16x64_bf16 v[84:87], v[184:187], a[56:63], v8
 ds_read_b128 v[72:75], v23 offset:6144
 s_waitcnt lgkmcnt(8)
 v_smfmac_f32_16x16x64_bf16 v[80:83], v[56:59], a[64:71], v8
 ds_read_b128 v[172:175], v15 offset:6144
 v_smfmac_f32_16x16x64_bf16 v[84:87], v[56:59], a[72:79], v8
 ds_read_b128 v[76:79], v23 offset:6176
 s_waitcnt lgkmcnt(8)
 v_smfmac_f32_16x16x64_bf16 v[80:83], v[60:63], a[80:87], v8
 ds_read_b128 v[176:179], v15 offset:7168
 v_smfmac_f32_16x16x64_bf16 v[84:87], v[60:63], a[88:95], v8
 ds_read_b128 v[180:183], v23 offset:7168
 s_waitcnt lgkmcnt(8)
 v_smfmac_f32_16x16x64_bf16 v[80:83], v[64:67], a[96:103], v8
 ds_read_b128 v[40:43], v14 offset:0
 v_smfmac_f32_16x16x64_bf16 v[84:87], v[64:67], a[104:111], v8
 ds_read_b128 v[184:187], v23 offset:7200
 s_waitcnt lgkmcnt(8)
 v_smfmac_f32_16x16x64_bf16 v[80:83], v[68:71], a[112:119], v8
 ds_read_b128 v[44:47], v14 offset:1024
 v_smfmac_f32_16x16x64_bf16 v[84:87], v[68:71], a[120:127], v8
 ds_read_b128 v[56:59], v23 offset:8192
 s_waitcnt lgkmcnt(8)
 v_smfmac_f32_16x16x64_bf16 v[80:83], v[72:75], a[128:135], v8
 ds_read_b128 v[48:51], v14 offset:2048
 v_smfmac_f32_16x16x64_bf16 v[84:87], v[72:75], a[136:143], v8
 ds_read_b128 v[60:63], v23 offset:8224
 s_waitcnt lgkmcnt(8)
 v_smfmac_f32_16x16x64_bf16 v[80:83], v[76:79], a[144:151], v8
 ds_read_b128 v[52:55], v14 offset:3072
 v_smfmac_f32_16x16x64_bf16 v[84:87], v[76:79], a[152:159], v8
 ds_read_b128 v[64:67], v23 offset:9216
 s_waitcnt lgkmcnt(8)
 v_smfmac_f32_16x16x64_bf16 v[80:83], v[180:183], a[160:167], v8
 v_smfmac_f32_16x16x64_bf16 v[84:87], v[180:183], a[168:175], v8
 ds_read_b128 v[68:71], v23 offset:9248
 s_waitcnt lgkmcnt(7)
 v_smfmac_f32_16x16x64_bf16 v[80:83], v[184:187], a[176:183], v8
 v_smfmac_f32_16x16x64_bf16 v[84:87], v[184:187], a[184:191], v8
 s_waitcnt lgkmcnt(5)
 v_smfmac_f32_16x16x64_bf16 v[80:83], v[56:59], a[192:199], v8
 v_smfmac_f32_16x16x64_bf16 v[84:87], v[56:59], a[200:207], v8
 s_waitcnt lgkmcnt(3)
 v_smfmac_f32_16x16x64_bf16 v[80:83], v[60:63], a[208:215], v8
 v_smfmac_f32_16x16x64_bf16 v[84:87], v[60:63], a[216:223], v8
 s_waitcnt lgkmcnt(1)
 v_smfmac_f32_16x16x64_bf16 v[80:83], v[64:67], a[224:231], v8
 v_smfmac_f32_16x16x64_bf16 v[84:87], v[64:67], a[232:239], v8
 s_waitcnt lgkmcnt(0)
 v_smfmac_f32_16x16x64_bf16 v[80:83], v[68:71], a[240:247], v8
 v_smfmac_f32_16x16x64_bf16 v[84:87], v[68:71], a[248:255], v8
 s_nop 2
 v_cvt_pk_bf16_f32 v116, v80, v81
 v_cvt_pk_bf16_f32 v117, v82, v83
 s_nop 2
 v_cvt_pk_bf16_f32 v118, v84, v85
 v_cvt_pk_bf16_f32 v119, v86, v87
 buffer_store_dwordx4 v[116:119], v18, s[4:7], s60 offen sc1
 ds_write_b128 v16, v[116:119] offset:10240
 buffer_store_dwordx4 v[32:35], v18, s[4:7], s63 offen sc1
 s_waitcnt vmcnt(2)
 v_readfirstlane_b32 s33, v13
 s_add_u32 s76, s53, 1
 s_waitcnt lgkmcnt(1)
 s_cmp_gt_u32 s33, s76
 s_cselect_b32 s33, 1, 0
 s_cselect_b32 s76, s76, 512
 s_lshl_b32 s16, s76, 19
 s_add_u32 s16, s16, s54
 s_xor_b32 s72, s16, 8192
 s_add_u32 s72, s72, s71
 s_add_u32 s16, s16, s70
 v_mfma_f32_16x16x32_bf16 v[100:103], v[148:151], v[40:43], v[108:111]
 s_add_u32 m0, s69, 49152
 s_nop 0
 buffer_load_dwordx4 v1, s[4:7], s16 offen offset:0 sc1 lds
 v_mov_b32 v80, 0
 ds_read_b128 v[56:59], v19 offset:0
 v_mfma_f32_16x16x32_bf16 v[104:107], v[164:167], v[40:43], v[112:115]
 v_mov_b32 v81, 0
 ds_read_b128 v[60:63], v19 offset:1024
 buffer_load_dwordx4 v1, s[4:7], s16 offen offset:1024 sc1 lds
 v_mfma_f32_16x16x32_bf16 v[100:103], v[152:155], v[44:47], v[100:103]
 v_mov_b32 v82, 0
 ds_read_b128 v[64:67], v19 offset:2048
 v_mfma_f32_16x16x32_bf16 v[104:107], v[168:171], v[44:47], v[104:107]
 v_mov_b32 v83, 0
 ds_read_b128 v[68:71], v19 offset:3072
 v_mfma_f32_16x16x32_bf16 v[100:103], v[156:159], v[48:51], v[100:103]
 v_mov_b32 v84, 0
 ds_read_b128 v[72:75], v19 offset:4096
 v_mfma_f32_16x16x32_bf16 v[104:107], v[172:175], v[48:51], v[104:107]
 buffer_load_dwordx4 v1, s[4:7], s16 offen offset:2048 sc1 lds
 v_mov_b32 v85, 0
 ds_read_b128 v[76:79], v19 offset:5120
 v_mfma_f32_16x16x32_bf16 v[100:103], v[160:163], v[52:55], v[100:103]
 v_mov_b32 v86, 0
 ds_read_b128 v[180:183], v19 offset:6144
 buffer_load_dwordx4 v1, s[4:7], s16 offen offset:3072 sc1 lds
 v_mfma_f32_16x16x32_bf16 v[104:107], v[176:179], v[52:55], v[104:107]
 v_mov_b32 v87, 0
 ds_read_b128 v[184:187], v19 offset:7168
 s_waitcnt lgkmcnt(8)
 s_barrier
 s_add_u32 m0, s69, 53248
 s_nop 0
 buffer_load_dwordx4 v6, s[4:7], s16 offen offset:0 sc1 lds
 ds_read_b128 v[140:143], v17 offset:10240
 ds_read_b128 v[144:147], v17 offset:11264
 s_nop 4
 v_cvt_pk_bf16_f32 v7, v100, v101
 v_lshlrev_b32 v100, 16, v7
 buffer_load_dwordx4 v6, s[4:7], s16 offen offset:1024 sc1 lds
 v_and_b32 v101, 0xffff0000, v7
 v_cvt_pk_bf16_f32 v7, v102, v103
 v_lshlrev_b32 v102, 16, v7
 v_and_b32 v103, 0xffff0000, v7
 v_cvt_pk_bf16_f32 v7, v104, v105
 buffer_load_dwordx4 v6, s[4:7], s16 offen offset:2048 sc1 lds
 v_lshlrev_b32 v104, 16, v7
 v_and_b32 v105, 0xffff0000, v7
 v_cvt_pk_bf16_f32 v7, v106, v107
 v_lshlrev_b32 v106, 16, v7
 v_and_b32 v107, 0xffff0000, v7
 buffer_load_dwordx4 v6, s[4:7], s16 offen offset:3072 sc1 lds
 v_pk_mul_f32 v[100:101], v[100:101], s[64:65] op_sel:[0,1] op_sel_hi:[1,1]
 v_pk_mul_f32 v[102:103], v[102:103], s[64:65] op_sel:[0,1] op_sel_hi:[1,1]
 v_pk_mul_f32 v[104:105], v[104:105], s[64:65] op_sel:[0,1] op_sel_hi:[1,1]
 v_pk_mul_f32 v[106:107], v[106:107], s[64:65] op_sel:[0,1] op_sel_hi:[1,1]
 v_cvt_pk_bf16_f32 v7, v100, v101
 v_lshlrev_b32 v100, 16, v7
 v_and_b32 v101, 0xffff0000, v7
 v_cvt_pk_bf16_f32 v7, v102, v103
 v_lshlrev_b32 v102, 16, v7
 v_and_b32 v103, 0xffff0000, v7
 v_cvt_pk_bf16_f32 v7, v104, v105
 v_lshlrev_b32 v104, 16, v7
 v_and_b32 v105, 0xffff0000, v7
 v_cvt_pk_bf16_f32 v7, v106, v107
 v_lshlrev_b32 v106, 16, v7
 v_and_b32 v107, 0xffff0000, v7
 v_max3_f32 v20, v100, v101, v102
 v_max3_f32 v20, v20, v103, v104
 v_max3_f32 v20, v20, v105, v106
 v_max_f32 v20, v20, v107
 v_mov_b32 v22, v20
 s_nop 1
 v_permlane16_swap_b32 v20, v22
 v_max_f32 v20, v20, v22
 v_mov_b32 v22, v20
 s_nop 1
 v_permlane32_swap_b32 v20, v22
 v_max_f32 v20, v20, v22
 v_mul_f32 v22, s66, v20
 v_fma_f32 v100, v100, s66, -v22
 v_fma_f32 v101, v101, s66, -v22
 v_fma_f32 v102, v102, s66, -v22
 v_fma_f32 v103, v103, s66, -v22
 v_fma_f32 v104, v104, s66, -v22
 v_fma_f32 v105, v105, s66, -v22
 v_fma_f32 v106, v106, s66, -v22
 v_fma_f32 v107, v107, s66, -v22
 v_exp_f32 v100, v100
 v_exp_f32 v101, v101
 v_exp_f32 v102, v102
 v_exp_f32 v103, v103
 v_exp_f32 v104, v104
 v_exp_f32 v105, v105
 v_exp_f32 v106, v106
 v_exp_f32 v107, v107
 buffer_load_dwordx4 v[124:127], v1, s[4:7], s60 offen offset:0 sc1
 buffer_load_dwordx4 v[128:131], v1, s[4:7], s60 offen offset:1024 sc1
 buffer_load_dwordx4 v[132:135], v1, s[4:7], s60 offen offset:2048 sc1
 buffer_load_dwordx4 v[136:139], v1, s[4:7], s60 offen offset:3072 sc1
 s_add_u32 m0, s68, 49152
 s_nop 0
 buffer_load_dwordx4 v1, s[4:7], s72 offen offset:0 sc1 nt lds
 buffer_load_dwordx4 v1, s[4:7], s72 offen offset:1024 sc1 nt lds
 buffer_load_dwordx4 v1, s[4:7], s72 offen offset:2048 sc1 nt lds
 buffer_load_dwordx4 v1, s[4:7], s72 offen offset:3072 sc1 nt lds
 v_add_f32 v21, v100, v101
 v_add_f32 v21, v21, v102
 v_add_f32 v21, v21, v103
 v_add_f32 v21, v21, v104
 v_add_f32 v21, v21, v105
 v_add_f32 v21, v21, v106
 v_add_f32 v21, v21, v107
 s_lshl_b32 s76, s53, 19
 s_add_u32 s76, s76, s54
 s_xor_b32 s76, s76, 8192
 s_add_u32 s76, s76, 67108864
 s_add_u32 s53, s53, 1
 s_add_u32 s67, s67, 4
 s_waitcnt vmcnt(4)
L_pk_309:
 v_max3_u32 v7, v124, v128, v132
 v_max_u32 v7, v7, v136
 v_cmp_eq_u32 vcc, -1, v7
 s_cbranch_vccnz L_rt_310
 v_mfma_f32_16x16x32_bf16 v[96:99], v[124:127], v[40:43], 0
 v_mfma_f32_16x16x32_bf16 v[96:99], v[128:131], v[44:47], v[96:99]
 v_mfma_f32_16x16x32_bf16 v[96:99], v[132:135], v[48:51], v[96:99]
 v_mfma_f32_16x16x32_bf16 v[96:99], v[136:139], v[52:55], v[96:99]
 s_nop 7
 v_cvt_pk_bf16_f32 v7, v98, v99
 v_lshlrev_b32 v98, 16, v7
 v_and_b32 v99, 0xffff0000, v7
 v_pk_mul_f32 v[98:99], v[98:99], s[64:65] op_sel:[0,1] op_sel_hi:[1,1]
 v_cvt_pk_bf16_f32 v7, v98, v99
 v_lshlrev_b32 v98, 16, v7
 v_and_b32 v99, 0xffff0000, v7
 v_max3_f32 v96, v98, v99, v20
 v_mov_b32 v22, v96
 s_nop 1
 v_permlane16_swap_b32 v96, v22
 v_max_f32 v96, v96, v22
 v_mov_b32 v22, v96
 s_nop 1
 v_permlane32_swap_b32 v96, v22
 v_max_f32 v96, v96, v22
 v_mul_f32 v96, s66, v96
 v_fma_f32 v28, v20, s66, -v96
 v_fma_f32 v98, v98, s66, -v96
 v_fma_f32 v99, v99, s66, -v96
 v_exp_f32 v28, v28
 v_exp_f32 v98, v98
 v_exp_f32 v99, v99
 s_nop 0
 v_fma_f32 v21, v21, v28, v98
 v_add_f32 v21, v21, v99
 v_mov_b32 v22, v21
 s_nop 1
 v_permlane16_swap_b32 v21, v22
 v_add_f32 v21, v21, v22
 v_mov_b32 v22, v21
 s_nop 1
 v_permlane32_swap_b32 v21, v22
 v_add_f32 v21, v21, v22
 v_rcp_f32 v21, v21
 s_nop 0
 v_mul_f32 v28, v28, v21
 v_pk_mul_f32 v[100:101], v[100:101], v[28:29] op_sel_hi:[1,0]
 v_cvt_pk_bf16_f32 v116, v100, v101
 v_pk_mul_f32 v[102:103], v[102:103], v[28:29] op_sel_hi:[1,0]
 v_cvt_pk_bf16_f32 v117, v102, v103
 v_pk_mul_f32 v[104:105], v[104:105], v[28:29] op_sel_hi:[1,0]
 v_cvt_pk_bf16_f32 v118, v104, v105
 v_pk_mul_f32 v[106:107], v[106:107], v[28:29] op_sel_hi:[1,0]
 v_cvt_pk_bf16_f32 v119, v106, v107
 v_pk_mul_f32 v[98:99], v[98:99], v[20:21] op_sel:[0,1] op_sel_hi:[1,1]
 s_waitcnt lgkmcnt(0)
 v_cvt_pk_bf16_f32 v120, v98, v99
 v_cvt_pk_bf16_f32 v123, v98, v99
 v_mfma_f32_16x16x32_bf16 v[148:151], v[56:59], v[116:119], 0
 v_mfma_f32_16x16x32_bf16 v[152:155], v[60:63], v[116:119], 0
 v_mfma_f32_16x16x16_bf16 v[148:151], v[140:141], v[120:121], v[148:151]
 v_mfma_f32_16x16x32_bf16 v[156:159], v[64:67], v[116:119], 0
 v_mfma_f32_16x16x16_bf16 v[152:155], v[140:141], v[122:123], v[152:155]
 v_mfma_f32_16x16x32_bf16 v[160:163], v[68:71], v[116:119], 0
 v_mfma_f32_16x16x16_bf16 v[156:159], v[142:143], v[120:121], v[156:159]
 v_mfma_f32_16x16x32_bf16 v[164:167], v[72:75], v[116:119], 0
 v_mfma_f32_16x16x16_bf16 v[160:163], v[142:143], v[122:123], v[160:163]
 v_cvt_pk_bf16_f32 v40, v148, v149
 v_cvt_pk_bf16_f32 v41, v150, v151
 v_cvt_pk_bf16_f32 v42, v152, v153
 v_cvt_pk_bf16_f32 v43, v154, v155
 buffer_store_dwordx4 v[40:43], v11, s[4:7], s76 offen offset:0 sc1
 v_mfma_f32_16x16x32_bf16 v[168:171], v[76:79], v[116:119], 0
 v_mfma_f32_16x16x16_bf16 v[164:167], v[144:145], v[120:121], v[164:167]
 v_mfma_f32_16x16x32_bf16 v[172:175], v[180:183], v[116:119], 0
 v_mfma_f32_16x16x16_bf16 v[168:171], v[144:145], v[122:123], v[168:171]
 v_cvt_pk_bf16_f32 v44, v156, v157
 v_cvt_pk_bf16_f32 v45, v158, v159
 v_cvt_pk_bf16_f32 v46, v160, v161
 v_cvt_pk_bf16_f32 v47, v162, v163
 buffer_store_dwordx4 v[44:47], v11, s[4:7], s76 offen offset:2048 sc1
 s_add_u32 s76, s76, 4096
 v_mfma_f32_16x16x32_bf16 v[176:179], v[184:187], v[116:119], 0
 v_mfma_f32_16x16x16_bf16 v[172:175], v[146:147], v[120:121], v[172:175]
 v_mfma_f32_16x16x16_bf16 v[176:179], v[146:147], v[122:123], v[176:179]
 v_cvt_pk_bf16_f32 v48, v164, v165
 v_cvt_pk_bf16_f32 v49, v166, v167
 v_cvt_pk_bf16_f32 v50, v168, v169
 v_cvt_pk_bf16_f32 v51, v170, v171
 buffer_store_dwordx4 v[48:51], v11, s[4:7], s76 offen offset:0 sc1
 v_mov_b32 v7, s53
 s_nop 2
 v_cvt_pk_bf16_f32 v52, v172, v173
 v_cvt_pk_bf16_f32 v53, v174, v175
 v_cvt_pk_bf16_f32 v54, v176, v177
 v_cvt_pk_bf16_f32 v55, v178, v179
 buffer_store_dwordx4 v[52:55], v11, s[4:7], s76 offen offset:2048 sc1
 s_mov_b64 exec, 1
 buffer_store_dword v7, off, s[4:7], s32 offset:8 sc1
 s_mov_b64 exec, -1
 s_mov_b32 s76, s53
 s_mov_b32 s34, s67
 s_cmp_eq_u32 s33, 0
 s_cbranch_scc1 L_nw_311
L_nj_312:
 s_mov_b32 s51, 0
 buffer_load_dword v7, off, s[4:7], s17 sc1
 s_waitcnt vmcnt(0)
L_go_313:
 v_cmp_gt_u32 vcc, s53, v7
 s_cbranch_vccnz L_rt_314
 v_mov_b32 v10, 1
 s_mov_b64 exec, 31
 buffer_atomic_add v10, v12, s[4:7], s34 offen
 s_mov_b64 exec, -1
 s_mov_b32 s51, 0
 s_nop 15
 s_nop 15
 s_nop 15
 s_nop 15
 buffer_load_dwordx4 v[40:43], v2, s[4:7], s57 offen offset:0 sc1
 buffer_load_dwordx4 v[44:47], v2, s[4:7], s57 offen offset:128 sc1
 buffer_load_dwordx4 v[48:51], v2, s[4:7], s57 offen offset:1024 sc1
 buffer_load_dwordx4 v[52:55], v2, s[4:7], s57 offen offset:1152 sc1
 buffer_load_dwordx4 v[56:59], v3, s[4:7], s57 offen offset:0 sc1
L_xm_315:
 s_waitcnt vmcnt(4)
 v_mfma_f32_16x16x32_bf16 v[60:63], v[24:27], v[40:43], 0
 s_waitcnt vmcnt(3)
 v_mfma_f32_16x16x32_bf16 v[64:67], v[24:27], v[44:47], 0
 s_waitcnt vmcnt(2)
 v_mfma_f32_16x16x32_bf16 v[68:71], v[24:27], v[48:51], 0
 v_max3_u32 v7, v40, v44, v48
 v_cvt_pk_bf16_f32 v60, v60, v61
 v_cvt_pk_bf16_f32 v61, v62, v63
 ds_write_b64 v4, v[60:61] offset:0
 s_waitcnt vmcnt(1)
 v_mfma_f32_16x16x32_bf16 v[72:75], v[24:27], v[52:55], 0
 v_cvt_pk_bf16_f32 v64, v64, v65
 v_cvt_pk_bf16_f32 v65, v66, v67
 ds_write_b64 v4, v[64:65] offset:8
 s_waitcnt vmcnt(0)
 v_mfma_f32_16x16x32_bf16 v[76:79], v[24:27], v[56:59], 0
 v_max3_u32 v7, v7, v52, v56
 v_cmp_eq_u32 vcc, -1, v7
 v_cvt_pk_bf16_f32 v68, v68, v69
 v_cvt_pk_bf16_f32 v69, v70, v71
 ds_write_b64 v4, v[68:69] offset:1024
 s_cbranch_vccnz L_rt_316
 v_cvt_pk_bf16_f32 v72, v72, v73
 v_cvt_pk_bf16_f32 v73, v74, v75
 ds_write_b64 v4, v[72:73] offset:1032
 s_nop 0
 v_cvt_pk_bf16_f32 v76, v76, v77
 v_cvt_pk_bf16_f32 v77, v78, v79
 ds_write_b64 v5, v[76:77] offset:0
 s_waitcnt lgkmcnt(0)
 s_barrier
 ds_read_b128 v[56:59], v23 offset:0
 ds_read_b128 v[60:63], v23 offset:32
 ds_read_b128 v[64:67], v23 offset:1024
 buffer_load_dword v13, off, s[4:7], s32 sc1
 s_waitcnt lgkmcnt(2)
 v_smfmac_f32_16x16x64_bf16 v[80:83], v[56:59], v[192:199], v8
 ds_read_b128 v[68:71], v23 offset:1056
 v_smfmac_f32_16x16x64_bf16 v[84:87], v[56:59], v[200:207], v8
 ds_read_b128 v[72:75], v23 offset:2048
 s_waitcnt lgkmcnt(3)
 v_smfmac_f32_16x16x64_bf16 v[80:83], v[60:63], v[208:215], v8
 ds_read_b128 v[76:79], v23 offset:2080
 v_smfmac_f32_16x16x64_bf16 v[84:87], v[60:63], v[216:223], v8
 ds_read_b128 v[180:183], v23 offset:3072
 s_waitcnt lgkmcnt(4)
 v_smfmac_f32_16x16x64_bf16 v[80:83], v[64:67], v[224:231], v8
 ds_read_b128 v[148:151], v15 offset:49152
 v_smfmac_f32_16x16x64_bf16 v[84:87], v[64:67], v[232:239], v8
 ds_read_b128 v[184:187], v23 offset:3104
 s_waitcnt lgkmcnt(5)
 v_smfmac_f32_16x16x64_bf16 v[80:83], v[68:71], v[240:247], v8
 ds_read_b128 v[152:155], v15 offset:50176
 v_smfmac_f32_16x16x64_bf16 v[84:87], v[68:71], v[248:255], v8
 ds_read_b128 v[56:59], v23 offset:4096
 s_waitcnt lgkmcnt(6)
 v_smfmac_f32_16x16x64_bf16 v[80:83], v[72:75], a[0:7], v8
 ds_read_b128 v[156:159], v15 offset:51200
 v_smfmac_f32_16x16x64_bf16 v[84:87], v[72:75], a[8:15], v8
 ds_read_b128 v[60:63], v23 offset:4128
 s_waitcnt lgkmcnt(7)
 v_smfmac_f32_16x16x64_bf16 v[80:83], v[76:79], a[16:23], v8
 ds_read_b128 v[160:163], v15 offset:52224
 v_smfmac_f32_16x16x64_bf16 v[84:87], v[76:79], a[24:31], v8
 ds_read_b128 v[64:67], v23 offset:5120
 s_waitcnt lgkmcnt(8)
 v_smfmac_f32_16x16x64_bf16 v[80:83], v[180:183], a[32:39], v8
 ds_read_b128 v[164:167], v15 offset:53248
 v_smfmac_f32_16x16x64_bf16 v[84:87], v[180:183], a[40:47], v8
 ds_read_b128 v[68:71], v23 offset:5152
 s_waitcnt lgkmcnt(8)
 v_smfmac_f32_16x16x64_bf16 v[80:83], v[184:187], a[48:55], v8
 ds_read_b128 v[168:171], v15 offset:54272
 v_smfmac_f32_16x16x64_bf16 v[84:87], v[184:187], a[56:63], v8
 ds_read_b128 v[72:75], v23 offset:6144
 s_waitcnt lgkmcnt(8)
 v_smfmac_f32_16x16x64_bf16 v[80:83], v[56:59], a[64:71], v8
 ds_read_b128 v[172:175], v15 offset:55296
 v_smfmac_f32_16x16x64_bf16 v[84:87], v[56:59], a[72:79], v8
 ds_read_b128 v[76:79], v23 offset:6176
 s_waitcnt lgkmcnt(8)
 v_smfmac_f32_16x16x64_bf16 v[80:83], v[60:63], a[80:87], v8
 ds_read_b128 v[176:179], v15 offset:56320
 v_smfmac_f32_16x16x64_bf16 v[84:87], v[60:63], a[88:95], v8
 ds_read_b128 v[180:183], v23 offset:7168
 s_waitcnt lgkmcnt(8)
 v_smfmac_f32_16x16x64_bf16 v[80:83], v[64:67], a[96:103], v8
 ds_read_b128 v[40:43], v14 offset:49152
 v_smfmac_f32_16x16x64_bf16 v[84:87], v[64:67], a[104:111], v8
 ds_read_b128 v[184:187], v23 offset:7200
 s_waitcnt lgkmcnt(8)
 v_smfmac_f32_16x16x64_bf16 v[80:83], v[68:71], a[112:119], v8
 ds_read_b128 v[44:47], v14 offset:50176
 v_smfmac_f32_16x16x64_bf16 v[84:87], v[68:71], a[120:127], v8
 ds_read_b128 v[56:59], v23 offset:8192
 s_waitcnt lgkmcnt(8)
 v_smfmac_f32_16x16x64_bf16 v[80:83], v[72:75], a[128:135], v8
 ds_read_b128 v[48:51], v14 offset:51200
 v_smfmac_f32_16x16x64_bf16 v[84:87], v[72:75], a[136:143], v8
 ds_read_b128 v[60:63], v23 offset:8224
 s_waitcnt lgkmcnt(8)
 v_smfmac_f32_16x16x64_bf16 v[80:83], v[76:79], a[144:151], v8
 ds_read_b128 v[52:55], v14 offset:52224
 v_smfmac_f32_16x16x64_bf16 v[84:87], v[76:79], a[152:159], v8
 ds_read_b128 v[64:67], v23 offset:9216
 s_waitcnt lgkmcnt(8)
 v_smfmac_f32_16x16x64_bf16 v[80:83], v[180:183], a[160:167], v8
 v_smfmac_f32_16x16x64_bf16 v[84:87], v[180:183], a[168:175], v8
 ds_read_b128 v[68:71], v23 offset:9248
 s_waitcnt lgkmcnt(7)
 v_smfmac_f32_16x16x64_bf16 v[80:83], v[184:187], a[176:183], v8
 v_smfmac_f32_16x16x64_bf16 v[84:87], v[184:187], a[184:191], v8
 s_waitcnt lgkmcnt(5)
 v_smfmac_f32_16x16x64_bf16 v[80:83], v[56:59], a[192:199], v8
 v_smfmac_f32_16x16x64_bf16 v[84:87], v[56:59], a[200:207], v8
 s_waitcnt lgkmcnt(3)
 v_smfmac_f32_16x16x64_bf16 v[80:83], v[60:63], a[208:215], v8
 v_smfmac_f32_16x16x64_bf16 v[84:87], v[60:63], a[216:223], v8
 s_waitcnt lgkmcnt(1)
 v_smfmac_f32_16x16x64_bf16 v[80:83], v[64:67], a[224:231], v8
 v_smfmac_f32_16x16x64_bf16 v[84:87], v[64:67], a[232:239], v8
 s_waitcnt lgkmcnt(0)
 v_smfmac_f32_16x16x64_bf16 v[80:83], v[68:71], a[240:247], v8
 v_smfmac_f32_16x16x64_bf16 v[84:87], v[68:71], a[248:255], v8
 s_nop 2
 v_cvt_pk_bf16_f32 v116, v80, v81
 v_cvt_pk_bf16_f32 v117, v82, v83
 s_nop 2
 v_cvt_pk_bf16_f32 v118, v84, v85
 v_cvt_pk_bf16_f32 v119, v86, v87
 buffer_store_dwordx4 v[116:119], v18, s[4:7], s61 offen sc1
 ds_write_b128 v16, v[116:119] offset:10240
 buffer_store_dwordx4 v[32:35], v18, s[4:7], s60 offen sc1
 s_waitcnt vmcnt(2)
 v_readfirstlane_b32 s33, v13
 s_add_u32 s76, s53, 1
 s_waitcnt lgkmcnt(1)
 s_cmp_gt_u32 s33, s76
 s_cselect_b32 s33, 1, 0
 s_cselect_b32 s76, s76, 512
 s_lshl_b32 s16, s76, 19
 s_add_u32 s16, s16, s54
 s_xor_b32 s72, s16, 8192
 s_add_u32 s72, s72, s71
 s_add_u32 s16, s16, s70
 v_mfma_f32_16x16x32_bf16 v[100:103], v[148:151], v[40:43], v[108:111]
 s_add_u32 m0, s69, 0
 s_nop 0
 buffer_load_dwordx4 v1, s[4:7], s16 offen offset:0 sc1 lds
 v_mov_b32 v80, 0
 ds_read_b128 v[56:59], v19 offset:49152
 v_mfma_f32_16x16x32_bf16 v[104:107], v[164:167], v[40:43], v[112:115]
 v_mov_b32 v81, 0
 ds_read_b128 v[60:63], v19 offset:50176
 buffer_load_dwordx4 v1, s[4:7], s16 offen offset:1024 sc1 lds
 v_mfma_f32_16x16x32_bf16 v[100:103], v[152:155], v[44:47], v[100:103]
 v_mov_b32 v82, 0
 ds_read_b128 v[64:67], v19 offset:51200
 v_mfma_f32_16x16x32_bf16 v[104:107], v[168:171], v[44:47], v[104:107]
 v_mov_b32 v83, 0
 ds_read_b128 v[68:71], v19 offset:52224
 v_mfma_f32_16x16x32_bf16 v[100:103], v[156:159], v[48:51], v[100:103]
 v_mov_b32 v84, 0
 ds_read_b128 v[72:75], v19 offset:53248
 v_mfma_f32_16x16x32_bf16 v[104:107], v[172:175], v[48:51], v[104:107]
 buffer_load_dwordx4 v1, s[4:7], s16 offen offset:2048 sc1 lds
 v_mov_b32 v85, 0
 ds_read_b128 v[76:79], v19 offset:54272
 v_mfma_f32_16x16x32_bf16 v[100:103], v[160:163], v[52:55], v[100:103]
 v_mov_b32 v86, 0
 ds_read_b128 v[180:183], v19 offset:55296
 buffer_load_dwordx4 v1, s[4:7], s16 offen offset:3072 sc1 lds
 v_mfma_f32_16x16x32_bf16 v[104:107], v[176:179], v[52:55], v[104:107]
 v_mov_b32 v87, 0
 ds_read_b128 v[184:187], v19 offset:56320
 s_waitcnt lgkmcnt(8)
 s_barrier
 s_add_u32 m0, s69, 4096
 s_nop 0
 buffer_load_dwordx4 v6, s[4:7], s16 offen offset:0 sc1 lds
 ds_read_b128 v[140:143], v17 offset:10240
 ds_read_b128 v[144:147], v17 offset:11264
 s_nop 4
 v_cvt_pk_bf16_f32 v7, v100, v101
 v_lshlrev_b32 v100, 16, v7
 buffer_load_dwordx4 v6, s[4:7], s16 offen offset:1024 sc1 lds
 v_and_b32 v101, 0xffff0000, v7
 v_cvt_pk_bf16_f32 v7, v102, v103
 v_lshlrev_b32 v102, 16, v7
 v_and_b32 v103, 0xffff0000, v7
 v_cvt_pk_bf16_f32 v7, v104, v105
 buffer_load_dwordx4 v6, s[4:7], s16 offen offset:2048 sc1 lds
 v_lshlrev_b32 v104, 16, v7
 v_and_b32 v105, 0xffff0000, v7
 v_cvt_pk_bf16_f32 v7, v106, v107
 v_lshlrev_b32 v106, 16, v7
 v_and_b32 v107, 0xffff0000, v7
 buffer_load_dwordx4 v6, s[4:7], s16 offen offset:3072 sc1 lds
 v_pk_mul_f32 v[100:101], v[100:101], s[64:65] op_sel:[0,1] op_sel_hi:[1,1]
 v_pk_mul_f32 v[102:103], v[102:103], s[64:65] op_sel:[0,1] op_sel_hi:[1,1]
 v_pk_mul_f32 v[104:105], v[104:105], s[64:65] op_sel:[0,1] op_sel_hi:[1,1]
 v_pk_mul_f32 v[106:107], v[106:107], s[64:65] op_sel:[0,1] op_sel_hi:[1,1]
 v_cvt_pk_bf16_f32 v7, v100, v101
 v_lshlrev_b32 v100, 16, v7
 v_and_b32 v101, 0xffff0000, v7
 v_cvt_pk_bf16_f32 v7, v102, v103
 v_lshlrev_b32 v102, 16, v7
 v_and_b32 v103, 0xffff0000, v7
 v_cvt_pk_bf16_f32 v7, v104, v105
 v_lshlrev_b32 v104, 16, v7
 v_and_b32 v105, 0xffff0000, v7
 v_cvt_pk_bf16_f32 v7, v106, v107
 v_lshlrev_b32 v106, 16, v7
 v_and_b32 v107, 0xffff0000, v7
 v_max3_f32 v20, v100, v101, v102
 v_max3_f32 v20, v20, v103, v104
 v_max3_f32 v20, v20, v105, v106
 v_max_f32 v20, v20, v107
 v_mov_b32 v22, v20
 s_nop 1
 v_permlane16_swap_b32 v20, v22
 v_max_f32 v20, v20, v22
 v_mov_b32 v22, v20
 s_nop 1
 v_permlane32_swap_b32 v20, v22
 v_max_f32 v20, v20, v22
 v_mul_f32 v22, s66, v20
 v_fma_f32 v100, v100, s66, -v22
 v_fma_f32 v101, v101, s66, -v22
 v_fma_f32 v102, v102, s66, -v22
 v_fma_f32 v103, v103, s66, -v22
 v_fma_f32 v104, v104, s66, -v22
 v_fma_f32 v105, v105, s66, -v22
 v_fma_f32 v106, v106, s66, -v22
 v_fma_f32 v107, v107, s66, -v22
 v_exp_f32 v100, v100
 v_exp_f32 v101, v101
 v_exp_f32 v102, v102
 v_exp_f32 v103, v103
 v_exp_f32 v104, v104
 v_exp_f32 v105, v105
 v_exp_f32 v106, v106
 v_exp_f32 v107, v107
 buffer_load_dwordx4 v[124:127], v1, s[4:7], s61 offen offset:0 sc1
 buffer_load_dwordx4 v[128:131], v1, s[4:7], s61 offen offset:1024 sc1
 buffer_load_dwordx4 v[132:135], v1, s[4:7], s61 offen offset:2048 sc1
 buffer_load_dwordx4 v[136:139], v1, s[4:7], s61 offen offset:3072 sc1
 s_add_u32 m0, s68, 0
 s_nop 0
 buffer_load_dwordx4 v1, s[4:7], s72 offen offset:0 sc1 nt lds
 buffer_load_dwordx4 v1, s[4:7], s72 offen offset:1024 sc1 nt lds
 buffer_load_dwordx4 v1, s[4:7], s72 offen offset:2048 sc1 nt lds
 buffer_load_dwordx4 v1, s[4:7], s72 offen offset:3072 sc1 nt lds
 v_add_f32 v21, v100, v101
 v_add_f32 v21, v21, v102
 v_add_f32 v21, v21, v103
 v_add_f32 v21, v21, v104
 v_add_f32 v21, v21, v105
 v_add_f32 v21, v21, v106
 v_add_f32 v21, v21, v107
 s_lshl_b32 s76, s53, 19
 s_add_u32 s76, s76, s54
 s_xor_b32 s76, s76, 8192
 s_add_u32 s76, s76, 67108864
 s_add_u32 s53, s53, 1
 s_add_u32 s67, s67, 4
 s_waitcnt vmcnt(4)
L_pk_317:
 v_max3_u32 v7, v124, v128, v132
 v_max_u32 v7, v7, v136
 v_cmp_eq_u32 vcc, -1, v7
 s_cbranch_vccnz L_rt_318
 v_mfma_f32_16x16x32_bf16 v[96:99], v[124:127], v[40:43], 0
 v_mfma_f32_16x16x32_bf16 v[96:99], v[128:131], v[44:47], v[96:99]
 v_mfma_f32_16x16x32_bf16 v[96:99], v[132:135], v[48:51], v[96:99]
 v_mfma_f32_16x16x32_bf16 v[96:99], v[136:139], v[52:55], v[96:99]
 s_nop 7
 v_cvt_pk_bf16_f32 v7, v98, v99
 v_lshlrev_b32 v98, 16, v7
 v_and_b32 v99, 0xffff0000, v7
 v_pk_mul_f32 v[98:99], v[98:99], s[64:65] op_sel:[0,1] op_sel_hi:[1,1]
 v_cvt_pk_bf16_f32 v7, v98, v99
 v_lshlrev_b32 v98, 16, v7
 v_and_b32 v99, 0xffff0000, v7
 v_max3_f32 v96, v98, v99, v20
 v_mov_b32 v22, v96
 s_nop 1
 v_permlane16_swap_b32 v96, v22
 v_max_f32 v96, v96, v22
 v_mov_b32 v22, v96
 s_nop 1
 v_permlane32_swap_b32 v96, v22
 v_max_f32 v96, v96, v22
 v_mul_f32 v96, s66, v96
 v_fma_f32 v28, v20, s66, -v96
 v_fma_f32 v98, v98, s66, -v96
 v_fma_f32 v99, v99, s66, -v96
 v_exp_f32 v28, v28
 v_exp_f32 v98, v98
 v_exp_f32 v99, v99
 s_nop 0
 v_fma_f32 v21, v21, v28, v98
 v_add_f32 v21, v21, v99
 v_mov_b32 v22, v21
 s_nop 1
 v_permlane16_swap_b32 v21, v22
 v_add_f32 v21, v21, v22
 v_mov_b32 v22, v21
 s_nop 1
 v_permlane32_swap_b32 v21, v22
 v_add_f32 v21, v21, v22
 v_rcp_f32 v21, v21
 s_nop 0
 v_mul_f32 v28, v28, v21
 v_pk_mul_f32 v[100:101], v[100:101], v[28:29] op_sel_hi:[1,0]
 v_cvt_pk_bf16_f32 v116, v100, v101
 v_pk_mul_f32 v[102:103], v[102:103], v[28:29] op_sel_hi:[1,0]
 v_cvt_pk_bf16_f32 v117, v102, v103
 v_pk_mul_f32 v[104:105], v[104:105], v[28:29] op_sel_hi:[1,0]
 v_cvt_pk_bf16_f32 v118, v104, v105
 v_pk_mul_f32 v[106:107], v[106:107], v[28:29] op_sel_hi:[1,0]
 v_cvt_pk_bf16_f32 v119, v106, v107
 v_pk_mul_f32 v[98:99], v[98:99], v[20:21] op_sel:[0,1] op_sel_hi:[1,1]
 s_waitcnt lgkmcnt(0)
 v_cvt_pk_bf16_f32 v120, v98, v99
 v_cvt_pk_bf16_f32 v123, v98, v99
 v_mfma_f32_16x16x32_bf16 v[148:151], v[56:59], v[116:119], 0
 v_mfma_f32_16x16x32_bf16 v[152:155], v[60:63], v[116:119], 0
 v_mfma_f32_16x16x16_bf16 v[148:151], v[140:141], v[120:121], v[148:151]
 v_mfma_f32_16x16x32_bf16 v[156:159], v[64:67], v[116:119], 0
 v_mfma_f32_16x16x16_bf16 v[152:155], v[140:141], v[122:123], v[152:155]
 v_mfma_f32_16x16x32_bf16 v[160:163], v[68:71], v[116:119], 0
 v_mfma_f32_16x16x16_bf16 v[156:159], v[142:143], v[120:121], v[156:159]
 v_mfma_f32_16x16x32_bf16 v[164:167], v[72:75], v[116:119], 0
 v_mfma_f32_16x16x16_bf16 v[160:163], v[142:143], v[122:123], v[160:163]
 v_cvt_pk_bf16_f32 v40, v148, v149
 v_cvt_pk_bf16_f32 v41, v150, v151
 v_cvt_pk_bf16_f32 v42, v152, v153
 v_cvt_pk_bf16_f32 v43, v154, v155
 buffer_store_dwordx4 v[40:43], v11, s[4:7], s76 offen offset:0 sc1
 v_mfma_f32_16x16x32_bf16 v[168:171], v[76:79], v[116:119], 0
 v_mfma_f32_16x16x16_bf16 v[164:167], v[144:145], v[120:121], v[164:167]
 v_mfma_f32_16x16x32_bf16 v[172:175], v[180:183], v[116:119], 0
 v_mfma_f32_16x16x16_bf16 v[168:171], v[144:145], v[122:123], v[168:171]
 v_cvt_pk_bf16_f32 v44, v156, v157
 v_cvt_pk_bf16_f32 v45, v158, v159
 v_cvt_pk_bf16_f32 v46, v160, v161
 v_cvt_pk_bf16_f32 v47, v162, v163
 buffer_store_dwordx4 v[44:47], v11, s[4:7], s76 offen offset:2048 sc1
 s_add_u32 s76, s76, 4096
 v_mfma_f32_16x16x32_bf16 v[176:179], v[184:187], v[116:119], 0
 v_mfma_f32_16x16x16_bf16 v[172:175], v[146:147], v[120:121], v[172:175]
 v_mfma_f32_16x16x16_bf16 v[176:179], v[146:147], v[122:123], v[176:179]
 v_cvt_pk_bf16_f32 v48, v164, v165
 v_cvt_pk_bf16_f32 v49, v166, v167
 v_cvt_pk_bf16_f32 v50, v168, v169
 v_cvt_pk_bf16_f32 v51, v170, v171
 buffer_store_dwordx4 v[48:51], v11, s[4:7], s76 offen offset:0 sc1
 v_mov_b32 v7, s53
 s_nop 2
 v_cvt_pk_bf16_f32 v52, v172, v173
 v_cvt_pk_bf16_f32 v53, v174, v175
 v_cvt_pk_bf16_f32 v54, v176, v177
 v_cvt_pk_bf16_f32 v55, v178, v179
 buffer_store_dwordx4 v[52:55], v11, s[4:7], s76 offen offset:2048 sc1
 s_mov_b64 exec, 1
 buffer_store_dword v7, off, s[4:7], s32 offset:8 sc1
 s_mov_b64 exec, -1
 s_mov_b32 s76, s53
 s_mov_b32 s34, s67
 s_cmp_eq_u32 s33, 0
 s_cbranch_scc1 L_nw_319
L_nj_320:
 s_mov_b32 s51, 0
 buffer_load_dword v7, off, s[4:7], s17 sc1
 s_waitcnt vmcnt(0)
L_go_321:
 v_cmp_gt_u32 vcc, s53, v7
 s_cbranch_vccnz L_rt_322
 v_mov_b32 v10, 1
 s_mov_b64 exec, 31
 buffer_atomic_add v10, v12, s[4:7], s34 offen
 s_mov_b64 exec, -1
 s_mov_b32 s51, 0
 s_nop 15
 s_nop 15
 s_nop 15
 s_nop 15
 buffer_load_dwordx4 v[40:43], v2, s[4:7], s58 offen offset:0 sc1
 buffer_load_dwordx4 v[44:47], v2, s[4:7], s58 offen offset:128 sc1
 buffer_load_dwordx4 v[48:51], v2, s[4:7], s58 offen offset:1024 sc1
 buffer_load_dwordx4 v[52:55], v2, s[4:7], s58 offen offset:1152 sc1
 buffer_load_dwordx4 v[56:59], v3, s[4:7], s58 offen offset:0 sc1
L_xm_323:
 s_waitcnt vmcnt(4)
 v_mfma_f32_16x16x32_bf16 v[60:63], v[24:27], v[40:43], 0
 s_waitcnt vmcnt(3)
 v_mfma_f32_16x16x32_bf16 v[64:67], v[24:27], v[44:47], 0
 s_waitcnt vmcnt(2)
 v_mfma_f32_16x16x32_bf16 v[68:71], v[24:27], v[48:51], 0
 v_max3_u32 v7, v40, v44, v48
 v_cvt_pk_bf16_f32 v60, v60, v61
 v_cvt_pk_bf16_f32 v61, v62, v63
 ds_write_b64 v4, v[60:61] offset:0
 s_waitcnt vmcnt(1)
 v_mfma_f32_16x16x32_bf16 v[72:75], v[24:27], v[52:55], 0
 v_cvt_pk_bf16_f32 v64, v64, v65
 v_cvt_pk_bf16_f32 v65, v66, v67
 ds_write_b64 v4, v[64:65] offset:8
 s_waitcnt vmcnt(0)
 v_mfma_f32_16x16x32_bf16 v[76:79], v[24:27], v[56:59], 0
 v_max3_u32 v7, v7, v52, v56
 v_cmp_eq_u32 vcc, -1, v7
 v_cvt_pk_bf16_f32 v68, v68, v69
 v_cvt_pk_bf16_f32 v69, v70, v71
 ds_write_b64 v4, v[68:69] offset:1024
 s_cbranch_vccnz L_rt_324
 v_cvt_pk_bf16_f32 v72, v72, v73
 v_cvt_pk_bf16_f32 v73, v74, v75
 ds_write_b64 v4, v[72:73] offset:1032
 s_nop 0
 v_cvt_pk_bf16_f32 v76, v76, v77
 v_cvt_pk_bf16_f32 v77, v78, v79
 ds_write_b64 v5, v[76:77] offset:0
 s_waitcnt lgkmcnt(0)
 s_barrier
 ds_read_b128 v[56:59], v23 offset:0
 ds_read_b128 v[60:63], v23 offset:32
 ds_read_b128 v[64:67], v23 offset:1024
 buffer_load_dword v13, off, s[4:7], s32 sc1
 s_waitcnt lgkmcnt(2)
 v_smfmac_f32_16x16x64_bf16 v[80:83], v[56:59], v[192:199], v8
 ds_read_b128 v[68:71], v23 offset:1056
 v_smfmac_f32_16x16x64_bf16 v[84:87], v[56:59], v[200:207], v8
 ds_read_b128 v[72:75], v23 offset:2048
 s_waitcnt lgkmcnt(3)
 v_smfmac_f32_16x16x64_bf16 v[80:83], v[60:63], v[208:215], v8
 ds_read_b128 v[76:79], v23 offset:2080
 v_smfmac_f32_16x16x64_bf16 v[84:87], v[60:63], v[216:223], v8
 ds_read_b128 v[180:183], v23 offset:3072
 s_waitcnt lgkmcnt(4)
 v_smfmac_f32_16x16x64_bf16 v[80:83], v[64:67], v[224:231], v8
 ds_read_b128 v[148:151], v15 offset:0
 v_smfmac_f32_16x16x64_bf16 v[84:87], v[64:67], v[232:239], v8
 ds_read_b128 v[184:187], v23 offset:3104
 s_waitcnt lgkmcnt(5)
 v_smfmac_f32_16x16x64_bf16 v[80:83], v[68:71], v[240:247], v8
 ds_read_b128 v[152:155], v15 offset:1024
 v_smfmac_f32_16x16x64_bf16 v[84:87], v[68:71], v[248:255], v8
 ds_read_b128 v[56:59], v23 offset:4096
 s_waitcnt lgkmcnt(6)
 v_smfmac_f32_16x16x64_bf16 v[80:83], v[72:75], a[0:7], v8
 ds_read_b128 v[156:159], v15 offset:2048
 v_smfmac_f32_16x16x64_bf16 v[84:87], v[72:75], a[8:15], v8
 ds_read_b128 v[60:63], v23 offset:4128
 s_waitcnt lgkmcnt(7)
 v_smfmac_f32_16x16x64_bf16 v[80:83], v[76:79], a[16:23], v8
 ds_read_b128 v[160:163], v15 offset:3072
 v_smfmac_f32_16x16x64_bf16 v[84:87], v[76:79], a[24:31], v8
 ds_read_b128 v[64:67], v23 offset:5120
 s_waitcnt lgkmcnt(8)
 v_smfmac_f32_16x16x64_bf16 v[80:83], v[180:183], a[32:39], v8
 ds_read_b128 v[164:167], v15 offset:4096
 v_smfmac_f32_16x16x64_bf16 v[84:87], v[180:183], a[40:47], v8
 ds_read_b128 v[68:71], v23 offset:5152
 s_waitcnt lgkmcnt(8)
 v_smfmac_f32_16x16x64_bf16 v[80:83], v[184:187], a[48:55], v8
 ds_read_b128 v[168:171], v15 offset:5120
 v_smfmac_f32_16x16x64_bf16 v[84:87], v[184:187], a[56:63], v8
 ds_read_b128 v[72:75], v23 offset:6144
 s_waitcnt lgkmcnt(8)
 v_smfmac_f32_16x16x64_bf16 v[80:83], v[56:59], a[64:71], v8
 ds_read_b128 v[172:175], v15 offset:6144
 v_smfmac_f32_16x16x64_bf16 v[84:87], v[56:59], a[72:79], v8
 ds_read_b128 v[76:79], v23 offset:6176
 s_waitcnt lgkmcnt(8)
 v_smfmac_f32_16x16x64_bf16 v[80:83], v[60:63], a[80:87], v8
 ds_read_b128 v[176:179], v15 offset:7168
 v_smfmac_f32_16x16x64_bf16 v[84:87], v[60:63], a[88:95], v8
 ds_read_b128 v[180:183], v23 offset:7168
 s_waitcnt lgkmcnt(8)
 v_smfmac_f32_16x16x64_bf16 v[80:83], v[64:67], a[96:103], v8
 ds_read_b128 v[40:43], v14 offset:0
 v_smfmac_f32_16x16x64_bf16 v[84:87], v[64:67], a[104:111], v8
 ds_read_b128 v[184:187], v23 offset:7200
 s_waitcnt lgkmcnt(8)
 v_smfmac_f32_16x16x64_bf16 v[80:83], v[68:71], a[112:119], v8
 ds_read_b128 v[44:47], v14 offset:1024
 v_smfmac_f32_16x16x64_bf16 v[84:87], v[68:71], a[120:127], v8
 ds_read_b128 v[56:59], v23 offset:8192
 s_waitcnt lgkmcnt(8)
 v_smfmac_f32_16x16x64_bf16 v[80:83], v[72:75], a[128:135], v8
 ds_read_b128 v[48:51], v14 offset:2048
 v_smfmac_f32_16x16x64_bf16 v[84:87], v[72:75], a[136:143], v8
 ds_read_b128 v[60:63], v23 offset:8224
 s_waitcnt lgkmcnt(8)
 v_smfmac_f32_16x16x64_bf16 v[80:83], v[76:79], a[144:151], v8
 ds_read_b128 v[52:55], v14 offset:3072
 v_smfmac_f32_16x16x64_bf16 v[84:87], v[76:79], a[152:159], v8
 ds_read_b128 v[64:67], v23 offset:9216
 s_waitcnt lgkmcnt(8)
 v_smfmac_f32_16x16x64_bf16 v[80:83], v[180:183], a[160:167], v8
 v_smfmac_f32_16x16x64_bf16 v[84:87], v[180:183], a[168:175], v8
 ds_read_b128 v[68:71], v23 offset:9248
 s_waitcnt lgkmcnt(7)
 v_smfmac_f32_16x16x64_bf16 v[80:83], v[184:187], a[176:183], v8
 v_smfmac_f32_16x16x64_bf16 v[84:87], v[184:187], a[184:191], v8
 s_waitcnt lgkmcnt(5)
 v_smfmac_f32_16x16x64_bf16 v[80:83], v[56:59], a[192:199], v8
 v_smfmac_f32_16x16x64_bf16 v[84:87], v[56:59], a[200:207], v8
 s_waitcnt lgkmcnt(3)
 v_smfmac_f32_16x16x64_bf16 v[80:83], v[60:63], a[208:215], v8
 v_smfmac_f32_16x16x64_bf16 v[84:87], v[60:63], a[216:223], v8
 s_waitcnt lgkmcnt(1)
 v_smfmac_f32_16x16x64_bf16 v[80:83], v[64:67], a[224:231], v8
 v_smfmac_f32_16x16x64_bf16 v[84:87], v[64:67], a[232:239], v8
 s_waitcnt lgkmcnt(0)
 v_smfmac_f32_16x16x64_bf16 v[80:83], v[68:71], a[240:247], v8
 v_smfmac_f32_16x16x64_bf16 v[84:87], v[68:71], a[248:255], v8
 s_nop 2
 v_cvt_pk_bf16_f32 v116, v80, v81
 v_cvt_pk_bf16_f32 v117, v82, v83
 s_nop 2
 v_cvt_pk_bf16_f32 v118, v84, v85
 v_cvt_pk_bf16_f32 v119, v86, v87
 buffer_store_dwordx4 v[116:119], v18, s[4:7], s62 offen sc1
 ds_write_b128 v16, v[116:119] offset:10240
 buffer_store_dwordx4 v[32:35], v18, s[4:7], s61 offen sc1
 s_waitcnt vmcnt(2)
 v_readfirstlane_b32 s33, v13
 s_add_u32 s76, s53, 1
 s_waitcnt lgkmcnt(1)
 s_cmp_gt_u32 s33, s76
 s_cselect_b32 s33, 1, 0
 s_cselect_b32 s76, s76, 512
 s_lshl_b32 s16, s76, 19
 s_add_u32 s16, s16, s54
 s_xor_b32 s72, s16, 8192
 s_add_u32 s72, s72, s71
 s_add_u32 s16, s16, s70
 v_mfma_f32_16x16x32_bf16 v[100:103], v[148:151], v[40:43], v[108:111]
 s_add_u32 m0, s69, 49152
 s_nop 0
 buffer_load_dwordx4 v1, s[4:7], s16 offen offset:0 sc1 lds
 v_mov_b32 v80, 0
 ds_read_b128 v[56:59], v19 offset:0
 v_mfma_f32_16x16x32_bf16 v[104:107], v[164:167], v[40:43], v[112:115]
 v_mov_b32 v81, 0
 ds_read_b128 v[60:63], v19 offset:1024
 buffer_load_dwordx4 v1, s[4:7], s16 offen offset:1024 sc1 lds
 v_mfma_f32_16x16x32_bf16 v[100:103], v[152:155], v[44:47], v[100:103]
 v_mov_b32 v82, 0
 ds_read_b128 v[64:67], v19 offset:2048
 v_mfma_f32_16x16x32_bf16 v[104:107], v[168:171], v[44:47], v[104:107]
 v_mov_b32 v83, 0
 ds_read_b128 v[68:71], v19 offset:3072
 v_mfma_f32_16x16x32_bf16 v[100:103], v[156:159], v[48:51], v[100:103]
 v_mov_b32 v84, 0
 ds_read_b128 v[72:75], v19 offset:4096
 v_mfma_f32_16x16x32_bf16 v[104:107], v[172:175], v[48:51], v[104:107]
 buffer_load_dwordx4 v1, s[4:7], s16 offen offset:2048 sc1 lds
 v_mov_b32 v85, 0
 ds_read_b128 v[76:79], v19 offset:5120
 v_mfma_f32_16x16x32_bf16 v[100:103], v[160:163], v[52:55], v[100:103]
 v_mov_b32 v86, 0
 ds_read_b128 v[180:183], v19 offset:6144
 buffer_load_dwordx4 v1, s[4:7], s16 offen offset:3072 sc1 lds
 v_mfma_f32_16x16x32_bf16 v[104:107], v[176:179], v[52:55], v[104:107]
 v_mov_b32 v87, 0
 ds_read_b128 v[184:187], v19 offset:7168
 s_waitcnt lgkmcnt(8)
 s_barrier
 s_add_u32 m0, s69, 53248
 s_nop 0
 buffer_load_dwordx4 v6, s[4:7], s16 offen offset:0 sc1 lds
 ds_read_b128 v[140:143], v17 offset:10240
 ds_read_b128 v[144:147], v17 offset:11264
 s_nop 4
 v_cvt_pk_bf16_f32 v7, v100, v101
 v_lshlrev_b32 v100, 16, v7
 buffer_load_dwordx4 v6, s[4:7], s16 offen offset:1024 sc1 lds
 v_and_b32 v101, 0xffff0000, v7
 v_cvt_pk_bf16_f32 v7, v102, v103
 v_lshlrev_b32 v102, 16, v7
 v_and_b32 v103, 0xffff0000, v7
 v_cvt_pk_bf16_f32 v7, v104, v105
 buffer_load_dwordx4 v6, s[4:7], s16 offen offset:2048 sc1 lds
 v_lshlrev_b32 v104, 16, v7
 v_and_b32 v105, 0xffff0000, v7
 v_cvt_pk_bf16_f32 v7, v106, v107
 v_lshlrev_b32 v106, 16, v7
 v_and_b32 v107, 0xffff0000, v7
 buffer_load_dwordx4 v6, s[4:7], s16 offen offset:3072 sc1 lds
 v_pk_mul_f32 v[100:101], v[100:101], s[64:65] op_sel:[0,1] op_sel_hi:[1,1]
 v_pk_mul_f32 v[102:103], v[102:103], s[64:65] op_sel:[0,1] op_sel_hi:[1,1]
 v_pk_mul_f32 v[104:105], v[104:105], s[64:65] op_sel:[0,1] op_sel_hi:[1,1]
 v_pk_mul_f32 v[106:107], v[106:107], s[64:65] op_sel:[0,1] op_sel_hi:[1,1]
 v_cvt_pk_bf16_f32 v7, v100, v101
 v_lshlrev_b32 v100, 16, v7
 v_and_b32 v101, 0xffff0000, v7
 v_cvt_pk_bf16_f32 v7, v102, v103
 v_lshlrev_b32 v102, 16, v7
 v_and_b32 v103, 0xffff0000, v7
 v_cvt_pk_bf16_f32 v7, v104, v105
 v_lshlrev_b32 v104, 16, v7
 v_and_b32 v105, 0xffff0000, v7
 v_cvt_pk_bf16_f32 v7, v106, v107
 v_lshlrev_b32 v106, 16, v7
 v_and_b32 v107, 0xffff0000, v7
 v_max3_f32 v20, v100, v101, v102
 v_max3_f32 v20, v20, v103, v104
 v_max3_f32 v20, v20, v105, v106
 v_max_f32 v20, v20, v107
 v_mov_b32 v22, v20
 s_nop 1
 v_permlane16_swap_b32 v20, v22
 v_max_f32 v20, v20, v22
 v_mov_b32 v22, v20
 s_nop 1
 v_permlane32_swap_b32 v20, v22
 v_max_f32 v20, v20, v22
 v_mul_f32 v22, s66, v20
 v_fma_f32 v100, v100, s66, -v22
 v_fma_f32 v101, v101, s66, -v22
 v_fma_f32 v102, v102, s66, -v22
 v_fma_f32 v103, v103, s66, -v22
 v_fma_f32 v104, v104, s66, -v22
 v_fma_f32 v105, v105, s66, -v22
 v_fma_f32 v106, v106, s66, -v22
 v_fma_f32 v107, v107, s66, -v22
 v_exp_f32 v100, v100
 v_exp_f32 v101, v101
 v_exp_f32 v102, v102
 v_exp_f32 v103, v103
 v_exp_f32 v104, v104
 v_exp_f32 v105, v105
 v_exp_f32 v106, v106
 v_exp_f32 v107, v107
 buffer_load_dwordx4 v[124:127], v1, s[4:7], s62 offen offset:0 sc1
 buffer_load_dwordx4 v[128:131], v1, s[4:7], s62 offen offset:1024 sc1
 buffer_load_dwordx4 v[132:135], v1, s[4:7], s62 offen offset:2048 sc1
 buffer_load_dwordx4 v[136:139], v1, s[4:7], s62 offen offset:3072 sc1
 s_add_u32 m0, s68, 49152
 s_nop 0
 buffer_load_dwordx4 v1, s[4:7], s72 offen offset:0 sc1 nt lds
 buffer_load_dwordx4 v1, s[4:7], s72 offen offset:1024 sc1 nt lds
 buffer_load_dwordx4 v1, s[4:7], s72 offen offset:2048 sc1 nt lds
 buffer_load_dwordx4 v1, s[4:7], s72 offen offset:3072 sc1 nt lds
 v_add_f32 v21, v100, v101
 v_add_f32 v21, v21, v102
 v_add_f32 v21, v21, v103
 v_add_f32 v21, v21, v104
 v_add_f32 v21, v21, v105
 v_add_f32 v21, v21, v106
 v_add_f32 v21, v21, v107
 s_lshl_b32 s76, s53, 19
 s_add_u32 s76, s76, s54
 s_xor_b32 s76, s76, 8192
 s_add_u32 s76, s76, 67108864
 s_add_u32 s53, s53, 1
 s_add_u32 s67, s67, 4
 s_waitcnt vmcnt(4)
L_pk_325:
 v_max3_u32 v7, v124, v128, v132
 v_max_u32 v7, v7, v136
 v_cmp_eq_u32 vcc, -1, v7
 s_cbranch_vccnz L_rt_326
 v_mfma_f32_16x16x32_bf16 v[96:99], v[124:127], v[40:43], 0
 v_mfma_f32_16x16x32_bf16 v[96:99], v[128:131], v[44:47], v[96:99]
 v_mfma_f32_16x16x32_bf16 v[96:99], v[132:135], v[48:51], v[96:99]
 v_mfma_f32_16x16x32_bf16 v[96:99], v[136:139], v[52:55], v[96:99]
 s_nop 7
 v_cvt_pk_bf16_f32 v7, v98, v99
 v_lshlrev_b32 v98, 16, v7
 v_and_b32 v99, 0xffff0000, v7
 v_pk_mul_f32 v[98:99], v[98:99], s[64:65] op_sel:[0,1] op_sel_hi:[1,1]
 v_cvt_pk_bf16_f32 v7, v98, v99
 v_lshlrev_b32 v98, 16, v7
 v_and_b32 v99, 0xffff0000, v7
 v_max3_f32 v96, v98, v99, v20
 v_mov_b32 v22, v96
 s_nop 1
 v_permlane16_swap_b32 v96, v22
 v_max_f32 v96, v96, v22
 v_mov_b32 v22, v96
 s_nop 1
 v_permlane32_swap_b32 v96, v22
 v_max_f32 v96, v96, v22
 v_mul_f32 v96, s66, v96
 v_fma_f32 v28, v20, s66, -v96
 v_fma_f32 v98, v98, s66, -v96
 v_fma_f32 v99, v99, s66, -v96
 v_exp_f32 v28, v28
 v_exp_f32 v98, v98
 v_exp_f32 v99, v99
 s_nop 0
 v_fma_f32 v21, v21, v28, v98
 v_add_f32 v21, v21, v99
 v_mov_b32 v22, v21
 s_nop 1
 v_permlane16_swap_b32 v21, v22
 v_add_f32 v21, v21, v22
 v_mov_b32 v22, v21
 s_nop 1
 v_permlane32_swap_b32 v21, v22
 v_add_f32 v21, v21, v22
 v_rcp_f32 v21, v21
 s_nop 0
 v_mul_f32 v28, v28, v21
 v_pk_mul_f32 v[100:101], v[100:101], v[28:29] op_sel_hi:[1,0]
 v_cvt_pk_bf16_f32 v116, v100, v101
 v_pk_mul_f32 v[102:103], v[102:103], v[28:29] op_sel_hi:[1,0]
 v_cvt_pk_bf16_f32 v117, v102, v103
 v_pk_mul_f32 v[104:105], v[104:105], v[28:29] op_sel_hi:[1,0]
 v_cvt_pk_bf16_f32 v118, v104, v105
 v_pk_mul_f32 v[106:107], v[106:107], v[28:29] op_sel_hi:[1,0]
 v_cvt_pk_bf16_f32 v119, v106, v107
 v_pk_mul_f32 v[98:99], v[98:99], v[20:21] op_sel:[0,1] op_sel_hi:[1,1]
 s_waitcnt lgkmcnt(0)
 v_cvt_pk_bf16_f32 v120, v98, v99
 v_cvt_pk_bf16_f32 v123, v98, v99
 v_mfma_f32_16x16x32_bf16 v[148:151], v[56:59], v[116:119], 0
 v_mfma_f32_16x16x32_bf16 v[152:155], v[60:63], v[116:119], 0
 v_mfma_f32_16x16x16_bf16 v[148:151], v[140:141], v[120:121], v[148:151]
 v_mfma_f32_16x16x32_bf16 v[156:159], v[64:67], v[116:119], 0
 v_mfma_f32_16x16x16_bf16 v[152:155], v[140:141], v[122:123], v[152:155]
 v_mfma_f32_16x16x32_bf16 v[160:163], v[68:71], v[116:119], 0
 v_mfma_f32_16x16x16_bf16 v[156:159], v[142:143], v[120:121], v[156:159]
 v_mfma_f32_16x16x32_bf16 v[164:167], v[72:75], v[116:119], 0
 v_mfma_f32_16x16x16_bf16 v[160:163], v[142:143], v[122:123], v[160:163]
 v_cvt_pk_bf16_f32 v40, v148, v149
 v_cvt_pk_bf16_f32 v41, v150, v151
 v_cvt_pk_bf16_f32 v42, v152, v153
 v_cvt_pk_bf16_f32 v43, v154, v155
 buffer_store_dwordx4 v[40:43], v11, s[4:7], s76 offen offset:0 sc1
 v_mfma_f32_16x16x32_bf16 v[168:171], v[76:79], v[116:119], 0
 v_mfma_f32_16x16x16_bf16 v[164:167], v[144:145], v[120:121], v[164:167]
 v_mfma_f32_16x16x32_bf16 v[172:175], v[180:183], v[116:119], 0
 v_mfma_f32_16x16x16_bf16 v[168:171], v[144:145], v[122:123], v[168:171]
 v_cvt_pk_bf16_f32 v44, v156, v157
 v_cvt_pk_bf16_f32 v45, v158, v159
 v_cvt_pk_bf16_f32 v46, v160, v161
 v_cvt_pk_bf16_f32 v47, v162, v163
 buffer_store_dwordx4 v[44:47], v11, s[4:7], s76 offen offset:2048 sc1
 s_add_u32 s76, s76, 4096
 v_mfma_f32_16x16x32_bf16 v[176:179], v[184:187], v[116:119], 0
 v_mfma_f32_16x16x16_bf16 v[172:175], v[146:147], v[120:121], v[172:175]
 v_mfma_f32_16x16x16_bf16 v[176:179], v[146:147], v[122:123], v[176:179]
 v_cvt_pk_bf16_f32 v48, v164, v165
 v_cvt_pk_bf16_f32 v49, v166, v167
 v_cvt_pk_bf16_f32 v50, v168, v169
 v_cvt_pk_bf16_f32 v51, v170, v171
 buffer_store_dwordx4 v[48:51], v11, s[4:7], s76 offen offset:0 sc1
 v_mov_b32 v7, s53
 s_nop 2
 v_cvt_pk_bf16_f32 v52, v172, v173
 v_cvt_pk_bf16_f32 v53, v174, v175
 v_cvt_pk_bf16_f32 v54, v176, v177
 v_cvt_pk_bf16_f32 v55, v178, v179
 buffer_store_dwordx4 v[52:55], v11, s[4:7], s76 offen offset:2048 sc1
 s_mov_b64 exec, 1
 buffer_store_dword v7, off, s[4:7], s32 offset:8 sc1
 s_mov_b64 exec, -1
 s_mov_b32 s76, s53
 s_mov_b32 s34, s67
 s_cmp_eq_u32 s33, 0
 s_cbranch_scc1 L_nw_327
L_nj_328:
 s_mov_b32 s51, 0
 buffer_load_dword v7, off, s[4:7], s17 sc1
 s_waitcnt vmcnt(0)
L_go_329:
 v_cmp_gt_u32 vcc, s53, v7
 s_cbranch_vccnz L_rt_330
 v_mov_b32 v10, 1
 s_mov_b64 exec, 31
 buffer_atomic_add v10, v12, s[4:7], s34 offen
 s_mov_b64 exec, -1
 s_mov_b32 s51, 0
 s_nop 15
 s_nop 15
 s_nop 15
 s_nop 15
 buffer_load_dwordx4 v[40:43], v2, s[4:7], s59 offen offset:0 sc1
 buffer_load_dwordx4 v[44:47], v2, s[4:7], s59 offen offset:128 sc1
 buffer_load_dwordx4 v[48:51], v2, s[4:7], s59 offen offset:1024 sc1
 buffer_load_dwordx4 v[52:55], v2, s[4:7], s59 offen offset:1152 sc1
 buffer_load_dwordx4 v[56:59], v3, s[4:7], s59 offen offset:0 sc1
L_xm_331:
 s_waitcnt vmcnt(4)
 v_mfma_f32_16x16x32_bf16 v[60:63], v[24:27], v[40:43], 0
 s_waitcnt vmcnt(3)
 v_mfma_f32_16x16x32_bf16 v[64:67], v[24:27], v[44:47], 0
 s_waitcnt vmcnt(2)
 v_mfma_f32_16x16x32_bf16 v[68:71], v[24:27], v[48:51], 0
 v_max3_u32 v7, v40, v44, v48
 v_cvt_pk_bf16_f32 v60, v60, v61
 v_cvt_pk_bf16_f32 v61, v62, v63
 ds_write_b64 v4, v[60:61] offset:0
 s_waitcnt vmcnt(1)
 v_mfma_f32_16x16x32_bf16 v[72:75], v[24:27], v[52:55], 0
 v_cvt_pk_bf16_f32 v64, v64, v65
 v_cvt_pk_bf16_f32 v65, v66, v67
 ds_write_b64 v4, v[64:65] offset:8
 s_waitcnt vmcnt(0)
 v_mfma_f32_16x16x32_bf16 v[76:79], v[24:27], v[56:59], 0
 v_max3_u32 v7, v7, v52, v56
 v_cmp_eq_u32 vcc, -1, v7
 v_cvt_pk_bf16_f32 v68, v68, v69
 v_cvt_pk_bf16_f32 v69, v70, v71
 ds_write_b64 v4, v[68:69] offset:1024
 s_cbranch_vccnz L_rt_332
 v_cvt_pk_bf16_f32 v72, v72, v73
 v_cvt_pk_bf16_f32 v73, v74, v75
 ds_write_b64 v4, v[72:73] offset:1032
 s_nop 0
 v_cvt_pk_bf16_f32 v76, v76, v77
 v_cvt_pk_bf16_f32 v77, v78, v79
 ds_write_b64 v5, v[76:77] offset:0
 s_waitcnt lgkmcnt(0)
 s_barrier
 ds_read_b128 v[56:59], v23 offset:0
 ds_read_b128 v[60:63], v23 offset:32
 ds_read_b128 v[64:67], v23 offset:1024
 buffer_load_dword v13, off, s[4:7], s32 sc1
 s_waitcnt lgkmcnt(2)
 v_smfmac_f32_16x16x64_bf16 v[80:83], v[56:59], v[192:199], v8
 ds_read_b128 v[68:71], v23 offset:1056
 v_smfmac_f32_16x16x64_bf16 v[84:87], v[56:59], v[200:207], v8
 ds_read_b128 v[72:75], v23 offset:2048
 s_waitcnt lgkmcnt(3)
 v_smfmac_f32_16x16x64_bf16 v[80:83], v[60:63], v[208:215], v8
 ds_read_b128 v[76:79], v23 offset:2080
 v_smfmac_f32_16x16x64_bf16 v[84:87], v[60:63], v[216:223], v8
 ds_read_b128 v[180:183], v23 offset:3072
 s_waitcnt lgkmcnt(4)
 v_smfmac_f32_16x16x64_bf16 v[80:83], v[64:67], v[224:231], v8
 ds_read_b128 v[148:151], v15 offset:49152
 v_smfmac_f32_16x16x64_bf16 v[84:87], v[64:67], v[232:239], v8
 ds_read_b128 v[184:187], v23 offset:3104
 s_waitcnt lgkmcnt(5)
 v_smfmac_f32_16x16x64_bf16 v[80:83], v[68:71], v[240:247], v8
 ds_read_b128 v[152:155], v15 offset:50176
 v_smfmac_f32_16x16x64_bf16 v[84:87], v[68:71], v[248:255], v8
 ds_read_b128 v[56:59], v23 offset:4096
 s_waitcnt lgkmcnt(6)
 v_smfmac_f32_16x16x64_bf16 v[80:83], v[72:75], a[0:7], v8
 ds_read_b128 v[156:159], v15 offset:51200
 v_smfmac_f32_16x16x64_bf16 v[84:87], v[72:75], a[8:15], v8
 ds_read_b128 v[60:63], v23 offset:4128
 s_waitcnt lgkmcnt(7)
 v_smfmac_f32_16x16x64_bf16 v[80:83], v[76:79], a[16:23], v8
 ds_read_b128 v[160:163], v15 offset:52224
 v_smfmac_f32_16x16x64_bf16 v[84:87], v[76:79], a[24:31], v8
 ds_read_b128 v[64:67], v23 offset:5120
 s_waitcnt lgkmcnt(8)
 v_smfmac_f32_16x16x64_bf16 v[80:83], v[180:183], a[32:39], v8
 ds_read_b128 v[164:167], v15 offset:53248
 v_smfmac_f32_16x16x64_bf16 v[84:87], v[180:183], a[40:47], v8
 ds_read_b128 v[68:71], v23 offset:5152
 s_waitcnt lgkmcnt(8)
 v_smfmac_f32_16x16x64_bf16 v[80:83], v[184:187], a[48:55], v8
 ds_read_b128 v[168:171], v15 offset:54272
 v_smfmac_f32_16x16x64_bf16 v[84:87], v[184:187], a[56:63], v8
 ds_read_b128 v[72:75], v23 offset:6144
 s_waitcnt lgkmcnt(8)
 v_smfmac_f32_16x16x64_bf16 v[80:83], v[56:59], a[64:71], v8
 ds_read_b128 v[172:175], v15 offset:55296
 v_smfmac_f32_16x16x64_bf16 v[84:87], v[56:59], a[72:79], v8
 ds_read_b128 v[76:79], v23 offset:6176
 s_waitcnt lgkmcnt(8)
 v_smfmac_f32_16x16x64_bf16 v[80:83], v[60:63], a[80:87], v8
 ds_read_b128 v[176:179], v15 offset:56320
 v_smfmac_f32_16x16x64_bf16 v[84:87], v[60:63], a[88:95], v8
 ds_read_b128 v[180:183], v23 offset:7168
 s_waitcnt lgkmcnt(8)
 v_smfmac_f32_16x16x64_bf16 v[80:83], v[64:67], a[96:103], v8
 ds_read_b128 v[40:43], v14 offset:49152
 v_smfmac_f32_16x16x64_bf16 v[84:87], v[64:67], a[104:111], v8
 ds_read_b128 v[184:187], v23 offset:7200
 s_waitcnt lgkmcnt(8)
 v_smfmac_f32_16x16x64_bf16 v[80:83], v[68:71], a[112:119], v8
 ds_read_b128 v[44:47], v14 offset:50176
 v_smfmac_f32_16x16x64_bf16 v[84:87], v[68:71], a[120:127], v8
 ds_read_b128 v[56:59], v23 offset:8192
 s_waitcnt lgkmcnt(8)
 v_smfmac_f32_16x16x64_bf16 v[80:83], v[72:75], a[128:135], v8
 ds_read_b128 v[48:51], v14 offset:51200
 v_smfmac_f32_16x16x64_bf16 v[84:87], v[72:75], a[136:143], v8
 ds_read_b128 v[60:63], v23 offset:8224
 s_waitcnt lgkmcnt(8)
 v_smfmac_f32_16x16x64_bf16 v[80:83], v[76:79], a[144:151], v8
 ds_read_b128 v[52:55], v14 offset:52224
 v_smfmac_f32_16x16x64_bf16 v[84:87], v[76:79], a[152:159], v8
 ds_read_b128 v[64:67], v23 offset:9216
 s_waitcnt lgkmcnt(8)
 v_smfmac_f32_16x16x64_bf16 v[80:83], v[180:183], a[160:167], v8
 v_smfmac_f32_16x16x64_bf16 v[84:87], v[180:183], a[168:175], v8
 ds_read_b128 v[68:71], v23 offset:9248
 s_waitcnt lgkmcnt(7)
 v_smfmac_f32_16x16x64_bf16 v[80:83], v[184:187], a[176:183], v8
 v_smfmac_f32_16x16x64_bf16 v[84:87], v[184:187], a[184:191], v8
 s_waitcnt lgkmcnt(5)
 v_smfmac_f32_16x16x64_bf16 v[80:83], v[56:59], a[192:199], v8
 v_smfmac_f32_16x16x64_bf16 v[84:87], v[56:59], a[200:207], v8
 s_waitcnt lgkmcnt(3)
 v_smfmac_f32_16x16x64_bf16 v[80:83], v[60:63], a[208:215], v8
 v_smfmac_f32_16x16x64_bf16 v[84:87], v[60:63], a[216:223], v8
 s_waitcnt lgkmcnt(1)
 v_smfmac_f32_16x16x64_bf16 v[80:83], v[64:67], a[224:231], v8
 v_smfmac_f32_16x16x64_bf16 v[84:87], v[64:67], a[232:239], v8
 s_waitcnt lgkmcnt(0)
 v_smfmac_f32_16x16x64_bf16 v[80:83], v[68:71], a[240:247], v8
 v_smfmac_f32_16x16x64_bf16 v[84:87], v[68:71], a[248:255], v8
 s_nop 2
 v_cvt_pk_bf16_f32 v116, v80, v81
 v_cvt_pk_bf16_f32 v117, v82, v83
 s_nop 2
 v_cvt_pk_bf16_f32 v118, v84, v85
 v_cvt_pk_bf16_f32 v119, v86, v87
 buffer_store_dwordx4 v[116:119], v18, s[4:7], s63 offen sc1
 ds_write_b128 v16, v[116:119] offset:10240
 buffer_store_dwordx4 v[32:35], v18, s[4:7], s62 offen sc1
 s_waitcnt vmcnt(2)
 v_readfirstlane_b32 s33, v13
 s_add_u32 s76, s53, 1
 s_waitcnt lgkmcnt(1)
 s_cmp_gt_u32 s33, s76
 s_cselect_b32 s33, 1, 0
 s_cselect_b32 s76, s76, 512
 s_lshl_b32 s16, s76, 19
 s_add_u32 s16, s16, s54
 s_xor_b32 s72, s16, 8192
 s_add_u32 s72, s72, s71
 s_add_u32 s16, s16, s70
 v_mfma_f32_16x16x32_bf16 v[100:103], v[148:151], v[40:43], v[108:111]
 s_add_u32 m0, s69, 0
 s_nop 0
 buffer_load_dwordx4 v1, s[4:7], s16 offen offset:0 sc1 lds
 v_mov_b32 v80, 0
 ds_read_b128 v[56:59], v19 offset:49152
 v_mfma_f32_16x16x32_bf16 v[104:107], v[164:167], v[40:43], v[112:115]
 v_mov_b32 v81, 0
 ds_read_b128 v[60:63], v19 offset:50176
 buffer_load_dwordx4 v1, s[4:7], s16 offen offset:1024 sc1 lds
 v_mfma_f32_16x16x32_bf16 v[100:103], v[152:155], v[44:47], v[100:103]
 v_mov_b32 v82, 0
 ds_read_b128 v[64:67], v19 offset:51200
 v_mfma_f32_16x16x32_bf16 v[104:107], v[168:171], v[44:47], v[104:107]
 v_mov_b32 v83, 0
 ds_read_b128 v[68:71], v19 offset:52224
 v_mfma_f32_16x16x32_bf16 v[100:103], v[156:159], v[48:51], v[100:103]
 v_mov_b32 v84, 0
 ds_read_b128 v[72:75], v19 offset:53248
 v_mfma_f32_16x16x32_bf16 v[104:107], v[172:175], v[48:51], v[104:107]
 buffer_load_dwordx4 v1, s[4:7], s16 offen offset:2048 sc1 lds
 v_mov_b32 v85, 0
 ds_read_b128 v[76:79], v19 offset:54272
 v_mfma_f32_16x16x32_bf16 v[100:103], v[160:163], v[52:55], v[100:103]
 v_mov_b32 v86, 0
 ds_read_b128 v[180:183], v19 offset:55296
 buffer_load_dwordx4 v1, s[4:7], s16 offen offset:3072 sc1 lds
 v_mfma_f32_16x16x32_bf16 v[104:107], v[176:179], v[52:55], v[104:107]
 v_mov_b32 v87, 0
 ds_read_b128 v[184:187], v19 offset:56320
 s_waitcnt lgkmcnt(8)
 s_barrier
 s_add_u32 m0, s69, 4096
 s_nop 0
 buffer_load_dwordx4 v6, s[4:7], s16 offen offset:0 sc1 lds
 ds_read_b128 v[140:143], v17 offset:10240
 ds_read_b128 v[144:147], v17 offset:11264
 s_nop 4
 v_cvt_pk_bf16_f32 v7, v100, v101
 v_lshlrev_b32 v100, 16, v7
 buffer_load_dwordx4 v6, s[4:7], s16 offen offset:1024 sc1 lds
 v_and_b32 v101, 0xffff0000, v7
 v_cvt_pk_bf16_f32 v7, v102, v103
 v_lshlrev_b32 v102, 16, v7
 v_and_b32 v103, 0xffff0000, v7
 v_cvt_pk_bf16_f32 v7, v104, v105
 buffer_load_dwordx4 v6, s[4:7], s16 offen offset:2048 sc1 lds
 v_lshlrev_b32 v104, 16, v7
 v_and_b32 v105, 0xffff0000, v7
 v_cvt_pk_bf16_f32 v7, v106, v107
 v_lshlrev_b32 v106, 16, v7
 v_and_b32 v107, 0xffff0000, v7
 buffer_load_dwordx4 v6, s[4:7], s16 offen offset:3072 sc1 lds
 v_pk_mul_f32 v[100:101], v[100:101], s[64:65] op_sel:[0,1] op_sel_hi:[1,1]
 v_pk_mul_f32 v[102:103], v[102:103], s[64:65] op_sel:[0,1] op_sel_hi:[1,1]
 v_pk_mul_f32 v[104:105], v[104:105], s[64:65] op_sel:[0,1] op_sel_hi:[1,1]
 v_pk_mul_f32 v[106:107], v[106:107], s[64:65] op_sel:[0,1] op_sel_hi:[1,1]
 v_cvt_pk_bf16_f32 v7, v100, v101
 v_lshlrev_b32 v100, 16, v7
 v_and_b32 v101, 0xffff0000, v7
 v_cvt_pk_bf16_f32 v7, v102, v103
 v_lshlrev_b32 v102, 16, v7
 v_and_b32 v103, 0xffff0000, v7
 v_cvt_pk_bf16_f32 v7, v104, v105
 v_lshlrev_b32 v104, 16, v7
 v_and_b32 v105, 0xffff0000, v7
 v_cvt_pk_bf16_f32 v7, v106, v107
 v_lshlrev_b32 v106, 16, v7
 v_and_b32 v107, 0xffff0000, v7
 v_max3_f32 v20, v100, v101, v102
 v_max3_f32 v20, v20, v103, v104
 v_max3_f32 v20, v20, v105, v106
 v_max_f32 v20, v20, v107
 v_mov_b32 v22, v20
 s_nop 1
 v_permlane16_swap_b32 v20, v22
 v_max_f32 v20, v20, v22
 v_mov_b32 v22, v20
 s_nop 1
 v_permlane32_swap_b32 v20, v22
 v_max_f32 v20, v20, v22
 v_mul_f32 v22, s66, v20
 v_fma_f32 v100, v100, s66, -v22
 v_fma_f32 v101, v101, s66, -v22
 v_fma_f32 v102, v102, s66, -v22
 v_fma_f32 v103, v103, s66, -v22
 v_fma_f32 v104, v104, s66, -v22
 v_fma_f32 v105, v105, s66, -v22
 v_fma_f32 v106, v106, s66, -v22
 v_fma_f32 v107, v107, s66, -v22
 v_exp_f32 v100, v100
 v_exp_f32 v101, v101
 v_exp_f32 v102, v102
 v_exp_f32 v103, v103
 v_exp_f32 v104, v104
 v_exp_f32 v105, v105
 v_exp_f32 v106, v106
 v_exp_f32 v107, v107
 buffer_load_dwordx4 v[124:127], v1, s[4:7], s63 offen offset:0 sc1
 buffer_load_dwordx4 v[128:131], v1, s[4:7], s63 offen offset:1024 sc1
 buffer_load_dwordx4 v[132:135], v1, s[4:7], s63 offen offset:2048 sc1
 buffer_load_dwordx4 v[136:139], v1, s[4:7], s63 offen offset:3072 sc1
 s_add_u32 m0, s68, 0
 s_nop 0
 buffer_load_dwordx4 v1, s[4:7], s72 offen offset:0 sc1 nt lds
 buffer_load_dwordx4 v1, s[4:7], s72 offen offset:1024 sc1 nt lds
 buffer_load_dwordx4 v1, s[4:7], s72 offen offset:2048 sc1 nt lds
 buffer_load_dwordx4 v1, s[4:7], s72 offen offset:3072 sc1 nt lds
 v_add_f32 v21, v100, v101
 v_add_f32 v21, v21, v102
 v_add_f32 v21, v21, v103
 v_add_f32 v21, v21, v104
 v_add_f32 v21, v21, v105
 v_add_f32 v21, v21, v106
 v_add_f32 v21, v21, v107
 s_lshl_b32 s76, s53, 19
 s_add_u32 s76, s76, s54
 s_xor_b32 s76, s76, 8192
 s_add_u32 s76, s76, 67108864
 s_add_u32 s53, s53, 1
 s_add_u32 s67, s67, 4
 s_waitcnt vmcnt(4)
L_pk_333:
 v_max3_u32 v7, v124, v128, v132
 v_max_u32 v7, v7, v136
 v_cmp_eq_u32 vcc, -1, v7
 s_cbranch_vccnz L_rt_334
 v_mfma_f32_16x16x32_bf16 v[96:99], v[124:127], v[40:43], 0
 v_mfma_f32_16x16x32_bf16 v[96:99], v[128:131], v[44:47], v[96:99]
 v_mfma_f32_16x16x32_bf16 v[96:99], v[132:135], v[48:51], v[96:99]
 v_mfma_f32_16x16x32_bf16 v[96:99], v[136:139], v[52:55], v[96:99]
 s_nop 7
 v_cvt_pk_bf16_f32 v7, v98, v99
 v_lshlrev_b32 v98, 16, v7
 v_and_b32 v99, 0xffff0000, v7
 v_pk_mul_f32 v[98:99], v[98:99], s[64:65] op_sel:[0,1] op_sel_hi:[1,1]
 v_cvt_pk_bf16_f32 v7, v98, v99
 v_lshlrev_b32 v98, 16, v7
 v_and_b32 v99, 0xffff0000, v7
 v_max3_f32 v96, v98, v99, v20
 v_mov_b32 v22, v96
 s_nop 1
 v_permlane16_swap_b32 v96, v22
 v_max_f32 v96, v96, v22
 v_mov_b32 v22, v96
 s_nop 1
 v_permlane32_swap_b32 v96, v22
 v_max_f32 v96, v96, v22
 v_mul_f32 v96, s66, v96
 v_fma_f32 v28, v20, s66, -v96
 v_fma_f32 v98, v98, s66, -v96
 v_fma_f32 v99, v99, s66, -v96
 v_exp_f32 v28, v28
 v_exp_f32 v98, v98
 v_exp_f32 v99, v99
 s_nop 0
 v_fma_f32 v21, v21, v28, v98
 v_add_f32 v21, v21, v99
 v_mov_b32 v22, v21
 s_nop 1
 v_permlane16_swap_b32 v21, v22
 v_add_f32 v21, v21, v22
 v_mov_b32 v22, v21
 s_nop 1
 v_permlane32_swap_b32 v21, v22
 v_add_f32 v21, v21, v22
 v_rcp_f32 v21, v21
 s_nop 0
 v_mul_f32 v28, v28, v21
 v_pk_mul_f32 v[100:101], v[100:101], v[28:29] op_sel_hi:[1,0]
 v_cvt_pk_bf16_f32 v116, v100, v101
 v_pk_mul_f32 v[102:103], v[102:103], v[28:29] op_sel_hi:[1,0]
 v_cvt_pk_bf16_f32 v117, v102, v103
 v_pk_mul_f32 v[104:105], v[104:105], v[28:29] op_sel_hi:[1,0]
 v_cvt_pk_bf16_f32 v118, v104, v105
 v_pk_mul_f32 v[106:107], v[106:107], v[28:29] op_sel_hi:[1,0]
 v_cvt_pk_bf16_f32 v119, v106, v107
 v_pk_mul_f32 v[98:99], v[98:99], v[20:21] op_sel:[0,1] op_sel_hi:[1,1]
 s_waitcnt lgkmcnt(0)
 v_cvt_pk_bf16_f32 v120, v98, v99
 v_cvt_pk_bf16_f32 v123, v98, v99
 v_mfma_f32_16x16x32_bf16 v[148:151], v[56:59], v[116:119], 0
 v_mfma_f32_16x16x32_bf16 v[152:155], v[60:63], v[116:119], 0
 v_mfma_f32_16x16x16_bf16 v[148:151], v[140:141], v[120:121], v[148:151]
 v_mfma_f32_16x16x32_bf16 v[156:159], v[64:67], v[116:119], 0
 v_mfma_f32_16x16x16_bf16 v[152:155], v[140:141], v[122:123], v[152:155]
 v_mfma_f32_16x16x32_bf16 v[160:163], v[68:71], v[116:119], 0
 v_mfma_f32_16x16x16_bf16 v[156:159], v[142:143], v[120:121], v[156:159]
 v_mfma_f32_16x16x32_bf16 v[164:167], v[72:75], v[116:119], 0
 v_mfma_f32_16x16x16_bf16 v[160:163], v[142:143], v[122:123], v[160:163]
 v_cvt_pk_bf16_f32 v40, v148, v149
 v_cvt_pk_bf16_f32 v41, v150, v151
 v_cvt_pk_bf16_f32 v42, v152, v153
 v_cvt_pk_bf16_f32 v43, v154, v155
 buffer_store_dwordx4 v[40:43], v11, s[4:7], s76 offen offset:0 sc1
 v_mfma_f32_16x16x32_bf16 v[168:171], v[76:79], v[116:119], 0
 v_mfma_f32_16x16x16_bf16 v[164:167], v[144:145], v[120:121], v[164:167]
 v_mfma_f32_16x16x32_bf16 v[172:175], v[180:183], v[116:119], 0
 v_mfma_f32_16x16x16_bf16 v[168:171], v[144:145], v[122:123], v[168:171]
 v_cvt_pk_bf16_f32 v44, v156, v157
 v_cvt_pk_bf16_f32 v45, v158, v159
 v_cvt_pk_bf16_f32 v46, v160, v161
 v_cvt_pk_bf16_f32 v47, v162, v163
 buffer_store_dwordx4 v[44:47], v11, s[4:7], s76 offen offset:2048 sc1
 s_add_u32 s76, s76, 4096
 v_mfma_f32_16x16x32_bf16 v[176:179], v[184:187], v[116:119], 0
 v_mfma_f32_16x16x16_bf16 v[172:175], v[146:147], v[120:121], v[172:175]
 v_mfma_f32_16x16x16_bf16 v[176:179], v[146:147], v[122:123], v[176:179]
 v_cvt_pk_bf16_f32 v48, v164, v165
 v_cvt_pk_bf16_f32 v49, v166, v167
 v_cvt_pk_bf16_f32 v50, v168, v169
 v_cvt_pk_bf16_f32 v51, v170, v171
 buffer_store_dwordx4 v[48:51], v11, s[4:7], s76 offen offset:0 sc1
 v_mov_b32 v7, s53
 s_nop 2
 v_cvt_pk_bf16_f32 v52, v172, v173
 v_cvt_pk_bf16_f32 v53, v174, v175
 v_cvt_pk_bf16_f32 v54, v176, v177
 v_cvt_pk_bf16_f32 v55, v178, v179
 buffer_store_dwordx4 v[52:55], v11, s[4:7], s76 offen offset:2048 sc1
 s_mov_b64 exec, 1
 buffer_store_dword v7, off, s[4:7], s32 offset:8 sc1
 s_mov_b64 exec, -1
 s_mov_b32 s76, s53
 s_cmp_eq_u32 s53, 64
 s_cbranch_scc1 L_vr_last
 s_mov_b32 s34, s67
 s_cmp_eq_u32 s33, 0
 s_cbranch_scc1 L_nw_335
L_nj_336:
 s_branch L_vr_loops
L_rt_306:
 s_nop 7
 buffer_load_dword v7, off, s[4:7], s17 sc1
 s_waitcnt vmcnt(0)
 s_add_u32 s51, s51, 1
 s_cmp_lt_u32 s51, 131072
 s_cbranch_scc1 L_go_305
 s_branch L_bail
L_rt_308:
 s_nop 7
 buffer_load_dwordx4 v[40:43], v2, s[4:7], s56 offen offset:0 sc1
 buffer_load_dwordx4 v[44:47], v2, s[4:7], s56 offen offset:128 sc1
 buffer_load_dwordx4 v[48:51], v2, s[4:7], s56 offen offset:1024 sc1
 buffer_load_dwordx4 v[52:55], v2, s[4:7], s56 offen offset:1152 sc1
 buffer_load_dwordx4 v[56:59], v3, s[4:7], s56 offen offset:0 sc1
 s_add_u32 s51, s51, 1
 s_cmp_lt_u32 s51, 131072
 s_cbranch_scc1 L_xm_307
 s_branch L_bail
L_rt_310:
 s_nop 7
 buffer_load_dwordx4 v[124:127], v1, s[4:7], s60 offen offset:0 sc1
 buffer_load_dwordx4 v[128:131], v1, s[4:7], s60 offen offset:1024 sc1
 buffer_load_dwordx4 v[132:135], v1, s[4:7], s60 offen offset:2048 sc1
 buffer_load_dwordx4 v[136:139], v1, s[4:7], s60 offen offset:3072 sc1
 s_waitcnt vmcnt(0)
 s_add_u32 s51, s51, 1
 s_cmp_lt_u32 s51, 131072
 s_cbranch_scc1 L_pk_309
 s_branch L_bail
L_nw_311:
 s_waitcnt vmcnt(0)
 v_mov_b32 v10, 1
 s_mov_b64 exec, 31
 buffer_atomic_add v10, v12, s[4:7], s67 offen
 s_mov_b64 exec, -1
 s_mov_b32 s34, 268435456
 s_add_u32 s77, s53, 1
 s_mov_b32 s51, 0
 s_mov_b64 exec, 1
L_pl_337:
 buffer_load_dword v7, v9, s[4:7], s32 offen sc1
 s_waitcnt vmcnt(0)
 v_cmp_gt_u32 vcc, s77, v7
 s_cbranch_vccz L_pld_338
 s_sleep 1
 s_add_u32 s51, s51, 1
 s_cmp_lt_u32 s51, 131072
 s_cbranch_scc1 L_pl_337
 s_branch L_bail
L_pld_338:
 s_mov_b64 exec, -1
 s_cmp_eq_u32 s3, s3
 s_cselect_b32 s76, s76, 512
 s_lshl_b32 s16, s76, 19
 s_add_u32 s16, s16, s54
 s_xor_b32 s72, s16, 8192
 s_add_u32 s72, s72, s71
 s_add_u32 s16, s16, s70
 s_add_u32 m0, s69, 49152
 s_nop 0
 buffer_load_dwordx4 v1, s[4:7], s16 offen offset:0 sc1 lds
 buffer_load_dwordx4 v1, s[4:7], s16 offen offset:1024 sc1 lds
 buffer_load_dwordx4 v1, s[4:7], s16 offen offset:2048 sc1 lds
 buffer_load_dwordx4 v1, s[4:7], s16 offen offset:3072 sc1 lds
 s_add_u32 m0, s69, 53248
 s_nop 0
 buffer_load_dwordx4 v6, s[4:7], s16 offen offset:0 sc1 lds
 buffer_load_dwordx4 v6, s[4:7], s16 offen offset:1024 sc1 lds
 buffer_load_dwordx4 v6, s[4:7], s16 offen offset:2048 sc1 lds
 buffer_load_dwordx4 v6, s[4:7], s16 offen offset:3072 sc1 lds
 s_add_u32 m0, s68, 49152
 s_nop 0
 buffer_load_dwordx4 v1, s[4:7], s72 offen offset:0 sc1 nt lds
 buffer_load_dwordx4 v1, s[4:7], s72 offen offset:1024 sc1 nt lds
 buffer_load_dwordx4 v1, s[4:7], s72 offen offset:2048 sc1 nt lds
 buffer_load_dwordx4 v1, s[4:7], s72 offen offset:3072 sc1 nt lds
 s_branch L_nj_312
L_rt_314:
 s_nop 7
 buffer_load_dword v7, off, s[4:7], s17 sc1
 s_waitcnt vmcnt(0)
 s_add_u32 s51, s51, 1
 s_cmp_lt_u32 s51, 131072
 s_cbranch_scc1 L_go_313
 s_branch L_bail
L_rt_316:
 s_nop 7
 buffer_load_dwordx4 v[40:43], v2, s[4:7], s57 offen offset:0 sc1
 buffer_load_dwordx4 v[44:47], v2, s[4:7], s57 offen offset:128 sc1
 buffer_load_dwordx4 v[48:51], v2, s[4:7], s57 offen offset:1024 sc1
 buffer_load_dwordx4 v[52:55], v2, s[4:7], s57 offen offset:1152 sc1
 buffer_load_dwordx4 v[56:59], v3, s[4:7], s57 offen offset:0 sc1
 s_add_u32 s51, s51, 1
 s_cmp_lt_u32 s51, 131072
 s_cbranch_scc1 L_xm_315
 s_branch L_bail
L_rt_318:
 s_nop 7
 buffer_load_dwordx4 v[124:127], v1, s[4:7], s61 offen offset:0 sc1
 buffer_load_dwordx4 v[128:131], v1, s[4:7], s61 offen offset:1024 sc1
 buffer_load_dwordx4 v[132:135], v1, s[4:7], s61 offen offset:2048 sc1
 buffer_load_dwordx4 v[136:139], v1, s[4:7], s61 offen offset:3072 sc1
 s_waitcnt vmcnt(0)
 s_add_u32 s51, s51, 1
 s_cmp_lt_u32 s51, 131072
 s_cbranch_scc1 L_pk_317
 s_branch L_bail
L_nw_319:
 s_waitcnt vmcnt(0)
 v_mov_b32 v10, 1
 s_mov_b64 exec, 31
 buffer_atomic_add v10, v12, s[4:7], s67 offen
 s_mov_b64 exec, -1
 s_mov_b32 s34, 268435456
 s_add_u32 s77, s53, 1
 s_mov_b32 s51, 0
 s_mov_b64 exec, 1
L_pl_339:
 buffer_load_dword v7, v9, s[4:7], s32 offen sc1
 s_waitcnt vmcnt(0)
 v_cmp_gt_u32 vcc, s77, v7
 s_cbranch_vccz L_pld_340
 s_sleep 1
 s_add_u32 s51, s51, 1
 s_cmp_lt_u32 s51, 131072
 s_cbranch_scc1 L_pl_339
 s_branch L_bail
L_pld_340:
 s_mov_b64 exec, -1
 s_cmp_eq_u32 s3, s3
 s_cselect_b32 s76, s76, 512
 s_lshl_b32 s16, s76, 19
 s_add_u32 s16, s16, s54
 s_xor_b32 s72, s16, 8192
 s_add_u32 s72, s72, s71
 s_add_u32 s16, s16, s70
 s_add_u32 m0, s69, 0
 s_nop 0
 buffer_load_dwordx4 v1, s[4:7], s16 offen offset:0 sc1 lds
 buffer_load_dwordx4 v1, s[4:7], s16 offen offset:1024 sc1 lds
 buffer_load_dwordx4 v1, s[4:7], s16 offen offset:2048 sc1 lds
 buffer_load_dwordx4 v1, s[4:7], s16 offen offset:3072 sc1 lds
 s_add_u32 m0, s69, 4096
 s_nop 0
 buffer_load_dwordx4 v6, s[4:7], s16 offen offset:0 sc1 lds
 buffer_load_dwordx4 v6, s[4:7], s16 offen offset:1024 sc1 lds
 buffer_load_dwordx4 v6, s[4:7], s16 offen offset:2048 sc1 lds
 buffer_load_dwordx4 v6, s[4:7], s16 offen offset:3072 sc1 lds
 s_add_u32 m0, s68, 0
 s_nop 0
 buffer_load_dwordx4 v1, s[4:7], s72 offen offset:0 sc1 nt lds
 buffer_load_dwordx4 v1, s[4:7], s72 offen offset:1024 sc1 nt lds
 buffer_load_dwordx4 v1, s[4:7], s72 offen offset:2048 sc1 nt lds
 buffer_load_dwordx4 v1, s[4:7], s72 offen offset:3072 sc1 nt lds
 s_branch L_nj_320
L_rt_322:
 s_nop 7
 buffer_load_dword v7, off, s[4:7], s17 sc1
 s_waitcnt vmcnt(0)
 s_add_u32 s51, s51, 1
 s_cmp_lt_u32 s51, 131072
 s_cbranch_scc1 L_go_321
 s_branch L_bail
L_rt_324:
 s_nop 7
 buffer_load_dwordx4 v[40:43], v2, s[4:7], s58 offen offset:0 sc1
 buffer_load_dwordx4 v[44:47], v2, s[4:7], s58 offen offset:128 sc1
 buffer_load_dwordx4 v[48:51], v2, s[4:7], s58 offen offset:1024 sc1
 buffer_load_dwordx4 v[52:55], v2, s[4:7], s58 offen offset:1152 sc1
 buffer_load_dwordx4 v[56:59], v3, s[4:7], s58 offen offset:0 sc1
 s_add_u32 s51, s51, 1
 s_cmp_lt_u32 s51, 131072
 s_cbranch_scc1 L_xm_323
 s_branch L_bail
L_rt_326:
 s_nop 7
 buffer_load_dwordx4 v[124:127], v1, s[4:7], s62 offen offset:0 sc1
 buffer_load_dwordx4 v[128:131], v1, s[4:7], s62 offen offset:1024 sc1
 buffer_load_dwordx4 v[132:135], v1, s[4:7], s62 offen offset:2048 sc1
 buffer_load_dwordx4 v[136:139], v1, s[4:7], s62 offen offset:3072 sc1
 s_waitcnt vmcnt(0)
 s_add_u32 s51, s51, 1
 s_cmp_lt_u32 s51, 131072
 s_cbranch_scc1 L_pk_325
 s_branch L_bail
L_nw_327:
 s_waitcnt vmcnt(0)
 v_mov_b32 v10, 1
 s_mov_b64 exec, 31
 buffer_atomic_add v10, v12, s[4:7], s67 offen
 s_mov_b64 exec, -1
 s_mov_b32 s34, 268435456
 s_add_u32 s77, s53, 1
 s_mov_b32 s51, 0
 s_mov_b64 exec, 1
L_pl_341:
 buffer_load_dword v7, v9, s[4:7], s32 offen sc1
 s_waitcnt vmcnt(0)
 v_cmp_gt_u32 vcc, s77, v7
 s_cbranch_vccz L_pld_342
 s_sleep 1
 s_add_u32 s51, s51, 1
 s_cmp_lt_u32 s51, 131072
 s_cbranch_scc1 L_pl_341
 s_branch L_bail
L_pld_342:
 s_mov_b64 exec, -1
 s_cmp_eq_u32 s3, s3
 s_cselect_b32 s76, s76, 512
 s_lshl_b32 s16, s76, 19
 s_add_u32 s16, s16, s54
 s_xor_b32 s72, s16, 8192
 s_add_u32 s72, s72, s71
 s_add_u32 s16, s16, s70
 s_add_u32 m0, s69, 49152
 s_nop 0
 buffer_load_dwordx4 v1, s[4:7], s16 offen offset:0 sc1 lds
 buffer_load_dwordx4 v1, s[4:7], s16 offen offset:1024 sc1 lds
 buffer_load_dwordx4 v1, s[4:7], s16 offen offset:2048 sc1 lds
 buffer_load_dwordx4 v1, s[4:7], s16 offen offset:3072 sc1 lds
 s_add_u32 m0, s69, 53248
 s_nop 0
 buffer_load_dwordx4 v6, s[4:7], s16 offen offset:0 sc1 lds
 buffer_load_dwordx4 v6, s[4:7], s16 offen offset:1024 sc1 lds
 buffer_load_dwordx4 v6, s[4:7], s16 offen offset:2048 sc1 lds
 buffer_load_dwordx4 v6, s[4:7], s16 offen offset:3072 sc1 lds
 s_add_u32 m0, s68, 49152
 s_nop 0
 buffer_load_dwordx4 v1, s[4:7], s72 offen offset:0 sc1 nt lds
 buffer_load_dwordx4 v1, s[4:7], s72 offen offset:1024 sc1 nt lds
 buffer_load_dwordx4 v1, s[4:7], s72 offen offset:2048 sc1 nt lds
 buffer_load_dwordx4 v1, s[4:7], s72 offen offset:3072 sc1 nt lds
 s_branch L_nj_328
L_rt_330:
 s_nop 7
 buffer_load_dword v7, off, s[4:7], s17 sc1
 s_waitcnt vmcnt(0)
 s_add_u32 s51, s51, 1
 s_cmp_lt_u32 s51, 131072
 s_cbranch_scc1 L_go_329
 s_branch L_bail
L_rt_332:
 s_nop 7
 buffer_load_dwordx4 v[40:43], v2, s[4:7], s59 offen offset:0 sc1
 buffer_load_dwordx4 v[44:47], v2, s[4:7], s59 offen offset:128 sc1
 buffer_load_dwordx4 v[48:51], v2, s[4:7], s59 offen offset:1024 sc1
 buffer_load_dwordx4 v[52:55], v2, s[4:7], s59 offen offset:1152 sc1
 buffer_load_dwordx4 v[56:59], v3, s[4:7], s59 offen offset:0 sc1
 s_add_u32 s51, s51, 1
 s_cmp_lt_u32 s51, 131072
 s_cbranch_scc1 L_xm_331
 s_branch L_bail
L_rt_334:
 s_nop 7
 buffer_load_dwordx4 v[124:127], v1, s[4:7], s63 offen offset:0 sc1
 buffer_load_dwordx4 v[128:131], v1, s[4:7], s63 offen offset:1024 sc1
 buffer_load_dwordx4 v[132:135], v1, s[4:7], s63 offen offset:2048 sc1
 buffer_load_dwordx4 v[136:139], v1, s[4:7], s63 offen offset:3072 sc1
 s_waitcnt vmcnt(0)
 s_add_u32 s51, s51, 1
 s_cmp_lt_u32 s51, 131072
 s_cbranch_scc1 L_pk_333
 s_branch L_bail
L_nw_335:
 s_waitcnt vmcnt(0)
 v_mov_b32 v10, 1
 s_mov_b64 exec, 31
 buffer_atomic_add v10, v12, s[4:7], s67 offen
 s_mov_b64 exec, -1
 s_mov_b32 s34, 268435456
 s_add_u32 s77, s53, 1
 s_mov_b32 s51, 0
 s_mov_b64 exec, 1
L_pl_343:
 buffer_load_dword v7, v9, s[4:7], s32 offen sc1
 s_waitcnt vmcnt(0)
 v_cmp_gt_u32 vcc, s77, v7
 s_cbranch_vccz L_pld_344
 s_sleep 1
 s_add_u32 s51, s51, 1
 s_cmp_lt_u32 s51, 131072
 s_cbranch_scc1 L_pl_343
 s_branch L_bail
L_pld_344:
 s_mov_b64 exec, -1
 s_cmp_eq_u32 s3, s3
 s_cselect_b32 s76, s76, 512
 s_lshl_b32 s16, s76, 19
 s_add_u32 s16, s16, s54
 s_xor_b32 s72, s16, 8192
 s_add_u32 s72, s72, s71
 s_add_u32 s16, s16, s70
 s_add_u32 m0, s69, 0
 s_nop 0
 buffer_load_dwordx4 v1, s[4:7], s16 offen offset:0 sc1 lds
 buffer_load_dwordx4 v1, s[4:7], s16 offen offset:1024 sc1 lds
 buffer_load_dwordx4 v1, s[4:7], s16 offen offset:2048 sc1 lds
 buffer_load_dwordx4 v1, s[4:7], s16 offen offset:3072 sc1 lds
 s_add_u32 m0, s69, 4096
 s_nop 0
 buffer_load_dwordx4 v6, s[4:7], s16 offen offset:0 sc1 lds
 buffer_load_dwordx4 v6, s[4:7], s16 offen offset:1024 sc1 lds
 buffer_load_dwordx4 v6, s[4:7], s16 offen offset:2048 sc1 lds
 buffer_load_dwordx4 v6, s[4:7], s16 offen offset:3072 sc1 lds
 s_add_u32 m0, s68, 0
 s_nop 0
 buffer_load_dwordx4 v1, s[4:7], s72 offen offset:0 sc1 nt lds
 buffer_load_dwordx4 v1, s[4:7], s72 offen offset:1024 sc1 nt lds
 buffer_load_dwordx4 v1, s[4:7], s72 offen offset:2048 sc1 nt lds
 buffer_load_dwordx4 v1, s[4:7], s72 offen offset:3072 sc1 nt lds
 s_branch L_nj_336
L_vr_last:
 s_waitcnt vmcnt(0)
 v_mov_b32 v10, 1
 s_mov_b64 exec, 31
 buffer_atomic_add v10, v12, s[4:7], s67 offen
 s_mov_b64 exec, -1
 s_endpgm
L_code_end:
 s_endpgm
.section .rodata,"a"
.p2align 6
.amdhsa_kernel interleave_layers__memory_aug_recurrent_mem_tr__ssm_conv_h3__prompt_kernel
  .amdhsa_next_free_vgpr 512
  .amdhsa_next_free_sgpr 102
  .amdhsa_accum_offset 256
  .amdhsa_group_segment_fixed_size 0
  .amdhsa_kernarg_size 128
  .amdhsa_user_sgpr_count 2
  .amdhsa_user_sgpr_kernarg_segment_ptr 1
  .amdhsa_system_sgpr_workgroup_id_x 1
  .amdhsa_float_denorm_mode_32 3
.end_amdhsa_kernel
.text
```

```asm
; @launch grid=(256,1,1) block=(256,1,1) lds=163840
.amdgcn_target "amdgcn-amd-amdhsa--gfx950"
.text
.globl interleave_layers__memory_aug_recurrent_mem_tr__ssm_conv_h3__prompt_kernel
.p2align 8
.type interleave_layers__memory_aug_recurrent_mem_tr__ssm_conv_h3__prompt_kernel,@function
interleave_layers__memory_aug_recurrent_mem_tr__ssm_conv_h3__prompt_kernel:
 s_cmp_ge_u32 s2, 256
 s_cbranch_scc1 L_bail
 s_load_dwordx16 s[16:31], s[0:1], 0
 s_load_dwordx16 s[32:47], s[0:1], 64
 s_getreg_b32 s48, hwreg(HW_REG_XCC_ID, 0, 3)
 v_lshrrev_b32 v1, 6, v0
 v_and_b32 v0, 63, v0
 s_nop 0
 v_readfirstlane_b32 s50, v1
 s_waitcnt lgkmcnt(0)
 s_mov_b32 s4, s46
 s_and_b32 s5, s47, 0xffff
 s_mov_b32 s6, 268435456
 s_mov_b32 s7, 0x00020000
 s_mov_b32 s8, s46
 s_and_b32 s9, s47, 0xffff
 s_mov_b32 s10, 268435456
 s_mov_b32 s11, 0x00020000
 s_mov_b32 s12, s46
 s_and_b32 s13, s47, 0xffff
 s_mov_b32 s14, 268435456
 s_mov_b32 s15, 0x00020000
 s_mov_b32 s96, s44
 s_and_b32 s97, s45, 0xffff
 s_mov_b32 s98, 256
 s_mov_b32 s99, 0x00020000
 s_cmp_lg_u32 s50, 0
 s_cbranch_scc1 L_tk_wait
 s_mov_b32 s96, s44
 s_and_b32 s97, s45, 0xffff
 s_mov_b32 s98, 256
 s_mov_b32 s99, 0x00020000
 s_lshl_b32 s3, s48, 5
 v_mov_b32 v1, 1
 v_mov_b32 v2, 0
 s_mov_b64 exec, 1
 buffer_atomic_add v1, off, s[96:99], s3 sc0
 s_waitcnt vmcnt(0)
 s_mov_b64 exec, -1
 v_readfirstlane_b32 s60, v1
 s_nop 3
 s_cmp_lt_u32 s60, 32
 s_cbranch_scc1 L_tk_ok
 v_lshlrev_b32 v3, 5, v0
 s_mov_b32 s51, 0
L_tk_lp:
 buffer_load_dword v4, v3, s[96:99], 0 offen sc1
 s_waitcnt vmcnt(0)
 s_mov_b32 s61, 0
 v_readlane_b32 s64, v4, 0
 s_nop 3
 s_add_u32 s61, s61, s64
 v_readlane_b32 s65, v4, 1
 s_nop 3
 s_add_u32 s61, s61, s65
 v_readlane_b32 s66, v4, 2
 s_nop 3
 s_add_u32 s61, s61, s66
 v_readlane_b32 s67, v4, 3
 s_nop 3
 s_add_u32 s61, s61, s67
 v_readlane_b32 s68, v4, 4
 s_nop 3
 s_add_u32 s61, s61, s68
 v_readlane_b32 s69, v4, 5
 s_nop 3
 s_add_u32 s61, s61, s69
 v_readlane_b32 s70, v4, 6
 s_nop 3
 s_add_u32 s61, s61, s70
 v_readlane_b32 s71, v4, 7
 s_nop 3
 s_add_u32 s61, s61, s71
 s_cmp_ge_u32 s61, 256
 s_cbranch_scc1 L_tk_all
 s_sleep 4
 s_add_u32 s51, s51, 1
 s_cmp_lt_u32 s51, 131072
 s_cbranch_scc1 L_tk_lp
 s_branch L_bail
L_tk_all:
 v_mov_b32 v1, 1
 s_mov_b64 exec, 1
 buffer_atomic_add v1, off, s[96:99], 0 offset:20 sc0
 s_waitcnt vmcnt(0)
 s_mov_b64 exec, -1
 v_readfirstlane_b32 s61, v1
 s_nop 3
 s_min_u32 s62, s64, 32
 s_add_u32 s60, s62, s61
 s_mov_b32 s48, 0
 s_cmp_lt_u32 s60, 32
 s_cbranch_scc1 L_tk_ok
 s_sub_u32 s61, s60, 32
 s_min_u32 s62, s65, 32
 s_add_u32 s60, s62, s61
 s_mov_b32 s48, 1
 s_cmp_lt_u32 s60, 32
 s_cbranch_scc1 L_tk_ok
 s_sub_u32 s61, s60, 32
 s_min_u32 s62, s66, 32
 s_add_u32 s60, s62, s61
 s_mov_b32 s48, 2
 s_cmp_lt_u32 s60, 32
 s_cbranch_scc1 L_tk_ok
 s_sub_u32 s61, s60, 32
 s_min_u32 s62, s67, 32
 s_add_u32 s60, s62, s61
 s_mov_b32 s48, 3
 s_cmp_lt_u32 s60, 32
 s_cbranch_scc1 L_tk_ok
 s_sub_u32 s61, s60, 32
 s_min_u32 s62, s68, 32
 s_add_u32 s60, s62, s61
 s_mov_b32 s48, 4
 s_cmp_lt_u32 s60, 32
 s_cbranch_scc1 L_tk_ok
 s_sub_u32 s61, s60, 32
 s_min_u32 s62, s69, 32
 s_add_u32 s60, s62, s61
 s_mov_b32 s48, 5
 s_cmp_lt_u32 s60, 32
 s_cbranch_scc1 L_tk_ok
 s_sub_u32 s61, s60, 32
 s_min_u32 s62, s70, 32
 s_add_u32 s60, s62, s61
 s_mov_b32 s48, 6
 s_cmp_lt_u32 s60, 32
 s_cbranch_scc1 L_tk_ok
 s_sub_u32 s61, s60, 32
 s_min_u32 s62, s71, 32
 s_add_u32 s60, s62, s61
 s_mov_b32 s48, 7
 s_cmp_lt_u32 s60, 32
 s_cbranch_scc1 L_tk_ok
 s_sub_u32 s61, s60, 32
 s_mov_b32 s48, 8
 s_mov_b32 s60, 0
L_tk_ok:
 s_lshl_b32 s3, s48, 5
 s_add_u32 s3, s3, s60
 v_mov_b32 v1, s3
 ds_write_b32 v2, v1
 s_waitcnt lgkmcnt(0)
L_tk_wait:
 s_barrier
 v_mov_b32 v2, 0
 ds_read_b32 v1, v2
 s_waitcnt lgkmcnt(0)
 v_readfirstlane_b32 s101, v1
 s_barrier
 s_mov_b32 s51, 0
 s_cmp_ge_u32 s101, 256
 s_cbranch_scc1 L_bail
 s_lshr_b32 s48, s101, 5
 s_and_b32 s48, s48, 7
 s_and_b32 s49, s101, 31
 s_cmp_ge_u32 s48, 4
 s_cbranch_scc1 L_hi
 s_cmp_ge_u32 s49, 24
 s_cbranch_scc1 L_lo2
 s_cmp_ge_u32 s48, 2
 s_cbranch_scc1 L_lo1
 s_cmp_lt_u32 s49, 16
 s_cbranch_scc1 L_ch_far
 s_branch L_vr_far
L_lo1:
 s_lshl_b32 s3, s48, 3
 s_add_u32 s3, s3, s49
 s_add_u32 s82, s3, 56
 s_mov_b32 s83, 4
 s_cmp_lt_u32 s49, 8
 s_cbranch_scc1 L_helper
 s_sub_u32 s82, s3, 24
 s_cmp_lt_u32 s49, 16
 s_cbranch_scc1 L_late
 s_sub_u32 s82, s3, 16
 s_mov_b32 s83, 2
 s_branch L_helper
L_lo2:
 s_lshl_b32 s82, s48, 1
 s_add_u32 s82, s82, s49
 s_add_u32 s82, s82, 58
 s_mov_b32 s83, 3
 s_cmp_ge_u32 s49, 30
 s_cbranch_scc1 L_helper
 s_lshl_b32 s52, s48, 2
 s_add_u32 s52, s52, s49
 s_sub_u32 s52, s52, 24
 s_mov_b32 s82, s52
 s_mov_b32 s83, 0
 s_cmp_lt_u32 s49, 28
 s_cbranch_scc1 L_helper
 s_lshl_b32 s3, s48, 1
 s_add_u32 s3, s3, s49
 s_add_u32 s3, s3, 4
 s_branch L_wo_idx
L_hi:
 s_mul_i32 s3, s48, 24
 s_add_u32 s3, s3, s49
 s_sub_u32 s3, s3, 96
 s_cmp_lt_u32 s49, 24
 s_cbranch_scc1 L_qkv_idx
 s_lshl_b32 s3, s48, 3
 s_add_u32 s3, s3, s49
 s_sub_u32 s3, s3, 56
L_wo_idx:
 s_mul_i32 s52, s3, 13108
 s_lshr_b32 s52, s52, 16
 s_mul_i32 s53, s52, 5
 s_sub_u32 s53, s3, s53
 s_add_u32 s82, s3, 32
 s_mov_b32 s83, 1
 s_cmp_ge_u32 s3, 32
 s_cbranch_scc1 L_wo_pair
 s_lshr_b32 s52, s3, 3
 s_lshl_b32 s52, s52, 1
 s_and_b32 s53, s3, 7
 s_cmp_lt_u32 s53, 5
 s_cbranch_scc1 L_helper
 s_add_u32 s52, s52, 1
 s_sub_u32 s53, s53, 5
 s_cmp_eq_u32 s53, 2
 s_cselect_b32 s53, 3, s53
 s_branch L_helper
L_wo_pair:
 s_and_b32 s53, s3, 1
 s_lshl_b32 s53, s53, 1
 s_add_u32 s53, s53, 2
 s_and_b32 s52, s3, 2
 s_lshl_b32 s52, s52, 1
 s_bfe_u32 s3, s3, 0x10002
 s_lshl_b32 s3, s3, 1
 s_add_u32 s52, s52, s3
 s_add_u32 s52, s52, 1
 s_branch L_helper
L_qkv_idx:
 s_mul_i32 s52, s3, 21846
 s_lshr_b32 s52, s52, 16
 s_mul_i32 s53, s52, 3
 s_sub_u32 s53, s3, s53
 s_mov_b32 s8, s24
 s_and_b32 s9, s25, 0xffff
 s_mov_b32 s10, 5242880
 s_mov_b32 s11, 0x00020000
 s_cmp_eq_u32 s53, 2
 s_cbranch_scc1 L_qkvv
 s_cmp_eq_u32 s53, 0
 s_cselect_b32 s8, s20, s22
 s_cselect_b32 s9, s21, s23
 s_and_b32 s9, s9, 0xffff
 s_branch L_qkvq
L_ch_far:
 s_branch L_ch
L_vr_far:
 s_branch L_vr
L_conv0:
 s_mov_b32 s8, s38
 s_and_b32 s9, s39, 0xffff
 s_mov_b32 s10, 2621440
 s_mov_b32 s11, 0x00020000
 s_mov_b32 s12, s40
 s_and_b32 s13, s41, 0xffff
 s_mov_b32 s14, 1280
 s_mov_b32 s15, 0x00020000
 v_lshlrev_b32 v130, 4, v0
 v_add_u32 v7, s71, v130
 v_mov_b32 v8, 0
 v_mov_b32 v9, 0
 v_mov_b32 v10, 0
 v_mov_b32 v11, 0
 s_mov_b32 exec_hi, 0
 ds_write_b128 v7, v[8:11] offset:0
 s_mov_b32 exec_lo, 3
 ds_write_b128 v7, v[8:11] offset:4608
 ds_write_b128 v7, v[8:11] offset:8768
 s_mov_b64 exec, -1
 v_and_b32 v8, 15, v0
 v_lshrrev_b32 v9, 5, v0
 v_sub_u32 v10, v8, v9
 v_lshlrev_b32 v10, 5, v10
 v_and_b32 v11, 16, v0
 v_add_u32 v10, v10, v11
 s_add_u32 s3, s71, 64
 v_add_u32 v14, s3, v10
 v_lshlrev_b32 v10, 5, v9
 v_lshl_add_u32 v10, v8, 1, v10
 v_sub_u32 v10, v10, v11
 v_and_b32 v11, 1, v0
 v_cmp_eq_u32 vcc, 1, v11
 v_mov_b32 v12, 8784
 v_mov_b32 v11, 4626
 s_nop 0
 v_cndmask_b32 v11, v12, v11, vcc
 v_add3_u32 v16, v10, v11, s71
 v_add_u32 v17, 512, v16
 v_add_u32 v18, 1024, v16
 v_add_u32 v19, 1536, v16
 v_lshlrev_b32 v10, 5, v8
 v_lshl_add_u32 v10, v9, 4, v10
 v_and_b32 v11, 16, v0
 v_lshrrev_b32 v11, 1, v11
 v_xor_b32 v11, 8, v11
 s_add_u32 s3, s71, 512
 v_add3_u32 v15, v10, v11, s3
 v_and_b32 v10, 1, v0
 v_lshlrev_b32 v10, 4, v10
 v_lshrrev_b32 v11, 4, v0
 v_lshl_add_u32 v10, v11, 2, v10
 s_mov_b32 s3, 40960
 v_mul_lo_u32 v13, v10, s3
 v_lshrrev_b32 v11, 1, v8
 v_lshl_add_u32 v13, v11, 3, v13
 s_cmp_lg_u32 s50, 0
 s_cbranch_scc1 L_ww_1
 s_mov_b32 s96, s44
 s_and_b32 s97, s45, 0xffff
 s_mov_b32 s98, 256
 s_mov_b32 s99, 0x00020000
 v_mov_b32 v24, 196
 s_mov_b32 s51, 0
 s_mov_b64 exec, 1
L_wb_2:
 buffer_load_dword v25, v24, s[96:99], 0 offen sc1
 s_waitcnt vmcnt(0)
 v_cmp_eq_u32 vcc, 0, v25
 s_cbranch_vccz L_wbd_3
 s_sleep 2
 s_add_u32 s51, s51, 1
 s_cmp_lt_u32 s51, 131072
 s_cbranch_scc1 L_wb_2
 s_branch L_bail
L_wbd_3:
 s_mov_b64 exec, -1
L_ww_1:
 s_barrier
 s_lshl_b32 s3, s70, 12
 s_add_u32 s3, s3, 198180864
 buffer_load_dwordx4 v[104:107], v130, s[4:7], s3 offen offset:0 sc1
 buffer_load_dwordx4 v[108:111], v130, s[4:7], s3 offen offset:1024 sc1
 s_waitcnt vmcnt(0)
L_cv_4:
 s_waitcnt vmcnt(4)
 ds_write_b128 v7, v[104:107] offset:512
 ds_write_b128 v7, v[96:99] offset:4640
 ds_write_b128 v7, v[112:115] offset:8800
 ds_write_b128 v7, v[108:111] offset:1536
 ds_write_b128 v7, v[100:103] offset:5664
 ds_write_b128 v7, v[116:119] offset:9824
 v_lshlrev_b32 v8, 16, v96
 v_lshlrev_b32 v12, 16, v128
 s_mov_b64 exec, 1
 ds_write_b32 v7, v8 offset:8796
 s_mov_b64 exec, -1
 s_lshl_b32 s72, s70, 6
 s_add_u32 s72, s72, 200802304
 s_add_u32 s70, s70, s69
 s_waitcnt lgkmcnt(0)
 s_lshl_b32 s73, s70, 12
 s_add_u32 s74, s73, 2
 buffer_load_dwordx4 v[96:99], v130, s[8:11], s73 offen offset:0
 buffer_load_dwordx4 v[100:103], v130, s[8:11], s73 offen offset:1024
 buffer_load_dwordx4 v[112:115], v130, s[8:11], s74 offen offset:0
 buffer_load_dwordx4 v[116:119], v130, s[8:11], s74 offen offset:1024
 s_lshl_b32 s3, s70, 1
 buffer_load_ushort v128, off, s[12:15], s3
 s_lshl_b32 s3, s70, 12
 s_add_u32 s3, s3, 198180864
 buffer_load_dwordx4 v[104:107], v130, s[4:7], s3 offen offset:0 sc1
 buffer_load_dwordx4 v[108:111], v130, s[4:7], s3 offen offset:1024 sc1
 ds_read_b128 v[32:35], v14 offset:448
 ds_read2_b32 v[64:65], v16 offset0:0 offset1:1
 ds_read2_b32 v[66:67], v16 offset0:2 offset1:3
 ds_read_b128 v[36:39], v14 offset:960
 ds_read2_b32 v[68:69], v17 offset0:0 offset1:1
 ds_read2_b32 v[70:71], v17 offset0:2 offset1:3
 ds_read_b128 v[40:43], v14 offset:1472
 ds_read2_b32 v[72:73], v18 offset0:0 offset1:1
 ds_read2_b32 v[74:75], v18 offset0:2 offset1:3
 ds_read_b128 v[44:47], v14 offset:1984
 ds_read2_b32 v[76:77], v19 offset0:0 offset1:1
 ds_read2_b32 v[78:79], v19 offset0:2 offset1:3
 s_waitcnt lgkmcnt(0)
 v_mfma_f32_16x16x32_bf16 v[144:147], v[64:67], v[32:35], 0
 ds_read_b128 v[176:179], v14 offset:384
 ds_read2_b32 v[208:209], v16 offset0:16 offset1:17
 v_mfma_f32_16x16x32_bf16 v[148:151], v[64:67], v[36:39], 0
 ds_read2_b32 v[210:211], v16 offset0:18 offset1:19
 ds_read_b128 v[180:183], v14 offset:896
 v_mfma_f32_16x16x32_bf16 v[152:155], v[64:67], v[40:43], 0
 ds_read2_b32 v[212:213], v17 offset0:16 offset1:17
 ds_read2_b32 v[214:215], v17 offset0:18 offset1:19
 v_mfma_f32_16x16x32_bf16 v[156:159], v[64:67], v[44:47], 0
 ds_read_b128 v[184:187], v14 offset:1408
 ds_read2_b32 v[216:217], v18 offset0:16 offset1:17
 v_mfma_f32_16x16x32_bf16 v[148:151], v[68:71], v[32:35], v[148:151]
 ds_read2_b32 v[218:219], v18 offset0:18 offset1:19
 ds_read_b128 v[188:191], v14 offset:1920
 v_mfma_f32_16x16x32_bf16 v[152:155], v[68:71], v[36:39], v[152:155]
 ds_read2_b32 v[220:221], v19 offset0:16 offset1:17
 ds_read2_b32 v[222:223], v19 offset0:18 offset1:19
 v_mfma_f32_16x16x32_bf16 v[156:159], v[68:71], v[40:43], v[156:159]
 v_mfma_f32_16x16x32_bf16 v[152:155], v[72:75], v[32:35], v[152:155]
 v_mfma_f32_16x16x32_bf16 v[156:159], v[72:75], v[36:39], v[156:159]
 v_mfma_f32_16x16x32_bf16 v[156:159], v[76:79], v[32:35], v[156:159]
 s_waitcnt lgkmcnt(0)
 v_mfma_f32_16x16x32_bf16 v[144:147], v[208:211], v[176:179], v[144:147]
 ds_read_b128 v[32:35], v14 offset:320
 ds_read2_b32 v[64:65], v16 offset0:32 offset1:33
 v_mfma_f32_16x16x32_bf16 v[148:151], v[208:211], v[180:183], v[148:151]
 ds_read2_b32 v[66:67], v16 offset0:34 offset1:35
 ds_read_b128 v[36:39], v14 offset:832
 v_mfma_f32_16x16x32_bf16 v[152:155], v[208:211], v[184:187], v[152:155]
 ds_read2_b32 v[68:69], v17 offset0:32 offset1:33
 ds_read2_b32 v[70:71], v17 offset0:34 offset1:35
 v_mfma_f32_16x16x32_bf16 v[156:159], v[208:211], v[188:191], v[156:159]
 ds_read_b128 v[40:43], v14 offset:1344
 ds_read2_b32 v[72:73], v18 offset0:32 offset1:33
 v_mfma_f32_16x16x32_bf16 v[148:151], v[212:215], v[176:179], v[148:151]
 ds_read2_b32 v[74:75], v18 offset0:34 offset1:35
 ds_read_b128 v[44:47], v14 offset:1856
 v_mfma_f32_16x16x32_bf16 v[152:155], v[212:215], v[180:183], v[152:155]
 ds_read2_b32 v[76:77], v19 offset0:32 offset1:33
 ds_read2_b32 v[78:79], v19 offset0:34 offset1:35
 v_mfma_f32_16x16x32_bf16 v[156:159], v[212:215], v[184:187], v[156:159]
 v_mfma_f32_16x16x32_bf16 v[152:155], v[216:219], v[176:179], v[152:155]
 v_mfma_f32_16x16x32_bf16 v[156:159], v[216:219], v[180:183], v[156:159]
 v_mfma_f32_16x16x32_bf16 v[156:159], v[220:223], v[176:179], v[156:159]
 s_waitcnt lgkmcnt(0)
 v_mfma_f32_16x16x32_bf16 v[144:147], v[64:67], v[32:35], v[144:147]
 ds_read_b128 v[176:179], v14 offset:256
 ds_read2_b32 v[208:209], v16 offset0:48 offset1:49
 v_mfma_f32_16x16x32_bf16 v[148:151], v[64:67], v[36:39], v[148:151]
 ds_read2_b32 v[210:211], v16 offset0:50 offset1:51
 ds_read_b128 v[180:183], v14 offset:768
 v_mfma_f32_16x16x32_bf16 v[152:155], v[64:67], v[40:43], v[152:155]
 ds_read2_b32 v[212:213], v17 offset0:48 offset1:49
 ds_read2_b32 v[214:215], v17 offset0:50 offset1:51
 v_mfma_f32_16x16x32_bf16 v[156:159], v[64:67], v[44:47], v[156:159]
 ds_read_b128 v[184:187], v14 offset:1280
 ds_read2_b32 v[216:217], v18 offset0:48 offset1:49
 v_mfma_f32_16x16x32_bf16 v[148:151], v[68:71], v[32:35], v[148:151]
 ds_read2_b32 v[218:219], v18 offset0:50 offset1:51
 ds_read_b128 v[188:191], v14 offset:1792
 v_mfma_f32_16x16x32_bf16 v[152:155], v[68:71], v[36:39], v[152:155]
 ds_read2_b32 v[220:221], v19 offset0:48 offset1:49
 ds_read2_b32 v[222:223], v19 offset0:50 offset1:51
 v_mfma_f32_16x16x32_bf16 v[156:159], v[68:71], v[40:43], v[156:159]
 v_mfma_f32_16x16x32_bf16 v[152:155], v[72:75], v[32:35], v[152:155]
 v_mfma_f32_16x16x32_bf16 v[156:159], v[72:75], v[36:39], v[156:159]
 v_mfma_f32_16x16x32_bf16 v[156:159], v[76:79], v[32:35], v[156:159]
 s_waitcnt lgkmcnt(0)
 v_mfma_f32_16x16x32_bf16 v[144:147], v[208:211], v[176:179], v[144:147]
 ds_read_b128 v[32:35], v14 offset:192
 ds_read2_b32 v[64:65], v16 offset0:64 offset1:65
 v_mfma_f32_16x16x32_bf16 v[148:151], v[208:211], v[180:183], v[148:151]
 ds_read2_b32 v[66:67], v16 offset0:66 offset1:67
 ds_read_b128 v[36:39], v14 offset:704
 v_mfma_f32_16x16x32_bf16 v[152:155], v[208:211], v[184:187], v[152:155]
 ds_read2_b32 v[68:69], v17 offset0:64 offset1:65
 ds_read2_b32 v[70:71], v17 offset0:66 offset1:67
 v_mfma_f32_16x16x32_bf16 v[156:159], v[208:211], v[188:191], v[156:159]
 ds_read_b128 v[40:43], v14 offset:1216
 ds_read2_b32 v[72:73], v18 offset0:64 offset1:65
 v_mfma_f32_16x16x32_bf16 v[148:151], v[212:215], v[176:179], v[148:151]
 ds_read2_b32 v[74:75], v18 offset0:66 offset1:67
 ds_read_b128 v[44:47], v14 offset:1728
 v_mfma_f32_16x16x32_bf16 v[152:155], v[212:215], v[180:183], v[152:155]
 ds_read2_b32 v[76:77], v19 offset0:64 offset1:65
 ds_read2_b32 v[78:79], v19 offset0:66 offset1:67
 v_mfma_f32_16x16x32_bf16 v[156:159], v[212:215], v[184:187], v[156:159]
 v_mfma_f32_16x16x32_bf16 v[152:155], v[216:219], v[176:179], v[152:155]
 v_mfma_f32_16x16x32_bf16 v[156:159], v[216:219], v[180:183], v[156:159]
 v_mfma_f32_16x16x32_bf16 v[156:159], v[220:223], v[176:179], v[156:159]
 s_waitcnt lgkmcnt(0)
 v_mfma_f32_16x16x32_bf16 v[144:147], v[64:67], v[32:35], v[144:147]
 ds_read_b128 v[176:179], v14 offset:128
 ds_read2_b32 v[208:209], v16 offset0:80 offset1:81
 v_mfma_f32_16x16x32_bf16 v[148:151], v[64:67], v[36:39], v[148:151]
 ds_read2_b32 v[210:211], v16 offset0:82 offset1:83
 ds_read_b128 v[180:183], v14 offset:640
 v_mfma_f32_16x16x32_bf16 v[152:155], v[64:67], v[40:43], v[152:155]
 ds_read2_b32 v[212:213], v17 offset0:80 offset1:81
 ds_read2_b32 v[214:215], v17 offset0:82 offset1:83
 v_mfma_f32_16x16x32_bf16 v[156:159], v[64:67], v[44:47], v[156:159]
 ds_read_b128 v[184:187], v14 offset:1152
 ds_read2_b32 v[216:217], v18 offset0:80 offset1:81
 v_mfma_f32_16x16x32_bf16 v[148:151], v[68:71], v[32:35], v[148:151]
 ds_read2_b32 v[218:219], v18 offset0:82 offset1:83
 ds_read_b128 v[188:191], v14 offset:1664
 v_mfma_f32_16x16x32_bf16 v[152:155], v[68:71], v[36:39], v[152:155]
 ds_read2_b32 v[220:221], v19 offset0:80 offset1:81
 ds_read2_b32 v[222:223], v19 offset0:82 offset1:83
 v_mfma_f32_16x16x32_bf16 v[156:159], v[68:71], v[40:43], v[156:159]
 v_mfma_f32_16x16x32_bf16 v[152:155], v[72:75], v[32:35], v[152:155]
 v_mfma_f32_16x16x32_bf16 v[156:159], v[72:75], v[36:39], v[156:159]
 v_mfma_f32_16x16x32_bf16 v[156:159], v[76:79], v[32:35], v[156:159]
 s_waitcnt lgkmcnt(0)
 v_mfma_f32_16x16x32_bf16 v[144:147], v[208:211], v[176:179], v[144:147]
 ds_read_b128 v[32:35], v14 offset:64
 ds_read2_b32 v[64:65], v16 offset0:96 offset1:97
 v_mfma_f32_16x16x32_bf16 v[148:151], v[208:211], v[180:183], v[148:151]
 ds_read2_b32 v[66:67], v16 offset0:98 offset1:99
 ds_read_b128 v[36:39], v14 offset:576
 v_mfma_f32_16x16x32_bf16 v[152:155], v[208:211], v[184:187], v[152:155]
 ds_read2_b32 v[68:69], v17 offset0:96 offset1:97
 ds_read2_b32 v[70:71], v17 offset0:98 offset1:99
 v_mfma_f32_16x16x32_bf16 v[156:159], v[208:211], v[188:191], v[156:159]
 ds_read_b128 v[40:43], v14 offset:1088
 ds_read2_b32 v[72:73], v18 offset0:96 offset1:97
 v_mfma_f32_16x16x32_bf16 v[148:151], v[212:215], v[176:179], v[148:151]
 ds_read2_b32 v[74:75], v18 offset0:98 offset1:99
 ds_read_b128 v[44:47], v14 offset:1600
 v_mfma_f32_16x16x32_bf16 v[152:155], v[212:215], v[180:183], v[152:155]
 ds_read2_b32 v[76:77], v19 offset0:96 offset1:97
 ds_read2_b32 v[78:79], v19 offset0:98 offset1:99
 v_mfma_f32_16x16x32_bf16 v[156:159], v[212:215], v[184:187], v[156:159]
 v_mfma_f32_16x16x32_bf16 v[152:155], v[216:219], v[176:179], v[152:155]
 v_mfma_f32_16x16x32_bf16 v[156:159], v[216:219], v[180:183], v[156:159]
 v_mfma_f32_16x16x32_bf16 v[156:159], v[220:223], v[176:179], v[156:159]
 s_waitcnt lgkmcnt(0)
 v_mfma_f32_16x16x32_bf16 v[144:147], v[64:67], v[32:35], v[144:147]
 ds_read_b128 v[176:179], v14 offset:0
 ds_read2_b32 v[208:209], v16 offset0:112 offset1:113
 v_mfma_f32_16x16x32_bf16 v[148:151], v[64:67], v[36:39], v[148:151]
 ds_read2_b32 v[210:211], v16 offset0:114 offset1:115
 ds_read_b128 v[180:183], v14 offset:512
 v_mfma_f32_16x16x32_bf16 v[152:155], v[64:67], v[40:43], v[152:155]
 ds_read2_b32 v[212:213], v17 offset0:112 offset1:113
 ds_read2_b32 v[214:215], v17 offset0:114 offset1:115
 v_mfma_f32_16x16x32_bf16 v[156:159], v[64:67], v[44:47], v[156:159]
 ds_read_b128 v[184:187], v14 offset:1024
 ds_read2_b32 v[216:217], v18 offset0:112 offset1:113
 v_mfma_f32_16x16x32_bf16 v[148:151], v[68:71], v[32:35], v[148:151]
 ds_read2_b32 v[218:219], v18 offset0:114 offset1:115
 ds_read_b128 v[188:191], v14 offset:1536
 v_mfma_f32_16x16x32_bf16 v[152:155], v[68:71], v[36:39], v[152:155]
 ds_read2_b32 v[220:221], v19 offset0:112 offset1:113
 ds_read2_b32 v[222:223], v19 offset0:114 offset1:115
 v_mfma_f32_16x16x32_bf16 v[156:159], v[68:71], v[40:43], v[156:159]
 v_mfma_f32_16x16x32_bf16 v[152:155], v[72:75], v[32:35], v[152:155]
 v_mfma_f32_16x16x32_bf16 v[156:159], v[72:75], v[36:39], v[156:159]
 v_mfma_f32_16x16x32_bf16 v[156:159], v[76:79], v[32:35], v[156:159]
 s_waitcnt lgkmcnt(0)
 v_mfma_f32_16x16x32_bf16 v[144:147], v[208:211], v[176:179], v[144:147]
 ds_read_b64 v[32:33], v15 offset:0
 ds_read_b64 v[34:35], v15 offset:512
 v_mfma_f32_16x16x32_bf16 v[148:151], v[208:211], v[180:183], v[148:151]
 ds_read_b64 v[36:37], v15 offset:1024
 ds_read_b64 v[38:39], v15 offset:1536
 v_mfma_f32_16x16x32_bf16 v[152:155], v[208:211], v[184:187], v[152:155]
 v_mfma_f32_16x16x32_bf16 v[156:159], v[208:211], v[188:191], v[156:159]
 v_mfma_f32_16x16x32_bf16 v[148:151], v[212:215], v[176:179], v[148:151]
 v_mfma_f32_16x16x32_bf16 v[152:155], v[212:215], v[180:183], v[152:155]
 v_mfma_f32_16x16x32_bf16 v[156:159], v[212:215], v[184:187], v[156:159]
 v_mfma_f32_16x16x32_bf16 v[152:155], v[216:219], v[176:179], v[152:155]
 v_mfma_f32_16x16x32_bf16 v[156:159], v[216:219], v[180:183], v[156:159]
 v_mfma_f32_16x16x32_bf16 v[156:159], v[220:223], v[176:179], v[156:159]
 s_waitcnt lgkmcnt(0)
 v_and_b32 v64, 0xffff0000, v33
 v_lshlrev_b32 v65, 16, v33
 v_and_b32 v66, 0xffff0000, v32
 v_lshlrev_b32 v67, 16, v32
 v_mul_f32 v64, v64, v12
 v_mul_f32 v65, v65, v12
 v_mul_f32 v66, v66, v12
 v_mul_f32 v67, v67, v12
 v_and_b32 v68, 0xffff0000, v35
 v_lshlrev_b32 v69, 16, v35
 v_and_b32 v70, 0xffff0000, v34
 v_lshlrev_b32 v71, 16, v34
 v_mul_f32 v68, v68, v12
 v_mul_f32 v69, v69, v12
 v_mul_f32 v70, v70, v12
 v_mul_f32 v71, v71, v12
 v_and_b32 v72, 0xffff0000, v37
 v_lshlrev_b32 v73, 16, v37
 v_and_b32 v74, 0xffff0000, v36
 v_lshlrev_b32 v75, 16, v36
 v_mul_f32 v72, v72, v12
 v_mul_f32 v73, v73, v12
 v_mul_f32 v74, v74, v12
 v_mul_f32 v75, v75, v12
 v_and_b32 v76, 0xffff0000, v39
 v_lshlrev_b32 v77, 16, v39
 v_and_b32 v78, 0xffff0000, v38
 v_lshlrev_b32 v79, 16, v38
 v_mul_f32 v76, v76, v12
 v_mul_f32 v77, v77, v12
 v_mul_f32 v78, v78, v12
 v_mul_f32 v79, v79, v12
 v_cvt_pk_bf16_f32 v8, v64, v65
 v_lshlrev_b32 v64, 16, v8
 v_and_b32 v65, 0xffff0000, v8
 v_cvt_pk_bf16_f32 v8, v66, v67
 v_lshlrev_b32 v66, 16, v8
 v_and_b32 v67, 0xffff0000, v8
 v_cvt_pk_bf16_f32 v8, v68, v69
 v_lshlrev_b32 v68, 16, v8
 v_and_b32 v69, 0xffff0000, v8
 v_cvt_pk_bf16_f32 v8, v70, v71
 v_lshlrev_b32 v70, 16, v8
 v_and_b32 v71, 0xffff0000, v8
 v_cvt_pk_bf16_f32 v8, v72, v73
 v_lshlrev_b32 v72, 16, v8
 v_and_b32 v73, 0xffff0000, v8
 v_cvt_pk_bf16_f32 v8, v74, v75
 v_lshlrev_b32 v74, 16, v8
 v_and_b32 v75, 0xffff0000, v8
 v_cvt_pk_bf16_f32 v8, v76, v77
 v_lshlrev_b32 v76, 16, v8
 v_and_b32 v77, 0xffff0000, v8
 v_cvt_pk_bf16_f32 v8, v78, v79
 v_lshlrev_b32 v78, 16, v8
 v_and_b32 v79, 0xffff0000, v8
 v_cvt_pk_bf16_f32 v8, v144, v145
 v_lshlrev_b32 v144, 16, v8
 v_and_b32 v145, 0xffff0000, v8
 v_cvt_pk_bf16_f32 v8, v146, v147
 v_lshlrev_b32 v146, 16, v8
 v_and_b32 v147, 0xffff0000, v8
 v_cvt_pk_bf16_f32 v8, v148, v149
 v_lshlrev_b32 v148, 16, v8
 v_and_b32 v149, 0xffff0000, v8
 v_cvt_pk_bf16_f32 v8, v150, v151
 v_lshlrev_b32 v150, 16, v8
 v_and_b32 v151, 0xffff0000, v8
 v_cvt_pk_bf16_f32 v8, v152, v153
 v_lshlrev_b32 v152, 16, v8
 v_and_b32 v153, 0xffff0000, v8
 v_cvt_pk_bf16_f32 v8, v154, v155
 v_lshlrev_b32 v154, 16, v8
 v_and_b32 v155, 0xffff0000, v8
 v_cvt_pk_bf16_f32 v8, v156, v157
 v_lshlrev_b32 v156, 16, v8
 v_and_b32 v157, 0xffff0000, v8
 v_cvt_pk_bf16_f32 v8, v158, v159
 v_lshlrev_b32 v158, 16, v8
 v_and_b32 v159, 0xffff0000, v8
 v_pk_add_f32 v[144:145], v[144:145], v[64:65]
 v_pk_add_f32 v[146:147], v[146:147], v[66:67]
 v_pk_add_f32 v[148:149], v[148:149], v[68:69]
 v_pk_add_f32 v[150:151], v[150:151], v[70:71]
 v_pk_add_f32 v[152:153], v[152:153], v[72:73]
 v_pk_add_f32 v[154:155], v[154:155], v[74:75]
 v_pk_add_f32 v[156:157], v[156:157], v[76:77]
 v_pk_add_f32 v[158:159], v[158:159], v[78:79]
 v_cvt_pk_bf16_f32 v160, v144, v148
 v_cvt_pk_bf16_f32 v161, v152, v156
 buffer_store_dwordx2 v[160:161], v13, s[4:7], s72 offen sc1
 s_add_u32 s72, s72, 40960
 v_cvt_pk_bf16_f32 v162, v145, v149
 v_cvt_pk_bf16_f32 v163, v153, v157
 buffer_store_dwordx2 v[162:163], v13, s[4:7], s72 offen sc1
 s_add_u32 s72, s72, 40960
 v_cvt_pk_bf16_f32 v164, v146, v150
 v_cvt_pk_bf16_f32 v165, v154, v158
 buffer_store_dwordx2 v[164:165], v13, s[4:7], s72 offen sc1
 s_add_u32 s72, s72, 40960
 v_cvt_pk_bf16_f32 v166, v147, v151
 v_cvt_pk_bf16_f32 v167, v155, v159
 buffer_store_dwordx2 v[166:167], v13, s[4:7], s72 offen sc1
 s_add_u32 s72, s72, 40960
 s_cmp_lt_u32 s70, 640
 s_cbranch_scc1 L_cv_4
 s_setpc_b64 s[76:77]
L_conv1:
 s_mov_b32 s8, s38
 s_and_b32 s9, s39, 0xffff
 s_mov_b32 s10, 2621440
 s_mov_b32 s11, 0x00020000
 s_mov_b32 s12, s40
 s_and_b32 s13, s41, 0xffff
 s_mov_b32 s14, 1280
 s_mov_b32 s15, 0x00020000
 v_lshlrev_b32 v130, 4, v0
 v_add_u32 v7, s71, v130
 v_mov_b32 v8, 0
 v_mov_b32 v9, 0
 v_mov_b32 v10, 0
 v_mov_b32 v11, 0
 s_mov_b32 exec_hi, 0
 ds_write_b128 v7, v[8:11] offset:0
 s_mov_b32 exec_lo, 3
 ds_write_b128 v7, v[8:11] offset:4608
 ds_write_b128 v7, v[8:11] offset:8768
 s_mov_b64 exec, -1
 v_and_b32 v8, 15, v0
 v_lshrrev_b32 v9, 5, v0
 v_sub_u32 v10, v8, v9
 v_lshlrev_b32 v10, 5, v10
 v_and_b32 v11, 16, v0
 v_add_u32 v10, v10, v11
 s_add_u32 s3, s71, 64
 v_add_u32 v14, s3, v10
 v_lshlrev_b32 v10, 5, v9
 v_lshl_add_u32 v10, v8, 1, v10
 v_sub_u32 v10, v10, v11
 v_and_b32 v11, 1, v0
 v_cmp_eq_u32 vcc, 1, v11
 v_mov_b32 v12, 8784
 v_mov_b32 v11, 4626
 s_nop 0
 v_cndmask_b32 v11, v12, v11, vcc
 v_add3_u32 v16, v10, v11, s71
 v_add_u32 v17, 512, v16
 v_add_u32 v18, 1024, v16
 v_add_u32 v19, 1536, v16
 v_add_u32 v20, 2048, v16
 v_add_u32 v21, 2560, v16
 v_add_u32 v22, 3072, v16
 v_add_u32 v23, 3584, v16
 v_lshlrev_b32 v10, 5, v8
 v_lshl_add_u32 v10, v9, 4, v10
 v_and_b32 v11, 16, v0
 v_lshrrev_b32 v11, 1, v11
 v_xor_b32 v11, 8, v11
 s_add_u32 s3, s71, 512
 v_add3_u32 v15, v10, v11, s3
 v_and_b32 v10, 1, v0
 v_lshlrev_b32 v10, 4, v10
 v_lshrrev_b32 v11, 4, v0
 v_lshl_add_u32 v10, v11, 2, v10
 s_mov_b32 s3, 40960
 v_mul_lo_u32 v13, v10, s3
 v_lshrrev_b32 v11, 1, v8
 v_lshl_add_u32 v13, v11, 3, v13
 s_waitcnt vmcnt(0)
L_cv_5:
 s_waitcnt vmcnt(4)
 ds_write_b128 v7, v[240:243] offset:512
 ds_write_b128 v7, v[96:99] offset:4640
 ds_write_b128 v7, v[112:115] offset:8800
 ds_write_b128 v7, v[244:247] offset:1536
 ds_write_b128 v7, v[100:103] offset:5664
 ds_write_b128 v7, v[116:119] offset:9824
 ds_write_b128 v7, v[248:251] offset:2560
 ds_write_b128 v7, v[104:107] offset:6688
 ds_write_b128 v7, v[120:123] offset:10848
 ds_write_b128 v7, v[252:255] offset:3584
 ds_write_b128 v7, v[108:111] offset:7712
 ds_write_b128 v7, v[124:127] offset:11872
 v_lshlrev_b32 v8, 16, v96
 v_lshlrev_b32 v12, 16, v128
 s_mov_b64 exec, 1
 ds_write_b32 v7, v8 offset:8796
 s_mov_b64 exec, -1
 s_lshl_b32 s72, s70, 6
 s_add_u32 s72, s72, 202113024
 s_add_u32 s70, s70, s69
 s_waitcnt lgkmcnt(0)
 s_lshl_b32 s73, s70, 12
 s_add_u32 s74, s73, 2
 buffer_load_dwordx4 v[96:99], v130, s[8:11], s73 offen offset:0
 buffer_load_dwordx4 v[100:103], v130, s[8:11], s73 offen offset:1024
 buffer_load_dwordx4 v[104:107], v130, s[8:11], s73 offen offset:2048
 buffer_load_dwordx4 v[108:111], v130, s[8:11], s73 offen offset:3072
 buffer_load_dwordx4 v[112:115], v130, s[8:11], s74 offen offset:0
 buffer_load_dwordx4 v[116:119], v130, s[8:11], s74 offen offset:1024
 buffer_load_dwordx4 v[120:123], v130, s[8:11], s74 offen offset:2048
 buffer_load_dwordx4 v[124:127], v130, s[8:11], s74 offen offset:3072
 s_lshl_b32 s3, s70, 1
 buffer_load_ushort v128, off, s[12:15], s3
 s_lshl_b32 s3, s70, 12
 s_add_u32 s3, s3, 198180864
 buffer_load_dwordx4 v[240:243], v130, s[4:7], s3 offen offset:0 sc1
 buffer_load_dwordx4 v[244:247], v130, s[4:7], s3 offen offset:1024 sc1
 buffer_load_dwordx4 v[248:251], v130, s[4:7], s3 offen offset:2048 sc1
 buffer_load_dwordx4 v[252:255], v130, s[4:7], s3 offen offset:3072 sc1
 ds_read_b128 v[32:35], v14 offset:448
 ds_read2_b32 v[64:65], v16 offset0:0 offset1:1
 ds_read2_b32 v[66:67], v16 offset0:2 offset1:3
 ds_read_b128 v[36:39], v14 offset:960
 ds_read2_b32 v[68:69], v17 offset0:0 offset1:1
 ds_read2_b32 v[70:71], v17 offset0:2 offset1:3
 ds_read_b128 v[40:43], v14 offset:1472
 ds_read2_b32 v[72:73], v18 offset0:0 offset1:1
 ds_read2_b32 v[74:75], v18 offset0:2 offset1:3
 ds_read_b128 v[44:47], v14 offset:1984
 ds_read2_b32 v[76:77], v19 offset0:0 offset1:1
 ds_read2_b32 v[78:79], v19 offset0:2 offset1:3
 ds_read_b128 v[48:51], v14 offset:2496
 ds_read2_b32 v[80:81], v20 offset0:0 offset1:1
 ds_read2_b32 v[82:83], v20 offset0:2 offset1:3
 ds_read_b128 v[52:55], v14 offset:3008
 ds_read2_b32 v[84:85], v21 offset0:0 offset1:1
 ds_read2_b32 v[86:87], v21 offset0:2 offset1:3
 ds_read_b128 v[56:59], v14 offset:3520
 ds_read2_b32 v[88:89], v22 offset0:0 offset1:1
 ds_read2_b32 v[90:91], v22 offset0:2 offset1:3
 ds_read_b128 v[60:63], v14 offset:4032
 ds_read2_b32 v[92:93], v23 offset0:0 offset1:1
 ds_read2_b32 v[94:95], v23 offset0:2 offset1:3
 s_waitcnt lgkmcnt(0)
 v_mfma_f32_16x16x32_bf16 v[144:147], v[64:67], v[48:51], 0
 ds_read_b128 v[176:179], v14 offset:384
 v_mfma_f32_16x16x32_bf16 v[148:151], v[64:67], v[52:55], 0
 ds_read2_b32 v[208:209], v16 offset0:16 offset1:17
 v_mfma_f32_16x16x32_bf16 v[152:155], v[64:67], v[56:59], 0
 ds_read2_b32 v[210:211], v16 offset0:18 offset1:19
 v_mfma_f32_16x16x32_bf16 v[156:159], v[64:67], v[60:63], 0
 ds_read_b128 v[180:183], v14 offset:896
 v_mfma_f32_16x16x32_bf16 v[144:147], v[68:71], v[44:47], v[144:147]
 ds_read2_b32 v[212:213], v17 offset0:16 offset1:17
 v_mfma_f32_16x16x32_bf16 v[148:151], v[68:71], v[48:51], v[148:151]
 ds_read2_b32 v[214:215], v17 offset0:18 offset1:19
 v_mfma_f32_16x16x32_bf16 v[152:155], v[68:71], v[52:55], v[152:155]
 ds_read_b128 v[184:187], v14 offset:1408
 v_mfma_f32_16x16x32_bf16 v[156:159], v[68:71], v[56:59], v[156:159]
 ds_read2_b32 v[216:217], v18 offset0:16 offset1:17
 v_mfma_f32_16x16x32_bf16 v[144:147], v[72:75], v[40:43], v[144:147]
 ds_read2_b32 v[218:219], v18 offset0:18 offset1:19
 v_mfma_f32_16x16x32_bf16 v[148:151], v[72:75], v[44:47], v[148:151]
 ds_read_b128 v[188:191], v14 offset:1920
 v_mfma_f32_16x16x32_bf16 v[152:155], v[72:75], v[48:51], v[152:155]
 ds_read2_b32 v[220:221], v19 offset0:16 offset1:17
 v_mfma_f32_16x16x32_bf16 v[156:159], v[72:75], v[52:55], v[156:159]
 ds_read2_b32 v[222:223], v19 offset0:18 offset1:19
 v_mfma_f32_16x16x32_bf16 v[144:147], v[76:79], v[36:39], v[144:147]
 ds_read_b128 v[192:195], v14 offset:2432
 v_mfma_f32_16x16x32_bf16 v[148:151], v[76:79], v[40:43], v[148:151]
 ds_read2_b32 v[224:225], v20 offset0:16 offset1:17
 v_mfma_f32_16x16x32_bf16 v[152:155], v[76:79], v[44:47], v[152:155]
 ds_read2_b32 v[226:227], v20 offset0:18 offset1:19
 v_mfma_f32_16x16x32_bf16 v[156:159], v[76:79], v[48:51], v[156:159]
 ds_read_b128 v[196:199], v14 offset:2944
 v_mfma_f32_16x16x32_bf16 v[144:147], v[80:83], v[32:35], v[144:147]
 ds_read2_b32 v[228:229], v21 offset0:16 offset1:17
 v_mfma_f32_16x16x32_bf16 v[148:151], v[80:83], v[36:39], v[148:151]
 ds_read2_b32 v[230:231], v21 offset0:18 offset1:19
 v_mfma_f32_16x16x32_bf16 v[152:155], v[80:83], v[40:43], v[152:155]
 ds_read_b128 v[200:203], v14 offset:3456
 v_mfma_f32_16x16x32_bf16 v[156:159], v[80:83], v[44:47], v[156:159]
 ds_read2_b32 v[232:233], v22 offset0:16 offset1:17
 v_mfma_f32_16x16x32_bf16 v[148:151], v[84:87], v[32:35], v[148:151]
 ds_read2_b32 v[234:235], v22 offset0:18 offset1:19
 v_mfma_f32_16x16x32_bf16 v[152:155], v[84:87], v[36:39], v[152:155]
 ds_read_b128 v[204:207], v14 offset:3968
 v_mfma_f32_16x16x32_bf16 v[156:159], v[84:87], v[40:43], v[156:159]
 ds_read2_b32 v[236:237], v23 offset0:16 offset1:17
 v_mfma_f32_16x16x32_bf16 v[152:155], v[88:91], v[32:35], v[152:155]
 ds_read2_b32 v[238:239], v23 offset0:18 offset1:19
 v_mfma_f32_16x16x32_bf16 v[156:159], v[88:91], v[36:39], v[156:159]
 v_mfma_f32_16x16x32_bf16 v[156:159], v[92:95], v[32:35], v[156:159]
 s_waitcnt lgkmcnt(0)
 v_mfma_f32_16x16x32_bf16 v[144:147], v[208:211], v[192:195], v[144:147]
 ds_read_b128 v[32:35], v14 offset:320
 v_mfma_f32_16x16x32_bf16 v[148:151], v[208:211], v[196:199], v[148:151]
 ds_read2_b32 v[64:65], v16 offset0:32 offset1:33
 v_mfma_f32_16x16x32_bf16 v[152:155], v[208:211], v[200:203], v[152:155]
 ds_read2_b32 v[66:67], v16 offset0:34 offset1:35
 v_mfma_f32_16x16x32_bf16 v[156:159], v[208:211], v[204:207], v[156:159]
 ds_read_b128 v[36:39], v14 offset:832
 v_mfma_f32_16x16x32_bf16 v[144:147], v[212:215], v[188:191], v[144:147]
 ds_read2_b32 v[68:69], v17 offset0:32 offset1:33
 v_mfma_f32_16x16x32_bf16 v[148:151], v[212:215], v[192:195], v[148:151]
 ds_read2_b32 v[70:71], v17 offset0:34 offset1:35
 v_mfma_f32_16x16x32_bf16 v[152:155], v[212:215], v[196:199], v[152:155]
 ds_read_b128 v[40:43], v14 offset:1344
 v_mfma_f32_16x16x32_bf16 v[156:159], v[212:215], v[200:203], v[156:159]
 ds_read2_b32 v[72:73], v18 offset0:32 offset1:33
 v_mfma_f32_16x16x32_bf16 v[144:147], v[216:219], v[184:187], v[144:147]
 ds_read2_b32 v[74:75], v18 offset0:34 offset1:35
 v_mfma_f32_16x16x32_bf16 v[148:151], v[216:219], v[188:191], v[148:151]
 ds_read_b128 v[44:47], v14 offset:1856
 v_mfma_f32_16x16x32_bf16 v[152:155], v[216:219], v[192:195], v[152:155]
 ds_read2_b32 v[76:77], v19 offset0:32 offset1:33
 v_mfma_f32_16x16x32_bf16 v[156:159], v[216:219], v[196:199], v[156:159]
 ds_read2_b32 v[78:79], v19 offset0:34 offset1:35
 v_mfma_f32_16x16x32_bf16 v[144:147], v[220:223], v[180:183], v[144:147]
 ds_read_b128 v[48:51], v14 offset:2368
 v_mfma_f32_16x16x32_bf16 v[148:151], v[220:223], v[184:187], v[148:151]
 ds_read2_b32 v[80:81], v20 offset0:32 offset1:33
 v_mfma_f32_16x16x32_bf16 v[152:155], v[220:223], v[188:191], v[152:155]
 ds_read2_b32 v[82:83], v20 offset0:34 offset1:35
 v_mfma_f32_16x16x32_bf16 v[156:159], v[220:223], v[192:195], v[156:159]
 ds_read_b128 v[52:55], v14 offset:2880
 v_mfma_f32_16x16x32_bf16 v[144:147], v[224:227], v[176:179], v[144:147]
 ds_read2_b32 v[84:85], v21 offset0:32 offset1:33
 v_mfma_f32_16x16x32_bf16 v[148:151], v[224:227], v[180:183], v[148:151]
 ds_read2_b32 v[86:87], v21 offset0:34 offset1:35
 v_mfma_f32_16x16x32_bf16 v[152:155], v[224:227], v[184:187], v[152:155]
 ds_read_b128 v[56:59], v14 offset:3392
 v_mfma_f32_16x16x32_bf16 v[156:159], v[224:227], v[188:191], v[156:159]
 ds_read2_b32 v[88:89], v22 offset0:32 offset1:33
 v_mfma_f32_16x16x32_bf16 v[148:151], v[228:231], v[176:179], v[148:151]
 ds_read2_b32 v[90:91], v22 offset0:34 offset1:35
 v_mfma_f32_16x16x32_bf16 v[152:155], v[228:231], v[180:183], v[152:155]
 ds_read_b128 v[60:63], v14 offset:3904
 v_mfma_f32_16x16x32_bf16 v[156:159], v[228:231], v[184:187], v[156:159]
 ds_read2_b32 v[92:93], v23 offset0:32 offset1:33
 v_mfma_f32_16x16x32_bf16 v[152:155], v[232:235], v[176:179], v[152:155]
 ds_read2_b32 v[94:95], v23 offset0:34 offset1:35
 v_mfma_f32_16x16x32_bf16 v[156:159], v[232:235], v[180:183], v[156:159]
 v_mfma_f32_16x16x32_bf16 v[156:159], v[236:239], v[176:179], v[156:159]
 s_waitcnt lgkmcnt(0)
 v_mfma_f32_16x16x32_bf16 v[144:147], v[64:67], v[48:51], v[144:147]
 ds_read_b128 v[176:179], v14 offset:256
 v_mfma_f32_16x16x32_bf16 v[148:151], v[64:67], v[52:55], v[148:151]
 ds_read2_b32 v[208:209], v16 offset0:48 offset1:49
 v_mfma_f32_16x16x32_bf16 v[152:155], v[64:67], v[56:59], v[152:155]
 ds_read2_b32 v[210:211], v16 offset0:50 offset1:51
 v_mfma_f32_16x16x32_bf16 v[156:159], v[64:67], v[60:63], v[156:159]
 ds_read_b128 v[180:183], v14 offset:768
 v_mfma_f32_16x16x32_bf16 v[144:147], v[68:71], v[44:47], v[144:147]
 ds_read2_b32 v[212:213], v17 offset0:48 offset1:49
 v_mfma_f32_16x16x32_bf16 v[148:151], v[68:71], v[48:51], v[148:151]
 ds_read2_b32 v[214:215], v17 offset0:50 offset1:51
 v_mfma_f32_16x16x32_bf16 v[152:155], v[68:71], v[52:55], v[152:155]
 ds_read_b128 v[184:187], v14 offset:1280
 v_mfma_f32_16x16x32_bf16 v[156:159], v[68:71], v[56:59], v[156:159]
 ds_read2_b32 v[216:217], v18 offset0:48 offset1:49
 v_mfma_f32_16x16x32_bf16 v[144:147], v[72:75], v[40:43], v[144:147]
 ds_read2_b32 v[218:219], v18 offset0:50 offset1:51
 v_mfma_f32_16x16x32_bf16 v[148:151], v[72:75], v[44:47], v[148:151]
 ds_read_b128 v[188:191], v14 offset:1792
 v_mfma_f32_16x16x32_bf16 v[152:155], v[72:75], v[48:51], v[152:155]
 ds_read2_b32 v[220:221], v19 offset0:48 offset1:49
 v_mfma_f32_16x16x32_bf16 v[156:159], v[72:75], v[52:55], v[156:159]
 ds_read2_b32 v[222:223], v19 offset0:50 offset1:51
 v_mfma_f32_16x16x32_bf16 v[144:147], v[76:79], v[36:39], v[144:147]
 ds_read_b128 v[192:195], v14 offset:2304
 v_mfma_f32_16x16x32_bf16 v[148:151], v[76:79], v[40:43], v[148:151]
 ds_read2_b32 v[224:225], v20 offset0:48 offset1:49
 v_mfma_f32_16x16x32_bf16 v[152:155], v[76:79], v[44:47], v[152:155]
 ds_read2_b32 v[226:227], v20 offset0:50 offset1:51
 v_mfma_f32_16x16x32_bf16 v[156:159], v[76:79], v[48:51], v[156:159]
 ds_read_b128 v[196:199], v14 offset:2816
 v_mfma_f32_16x16x32_bf16 v[144:147], v[80:83], v[32:35], v[144:147]
 ds_read2_b32 v[228:229], v21 offset0:48 offset1:49
 v_mfma_f32_16x16x32_bf16 v[148:151], v[80:83], v[36:39], v[148:151]
 ds_read2_b32 v[230:231], v21 offset0:50 offset1:51
 v_mfma_f32_16x16x32_bf16 v[152:155], v[80:83], v[40:43], v[152:155]
 ds_read_b128 v[200:203], v14 offset:3328
 v_mfma_f32_16x16x32_bf16 v[156:159], v[80:83], v[44:47], v[156:159]
 ds_read2_b32 v[232:233], v22 offset0:48 offset1:49
 v_mfma_f32_16x16x32_bf16 v[148:151], v[84:87], v[32:35], v[148:151]
 ds_read2_b32 v[234:235], v22 offset0:50 offset1:51
 v_mfma_f32_16x16x32_bf16 v[152:155], v[84:87], v[36:39], v[152:155]
 ds_read_b128 v[204:207], v14 offset:3840
 v_mfma_f32_16x16x32_bf16 v[156:159], v[84:87], v[40:43], v[156:159]
 ds_read2_b32 v[236:237], v23 offset0:48 offset1:49
 v_mfma_f32_16x16x32_bf16 v[152:155], v[88:91], v[32:35], v[152:155]
 ds_read2_b32 v[238:239], v23 offset0:50 offset1:51
 v_mfma_f32_16x16x32_bf16 v[156:159], v[88:91], v[36:39], v[156:159]
 v_mfma_f32_16x16x32_bf16 v[156:159], v[92:95], v[32:35], v[156:159]
 s_waitcnt lgkmcnt(0)
 v_mfma_f32_16x16x32_bf16 v[144:147], v[208:211], v[192:195], v[144:147]
 ds_read_b128 v[32:35], v14 offset:192
 v_mfma_f32_16x16x32_bf16 v[148:151], v[208:211], v[196:199], v[148:151]
 ds_read2_b32 v[64:65], v16 offset0:64 offset1:65
 v_mfma_f32_16x16x32_bf16 v[152:155], v[208:211], v[200:203], v[152:155]
 ds_read2_b32 v[66:67], v16 offset0:66 offset1:67
 v_mfma_f32_16x16x32_bf16 v[156:159], v[208:211], v[204:207], v[156:159]
 ds_read_b128 v[36:39], v14 offset:704
 v_mfma_f32_16x16x32_bf16 v[144:147], v[212:215], v[188:191], v[144:147]
 ds_read2_b32 v[68:69], v17 offset0:64 offset1:65
 v_mfma_f32_16x16x32_bf16 v[148:151], v[212:215], v[192:195], v[148:151]
 ds_read2_b32 v[70:71], v17 offset0:66 offset1:67
 v_mfma_f32_16x16x32_bf16 v[152:155], v[212:215], v[196:199], v[152:155]
 ds_read_b128 v[40:43], v14 offset:1216
 v_mfma_f32_16x16x32_bf16 v[156:159], v[212:215], v[200:203], v[156:159]
 ds_read2_b32 v[72:73], v18 offset0:64 offset1:65
 v_mfma_f32_16x16x32_bf16 v[144:147], v[216:219], v[184:187], v[144:147]
 ds_read2_b32 v[74:75], v18 offset0:66 offset1:67
 v_mfma_f32_16x16x32_bf16 v[148:151], v[216:219], v[188:191], v[148:151]
 ds_read_b128 v[44:47], v14 offset:1728
 v_mfma_f32_16x16x32_bf16 v[152:155], v[216:219], v[192:195], v[152:155]
 ds_read2_b32 v[76:77], v19 offset0:64 offset1:65
 v_mfma_f32_16x16x32_bf16 v[156:159], v[216:219], v[196:199], v[156:159]
 ds_read2_b32 v[78:79], v19 offset0:66 offset1:67
 v_mfma_f32_16x16x32_bf16 v[144:147], v[220:223], v[180:183], v[144:147]
 ds_read_b128 v[48:51], v14 offset:2240
 v_mfma_f32_16x16x32_bf16 v[148:151], v[220:223], v[184:187], v[148:151]
 ds_read2_b32 v[80:81], v20 offset0:64 offset1:65
 v_mfma_f32_16x16x32_bf16 v[152:155], v[220:223], v[188:191], v[152:155]
 ds_read2_b32 v[82:83], v20 offset0:66 offset1:67
 v_mfma_f32_16x16x32_bf16 v[156:159], v[220:223], v[192:195], v[156:159]
 ds_read_b128 v[52:55], v14 offset:2752
 v_mfma_f32_16x16x32_bf16 v[144:147], v[224:227], v[176:179], v[144:147]
 ds_read2_b32 v[84:85], v21 offset0:64 offset1:65
 v_mfma_f32_16x16x32_bf16 v[148:151], v[224:227], v[180:183], v[148:151]
 ds_read2_b32 v[86:87], v21 offset0:66 offset1:67
 v_mfma_f32_16x16x32_bf16 v[152:155], v[224:227], v[184:187], v[152:155]
 ds_read_b128 v[56:59], v14 offset:3264
 v_mfma_f32_16x16x32_bf16 v[156:159], v[224:227], v[188:191], v[156:159]
 ds_read2_b32 v[88:89], v22 offset0:64 offset1:65
 v_mfma_f32_16x16x32_bf16 v[148:151], v[228:231], v[176:179], v[148:151]
 ds_read2_b32 v[90:91], v22 offset0:66 offset1:67
 v_mfma_f32_16x16x32_bf16 v[152:155], v[228:231], v[180:183], v[152:155]
 ds_read_b128 v[60:63], v14 offset:3776
 v_mfma_f32_16x16x32_bf16 v[156:159], v[228:231], v[184:187], v[156:159]
 ds_read2_b32 v[92:93], v23 offset0:64 offset1:65
 v_mfma_f32_16x16x32_bf16 v[152:155], v[232:235], v[176:179], v[152:155]
 ds_read2_b32 v[94:95], v23 offset0:66 offset1:67
 v_mfma_f32_16x16x32_bf16 v[156:159], v[232:235], v[180:183], v[156:159]
 v_mfma_f32_16x16x32_bf16 v[156:159], v[236:239], v[176:179], v[156:159]
 s_waitcnt lgkmcnt(0)
 v_mfma_f32_16x16x32_bf16 v[144:147], v[64:67], v[48:51], v[144:147]
 ds_read_b128 v[176:179], v14 offset:128
 v_mfma_f32_16x16x32_bf16 v[148:151], v[64:67], v[52:55], v[148:151]
 ds_read2_b32 v[208:209], v16 offset0:80 offset1:81
 v_mfma_f32_16x16x32_bf16 v[152:155], v[64:67], v[56:59], v[152:155]
 ds_read2_b32 v[210:211], v16 offset0:82 offset1:83
 v_mfma_f32_16x16x32_bf16 v[156:159], v[64:67], v[60:63], v[156:159]
 ds_read_b128 v[180:183], v14 offset:640
 v_mfma_f32_16x16x32_bf16 v[144:147], v[68:71], v[44:47], v[144:147]
 ds_read2_b32 v[212:213], v17 offset0:80 offset1:81
 v_mfma_f32_16x16x32_bf16 v[148:151], v[68:71], v[48:51], v[148:151]
 ds_read2_b32 v[214:215], v17 offset0:82 offset1:83
 v_mfma_f32_16x16x32_bf16 v[152:155], v[68:71], v[52:55], v[152:155]
 ds_read_b128 v[184:187], v14 offset:1152
 v_mfma_f32_16x16x32_bf16 v[156:159], v[68:71], v[56:59], v[156:159]
 ds_read2_b32 v[216:217], v18 offset0:80 offset1:81
 v_mfma_f32_16x16x32_bf16 v[144:147], v[72:75], v[40:43], v[144:147]
 ds_read2_b32 v[218:219], v18 offset0:82 offset1:83
 v_mfma_f32_16x16x32_bf16 v[148:151], v[72:75], v[44:47], v[148:151]
 ds_read_b128 v[188:191], v14 offset:1664
 v_mfma_f32_16x16x32_bf16 v[152:155], v[72:75], v[48:51], v[152:155]
 ds_read2_b32 v[220:221], v19 offset0:80 offset1:81
 v_mfma_f32_16x16x32_bf16 v[156:159], v[72:75], v[52:55], v[156:159]
 ds_read2_b32 v[222:223], v19 offset0:82 offset1:83
 v_mfma_f32_16x16x32_bf16 v[144:147], v[76:79], v[36:39], v[144:147]
 ds_read_b128 v[192:195], v14 offset:2176
 v_mfma_f32_16x16x32_bf16 v[148:151], v[76:79], v[40:43], v[148:151]
 ds_read2_b32 v[224:225], v20 offset0:80 offset1:81
 v_mfma_f32_16x16x32_bf16 v[152:155], v[76:79], v[44:47], v[152:155]
 ds_read2_b32 v[226:227], v20 offset0:82 offset1:83
 v_mfma_f32_16x16x32_bf16 v[156:159], v[76:79], v[48:51], v[156:159]
 ds_read_b128 v[196:199], v14 offset:2688
 v_mfma_f32_16x16x32_bf16 v[144:147], v[80:83], v[32:35], v[144:147]
 ds_read2_b32 v[228:229], v21 offset0:80 offset1:81
 v_mfma_f32_16x16x32_bf16 v[148:151], v[80:83], v[36:39], v[148:151]
 ds_read2_b32 v[230:231], v21 offset0:82 offset1:83
 v_mfma_f32_16x16x32_bf16 v[152:155], v[80:83], v[40:43], v[152:155]
 ds_read_b128 v[200:203], v14 offset:3200
 v_mfma_f32_16x16x32_bf16 v[156:159], v[80:83], v[44:47], v[156:159]
 ds_read2_b32 v[232:233], v22 offset0:80 offset1:81
 v_mfma_f32_16x16x32_bf16 v[148:151], v[84:87], v[32:35], v[148:151]
 ds_read2_b32 v[234:235], v22 offset0:82 offset1:83
 v_mfma_f32_16x16x32_bf16 v[152:155], v[84:87], v[36:39], v[152:155]
 ds_read_b128 v[204:207], v14 offset:3712
 v_mfma_f32_16x16x32_bf16 v[156:159], v[84:87], v[40:43], v[156:159]
 ds_read2_b32 v[236:237], v23 offset0:80 offset1:81
 v_mfma_f32_16x16x32_bf16 v[152:155], v[88:91], v[32:35], v[152:155]
 ds_read2_b32 v[238:239], v23 offset0:82 offset1:83
 v_mfma_f32_16x16x32_bf16 v[156:159], v[88:91], v[36:39], v[156:159]
 v_mfma_f32_16x16x32_bf16 v[156:159], v[92:95], v[32:35], v[156:159]
 s_waitcnt lgkmcnt(0)
 v_mfma_f32_16x16x32_bf16 v[144:147], v[208:211], v[192:195], v[144:147]
 ds_read_b128 v[32:35], v14 offset:64
 v_mfma_f32_16x16x32_bf16 v[148:151], v[208:211], v[196:199], v[148:151]
 ds_read2_b32 v[64:65], v16 offset0:96 offset1:97
 v_mfma_f32_16x16x32_bf16 v[152:155], v[208:211], v[200:203], v[152:155]
 ds_read2_b32 v[66:67], v16 offset0:98 offset1:99
 v_mfma_f32_16x16x32_bf16 v[156:159], v[208:211], v[204:207], v[156:159]
 ds_read_b128 v[36:39], v14 offset:576
 v_mfma_f32_16x16x32_bf16 v[144:147], v[212:215], v[188:191], v[144:147]
 ds_read2_b32 v[68:69], v17 offset0:96 offset1:97
 v_mfma_f32_16x16x32_bf16 v[148:151], v[212:215], v[192:195], v[148:151]
 ds_read2_b32 v[70:71], v17 offset0:98 offset1:99
 v_mfma_f32_16x16x32_bf16 v[152:155], v[212:215], v[196:199], v[152:155]
 ds_read_b128 v[40:43], v14 offset:1088
 v_mfma_f32_16x16x32_bf16 v[156:159], v[212:215], v[200:203], v[156:159]
 ds_read2_b32 v[72:73], v18 offset0:96 offset1:97
 v_mfma_f32_16x16x32_bf16 v[144:147], v[216:219], v[184:187], v[144:147]
 ds_read2_b32 v[74:75], v18 offset0:98 offset1:99
 v_mfma_f32_16x16x32_bf16 v[148:151], v[216:219], v[188:191], v[148:151]
 ds_read_b128 v[44:47], v14 offset:1600
 v_mfma_f32_16x16x32_bf16 v[152:155], v[216:219], v[192:195], v[152:155]
 ds_read2_b32 v[76:77], v19 offset0:96 offset1:97
 v_mfma_f32_16x16x32_bf16 v[156:159], v[216:219], v[196:199], v[156:159]
 ds_read2_b32 v[78:79], v19 offset0:98 offset1:99
 v_mfma_f32_16x16x32_bf16 v[144:147], v[220:223], v[180:183], v[144:147]
 ds_read_b128 v[48:51], v14 offset:2112
 v_mfma_f32_16x16x32_bf16 v[148:151], v[220:223], v[184:187], v[148:151]
 ds_read2_b32 v[80:81], v20 offset0:96 offset1:97
 v_mfma_f32_16x16x32_bf16 v[152:155], v[220:223], v[188:191], v[152:155]
 ds_read2_b32 v[82:83], v20 offset0:98 offset1:99
 v_mfma_f32_16x16x32_bf16 v[156:159], v[220:223], v[192:195], v[156:159]
 ds_read_b128 v[52:55], v14 offset:2624
 v_mfma_f32_16x16x32_bf16 v[144:147], v[224:227], v[176:179], v[144:147]
 ds_read2_b32 v[84:85], v21 offset0:96 offset1:97
 v_mfma_f32_16x16x32_bf16 v[148:151], v[224:227], v[180:183], v[148:151]
 ds_read2_b32 v[86:87], v21 offset0:98 offset1:99
 v_mfma_f32_16x16x32_bf16 v[152:155], v[224:227], v[184:187], v[152:155]
 ds_read_b128 v[56:59], v14 offset:3136
 v_mfma_f32_16x16x32_bf16 v[156:159], v[224:227], v[188:191], v[156:159]
 ds_read2_b32 v[88:89], v22 offset0:96 offset1:97
 v_mfma_f32_16x16x32_bf16 v[148:151], v[228:231], v[176:179], v[148:151]
 ds_read2_b32 v[90:91], v22 offset0:98 offset1:99
 v_mfma_f32_16x16x32_bf16 v[152:155], v[228:231], v[180:183], v[152:155]
 ds_read_b128 v[60:63], v14 offset:3648
 v_mfma_f32_16x16x32_bf16 v[156:159], v[228:231], v[184:187], v[156:159]
 ds_read2_b32 v[92:93], v23 offset0:96 offset1:97
 v_mfma_f32_16x16x32_bf16 v[152:155], v[232:235], v[176:179], v[152:155]
 ds_read2_b32 v[94:95], v23 offset0:98 offset1:99
 v_mfma_f32_16x16x32_bf16 v[156:159], v[232:235], v[180:183], v[156:159]
 v_mfma_f32_16x16x32_bf16 v[156:159], v[236:239], v[176:179], v[156:159]
 s_waitcnt lgkmcnt(0)
 v_mfma_f32_16x16x32_bf16 v[144:147], v[64:67], v[48:51], v[144:147]
 ds_read_b128 v[176:179], v14 offset:0
 v_mfma_f32_16x16x32_bf16 v[148:151], v[64:67], v[52:55], v[148:151]
 ds_read2_b32 v[208:209], v16 offset0:112 offset1:113
 v_mfma_f32_16x16x32_bf16 v[152:155], v[64:67], v[56:59], v[152:155]
 ds_read2_b32 v[210:211], v16 offset0:114 offset1:115
 v_mfma_f32_16x16x32_bf16 v[156:159], v[64:67], v[60:63], v[156:159]
 ds_read_b128 v[180:183], v14 offset:512
 v_mfma_f32_16x16x32_bf16 v[144:147], v[68:71], v[44:47], v[144:147]
 ds_read2_b32 v[212:213], v17 offset0:112 offset1:113
 v_mfma_f32_16x16x32_bf16 v[148:151], v[68:71], v[48:51], v[148:151]
 ds_read2_b32 v[214:215], v17 offset0:114 offset1:115
 v_mfma_f32_16x16x32_bf16 v[152:155], v[68:71], v[52:55], v[152:155]
 ds_read_b128 v[184:187], v14 offset:1024
 v_mfma_f32_16x16x32_bf16 v[156:159], v[68:71], v[56:59], v[156:159]
 ds_read2_b32 v[216:217], v18 offset0:112 offset1:113
 v_mfma_f32_16x16x32_bf16 v[144:147], v[72:75], v[40:43], v[144:147]
 ds_read2_b32 v[218:219], v18 offset0:114 offset1:115
 v_mfma_f32_16x16x32_bf16 v[148:151], v[72:75], v[44:47], v[148:151]
 ds_read_b128 v[188:191], v14 offset:1536
 v_mfma_f32_16x16x32_bf16 v[152:155], v[72:75], v[48:51], v[152:155]
 ds_read2_b32 v[220:221], v19 offset0:112 offset1:113
 v_mfma_f32_16x16x32_bf16 v[156:159], v[72:75], v[52:55], v[156:159]
 ds_read2_b32 v[222:223], v19 offset0:114 offset1:115
 v_mfma_f32_16x16x32_bf16 v[144:147], v[76:79], v[36:39], v[144:147]
 ds_read_b128 v[192:195], v14 offset:2048
 v_mfma_f32_16x16x32_bf16 v[148:151], v[76:79], v[40:43], v[148:151]
 ds_read2_b32 v[224:225], v20 offset0:112 offset1:113
 v_mfma_f32_16x16x32_bf16 v[152:155], v[76:79], v[44:47], v[152:155]
 ds_read2_b32 v[226:227], v20 offset0:114 offset1:115
 v_mfma_f32_16x16x32_bf16 v[156:159], v[76:79], v[48:51], v[156:159]
 ds_read_b128 v[196:199], v14 offset:2560
 v_mfma_f32_16x16x32_bf16 v[144:147], v[80:83], v[32:35], v[144:147]
 ds_read2_b32 v[228:229], v21 offset0:112 offset1:113
 v_mfma_f32_16x16x32_bf16 v[148:151], v[80:83], v[36:39], v[148:151]
 ds_read2_b32 v[230:231], v21 offset0:114 offset1:115
 v_mfma_f32_16x16x32_bf16 v[152:155], v[80:83], v[40:43], v[152:155]
 ds_read_b128 v[200:203], v14 offset:3072
 v_mfma_f32_16x16x32_bf16 v[156:159], v[80:83], v[44:47], v[156:159]
 ds_read2_b32 v[232:233], v22 offset0:112 offset1:113
 v_mfma_f32_16x16x32_bf16 v[148:151], v[84:87], v[32:35], v[148:151]
 ds_read2_b32 v[234:235], v22 offset0:114 offset1:115
 v_mfma_f32_16x16x32_bf16 v[152:155], v[84:87], v[36:39], v[152:155]
 ds_read_b128 v[204:207], v14 offset:3584
 v_mfma_f32_16x16x32_bf16 v[156:159], v[84:87], v[40:43], v[156:159]
 ds_read2_b32 v[236:237], v23 offset0:112 offset1:113
 v_mfma_f32_16x16x32_bf16 v[152:155], v[88:91], v[32:35], v[152:155]
 ds_read2_b32 v[238:239], v23 offset0:114 offset1:115
 v_mfma_f32_16x16x32_bf16 v[156:159], v[88:91], v[36:39], v[156:159]
 v_mfma_f32_16x16x32_bf16 v[156:159], v[92:95], v[32:35], v[156:159]
 s_waitcnt lgkmcnt(0)
 v_mfma_f32_16x16x32_bf16 v[144:147], v[208:211], v[192:195], v[144:147]
 ds_read_b64 v[32:33], v15 offset:2048
 v_mfma_f32_16x16x32_bf16 v[148:151], v[208:211], v[196:199], v[148:151]
 ds_read_b64 v[34:35], v15 offset:2560
 v_mfma_f32_16x16x32_bf16 v[152:155], v[208:211], v[200:203], v[152:155]
 ds_read_b64 v[36:37], v15 offset:3072
 v_mfma_f32_16x16x32_bf16 v[156:159], v[208:211], v[204:207], v[156:159]
 ds_read_b64 v[38:39], v15 offset:3584
 v_mfma_f32_16x16x32_bf16 v[144:147], v[212:215], v[188:191], v[144:147]
 v_mfma_f32_16x16x32_bf16 v[148:151], v[212:215], v[192:195], v[148:151]
 v_mfma_f32_16x16x32_bf16 v[152:155], v[212:215], v[196:199], v[152:155]
 v_mfma_f32_16x16x32_bf16 v[156:159], v[212:215], v[200:203], v[156:159]
 v_mfma_f32_16x16x32_bf16 v[144:147], v[216:219], v[184:187], v[144:147]
 v_mfma_f32_16x16x32_bf16 v[148:151], v[216:219], v[188:191], v[148:151]
 v_mfma_f32_16x16x32_bf16 v[152:155], v[216:219], v[192:195], v[152:155]
 v_mfma_f32_16x16x32_bf16 v[156:159], v[216:219], v[196:199], v[156:159]
 v_mfma_f32_16x16x32_bf16 v[144:147], v[220:223], v[180:183], v[144:147]
 v_mfma_f32_16x16x32_bf16 v[148:151], v[220:223], v[184:187], v[148:151]
 v_mfma_f32_16x16x32_bf16 v[152:155], v[220:223], v[188:191], v[152:155]
 v_mfma_f32_16x16x32_bf16 v[156:159], v[220:223], v[192:195], v[156:159]
 v_mfma_f32_16x16x32_bf16 v[144:147], v[224:227], v[176:179], v[144:147]
 v_mfma_f32_16x16x32_bf16 v[148:151], v[224:227], v[180:183], v[148:151]
 v_mfma_f32_16x16x32_bf16 v[152:155], v[224:227], v[184:187], v[152:155]
 v_mfma_f32_16x16x32_bf16 v[156:159], v[224:227], v[188:191], v[156:159]
 v_mfma_f32_16x16x32_bf16 v[148:151], v[228:231], v[176:179], v[148:151]
 v_mfma_f32_16x16x32_bf16 v[152:155], v[228:231], v[180:183], v[152:155]
 v_mfma_f32_16x16x32_bf16 v[156:159], v[228:231], v[184:187], v[156:159]
 v_mfma_f32_16x16x32_bf16 v[152:155], v[232:235], v[176:179], v[152:155]
 v_mfma_f32_16x16x32_bf16 v[156:159], v[232:235], v[180:183], v[156:159]
 v_mfma_f32_16x16x32_bf16 v[156:159], v[236:239], v[176:179], v[156:159]
 s_waitcnt lgkmcnt(0)
 v_and_b32 v64, 0xffff0000, v33
 v_lshlrev_b32 v65, 16, v33
 v_and_b32 v66, 0xffff0000, v32
 v_lshlrev_b32 v67, 16, v32
 v_mul_f32 v64, v64, v12
 v_mul_f32 v65, v65, v12
 v_mul_f32 v66, v66, v12
 v_mul_f32 v67, v67, v12
 v_and_b32 v68, 0xffff0000, v35
 v_lshlrev_b32 v69, 16, v35
 v_and_b32 v70, 0xffff0000, v34
 v_lshlrev_b32 v71, 16, v34
 v_mul_f32 v68, v68, v12
 v_mul_f32 v69, v69, v12
 v_mul_f32 v70, v70, v12
 v_mul_f32 v71, v71, v12
 v_and_b32 v72, 0xffff0000, v37
 v_lshlrev_b32 v73, 16, v37
 v_and_b32 v74, 0xffff0000, v36
 v_lshlrev_b32 v75, 16, v36
 v_mul_f32 v72, v72, v12
 v_mul_f32 v73, v73, v12
 v_mul_f32 v74, v74, v12
 v_mul_f32 v75, v75, v12
 v_and_b32 v76, 0xffff0000, v39
 v_lshlrev_b32 v77, 16, v39
 v_and_b32 v78, 0xffff0000, v38
 v_lshlrev_b32 v79, 16, v38
 v_mul_f32 v76, v76, v12
 v_mul_f32 v77, v77, v12
 v_mul_f32 v78, v78, v12
 v_mul_f32 v79, v79, v12
 v_cvt_pk_bf16_f32 v8, v64, v65
 v_lshlrev_b32 v64, 16, v8
 v_and_b32 v65, 0xffff0000, v8
 v_cvt_pk_bf16_f32 v8, v66, v67
 v_lshlrev_b32 v66, 16, v8
 v_and_b32 v67, 0xffff0000, v8
 v_cvt_pk_bf16_f32 v8, v68, v69
 v_lshlrev_b32 v68, 16, v8
 v_and_b32 v69, 0xffff0000, v8
 v_cvt_pk_bf16_f32 v8, v70, v71
 v_lshlrev_b32 v70, 16, v8
 v_and_b32 v71, 0xffff0000, v8
 v_cvt_pk_bf16_f32 v8, v72, v73
 v_lshlrev_b32 v72, 16, v8
 v_and_b32 v73, 0xffff0000, v8
 v_cvt_pk_bf16_f32 v8, v74, v75
 v_lshlrev_b32 v74, 16, v8
 v_and_b32 v75, 0xffff0000, v8
 v_cvt_pk_bf16_f32 v8, v76, v77
 v_lshlrev_b32 v76, 16, v8
 v_and_b32 v77, 0xffff0000, v8
 v_cvt_pk_bf16_f32 v8, v78, v79
 v_lshlrev_b32 v78, 16, v8
 v_and_b32 v79, 0xffff0000, v8
 v_cvt_pk_bf16_f32 v8, v144, v145
 v_lshlrev_b32 v144, 16, v8
 v_and_b32 v145, 0xffff0000, v8
 v_cvt_pk_bf16_f32 v8, v146, v147
 v_lshlrev_b32 v146, 16, v8
 v_and_b32 v147, 0xffff0000, v8
 v_cvt_pk_bf16_f32 v8, v148, v149
 v_lshlrev_b32 v148, 16, v8
 v_and_b32 v149, 0xffff0000, v8
 v_cvt_pk_bf16_f32 v8, v150, v151
 v_lshlrev_b32 v150, 16, v8
 v_and_b32 v151, 0xffff0000, v8
 v_cvt_pk_bf16_f32 v8, v152, v153
 v_lshlrev_b32 v152, 16, v8
 v_and_b32 v153, 0xffff0000, v8
 v_cvt_pk_bf16_f32 v8, v154, v155
 v_lshlrev_b32 v154, 16, v8
 v_and_b32 v155, 0xffff0000, v8
 v_cvt_pk_bf16_f32 v8, v156, v157
 v_lshlrev_b32 v156, 16, v8
 v_and_b32 v157, 0xffff0000, v8
 v_cvt_pk_bf16_f32 v8, v158, v159
 v_lshlrev_b32 v158, 16, v8
 v_and_b32 v159, 0xffff0000, v8
 v_pk_add_f32 v[144:145], v[144:145], v[64:65]
 v_pk_add_f32 v[146:147], v[146:147], v[66:67]
 v_pk_add_f32 v[148:149], v[148:149], v[68:69]
 v_pk_add_f32 v[150:151], v[150:151], v[70:71]
 v_pk_add_f32 v[152:153], v[152:153], v[72:73]
 v_pk_add_f32 v[154:155], v[154:155], v[74:75]
 v_pk_add_f32 v[156:157], v[156:157], v[76:77]
 v_pk_add_f32 v[158:159], v[158:159], v[78:79]
 v_cvt_pk_bf16_f32 v160, v144, v148
 v_cvt_pk_bf16_f32 v161, v152, v156
 buffer_store_dwordx2 v[160:161], v13, s[4:7], s72 offen sc1
 s_add_u32 s72, s72, 40960
 v_cvt_pk_bf16_f32 v162, v145, v149
 v_cvt_pk_bf16_f32 v163, v153, v157
 buffer_store_dwordx2 v[162:163], v13, s[4:7], s72 offen sc1
 s_add_u32 s72, s72, 40960
 v_cvt_pk_bf16_f32 v164, v146, v150
 v_cvt_pk_bf16_f32 v165, v154, v158
 buffer_store_dwordx2 v[164:165], v13, s[4:7], s72 offen sc1
 s_add_u32 s72, s72, 40960
 v_cvt_pk_bf16_f32 v166, v147, v151
 v_cvt_pk_bf16_f32 v167, v155, v159
 buffer_store_dwordx2 v[166:167], v13, s[4:7], s72 offen sc1
 s_add_u32 s72, s72, 40960
 s_cmp_lt_u32 s70, 640
 s_cbranch_scc1 L_cv_5
 s_setpc_b64 s[76:77]
L_helper:
 s_and_b32 s3, s82, 0x78
 s_cmp_lg_u32 s3, 80
 s_cbranch_scc1 L_np_7
 s_cmp_lg_u32 s50, 0
 s_cbranch_scc1 L_np_6
 s_mov_b32 s64, 0xffff
 s_mov_b32 s65, 0xffff
 s_mov_b32 s62, 0
 s_getreg_b32 s70, hwreg(HW_REG_XCC_ID, 2, 1)
 s_lshl_b32 s70, s70, 13
 v_lshlrev_b32 v1, 8, v0
 v_mov_b32 v2, 0
 s_mov_b32 s96, s44
 s_and_b32 s97, s45, 0xffff
 s_mov_b32 s98, 256
 s_mov_b32 s99, 0x00020000
L_probe0:
 s_sub_u32 s61, s82, 80
 s_lshl_b32 s61, s61, 14
 s_add_u32 s61, s61, 12582912
 s_add_u32 s63, s61, 8192
 s_mov_b64 exec, -1
 buffer_store_dword v2, v1, s[4:7], s61 offen sc1
 s_waitcnt vmcnt(0)
 s_mov_b64 exec, 1
L_probe:
 s_add_u32 s60, s61, 0
 s_xor_b32 s60, s60, s70
 s_memtime s[66:67]
 s_waitcnt lgkmcnt(0)
 buffer_load_dword v3, off, s[4:7], s60 sc1
 s_waitcnt vmcnt(0)
 s_memtime s[68:69]
 s_waitcnt lgkmcnt(0)
 s_sub_u32 s68, s68, s66
 s_min_u32 s64, s64, s68
 s_add_u32 s60, s61, 8192
 s_xor_b32 s60, s60, s70
 s_memtime s[66:67]
 s_waitcnt lgkmcnt(0)
 buffer_load_dword v3, off, s[4:7], s60 sc1
 s_waitcnt vmcnt(0)
 s_memtime s[68:69]
 s_waitcnt lgkmcnt(0)
 s_sub_u32 s68, s68, s66
 s_min_u32 s65, s65, s68
 s_add_u32 s61, s61, 2048
 s_cmp_lt_u32 s61, s63
 s_cbranch_scc1 L_probe
 s_cmp_lg_u32 s62, 0
 s_cbranch_scc1 L_probe_dec
 s_sub_u32 s66, 0x10000, s64
 s_sub_u32 s67, 0x10000, s65
 v_mov_b32 v4, s66
 v_mov_b32 v5, s67
 v_mov_b32 v3, 1
 buffer_atomic_umax v4, off, s[96:99], 0 offset:24
 buffer_atomic_umax v5, off, s[96:99], 0 offset:28
 s_waitcnt vmcnt(0)
 buffer_atomic_add v3, off, s[96:99], 0 offset:16 sc0
 s_waitcnt vmcnt(0)
 v_cmp_eq_u32 vcc, 7, v3
 s_cbranch_vccz L_probe_done
 buffer_atomic_umax v4, off, s[96:99], 0 offset:24 sc0
 buffer_atomic_umax v5, off, s[96:99], 0 offset:28 sc0
 s_waitcnt vmcnt(0)
 v_readfirstlane_b32 s66, v4
 v_readfirstlane_b32 s67, v5
 s_nop 3
 s_sub_u32 s64, 0x10000, s66
 s_sub_u32 s65, 0x10000, s67
L_probe_dec:
 s_add_u32 s62, s62, 1
 s_absdiff_i32 s60, s64, s65
 s_cmp_ge_u32 s62, 5
 s_cselect_b32 s60, 0xffff, s60
 s_cmp_lt_u32 s60, 112
 s_cbranch_scc1 L_probe0
 s_cmp_gt_u32 s64, s65
 s_cselect_b32 s60, 2, 1
 v_mov_b32 v3, s60
 buffer_store_dword v3, off, s[96:99], 0 offset:144 sc1
 v_mov_b32 v4, s62
 buffer_store_dword v4, off, s[96:99], 0 offset:60 sc1
L_probe_done:
 s_mov_b64 exec, -1
L_np_6:
 s_barrier
 s_lshl_b32 s72, s82, 2
 s_add_u32 s72, s72, s50
 s_add_u32 s72, s72, 32
 s_mov_b32 s8, s16
 s_and_b32 s9, s17, 0xffff
 s_mov_b32 s10, 2621440
 s_mov_b32 s11, 0x00020000
 v_lshlrev_b32 v1, 4, v0
 v_lshlrev_b32 v2, 3, v0
 v_cmp_lt_u32 vcc, 31, v0
 v_mov_b32 v3, 268435456
 s_nop 1
 v_cndmask_b32 v7, v2, v3, vcc
 s_mov_b32 s63, 0x3acccccd
 s_mov_b32 s68, 0x3727c5ac
 s_add_u32 s3, s72, 0
 s_mul_i32 s3, s3, 1280
 buffer_load_dwordx2 v[48:49], v2, s[8:11], s3 offen offset:0
 buffer_load_dwordx2 v[50:51], v2, s[8:11], s3 offen offset:512
 buffer_load_dwordx2 v[52:53], v7, s[8:11], s3 offen offset:1024
 s_waitcnt vmcnt(0)
L_ln_8:
 v_lshlrev_b32 v12, 16, v48
 v_and_b32 v13, 0xffff0000, v48
 v_lshlrev_b32 v14, 16, v49
 v_and_b32 v15, 0xffff0000, v49
 v_lshlrev_b32 v16, 16, v50
 v_and_b32 v17, 0xffff0000, v50
 v_lshlrev_b32 v18, 16, v51
 v_and_b32 v19, 0xffff0000, v51
 v_lshlrev_b32 v20, 16, v52
 v_and_b32 v21, 0xffff0000, v52
 v_lshlrev_b32 v22, 16, v53
 v_and_b32 v23, 0xffff0000, v53
 s_add_u32 s3, s72, 32
 s_mul_i32 s3, s3, 1280
 buffer_load_dwordx2 v[48:49], v2, s[8:11], s3 offen offset:0
 buffer_load_dwordx2 v[50:51], v2, s[8:11], s3 offen offset:512
 buffer_load_dwordx2 v[52:53], v7, s[8:11], s3 offen offset:1024
 s_and_b32 s3, s72, 15
 v_lshrrev_b32 v4, 3, v0
 v_lshlrev_b32 v4, 2, v4
 v_and_b32 v9, 3, v0
 v_add_u32 v4, v4, v9
 v_xor_b32 v4, s3, v4
 v_lshlrev_b32 v4, 4, v4
 v_and_b32 v9, 4, v0
 v_lshl_add_u32 v4, v9, 1, v4
 v_cndmask_b32 v8, v4, v3, vcc
 v_readfirstlane_b32 s3, v12
 s_nop 1
 v_subrev_f32 v36, s3, v12
 v_subrev_f32 v37, s3, v13
 v_subrev_f32 v38, s3, v14
 v_subrev_f32 v39, s3, v15
 v_subrev_f32 v40, s3, v16
 v_subrev_f32 v41, s3, v17
 v_subrev_f32 v42, s3, v18
 v_subrev_f32 v43, s3, v19
 v_mov_b32 v44, 0
 v_mov_b32 v45, 0
 v_mov_b32 v46, 0
 v_mov_b32 v47, 0
 s_mov_b32 exec_hi, 0
 v_subrev_f32 v44, s3, v20
 v_subrev_f32 v45, s3, v21
 v_subrev_f32 v46, s3, v22
 v_subrev_f32 v47, s3, v23
 s_mov_b32 exec_hi, -1
 v_pk_mul_f32 v[10:11], v[36:37], v[36:37]
 v_pk_fma_f32 v[10:11], v[38:39], v[38:39], v[10:11]
 v_pk_fma_f32 v[10:11], v[40:41], v[40:41], v[10:11]
 v_pk_fma_f32 v[10:11], v[42:43], v[42:43], v[10:11]
 v_pk_fma_f32 v[10:11], v[44:45], v[44:45], v[10:11]
 v_pk_fma_f32 v[10:11], v[46:47], v[46:47], v[10:11]
 v_pk_add_f32 v[36:37], v[36:37], v[38:39]
 v_pk_add_f32 v[36:37], v[36:37], v[40:41]
 v_pk_add_f32 v[36:37], v[36:37], v[42:43]
 v_pk_add_f32 v[36:37], v[36:37], v[44:45]
 v_pk_add_f32 v[36:37], v[36:37], v[46:47]
 v_add_f32 v11, v10, v11
 v_add_f32 v10, v36, v37
 s_nop 0
 v_add_f32_dpp v11, v11, v11 quad_perm:[1,0,3,2] row_mask:0xf bank_mask:0xf
 v_add_f32_dpp v10, v10, v10 quad_perm:[1,0,3,2] row_mask:0xf bank_mask:0xf
 s_nop 0
 v_add_f32_dpp v11, v11, v11 quad_perm:[2,3,0,1] row_mask:0xf bank_mask:0xf
 v_add_f32_dpp v10, v10, v10 quad_perm:[2,3,0,1] row_mask:0xf bank_mask:0xf
 s_nop 0
 v_add_f32_dpp v11, v11, v11 row_half_mirror row_mask:0xf bank_mask:0xf
 v_add_f32_dpp v10, v10, v10 row_half_mirror row_mask:0xf bank_mask:0xf
 s_nop 0
 v_add_f32_dpp v11, v11, v11 row_mirror row_mask:0xf bank_mask:0xf
 v_add_f32_dpp v10, v10, v10 row_mirror row_mask:0xf bank_mask:0xf
 v_mov_b32 v37, v11
 v_mov_b32 v36, v10
 s_nop 0
 v_permlane16_swap_b32 v11, v37
 v_permlane16_swap_b32 v10, v36
 v_pk_add_f32 v[10:11], v[10:11], v[36:37]
 v_mov_b32 v37, v11
 v_mov_b32 v36, v10
 s_nop 0
 v_permlane32_swap_b32 v11, v37
 v_permlane32_swap_b32 v10, v36
 v_pk_add_f32 v[10:11], v[10:11], v[36:37]
 v_mul_f32 v10, s63, v10
 v_mul_f32 v11, s63, v11
 v_fma_f32 v11, -v10, v10, v11
 v_max_f32 v11, 0, v11
 v_add_f32 v10, s3, v10
 v_cvt_pk_bf16_f32 v9, v10, v11
 v_lshlrev_b32 v10, 16, v9
 v_and_b32 v11, 0xffff0000, v9
 v_add_f32 v11, s68, v11
 v_cvt_pk_bf16_f32 v11, v11, v11
 v_and_b32 v11, 0xffff0000, v11
 v_sqrt_f32 v11, v11
 s_nop 0
 v_pk_add_f32 v[36:37], v[12:13], v[10:11] op_sel_hi:[1,0] neg_lo:[0,1] neg_hi:[0,1]
 v_pk_add_f32 v[38:39], v[14:15], v[10:11] op_sel_hi:[1,0] neg_lo:[0,1] neg_hi:[0,1]
 v_pk_add_f32 v[40:41], v[16:17], v[10:11] op_sel_hi:[1,0] neg_lo:[0,1] neg_hi:[0,1]
 v_pk_add_f32 v[42:43], v[18:19], v[10:11] op_sel_hi:[1,0] neg_lo:[0,1] neg_hi:[0,1]
 v_pk_add_f32 v[44:45], v[20:21], v[10:11] op_sel_hi:[1,0] neg_lo:[0,1] neg_hi:[0,1]
 v_pk_add_f32 v[46:47], v[22:23], v[10:11] op_sel_hi:[1,0] neg_lo:[0,1] neg_hi:[0,1]
 v_cvt_pk_bf16_f32 v11, v11, v11
 v_and_b32 v11, 0xffff0000, v11
 v_rcp_f32 v11, v11
 v_cvt_pk_bf16_f32 v9, v36, v37
 v_lshlrev_b32 v36, 16, v9
 v_and_b32 v37, 0xffff0000, v9
 v_cvt_pk_bf16_f32 v9, v38, v39
 v_lshlrev_b32 v38, 16, v9
 v_and_b32 v39, 0xffff0000, v9
 v_cvt_pk_bf16_f32 v9, v40, v41
 v_lshlrev_b32 v40, 16, v9
 v_and_b32 v41, 0xffff0000, v9
 v_cvt_pk_bf16_f32 v9, v42, v43
 v_lshlrev_b32 v42, 16, v9
 v_and_b32 v43, 0xffff0000, v9
 v_cvt_pk_bf16_f32 v9, v44, v45
 v_lshlrev_b32 v44, 16, v9
 v_and_b32 v45, 0xffff0000, v9
 v_cvt_pk_bf16_f32 v9, v46, v47
 v_lshlrev_b32 v46, 16, v9
 v_and_b32 v47, 0xffff0000, v9
 v_pk_mul_f32 v[36:37], v[36:37], v[10:11] op_sel:[0,1] op_sel_hi:[1,1]
 v_pk_mul_f32 v[38:39], v[38:39], v[10:11] op_sel:[0,1] op_sel_hi:[1,1]
 v_pk_mul_f32 v[40:41], v[40:41], v[10:11] op_sel:[0,1] op_sel_hi:[1,1]
 v_pk_mul_f32 v[42:43], v[42:43], v[10:11] op_sel:[0,1] op_sel_hi:[1,1]
 v_pk_mul_f32 v[44:45], v[44:45], v[10:11] op_sel:[0,1] op_sel_hi:[1,1]
 v_pk_mul_f32 v[46:47], v[46:47], v[10:11] op_sel:[0,1] op_sel_hi:[1,1]
 v_cvt_pk_bf16_f32 v24, v36, v37
 v_cvt_pk_bf16_f32 v25, v38, v39
 v_cvt_pk_bf16_f32 v26, v40, v41
 v_cvt_pk_bf16_f32 v27, v42, v43
 v_cvt_pk_bf16_f32 v28, v44, v45
 v_cvt_pk_bf16_f32 v29, v46, v47
 s_mul_i32 s3, s72, 1280
 s_add_u32 s3, s3, 192937984
 buffer_store_dwordx2 v[24:25], v4, s[4:7], s3 offen offset:0 sc1
 buffer_store_dwordx2 v[26:27], v4, s[4:7], s3 offen offset:512 sc1
 buffer_store_dwordx2 v[28:29], v8, s[4:7], s3 offen offset:1024 sc1
 s_add_u32 s72, s72, 32
 s_waitcnt vmcnt(3)
 s_cmp_lt_u32 s72, 544
 s_cbranch_scc1 L_ln_8
 s_waitcnt vmcnt(0)
 s_barrier
 s_cmp_lg_u32 s50, 3
 s_cbranch_scc1 L_ar_9
 s_mov_b32 s96, s44
 s_and_b32 s97, s45, 0xffff
 s_mov_b32 s98, 256
 s_mov_b32 s99, 0x00020000
 v_mov_b32 v1, 1
 s_mov_b64 exec, 1
 buffer_atomic_add v1, off, s[96:99], 0 offset:72 sc0
 s_waitcnt vmcnt(0)
 v_cmp_eq_u32 vcc, 7, v1
 s_cbranch_vccz L_aw_10
 buffer_store_dword v1, off, s[96:99], 0 offset:200 sc1
L_aw_10:
 s_mov_b64 exec, -1
L_ar_9:
 s_branch L_help_done
L_np_7:
 s_lshl_b32 s60, s82, 2
 s_add_u32 s60, s60, s50
 s_sub_u32 s3, s60, 32
 s_cmp_ge_u32 s60, 320
 s_cselect_b32 s60, s3, s60
 s_mov_b32 s72, s60
 s_mov_b32 s8, s16
 s_and_b32 s9, s17, 0xffff
 s_mov_b32 s10, 2621440
 s_mov_b32 s11, 0x00020000
 v_lshlrev_b32 v1, 4, v0
 v_lshlrev_b32 v2, 3, v0
 v_cmp_lt_u32 vcc, 31, v0
 v_mov_b32 v3, 268435456
 s_nop 1
 v_cndmask_b32 v7, v2, v3, vcc
 s_mov_b32 s63, 0x3acccccd
 s_mov_b32 s68, 0x3727c5ac
 s_add_u32 s3, s72, 0
 s_mul_i32 s3, s3, 1280
 buffer_load_dwordx2 v[48:49], v2, s[8:11], s3 offen offset:0
 buffer_load_dwordx2 v[50:51], v2, s[8:11], s3 offen offset:512
 buffer_load_dwordx2 v[52:53], v7, s[8:11], s3 offen offset:1024
 v_mov_b32 v12, 0
 v_mov_b32 v13, 0
 v_mov_b32 v14, 0
 v_mov_b32 v15, 0
 s_lshl_b32 s73, s60, 10
 s_add_u32 s73, s73, 0
L_cl_11:
 s_cmp_ge_u32 s73, 1736704
 s_cbranch_scc1 L_cle_12
 buffer_store_dwordx4 v[12:15], v1, s[4:7], s73 offen sc1
 s_add_u32 s73, s73, 360448
 s_branch L_cl_11
L_cle_12:
 s_nop 1
 v_mov_b32 v12, -1
 v_mov_b32 v13, -1
 v_mov_b32 v14, -1
 v_mov_b32 v15, -1
 s_lshl_b32 s73, s60, 10
 s_add_u32 s73, s73, 1736704
L_cl_13:
 s_cmp_ge_u32 s73, 3309568
 s_cbranch_scc1 L_cle_14
 buffer_store_dwordx4 v[12:15], v1, s[4:7], s73 offen sc1
 s_add_u32 s73, s73, 360448
 s_branch L_cl_13
L_cle_14:
 s_nop 1
 v_mov_b32 v12, -1
 v_mov_b32 v13, -1
 v_mov_b32 v14, -1
 v_mov_b32 v15, -1
 s_lshl_b32 s73, s60, 10
 s_add_u32 s73, s73, 4194304
L_cl_15:
 s_cmp_ge_u32 s73, 4325376
 s_cbranch_scc1 L_cle_16
 buffer_store_dwordx4 v[12:15], v1, s[4:7], s73 offen sc1
 s_add_u32 s73, s73, 360448
 s_branch L_cl_15
L_cle_16:
 s_nop 1
 v_mov_b32 v12, -1
 v_mov_b32 v13, -1
 v_mov_b32 v14, -1
 v_mov_b32 v15, -1
 s_lshl_b32 s73, s60, 10
 s_add_u32 s73, s73, 6291456
L_cl_17:
 s_cmp_ge_u32 s73, 6422528
 s_cbranch_scc1 L_cle_18
 buffer_store_dwordx4 v[12:15], v1, s[4:7], s73 offen sc1
 s_add_u32 s73, s73, 360448
 s_branch L_cl_17
L_cle_18:
 s_nop 1
 v_mov_b32 v12, -1
 v_mov_b32 v13, -1
 v_mov_b32 v14, -1
 v_mov_b32 v15, -1
 s_lshl_b32 s73, s60, 10
 s_add_u32 s73, s73, 8388608
L_cl_19:
 s_cmp_ge_u32 s73, 8519680
 s_cbranch_scc1 L_cle_20
 buffer_store_dwordx4 v[12:15], v1, s[4:7], s73 offen sc1
 s_add_u32 s73, s73, 360448
 s_branch L_cl_19
L_cle_20:
 s_nop 1
 v_mov_b32 v12, -1
 v_mov_b32 v13, -1
 v_mov_b32 v14, -1
 v_mov_b32 v15, -1
 s_lshl_b32 s73, s60, 10
 s_add_u32 s73, s73, 10485760
L_cl_21:
 s_cmp_ge_u32 s73, 10616832
 s_cbranch_scc1 L_cle_22
 buffer_store_dwordx4 v[12:15], v1, s[4:7], s73 offen sc1
 s_add_u32 s73, s73, 360448
 s_branch L_cl_21
L_cle_22:
 s_nop 1
 s_waitcnt vmcnt(8)
L_ln_23:
 v_lshlrev_b32 v12, 16, v48
 v_and_b32 v13, 0xffff0000, v48
 v_lshlrev_b32 v14, 16, v49
 v_and_b32 v15, 0xffff0000, v49
 v_lshlrev_b32 v16, 16, v50
 v_and_b32 v17, 0xffff0000, v50
 v_lshlrev_b32 v18, 16, v51
 v_and_b32 v19, 0xffff0000, v51
 v_lshlrev_b32 v20, 16, v52
 v_and_b32 v21, 0xffff0000, v52
 v_lshlrev_b32 v22, 16, v53
 v_and_b32 v23, 0xffff0000, v53
 s_and_b32 s3, s72, 15
 v_lshrrev_b32 v4, 3, v0
 v_lshlrev_b32 v4, 2, v4
 v_and_b32 v9, 3, v0
 v_add_u32 v4, v4, v9
 v_xor_b32 v4, s3, v4
 v_lshlrev_b32 v4, 4, v4
 v_and_b32 v9, 4, v0
 v_lshl_add_u32 v4, v9, 1, v4
 v_cndmask_b32 v8, v4, v3, vcc
 v_readfirstlane_b32 s3, v12
 s_nop 1
 v_subrev_f32 v36, s3, v12
 v_subrev_f32 v37, s3, v13
 v_subrev_f32 v38, s3, v14
 v_subrev_f32 v39, s3, v15
 v_subrev_f32 v40, s3, v16
 v_subrev_f32 v41, s3, v17
 v_subrev_f32 v42, s3, v18
 v_subrev_f32 v43, s3, v19
 v_mov_b32 v44, 0
 v_mov_b32 v45, 0
 v_mov_b32 v46, 0
 v_mov_b32 v47, 0
 s_mov_b32 exec_hi, 0
 v_subrev_f32 v44, s3, v20
 v_subrev_f32 v45, s3, v21
 v_subrev_f32 v46, s3, v22
 v_subrev_f32 v47, s3, v23
 s_mov_b32 exec_hi, -1
 v_pk_mul_f32 v[10:11], v[36:37], v[36:37]
 v_pk_fma_f32 v[10:11], v[38:39], v[38:39], v[10:11]
 v_pk_fma_f32 v[10:11], v[40:41], v[40:41], v[10:11]
 v_pk_fma_f32 v[10:11], v[42:43], v[42:43], v[10:11]
 v_pk_fma_f32 v[10:11], v[44:45], v[44:45], v[10:11]
 v_pk_fma_f32 v[10:11], v[46:47], v[46:47], v[10:11]
 v_pk_add_f32 v[36:37], v[36:37], v[38:39]
 v_pk_add_f32 v[36:37], v[36:37], v[40:41]
 v_pk_add_f32 v[36:37], v[36:37], v[42:43]
 v_pk_add_f32 v[36:37], v[36:37], v[44:45]
 v_pk_add_f32 v[36:37], v[36:37], v[46:47]
 v_add_f32 v11, v10, v11
 v_add_f32 v10, v36, v37
 s_nop 0
 v_add_f32_dpp v11, v11, v11 quad_perm:[1,0,3,2] row_mask:0xf bank_mask:0xf
 v_add_f32_dpp v10, v10, v10 quad_perm:[1,0,3,2] row_mask:0xf bank_mask:0xf
 s_nop 0
 v_add_f32_dpp v11, v11, v11 quad_perm:[2,3,0,1] row_mask:0xf bank_mask:0xf
 v_add_f32_dpp v10, v10, v10 quad_perm:[2,3,0,1] row_mask:0xf bank_mask:0xf
 s_nop 0
 v_add_f32_dpp v11, v11, v11 row_half_mirror row_mask:0xf bank_mask:0xf
 v_add_f32_dpp v10, v10, v10 row_half_mirror row_mask:0xf bank_mask:0xf
 s_nop 0
 v_add_f32_dpp v11, v11, v11 row_mirror row_mask:0xf bank_mask:0xf
 v_add_f32_dpp v10, v10, v10 row_mirror row_mask:0xf bank_mask:0xf
 v_mov_b32 v37, v11
 v_mov_b32 v36, v10
 s_nop 0
 v_permlane16_swap_b32 v11, v37
 v_permlane16_swap_b32 v10, v36
 v_pk_add_f32 v[10:11], v[10:11], v[36:37]
 v_mov_b32 v37, v11
 v_mov_b32 v36, v10
 s_nop 0
 v_permlane32_swap_b32 v11, v37
 v_permlane32_swap_b32 v10, v36
 v_pk_add_f32 v[10:11], v[10:11], v[36:37]
 v_mul_f32 v10, s63, v10
 v_mul_f32 v11, s63, v11
 v_fma_f32 v11, -v10, v10, v11
 v_max_f32 v11, 0, v11
 v_add_f32 v10, s3, v10
 v_cvt_pk_bf16_f32 v9, v10, v11
 v_lshlrev_b32 v10, 16, v9
 v_and_b32 v11, 0xffff0000, v9
 v_add_f32 v11, s68, v11
 v_cvt_pk_bf16_f32 v11, v11, v11
 v_and_b32 v11, 0xffff0000, v11
 v_sqrt_f32 v11, v11
 s_nop 0
 v_pk_add_f32 v[36:37], v[12:13], v[10:11] op_sel_hi:[1,0] neg_lo:[0,1] neg_hi:[0,1]
 v_pk_add_f32 v[38:39], v[14:15], v[10:11] op_sel_hi:[1,0] neg_lo:[0,1] neg_hi:[0,1]
 v_pk_add_f32 v[40:41], v[16:17], v[10:11] op_sel_hi:[1,0] neg_lo:[0,1] neg_hi:[0,1]
 v_pk_add_f32 v[42:43], v[18:19], v[10:11] op_sel_hi:[1,0] neg_lo:[0,1] neg_hi:[0,1]
 v_pk_add_f32 v[44:45], v[20:21], v[10:11] op_sel_hi:[1,0] neg_lo:[0,1] neg_hi:[0,1]
 v_pk_add_f32 v[46:47], v[22:23], v[10:11] op_sel_hi:[1,0] neg_lo:[0,1] neg_hi:[0,1]
 v_cvt_pk_bf16_f32 v11, v11, v11
 v_and_b32 v11, 0xffff0000, v11
 v_rcp_f32 v11, v11
 v_cvt_pk_bf16_f32 v9, v36, v37
 v_lshlrev_b32 v36, 16, v9
 v_and_b32 v37, 0xffff0000, v9
 v_cvt_pk_bf16_f32 v9, v38, v39
 v_lshlrev_b32 v38, 16, v9
 v_and_b32 v39, 0xffff0000, v9
 v_cvt_pk_bf16_f32 v9, v40, v41
 v_lshlrev_b32 v40, 16, v9
 v_and_b32 v41, 0xffff0000, v9
 v_cvt_pk_bf16_f32 v9, v42, v43
 v_lshlrev_b32 v42, 16, v9
 v_and_b32 v43, 0xffff0000, v9
 v_cvt_pk_bf16_f32 v9, v44, v45
 v_lshlrev_b32 v44, 16, v9
 v_and_b32 v45, 0xffff0000, v9
 v_cvt_pk_bf16_f32 v9, v46, v47
 v_lshlrev_b32 v46, 16, v9
 v_and_b32 v47, 0xffff0000, v9
 v_pk_mul_f32 v[36:37], v[36:37], v[10:11] op_sel:[0,1] op_sel_hi:[1,1]
 v_pk_mul_f32 v[38:39], v[38:39], v[10:11] op_sel:[0,1] op_sel_hi:[1,1]
 v_pk_mul_f32 v[40:41], v[40:41], v[10:11] op_sel:[0,1] op_sel_hi:[1,1]
 v_pk_mul_f32 v[42:43], v[42:43], v[10:11] op_sel:[0,1] op_sel_hi:[1,1]
 v_pk_mul_f32 v[44:45], v[44:45], v[10:11] op_sel:[0,1] op_sel_hi:[1,1]
 v_pk_mul_f32 v[46:47], v[46:47], v[10:11] op_sel:[0,1] op_sel_hi:[1,1]
 v_cvt_pk_bf16_f32 v24, v36, v37
 v_cvt_pk_bf16_f32 v25, v38, v39
 v_cvt_pk_bf16_f32 v26, v40, v41
 v_cvt_pk_bf16_f32 v27, v42, v43
 v_cvt_pk_bf16_f32 v28, v44, v45
 v_cvt_pk_bf16_f32 v29, v46, v47
 s_mul_i32 s3, s72, 1280
 s_add_u32 s3, s3, 192937984
 buffer_store_dwordx2 v[24:25], v4, s[4:7], s3 offen offset:0 sc1
 buffer_store_dwordx2 v[26:27], v4, s[4:7], s3 offen offset:512 sc1
 buffer_store_dwordx2 v[28:29], v8, s[4:7], s3 offen offset:1024 sc1
 s_waitcnt vmcnt(0)
 s_barrier
 s_cmp_lg_u32 s50, 3
 s_cbranch_scc1 L_ar_24
 s_mov_b32 s96, s44
 s_and_b32 s97, s45, 0xffff
 s_mov_b32 s98, 256
 s_mov_b32 s99, 0x00020000
 v_mov_b32 v1, 1
 s_mov_b64 exec, 1
 buffer_atomic_add v1, off, s[96:99], 0 offset:4 sc0
 s_waitcnt vmcnt(0)
 v_cmp_eq_u32 vcc, 87, v1
 s_cbranch_vccz L_aw_25
 buffer_store_dword v1, off, s[96:99], 0 offset:132 sc1
L_aw_25:
 s_mov_b64 exec, -1
L_ar_24:
 s_cmp_eq_u32 s83, 3
 s_cbranch_scc1 L_help_done
 s_sub_u32 s60, s60, 128
 s_cmp_eq_u32 s83, 1
 s_cbranch_scc1 L_k2_26
 s_add_u32 s3, s60, 288
 s_add_u32 s60, s60, 128
 s_cmp_lt_u32 s82, 32
 s_cselect_b32 s60, s3, s60
L_k2_26:
 s_mov_b32 s8, s32
 s_and_b32 s9, s33, 0xffff
 s_mov_b32 s10, 2621440
 s_mov_b32 s11, 0x00020000
 s_mov_b32 s12, s34
 s_and_b32 s13, s35, 0xffff
 s_mov_b32 s14, 2621440
 s_mov_b32 s15, 0x00020000
 s_mul_i32 s73, s60, 6554
 s_lshr_b32 s73, s73, 16
 s_mul_i32 s3, s73, 10
 s_sub_u32 s74, s60, s3
 s_mul_i32 s69, s73, 81920
 s_lshl_b32 s3, s74, 7
 s_add_u32 s69, s69, s3
 v_lshrrev_b32 v90, 3, v0
 s_mov_b32 s3, 10240
 v_mul_lo_u32 v91, v90, s3
 v_and_b32 v92, 7, v0
 v_lshl_add_u32 v91, v92, 4, v91
 v_add_u32 v91, s69, v91
 v_subrev_u32 v93, 3840, v91
 v_cmp_gt_i32 vcc, 0, v93
 s_nop 1
 v_cndmask_b32 v93, v93, v3, vcc
 buffer_load_dwordx4 v[100:103], v93, s[8:11], 0 offen offset:0
 buffer_load_dwordx4 v[104:107], v93, s[8:11], 0 offen offset:1280
 buffer_load_dwordx4 v[108:111], v93, s[8:11], 0 offen offset:2560
 s_mov_b32 s3, 0
 buffer_load_dwordx4 v[112:115], v91, s[8:11], s3 offen
 buffer_load_dwordx4 v[144:147], v91, s[12:15], s3 offen
 s_mov_b32 s3, 1280
 buffer_load_dwordx4 v[116:119], v91, s[8:11], s3 offen
 buffer_load_dwordx4 v[148:151], v91, s[12:15], s3 offen
 s_mov_b32 s3, 2560
 buffer_load_dwordx4 v[120:123], v91, s[8:11], s3 offen
 buffer_load_dwordx4 v[152:155], v91, s[12:15], s3 offen
 s_mov_b32 s3, 3840
 buffer_load_dwordx4 v[124:127], v91, s[8:11], s3 offen
 buffer_load_dwordx4 v[156:159], v91, s[12:15], s3 offen
 s_mov_b32 s3, 5120
 buffer_load_dwordx4 v[128:131], v91, s[8:11], s3 offen
 buffer_load_dwordx4 v[160:163], v91, s[12:15], s3 offen
 s_mov_b32 s3, 6400
 buffer_load_dwordx4 v[132:135], v91, s[8:11], s3 offen
 buffer_load_dwordx4 v[164:167], v91, s[12:15], s3 offen
 s_mov_b32 s3, 7680
 buffer_load_dwordx4 v[136:139], v91, s[8:11], s3 offen
 buffer_load_dwordx4 v[168:171], v91, s[12:15], s3 offen
 s_mov_b32 s3, 8960
 buffer_load_dwordx4 v[140:143], v91, s[8:11], s3 offen
 buffer_load_dwordx4 v[172:175], v91, s[12:15], s3 offen
 s_mov_b32 s8, s36
 s_and_b32 s9, s37, 0xffff
 s_mov_b32 s10, 5120
 s_mov_b32 s11, 0x00020000
 v_lshlrev_b32 v93, 6, v92
 s_lshl_b32 s3, s74, 9
 buffer_load_dwordx4 v[176:179], v93, s[8:11], s3 offen offset:0
 buffer_load_dwordx4 v[180:183], v93, s[8:11], s3 offen offset:16
 buffer_load_dwordx4 v[184:187], v93, s[8:11], s3 offen offset:32
 buffer_load_dwordx4 v[188:191], v93, s[8:11], s3 offen offset:48
 v_lshlrev_b32 v94, 15, v92
 v_lshl_add_u32 v94, v90, 4, v94
 s_lshl_b32 s70, s74, 18
 s_lshl_b32 s3, s73, 7
 s_add_u32 s70, s70, s3
 s_add_u32 s70, s70, 198180864
 s_waitcnt vmcnt(0)
 v_lshlrev_b32 v12, 16, v100
 v_and_b32 v13, 0xffff0000, v100
 v_lshlrev_b32 v14, 16, v104
 v_and_b32 v15, 0xffff0000, v104
 v_lshlrev_b32 v16, 16, v108
 v_and_b32 v17, 0xffff0000, v108
 v_lshlrev_b32 v18, 16, v112
 v_and_b32 v19, 0xffff0000, v112
 v_lshlrev_b32 v20, 16, v116
 v_and_b32 v21, 0xffff0000, v116
 v_lshlrev_b32 v22, 16, v120
 v_and_b32 v23, 0xffff0000, v120
 v_lshlrev_b32 v24, 16, v124
 v_and_b32 v25, 0xffff0000, v124
 v_lshlrev_b32 v26, 16, v128
 v_and_b32 v27, 0xffff0000, v128
 v_lshlrev_b32 v28, 16, v132
 v_and_b32 v29, 0xffff0000, v132
 v_lshlrev_b32 v30, 16, v136
 v_and_b32 v31, 0xffff0000, v136
 v_lshlrev_b32 v32, 16, v140
 v_and_b32 v33, 0xffff0000, v140
 v_lshlrev_b32 v68, 16, v176
 v_lshlrev_b32 v69, 16, v178
 v_and_b32 v70, 0xffff0000, v176
 v_and_b32 v71, 0xffff0000, v178
 v_lshlrev_b32 v72, 16, v177
 v_lshlrev_b32 v73, 16, v179
 v_and_b32 v74, 0xffff0000, v177
 v_and_b32 v75, 0xffff0000, v179
 v_pk_mul_f32 v[36:37], v[12:13], v[74:75]
 v_pk_mul_f32 v[38:39], v[14:15], v[74:75]
 v_pk_mul_f32 v[40:41], v[16:17], v[74:75]
 v_pk_mul_f32 v[42:43], v[18:19], v[74:75]
 v_pk_mul_f32 v[44:45], v[20:21], v[74:75]
 v_pk_mul_f32 v[46:47], v[22:23], v[74:75]
 v_pk_mul_f32 v[48:49], v[24:25], v[74:75]
 v_pk_mul_f32 v[50:51], v[26:27], v[74:75]
 v_cvt_pk_bf16_f32 v84, v36, v37
 v_lshlrev_b32 v36, 16, v84
 v_and_b32 v37, 0xffff0000, v84
 v_cvt_pk_bf16_f32 v84, v38, v39
 v_lshlrev_b32 v38, 16, v84
 v_and_b32 v39, 0xffff0000, v84
 v_cvt_pk_bf16_f32 v84, v40, v41
 v_lshlrev_b32 v40, 16, v84
 v_and_b32 v41, 0xffff0000, v84
 v_cvt_pk_bf16_f32 v84, v42, v43
 v_lshlrev_b32 v42, 16, v84
 v_and_b32 v43, 0xffff0000, v84
 v_cvt_pk_bf16_f32 v84, v44, v45
 v_lshlrev_b32 v44, 16, v84
 v_and_b32 v45, 0xffff0000, v84
 v_cvt_pk_bf16_f32 v84, v46, v47
 v_lshlrev_b32 v46, 16, v84
 v_and_b32 v47, 0xffff0000, v84
 v_cvt_pk_bf16_f32 v84, v48, v49
 v_lshlrev_b32 v48, 16, v84
 v_and_b32 v49, 0xffff0000, v84
 v_cvt_pk_bf16_f32 v84, v50, v51
 v_lshlrev_b32 v50, 16, v84
 v_and_b32 v51, 0xffff0000, v84
 v_pk_mul_f32 v[52:53], v[14:15], v[72:73]
 v_pk_mul_f32 v[54:55], v[16:17], v[72:73]
 v_pk_mul_f32 v[56:57], v[18:19], v[72:73]
 v_pk_mul_f32 v[58:59], v[20:21], v[72:73]
 v_pk_mul_f32 v[60:61], v[22:23], v[72:73]
 v_pk_mul_f32 v[62:63], v[24:25], v[72:73]
 v_pk_mul_f32 v[64:65], v[26:27], v[72:73]
 v_pk_mul_f32 v[66:67], v[28:29], v[72:73]
 v_cvt_pk_bf16_f32 v84, v52, v53
 v_lshlrev_b32 v52, 16, v84
 v_and_b32 v53, 0xffff0000, v84
 v_cvt_pk_bf16_f32 v84, v54, v55
 v_lshlrev_b32 v54, 16, v84
 v_and_b32 v55, 0xffff0000, v84
 v_cvt_pk_bf16_f32 v84, v56, v57
 v_lshlrev_b32 v56, 16, v84
 v_and_b32 v57, 0xffff0000, v84
 v_cvt_pk_bf16_f32 v84, v58, v59
 v_lshlrev_b32 v58, 16, v84
 v_and_b32 v59, 0xffff0000, v84
 v_cvt_pk_bf16_f32 v84, v60, v61
 v_lshlrev_b32 v60, 16, v84
 v_and_b32 v61, 0xffff0000, v84
 v_cvt_pk_bf16_f32 v84, v62, v63
 v_lshlrev_b32 v62, 16, v84
 v_and_b32 v63, 0xffff0000, v84
 v_cvt_pk_bf16_f32 v84, v64, v65
 v_lshlrev_b32 v64, 16, v84
 v_and_b32 v65, 0xffff0000, v84
 v_cvt_pk_bf16_f32 v84, v66, v67
 v_lshlrev_b32 v66, 16, v84
 v_and_b32 v67, 0xffff0000, v84
 v_pk_add_f32 v[36:37], v[36:37], v[52:53]
 v_pk_add_f32 v[38:39], v[38:39], v[54:55]
 v_pk_add_f32 v[40:41], v[40:41], v[56:57]
 v_pk_add_f32 v[42:43], v[42:43], v[58:59]
 v_pk_add_f32 v[44:45], v[44:45], v[60:61]
 v_pk_add_f32 v[46:47], v[46:47], v[62:63]
 v_pk_add_f32 v[48:49], v[48:49], v[64:65]
 v_pk_add_f32 v[50:51], v[50:51], v[66:67]
 v_cvt_pk_bf16_f32 v84, v36, v37
 v_lshlrev_b32 v36, 16, v84
 v_and_b32 v37, 0xffff0000, v84
 v_cvt_pk_bf16_f32 v84, v38, v39
 v_lshlrev_b32 v38, 16, v84
 v_and_b32 v39, 0xffff0000, v84
 v_cvt_pk_bf16_f32 v84, v40, v41
 v_lshlrev_b32 v40, 16, v84
 v_and_b32 v41, 0xffff0000, v84
 v_cvt_pk_bf16_f32 v84, v42, v43
 v_lshlrev_b32 v42, 16, v84
 v_and_b32 v43, 0xffff0000, v84
 v_cvt_pk_bf16_f32 v84, v44, v45
 v_lshlrev_b32 v44, 16, v84
 v_and_b32 v45, 0xffff0000, v84
 v_cvt_pk_bf16_f32 v84, v46, v47
 v_lshlrev_b32 v46, 16, v84
 v_and_b32 v47, 0xffff0000, v84
 v_cvt_pk_bf16_f32 v84, v48, v49
 v_lshlrev_b32 v48, 16, v84
 v_and_b32 v49, 0xffff0000, v84
 v_cvt_pk_bf16_f32 v84, v50, v51
 v_lshlrev_b32 v50, 16, v84
 v_and_b32 v51, 0xffff0000, v84
 v_pk_mul_f32 v[52:53], v[16:17], v[70:71]
 v_pk_mul_f32 v[54:55], v[18:19], v[70:71]
 v_pk_mul_f32 v[56:57], v[20:21], v[70:71]
 v_pk_mul_f32 v[58:59], v[22:23], v[70:71]
 v_pk_mul_f32 v[60:61], v[24:25], v[70:71]
 v_pk_mul_f32 v[62:63], v[26:27], v[70:71]
 v_pk_mul_f32 v[64:65], v[28:29], v[70:71]
 v_pk_mul_f32 v[66:67], v[30:31], v[70:71]
 v_cvt_pk_bf16_f32 v84, v52, v53
 v_lshlrev_b32 v52, 16, v84
 v_and_b32 v53, 0xffff0000, v84
 v_cvt_pk_bf16_f32 v84, v54, v55
 v_lshlrev_b32 v54, 16, v84
 v_and_b32 v55, 0xffff0000, v84
 v_cvt_pk_bf16_f32 v84, v56, v57
 v_lshlrev_b32 v56, 16, v84
 v_and_b32 v57, 0xffff0000, v84
 v_cvt_pk_bf16_f32 v84, v58, v59
 v_lshlrev_b32 v58, 16, v84
 v_and_b32 v59, 0xffff0000, v84
 v_cvt_pk_bf16_f32 v84, v60, v61
 v_lshlrev_b32 v60, 16, v84
 v_and_b32 v61, 0xffff0000, v84
 v_cvt_pk_bf16_f32 v84, v62, v63
 v_lshlrev_b32 v62, 16, v84
 v_and_b32 v63, 0xffff0000, v84
 v_cvt_pk_bf16_f32 v84, v64, v65
 v_lshlrev_b32 v64, 16, v84
 v_and_b32 v65, 0xffff0000, v84
 v_cvt_pk_bf16_f32 v84, v66, v67
 v_lshlrev_b32 v66, 16, v84
 v_and_b32 v67, 0xffff0000, v84
 v_pk_add_f32 v[36:37], v[36:37], v[52:53]
 v_pk_add_f32 v[38:39], v[38:39], v[54:55]
 v_pk_add_f32 v[40:41], v[40:41], v[56:57]
 v_pk_add_f32 v[42:43], v[42:43], v[58:59]
 v_pk_add_f32 v[44:45], v[44:45], v[60:61]
 v_pk_add_f32 v[46:47], v[46:47], v[62:63]
 v_pk_add_f32 v[48:49], v[48:49], v[64:65]
 v_pk_add_f32 v[50:51], v[50:51], v[66:67]
 v_cvt_pk_bf16_f32 v84, v36, v37
 v_lshlrev_b32 v36, 16, v84
 v_and_b32 v37, 0xffff0000, v84
 v_cvt_pk_bf16_f32 v84, v38, v39
 v_lshlrev_b32 v38, 16, v84
 v_and_b32 v39, 0xffff0000, v84
 v_cvt_pk_bf16_f32 v84, v40, v41
 v_lshlrev_b32 v40, 16, v84
 v_and_b32 v41, 0xffff0000, v84
 v_cvt_pk_bf16_f32 v84, v42, v43
 v_lshlrev_b32 v42, 16, v84
 v_and_b32 v43, 0xffff0000, v84
 v_cvt_pk_bf16_f32 v84, v44, v45
 v_lshlrev_b32 v44, 16, v84
 v_and_b32 v45, 0xffff0000, v84
 v_cvt_pk_bf16_f32 v84, v46, v47
 v_lshlrev_b32 v46, 16, v84
 v_and_b32 v47, 0xffff0000, v84
 v_cvt_pk_bf16_f32 v84, v48, v49
 v_lshlrev_b32 v48, 16, v84
 v_and_b32 v49, 0xffff0000, v84
 v_cvt_pk_bf16_f32 v84, v50, v51
 v_lshlrev_b32 v50, 16, v84
 v_and_b32 v51, 0xffff0000, v84
 v_pk_mul_f32 v[52:53], v[18:19], v[68:69]
 v_pk_mul_f32 v[54:55], v[20:21], v[68:69]
 v_pk_mul_f32 v[56:57], v[22:23], v[68:69]
 v_pk_mul_f32 v[58:59], v[24:25], v[68:69]
 v_pk_mul_f32 v[60:61], v[26:27], v[68:69]
 v_pk_mul_f32 v[62:63], v[28:29], v[68:69]
 v_pk_mul_f32 v[64:65], v[30:31], v[68:69]
 v_pk_mul_f32 v[66:67], v[32:33], v[68:69]
 v_cvt_pk_bf16_f32 v84, v52, v53
 v_lshlrev_b32 v52, 16, v84
 v_and_b32 v53, 0xffff0000, v84
 v_cvt_pk_bf16_f32 v84, v54, v55
 v_lshlrev_b32 v54, 16, v84
 v_and_b32 v55, 0xffff0000, v84
 v_cvt_pk_bf16_f32 v84, v56, v57
 v_lshlrev_b32 v56, 16, v84
 v_and_b32 v57, 0xffff0000, v84
 v_cvt_pk_bf16_f32 v84, v58, v59
 v_lshlrev_b32 v58, 16, v84
 v_and_b32 v59, 0xffff0000, v84
 v_cvt_pk_bf16_f32 v84, v60, v61
 v_lshlrev_b32 v60, 16, v84
 v_and_b32 v61, 0xffff0000, v84
 v_cvt_pk_bf16_f32 v84, v62, v63
 v_lshlrev_b32 v62, 16, v84
 v_and_b32 v63, 0xffff0000, v84
 v_cvt_pk_bf16_f32 v84, v64, v65
 v_lshlrev_b32 v64, 16, v84
 v_and_b32 v65, 0xffff0000, v84
 v_cvt_pk_bf16_f32 v84, v66, v67
 v_lshlrev_b32 v66, 16, v84
 v_and_b32 v67, 0xffff0000, v84
 v_pk_add_f32 v[36:37], v[36:37], v[52:53]
 v_pk_add_f32 v[38:39], v[38:39], v[54:55]
 v_pk_add_f32 v[40:41], v[40:41], v[56:57]
 v_pk_add_f32 v[42:43], v[42:43], v[58:59]
 v_pk_add_f32 v[44:45], v[44:45], v[60:61]
 v_pk_add_f32 v[46:47], v[46:47], v[62:63]
 v_pk_add_f32 v[48:49], v[48:49], v[64:65]
 v_pk_add_f32 v[50:51], v[50:51], v[66:67]
 v_cvt_pk_bf16_f32 v84, v36, v37
 v_lshlrev_b32 v36, 16, v84
 v_and_b32 v37, 0xffff0000, v84
 v_cvt_pk_bf16_f32 v84, v38, v39
 v_lshlrev_b32 v38, 16, v84
 v_and_b32 v39, 0xffff0000, v84
 v_cvt_pk_bf16_f32 v84, v40, v41
 v_lshlrev_b32 v40, 16, v84
 v_and_b32 v41, 0xffff0000, v84
 v_cvt_pk_bf16_f32 v84, v42, v43
 v_lshlrev_b32 v42, 16, v84
 v_and_b32 v43, 0xffff0000, v84
 v_cvt_pk_bf16_f32 v84, v44, v45
 v_lshlrev_b32 v44, 16, v84
 v_and_b32 v45, 0xffff0000, v84
 v_cvt_pk_bf16_f32 v84, v46, v47
 v_lshlrev_b32 v46, 16, v84
 v_and_b32 v47, 0xffff0000, v84
 v_cvt_pk_bf16_f32 v84, v48, v49
 v_lshlrev_b32 v48, 16, v84
 v_and_b32 v49, 0xffff0000, v84
 v_cvt_pk_bf16_f32 v84, v50, v51
 v_lshlrev_b32 v50, 16, v84
 v_and_b32 v51, 0xffff0000, v84
 v_lshlrev_b32 v12, 16, v144
 v_and_b32 v13, 0xffff0000, v144
 v_lshlrev_b32 v14, 16, v148
 v_and_b32 v15, 0xffff0000, v148
 v_lshlrev_b32 v16, 16, v152
 v_and_b32 v17, 0xffff0000, v152
 v_lshlrev_b32 v18, 16, v156
 v_and_b32 v19, 0xffff0000, v156
 v_lshlrev_b32 v20, 16, v160
 v_and_b32 v21, 0xffff0000, v160
 v_lshlrev_b32 v22, 16, v164
 v_and_b32 v23, 0xffff0000, v164
 v_lshlrev_b32 v24, 16, v168
 v_and_b32 v25, 0xffff0000, v168
 v_lshlrev_b32 v26, 16, v172
 v_and_b32 v27, 0xffff0000, v172
 v_pk_mul_f32 v[36:37], v[36:37], v[12:13]
 v_pk_mul_f32 v[38:39], v[38:39], v[14:15]
 v_pk_mul_f32 v[40:41], v[40:41], v[16:17]
 v_pk_mul_f32 v[42:43], v[42:43], v[18:19]
 v_pk_mul_f32 v[44:45], v[44:45], v[20:21]
 v_pk_mul_f32 v[46:47], v[46:47], v[22:23]
 v_pk_mul_f32 v[48:49], v[48:49], v[24:25]
 v_pk_mul_f32 v[50:51], v[50:51], v[26:27]
 v_cvt_pk_bf16_f32 v76, v50, v48
 v_cvt_pk_bf16_f32 v77, v46, v44
 v_cvt_pk_bf16_f32 v78, v42, v40
 v_cvt_pk_bf16_f32 v79, v38, v36
 s_add_u32 s3, s70, 0
 buffer_store_dwordx4 v[76:79], v94, s[4:7], s3 offen sc1
 v_cvt_pk_bf16_f32 v80, v51, v49
 v_cvt_pk_bf16_f32 v81, v47, v45
 v_cvt_pk_bf16_f32 v82, v43, v41
 v_cvt_pk_bf16_f32 v83, v39, v37
 s_add_u32 s3, s70, 4096
 buffer_store_dwordx4 v[80:83], v94, s[4:7], s3 offen sc1
 v_lshlrev_b32 v12, 16, v101
 v_and_b32 v13, 0xffff0000, v101
 v_lshlrev_b32 v14, 16, v105
 v_and_b32 v15, 0xffff0000, v105
 v_lshlrev_b32 v16, 16, v109
 v_and_b32 v17, 0xffff0000, v109
 v_lshlrev_b32 v18, 16, v113
 v_and_b32 v19, 0xffff0000, v113
 v_lshlrev_b32 v20, 16, v117
 v_and_b32 v21, 0xffff0000, v117
 v_lshlrev_b32 v22, 16, v121
 v_and_b32 v23, 0xffff0000, v121
 v_lshlrev_b32 v24, 16, v125
 v_and_b32 v25, 0xffff0000, v125
 v_lshlrev_b32 v26, 16, v129
 v_and_b32 v27, 0xffff0000, v129
 v_lshlrev_b32 v28, 16, v133
 v_and_b32 v29, 0xffff0000, v133
 v_lshlrev_b32 v30, 16, v137
 v_and_b32 v31, 0xffff0000, v137
 v_lshlrev_b32 v32, 16, v141
 v_and_b32 v33, 0xffff0000, v141
 v_lshlrev_b32 v68, 16, v180
 v_lshlrev_b32 v69, 16, v182
 v_and_b32 v70, 0xffff0000, v180
 v_and_b32 v71, 0xffff0000, v182
 v_lshlrev_b32 v72, 16, v181
 v_lshlrev_b32 v73, 16, v183
 v_and_b32 v74, 0xffff0000, v181
 v_and_b32 v75, 0xffff0000, v183
 v_pk_mul_f32 v[36:37], v[12:13], v[74:75]
 v_pk_mul_f32 v[38:39], v[14:15], v[74:75]
 v_pk_mul_f32 v[40:41], v[16:17], v[74:75]
 v_pk_mul_f32 v[42:43], v[18:19], v[74:75]
 v_pk_mul_f32 v[44:45], v[20:21], v[74:75]
 v_pk_mul_f32 v[46:47], v[22:23], v[74:75]
 v_pk_mul_f32 v[48:49], v[24:25], v[74:75]
 v_pk_mul_f32 v[50:51], v[26:27], v[74:75]
 v_cvt_pk_bf16_f32 v84, v36, v37
 v_lshlrev_b32 v36, 16, v84
 v_and_b32 v37, 0xffff0000, v84
 v_cvt_pk_bf16_f32 v84, v38, v39
 v_lshlrev_b32 v38, 16, v84
 v_and_b32 v39, 0xffff0000, v84
 v_cvt_pk_bf16_f32 v84, v40, v41
 v_lshlrev_b32 v40, 16, v84
 v_and_b32 v41, 0xffff0000, v84
 v_cvt_pk_bf16_f32 v84, v42, v43
 v_lshlrev_b32 v42, 16, v84
 v_and_b32 v43, 0xffff0000, v84
 v_cvt_pk_bf16_f32 v84, v44, v45
 v_lshlrev_b32 v44, 16, v84
 v_and_b32 v45, 0xffff0000, v84
 v_cvt_pk_bf16_f32 v84, v46, v47
 v_lshlrev_b32 v46, 16, v84
 v_and_b32 v47, 0xffff0000, v84
 v_cvt_pk_bf16_f32 v84, v48, v49
 v_lshlrev_b32 v48, 16, v84
 v_and_b32 v49, 0xffff0000, v84
 v_cvt_pk_bf16_f32 v84, v50, v51
 v_lshlrev_b32 v50, 16, v84
 v_and_b32 v51, 0xffff0000, v84
 v_pk_mul_f32 v[52:53], v[14:15], v[72:73]
 v_pk_mul_f32 v[54:55], v[16:17], v[72:73]
 v_pk_mul_f32 v[56:57], v[18:19], v[72:73]
 v_pk_mul_f32 v[58:59], v[20:21], v[72:73]
 v_pk_mul_f32 v[60:61], v[22:23], v[72:73]
 v_pk_mul_f32 v[62:63], v[24:25], v[72:73]
 v_pk_mul_f32 v[64:65], v[26:27], v[72:73]
 v_pk_mul_f32 v[66:67], v[28:29], v[72:73]
 v_cvt_pk_bf16_f32 v84, v52, v53
 v_lshlrev_b32 v52, 16, v84
 v_and_b32 v53, 0xffff0000, v84
 v_cvt_pk_bf16_f32 v84, v54, v55
 v_lshlrev_b32 v54, 16, v84
 v_and_b32 v55, 0xffff0000, v84
 v_cvt_pk_bf16_f32 v84, v56, v57
 v_lshlrev_b32 v56, 16, v84
 v_and_b32 v57, 0xffff0000, v84
 v_cvt_pk_bf16_f32 v84, v58, v59
 v_lshlrev_b32 v58, 16, v84
 v_and_b32 v59, 0xffff0000, v84
 v_cvt_pk_bf16_f32 v84, v60, v61
 v_lshlrev_b32 v60, 16, v84
 v_and_b32 v61, 0xffff0000, v84
 v_cvt_pk_bf16_f32 v84, v62, v63
 v_lshlrev_b32 v62, 16, v84
 v_and_b32 v63, 0xffff0000, v84
 v_cvt_pk_bf16_f32 v84, v64, v65
 v_lshlrev_b32 v64, 16, v84
 v_and_b32 v65, 0xffff0000, v84
 v_cvt_pk_bf16_f32 v84, v66, v67
 v_lshlrev_b32 v66, 16, v84
 v_and_b32 v67, 0xffff0000, v84
 v_pk_add_f32 v[36:37], v[36:37], v[52:53]
 v_pk_add_f32 v[38:39], v[38:39], v[54:55]
 v_pk_add_f32 v[40:41], v[40:41], v[56:57]
 v_pk_add_f32 v[42:43], v[42:43], v[58:59]
 v_pk_add_f32 v[44:45], v[44:45], v[60:61]
 v_pk_add_f32 v[46:47], v[46:47], v[62:63]
 v_pk_add_f32 v[48:49], v[48:49], v[64:65]
 v_pk_add_f32 v[50:51], v[50:51], v[66:67]
 v_cvt_pk_bf16_f32 v84, v36, v37
 v_lshlrev_b32 v36, 16, v84
 v_and_b32 v37, 0xffff0000, v84
 v_cvt_pk_bf16_f32 v84, v38, v39
 v_lshlrev_b32 v38, 16, v84
 v_and_b32 v39, 0xffff0000, v84
 v_cvt_pk_bf16_f32 v84, v40, v41
 v_lshlrev_b32 v40, 16, v84
 v_and_b32 v41, 0xffff0000, v84
 v_cvt_pk_bf16_f32 v84, v42, v43
 v_lshlrev_b32 v42, 16, v84
 v_and_b32 v43, 0xffff0000, v84
 v_cvt_pk_bf16_f32 v84, v44, v45
 v_lshlrev_b32 v44, 16, v84
 v_and_b32 v45, 0xffff0000, v84
 v_cvt_pk_bf16_f32 v84, v46, v47
 v_lshlrev_b32 v46, 16, v84
 v_and_b32 v47, 0xffff0000, v84
 v_cvt_pk_bf16_f32 v84, v48, v49
 v_lshlrev_b32 v48, 16, v84
 v_and_b32 v49, 0xffff0000, v84
 v_cvt_pk_bf16_f32 v84, v50, v51
 v_lshlrev_b32 v50, 16, v84
 v_and_b32 v51, 0xffff0000, v84
 v_pk_mul_f32 v[52:53], v[16:17], v[70:71]
 v_pk_mul_f32 v[54:55], v[18:19], v[70:71]
 v_pk_mul_f32 v[56:57], v[20:21], v[70:71]
 v_pk_mul_f32 v[58:59], v[22:23], v[70:71]
 v_pk_mul_f32 v[60:61], v[24:25], v[70:71]
 v_pk_mul_f32 v[62:63], v[26:27], v[70:71]
 v_pk_mul_f32 v[64:65], v[28:29], v[70:71]
 v_pk_mul_f32 v[66:67], v[30:31], v[70:71]
 v_cvt_pk_bf16_f32 v84, v52, v53
 v_lshlrev_b32 v52, 16, v84
 v_and_b32 v53, 0xffff0000, v84
 v_cvt_pk_bf16_f32 v84, v54, v55
 v_lshlrev_b32 v54, 16, v84
 v_and_b32 v55, 0xffff0000, v84
 v_cvt_pk_bf16_f32 v84, v56, v57
 v_lshlrev_b32 v56, 16, v84
 v_and_b32 v57, 0xffff0000, v84
 v_cvt_pk_bf16_f32 v84, v58, v59
 v_lshlrev_b32 v58, 16, v84
 v_and_b32 v59, 0xffff0000, v84
 v_cvt_pk_bf16_f32 v84, v60, v61
 v_lshlrev_b32 v60, 16, v84
 v_and_b32 v61, 0xffff0000, v84
 v_cvt_pk_bf16_f32 v84, v62, v63
 v_lshlrev_b32 v62, 16, v84
 v_and_b32 v63, 0xffff0000, v84
 v_cvt_pk_bf16_f32 v84, v64, v65
 v_lshlrev_b32 v64, 16, v84
 v_and_b32 v65, 0xffff0000, v84
 v_cvt_pk_bf16_f32 v84, v66, v67
 v_lshlrev_b32 v66, 16, v84
 v_and_b32 v67, 0xffff0000, v84
 v_pk_add_f32 v[36:37], v[36:37], v[52:53]
 v_pk_add_f32 v[38:39], v[38:39], v[54:55]
 v_pk_add_f32 v[40:41], v[40:41], v[56:57]
 v_pk_add_f32 v[42:43], v[42:43], v[58:59]
 v_pk_add_f32 v[44:45], v[44:45], v[60:61]
 v_pk_add_f32 v[46:47], v[46:47], v[62:63]
 v_pk_add_f32 v[48:49], v[48:49], v[64:65]
 v_pk_add_f32 v[50:51], v[50:51], v[66:67]
 v_cvt_pk_bf16_f32 v84, v36, v37
 v_lshlrev_b32 v36, 16, v84
 v_and_b32 v37, 0xffff0000, v84
 v_cvt_pk_bf16_f32 v84, v38, v39
 v_lshlrev_b32 v38, 16, v84
 v_and_b32 v39, 0xffff0000, v84
 v_cvt_pk_bf16_f32 v84, v40, v41
 v_lshlrev_b32 v40, 16, v84
 v_and_b32 v41, 0xffff0000, v84
 v_cvt_pk_bf16_f32 v84, v42, v43
 v_lshlrev_b32 v42, 16, v84
 v_and_b32 v43, 0xffff0000, v84
 v_cvt_pk_bf16_f32 v84, v44, v45
 v_lshlrev_b32 v44, 16, v84
 v_and_b32 v45, 0xffff0000, v84
 v_cvt_pk_bf16_f32 v84, v46, v47
 v_lshlrev_b32 v46, 16, v84
 v_and_b32 v47, 0xffff0000, v84
 v_cvt_pk_bf16_f32 v84, v48, v49
 v_lshlrev_b32 v48, 16, v84
 v_and_b32 v49, 0xffff0000, v84
 v_cvt_pk_bf16_f32 v84, v50, v51
 v_lshlrev_b32 v50, 16, v84
 v_and_b32 v51, 0xffff0000, v84
 v_pk_mul_f32 v[52:53], v[18:19], v[68:69]
 v_pk_mul_f32 v[54:55], v[20:21], v[68:69]
 v_pk_mul_f32 v[56:57], v[22:23], v[68:69]
 v_pk_mul_f32 v[58:59], v[24:25], v[68:69]
 v_pk_mul_f32 v[60:61], v[26:27], v[68:69]
 v_pk_mul_f32 v[62:63], v[28:29], v[68:69]
 v_pk_mul_f32 v[64:65], v[30:31], v[68:69]
 v_pk_mul_f32 v[66:67], v[32:33], v[68:69]
 v_cvt_pk_bf16_f32 v84, v52, v53
 v_lshlrev_b32 v52, 16, v84
 v_and_b32 v53, 0xffff0000, v84
 v_cvt_pk_bf16_f32 v84, v54, v55
 v_lshlrev_b32 v54, 16, v84
 v_and_b32 v55, 0xffff0000, v84
 v_cvt_pk_bf16_f32 v84, v56, v57
 v_lshlrev_b32 v56, 16, v84
 v_and_b32 v57, 0xffff0000, v84
 v_cvt_pk_bf16_f32 v84, v58, v59
 v_lshlrev_b32 v58, 16, v84
 v_and_b32 v59, 0xffff0000, v84
 v_cvt_pk_bf16_f32 v84, v60, v61
 v_lshlrev_b32 v60, 16, v84
 v_and_b32 v61, 0xffff0000, v84
 v_cvt_pk_bf16_f32 v84, v62, v63
 v_lshlrev_b32 v62, 16, v84
 v_and_b32 v63, 0xffff0000, v84
 v_cvt_pk_bf16_f32 v84, v64, v65
 v_lshlrev_b32 v64, 16, v84
 v_and_b32 v65, 0xffff0000, v84
 v_cvt_pk_bf16_f32 v84, v66, v67
 v_lshlrev_b32 v66, 16, v84
 v_and_b32 v67, 0xffff0000, v84
 v_pk_add_f32 v[36:37], v[36:37], v[52:53]
 v_pk_add_f32 v[38:39], v[38:39], v[54:55]
 v_pk_add_f32 v[40:41], v[40:41], v[56:57]
 v_pk_add_f32 v[42:43], v[42:43], v[58:59]
 v_pk_add_f32 v[44:45], v[44:45], v[60:61]
 v_pk_add_f32 v[46:47], v[46:47], v[62:63]
 v_pk_add_f32 v[48:49], v[48:49], v[64:65]
 v_pk_add_f32 v[50:51], v[50:51], v[66:67]
 v_cvt_pk_bf16_f32 v84, v36, v37
 v_lshlrev_b32 v36, 16, v84
 v_and_b32 v37, 0xffff0000, v84
 v_cvt_pk_bf16_f32 v84, v38, v39
 v_lshlrev_b32 v38, 16, v84
 v_and_b32 v39, 0xffff0000, v84
 v_cvt_pk_bf16_f32 v84, v40, v41
 v_lshlrev_b32 v40, 16, v84
 v_and_b32 v41, 0xffff0000, v84
 v_cvt_pk_bf16_f32 v84, v42, v43
 v_lshlrev_b32 v42, 16, v84
 v_and_b32 v43, 0xffff0000, v84
 v_cvt_pk_bf16_f32 v84, v44, v45
 v_lshlrev_b32 v44, 16, v84
 v_and_b32 v45, 0xffff0000, v84
 v_cvt_pk_bf16_f32 v84, v46, v47
 v_lshlrev_b32 v46, 16, v84
 v_and_b32 v47, 0xffff0000, v84
 v_cvt_pk_bf16_f32 v84, v48, v49
 v_lshlrev_b32 v48, 16, v84
 v_and_b32 v49, 0xffff0000, v84
 v_cvt_pk_bf16_f32 v84, v50, v51
 v_lshlrev_b32 v50, 16, v84
 v_and_b32 v51, 0xffff0000, v84
 v_lshlrev_b32 v12, 16, v145
 v_and_b32 v13, 0xffff0000, v145
 v_lshlrev_b32 v14, 16, v149
 v_and_b32 v15, 0xffff0000, v149
 v_lshlrev_b32 v16, 16, v153
 v_and_b32 v17, 0xffff0000, v153
 v_lshlrev_b32 v18, 16, v157
 v_and_b32 v19, 0xffff0000, v157
 v_lshlrev_b32 v20, 16, v161
 v_and_b32 v21, 0xffff0000, v161
 v_lshlrev_b32 v22, 16, v165
 v_and_b32 v23, 0xffff0000, v165
 v_lshlrev_b32 v24, 16, v169
 v_and_b32 v25, 0xffff0000, v169
 v_lshlrev_b32 v26, 16, v173
 v_and_b32 v27, 0xffff0000, v173
 v_pk_mul_f32 v[36:37], v[36:37], v[12:13]
 v_pk_mul_f32 v[38:39], v[38:39], v[14:15]
 v_pk_mul_f32 v[40:41], v[40:41], v[16:17]
 v_pk_mul_f32 v[42:43], v[42:43], v[18:19]
 v_pk_mul_f32 v[44:45], v[44:45], v[20:21]
 v_pk_mul_f32 v[46:47], v[46:47], v[22:23]
 v_pk_mul_f32 v[48:49], v[48:49], v[24:25]
 v_pk_mul_f32 v[50:51], v[50:51], v[26:27]
 v_cvt_pk_bf16_f32 v76, v50, v48
 v_cvt_pk_bf16_f32 v77, v46, v44
 v_cvt_pk_bf16_f32 v78, v42, v40
 v_cvt_pk_bf16_f32 v79, v38, v36
 s_add_u32 s3, s70, 8192
 buffer_store_dwordx4 v[76:79], v94, s[4:7], s3 offen sc1
 v_cvt_pk_bf16_f32 v80, v51, v49
 v_cvt_pk_bf16_f32 v81, v47, v45
 v_cvt_pk_bf16_f32 v82, v43, v41
 v_cvt_pk_bf16_f32 v83, v39, v37
 s_add_u32 s3, s70, 12288
 buffer_store_dwordx4 v[80:83], v94, s[4:7], s3 offen sc1
 v_lshlrev_b32 v12, 16, v102
 v_and_b32 v13, 0xffff0000, v102
 v_lshlrev_b32 v14, 16, v106
 v_and_b32 v15, 0xffff0000, v106
 v_lshlrev_b32 v16, 16, v110
 v_and_b32 v17, 0xffff0000, v110
 v_lshlrev_b32 v18, 16, v114
 v_and_b32 v19, 0xffff0000, v114
 v_lshlrev_b32 v20, 16, v118
 v_and_b32 v21, 0xffff0000, v118
 v_lshlrev_b32 v22, 16, v122
 v_and_b32 v23, 0xffff0000, v122
 v_lshlrev_b32 v24, 16, v126
 v_and_b32 v25, 0xffff0000, v126
 v_lshlrev_b32 v26, 16, v130
 v_and_b32 v27, 0xffff0000, v130
 v_lshlrev_b32 v28, 16, v134
 v_and_b32 v29, 0xffff0000, v134
 v_lshlrev_b32 v30, 16, v138
 v_and_b32 v31, 0xffff0000, v138
 v_lshlrev_b32 v32, 16, v142
 v_and_b32 v33, 0xffff0000, v142
 v_lshlrev_b32 v68, 16, v184
 v_lshlrev_b32 v69, 16, v186
 v_and_b32 v70, 0xffff0000, v184
 v_and_b32 v71, 0xffff0000, v186
 v_lshlrev_b32 v72, 16, v185
 v_lshlrev_b32 v73, 16, v187
 v_and_b32 v74, 0xffff0000, v185
 v_and_b32 v75, 0xffff0000, v187
 v_pk_mul_f32 v[36:37], v[12:13], v[74:75]
 v_pk_mul_f32 v[38:39], v[14:15], v[74:75]
 v_pk_mul_f32 v[40:41], v[16:17], v[74:75]
 v_pk_mul_f32 v[42:43], v[18:19], v[74:75]
 v_pk_mul_f32 v[44:45], v[20:21], v[74:75]
 v_pk_mul_f32 v[46:47], v[22:23], v[74:75]
 v_pk_mul_f32 v[48:49], v[24:25], v[74:75]
 v_pk_mul_f32 v[50:51], v[26:27], v[74:75]
 v_cvt_pk_bf16_f32 v84, v36, v37
 v_lshlrev_b32 v36, 16, v84
 v_and_b32 v37, 0xffff0000, v84
 v_cvt_pk_bf16_f32 v84, v38, v39
 v_lshlrev_b32 v38, 16, v84
 v_and_b32 v39, 0xffff0000, v84
 v_cvt_pk_bf16_f32 v84, v40, v41
 v_lshlrev_b32 v40, 16, v84
 v_and_b32 v41, 0xffff0000, v84
 v_cvt_pk_bf16_f32 v84, v42, v43
 v_lshlrev_b32 v42, 16, v84
 v_and_b32 v43, 0xffff0000, v84
 v_cvt_pk_bf16_f32 v84, v44, v45
 v_lshlrev_b32 v44, 16, v84
 v_and_b32 v45, 0xffff0000, v84
 v_cvt_pk_bf16_f32 v84, v46, v47
 v_lshlrev_b32 v46, 16, v84
 v_and_b32 v47, 0xffff0000, v84
 v_cvt_pk_bf16_f32 v84, v48, v49
 v_lshlrev_b32 v48, 16, v84
 v_and_b32 v49, 0xffff0000, v84
 v_cvt_pk_bf16_f32 v84, v50, v51
 v_lshlrev_b32 v50, 16, v84
 v_and_b32 v51, 0xffff0000, v84
 v_pk_mul_f32 v[52:53], v[14:15], v[72:73]
 v_pk_mul_f32 v[54:55], v[16:17], v[72:73]
 v_pk_mul_f32 v[56:57], v[18:19], v[72:73]
 v_pk_mul_f32 v[58:59], v[20:21], v[72:73]
 v_pk_mul_f32 v[60:61], v[22:23], v[72:73]
 v_pk_mul_f32 v[62:63], v[24:25], v[72:73]
 v_pk_mul_f32 v[64:65], v[26:27], v[72:73]
 v_pk_mul_f32 v[66:67], v[28:29], v[72:73]
 v_cvt_pk_bf16_f32 v84, v52, v53
 v_lshlrev_b32 v52, 16, v84
 v_and_b32 v53, 0xffff0000, v84
 v_cvt_pk_bf16_f32 v84, v54, v55
 v_lshlrev_b32 v54, 16, v84
 v_and_b32 v55, 0xffff0000, v84
 v_cvt_pk_bf16_f32 v84, v56, v57
 v_lshlrev_b32 v56, 16, v84
 v_and_b32 v57, 0xffff0000, v84
 v_cvt_pk_bf16_f32 v84, v58, v59
 v_lshlrev_b32 v58, 16, v84
 v_and_b32 v59, 0xffff0000, v84
 v_cvt_pk_bf16_f32 v84, v60, v61
 v_lshlrev_b32 v60, 16, v84
 v_and_b32 v61, 0xffff0000, v84
 v_cvt_pk_bf16_f32 v84, v62, v63
 v_lshlrev_b32 v62, 16, v84
 v_and_b32 v63, 0xffff0000, v84
 v_cvt_pk_bf16_f32 v84, v64, v65
 v_lshlrev_b32 v64, 16, v84
 v_and_b32 v65, 0xffff0000, v84
 v_cvt_pk_bf16_f32 v84, v66, v67
 v_lshlrev_b32 v66, 16, v84
 v_and_b32 v67, 0xffff0000, v84
 v_pk_add_f32 v[36:37], v[36:37], v[52:53]
 v_pk_add_f32 v[38:39], v[38:39], v[54:55]
 v_pk_add_f32 v[40:41], v[40:41], v[56:57]
 v_pk_add_f32 v[42:43], v[42:43], v[58:59]
 v_pk_add_f32 v[44:45], v[44:45], v[60:61]
 v_pk_add_f32 v[46:47], v[46:47], v[62:63]
 v_pk_add_f32 v[48:49], v[48:49], v[64:65]
 v_pk_add_f32 v[50:51], v[50:51], v[66:67]
 v_cvt_pk_bf16_f32 v84, v36, v37
 v_lshlrev_b32 v36, 16, v84
 v_and_b32 v37, 0xffff0000, v84
 v_cvt_pk_bf16_f32 v84, v38, v39
 v_lshlrev_b32 v38, 16, v84
 v_and_b32 v39, 0xffff0000, v84
 v_cvt_pk_bf16_f32 v84, v40, v41
 v_lshlrev_b32 v40, 16, v84
 v_and_b32 v41, 0xffff0000, v84
 v_cvt_pk_bf16_f32 v84, v42, v43
 v_lshlrev_b32 v42, 16, v84
 v_and_b32 v43, 0xffff0000, v84
 v_cvt_pk_bf16_f32 v84, v44, v45
 v_lshlrev_b32 v44, 16, v84
 v_and_b32 v45, 0xffff0000, v84
 v_cvt_pk_bf16_f32 v84, v46, v47
 v_lshlrev_b32 v46, 16, v84
 v_and_b32 v47, 0xffff0000, v84
 v_cvt_pk_bf16_f32 v84, v48, v49
 v_lshlrev_b32 v48, 16, v84
 v_and_b32 v49, 0xffff0000, v84
 v_cvt_pk_bf16_f32 v84, v50, v51
 v_lshlrev_b32 v50, 16, v84
 v_and_b32 v51, 0xffff0000, v84
 v_pk_mul_f32 v[52:53], v[16:17], v[70:71]
 v_pk_mul_f32 v[54:55], v[18:19], v[70:71]
 v_pk_mul_f32 v[56:57], v[20:21], v[70:71]
 v_pk_mul_f32 v[58:59], v[22:23], v[70:71]
 v_pk_mul_f32 v[60:61], v[24:25], v[70:71]
 v_pk_mul_f32 v[62:63], v[26:27], v[70:71]
 v_pk_mul_f32 v[64:65], v[28:29], v[70:71]
 v_pk_mul_f32 v[66:67], v[30:31], v[70:71]
 v_cvt_pk_bf16_f32 v84, v52, v53
 v_lshlrev_b32 v52, 16, v84
 v_and_b32 v53, 0xffff0000, v84
 v_cvt_pk_bf16_f32 v84, v54, v55
 v_lshlrev_b32 v54, 16, v84
 v_and_b32 v55, 0xffff0000, v84
 v_cvt_pk_bf16_f32 v84, v56, v57
 v_lshlrev_b32 v56, 16, v84
 v_and_b32 v57, 0xffff0000, v84
 v_cvt_pk_bf16_f32 v84, v58, v59
 v_lshlrev_b32 v58, 16, v84
 v_and_b32 v59, 0xffff0000, v84
 v_cvt_pk_bf16_f32 v84, v60, v61
 v_lshlrev_b32 v60, 16, v84
 v_and_b32 v61, 0xffff0000, v84
 v_cvt_pk_bf16_f32 v84, v62, v63
 v_lshlrev_b32 v62, 16, v84
 v_and_b32 v63, 0xffff0000, v84
 v_cvt_pk_bf16_f32 v84, v64, v65
 v_lshlrev_b32 v64, 16, v84
 v_and_b32 v65, 0xffff0000, v84
 v_cvt_pk_bf16_f32 v84, v66, v67
 v_lshlrev_b32 v66, 16, v84
 v_and_b32 v67, 0xffff0000, v84
 v_pk_add_f32 v[36:37], v[36:37], v[52:53]
 v_pk_add_f32 v[38:39], v[38:39], v[54:55]
 v_pk_add_f32 v[40:41], v[40:41], v[56:57]
 v_pk_add_f32 v[42:43], v[42:43], v[58:59]
 v_pk_add_f32 v[44:45], v[44:45], v[60:61]
 v_pk_add_f32 v[46:47], v[46:47], v[62:63]
 v_pk_add_f32 v[48:49], v[48:49], v[64:65]
 v_pk_add_f32 v[50:51], v[50:51], v[66:67]
 v_cvt_pk_bf16_f32 v84, v36, v37
 v_lshlrev_b32 v36, 16, v84
 v_and_b32 v37, 0xffff0000, v84
 v_cvt_pk_bf16_f32 v84, v38, v39
 v_lshlrev_b32 v38, 16, v84
 v_and_b32 v39, 0xffff0000, v84
 v_cvt_pk_bf16_f32 v84, v40, v41
 v_lshlrev_b32 v40, 16, v84
 v_and_b32 v41, 0xffff0000, v84
 v_cvt_pk_bf16_f32 v84, v42, v43
 v_lshlrev_b32 v42, 16, v84
 v_and_b32 v43, 0xffff0000, v84
 v_cvt_pk_bf16_f32 v84, v44, v45
 v_lshlrev_b32 v44, 16, v84
 v_and_b32 v45, 0xffff0000, v84
 v_cvt_pk_bf16_f32 v84, v46, v47
 v_lshlrev_b32 v46, 16, v84
 v_and_b32 v47, 0xffff0000, v84
 v_cvt_pk_bf16_f32 v84, v48, v49
 v_lshlrev_b32 v48, 16, v84
 v_and_b32 v49, 0xffff0000, v84
 v_cvt_pk_bf16_f32 v84, v50, v51
 v_lshlrev_b32 v50, 16, v84
 v_and_b32 v51, 0xffff0000, v84
 v_pk_mul_f32 v[52:53], v[18:19], v[68:69]
 v_pk_mul_f32 v[54:55], v[20:21], v[68:69]
 v_pk_mul_f32 v[56:57], v[22:23], v[68:69]
 v_pk_mul_f32 v[58:59], v[24:25], v[68:69]
 v_pk_mul_f32 v[60:61], v[26:27], v[68:69]
 v_pk_mul_f32 v[62:63], v[28:29], v[68:69]
 v_pk_mul_f32 v[64:65], v[30:31], v[68:69]
 v_pk_mul_f32 v[66:67], v[32:33], v[68:69]
 v_cvt_pk_bf16_f32 v84, v52, v53
 v_lshlrev_b32 v52, 16, v84
 v_and_b32 v53, 0xffff0000, v84
 v_cvt_pk_bf16_f32 v84, v54, v55
 v_lshlrev_b32 v54, 16, v84
 v_and_b32 v55, 0xffff0000, v84
 v_cvt_pk_bf16_f32 v84, v56, v57
 v_lshlrev_b32 v56, 16, v84
 v_and_b32 v57, 0xffff0000, v84
 v_cvt_pk_bf16_f32 v84, v58, v59
 v_lshlrev_b32 v58, 16, v84
 v_and_b32 v59, 0xffff0000, v84
 v_cvt_pk_bf16_f32 v84, v60, v61
 v_lshlrev_b32 v60, 16, v84
 v_and_b32 v61, 0xffff0000, v84
 v_cvt_pk_bf16_f32 v84, v62, v63
 v_lshlrev_b32 v62, 16, v84
 v_and_b32 v63, 0xffff0000, v84
 v_cvt_pk_bf16_f32 v84, v64, v65
 v_lshlrev_b32 v64, 16, v84
 v_and_b32 v65, 0xffff0000, v84
 v_cvt_pk_bf16_f32 v84, v66, v67
 v_lshlrev_b32 v66, 16, v84
 v_and_b32 v67, 0xffff0000, v84
 v_pk_add_f32 v[36:37], v[36:37], v[52:53]
 v_pk_add_f32 v[38:39], v[38:39], v[54:55]
 v_pk_add_f32 v[40:41], v[40:41], v[56:57]
 v_pk_add_f32 v[42:43], v[42:43], v[58:59]
 v_pk_add_f32 v[44:45], v[44:45], v[60:61]
 v_pk_add_f32 v[46:47], v[46:47], v[62:63]
 v_pk_add_f32 v[48:49], v[48:49], v[64:65]
 v_pk_add_f32 v[50:51], v[50:51], v[66:67]
 v_cvt_pk_bf16_f32 v84, v36, v37
 v_lshlrev_b32 v36, 16, v84
 v_and_b32 v37, 0xffff0000, v84
 v_cvt_pk_bf16_f32 v84, v38, v39
 v_lshlrev_b32 v38, 16, v84
 v_and_b32 v39, 0xffff0000, v84
 v_cvt_pk_bf16_f32 v84, v40, v41
 v_lshlrev_b32 v40, 16, v84
 v_and_b32 v41, 0xffff0000, v84
 v_cvt_pk_bf16_f32 v84, v42, v43
 v_lshlrev_b32 v42, 16, v84
 v_and_b32 v43, 0xffff0000, v84
 v_cvt_pk_bf16_f32 v84, v44, v45
 v_lshlrev_b32 v44, 16, v84
 v_and_b32 v45, 0xffff0000, v84
 v_cvt_pk_bf16_f32 v84, v46, v47
 v_lshlrev_b32 v46, 16, v84
 v_and_b32 v47, 0xffff0000, v84
 v_cvt_pk_bf16_f32 v84, v48, v49
 v_lshlrev_b32 v48, 16, v84
 v_and_b32 v49, 0xffff0000, v84
 v_cvt_pk_bf16_f32 v84, v50, v51
 v_lshlrev_b32 v50, 16, v84
 v_and_b32 v51, 0xffff0000, v84
 v_lshlrev_b32 v12, 16, v146
 v_and_b32 v13, 0xffff0000, v146
 v_lshlrev_b32 v14, 16, v150
 v_and_b32 v15, 0xffff0000, v150
 v_lshlrev_b32 v16, 16, v154
 v_and_b32 v17, 0xffff0000, v154
 v_lshlrev_b32 v18, 16, v158
 v_and_b32 v19, 0xffff0000, v158
 v_lshlrev_b32 v20, 16, v162
 v_and_b32 v21, 0xffff0000, v162
 v_lshlrev_b32 v22, 16, v166
 v_and_b32 v23, 0xffff0000, v166
 v_lshlrev_b32 v24, 16, v170
 v_and_b32 v25, 0xffff0000, v170
 v_lshlrev_b32 v26, 16, v174
 v_and_b32 v27, 0xffff0000, v174
 v_pk_mul_f32 v[36:37], v[36:37], v[12:13]
 v_pk_mul_f32 v[38:39], v[38:39], v[14:15]
 v_pk_mul_f32 v[40:41], v[40:41], v[16:17]
 v_pk_mul_f32 v[42:43], v[42:43], v[18:19]
 v_pk_mul_f32 v[44:45], v[44:45], v[20:21]
 v_pk_mul_f32 v[46:47], v[46:47], v[22:23]
 v_pk_mul_f32 v[48:49], v[48:49], v[24:25]
 v_pk_mul_f32 v[50:51], v[50:51], v[26:27]
 v_cvt_pk_bf16_f32 v76, v50, v48
 v_cvt_pk_bf16_f32 v77, v46, v44
 v_cvt_pk_bf16_f32 v78, v42, v40
 v_cvt_pk_bf16_f32 v79, v38, v36
 s_add_u32 s3, s70, 16384
 buffer_store_dwordx4 v[76:79], v94, s[4:7], s3 offen sc1
 v_cvt_pk_bf16_f32 v80, v51, v49
 v_cvt_pk_bf16_f32 v81, v47, v45
 v_cvt_pk_bf16_f32 v82, v43, v41
 v_cvt_pk_bf16_f32 v83, v39, v37
 s_add_u32 s3, s70, 20480
 buffer_store_dwordx4 v[80:83], v94, s[4:7], s3 offen sc1
 v_lshlrev_b32 v12, 16, v103
 v_and_b32 v13, 0xffff0000, v103
 v_lshlrev_b32 v14, 16, v107
 v_and_b32 v15, 0xffff0000, v107
 v_lshlrev_b32 v16, 16, v111
 v_and_b32 v17, 0xffff0000, v111
 v_lshlrev_b32 v18, 16, v115
 v_and_b32 v19, 0xffff0000, v115
 v_lshlrev_b32 v20, 16, v119
 v_and_b32 v21, 0xffff0000, v119
 v_lshlrev_b32 v22, 16, v123
 v_and_b32 v23, 0xffff0000, v123
 v_lshlrev_b32 v24, 16, v127
 v_and_b32 v25, 0xffff0000, v127
 v_lshlrev_b32 v26, 16, v131
 v_and_b32 v27, 0xffff0000, v131
 v_lshlrev_b32 v28, 16, v135
 v_and_b32 v29, 0xffff0000, v135
 v_lshlrev_b32 v30, 16, v139
 v_and_b32 v31, 0xffff0000, v139
 v_lshlrev_b32 v32, 16, v143
 v_and_b32 v33, 0xffff0000, v143
 v_lshlrev_b32 v68, 16, v188
 v_lshlrev_b32 v69, 16, v190
 v_and_b32 v70, 0xffff0000, v188
 v_and_b32 v71, 0xffff0000, v190
 v_lshlrev_b32 v72, 16, v189
 v_lshlrev_b32 v73, 16, v191
 v_and_b32 v74, 0xffff0000, v189
 v_and_b32 v75, 0xffff0000, v191
 v_pk_mul_f32 v[36:37], v[12:13], v[74:75]
 v_pk_mul_f32 v[38:39], v[14:15], v[74:75]
 v_pk_mul_f32 v[40:41], v[16:17], v[74:75]
 v_pk_mul_f32 v[42:43], v[18:19], v[74:75]
 v_pk_mul_f32 v[44:45], v[20:21], v[74:75]
 v_pk_mul_f32 v[46:47], v[22:23], v[74:75]
 v_pk_mul_f32 v[48:49], v[24:25], v[74:75]
 v_pk_mul_f32 v[50:51], v[26:27], v[74:75]
 v_cvt_pk_bf16_f32 v84, v36, v37
 v_lshlrev_b32 v36, 16, v84
 v_and_b32 v37, 0xffff0000, v84
 v_cvt_pk_bf16_f32 v84, v38, v39
 v_lshlrev_b32 v38, 16, v84
 v_and_b32 v39, 0xffff0000, v84
 v_cvt_pk_bf16_f32 v84, v40, v41
 v_lshlrev_b32 v40, 16, v84
 v_and_b32 v41, 0xffff0000, v84
 v_cvt_pk_bf16_f32 v84, v42, v43
 v_lshlrev_b32 v42, 16, v84
 v_and_b32 v43, 0xffff0000, v84
 v_cvt_pk_bf16_f32 v84, v44, v45
 v_lshlrev_b32 v44, 16, v84
 v_and_b32 v45, 0xffff0000, v84
 v_cvt_pk_bf16_f32 v84, v46, v47
 v_lshlrev_b32 v46, 16, v84
 v_and_b32 v47, 0xffff0000, v84
 v_cvt_pk_bf16_f32 v84, v48, v49
 v_lshlrev_b32 v48, 16, v84
 v_and_b32 v49, 0xffff0000, v84
 v_cvt_pk_bf16_f32 v84, v50, v51
 v_lshlrev_b32 v50, 16, v84
 v_and_b32 v51, 0xffff0000, v84
 v_pk_mul_f32 v[52:53], v[14:15], v[72:73]
 v_pk_mul_f32 v[54:55], v[16:17], v[72:73]
 v_pk_mul_f32 v[56:57], v[18:19], v[72:73]
 v_pk_mul_f32 v[58:59], v[20:21], v[72:73]
 v_pk_mul_f32 v[60:61], v[22:23], v[72:73]
 v_pk_mul_f32 v[62:63], v[24:25], v[72:73]
 v_pk_mul_f32 v[64:65], v[26:27], v[72:73]
 v_pk_mul_f32 v[66:67], v[28:29], v[72:73]
 v_cvt_pk_bf16_f32 v84, v52, v53
 v_lshlrev_b32 v52, 16, v84
 v_and_b32 v53, 0xffff0000, v84
 v_cvt_pk_bf16_f32 v84, v54, v55
 v_lshlrev_b32 v54, 16, v84
 v_and_b32 v55, 0xffff0000, v84
 v_cvt_pk_bf16_f32 v84, v56, v57
 v_lshlrev_b32 v56, 16, v84
 v_and_b32 v57, 0xffff0000, v84
 v_cvt_pk_bf16_f32 v84, v58, v59
 v_lshlrev_b32 v58, 16, v84
 v_and_b32 v59, 0xffff0000, v84
 v_cvt_pk_bf16_f32 v84, v60, v61
 v_lshlrev_b32 v60, 16, v84
 v_and_b32 v61, 0xffff0000, v84
 v_cvt_pk_bf16_f32 v84, v62, v63
 v_lshlrev_b32 v62, 16, v84
 v_and_b32 v63, 0xffff0000, v84
 v_cvt_pk_bf16_f32 v84, v64, v65
 v_lshlrev_b32 v64, 16, v84
 v_and_b32 v65, 0xffff0000, v84
 v_cvt_pk_bf16_f32 v84, v66, v67
 v_lshlrev_b32 v66, 16, v84
 v_and_b32 v67, 0xffff0000, v84
 v_pk_add_f32 v[36:37], v[36:37], v[52:53]
 v_pk_add_f32 v[38:39], v[38:39], v[54:55]
 v_pk_add_f32 v[40:41], v[40:41], v[56:57]
 v_pk_add_f32 v[42:43], v[42:43], v[58:59]
 v_pk_add_f32 v[44:45], v[44:45], v[60:61]
 v_pk_add_f32 v[46:47], v[46:47], v[62:63]
 v_pk_add_f32 v[48:49], v[48:49], v[64:65]
 v_pk_add_f32 v[50:51], v[50:51], v[66:67]
 v_cvt_pk_bf16_f32 v84, v36, v37
 v_lshlrev_b32 v36, 16, v84
 v_and_b32 v37, 0xffff0000, v84
 v_cvt_pk_bf16_f32 v84, v38, v39
 v_lshlrev_b32 v38, 16, v84
 v_and_b32 v39, 0xffff0000, v84
 v_cvt_pk_bf16_f32 v84, v40, v41
 v_lshlrev_b32 v40, 16, v84
 v_and_b32 v41, 0xffff0000, v84
 v_cvt_pk_bf16_f32 v84, v42, v43
 v_lshlrev_b32 v42, 16, v84
 v_and_b32 v43, 0xffff0000, v84
 v_cvt_pk_bf16_f32 v84, v44, v45
 v_lshlrev_b32 v44, 16, v84
 v_and_b32 v45, 0xffff0000, v84
 v_cvt_pk_bf16_f32 v84, v46, v47
 v_lshlrev_b32 v46, 16, v84
 v_and_b32 v47, 0xffff0000, v84
 v_cvt_pk_bf16_f32 v84, v48, v49
 v_lshlrev_b32 v48, 16, v84
 v_and_b32 v49, 0xffff0000, v84
 v_cvt_pk_bf16_f32 v84, v50, v51
 v_lshlrev_b32 v50, 16, v84
 v_and_b32 v51, 0xffff0000, v84
 v_pk_mul_f32 v[52:53], v[16:17], v[70:71]
 v_pk_mul_f32 v[54:55], v[18:19], v[70:71]
 v_pk_mul_f32 v[56:57], v[20:21], v[70:71]
 v_pk_mul_f32 v[58:59], v[22:23], v[70:71]
 v_pk_mul_f32 v[60:61], v[24:25], v[70:71]
 v_pk_mul_f32 v[62:63], v[26:27], v[70:71]
 v_pk_mul_f32 v[64:65], v[28:29], v[70:71]
 v_pk_mul_f32 v[66:67], v[30:31], v[70:71]
 v_cvt_pk_bf16_f32 v84, v52, v53
 v_lshlrev_b32 v52, 16, v84
 v_and_b32 v53, 0xffff0000, v84
 v_cvt_pk_bf16_f32 v84, v54, v55
 v_lshlrev_b32 v54, 16, v84
 v_and_b32 v55, 0xffff0000, v84
 v_cvt_pk_bf16_f32 v84, v56, v57
 v_lshlrev_b32 v56, 16, v84
 v_and_b32 v57, 0xffff0000, v84
 v_cvt_pk_bf16_f32 v84, v58, v59
 v_lshlrev_b32 v58, 16, v84
 v_and_b32 v59, 0xffff0000, v84
 v_cvt_pk_bf16_f32 v84, v60, v61
 v_lshlrev_b32 v60, 16, v84
 v_and_b32 v61, 0xffff0000, v84
 v_cvt_pk_bf16_f32 v84, v62, v63
 v_lshlrev_b32 v62, 16, v84
 v_and_b32 v63, 0xffff0000, v84
 v_cvt_pk_bf16_f32 v84, v64, v65
 v_lshlrev_b32 v64, 16, v84
 v_and_b32 v65, 0xffff0000, v84
 v_cvt_pk_bf16_f32 v84, v66, v67
 v_lshlrev_b32 v66, 16, v84
 v_and_b32 v67, 0xffff0000, v84
 v_pk_add_f32 v[36:37], v[36:37], v[52:53]
 v_pk_add_f32 v[38:39], v[38:39], v[54:55]
 v_pk_add_f32 v[40:41], v[40:41], v[56:57]
 v_pk_add_f32 v[42:43], v[42:43], v[58:59]
 v_pk_add_f32 v[44:45], v[44:45], v[60:61]
 v_pk_add_f32 v[46:47], v[46:47], v[62:63]
 v_pk_add_f32 v[48:49], v[48:49], v[64:65]
 v_pk_add_f32 v[50:51], v[50:51], v[66:67]
 v_cvt_pk_bf16_f32 v84, v36, v37
 v_lshlrev_b32 v36, 16, v84
 v_and_b32 v37, 0xffff0000, v84
 v_cvt_pk_bf16_f32 v84, v38, v39
 v_lshlrev_b32 v38, 16, v84
 v_and_b32 v39, 0xffff0000, v84
 v_cvt_pk_bf16_f32 v84, v40, v41
 v_lshlrev_b32 v40, 16, v84
 v_and_b32 v41, 0xffff0000, v84
 v_cvt_pk_bf16_f32 v84, v42, v43
 v_lshlrev_b32 v42, 16, v84
 v_and_b32 v43, 0xffff0000, v84
 v_cvt_pk_bf16_f32 v84, v44, v45
 v_lshlrev_b32 v44, 16, v84
 v_and_b32 v45, 0xffff0000, v84
 v_cvt_pk_bf16_f32 v84, v46, v47
 v_lshlrev_b32 v46, 16, v84
 v_and_b32 v47, 0xffff0000, v84
 v_cvt_pk_bf16_f32 v84, v48, v49
 v_lshlrev_b32 v48, 16, v84
 v_and_b32 v49, 0xffff0000, v84
 v_cvt_pk_bf16_f32 v84, v50, v51
 v_lshlrev_b32 v50, 16, v84
 v_and_b32 v51, 0xffff0000, v84
 v_pk_mul_f32 v[52:53], v[18:19], v[68:69]
 v_pk_mul_f32 v[54:55], v[20:21], v[68:69]
 v_pk_mul_f32 v[56:57], v[22:23], v[68:69]
 v_pk_mul_f32 v[58:59], v[24:25], v[68:69]
 v_pk_mul_f32 v[60:61], v[26:27], v[68:69]
 v_pk_mul_f32 v[62:63], v[28:29], v[68:69]
 v_pk_mul_f32 v[64:65], v[30:31], v[68:69]
 v_pk_mul_f32 v[66:67], v[32:33], v[68:69]
 v_cvt_pk_bf16_f32 v84, v52, v53
 v_lshlrev_b32 v52, 16, v84
 v_and_b32 v53, 0xffff0000, v84
 v_cvt_pk_bf16_f32 v84, v54, v55
 v_lshlrev_b32 v54, 16, v84
 v_and_b32 v55, 0xffff0000, v84
 v_cvt_pk_bf16_f32 v84, v56, v57
 v_lshlrev_b32 v56, 16, v84
 v_and_b32 v57, 0xffff0000, v84
 v_cvt_pk_bf16_f32 v84, v58, v59
 v_lshlrev_b32 v58, 16, v84
 v_and_b32 v59, 0xffff0000, v84
 v_cvt_pk_bf16_f32 v84, v60, v61
 v_lshlrev_b32 v60, 16, v84
 v_and_b32 v61, 0xffff0000, v84
 v_cvt_pk_bf16_f32 v84, v62, v63
 v_lshlrev_b32 v62, 16, v84
 v_and_b32 v63, 0xffff0000, v84
 v_cvt_pk_bf16_f32 v84, v64, v65
 v_lshlrev_b32 v64, 16, v84
 v_and_b32 v65, 0xffff0000, v84
 v_cvt_pk_bf16_f32 v84, v66, v67
 v_lshlrev_b32 v66, 16, v84
 v_and_b32 v67, 0xffff0000, v84
 v_pk_add_f32 v[36:37], v[36:37], v[52:53]
 v_pk_add_f32 v[38:39], v[38:39], v[54:55]
 v_pk_add_f32 v[40:41], v[40:41], v[56:57]
 v_pk_add_f32 v[42:43], v[42:43], v[58:59]
 v_pk_add_f32 v[44:45], v[44:45], v[60:61]
 v_pk_add_f32 v[46:47], v[46:47], v[62:63]
 v_pk_add_f32 v[48:49], v[48:49], v[64:65]
 v_pk_add_f32 v[50:51], v[50:51], v[66:67]
 v_cvt_pk_bf16_f32 v84, v36, v37
 v_lshlrev_b32 v36, 16, v84
 v_and_b32 v37, 0xffff0000, v84
 v_cvt_pk_bf16_f32 v84, v38, v39
 v_lshlrev_b32 v38, 16, v84
 v_and_b32 v39, 0xffff0000, v84
 v_cvt_pk_bf16_f32 v84, v40, v41
 v_lshlrev_b32 v40, 16, v84
 v_and_b32 v41, 0xffff0000, v84
 v_cvt_pk_bf16_f32 v84, v42, v43
 v_lshlrev_b32 v42, 16, v84
 v_and_b32 v43, 0xffff0000, v84
 v_cvt_pk_bf16_f32 v84, v44, v45
 v_lshlrev_b32 v44, 16, v84
 v_and_b32 v45, 0xffff0000, v84
 v_cvt_pk_bf16_f32 v84, v46, v47
 v_lshlrev_b32 v46, 16, v84
 v_and_b32 v47, 0xffff0000, v84
 v_cvt_pk_bf16_f32 v84, v48, v49
 v_lshlrev_b32 v48, 16, v84
 v_and_b32 v49, 0xffff0000, v84
 v_cvt_pk_bf16_f32 v84, v50, v51
 v_lshlrev_b32 v50, 16, v84
 v_and_b32 v51, 0xffff0000, v84
 v_lshlrev_b32 v12, 16, v147
 v_and_b32 v13, 0xffff0000, v147
 v_lshlrev_b32 v14, 16, v151
 v_and_b32 v15, 0xffff0000, v151
 v_lshlrev_b32 v16, 16, v155
 v_and_b32 v17, 0xffff0000, v155
 v_lshlrev_b32 v18, 16, v159
 v_and_b32 v19, 0xffff0000, v159
 v_lshlrev_b32 v20, 16, v163
 v_and_b32 v21, 0xffff0000, v163
 v_lshlrev_b32 v22, 16, v167
 v_and_b32 v23, 0xffff0000, v167
 v_lshlrev_b32 v24, 16, v171
 v_and_b32 v25, 0xffff0000, v171
 v_lshlrev_b32 v26, 16, v175
 v_and_b32 v27, 0xffff0000, v175
 v_pk_mul_f32 v[36:37], v[36:37], v[12:13]
 v_pk_mul_f32 v[38:39], v[38:39], v[14:15]
 v_pk_mul_f32 v[40:41], v[40:41], v[16:17]
 v_pk_mul_f32 v[42:43], v[42:43], v[18:19]
 v_pk_mul_f32 v[44:45], v[44:45], v[20:21]
 v_pk_mul_f32 v[46:47], v[46:47], v[22:23]
 v_pk_mul_f32 v[48:49], v[48:49], v[24:25]
 v_pk_mul_f32 v[50:51], v[50:51], v[26:27]
 v_cvt_pk_bf16_f32 v76, v50, v48
 v_cvt_pk_bf16_f32 v77, v46, v44
 v_cvt_pk_bf16_f32 v78, v42, v40
 v_cvt_pk_bf16_f32 v79, v38, v36
 s_add_u32 s3, s70, 24576
 buffer_store_dwordx4 v[76:79], v94, s[4:7], s3 offen sc1
 v_cvt_pk_bf16_f32 v80, v51, v49
 v_cvt_pk_bf16_f32 v81, v47, v45
 v_cvt_pk_bf16_f32 v82, v43, v41
 v_cvt_pk_bf16_f32 v83, v39, v37
 s_add_u32 s3, s70, 28672
 buffer_store_dwordx4 v[80:83], v94, s[4:7], s3 offen sc1
 s_cmp_eq_u32 s83, 1
 s_cbranch_scc1 L_k3_27
 s_waitcnt vmcnt(0)
 s_barrier
 s_cmp_lg_u32 s50, 3
 s_cbranch_scc1 L_ar_28
 s_mov_b32 s96, s44
 s_and_b32 s97, s45, 0xffff
 s_mov_b32 s98, 256
 s_mov_b32 s99, 0x00020000
 v_mov_b32 v1, 1
 s_mov_b64 exec, 1
 buffer_atomic_add v1, off, s[96:99], 0 offset:80 sc0
 s_waitcnt vmcnt(0)
 v_cmp_eq_u32 vcc, 39, v1
 s_cbranch_vccz L_aw_29
 buffer_store_dword v1, off, s[96:99], 0 offset:208 sc1
L_aw_29:
 s_mov_b64 exec, -1
L_ar_28:
 s_branch L_help_conv
L_k3_27:
 s_waitcnt vmcnt(0)
 s_barrier
 s_cmp_lg_u32 s50, 3
 s_cbranch_scc1 L_ar_30
 s_mov_b32 s96, s44
 s_and_b32 s97, s45, 0xffff
 s_mov_b32 s98, 256
 s_mov_b32 s99, 0x00020000
 v_mov_b32 v1, 1
 s_mov_b64 exec, 1
 buffer_atomic_add v1, off, s[96:99], 0 offset:68 sc0
 s_waitcnt vmcnt(0)
 v_cmp_eq_u32 vcc, 39, v1
 s_cbranch_vccz L_aw_31
 buffer_store_dword v1, off, s[96:99], 0 offset:196 sc1
L_aw_31:
 s_mov_b64 exec, -1
L_ar_30:
 s_mov_b32 s8, s26
 s_and_b32 s9, s27, 0xffff
 s_mov_b32 s10, 5242880
 s_mov_b32 s11, 0x00020000
 s_mul_i32 s57, s50, 40960
 s_and_b32 s55, s53, 3
 s_add_u32 s64, s55, 0
 s_sub_u32 s3, s64, 4
 s_cmp_ge_u32 s64, 4
 s_cselect_b32 s64, s3, s64
 s_add_u32 s65, s55, 1
 s_sub_u32 s3, s65, 4
 s_cmp_ge_u32 s65, 4
 s_cselect_b32 s65, s3, s65
 s_add_u32 s66, s55, 2
 s_sub_u32 s3, s66, 4
 s_cmp_ge_u32 s66, 4
 s_cselect_b32 s66, s3, s66
 s_add_u32 s67, s55, 3
 s_sub_u32 s3, s67, 4
 s_cmp_ge_u32 s67, 4
 s_cselect_b32 s67, s3, s67
 s_mul_i32 s55, s52, 655360
 s_lshl_b32 s3, s53, 8
 s_add_u32 s55, s55, s3
 v_lshrrev_b32 v4, 4, v0
 s_mov_b32 s3, 1280
 v_mul_lo_u32 v4, v4, s3
 v_lshrrev_b32 v3, 3, v0
 v_and_b32 v3, 6, v3
 v_xor_b32 v3, v3, v0
 v_and_b32 v3, 15, v3
 v_lshl_add_u32 v4, v3, 4, v4
 v_xor_b32 v5, 128, v4
 s_lshl_b32 s57, s50, 13
 s_mul_i32 s3, s50, 40960
 s_add_u32 s55, s55, s3
 s_mul_i32 s51, s64, 163840
 s_add_u32 s51, s51, s55
 s_add_u32 m0, s57, 0
 s_nop 0
 buffer_load_dwordx4 v4, s[8:11], s51 offen lds
 s_add_u32 s51, s51, 5120
 s_add_u32 m0, s57, 1024
 s_nop 0
 buffer_load_dwordx4 v5, s[8:11], s51 offen lds
 s_add_u32 s51, s51, 5120
 s_add_u32 m0, s57, 2048
 s_nop 0
 buffer_load_dwordx4 v4, s[8:11], s51 offen lds
 s_add_u32 s51, s51, 5120
 s_add_u32 m0, s57, 3072
 s_nop 0
 buffer_load_dwordx4 v5, s[8:11], s51 offen lds
 s_add_u32 s51, s51, 5120
 s_add_u32 m0, s57, 4096
 s_nop 0
 buffer_load_dwordx4 v4, s[8:11], s51 offen lds
 s_add_u32 s51, s51, 5120
 s_add_u32 m0, s57, 5120
 s_nop 0
 buffer_load_dwordx4 v5, s[8:11], s51 offen lds
 s_add_u32 s51, s51, 5120
 s_add_u32 m0, s57, 6144
 s_nop 0
 buffer_load_dwordx4 v4, s[8:11], s51 offen lds
 s_add_u32 s51, s51, 5120
 s_add_u32 m0, s57, 7168
 s_nop 0
 buffer_load_dwordx4 v5, s[8:11], s51 offen lds
 s_add_u32 s51, s51, 5120
 s_mul_i32 s51, s65, 163840
 s_add_u32 s51, s51, s55
 s_add_u32 m0, s57, 32768
 s_nop 0
 buffer_load_dwordx4 v4, s[8:11], s51 offen lds
 s_add_u32 s51, s51, 5120
 s_add_u32 m0, s57, 33792
 s_nop 0
 buffer_load_dwordx4 v5, s[8:11], s51 offen lds
 s_add_u32 s51, s51, 5120
 s_add_u32 m0, s57, 34816
 s_nop 0
 buffer_load_dwordx4 v4, s[8:11], s51 offen lds
 s_add_u32 s51, s51, 5120
 s_add_u32 m0, s57, 35840
 s_nop 0
 buffer_load_dwordx4 v5, s[8:11], s51 offen lds
 s_add_u32 s51, s51, 5120
 s_add_u32 m0, s57, 36864
 s_nop 0
 buffer_load_dwordx4 v4, s[8:11], s51 offen lds
 s_add_u32 s51, s51, 5120
 s_add_u32 m0, s57, 37888
 s_nop 0
 buffer_load_dwordx4 v5, s[8:11], s51 offen lds
 s_add_u32 s51, s51, 5120
 s_add_u32 m0, s57, 38912
 s_nop 0
 buffer_load_dwordx4 v4, s[8:11], s51 offen lds
 s_add_u32 s51, s51, 5120
 s_add_u32 m0, s57, 39936
 s_nop 0
 buffer_load_dwordx4 v5, s[8:11], s51 offen lds
 s_add_u32 s51, s51, 5120
 s_mul_i32 s51, s66, 163840
 s_add_u32 s51, s51, s55
 s_add_u32 m0, s57, 65536
 s_nop 0
 buffer_load_dwordx4 v4, s[8:11], s51 offen lds
 s_add_u32 s51, s51, 5120
 s_add_u32 m0, s57, 66560
 s_nop 0
 buffer_load_dwordx4 v5, s[8:11], s51 offen lds
 s_add_u32 s51, s51, 5120
 s_add_u32 m0, s57, 67584
 s_nop 0
 buffer_load_dwordx4 v4, s[8:11], s51 offen lds
 s_add_u32 s51, s51, 5120
 s_add_u32 m0, s57, 68608
 s_nop 0
 buffer_load_dwordx4 v5, s[8:11], s51 offen lds
 s_add_u32 s51, s51, 5120
 s_add_u32 m0, s57, 69632
 s_nop 0
 buffer_load_dwordx4 v4, s[8:11], s51 offen lds
 s_add_u32 s51, s51, 5120
 s_add_u32 m0, s57, 70656
 s_nop 0
 buffer_load_dwordx4 v5, s[8:11], s51 offen lds
 s_add_u32 s51, s51, 5120
 s_add_u32 m0, s57, 71680
 s_nop 0
 buffer_load_dwordx4 v4, s[8:11], s51 offen lds
 s_add_u32 s51, s51, 5120
 s_add_u32 m0, s57, 72704
 s_nop 0
 buffer_load_dwordx4 v5, s[8:11], s51 offen lds
 s_add_u32 s51, s51, 5120
 s_mul_i32 s51, s67, 163840
 s_add_u32 s51, s51, s55
 s_add_u32 m0, s57, 98304
 s_nop 0
 buffer_load_dwordx4 v4, s[8:11], s51 offen lds
 s_add_u32 s51, s51, 5120
 s_add_u32 m0, s57, 99328
 s_nop 0
 buffer_load_dwordx4 v5, s[8:11], s51 offen lds
 s_add_u32 s51, s51, 5120
 s_add_u32 m0, s57, 100352
 s_nop 0
 buffer_load_dwordx4 v4, s[8:11], s51 offen lds
 s_add_u32 s51, s51, 5120
 s_add_u32 m0, s57, 101376
 s_nop 0
 buffer_load_dwordx4 v5, s[8:11], s51 offen lds
 s_add_u32 s51, s51, 5120
 s_add_u32 m0, s57, 102400
 s_nop 0
 buffer_load_dwordx4 v4, s[8:11], s51 offen lds
 s_add_u32 s51, s51, 5120
 s_add_u32 m0, s57, 103424
 s_nop 0
 buffer_load_dwordx4 v5, s[8:11], s51 offen lds
 s_add_u32 s51, s51, 5120
 s_add_u32 m0, s57, 104448
 s_nop 0
 buffer_load_dwordx4 v4, s[8:11], s51 offen lds
 s_add_u32 s51, s51, 5120
 s_add_u32 m0, s57, 105472
 s_nop 0
 buffer_load_dwordx4 v5, s[8:11], s51 offen lds
 s_add_u32 s51, s51, 5120
 v_lshrrev_b32 v2, 3, v0
 v_and_b32 v2, 4, v2
 v_bfe_u32 v3, v0, 2, 2
 v_or_b32 v2, v2, v3
 v_bfe_u32 v3, v0, 4, 1
 v_xor_b32 v3, v3, v2
 s_lshl_b32 s3, s50, 1
 v_xor_b32 v3, s3, v3
 v_lshlrev_b32 v2, 8, v2
 v_lshl_add_u32 v2, v3, 5, v2
 v_and_b32 v3, 3, v0
 v_lshl_add_u32 v2, v3, 3, v2
 s_waitcnt vmcnt(24)
 s_barrier
 ds_read_b64_tr_b16 a[0:1], v2 offset:0
 ds_read_b64_tr_b16 a[2:3], v2 offset:4096
 ds_read_b64_tr_b16 a[4:5], v2 offset:2048
 ds_read_b64_tr_b16 a[6:7], v2 offset:6144
 ds_read_b64_tr_b16 a[8:9], v2 offset:8192
 ds_read_b64_tr_b16 a[10:11], v2 offset:12288
 ds_read_b64_tr_b16 a[12:13], v2 offset:10240
 ds_read_b64_tr_b16 a[14:15], v2 offset:14336
 ds_read_b64_tr_b16 a[16:17], v2 offset:16384
 ds_read_b64_tr_b16 a[18:19], v2 offset:20480
 ds_read_b64_tr_b16 a[20:21], v2 offset:18432
 ds_read_b64_tr_b16 a[22:23], v2 offset:22528
 ds_read_b64_tr_b16 a[24:25], v2 offset:24576
 ds_read_b64_tr_b16 a[26:27], v2 offset:28672
 ds_read_b64_tr_b16 a[28:29], v2 offset:26624
 ds_read_b64_tr_b16 a[30:31], v2 offset:30720
 v_add_u32 v2, 0x8000, v2
 s_waitcnt vmcnt(16)
 s_barrier
 ds_read_b64_tr_b16 a[32:33], v2 offset:0
 ds_read_b64_tr_b16 a[34:35], v2 offset:4096
 ds_read_b64_tr_b16 a[36:37], v2 offset:2048
 ds_read_b64_tr_b16 a[38:39], v2 offset:6144
 ds_read_b64_tr_b16 a[40:41], v2 offset:8192
 ds_read_b64_tr_b16 a[42:43], v2 offset:12288
 ds_read_b64_tr_b16 a[44:45], v2 offset:10240
 ds_read_b64_tr_b16 a[46:47], v2 offset:14336
 ds_read_b64_tr_b16 a[48:49], v2 offset:16384
 ds_read_b64_tr_b16 a[50:51], v2 offset:20480
 ds_read_b64_tr_b16 a[52:53], v2 offset:18432
 ds_read_b64_tr_b16 a[54:55], v2 offset:22528
 ds_read_b64_tr_b16 a[56:57], v2 offset:24576
 ds_read_b64_tr_b16 a[58:59], v2 offset:28672
 ds_read_b64_tr_b16 a[60:61], v2 offset:26624
 ds_read_b64_tr_b16 a[62:63], v2 offset:30720
 v_add_u32 v2, 0x8000, v2
 s_waitcnt vmcnt(8)
 s_barrier
 ds_read_b64_tr_b16 a[64:65], v2 offset:0
 ds_read_b64_tr_b16 a[66:67], v2 offset:4096
 ds_read_b64_tr_b16 a[68:69], v2 offset:2048
 ds_read_b64_tr_b16 a[70:71], v2 offset:6144
 ds_read_b64_tr_b16 a[72:73], v2 offset:8192
 ds_read_b64_tr_b16 a[74:75], v2 offset:12288
 ds_read_b64_tr_b16 a[76:77], v2 offset:10240
 ds_read_b64_tr_b16 a[78:79], v2 offset:14336
 ds_read_b64_tr_b16 a[80:81], v2 offset:16384
 ds_read_b64_tr_b16 a[82:83], v2 offset:20480
 ds_read_b64_tr_b16 a[84:85], v2 offset:18432
 ds_read_b64_tr_b16 a[86:87], v2 offset:22528
 ds_read_b64_tr_b16 a[88:89], v2 offset:24576
 ds_read_b64_tr_b16 a[90:91], v2 offset:28672
 ds_read_b64_tr_b16 a[92:93], v2 offset:26624
 ds_read_b64_tr_b16 a[94:95], v2 offset:30720
 v_add_u32 v2, 0x8000, v2
 s_waitcnt vmcnt(0)
 s_barrier
 ds_read_b64_tr_b16 a[96:97], v2 offset:0
 ds_read_b64_tr_b16 a[98:99], v2 offset:4096
 ds_read_b64_tr_b16 a[100:101], v2 offset:2048
 ds_read_b64_tr_b16 a[102:103], v2 offset:6144
 ds_read_b64_tr_b16 a[104:105], v2 offset:8192
 ds_read_b64_tr_b16 a[106:107], v2 offset:12288
 ds_read_b64_tr_b16 a[108:109], v2 offset:10240
 ds_read_b64_tr_b16 a[110:111], v2 offset:14336
 ds_read_b64_tr_b16 a[112:113], v2 offset:16384
 ds_read_b64_tr_b16 a[114:115], v2 offset:20480
 ds_read_b64_tr_b16 a[116:117], v2 offset:18432
 ds_read_b64_tr_b16 a[118:119], v2 offset:22528
 ds_read_b64_tr_b16 a[120:121], v2 offset:24576
 ds_read_b64_tr_b16 a[122:123], v2 offset:28672
 ds_read_b64_tr_b16 a[124:125], v2 offset:26624
 ds_read_b64_tr_b16 a[126:127], v2 offset:30720
 v_add_u32 v2, 0x8000, v2
 s_waitcnt lgkmcnt(0)
 s_barrier
L_help_conv:
 s_cmp_ge_u32 s82, 64
 s_cbranch_scc1 L_help_done
 s_lshl_b32 s70, s82, 2
 s_add_u32 s70, s70, s50
 s_add_u32 s70, s70, 384
 s_mul_i32 s71, s50, 13312
 s_mov_b32 s69, 640
 s_mov_b32 s8, s38
 s_and_b32 s9, s39, 0xffff
 s_mov_b32 s10, 2621440
 s_mov_b32 s11, 0x00020000
 s_mov_b32 s12, s40
 s_and_b32 s13, s41, 0xffff
 s_mov_b32 s14, 1280
 s_mov_b32 s15, 0x00020000
 v_lshlrev_b32 v130, 4, v0
 s_lshl_b32 s73, s70, 12
 s_add_u32 s74, s73, 2
 buffer_load_dwordx4 v[96:99], v130, s[8:11], s73 offen offset:0
 buffer_load_dwordx4 v[100:103], v130, s[8:11], s73 offen offset:1024
 buffer_load_dwordx4 v[112:115], v130, s[8:11], s74 offen offset:0
 buffer_load_dwordx4 v[116:119], v130, s[8:11], s74 offen offset:1024
 s_lshl_b32 s3, s70, 1
 buffer_load_ushort v128, off, s[12:15], s3
 s_getpc_b64 s[76:77]
L_ca_32:
 s_add_u32 s76, s76, L_conv0-L_ca_32
 s_addc_u32 s77, s77, -1
 s_swappc_b64 s[76:77], s[76:77]
 s_waitcnt vmcnt(0)
 s_barrier
 s_cmp_lg_u32 s50, 3
 s_cbranch_scc1 L_ar_33
 s_mov_b32 s96, s44
 s_and_b32 s97, s45, 0xffff
 s_mov_b32 s98, 256
 s_mov_b32 s99, 0x00020000
 v_mov_b32 v1, 1
 s_mov_b64 exec, 1
 buffer_atomic_add v1, off, s[96:99], 0 offset:8 sc0
 s_waitcnt vmcnt(0)
 v_cmp_eq_u32 vcc, 159, v1
 s_cbranch_vccz L_aw_34
 buffer_store_dword v1, off, s[96:99], 0 offset:136 sc1
L_aw_34:
 s_mov_b64 exec, -1
L_ar_33:
L_help_done:
 s_cmp_lg_u32 s50, 0
 s_cbranch_scc1 L_ww_35
 s_mov_b32 s96, s44
 s_and_b32 s97, s45, 0xffff
 s_mov_b32 s98, 256
 s_mov_b32 s99, 0x00020000
 v_mov_b32 v1, 132
 s_mov_b32 s51, 0
 s_mov_b64 exec, 1
L_wb_36:
 buffer_load_dword v2, v1, s[96:99], 0 offen sc1
 s_waitcnt vmcnt(0)
 v_cmp_eq_u32 vcc, 0, v2
 s_cbranch_vccz L_wbd_37
 s_sleep 2
 s_add_u32 s51, s51, 1
 s_cmp_lt_u32 s51, 131072
 s_cbranch_scc1 L_wb_36
 s_branch L_bail
L_wbd_37:
 s_mov_b64 exec, -1
L_ww_35:
 s_barrier
 s_cmp_eq_u32 s83, 0
 s_cbranch_scc1 L_t4
 s_cmp_eq_u32 s83, 1
 s_cbranch_scc1 L_wo
 s_cmp_eq_u32 s83, 2
 s_cbranch_scc1 L_vr_far
 s_cmp_eq_u32 s83, 4
 s_cbranch_scc1 L_ch_far
 s_branch L_wm
L_late:
 s_lshl_b32 s60, s82, 2
 s_add_u32 s60, s60, s50
 s_mul_i32 s71, s50, 13312
 s_add_u32 s72, s60, 544
 s_mov_b32 s8, s16
 s_and_b32 s9, s17, 0xffff
 s_mov_b32 s10, 2621440
 s_mov_b32 s11, 0x00020000
 v_lshlrev_b32 v1, 4, v0
 v_lshlrev_b32 v2, 3, v0
 v_cmp_lt_u32 vcc, 31, v0
 v_mov_b32 v3, 268435456
 s_nop 1
 v_cndmask_b32 v7, v2, v3, vcc
 s_mov_b32 s63, 0x3acccccd
 s_mov_b32 s68, 0x3727c5ac
 s_add_u32 s3, s72, 0
 s_mul_i32 s3, s3, 1280
 buffer_load_dwordx2 v[48:49], v2, s[8:11], s3 offen offset:0
 buffer_load_dwordx2 v[50:51], v2, s[8:11], s3 offen offset:512
 buffer_load_dwordx2 v[52:53], v7, s[8:11], s3 offen offset:1024
 s_waitcnt vmcnt(0)
L_ln_38:
 v_lshlrev_b32 v12, 16, v48
 v_and_b32 v13, 0xffff0000, v48
 v_lshlrev_b32 v14, 16, v49
 v_and_b32 v15, 0xffff0000, v49
 v_lshlrev_b32 v16, 16, v50
 v_and_b32 v17, 0xffff0000, v50
 v_lshlrev_b32 v18, 16, v51
 v_and_b32 v19, 0xffff0000, v51
 v_lshlrev_b32 v20, 16, v52
 v_and_b32 v21, 0xffff0000, v52
 v_lshlrev_b32 v22, 16, v53
 v_and_b32 v23, 0xffff0000, v53
 s_add_u32 s3, s72, 64
 s_mul_i32 s3, s3, 1280
 buffer_load_dwordx2 v[48:49], v2, s[8:11], s3 offen offset:0
 buffer_load_dwordx2 v[50:51], v2, s[8:11], s3 offen offset:512
 buffer_load_dwordx2 v[52:53], v7, s[8:11], s3 offen offset:1024
 s_and_b32 s3, s72, 15
 v_lshrrev_b32 v4, 3, v0
 v_lshlrev_b32 v4, 2, v4
 v_and_b32 v9, 3, v0
 v_add_u32 v4, v4, v9
 v_xor_b32 v4, s3, v4
 v_lshlrev_b32 v4, 4, v4
 v_and_b32 v9, 4, v0
 v_lshl_add_u32 v4, v9, 1, v4
 v_cndmask_b32 v8, v4, v3, vcc
 v_readfirstlane_b32 s3, v12
 s_nop 1
 v_subrev_f32 v36, s3, v12
 v_subrev_f32 v37, s3, v13
 v_subrev_f32 v38, s3, v14
 v_subrev_f32 v39, s3, v15
 v_subrev_f32 v40, s3, v16
 v_subrev_f32 v41, s3, v17
 v_subrev_f32 v42, s3, v18
 v_subrev_f32 v43, s3, v19
 v_mov_b32 v44, 0
 v_mov_b32 v45, 0
 v_mov_b32 v46, 0
 v_mov_b32 v47, 0
 s_mov_b32 exec_hi, 0
 v_subrev_f32 v44, s3, v20
 v_subrev_f32 v45, s3, v21
 v_subrev_f32 v46, s3, v22
 v_subrev_f32 v47, s3, v23
 s_mov_b32 exec_hi, -1
 v_pk_mul_f32 v[10:11], v[36:37], v[36:37]
 v_pk_fma_f32 v[10:11], v[38:39], v[38:39], v[10:11]
 v_pk_fma_f32 v[10:11], v[40:41], v[40:41], v[10:11]
 v_pk_fma_f32 v[10:11], v[42:43], v[42:43], v[10:11]
 v_pk_fma_f32 v[10:11], v[44:45], v[44:45], v[10:11]
 v_pk_fma_f32 v[10:11], v[46:47], v[46:47], v[10:11]
 v_pk_add_f32 v[36:37], v[36:37], v[38:39]
 v_pk_add_f32 v[36:37], v[36:37], v[40:41]
 v_pk_add_f32 v[36:37], v[36:37], v[42:43]
 v_pk_add_f32 v[36:37], v[36:37], v[44:45]
 v_pk_add_f32 v[36:37], v[36:37], v[46:47]
 v_add_f32 v11, v10, v11
 v_add_f32 v10, v36, v37
 s_nop 0
 v_add_f32_dpp v11, v11, v11 quad_perm:[1,0,3,2] row_mask:0xf bank_mask:0xf
 v_add_f32_dpp v10, v10, v10 quad_perm:[1,0,3,2] row_mask:0xf bank_mask:0xf
 s_nop 0
 v_add_f32_dpp v11, v11, v11 quad_perm:[2,3,0,1] row_mask:0xf bank_mask:0xf
 v_add_f32_dpp v10, v10, v10 quad_perm:[2,3,0,1] row_mask:0xf bank_mask:0xf
 s_nop 0
 v_add_f32_dpp v11, v11, v11 row_half_mirror row_mask:0xf bank_mask:0xf
 v_add_f32_dpp v10, v10, v10 row_half_mirror row_mask:0xf bank_mask:0xf
 s_nop 0
 v_add_f32_dpp v11, v11, v11 row_mirror row_mask:0xf bank_mask:0xf
 v_add_f32_dpp v10, v10, v10 row_mirror row_mask:0xf bank_mask:0xf
 v_mov_b32 v37, v11
 v_mov_b32 v36, v10
 s_nop 0
 v_permlane16_swap_b32 v11, v37
 v_permlane16_swap_b32 v10, v36
 v_pk_add_f32 v[10:11], v[10:11], v[36:37]
 v_mov_b32 v37, v11
 v_mov_b32 v36, v10
 s_nop 0
 v_permlane32_swap_b32 v11, v37
 v_permlane32_swap_b32 v10, v36
 v_pk_add_f32 v[10:11], v[10:11], v[36:37]
 v_mul_f32 v10, s63, v10
 v_mul_f32 v11, s63, v11
 v_fma_f32 v11, -v10, v10, v11
 v_max_f32 v11, 0, v11
 v_add_f32 v10, s3, v10
 v_cvt_pk_bf16_f32 v9, v10, v11
 v_lshlrev_b32 v10, 16, v9
 v_and_b32 v11, 0xffff0000, v9
 v_add_f32 v11, s68, v11
 v_cvt_pk_bf16_f32 v11, v11, v11
 v_and_b32 v11, 0xffff0000, v11
 v_sqrt_f32 v11, v11
 s_nop 0
 v_pk_add_f32 v[36:37], v[12:13], v[10:11] op_sel_hi:[1,0] neg_lo:[0,1] neg_hi:[0,1]
 v_pk_add_f32 v[38:39], v[14:15], v[10:11] op_sel_hi:[1,0] neg_lo:[0,1] neg_hi:[0,1]
 v_pk_add_f32 v[40:41], v[16:17], v[10:11] op_sel_hi:[1,0] neg_lo:[0,1] neg_hi:[0,1]
 v_pk_add_f32 v[42:43], v[18:19], v[10:11] op_sel_hi:[1,0] neg_lo:[0,1] neg_hi:[0,1]
 v_pk_add_f32 v[44:45], v[20:21], v[10:11] op_sel_hi:[1,0] neg_lo:[0,1] neg_hi:[0,1]
 v_pk_add_f32 v[46:47], v[22:23], v[10:11] op_sel_hi:[1,0] neg_lo:[0,1] neg_hi:[0,1]
 v_cvt_pk_bf16_f32 v11, v11, v11
 v_and_b32 v11, 0xffff0000, v11
 v_rcp_f32 v11, v11
 v_cvt_pk_bf16_f32 v9, v36, v37
 v_lshlrev_b32 v36, 16, v9
 v_and_b32 v37, 0xffff0000, v9
 v_cvt_pk_bf16_f32 v9, v38, v39
 v_lshlrev_b32 v38, 16, v9
 v_and_b32 v39, 0xffff0000, v9
 v_cvt_pk_bf16_f32 v9, v40, v41
 v_lshlrev_b32 v40, 16, v9
 v_and_b32 v41, 0xffff0000, v9
 v_cvt_pk_bf16_f32 v9, v42, v43
 v_lshlrev_b32 v42, 16, v9
 v_and_b32 v43, 0xffff0000, v9
 v_cvt_pk_bf16_f32 v9, v44, v45
 v_lshlrev_b32 v44, 16, v9
 v_and_b32 v45, 0xffff0000, v9
 v_cvt_pk_bf16_f32 v9, v46, v47
 v_lshlrev_b32 v46, 16, v9
 v_and_b32 v47, 0xffff0000, v9
 v_pk_mul_f32 v[36:37], v[36:37], v[10:11] op_sel:[0,1] op_sel_hi:[1,1]
 v_pk_mul_f32 v[38:39], v[38:39], v[10:11] op_sel:[0,1] op_sel_hi:[1,1]
 v_pk_mul_f32 v[40:41], v[40:41], v[10:11] op_sel:[0,1] op_sel_hi:[1,1]
 v_pk_mul_f32 v[42:43], v[42:43], v[10:11] op_sel:[0,1] op_sel_hi:[1,1]
 v_pk_mul_f32 v[44:45], v[44:45], v[10:11] op_sel:[0,1] op_sel_hi:[1,1]
 v_pk_mul_f32 v[46:47], v[46:47], v[10:11] op_sel:[0,1] op_sel_hi:[1,1]
 v_cvt_pk_bf16_f32 v24, v36, v37
 v_cvt_pk_bf16_f32 v25, v38, v39
 v_cvt_pk_bf16_f32 v26, v40, v41
 v_cvt_pk_bf16_f32 v27, v42, v43
 v_cvt_pk_bf16_f32 v28, v44, v45
 v_cvt_pk_bf16_f32 v29, v46, v47
 s_mul_i32 s3, s72, 1280
 s_add_u32 s3, s3, 192937984
 buffer_store_dwordx2 v[24:25], v4, s[4:7], s3 offen offset:0 sc1
 buffer_store_dwordx2 v[26:27], v4, s[4:7], s3 offen offset:512 sc1
 buffer_store_dwordx2 v[28:29], v8, s[4:7], s3 offen offset:1024 sc1
 s_add_u32 s72, s72, 64
 s_waitcnt vmcnt(3)
 s_cmp_lt_u32 s72, 2048
 s_cbranch_scc1 L_ln_38
 s_waitcnt vmcnt(0)
 s_mov_b32 s96, s44
 s_and_b32 s97, s45, 0xffff
 s_mov_b32 s98, 256
 s_mov_b32 s99, 0x00020000
 v_mov_b32 v1, 1
 s_mov_b64 exec, 1
 buffer_atomic_add v1, off, s[96:99], 0 offset:12 sc0
 s_waitcnt vmcnt(0)
 v_cmp_eq_u32 vcc, 63, v1
 s_cbranch_vccz L_aw_39
 buffer_store_dword v1, off, s[96:99], 0 offset:140 sc1
L_aw_39:
 s_mov_b64 exec, -1
 s_branch L_ch_far
L_qkvq:
 s_mul_i32 s57, s50, 40960
 s_mul_i32 s62, s52, 3
 s_add_u32 s62, s62, s53
 s_mul_i32 s3, s62, 13108
 s_lshr_b32 s3, s3, 16
 s_mul_i32 s3, s3, 5
 s_sub_u32 s55, s62, s3
 s_add_u32 s64, s55, 0
 s_sub_u32 s3, s64, 5
 s_cmp_ge_u32 s64, 5
 s_cselect_b32 s64, s3, s64
 s_add_u32 s65, s55, 1
 s_sub_u32 s3, s65, 5
 s_cmp_ge_u32 s65, 5
 s_cselect_b32 s65, s3, s65
 s_add_u32 s66, s55, 2
 s_sub_u32 s3, s66, 5
 s_cmp_ge_u32 s66, 5
 s_cselect_b32 s66, s3, s66
 s_add_u32 s67, s55, 3
 s_sub_u32 s3, s67, 5
 s_cmp_ge_u32 s67, 5
 s_cselect_b32 s67, s3, s67
 s_add_u32 s68, s55, 4
 s_sub_u32 s3, s68, 5
 s_cmp_ge_u32 s68, 5
 s_cselect_b32 s68, s3, s68
 s_lshl_b32 s55, s52, 8
 v_lshrrev_b32 v4, 4, v0
 s_mov_b32 s3, 8192
 v_mul_lo_u32 v4, v4, s3
 v_lshrrev_b32 v3, 3, v0
 v_and_b32 v3, 6, v3
 v_xor_b32 v3, v3, v0
 v_and_b32 v3, 15, v3
 v_lshl_add_u32 v4, v3, 4, v4
 v_xor_b32 v5, 128, v4
 s_lshl_b32 s57, s50, 13
 s_mul_i32 s3, s50, 262144
 s_add_u32 s55, s55, s3
 s_mul_i32 s51, s64, 1048576
 s_add_u32 s51, s51, s55
 s_add_u32 m0, s57, 0
 s_nop 0
 buffer_load_dwordx4 v4, s[8:11], s51 offen lds
 s_add_u32 s51, s51, 32768
 s_add_u32 m0, s57, 1024
 s_nop 0
 buffer_load_dwordx4 v5, s[8:11], s51 offen lds
 s_add_u32 s51, s51, 32768
 s_add_u32 m0, s57, 2048
 s_nop 0
 buffer_load_dwordx4 v4, s[8:11], s51 offen lds
 s_add_u32 s51, s51, 32768
 s_add_u32 m0, s57, 3072
 s_nop 0
 buffer_load_dwordx4 v5, s[8:11], s51 offen lds
 s_add_u32 s51, s51, 32768
 s_add_u32 m0, s57, 4096
 s_nop 0
 buffer_load_dwordx4 v4, s[8:11], s51 offen lds
 s_add_u32 s51, s51, 32768
 s_add_u32 m0, s57, 5120
 s_nop 0
 buffer_load_dwordx4 v5, s[8:11], s51 offen lds
 s_add_u32 s51, s51, 32768
 s_add_u32 m0, s57, 6144
 s_nop 0
 buffer_load_dwordx4 v4, s[8:11], s51 offen lds
 s_add_u32 s51, s51, 32768
 s_add_u32 m0, s57, 7168
 s_nop 0
 buffer_load_dwordx4 v5, s[8:11], s51 offen lds
 s_add_u32 s51, s51, 32768
 s_mul_i32 s51, s65, 1048576
 s_add_u32 s51, s51, s55
 s_add_u32 m0, s57, 32768
 s_nop 0
 buffer_load_dwordx4 v4, s[8:11], s51 offen lds
 s_add_u32 s51, s51, 32768
 s_add_u32 m0, s57, 33792
 s_nop 0
 buffer_load_dwordx4 v5, s[8:11], s51 offen lds
 s_add_u32 s51, s51, 32768
 s_add_u32 m0, s57, 34816
 s_nop 0
 buffer_load_dwordx4 v4, s[8:11], s51 offen lds
 s_add_u32 s51, s51, 32768
 s_add_u32 m0, s57, 35840
 s_nop 0
 buffer_load_dwordx4 v5, s[8:11], s51 offen lds
 s_add_u32 s51, s51, 32768
 s_add_u32 m0, s57, 36864
 s_nop 0
 buffer_load_dwordx4 v4, s[8:11], s51 offen lds
 s_add_u32 s51, s51, 32768
 s_add_u32 m0, s57, 37888
 s_nop 0
 buffer_load_dwordx4 v5, s[8:11], s51 offen lds
 s_add_u32 s51, s51, 32768
 s_add_u32 m0, s57, 38912
 s_nop 0
 buffer_load_dwordx4 v4, s[8:11], s51 offen lds
 s_add_u32 s51, s51, 32768
 s_add_u32 m0, s57, 39936
 s_nop 0
 buffer_load_dwordx4 v5, s[8:11], s51 offen lds
 s_add_u32 s51, s51, 32768
 s_mul_i32 s51, s66, 1048576
 s_add_u32 s51, s51, s55
 s_add_u32 m0, s57, 65536
 s_nop 0
 buffer_load_dwordx4 v4, s[8:11], s51 offen lds
 s_add_u32 s51, s51, 32768
 s_add_u32 m0, s57, 66560
 s_nop 0
 buffer_load_dwordx4 v5, s[8:11], s51 offen lds
 s_add_u32 s51, s51, 32768
 s_add_u32 m0, s57, 67584
 s_nop 0
 buffer_load_dwordx4 v4, s[8:11], s51 offen lds
 s_add_u32 s51, s51, 32768
 s_add_u32 m0, s57, 68608
 s_nop 0
 buffer_load_dwordx4 v5, s[8:11], s51 offen lds
 s_add_u32 s51, s51, 32768
 s_add_u32 m0, s57, 69632
 s_nop 0
 buffer_load_dwordx4 v4, s[8:11], s51 offen lds
 s_add_u32 s51, s51, 32768
 s_add_u32 m0, s57, 70656
 s_nop 0
 buffer_load_dwordx4 v5, s[8:11], s51 offen lds
 s_add_u32 s51, s51, 32768
 s_add_u32 m0, s57, 71680
 s_nop 0
 buffer_load_dwordx4 v4, s[8:11], s51 offen lds
 s_add_u32 s51, s51, 32768
 s_add_u32 m0, s57, 72704
 s_nop 0
 buffer_load_dwordx4 v5, s[8:11], s51 offen lds
 s_add_u32 s51, s51, 32768
 s_mul_i32 s51, s67, 1048576
 s_add_u32 s51, s51, s55
 s_add_u32 m0, s57, 98304
 s_nop 0
 buffer_load_dwordx4 v4, s[8:11], s51 offen lds
 s_add_u32 s51, s51, 32768
 s_add_u32 m0, s57, 99328
 s_nop 0
 buffer_load_dwordx4 v5, s[8:11], s51 offen lds
 s_add_u32 s51, s51, 32768
 s_add_u32 m0, s57, 100352
 s_nop 0
 buffer_load_dwordx4 v4, s[8:11], s51 offen lds
 s_add_u32 s51, s51, 32768
 s_add_u32 m0, s57, 101376
 s_nop 0
 buffer_load_dwordx4 v5, s[8:11], s51 offen lds
 s_add_u32 s51, s51, 32768
 s_add_u32 m0, s57, 102400
 s_nop 0
 buffer_load_dwordx4 v4, s[8:11], s51 offen lds
 s_add_u32 s51, s51, 32768
 s_add_u32 m0, s57, 103424
 s_nop 0
 buffer_load_dwordx4 v5, s[8:11], s51 offen lds
 s_add_u32 s51, s51, 32768
 s_add_u32 m0, s57, 104448
 s_nop 0
 buffer_load_dwordx4 v4, s[8:11], s51 offen lds
 s_add_u32 s51, s51, 32768
 s_add_u32 m0, s57, 105472
 s_nop 0
 buffer_load_dwordx4 v5, s[8:11], s51 offen lds
 s_add_u32 s51, s51, 32768
 s_mul_i32 s51, s68, 1048576
 s_add_u32 s51, s51, s55
 s_add_u32 m0, s57, 131072
 s_nop 0
 buffer_load_dwordx4 v4, s[8:11], s51 offen lds
 s_add_u32 s51, s51, 32768
 s_add_u32 m0, s57, 132096
 s_nop 0
 buffer_load_dwordx4 v5, s[8:11], s51 offen lds
 s_add_u32 s51, s51, 32768
 s_add_u32 m0, s57, 133120
 s_nop 0
 buffer_load_dwordx4 v4, s[8:11], s51 offen lds
 s_add_u32 s51, s51, 32768
 s_add_u32 m0, s57, 134144
 s_nop 0
 buffer_load_dwordx4 v5, s[8:11], s51 offen lds
 s_add_u32 s51, s51, 32768
 s_add_u32 m0, s57, 135168
 s_nop 0
 buffer_load_dwordx4 v4, s[8:11], s51 offen lds
 s_add_u32 s51, s51, 32768
 s_add_u32 m0, s57, 136192
 s_nop 0
 buffer_load_dwordx4 v5, s[8:11], s51 offen lds
 s_add_u32 s51, s51, 32768
 s_add_u32 m0, s57, 137216
 s_nop 0
 buffer_load_dwordx4 v4, s[8:11], s51 offen lds
 s_add_u32 s51, s51, 32768
 s_add_u32 m0, s57, 138240
 s_nop 0
 buffer_load_dwordx4 v5, s[8:11], s51 offen lds
 s_add_u32 s51, s51, 32768
 s_mov_b32 s96, s44
 s_and_b32 s97, s45, 0xffff
 s_mov_b32 s98, 256
 s_mov_b32 s99, 0x00020000
 buffer_load_dword v30, off, s[96:99], 0 offset:132 sc1
 v_lshrrev_b32 v2, 3, v0
 v_and_b32 v2, 4, v2
 v_bfe_u32 v3, v0, 2, 2
 v_or_b32 v2, v2, v3
 v_bfe_u32 v3, v0, 4, 1
 v_xor_b32 v3, v3, v2
 s_lshl_b32 s3, s50, 1
 v_xor_b32 v3, s3, v3
 v_lshlrev_b32 v2, 8, v2
 v_lshl_add_u32 v2, v3, 5, v2
 v_and_b32 v3, 3, v0
 v_lshl_add_u32 v2, v3, 3, v2
 s_waitcnt vmcnt(32)
 s_barrier
 ds_read_b64_tr_b16 a[0:1], v2 offset:0
 ds_read_b64_tr_b16 a[2:3], v2 offset:4096
 ds_read_b64_tr_b16 a[4:5], v2 offset:2048
 ds_read_b64_tr_b16 a[6:7], v2 offset:6144
 ds_read_b64_tr_b16 a[8:9], v2 offset:8192
 ds_read_b64_tr_b16 a[10:11], v2 offset:12288
 ds_read_b64_tr_b16 a[12:13], v2 offset:10240
 ds_read_b64_tr_b16 a[14:15], v2 offset:14336
 ds_read_b64_tr_b16 a[16:17], v2 offset:16384
 ds_read_b64_tr_b16 a[18:19], v2 offset:20480
 ds_read_b64_tr_b16 a[20:21], v2 offset:18432
 ds_read_b64_tr_b16 a[22:23], v2 offset:22528
 ds_read_b64_tr_b16 a[24:25], v2 offset:24576
 ds_read_b64_tr_b16 a[26:27], v2 offset:28672
 ds_read_b64_tr_b16 a[28:29], v2 offset:26624
 ds_read_b64_tr_b16 a[30:31], v2 offset:30720
 v_add_u32 v2, 0x8000, v2
 s_waitcnt vmcnt(24)
 s_barrier
 ds_read_b64_tr_b16 a[32:33], v2 offset:0
 ds_read_b64_tr_b16 a[34:35], v2 offset:4096
 ds_read_b64_tr_b16 a[36:37], v2 offset:2048
 ds_read_b64_tr_b16 a[38:39], v2 offset:6144
 ds_read_b64_tr_b16 a[40:41], v2 offset:8192
 ds_read_b64_tr_b16 a[42:43], v2 offset:12288
 ds_read_b64_tr_b16 a[44:45], v2 offset:10240
 ds_read_b64_tr_b16 a[46:47], v2 offset:14336
 ds_read_b64_tr_b16 a[48:49], v2 offset:16384
 ds_read_b64_tr_b16 a[50:51], v2 offset:20480
 ds_read_b64_tr_b16 a[52:53], v2 offset:18432
 ds_read_b64_tr_b16 a[54:55], v2 offset:22528
 ds_read_b64_tr_b16 a[56:57], v2 offset:24576
 ds_read_b64_tr_b16 a[58:59], v2 offset:28672
 ds_read_b64_tr_b16 a[60:61], v2 offset:26624
 ds_read_b64_tr_b16 a[62:63], v2 offset:30720
 v_add_u32 v2, 0x8000, v2
 s_waitcnt vmcnt(16)
 s_barrier
 ds_read_b64_tr_b16 a[64:65], v2 offset:0
 ds_read_b64_tr_b16 a[66:67], v2 offset:4096
 ds_read_b64_tr_b16 a[68:69], v2 offset:2048
 ds_read_b64_tr_b16 a[70:71], v2 offset:6144
 ds_read_b64_tr_b16 a[72:73], v2 offset:8192
 ds_read_b64_tr_b16 a[74:75], v2 offset:12288
 ds_read_b64_tr_b16 a[76:77], v2 offset:10240
 ds_read_b64_tr_b16 a[78:79], v2 offset:14336
 ds_read_b64_tr_b16 a[80:81], v2 offset:16384
 ds_read_b64_tr_b16 a[82:83], v2 offset:20480
 ds_read_b64_tr_b16 a[84:85], v2 offset:18432
 ds_read_b64_tr_b16 a[86:87], v2 offset:22528
 ds_read_b64_tr_b16 a[88:89], v2 offset:24576
 ds_read_b64_tr_b16 a[90:91], v2 offset:28672
 ds_read_b64_tr_b16 a[92:93], v2 offset:26624
 ds_read_b64_tr_b16 a[94:95], v2 offset:30720
 v_add_u32 v2, 0x8000, v2
 s_waitcnt vmcnt(8)
 s_barrier
 ds_read_b64_tr_b16 a[96:97], v2 offset:0
 ds_read_b64_tr_b16 a[98:99], v2 offset:4096
 ds_read_b64_tr_b16 a[100:101], v2 offset:2048
 ds_read_b64_tr_b16 a[102:103], v2 offset:6144
 ds_read_b64_tr_b16 a[104:105], v2 offset:8192
 ds_read_b64_tr_b16 a[106:107], v2 offset:12288
 ds_read_b64_tr_b16 a[108:109], v2 offset:10240
 ds_read_b64_tr_b16 a[110:111], v2 offset:14336
 ds_read_b64_tr_b16 a[112:113], v2 offset:16384
 ds_read_b64_tr_b16 a[114:115], v2 offset:20480
 ds_read_b64_tr_b16 a[116:117], v2 offset:18432
 ds_read_b64_tr_b16 a[118:119], v2 offset:22528
 ds_read_b64_tr_b16 a[120:121], v2 offset:24576
 ds_read_b64_tr_b16 a[122:123], v2 offset:28672
 ds_read_b64_tr_b16 a[124:125], v2 offset:26624
 ds_read_b64_tr_b16 a[126:127], v2 offset:30720
 v_add_u32 v2, 0x8000, v2
 s_waitcnt vmcnt(0)
 s_barrier
 ds_read_b64_tr_b16 a[128:129], v2 offset:0
 ds_read_b64_tr_b16 a[130:131], v2 offset:4096
 ds_read_b64_tr_b16 a[132:133], v2 offset:2048
 ds_read_b64_tr_b16 a[134:135], v2 offset:6144
 ds_read_b64_tr_b16 a[136:137], v2 offset:8192
 ds_read_b64_tr_b16 a[138:139], v2 offset:12288
 ds_read_b64_tr_b16 a[140:141], v2 offset:10240
 ds_read_b64_tr_b16 a[142:143], v2 offset:14336
 ds_read_b64_tr_b16 a[144:145], v2 offset:16384
 ds_read_b64_tr_b16 a[146:147], v2 offset:20480
 ds_read_b64_tr_b16 a[148:149], v2 offset:18432
 ds_read_b64_tr_b16 a[150:151], v2 offset:22528
 ds_read_b64_tr_b16 a[152:153], v2 offset:24576
 ds_read_b64_tr_b16 a[154:155], v2 offset:28672
 ds_read_b64_tr_b16 a[156:157], v2 offset:26624
 ds_read_b64_tr_b16 a[158:159], v2 offset:30720
 v_add_u32 v2, 0x8000, v2
 s_waitcnt lgkmcnt(0)
 s_barrier
 v_cmp_eq_u32 vcc, 0, v30
 s_cbranch_vccz L_qa_40
 s_mov_b32 s96, s44
 s_and_b32 s97, s45, 0xffff
 s_mov_b32 s98, 256
 s_mov_b32 s99, 0x00020000
 v_mov_b32 v1, 132
 s_mov_b32 s51, 0
 s_mov_b64 exec, 1
L_wb_41:
 buffer_load_dword v2, v1, s[96:99], 0 offen sc1
 s_waitcnt vmcnt(0)
 v_cmp_eq_u32 vcc, 0, v2
 s_cbranch_vccz L_wbd_42
 s_sleep 2
 s_add_u32 s51, s51, 1
 s_cmp_lt_u32 s51, 131072
 s_cbranch_scc1 L_wb_41
 s_branch L_bail
L_wbd_42:
 s_mov_b64 exec, -1
L_qa_40:
 s_lshl_b32 s64, s64, 8
 s_lshl_b32 s65, s65, 8
 s_lshl_b32 s66, s66, 8
 s_lshl_b32 s67, s67, 8
 s_lshl_b32 s68, s68, 8
 v_lshrrev_b32 v1, 4, v0
 s_mov_b32 s3, 1280
 v_mul_lo_u32 v1, v1, s3
 v_and_b32 v3, 15, v0
 v_lshl_add_u32 v1, v3, 4, v1
 v_add_u32 v6, 5120, v1
 v_mov_b32 v24, v6
 v_and_b32 v2, 31, v0
 v_lshlrev_b32 v2, 8, v2
 v_lshrrev_b32 v4, 5, v0
 v_xor_b32 v4, v4, v3
 v_xor_b32 v8, 0, v4
 v_lshl_add_u32 v8, v8, 4, v2
 v_add_u32 v16, 40960, v8
 v_xor_b32 v9, 2, v4
 v_lshl_add_u32 v9, v9, 4, v2
 v_add_u32 v17, 40960, v9
 v_xor_b32 v10, 4, v4
 v_lshl_add_u32 v10, v10, 4, v2
 v_add_u32 v18, 40960, v10
 v_xor_b32 v11, 6, v4
 v_lshl_add_u32 v11, v11, 4, v2
 v_add_u32 v19, 40960, v11
 v_xor_b32 v12, 8, v4
 v_lshl_add_u32 v12, v12, 4, v2
 v_add_u32 v20, 40960, v12
 v_xor_b32 v13, 10, v4
 v_lshl_add_u32 v13, v13, 4, v2
 v_add_u32 v21, 40960, v13
 v_xor_b32 v14, 12, v4
 v_lshl_add_u32 v14, v14, 4, v2
 v_add_u32 v22, 40960, v14
 v_xor_b32 v15, 14, v4
 v_lshl_add_u32 v15, v15, 4, v2
 v_add_u32 v23, 40960, v15
 v_lshrrev_b32 v4, 5, v0
 v_lshlrev_b32 v4, 8, v4
 v_lshl_add_u32 v4, v3, 4, v4
 v_and_b32 v2, 16, v0
 v_lshl_add_u32 v4, v2, 8, v4
 s_lshl_b32 s3, s50, 10
 v_add_u32 v4, s3, v4
 v_mul_u32_u24 v5, 49152, v0
 v_mov_b32 v7, 163776
 s_lshl_b32 s75, s62, 2
 s_add_u32 s75, s75, s50
 s_and_b32 s100, s52, 1
 s_lshl_b32 s100, s100, 13
 s_lshl_b32 s58, s52, 14
 s_add_u32 s58, s58, s100
 s_add_u32 s58, s58, 16777216
 s_cmp_eq_u32 s53, 0
 s_cselect_b32 s82, 8192, 0
 s_lshl_b32 s59, s52, 8
 s_add_u32 s59, s59, 16384
 s_lshl_b32 s56, s50, 11
 s_mov_b32 s54, 0
 s_mov_b32 s61, 0
 s_mov_b32 s70, s75
 s_mul_i32 s55, s54, 40960
 s_mul_i32 s3, s50, 10240
 s_add_u32 s55, s55, s3
 s_add_u32 s55, s55, 192937984
 s_add_u32 m0, s56, 0
 s_add_u32 s3, s55, s64
 buffer_load_dwordx4 v1, s[4:7], s3 offen sc1 lds
 s_add_u32 m0, s56, 1024
 s_add_u32 s3, s55, s64
 buffer_load_dwordx4 v24, s[4:7], s3 offen sc1 lds
 s_add_u32 m0, s56, 8192
 s_add_u32 s3, s55, s65
 buffer_load_dwordx4 v1, s[4:7], s3 offen sc1 lds
 s_add_u32 m0, s56, 9216
 s_add_u32 s3, s55, s65
 buffer_load_dwordx4 v24, s[4:7], s3 offen sc1 lds
 s_add_u32 m0, s56, 16384
 s_add_u32 s3, s55, s66
 buffer_load_dwordx4 v1, s[4:7], s3 offen sc1 lds
 s_add_u32 m0, s56, 17408
 s_add_u32 s3, s55, s66
 buffer_load_dwordx4 v24, s[4:7], s3 offen sc1 lds
 s_add_u32 m0, s56, 24576
 s_add_u32 s3, s55, s67
 buffer_load_dwordx4 v1, s[4:7], s3 offen sc1 lds
 s_add_u32 m0, s56, 25600
 s_add_u32 s3, s55, s67
 buffer_load_dwordx4 v24, s[4:7], s3 offen sc1 lds
 s_add_u32 m0, s56, 32768
 s_add_u32 s3, s55, s68
 buffer_load_dwordx4 v1, s[4:7], s3 offen sc1 lds
 s_add_u32 m0, s56, 33792
 s_add_u32 s3, s55, s68
 buffer_load_dwordx4 v24, s[4:7], s3 offen sc1 lds
 s_waitcnt vmcnt(0)
L_qkvq_pre:
 s_barrier
 s_mov_b32 s60, s54
 s_add_u32 s54, s54, 1
 s_mul_i32 s55, s54, 40960
 s_mul_i32 s3, s50, 10240
 s_add_u32 s55, s55, s3
 s_add_u32 s55, s55, 192937984
 ds_read_b128 v[32:35], v8 offset:0
 ds_read_b128 v[36:39], v9 offset:0
 ds_read_b128 v[40:43], v10 offset:0
 ds_read_b128 v[44:47], v11 offset:0
 s_waitcnt lgkmcnt(3)
 v_mfma_f32_32x32x16_bf16 v[64:79], a[0:3], v[32:35], 0
 ds_read_b128 v[48:51], v12 offset:0
 s_add_u32 m0, s56, 40960
 s_add_u32 s3, s55, s64
 buffer_load_dwordx4 v1, s[4:7], s3 offen sc1 lds
 s_waitcnt lgkmcnt(3)
 v_mfma_f32_32x32x16_bf16 v[64:79], a[4:7], v[36:39], v[64:79]
 ds_read_b128 v[52:55], v13 offset:0
 s_waitcnt lgkmcnt(3)
 v_mfma_f32_32x32x16_bf16 v[64:79], a[8:11], v[40:43], v[64:79]
 ds_read_b128 v[56:59], v14 offset:0
 s_waitcnt lgkmcnt(3)
 v_mfma_f32_32x32x16_bf16 v[64:79], a[12:15], v[44:47], v[64:79]
 ds_read_b128 v[60:63], v15 offset:0
 s_add_u32 m0, s56, 41984
 s_add_u32 s3, s55, s64
 buffer_load_dwordx4 v24, s[4:7], s3 offen sc1 lds
 s_waitcnt lgkmcnt(3)
 v_mfma_f32_32x32x16_bf16 v[64:79], a[16:19], v[48:51], v[64:79]
 ds_read_b128 v[32:35], v8 offset:8192
 s_waitcnt lgkmcnt(3)
 v_mfma_f32_32x32x16_bf16 v[64:79], a[20:23], v[52:55], v[64:79]
 ds_read_b128 v[36:39], v9 offset:8192
 s_waitcnt lgkmcnt(3)
 v_mfma_f32_32x32x16_bf16 v[64:79], a[24:27], v[56:59], v[64:79]
 ds_read_b128 v[40:43], v10 offset:8192
 s_add_u32 m0, s56, 49152
 s_add_u32 s3, s55, s65
 buffer_load_dwordx4 v1, s[4:7], s3 offen sc1 lds
 s_waitcnt lgkmcnt(3)
 v_mfma_f32_32x32x16_bf16 v[64:79], a[28:31], v[60:63], v[64:79]
 ds_read_b128 v[44:47], v11 offset:8192
 s_waitcnt lgkmcnt(3)
 v_mfma_f32_32x32x16_bf16 v[64:79], a[32:35], v[32:35], v[64:79]
 ds_read_b128 v[48:51], v12 offset:8192
 s_waitcnt lgkmcnt(3)
 v_mfma_f32_32x32x16_bf16 v[64:79], a[36:39], v[36:39], v[64:79]
 ds_read_b128 v[52:55], v13 offset:8192
 s_add_u32 m0, s56, 50176
 s_add_u32 s3, s55, s65
 buffer_load_dwordx4 v24, s[4:7], s3 offen sc1 lds
 s_waitcnt lgkmcnt(3)
 v_mfma_f32_32x32x16_bf16 v[64:79], a[40:43], v[40:43], v[64:79]
 ds_read_b128 v[56:59], v14 offset:8192
 s_waitcnt lgkmcnt(3)
 v_mfma_f32_32x32x16_bf16 v[64:79], a[44:47], v[44:47], v[64:79]
 ds_read_b128 v[60:63], v15 offset:8192
 s_waitcnt lgkmcnt(3)
 v_mfma_f32_32x32x16_bf16 v[64:79], a[48:51], v[48:51], v[64:79]
 ds_read_b128 v[32:35], v8 offset:16384
 s_add_u32 m0, s56, 57344
 s_add_u32 s3, s55, s66
 buffer_load_dwordx4 v1, s[4:7], s3 offen sc1 lds
 s_waitcnt lgkmcnt(3)
 v_mfma_f32_32x32x16_bf16 v[64:79], a[52:55], v[52:55], v[64:79]
 ds_read_b128 v[36:39], v9 offset:16384
 s_waitcnt lgkmcnt(3)
 v_mfma_f32_32x32x16_bf16 v[64:79], a[56:59], v[56:59], v[64:79]
 ds_read_b128 v[40:43], v10 offset:16384
 s_waitcnt lgkmcnt(3)
 v_mfma_f32_32x32x16_bf16 v[64:79], a[60:63], v[60:63], v[64:79]
 ds_read_b128 v[44:47], v11 offset:16384
 s_add_u32 m0, s56, 58368
 s_add_u32 s3, s55, s66
 buffer_load_dwordx4 v24, s[4:7], s3 offen sc1 lds
 s_waitcnt lgkmcnt(3)
 v_mfma_f32_32x32x16_bf16 v[64:79], a[64:67], v[32:35], v[64:79]
 ds_read_b128 v[48:51], v12 offset:16384
 s_waitcnt lgkmcnt(3)
 v_mfma_f32_32x32x16_bf16 v[64:79], a[68:71], v[36:39], v[64:79]
 ds_read_b128 v[52:55], v13 offset:16384
 s_waitcnt lgkmcnt(3)
 v_mfma_f32_32x32x16_bf16 v[64:79], a[72:75], v[40:43], v[64:79]
 ds_read_b128 v[56:59], v14 offset:16384
 s_add_u32 m0, s56, 65536
 s_add_u32 s3, s55, s67
 buffer_load_dwordx4 v1, s[4:7], s3 offen sc1 lds
 s_waitcnt lgkmcnt(3)
 v_mfma_f32_32x32x16_bf16 v[64:79], a[76:79], v[44:47], v[64:79]
 ds_read_b128 v[60:63], v15 offset:16384
 s_waitcnt vmcnt(7)
 s_cmp_eq_u32 s61, 0
 s_cbranch_scc1 L_pf_43
 s_lshl_b32 s3, s61, 2
 s_add_u32 s3, s3, s59
 s_sub_u32 s3, s3, 4
 v_mov_b32 v3, 1
 s_mov_b64 exec, 1
 buffer_atomic_add v3, v5, s[4:7], s3 offen
 s_mov_b64 exec, -1
 s_mov_b32 s61, 0
L_pf_43:
 s_waitcnt lgkmcnt(3)
 v_mfma_f32_32x32x16_bf16 v[64:79], a[80:83], v[48:51], v[64:79]
 ds_read_b128 v[32:35], v8 offset:24576
 s_waitcnt lgkmcnt(3)
 v_mfma_f32_32x32x16_bf16 v[64:79], a[84:87], v[52:55], v[64:79]
 ds_read_b128 v[36:39], v9 offset:24576
 s_add_u32 m0, s56, 66560
 s_add_u32 s3, s55, s67
 buffer_load_dwordx4 v24, s[4:7], s3 offen sc1 lds
 s_waitcnt lgkmcnt(3)
 v_mfma_f32_32x32x16_bf16 v[64:79], a[88:91], v[56:59], v[64:79]
 ds_read_b128 v[40:43], v10 offset:24576
 s_waitcnt lgkmcnt(3)
 v_mfma_f32_32x32x16_bf16 v[64:79], a[92:95], v[60:63], v[64:79]
 ds_read_b128 v[44:47], v11 offset:24576
 s_waitcnt lgkmcnt(3)
 v_mfma_f32_32x32x16_bf16 v[64:79], a[96:99], v[32:35], v[64:79]
 ds_read_b128 v[48:51], v12 offset:24576
 s_add_u32 m0, s56, 73728
 s_add_u32 s3, s55, s68
 buffer_load_dwordx4 v1, s[4:7], s3 offen sc1 lds
 s_waitcnt lgkmcnt(3)
 v_mfma_f32_32x32x16_bf16 v[64:79], a[100:103], v[36:39], v[64:79]
 ds_read_b128 v[52:55], v13 offset:24576
 s_waitcnt lgkmcnt(3)
 v_mfma_f32_32x32x16_bf16 v[64:79], a[104:107], v[40:43], v[64:79]
 ds_read_b128 v[56:59], v14 offset:24576
 s_waitcnt lgkmcnt(3)
 v_mfma_f32_32x32x16_bf16 v[64:79], a[108:111], v[44:47], v[64:79]
 ds_read_b128 v[60:63], v15 offset:24576
 s_add_u32 m0, s56, 74752
 s_add_u32 s3, s55, s68
 buffer_load_dwordx4 v24, s[4:7], s3 offen sc1 lds
 s_waitcnt lgkmcnt(3)
 v_mfma_f32_32x32x16_bf16 v[64:79], a[112:115], v[48:51], v[64:79]
 ds_read_b128 v[32:35], v8 offset:32768
 s_waitcnt lgkmcnt(3)
 v_mfma_f32_32x32x16_bf16 v[64:79], a[116:119], v[52:55], v[64:79]
 ds_read_b128 v[36:39], v9 offset:32768
 s_waitcnt lgkmcnt(3)
 v_mfma_f32_32x32x16_bf16 v[64:79], a[120:123], v[56:59], v[64:79]
 ds_read_b128 v[40:43], v10 offset:32768
 s_waitcnt lgkmcnt(3)
 v_mfma_f32_32x32x16_bf16 v[64:79], a[124:127], v[60:63], v[64:79]
 ds_read_b128 v[44:47], v11 offset:32768
 s_waitcnt lgkmcnt(3)
 v_mfma_f32_32x32x16_bf16 v[64:79], a[128:131], v[32:35], v[64:79]
 ds_read_b128 v[48:51], v12 offset:32768
 s_waitcnt lgkmcnt(3)
 v_mfma_f32_32x32x16_bf16 v[64:79], a[132:135], v[36:39], v[64:79]
 ds_read_b128 v[52:55], v13 offset:32768
 s_waitcnt lgkmcnt(3)
 v_mfma_f32_32x32x16_bf16 v[64:79], a[136:139], v[40:43], v[64:79]
 ds_read_b128 v[56:59], v14 offset:32768
 s_waitcnt lgkmcnt(3)
 v_mfma_f32_32x32x16_bf16 v[64:79], a[140:143], v[44:47], v[64:79]
 ds_read_b128 v[60:63], v15 offset:32768
 s_waitcnt lgkmcnt(3)
 v_mfma_f32_32x32x16_bf16 v[64:79], a[144:147], v[48:51], v[64:79]
 s_waitcnt lgkmcnt(2)
 v_mfma_f32_32x32x16_bf16 v[64:79], a[148:151], v[52:55], v[64:79]
 s_waitcnt lgkmcnt(1)
 v_mfma_f32_32x32x16_bf16 v[64:79], a[152:155], v[56:59], v[64:79]
 s_waitcnt lgkmcnt(0)
 v_mfma_f32_32x32x16_bf16 v[64:79], a[156:159], v[60:63], v[64:79]
 s_lshl_b32 s3, s60, 19
 s_add_u32 s3, s3, s58
 s_xor_b32 s3, s3, s82
 s_nop 8
 v_cvt_pk_bf16_f32 v80, v64, v65
 v_cvt_pk_bf16_f32 v81, v66, v67
 v_cvt_pk_bf16_f32 v82, v72, v73
 v_cvt_pk_bf16_f32 v83, v74, v75
 buffer_store_dwordx4 v[80:83], v4, s[4:7], s3 offen offset:0 sc1
 v_cvt_pk_bf16_f32 v84, v68, v69
 v_cvt_pk_bf16_f32 v85, v70, v71
 v_cvt_pk_bf16_f32 v86, v76, v77
 v_cvt_pk_bf16_f32 v87, v78, v79
 buffer_store_dwordx4 v[84:87], v4, s[4:7], s3 offen offset:512 sc1
 s_mov_b32 s61, s54
 s_cmp_lg_u32 s54, 1
 s_cbranch_scc1 L_f1_44
 s_waitcnt vmcnt(0)
 s_cmp_eq_u32 s61, 0
 s_cbranch_scc1 L_pf_45
 s_lshl_b32 s3, s61, 2
 s_add_u32 s3, s3, s59
 s_sub_u32 s3, s3, 4
 v_mov_b32 v3, 1
 s_mov_b64 exec, 1
 buffer_atomic_add v3, v5, s[4:7], s3 offen
 s_mov_b64 exec, -1
 s_mov_b32 s61, 0
L_pf_45:
 s_mov_b32 s8, s38
 s_and_b32 s9, s39, 0xffff
 s_mov_b32 s10, 2621440
 s_mov_b32 s11, 0x00020000
 s_mov_b32 s12, s40
 s_and_b32 s13, s41, 0xffff
 s_mov_b32 s14, 1280
 s_mov_b32 s15, 0x00020000
 v_lshlrev_b32 v130, 4, v0
 s_lshl_b32 s73, s70, 12
 s_add_u32 s74, s73, 2
 buffer_load_dwordx4 v[96:99], v130, s[8:11], s73 offen offset:0
 buffer_load_dwordx4 v[100:103], v130, s[8:11], s73 offen offset:1024
 buffer_load_dwordx4 v[112:115], v130, s[8:11], s74 offen offset:0
 buffer_load_dwordx4 v[116:119], v130, s[8:11], s74 offen offset:1024
 s_lshl_b32 s3, s70, 1
 buffer_load_ushort v128, off, s[12:15], s3
 s_branch L_f2_46
L_f1_44:
 s_waitcnt vmcnt(2)
L_f2_46:
 s_barrier
 s_mov_b32 s60, s54
 s_add_u32 s54, s54, 1
 s_mul_i32 s55, s54, 40960
 s_mul_i32 s3, s50, 10240
 s_add_u32 s55, s55, s3
 s_add_u32 s55, s55, 192937984
 ds_read_b128 v[32:35], v16 offset:0
 ds_read_b128 v[36:39], v17 offset:0
 ds_read_b128 v[40:43], v18 offset:0
 ds_read_b128 v[44:47], v19 offset:0
 s_waitcnt lgkmcnt(3)
 v_mfma_f32_32x32x16_bf16 v[64:79], a[0:3], v[32:35], 0
 ds_read_b128 v[48:51], v20 offset:0
 s_add_u32 m0, s56, 0
 s_add_u32 s3, s55, s64
 buffer_load_dwordx4 v1, s[4:7], s3 offen sc1 lds
 s_waitcnt lgkmcnt(3)
 v_mfma_f32_32x32x16_bf16 v[64:79], a[4:7], v[36:39], v[64:79]
 ds_read_b128 v[52:55], v21 offset:0
 s_waitcnt lgkmcnt(3)
 v_mfma_f32_32x32x16_bf16 v[64:79], a[8:11], v[40:43], v[64:79]
 ds_read_b128 v[56:59], v22 offset:0
 s_waitcnt lgkmcnt(3)
 v_mfma_f32_32x32x16_bf16 v[64:79], a[12:15], v[44:47], v[64:79]
 ds_read_b128 v[60:63], v23 offset:0
 s_add_u32 m0, s56, 1024
 s_add_u32 s3, s55, s64
 buffer_load_dwordx4 v24, s[4:7], s3 offen sc1 lds
 s_waitcnt lgkmcnt(3)
 v_mfma_f32_32x32x16_bf16 v[64:79], a[16:19], v[48:51], v[64:79]
 ds_read_b128 v[32:35], v16 offset:8192
 s_waitcnt lgkmcnt(3)
 v_mfma_f32_32x32x16_bf16 v[64:79], a[20:23], v[52:55], v[64:79]
 ds_read_b128 v[36:39], v17 offset:8192
 s_waitcnt lgkmcnt(3)
 v_mfma_f32_32x32x16_bf16 v[64:79], a[24:27], v[56:59], v[64:79]
 ds_read_b128 v[40:43], v18 offset:8192
 s_add_u32 m0, s56, 8192
 s_add_u32 s3, s55, s65
 buffer_load_dwordx4 v1, s[4:7], s3 offen sc1 lds
 s_waitcnt lgkmcnt(3)
 v_mfma_f32_32x32x16_bf16 v[64:79], a[28:31], v[60:63], v[64:79]
 ds_read_b128 v[44:47], v19 offset:8192
 s_waitcnt lgkmcnt(3)
 v_mfma_f32_32x32x16_bf16 v[64:79], a[32:35], v[32:35], v[64:79]
 ds_read_b128 v[48:51], v20 offset:8192
 s_waitcnt lgkmcnt(3)
 v_mfma_f32_32x32x16_bf16 v[64:79], a[36:39], v[36:39], v[64:79]
 ds_read_b128 v[52:55], v21 offset:8192
 s_add_u32 m0, s56, 9216
 s_add_u32 s3, s55, s65
 buffer_load_dwordx4 v24, s[4:7], s3 offen sc1 lds
 s_waitcnt lgkmcnt(3)
 v_mfma_f32_32x32x16_bf16 v[64:79], a[40:43], v[40:43], v[64:79]
 ds_read_b128 v[56:59], v22 offset:8192
 s_waitcnt lgkmcnt(3)
 v_mfma_f32_32x32x16_bf16 v[64:79], a[44:47], v[44:47], v[64:79]
 ds_read_b128 v[60:63], v23 offset:8192
 s_waitcnt lgkmcnt(3)
 v_mfma_f32_32x32x16_bf16 v[64:79], a[48:51], v[48:51], v[64:79]
 ds_read_b128 v[32:35], v16 offset:16384
 s_add_u32 m0, s56, 16384
 s_add_u32 s3, s55, s66
 buffer_load_dwordx4 v1, s[4:7], s3 offen sc1 lds
 s_waitcnt lgkmcnt(3)
 v_mfma_f32_32x32x16_bf16 v[64:79], a[52:55], v[52:55], v[64:79]
 ds_read_b128 v[36:39], v17 offset:16384
 s_waitcnt lgkmcnt(3)
 v_mfma_f32_32x32x16_bf16 v[64:79], a[56:59], v[56:59], v[64:79]
 ds_read_b128 v[40:43], v18 offset:16384
 s_waitcnt lgkmcnt(3)
 v_mfma_f32_32x32x16_bf16 v[64:79], a[60:63], v[60:63], v[64:79]
 ds_read_b128 v[44:47], v19 offset:16384
 s_add_u32 m0, s56, 17408
 s_add_u32 s3, s55, s66
 buffer_load_dwordx4 v24, s[4:7], s3 offen sc1 lds
 s_waitcnt lgkmcnt(3)
 v_mfma_f32_32x32x16_bf16 v[64:79], a[64:67], v[32:35], v[64:79]
 ds_read_b128 v[48:51], v20 offset:16384
 s_waitcnt lgkmcnt(3)
 v_mfma_f32_32x32x16_bf16 v[64:79], a[68:71], v[36:39], v[64:79]
 ds_read_b128 v[52:55], v21 offset:16384
 s_waitcnt lgkmcnt(3)
 v_mfma_f32_32x32x16_bf16 v[64:79], a[72:75], v[40:43], v[64:79]
 ds_read_b128 v[56:59], v22 offset:16384
 s_add_u32 m0, s56, 24576
 s_add_u32 s3, s55, s67
 buffer_load_dwordx4 v1, s[4:7], s3 offen sc1 lds
 s_waitcnt lgkmcnt(3)
 v_mfma_f32_32x32x16_bf16 v[64:79], a[76:79], v[44:47], v[64:79]
 ds_read_b128 v[60:63], v23 offset:16384
 s_waitcnt vmcnt(7)
 s_cmp_eq_u32 s61, 0
 s_cbranch_scc1 L_pf_47
 s_lshl_b32 s3, s61, 2
 s_add_u32 s3, s3, s59
 s_sub_u32 s3, s3, 4
 v_mov_b32 v3, 1
 s_mov_b64 exec, 1
 buffer_atomic_add v3, v5, s[4:7], s3 offen
 s_mov_b64 exec, -1
 s_mov_b32 s61, 0
L_pf_47:
 s_waitcnt lgkmcnt(3)
 v_mfma_f32_32x32x16_bf16 v[64:79], a[80:83], v[48:51], v[64:79]
 ds_read_b128 v[32:35], v16 offset:24576
 s_waitcnt lgkmcnt(3)
 v_mfma_f32_32x32x16_bf16 v[64:79], a[84:87], v[52:55], v[64:79]
 ds_read_b128 v[36:39], v17 offset:24576
 s_add_u32 m0, s56, 25600
 s_add_u32 s3, s55, s67
 buffer_load_dwordx4 v24, s[4:7], s3 offen sc1 lds
 s_waitcnt lgkmcnt(3)
 v_mfma_f32_32x32x16_bf16 v[64:79], a[88:91], v[56:59], v[64:79]
 ds_read_b128 v[40:43], v18 offset:24576
 s_waitcnt lgkmcnt(3)
 v_mfma_f32_32x32x16_bf16 v[64:79], a[92:95], v[60:63], v[64:79]
 ds_read_b128 v[44:47], v19 offset:24576
 s_waitcnt lgkmcnt(3)
 v_mfma_f32_32x32x16_bf16 v[64:79], a[96:99], v[32:35], v[64:79]
 ds_read_b128 v[48:51], v20 offset:24576
 s_add_u32 m0, s56, 32768
 s_add_u32 s3, s55, s68
 buffer_load_dwordx4 v1, s[4:7], s3 offen sc1 lds
 s_waitcnt lgkmcnt(3)
 v_mfma_f32_32x32x16_bf16 v[64:79], a[100:103], v[36:39], v[64:79]
 ds_read_b128 v[52:55], v21 offset:24576
 s_waitcnt lgkmcnt(3)
 v_mfma_f32_32x32x16_bf16 v[64:79], a[104:107], v[40:43], v[64:79]
 ds_read_b128 v[56:59], v22 offset:24576
 s_waitcnt lgkmcnt(3)
 v_mfma_f32_32x32x16_bf16 v[64:79], a[108:111], v[44:47], v[64:79]
 ds_read_b128 v[60:63], v23 offset:24576
 s_add_u32 m0, s56, 33792
 s_add_u32 s3, s55, s68
 buffer_load_dwordx4 v24, s[4:7], s3 offen sc1 lds
 s_waitcnt lgkmcnt(3)
 v_mfma_f32_32x32x16_bf16 v[64:79], a[112:115], v[48:51], v[64:79]
 ds_read_b128 v[32:35], v16 offset:32768
 s_waitcnt lgkmcnt(3)
 v_mfma_f32_32x32x16_bf16 v[64:79], a[116:119], v[52:55], v[64:79]
 ds_read_b128 v[36:39], v17 offset:32768
 s_waitcnt lgkmcnt(3)
 v_mfma_f32_32x32x16_bf16 v[64:79], a[120:123], v[56:59], v[64:79]
 ds_read_b128 v[40:43], v18 offset:32768
 s_waitcnt lgkmcnt(3)
 v_mfma_f32_32x32x16_bf16 v[64:79], a[124:127], v[60:63], v[64:79]
 ds_read_b128 v[44:47], v19 offset:32768
 s_waitcnt lgkmcnt(3)
 v_mfma_f32_32x32x16_bf16 v[64:79], a[128:131], v[32:35], v[64:79]
 ds_read_b128 v[48:51], v20 offset:32768
 s_waitcnt lgkmcnt(3)
 v_mfma_f32_32x32x16_bf16 v[64:79], a[132:135], v[36:39], v[64:79]
 ds_read_b128 v[52:55], v21 offset:32768
 s_waitcnt lgkmcnt(3)
 v_mfma_f32_32x32x16_bf16 v[64:79], a[136:139], v[40:43], v[64:79]
 ds_read_b128 v[56:59], v22 offset:32768
 s_waitcnt lgkmcnt(3)
 v_mfma_f32_32x32x16_bf16 v[64:79], a[140:143], v[44:47], v[64:79]
 ds_read_b128 v[60:63], v23 offset:32768
 s_waitcnt lgkmcnt(3)
 v_mfma_f32_32x32x16_bf16 v[64:79], a[144:147], v[48:51], v[64:79]
 s_waitcnt lgkmcnt(2)
 v_mfma_f32_32x32x16_bf16 v[64:79], a[148:151], v[52:55], v[64:79]
 s_waitcnt lgkmcnt(1)
 v_mfma_f32_32x32x16_bf16 v[64:79], a[152:155], v[56:59], v[64:79]
 s_waitcnt lgkmcnt(0)
 v_mfma_f32_32x32x16_bf16 v[64:79], a[156:159], v[60:63], v[64:79]
 s_lshl_b32 s3, s60, 19
 s_add_u32 s3, s3, s58
 s_xor_b32 s3, s3, s82
 s_nop 8
 v_cvt_pk_bf16_f32 v88, v64, v65
 v_cvt_pk_bf16_f32 v89, v66, v67
 v_cvt_pk_bf16_f32 v90, v72, v73
 v_cvt_pk_bf16_f32 v91, v74, v75
 buffer_store_dwordx4 v[88:91], v4, s[4:7], s3 offen offset:0 sc1
 v_cvt_pk_bf16_f32 v92, v68, v69
 v_cvt_pk_bf16_f32 v93, v70, v71
 v_cvt_pk_bf16_f32 v94, v76, v77
 v_cvt_pk_bf16_f32 v95, v78, v79
 buffer_store_dwordx4 v[92:95], v4, s[4:7], s3 offen offset:512 sc1
 s_mov_b32 s61, s54
 s_waitcnt vmcnt(2)
 s_cmp_lg_u32 s54, 4
 s_cbranch_scc1 L_cv_48
 s_waitcnt vmcnt(0)
 s_cmp_eq_u32 s61, 0
 s_cbranch_scc1 L_pf_49
 s_lshl_b32 s3, s61, 2
 s_add_u32 s3, s3, s59
 s_sub_u32 s3, s3, 4
 v_mov_b32 v3, 1
 s_mov_b64 exec, 1
 buffer_atomic_add v3, v5, s[4:7], s3 offen
 s_mov_b64 exec, -1
 s_mov_b32 s61, 0
L_pf_49:
 s_mul_i32 s71, s50, 13312
 s_add_u32 s71, s71, 81920
 s_mov_b32 s70, s75
 s_mov_b32 s69, 640
 s_getpc_b64 s[76:77]
L_ca_50:
 s_add_u32 s76, s76, L_conv0-L_ca_50
 s_addc_u32 s77, s77, -1
 s_swappc_b64 s[76:77], s[76:77]
 s_waitcnt vmcnt(0)
 s_barrier
 s_cmp_lg_u32 s50, 3
 s_cbranch_scc1 L_ar_51
 s_mov_b32 s96, s44
 s_and_b32 s97, s45, 0xffff
 s_mov_b32 s98, 256
 s_mov_b32 s99, 0x00020000
 v_mov_b32 v1, 1
 s_mov_b64 exec, 1
 buffer_atomic_add v1, off, s[96:99], 0 offset:8 sc0
 s_waitcnt vmcnt(0)
 v_cmp_eq_u32 vcc, 159, v1
 s_cbranch_vccz L_aw_52
 buffer_store_dword v1, off, s[96:99], 0 offset:136 sc1
L_aw_52:
 s_mov_b64 exec, -1
L_ar_51:
 s_cmp_lg_u32 s50, 0
 s_cbranch_scc1 L_ww_53
 s_mov_b32 s96, s44
 s_and_b32 s97, s45, 0xffff
 s_mov_b32 s98, 256
 s_mov_b32 s99, 0x00020000
 v_mov_b32 v24, 208
 s_mov_b32 s51, 0
 s_mov_b64 exec, 1
L_wb_54:
 buffer_load_dword v25, v24, s[96:99], 0 offen sc1
 s_waitcnt vmcnt(0)
 v_cmp_eq_u32 vcc, 0, v25
 s_cbranch_vccz L_wbd_55
 s_sleep 2
 s_add_u32 s51, s51, 1
 s_cmp_lt_u32 s51, 131072
 s_cbranch_scc1 L_wb_54
 s_branch L_bail
L_wbd_55:
 s_mov_b64 exec, -1
L_ww_53:
 s_barrier
 s_mov_b32 s70, s75
 s_mov_b32 s8, s38
 s_and_b32 s9, s39, 0xffff
 s_mov_b32 s10, 2621440
 s_mov_b32 s11, 0x00020000
 s_mov_b32 s12, s40
 s_and_b32 s13, s41, 0xffff
 s_mov_b32 s14, 1280
 s_mov_b32 s15, 0x00020000
 v_lshlrev_b32 v130, 4, v0
 s_lshl_b32 s73, s70, 12
 s_add_u32 s74, s73, 2
 buffer_load_dwordx4 v[96:99], v130, s[8:11], s73 offen offset:0
 buffer_load_dwordx4 v[100:103], v130, s[8:11], s73 offen offset:1024
 buffer_load_dwordx4 v[104:107], v130, s[8:11], s73 offen offset:2048
 buffer_load_dwordx4 v[108:111], v130, s[8:11], s73 offen offset:3072
 buffer_load_dwordx4 v[112:115], v130, s[8:11], s74 offen offset:0
 buffer_load_dwordx4 v[116:119], v130, s[8:11], s74 offen offset:1024
 buffer_load_dwordx4 v[120:123], v130, s[8:11], s74 offen offset:2048
 buffer_load_dwordx4 v[124:127], v130, s[8:11], s74 offen offset:3072
 s_lshl_b32 s3, s70, 1
 buffer_load_ushort v128, off, s[12:15], s3
 s_lshl_b32 s3, s70, 12
 s_add_u32 s3, s3, 198180864
 buffer_load_dwordx4 v[240:243], v130, s[4:7], s3 offen offset:0 sc1
 buffer_load_dwordx4 v[244:247], v130, s[4:7], s3 offen offset:1024 sc1
 buffer_load_dwordx4 v[248:251], v130, s[4:7], s3 offen offset:2048 sc1
 buffer_load_dwordx4 v[252:255], v130, s[4:7], s3 offen offset:3072 sc1
 v_lshrrev_b32 v1, 4, v0
 s_mov_b32 s3, 1280
 v_mul_lo_u32 v1, v1, s3
 v_and_b32 v3, 15, v0
 v_lshl_add_u32 v1, v3, 4, v1
 v_add_u32 v6, 5120, v1
 v_mov_b32 v24, v6
 v_and_b32 v2, 31, v0
 v_lshlrev_b32 v2, 8, v2
 v_lshrrev_b32 v4, 5, v0
 v_xor_b32 v4, v4, v3
 v_xor_b32 v8, 0, v4
 v_lshl_add_u32 v8, v8, 4, v2
 v_add_u32 v16, 40960, v8
 v_xor_b32 v9, 2, v4
 v_lshl_add_u32 v9, v9, 4, v2
 v_add_u32 v17, 40960, v9
 v_xor_b32 v10, 4, v4
 v_lshl_add_u32 v10, v10, 4, v2
 v_add_u32 v18, 40960, v10
 v_xor_b32 v11, 6, v4
 v_lshl_add_u32 v11, v11, 4, v2
 v_add_u32 v19, 40960, v11
 v_xor_b32 v12, 8, v4
 v_lshl_add_u32 v12, v12, 4, v2
 v_add_u32 v20, 40960, v12
 v_xor_b32 v13, 10, v4
 v_lshl_add_u32 v13, v13, 4, v2
 v_add_u32 v21, 40960, v13
 v_xor_b32 v14, 12, v4
 v_lshl_add_u32 v14, v14, 4, v2
 v_add_u32 v22, 40960, v14
 v_xor_b32 v15, 14, v4
 v_lshl_add_u32 v15, v15, 4, v2
 v_add_u32 v23, 40960, v15
 v_lshrrev_b32 v4, 5, v0
 v_lshlrev_b32 v4, 8, v4
 v_lshl_add_u32 v4, v3, 4, v4
 v_and_b32 v2, 16, v0
 v_lshl_add_u32 v4, v2, 8, v4
 s_lshl_b32 s3, s50, 10
 v_add_u32 v4, s3, v4
 v_mul_u32_u24 v5, 49152, v0
 v_mov_b32 v7, 163776
L_cv_48:
 s_cmp_lt_u32 s54, 10
 s_cbranch_scc1 L_qkvq_pre
 s_waitcnt vmcnt(0)
 s_cmp_eq_u32 s61, 0
 s_cbranch_scc1 L_pf_56
 s_lshl_b32 s3, s61, 2
 s_add_u32 s3, s3, s59
 s_sub_u32 s3, s3, 4
 v_mov_b32 v3, 1
 s_mov_b64 exec, 1
 buffer_atomic_add v3, v5, s[4:7], s3 offen
 s_mov_b64 exec, -1
 s_mov_b32 s61, 0
L_pf_56:
 s_mul_i32 s71, s50, 13312
 s_add_u32 s71, s71, 81920
 s_mov_b32 s70, s75
 s_mov_b32 s69, 640
 s_getpc_b64 s[76:77]
L_ca_57:
 s_add_u32 s76, s76, L_conv1-L_ca_57
 s_addc_u32 s77, s77, -1
 s_swappc_b64 s[76:77], s[76:77]
 s_waitcnt vmcnt(0)
 s_barrier
 s_cmp_lg_u32 s50, 3
 s_cbranch_scc1 L_ar_58
 s_mov_b32 s96, s44
 s_and_b32 s97, s45, 0xffff
 s_mov_b32 s98, 256
 s_mov_b32 s99, 0x00020000
 v_mov_b32 v1, 1
 s_mov_b64 exec, 1
 buffer_atomic_add v1, off, s[96:99], 0 offset:76 sc0
 s_waitcnt vmcnt(0)
 v_cmp_eq_u32 vcc, 127, v1
 s_cbranch_vccz L_aw_59
 buffer_store_dword v1, off, s[96:99], 0 offset:204 sc1
L_aw_59:
 s_mov_b64 exec, -1
L_ar_58:
 v_lshrrev_b32 v1, 4, v0
 s_mov_b32 s3, 1280
 v_mul_lo_u32 v1, v1, s3
 v_and_b32 v3, 15, v0
 v_lshl_add_u32 v1, v3, 4, v1
 v_add_u32 v6, 5120, v1
 v_mov_b32 v24, v6
 v_and_b32 v2, 31, v0
 v_lshlrev_b32 v2, 8, v2
 v_lshrrev_b32 v4, 5, v0
 v_xor_b32 v4, v4, v3
 v_xor_b32 v8, 0, v4
 v_lshl_add_u32 v8, v8, 4, v2
 v_add_u32 v16, 40960, v8
 v_xor_b32 v9, 2, v4
 v_lshl_add_u32 v9, v9, 4, v2
 v_add_u32 v17, 40960, v9
 v_xor_b32 v10, 4, v4
 v_lshl_add_u32 v10, v10, 4, v2
 v_add_u32 v18, 40960, v10
 v_xor_b32 v11, 6, v4
 v_lshl_add_u32 v11, v11, 4, v2
 v_add_u32 v19, 40960, v11
 v_xor_b32 v12, 8, v4
 v_lshl_add_u32 v12, v12, 4, v2
 v_add_u32 v20, 40960, v12
 v_xor_b32 v13, 10, v4
 v_lshl_add_u32 v13, v13, 4, v2
 v_add_u32 v21, 40960, v13
 v_xor_b32 v14, 12, v4
 v_lshl_add_u32 v14, v14, 4, v2
 v_add_u32 v22, 40960, v14
 v_xor_b32 v15, 14, v4
 v_lshl_add_u32 v15, v15, 4, v2
 v_add_u32 v23, 40960, v15
 v_lshrrev_b32 v4, 5, v0
 v_lshlrev_b32 v4, 8, v4
 v_lshl_add_u32 v4, v3, 4, v4
 v_and_b32 v2, 16, v0
 v_lshl_add_u32 v4, v2, 8, v4
 s_lshl_b32 s3, s50, 10
 v_add_u32 v4, s3, v4
 v_mul_u32_u24 v5, 49152, v0
 v_mov_b32 v7, 163776
 s_cmp_lg_u32 s50, 0
 s_cbranch_scc1 L_ww_60
 s_mov_b32 s96, s44
 s_and_b32 s97, s45, 0xffff
 s_mov_b32 s98, 256
 s_mov_b32 s99, 0x00020000
 v_mov_b32 v25, 200
 s_mov_b32 s51, 0
 s_mov_b64 exec, 1
L_wb_61:
 buffer_load_dword v26, v25, s[96:99], 0 offen sc1
 s_waitcnt vmcnt(0)
 v_cmp_eq_u32 vcc, 0, v26
 s_cbranch_vccz L_wbd_62
 s_sleep 2
 s_add_u32 s51, s51, 1
 s_cmp_lt_u32 s51, 131072
 s_cbranch_scc1 L_wb_61
 s_branch L_bail
L_wbd_62:
 s_mov_b64 exec, -1
L_ww_60:
 s_barrier
 s_mov_b32 s96, s44
 s_and_b32 s97, s45, 0xffff
 s_mov_b32 s98, 256
 s_mov_b32 s99, 0x00020000
 v_mov_b32 v25, 132
 s_mov_b32 s3, 144
 v_writelane_b32 v25, s3, 1
 s_mov_b32 s51, 0
 s_mov_b64 exec, 3
L_wb_63:
 buffer_load_dword v26, v25, s[96:99], 0 offen sc1
 s_waitcnt vmcnt(0)
 v_cmp_eq_u32 vcc, 0, v26
 s_cbranch_vccz L_wbd_64
 s_sleep 2
 s_add_u32 s51, s51, 1
 s_cmp_lt_u32 s51, 131072
 s_cbranch_scc1 L_wb_63
 s_branch L_bail
L_wbd_64:
 s_mov_b64 exec, -1
 v_readlane_b32 s81, v26, 1
 s_nop 3
 s_sub_u32 s81, s81, 1
 s_xor_b32 s78, s81, 0
 s_lshl_b32 s78, s78, 13
 s_xor_b32 s79, s78, 8192
 s_cmp_lt_u32 s62, 96
 s_cselect_b32 s3, s79, s78
 s_lshl_b32 s62, s62, 8
 s_lshr_b32 s100, s62, 13
 s_lshl_b32 s100, s100, 13
 s_add_u32 s62, s62, s100
 s_add_u32 s62, s62, s3
 s_add_u32 s62, s62, 229376
 s_add_u32 s63, s59, s78
 s_add_u32 s63, s63, 16344
 s_mov_b32 s72, 0
L_qkvq_block:
 s_lshl_b32 s55, s54, 2
 s_add_u32 s55, s55, s62
 s_sub_u32 s55, s55, 40
 s_cmp_lg_u32 s50, 0
 s_cselect_b32 s3, 268435456, s55
 v_mov_b32 v6, 8
 s_mov_b64 exec, 15
 v_mov_b32 v6, 0
 buffer_atomic_add v6, v5, s[4:7], s3 offen sc0
 s_mov_b64 exec, -1
 s_waitcnt vmcnt(0)
 s_cmp_eq_u32 s61, 0
 s_cbranch_scc1 L_pf_67
 s_lshl_b32 s3, s61, 2
 s_add_u32 s3, s3, s59
 s_sub_u32 s3, s3, 4
 v_mov_b32 v3, 1
 s_mov_b64 exec, 1
 buffer_atomic_add v3, v5, s[4:7], s3 offen
 s_mov_b64 exec, -1
 s_mov_b32 s61, 0
L_pf_67:
 s_cmp_lg_u32 s50, 0
 s_cbranch_scc1 L_w_65
 v_cmp_gt_u32 vcc, 8, v6
 s_cbranch_vccz L_w_65
 s_mov_b32 s51, 0
 s_mov_b64 exec, 15
 v_mov_b32 v28, 0
 buffer_atomic_add v28, v5, s[4:7], s55 offen sc0
 s_sleep 5
L_wc_68:
 v_mov_b32 v29, 0
 buffer_atomic_add v29, v5, s[4:7], s55 offen sc0
 s_waitcnt vmcnt(1)
 v_cmp_gt_u32 vcc, 8, v28
 s_cbranch_vccz L_wcd_69
 v_mov_b32 v28, 0
 buffer_atomic_add v28, v5, s[4:7], s55 offen sc0
 s_waitcnt vmcnt(1)
 v_cmp_gt_u32 vcc, 8, v29
 s_cbranch_vccz L_wcd_69
 s_add_u32 s51, s51, 1
 s_cmp_lt_u32 s51, 131072
 s_cbranch_scc1 L_wc_68
 s_branch L_bail
L_wcd_69:
 s_mov_b64 exec, -1
L_w_65:
 s_barrier
L_qkvq_loop:
 s_cmp_lg_u32 s54, 17
 s_cbranch_scc1 L_c2_70
 s_cmp_lg_u32 s50, 0
 s_cbranch_scc1 L_ww_71
 s_mov_b32 s96, s44
 s_and_b32 s97, s45, 0xffff
 s_mov_b32 s98, 256
 s_mov_b32 s99, 0x00020000
 v_mov_b32 v25, 140
 s_mov_b32 s51, 0
 s_mov_b64 exec, 1
L_wb_72:
 buffer_load_dword v26, v25, s[96:99], 0 offen sc1
 s_waitcnt vmcnt(0)
 v_cmp_eq_u32 vcc, 0, v26
 s_cbranch_vccz L_wbd_73
 s_sleep 2
 s_add_u32 s51, s51, 1
 s_cmp_lt_u32 s51, 131072
 s_cbranch_scc1 L_wb_72
 s_branch L_bail
L_wbd_73:
 s_mov_b64 exec, -1
L_ww_71:
 s_barrier
L_c2_70:
 s_sub_u32 s60, s54, 10
 s_cmp_lg_u32 s72, 0
 s_cbranch_scc1 L_hv_74
 s_mul_i32 s55, s60, 40960
 s_mul_i32 s3, s50, 10240
 s_add_u32 s55, s55, s3
 s_add_u32 s55, s55, 195559424
 s_add_u32 m0, s56, 40960
 s_add_u32 s3, s55, s64
 buffer_load_dwordx4 v1, s[4:7], s3 offen sc1 lds
 s_add_u32 m0, s56, 41984
 s_add_u32 s3, s55, s64
 buffer_load_dwordx4 v24, s[4:7], s3 offen sc1 lds
 s_add_u32 m0, s56, 49152
 s_add_u32 s3, s55, s65
 buffer_load_dwordx4 v1, s[4:7], s3 offen sc1 lds
 s_add_u32 m0, s56, 50176
 s_add_u32 s3, s55, s65
 buffer_load_dwordx4 v24, s[4:7], s3 offen sc1 lds
 s_add_u32 m0, s56, 57344
 s_add_u32 s3, s55, s66
 buffer_load_dwordx4 v1, s[4:7], s3 offen sc1 lds
 s_add_u32 m0, s56, 58368
 s_add_u32 s3, s55, s66
 buffer_load_dwordx4 v24, s[4:7], s3 offen sc1 lds
 s_add_u32 m0, s56, 65536
 s_add_u32 s3, s55, s67
 buffer_load_dwordx4 v1, s[4:7], s3 offen sc1 lds
 s_add_u32 m0, s56, 66560
 s_add_u32 s3, s55, s67
 buffer_load_dwordx4 v24, s[4:7], s3 offen sc1 lds
 s_add_u32 m0, s56, 73728
 s_add_u32 s3, s55, s68
 buffer_load_dwordx4 v1, s[4:7], s3 offen sc1 lds
 s_add_u32 m0, s56, 74752
 s_add_u32 s3, s55, s68
 buffer_load_dwordx4 v24, s[4:7], s3 offen sc1 lds
L_hv_74:
 s_mov_b32 s72, 0
 s_min_u32 s51, s54, 63
 s_mul_i32 s55, s51, 40960
 s_mul_i32 s3, s50, 10240
 s_add_u32 s55, s55, s3
 s_add_u32 s55, s55, 192937984
 s_waitcnt vmcnt(8)
 s_barrier
 ds_read_b128 v[32:35], v16 offset:0
 ds_read_b128 v[36:39], v17 offset:0
 ds_read_b128 v[40:43], v18 offset:0
 ds_read_b128 v[44:47], v19 offset:0
 s_waitcnt lgkmcnt(3)
 v_mfma_f32_32x32x16_bf16 v[64:79], a[0:3], v[32:35], 0
 ds_read_b128 v[48:51], v20 offset:0
 s_add_u32 m0, s56, 0
 s_add_u32 s3, s55, s64
 buffer_load_dwordx4 v1, s[4:7], s3 offen sc1 lds
 s_waitcnt lgkmcnt(3)
 v_mfma_f32_32x32x16_bf16 v[64:79], a[4:7], v[36:39], v[64:79]
 ds_read_b128 v[52:55], v21 offset:0
 s_waitcnt lgkmcnt(3)
 v_mfma_f32_32x32x16_bf16 v[64:79], a[8:11], v[40:43], v[64:79]
 ds_read_b128 v[56:59], v22 offset:0
 s_waitcnt lgkmcnt(3)
 v_mfma_f32_32x32x16_bf16 v[64:79], a[12:15], v[44:47], v[64:79]
 ds_read_b128 v[60:63], v23 offset:0
 s_add_u32 m0, s56, 1024
 s_add_u32 s3, s55, s64
 buffer_load_dwordx4 v24, s[4:7], s3 offen sc1 lds
 s_waitcnt lgkmcnt(3)
 v_mfma_f32_32x32x16_bf16 v[64:79], a[16:19], v[48:51], v[64:79]
 s_waitcnt vmcnt(8)
 s_barrier
 ds_read_b128 v[32:35], v16 offset:8192
 s_waitcnt lgkmcnt(3)
 v_mfma_f32_32x32x16_bf16 v[64:79], a[20:23], v[52:55], v[64:79]
 ds_read_b128 v[36:39], v17 offset:8192
 s_waitcnt lgkmcnt(3)
 v_mfma_f32_32x32x16_bf16 v[64:79], a[24:27], v[56:59], v[64:79]
 ds_read_b128 v[40:43], v18 offset:8192
 s_add_u32 m0, s56, 8192
 s_add_u32 s3, s55, s65
 buffer_load_dwordx4 v1, s[4:7], s3 offen sc1 lds
 s_waitcnt lgkmcnt(3)
 v_mfma_f32_32x32x16_bf16 v[64:79], a[28:31], v[60:63], v[64:79]
 ds_read_b128 v[44:47], v19 offset:8192
 s_waitcnt lgkmcnt(3)
 v_mfma_f32_32x32x16_bf16 v[64:79], a[32:35], v[32:35], v[64:79]
 ds_read_b128 v[48:51], v20 offset:8192
 s_waitcnt lgkmcnt(3)
 v_mfma_f32_32x32x16_bf16 v[64:79], a[36:39], v[36:39], v[64:79]
 ds_read_b128 v[52:55], v21 offset:8192
 s_add_u32 m0, s56, 9216
 s_add_u32 s3, s55, s65
 buffer_load_dwordx4 v24, s[4:7], s3 offen sc1 lds
 s_waitcnt lgkmcnt(3)
 v_mfma_f32_32x32x16_bf16 v[64:79], a[40:43], v[40:43], v[64:79]
 ds_read_b128 v[56:59], v22 offset:8192
 s_waitcnt lgkmcnt(3)
 v_mfma_f32_32x32x16_bf16 v[64:79], a[44:47], v[44:47], v[64:79]
 ds_read_b128 v[60:63], v23 offset:8192
 s_waitcnt lgkmcnt(3)
 v_mfma_f32_32x32x16_bf16 v[64:79], a[48:51], v[48:51], v[64:79]
 s_waitcnt vmcnt(8)
 s_barrier
 ds_read_b128 v[32:35], v16 offset:16384
 s_add_u32 m0, s56, 16384
 s_add_u32 s3, s55, s66
 buffer_load_dwordx4 v1, s[4:7], s3 offen sc1 lds
 s_waitcnt lgkmcnt(3)
 v_mfma_f32_32x32x16_bf16 v[64:79], a[52:55], v[52:55], v[64:79]
 ds_read_b128 v[36:39], v17 offset:16384
 s_waitcnt lgkmcnt(3)
 v_mfma_f32_32x32x16_bf16 v[64:79], a[56:59], v[56:59], v[64:79]
 ds_read_b128 v[40:43], v18 offset:16384
 s_waitcnt lgkmcnt(3)
 v_mfma_f32_32x32x16_bf16 v[64:79], a[60:63], v[60:63], v[64:79]
 ds_read_b128 v[44:47], v19 offset:16384
 s_add_u32 m0, s56, 17408
 s_add_u32 s3, s55, s66
 buffer_load_dwordx4 v24, s[4:7], s3 offen sc1 lds
 s_waitcnt lgkmcnt(3)
 v_mfma_f32_32x32x16_bf16 v[64:79], a[64:67], v[32:35], v[64:79]
 ds_read_b128 v[48:51], v20 offset:16384
 s_waitcnt lgkmcnt(3)
 v_mfma_f32_32x32x16_bf16 v[64:79], a[68:71], v[36:39], v[64:79]
 ds_read_b128 v[52:55], v21 offset:16384
 s_waitcnt lgkmcnt(3)
 v_mfma_f32_32x32x16_bf16 v[64:79], a[72:75], v[40:43], v[64:79]
 ds_read_b128 v[56:59], v22 offset:16384
 s_add_u32 m0, s56, 24576
 s_add_u32 s3, s55, s67
 buffer_load_dwordx4 v1, s[4:7], s3 offen sc1 lds
 s_waitcnt lgkmcnt(3)
 v_mfma_f32_32x32x16_bf16 v[64:79], a[76:79], v[44:47], v[64:79]
 ds_read_b128 v[60:63], v23 offset:16384
 s_waitcnt lgkmcnt(3)
 v_mfma_f32_32x32x16_bf16 v[64:79], a[80:83], v[48:51], v[64:79]
 s_waitcnt vmcnt(9)
 s_barrier
 ds_read_b128 v[32:35], v16 offset:24576
 s_waitcnt lgkmcnt(3)
 v_mfma_f32_32x32x16_bf16 v[64:79], a[84:87], v[52:55], v[64:79]
 ds_read_b128 v[36:39], v17 offset:24576
 s_add_u32 m0, s56, 25600
 s_add_u32 s3, s55, s67
 buffer_load_dwordx4 v24, s[4:7], s3 offen sc1 lds
 s_waitcnt lgkmcnt(3)
 v_mfma_f32_32x32x16_bf16 v[64:79], a[88:91], v[56:59], v[64:79]
 ds_read_b128 v[40:43], v18 offset:24576
 s_waitcnt lgkmcnt(3)
 v_mfma_f32_32x32x16_bf16 v[64:79], a[92:95], v[60:63], v[64:79]
 ds_read_b128 v[44:47], v19 offset:24576
 s_waitcnt lgkmcnt(3)
 v_mfma_f32_32x32x16_bf16 v[64:79], a[96:99], v[32:35], v[64:79]
 ds_read_b128 v[48:51], v20 offset:24576
 s_add_u32 m0, s56, 32768
 s_add_u32 s3, s55, s68
 buffer_load_dwordx4 v1, s[4:7], s3 offen sc1 lds
 s_waitcnt lgkmcnt(3)
 v_mfma_f32_32x32x16_bf16 v[64:79], a[100:103], v[36:39], v[64:79]
 ds_read_b128 v[52:55], v21 offset:24576
 s_waitcnt lgkmcnt(3)
 v_mfma_f32_32x32x16_bf16 v[64:79], a[104:107], v[40:43], v[64:79]
 ds_read_b128 v[56:59], v22 offset:24576
 s_waitcnt lgkmcnt(3)
 v_mfma_f32_32x32x16_bf16 v[64:79], a[108:111], v[44:47], v[64:79]
 ds_read_b128 v[60:63], v23 offset:24576
 s_add_u32 m0, s56, 33792
 s_add_u32 s3, s55, s68
 buffer_load_dwordx4 v24, s[4:7], s3 offen sc1 lds
 s_waitcnt lgkmcnt(3)
 v_mfma_f32_32x32x16_bf16 v[64:79], a[112:115], v[48:51], v[64:79]
 s_waitcnt vmcnt(10)
 s_barrier
 ds_read_b128 v[32:35], v16 offset:32768
 s_waitcnt lgkmcnt(3)
 v_mfma_f32_32x32x16_bf16 v[64:79], a[116:119], v[52:55], v[64:79]
 ds_read_b128 v[36:39], v17 offset:32768
 s_waitcnt lgkmcnt(3)
 v_mfma_f32_32x32x16_bf16 v[64:79], a[120:123], v[56:59], v[64:79]
 ds_read_b128 v[40:43], v18 offset:32768
 s_waitcnt lgkmcnt(3)
 v_mfma_f32_32x32x16_bf16 v[64:79], a[124:127], v[60:63], v[64:79]
 ds_read_b128 v[44:47], v19 offset:32768
 s_waitcnt lgkmcnt(3)
 v_mfma_f32_32x32x16_bf16 v[64:79], a[128:131], v[32:35], v[64:79]
 ds_read_b128 v[48:51], v20 offset:32768
 s_waitcnt lgkmcnt(3)
 v_mfma_f32_32x32x16_bf16 v[64:79], a[132:135], v[36:39], v[64:79]
 ds_read_b128 v[52:55], v21 offset:32768
 s_waitcnt lgkmcnt(3)
 v_mfma_f32_32x32x16_bf16 v[64:79], a[136:139], v[40:43], v[64:79]
 ds_read_b128 v[56:59], v22 offset:32768
 s_waitcnt lgkmcnt(3)
 v_mfma_f32_32x32x16_bf16 v[64:79], a[140:143], v[44:47], v[64:79]
 ds_read_b128 v[60:63], v23 offset:32768
 s_waitcnt lgkmcnt(3)
 v_mfma_f32_32x32x16_bf16 v[64:79], a[144:147], v[48:51], v[64:79]
 s_waitcnt lgkmcnt(2)
 v_mfma_f32_32x32x16_bf16 v[64:79], a[148:151], v[52:55], v[64:79]
 s_lshl_b32 s55, s54, 2
 s_add_u32 s55, s55, s62
 s_sub_u32 s55, s55, 36
 s_cmp_lg_u32 s50, 0
 s_cselect_b32 s55, 268435456, s55
 v_mov_b32 v6, 8
 s_mov_b64 exec, 15
 v_mov_b32 v6, 0
 buffer_atomic_add v6, v5, s[4:7], s55 offen sc0
 s_mov_b64 exec, -1
 s_waitcnt lgkmcnt(1)
 v_mfma_f32_32x32x16_bf16 v[64:79], a[152:155], v[56:59], v[64:79]
 s_waitcnt lgkmcnt(0)
 v_mfma_f32_32x32x16_bf16 v[64:79], a[156:159], v[60:63], v[64:79]
 s_lshl_b32 s3, s60, 19
 s_add_u32 s3, s3, s58
 s_xor_b32 s3, s3, s82
 s_add_u32 s3, s3, 33554432
 s_nop 8
 v_cvt_pk_bf16_f32 v88, v64, v65
 v_cvt_pk_bf16_f32 v89, v66, v67
 v_cvt_pk_bf16_f32 v90, v72, v73
 v_cvt_pk_bf16_f32 v91, v74, v75
 buffer_store_dwordx4 v[88:91], v4, s[4:7], s3 offen offset:0 sc1
 v_cvt_pk_bf16_f32 v92, v68, v69
 v_cvt_pk_bf16_f32 v93, v70, v71
 v_cvt_pk_bf16_f32 v94, v76, v77
 v_cvt_pk_bf16_f32 v95, v78, v79
 buffer_store_dwordx4 v[92:95], v4, s[4:7], s3 offen offset:512 sc1
 s_cmp_ge_u32 s54, 64
 s_cbranch_scc1 L_n0_75
 s_waitcnt vmcnt(3)
 s_barrier
 s_mov_b32 s60, s54
 ds_read_b128 v[32:35], v8 offset:0
 ds_read_b128 v[36:39], v9 offset:0
 ds_read_b128 v[40:43], v10 offset:0
 ds_read_b128 v[44:47], v11 offset:0
 s_waitcnt lgkmcnt(3)
 v_mfma_f32_32x32x16_bf16 v[64:79], a[0:3], v[32:35], 0
 ds_read_b128 v[48:51], v12 offset:0
 s_waitcnt lgkmcnt(3)
 v_mfma_f32_32x32x16_bf16 v[64:79], a[4:7], v[36:39], v[64:79]
 ds_read_b128 v[52:55], v13 offset:0
 s_waitcnt lgkmcnt(3)
 v_mfma_f32_32x32x16_bf16 v[64:79], a[8:11], v[40:43], v[64:79]
 ds_read_b128 v[56:59], v14 offset:0
 s_waitcnt lgkmcnt(3)
 v_mfma_f32_32x32x16_bf16 v[64:79], a[12:15], v[44:47], v[64:79]
 ds_read_b128 v[60:63], v15 offset:0
 s_waitcnt lgkmcnt(3)
 v_mfma_f32_32x32x16_bf16 v[64:79], a[16:19], v[48:51], v[64:79]
 ds_read_b128 v[32:35], v8 offset:8192
 s_waitcnt lgkmcnt(3)
 v_mfma_f32_32x32x16_bf16 v[64:79], a[20:23], v[52:55], v[64:79]
 ds_read_b128 v[36:39], v9 offset:8192
 s_waitcnt lgkmcnt(3)
 v_mfma_f32_32x32x16_bf16 v[64:79], a[24:27], v[56:59], v[64:79]
 ds_read_b128 v[40:43], v10 offset:8192
 s_waitcnt lgkmcnt(3)
 v_mfma_f32_32x32x16_bf16 v[64:79], a[28:31], v[60:63], v[64:79]
 ds_read_b128 v[44:47], v11 offset:8192
 s_waitcnt lgkmcnt(3)
 v_mfma_f32_32x32x16_bf16 v[64:79], a[32:35], v[32:35], v[64:79]
 ds_read_b128 v[48:51], v12 offset:8192
 s_waitcnt lgkmcnt(3)
 v_mfma_f32_32x32x16_bf16 v[64:79], a[36:39], v[36:39], v[64:79]
 ds_read_b128 v[52:55], v13 offset:8192
 s_waitcnt lgkmcnt(3)
 v_mfma_f32_32x32x16_bf16 v[64:79], a[40:43], v[40:43], v[64:79]
 ds_read_b128 v[56:59], v14 offset:8192
 s_waitcnt lgkmcnt(3)
 v_mfma_f32_32x32x16_bf16 v[64:79], a[44:47], v[44:47], v[64:79]
 ds_read_b128 v[60:63], v15 offset:8192
 s_waitcnt lgkmcnt(3)
 v_mfma_f32_32x32x16_bf16 v[64:79], a[48:51], v[48:51], v[64:79]
 ds_read_b128 v[32:35], v8 offset:16384
 s_waitcnt lgkmcnt(3)
 v_mfma_f32_32x32x16_bf16 v[64:79], a[52:55], v[52:55], v[64:79]
 ds_read_b128 v[36:39], v9 offset:16384
 s_waitcnt lgkmcnt(3)
 v_mfma_f32_32x32x16_bf16 v[64:79], a[56:59], v[56:59], v[64:79]
 ds_read_b128 v[40:43], v10 offset:16384
 s_waitcnt lgkmcnt(3)
 v_mfma_f32_32x32x16_bf16 v[64:79], a[60:63], v[60:63], v[64:79]
 ds_read_b128 v[44:47], v11 offset:16384
 s_waitcnt lgkmcnt(3)
 v_mfma_f32_32x32x16_bf16 v[64:79], a[64:67], v[32:35], v[64:79]
 ds_read_b128 v[48:51], v12 offset:16384
 s_waitcnt lgkmcnt(3)
 v_mfma_f32_32x32x16_bf16 v[64:79], a[68:71], v[36:39], v[64:79]
 ds_read_b128 v[52:55], v13 offset:16384
 s_waitcnt vmcnt(0)
 v_cmp_gt_u32 vcc, 8, v6
 s_cmp_lg_u32 s50, 0
 s_nop 1
 v_mov_b32 v2, vcc_lo
 s_cselect_b64 exec, 0, 1
 ds_write_b32 v7, v2 offset:16
 s_mov_b64 exec, -1
 s_lshl_b32 s3, s54, 2
 s_add_u32 s3, s3, s63
 v_mov_b32 v3, 1
 s_mov_b64 exec, 1
 buffer_atomic_add v3, v5, s[4:7], s3 offen
 s_mov_b64 exec, -1
 s_cmp_eq_u32 s61, 0
 s_cbranch_scc1 L_pf_76
 s_lshl_b32 s3, s61, 2
 s_add_u32 s3, s3, s59
 s_sub_u32 s3, s3, 4
 v_mov_b32 v3, 1
 s_mov_b64 exec, 1
 buffer_atomic_add v3, v5, s[4:7], s3 offen
 s_mov_b64 exec, -1
 s_mov_b32 s61, 0
L_pf_76:
 s_waitcnt lgkmcnt(3)
 v_mfma_f32_32x32x16_bf16 v[64:79], a[72:75], v[40:43], v[64:79]
 ds_read_b128 v[56:59], v14 offset:16384
 s_waitcnt lgkmcnt(3)
 v_mfma_f32_32x32x16_bf16 v[64:79], a[76:79], v[44:47], v[64:79]
 ds_read_b128 v[60:63], v15 offset:16384
 s_waitcnt lgkmcnt(3)
 v_mfma_f32_32x32x16_bf16 v[64:79], a[80:83], v[48:51], v[64:79]
 ds_read_b128 v[32:35], v8 offset:24576
 s_waitcnt lgkmcnt(3)
 v_mfma_f32_32x32x16_bf16 v[64:79], a[84:87], v[52:55], v[64:79]
 ds_read_b128 v[36:39], v9 offset:24576
 s_waitcnt lgkmcnt(3)
 v_mfma_f32_32x32x16_bf16 v[64:79], a[88:91], v[56:59], v[64:79]
 ds_read_b128 v[40:43], v10 offset:24576
 s_barrier
 ds_read_b32 v2, v7 offset:16
 s_waitcnt lgkmcnt(3)
 v_mfma_f32_32x32x16_bf16 v[64:79], a[92:95], v[60:63], v[64:79]
 ds_read_b128 v[44:47], v11 offset:24576
 s_waitcnt lgkmcnt(3)
 v_mfma_f32_32x32x16_bf16 v[64:79], a[96:99], v[32:35], v[64:79]
 ds_read_b128 v[48:51], v12 offset:24576
 s_waitcnt lgkmcnt(3)
 v_mfma_f32_32x32x16_bf16 v[64:79], a[100:103], v[36:39], v[64:79]
 ds_read_b128 v[52:55], v13 offset:24576
 s_waitcnt lgkmcnt(3)
 v_mfma_f32_32x32x16_bf16 v[64:79], a[104:107], v[40:43], v[64:79]
 ds_read_b128 v[56:59], v14 offset:24576
 s_waitcnt lgkmcnt(3)
 v_mfma_f32_32x32x16_bf16 v[64:79], a[108:111], v[44:47], v[64:79]
 ds_read_b128 v[60:63], v15 offset:24576
 v_readfirstlane_b32 s3, v2
 s_cmp_lg_u32 s3, 0
 s_cbranch_scc1 L_pf_77
 s_sub_u32 s72, s54, 9
 s_mul_i32 s55, s72, 40960
 s_mul_i32 s3, s50, 10240
 s_add_u32 s55, s55, s3
 s_add_u32 s55, s55, 195559424
 s_add_u32 m0, s56, 40960
 s_add_u32 s3, s55, s64
 buffer_load_dwordx4 v1, s[4:7], s3 offen sc1 lds
 s_branch L_pf_78
L_pf_77:
 s_mov_b64 exec, 15
 v_mov_b32 v6, 0
 buffer_atomic_add v6, v5, s[4:7], s55 offen sc0
 s_mov_b64 exec, -1
L_pf_78:
 s_waitcnt lgkmcnt(3)
 v_mfma_f32_32x32x16_bf16 v[64:79], a[112:115], v[48:51], v[64:79]
 ds_read_b128 v[32:35], v8 offset:32768
 s_cmp_eq_u32 s72, 0
 s_cbranch_scc1 L_pf_79
 s_add_u32 m0, s56, 41984
 s_add_u32 s3, s55, s64
 buffer_load_dwordx4 v24, s[4:7], s3 offen sc1 lds
L_pf_79:
 s_waitcnt lgkmcnt(3)
 v_mfma_f32_32x32x16_bf16 v[64:79], a[116:119], v[52:55], v[64:79]
 ds_read_b128 v[36:39], v9 offset:32768
 s_cmp_eq_u32 s72, 0
 s_cbranch_scc1 L_pf_80
 s_add_u32 m0, s56, 49152
 s_add_u32 s3, s55, s65
 buffer_load_dwordx4 v1, s[4:7], s3 offen sc1 lds
L_pf_80:
 s_waitcnt lgkmcnt(3)
 v_mfma_f32_32x32x16_bf16 v[64:79], a[120:123], v[56:59], v[64:79]
 ds_read_b128 v[40:43], v10 offset:32768
 s_cmp_eq_u32 s72, 0
 s_cbranch_scc1 L_pf_81
 s_add_u32 m0, s56, 50176
 s_add_u32 s3, s55, s65
 buffer_load_dwordx4 v24, s[4:7], s3 offen sc1 lds
L_pf_81:
 s_waitcnt lgkmcnt(3)
 v_mfma_f32_32x32x16_bf16 v[64:79], a[124:127], v[60:63], v[64:79]
 ds_read_b128 v[44:47], v11 offset:32768
 s_cmp_eq_u32 s72, 0
 s_cbranch_scc1 L_pf_82
 s_add_u32 m0, s56, 57344
 s_add_u32 s3, s55, s66
 buffer_load_dwordx4 v1, s[4:7], s3 offen sc1 lds
L_pf_82:
 s_waitcnt lgkmcnt(3)
 v_mfma_f32_32x32x16_bf16 v[64:79], a[128:131], v[32:35], v[64:79]
 ds_read_b128 v[48:51], v12 offset:32768
 s_cmp_eq_u32 s72, 0
 s_cbranch_scc1 L_pf_83
 s_add_u32 m0, s56, 58368
 s_add_u32 s3, s55, s66
 buffer_load_dwordx4 v24, s[4:7], s3 offen sc1 lds
L_pf_83:
 s_waitcnt lgkmcnt(3)
 v_mfma_f32_32x32x16_bf16 v[64:79], a[132:135], v[36:39], v[64:79]
 ds_read_b128 v[52:55], v13 offset:32768
 s_cmp_eq_u32 s72, 0
 s_cbranch_scc1 L_pf_84
 s_add_u32 m0, s56, 65536
 s_add_u32 s3, s55, s67
 buffer_load_dwordx4 v1, s[4:7], s3 offen sc1 lds
L_pf_84:
 s_waitcnt lgkmcnt(3)
 v_mfma_f32_32x32x16_bf16 v[64:79], a[136:139], v[40:43], v[64:79]
 ds_read_b128 v[56:59], v14 offset:32768
 s_cmp_eq_u32 s72, 0
 s_cbranch_scc1 L_pf_85
 s_add_u32 m0, s56, 66560
 s_add_u32 s3, s55, s67
 buffer_load_dwordx4 v24, s[4:7], s3 offen sc1 lds
L_pf_85:
 s_waitcnt lgkmcnt(3)
 v_mfma_f32_32x32x16_bf16 v[64:79], a[140:143], v[44:47], v[64:79]
 ds_read_b128 v[60:63], v15 offset:32768
 s_cmp_eq_u32 s72, 0
 s_cbranch_scc1 L_pf_86
 s_add_u32 m0, s56, 73728
 s_add_u32 s3, s55, s68
 buffer_load_dwordx4 v1, s[4:7], s3 offen sc1 lds
L_pf_86:
 s_waitcnt lgkmcnt(3)
 v_mfma_f32_32x32x16_bf16 v[64:79], a[144:147], v[48:51], v[64:79]
 s_cmp_eq_u32 s72, 0
 s_cbranch_scc1 L_pf_87
 s_add_u32 m0, s56, 74752
 s_add_u32 s3, s55, s68
 buffer_load_dwordx4 v24, s[4:7], s3 offen sc1 lds
L_pf_87:
 s_waitcnt lgkmcnt(2)
 v_mfma_f32_32x32x16_bf16 v[64:79], a[148:151], v[52:55], v[64:79]
 s_waitcnt lgkmcnt(1)
 v_mfma_f32_32x32x16_bf16 v[64:79], a[152:155], v[56:59], v[64:79]
 s_waitcnt lgkmcnt(0)
 v_mfma_f32_32x32x16_bf16 v[64:79], a[156:159], v[60:63], v[64:79]
 s_lshl_b32 s3, s60, 19
 s_add_u32 s3, s3, s58
 s_xor_b32 s3, s3, s82
 s_nop 8
 v_cvt_pk_bf16_f32 v80, v64, v65
 v_cvt_pk_bf16_f32 v81, v66, v67
 v_cvt_pk_bf16_f32 v82, v72, v73
 v_cvt_pk_bf16_f32 v83, v74, v75
 buffer_store_dwordx4 v[80:83], v4, s[4:7], s3 offen offset:0 sc1
 v_cvt_pk_bf16_f32 v84, v68, v69
 v_cvt_pk_bf16_f32 v85, v70, v71
 v_cvt_pk_bf16_f32 v86, v76, v77
 v_cvt_pk_bf16_f32 v87, v78, v79
 buffer_store_dwordx4 v[84:87], v4, s[4:7], s3 offen offset:512 sc1
 s_add_u32 s54, s54, 1
 s_mov_b32 s61, s54
 s_cmp_lg_u32 s72, 0
 s_cbranch_scc1 L_qkvq_loop
 s_cmp_lg_u32 s50, 0
 s_cbranch_scc1 L_w_88
 s_waitcnt vmcnt(2)
 v_cmp_gt_u32 vcc, 8, v6
 s_nop 1
 v_mov_b32 v3, vcc_lo
 ds_write_b32 v7, v3
 s_waitcnt lgkmcnt(0)
L_w_88:
 s_barrier
 ds_read_b32 v3, v7
 s_waitcnt lgkmcnt(0)
 v_readfirstlane_b32 s3, v3
 s_cmp_eq_u32 s3, 0
 s_cbranch_scc1 L_qkvq_loop
 s_branch L_qkvq_block
L_n0_75:
 s_waitcnt vmcnt(0)
 s_lshl_b32 s3, s54, 2
 s_add_u32 s3, s3, s63
 v_mov_b32 v3, 1
 s_mov_b64 exec, 1
 buffer_atomic_add v3, v5, s[4:7], s3 offen
 s_mov_b64 exec, -1
 s_add_u32 s54, s54, 1
 s_cmp_lt_u32 s54, 74
 s_cbranch_scc1 L_qkvq_block
 s_endpgm
L_qkvv:
 s_mul_i32 s57, s50, 40960
 s_mul_i32 s62, s52, 3
 s_add_u32 s62, s62, s53
 s_mul_i32 s3, s62, 13108
 s_lshr_b32 s3, s3, 16
 s_mul_i32 s3, s3, 5
 s_sub_u32 s55, s62, s3
 s_add_u32 s64, s55, 0
 s_sub_u32 s3, s64, 5
 s_cmp_ge_u32 s64, 5
 s_cselect_b32 s64, s3, s64
 s_add_u32 s65, s55, 1
 s_sub_u32 s3, s65, 5
 s_cmp_ge_u32 s65, 5
 s_cselect_b32 s65, s3, s65
 s_add_u32 s66, s55, 2
 s_sub_u32 s3, s66, 5
 s_cmp_ge_u32 s66, 5
 s_cselect_b32 s66, s3, s66
 s_add_u32 s67, s55, 3
 s_sub_u32 s3, s67, 5
 s_cmp_ge_u32 s67, 5
 s_cselect_b32 s67, s3, s67
 s_add_u32 s68, s55, 4
 s_sub_u32 s3, s68, 5
 s_cmp_ge_u32 s68, 5
 s_cselect_b32 s68, s3, s68
 s_lshl_b32 s55, s52, 8
 v_lshrrev_b32 v4, 4, v0
 s_mov_b32 s3, 8192
 v_mul_lo_u32 v4, v4, s3
 v_lshrrev_b32 v3, 3, v0
 v_and_b32 v3, 6, v3
 v_xor_b32 v3, v3, v0
 v_and_b32 v3, 15, v3
 v_lshl_add_u32 v4, v3, 4, v4
 v_xor_b32 v5, 128, v4
 s_lshl_b32 s57, s50, 13
 s_mul_i32 s3, s50, 262144
 s_add_u32 s55, s55, s3
 s_mul_i32 s51, s64, 1048576
 s_add_u32 s51, s51, s55
 s_add_u32 m0, s57, 0
 s_nop 0
 buffer_load_dwordx4 v4, s[8:11], s51 offen lds
 s_add_u32 s51, s51, 32768
 s_add_u32 m0, s57, 1024
 s_nop 0
 buffer_load_dwordx4 v5, s[8:11], s51 offen lds
 s_add_u32 s51, s51, 32768
 s_add_u32 m0, s57, 2048
 s_nop 0
 buffer_load_dwordx4 v4, s[8:11], s51 offen lds
 s_add_u32 s51, s51, 32768
 s_add_u32 m0, s57, 3072
 s_nop 0
 buffer_load_dwordx4 v5, s[8:11], s51 offen lds
 s_add_u32 s51, s51, 32768
 s_add_u32 m0, s57, 4096
 s_nop 0
 buffer_load_dwordx4 v4, s[8:11], s51 offen lds
 s_add_u32 s51, s51, 32768
 s_add_u32 m0, s57, 5120
 s_nop 0
 buffer_load_dwordx4 v5, s[8:11], s51 offen lds
 s_add_u32 s51, s51, 32768
 s_add_u32 m0, s57, 6144
 s_nop 0
 buffer_load_dwordx4 v4, s[8:11], s51 offen lds
 s_add_u32 s51, s51, 32768
 s_add_u32 m0, s57, 7168
 s_nop 0
 buffer_load_dwordx4 v5, s[8:11], s51 offen lds
 s_add_u32 s51, s51, 32768
 s_mul_i32 s51, s65, 1048576
 s_add_u32 s51, s51, s55
 s_add_u32 m0, s57, 32768
 s_nop 0
 buffer_load_dwordx4 v4, s[8:11], s51 offen lds
 s_add_u32 s51, s51, 32768
 s_add_u32 m0, s57, 33792
 s_nop 0
 buffer_load_dwordx4 v5, s[8:11], s51 offen lds
 s_add_u32 s51, s51, 32768
 s_add_u32 m0, s57, 34816
 s_nop 0
 buffer_load_dwordx4 v4, s[8:11], s51 offen lds
 s_add_u32 s51, s51, 32768
 s_add_u32 m0, s57, 35840
 s_nop 0
 buffer_load_dwordx4 v5, s[8:11], s51 offen lds
 s_add_u32 s51, s51, 32768
 s_add_u32 m0, s57, 36864
 s_nop 0
 buffer_load_dwordx4 v4, s[8:11], s51 offen lds
 s_add_u32 s51, s51, 32768
 s_add_u32 m0, s57, 37888
 s_nop 0
 buffer_load_dwordx4 v5, s[8:11], s51 offen lds
 s_add_u32 s51, s51, 32768
 s_add_u32 m0, s57, 38912
 s_nop 0
 buffer_load_dwordx4 v4, s[8:11], s51 offen lds
 s_add_u32 s51, s51, 32768
 s_add_u32 m0, s57, 39936
 s_nop 0
 buffer_load_dwordx4 v5, s[8:11], s51 offen lds
 s_add_u32 s51, s51, 32768
 s_mul_i32 s51, s66, 1048576
 s_add_u32 s51, s51, s55
 s_add_u32 m0, s57, 65536
 s_nop 0
 buffer_load_dwordx4 v4, s[8:11], s51 offen lds
 s_add_u32 s51, s51, 32768
 s_add_u32 m0, s57, 66560
 s_nop 0
 buffer_load_dwordx4 v5, s[8:11], s51 offen lds
 s_add_u32 s51, s51, 32768
 s_add_u32 m0, s57, 67584
 s_nop 0
 buffer_load_dwordx4 v4, s[8:11], s51 offen lds
 s_add_u32 s51, s51, 32768
 s_add_u32 m0, s57, 68608
 s_nop 0
 buffer_load_dwordx4 v5, s[8:11], s51 offen lds
 s_add_u32 s51, s51, 32768
 s_add_u32 m0, s57, 69632
 s_nop 0
 buffer_load_dwordx4 v4, s[8:11], s51 offen lds
 s_add_u32 s51, s51, 32768
 s_add_u32 m0, s57, 70656
 s_nop 0
 buffer_load_dwordx4 v5, s[8:11], s51 offen lds
 s_add_u32 s51, s51, 32768
 s_add_u32 m0, s57, 71680
 s_nop 0
 buffer_load_dwordx4 v4, s[8:11], s51 offen lds
 s_add_u32 s51, s51, 32768
 s_add_u32 m0, s57, 72704
 s_nop 0
 buffer_load_dwordx4 v5, s[8:11], s51 offen lds
 s_add_u32 s51, s51, 32768
 s_mul_i32 s51, s67, 1048576
 s_add_u32 s51, s51, s55
 s_add_u32 m0, s57, 98304
 s_nop 0
 buffer_load_dwordx4 v4, s[8:11], s51 offen lds
 s_add_u32 s51, s51, 32768
 s_add_u32 m0, s57, 99328
 s_nop 0
 buffer_load_dwordx4 v5, s[8:11], s51 offen lds
 s_add_u32 s51, s51, 32768
 s_add_u32 m0, s57, 100352
 s_nop 0
 buffer_load_dwordx4 v4, s[8:11], s51 offen lds
 s_add_u32 s51, s51, 32768
 s_add_u32 m0, s57, 101376
 s_nop 0
 buffer_load_dwordx4 v5, s[8:11], s51 offen lds
 s_add_u32 s51, s51, 32768
 s_add_u32 m0, s57, 102400
 s_nop 0
 buffer_load_dwordx4 v4, s[8:11], s51 offen lds
 s_add_u32 s51, s51, 32768
 s_add_u32 m0, s57, 103424
 s_nop 0
 buffer_load_dwordx4 v5, s[8:11], s51 offen lds
 s_add_u32 s51, s51, 32768
 s_add_u32 m0, s57, 104448
 s_nop 0
 buffer_load_dwordx4 v4, s[8:11], s51 offen lds
 s_add_u32 s51, s51, 32768
 s_add_u32 m0, s57, 105472
 s_nop 0
 buffer_load_dwordx4 v5, s[8:11], s51 offen lds
 s_add_u32 s51, s51, 32768
 s_mul_i32 s51, s68, 1048576
 s_add_u32 s51, s51, s55
 s_add_u32 m0, s57, 131072
 s_nop 0
 buffer_load_dwordx4 v4, s[8:11], s51 offen lds
 s_add_u32 s51, s51, 32768
 s_add_u32 m0, s57, 132096
 s_nop 0
 buffer_load_dwordx4 v5, s[8:11], s51 offen lds
 s_add_u32 s51, s51, 32768
 s_add_u32 m0, s57, 133120
 s_nop 0
 buffer_load_dwordx4 v4, s[8:11], s51 offen lds
 s_add_u32 s51, s51, 32768
 s_add_u32 m0, s57, 134144
 s_nop 0
 buffer_load_dwordx4 v5, s[8:11], s51 offen lds
 s_add_u32 s51, s51, 32768
 s_add_u32 m0, s57, 135168
 s_nop 0
 buffer_load_dwordx4 v4, s[8:11], s51 offen lds
 s_add_u32 s51, s51, 32768
 s_add_u32 m0, s57, 136192
 s_nop 0
 buffer_load_dwordx4 v5, s[8:11], s51 offen lds
 s_add_u32 s51, s51, 32768
 s_add_u32 m0, s57, 137216
 s_nop 0
 buffer_load_dwordx4 v4, s[8:11], s51 offen lds
 s_add_u32 s51, s51, 32768
 s_add_u32 m0, s57, 138240
 s_nop 0
 buffer_load_dwordx4 v5, s[8:11], s51 offen lds
 s_add_u32 s51, s51, 32768
 s_mov_b32 s96, s44
 s_and_b32 s97, s45, 0xffff
 s_mov_b32 s98, 256
 s_mov_b32 s99, 0x00020000
 buffer_load_dword v30, off, s[96:99], 0 offset:132 sc1
 v_lshrrev_b32 v2, 3, v0
 v_and_b32 v2, 4, v2
 v_bfe_u32 v3, v0, 2, 2
 v_or_b32 v2, v2, v3
 v_bfe_u32 v3, v0, 4, 1
 v_xor_b32 v3, v3, v2
 s_lshl_b32 s3, s50, 1
 v_xor_b32 v3, s3, v3
 v_lshlrev_b32 v2, 8, v2
 v_lshl_add_u32 v2, v3, 5, v2
 v_and_b32 v3, 3, v0
 v_lshl_add_u32 v2, v3, 3, v2
 s_waitcnt vmcnt(32)
 s_barrier
 ds_read_b64_tr_b16 a[0:1], v2 offset:0
 ds_read_b64_tr_b16 a[2:3], v2 offset:4096
 ds_read_b64_tr_b16 a[4:5], v2 offset:2048
 ds_read_b64_tr_b16 a[6:7], v2 offset:6144
 ds_read_b64_tr_b16 a[8:9], v2 offset:8192
 ds_read_b64_tr_b16 a[10:11], v2 offset:12288
 ds_read_b64_tr_b16 a[12:13], v2 offset:10240
 ds_read_b64_tr_b16 a[14:15], v2 offset:14336
 ds_read_b64_tr_b16 a[16:17], v2 offset:16384
 ds_read_b64_tr_b16 a[18:19], v2 offset:20480
 ds_read_b64_tr_b16 a[20:21], v2 offset:18432
 ds_read_b64_tr_b16 a[22:23], v2 offset:22528
 ds_read_b64_tr_b16 a[24:25], v2 offset:24576
 ds_read_b64_tr_b16 a[26:27], v2 offset:28672
 ds_read_b64_tr_b16 a[28:29], v2 offset:26624
 ds_read_b64_tr_b16 a[30:31], v2 offset:30720
 v_add_u32 v2, 0x8000, v2
 s_waitcnt vmcnt(24)
 s_barrier
 ds_read_b64_tr_b16 a[32:33], v2 offset:0
 ds_read_b64_tr_b16 a[34:35], v2 offset:4096
 ds_read_b64_tr_b16 a[36:37], v2 offset:2048
 ds_read_b64_tr_b16 a[38:39], v2 offset:6144
 ds_read_b64_tr_b16 a[40:41], v2 offset:8192
 ds_read_b64_tr_b16 a[42:43], v2 offset:12288
 ds_read_b64_tr_b16 a[44:45], v2 offset:10240
 ds_read_b64_tr_b16 a[46:47], v2 offset:14336
 ds_read_b64_tr_b16 a[48:49], v2 offset:16384
 ds_read_b64_tr_b16 a[50:51], v2 offset:20480
 ds_read_b64_tr_b16 a[52:53], v2 offset:18432
 ds_read_b64_tr_b16 a[54:55], v2 offset:22528
 ds_read_b64_tr_b16 a[56:57], v2 offset:24576
 ds_read_b64_tr_b16 a[58:59], v2 offset:28672
 ds_read_b64_tr_b16 a[60:61], v2 offset:26624
 ds_read_b64_tr_b16 a[62:63], v2 offset:30720
 v_add_u32 v2, 0x8000, v2
 s_waitcnt vmcnt(16)
 s_barrier
 ds_read_b64_tr_b16 a[64:65], v2 offset:0
 ds_read_b64_tr_b16 a[66:67], v2 offset:4096
 ds_read_b64_tr_b16 a[68:69], v2 offset:2048
 ds_read_b64_tr_b16 a[70:71], v2 offset:6144
 ds_read_b64_tr_b16 a[72:73], v2 offset:8192
 ds_read_b64_tr_b16 a[74:75], v2 offset:12288
 ds_read_b64_tr_b16 a[76:77], v2 offset:10240
 ds_read_b64_tr_b16 a[78:79], v2 offset:14336
 ds_read_b64_tr_b16 a[80:81], v2 offset:16384
 ds_read_b64_tr_b16 a[82:83], v2 offset:20480
 ds_read_b64_tr_b16 a[84:85], v2 offset:18432
 ds_read_b64_tr_b16 a[86:87], v2 offset:22528
 ds_read_b64_tr_b16 a[88:89], v2 offset:24576
 ds_read_b64_tr_b16 a[90:91], v2 offset:28672
 ds_read_b64_tr_b16 a[92:93], v2 offset:26624
 ds_read_b64_tr_b16 a[94:95], v2 offset:30720
 v_add_u32 v2, 0x8000, v2
 s_waitcnt vmcnt(8)
 s_barrier
 ds_read_b64_tr_b16 a[96:97], v2 offset:0
 ds_read_b64_tr_b16 a[98:99], v2 offset:4096
 ds_read_b64_tr_b16 a[100:101], v2 offset:2048
 ds_read_b64_tr_b16 a[102:103], v2 offset:6144
 ds_read_b64_tr_b16 a[104:105], v2 offset:8192
 ds_read_b64_tr_b16 a[106:107], v2 offset:12288
 ds_read_b64_tr_b16 a[108:109], v2 offset:10240
 ds_read_b64_tr_b16 a[110:111], v2 offset:14336
 ds_read_b64_tr_b16 a[112:113], v2 offset:16384
 ds_read_b64_tr_b16 a[114:115], v2 offset:20480
 ds_read_b64_tr_b16 a[116:117], v2 offset:18432
 ds_read_b64_tr_b16 a[118:119], v2 offset:22528
 ds_read_b64_tr_b16 a[120:121], v2 offset:24576
 ds_read_b64_tr_b16 a[122:123], v2 offset:28672
 ds_read_b64_tr_b16 a[124:125], v2 offset:26624
 ds_read_b64_tr_b16 a[126:127], v2 offset:30720
 v_add_u32 v2, 0x8000, v2
 s_waitcnt vmcnt(0)
 s_barrier
 ds_read_b64_tr_b16 a[128:129], v2 offset:0
 ds_read_b64_tr_b16 a[130:131], v2 offset:4096
 ds_read_b64_tr_b16 a[132:133], v2 offset:2048
 ds_read_b64_tr_b16 a[134:135], v2 offset:6144
 ds_read_b64_tr_b16 a[136:137], v2 offset:8192
 ds_read_b64_tr_b16 a[138:139], v2 offset:12288
 ds_read_b64_tr_b16 a[140:141], v2 offset:10240
 ds_read_b64_tr_b16 a[142:143], v2 offset:14336
 ds_read_b64_tr_b16 a[144:145], v2 offset:16384
 ds_read_b64_tr_b16 a[146:147], v2 offset:20480
 ds_read_b64_tr_b16 a[148:149], v2 offset:18432
 ds_read_b64_tr_b16 a[150:151], v2 offset:22528
 ds_read_b64_tr_b16 a[152:153], v2 offset:24576
 ds_read_b64_tr_b16 a[154:155], v2 offset:28672
 ds_read_b64_tr_b16 a[156:157], v2 offset:26624
 ds_read_b64_tr_b16 a[158:159], v2 offset:30720
 v_add_u32 v2, 0x8000, v2
 s_waitcnt lgkmcnt(0)
 s_barrier
 v_cmp_eq_u32 vcc, 0, v30
 s_cbranch_vccz L_qa_89
 s_mov_b32 s96, s44
 s_and_b32 s97, s45, 0xffff
 s_mov_b32 s98, 256
 s_mov_b32 s99, 0x00020000
 v_mov_b32 v1, 132
 s_mov_b32 s51, 0
 s_mov_b64 exec, 1
L_wb_90:
 buffer_load_dword v2, v1, s[96:99], 0 offen sc1
 s_waitcnt vmcnt(0)
 v_cmp_eq_u32 vcc, 0, v2
 s_cbranch_vccz L_wbd_91
 s_sleep 2
 s_add_u32 s51, s51, 1
 s_cmp_lt_u32 s51, 131072
 s_cbranch_scc1 L_wb_90
 s_branch L_bail
L_wbd_91:
 s_mov_b64 exec, -1
L_qa_89:
 s_lshl_b32 s64, s64, 8
 s_lshl_b32 s65, s65, 8
 s_lshl_b32 s66, s66, 8
 s_lshl_b32 s67, s67, 8
 s_lshl_b32 s68, s68, 8
 v_lshrrev_b32 v1, 4, v0
 s_mov_b32 s3, 1280
 v_mul_lo_u32 v1, v1, s3
 v_and_b32 v3, 15, v0
 v_lshl_add_u32 v1, v3, 4, v1
 v_add_u32 v6, 5120, v1
 v_mov_b32 v24, v6
 v_and_b32 v2, 31, v0
 v_lshlrev_b32 v2, 8, v2
 v_lshrrev_b32 v4, 5, v0
 v_xor_b32 v4, v4, v3
 v_xor_b32 v8, 0, v4
 v_lshl_add_u32 v8, v8, 4, v2
 v_add_u32 v16, 40960, v8
 v_xor_b32 v9, 2, v4
 v_lshl_add_u32 v9, v9, 4, v2
 v_add_u32 v17, 40960, v9
 v_xor_b32 v10, 4, v4
 v_lshl_add_u32 v10, v10, 4, v2
 v_add_u32 v18, 40960, v10
 v_xor_b32 v11, 6, v4
 v_lshl_add_u32 v11, v11, 4, v2
 v_add_u32 v19, 40960, v11
 v_xor_b32 v12, 8, v4
 v_lshl_add_u32 v12, v12, 4, v2
 v_add_u32 v20, 40960, v12
 v_xor_b32 v13, 10, v4
 v_lshl_add_u32 v13, v13, 4, v2
 v_add_u32 v21, 40960, v13
 v_xor_b32 v14, 12, v4
 v_lshl_add_u32 v14, v14, 4, v2
 v_add_u32 v22, 40960, v14
 v_xor_b32 v15, 14, v4
 v_lshl_add_u32 v15, v15, 4, v2
 v_add_u32 v23, 40960, v15
 v_lshrrev_b32 v4, 5, v0
 v_lshlrev_b32 v4, 8, v4
 v_lshl_add_u32 v4, v3, 4, v4
 v_and_b32 v2, 16, v0
 v_lshl_add_u32 v4, v2, 6, v4
 s_lshl_b32 s3, s50, 11
 v_add_u32 v4, s3, v4
 v_mul_u32_u24 v5, 49152, v0
 v_mov_b32 v7, 163776
 s_lshl_b32 s75, s62, 2
 s_add_u32 s75, s75, s50
 s_and_b32 s100, s52, 1
 s_lshl_b32 s100, s100, 13
 s_lshl_b32 s58, s52, 14
 s_add_u32 s58, s58, s100
 s_add_u32 s58, s58, 83886080
 s_cmp_eq_u32 s53, 0
 s_cselect_b32 s82, 8192, 0
 s_lshl_b32 s59, s52, 8
 s_add_u32 s59, s59, 16384
 s_lshl_b32 s56, s50, 11
 s_mov_b32 s54, 0
 s_mov_b32 s61, 0
 s_mov_b32 s70, s75
 s_mul_i32 s55, s54, 40960
 s_mul_i32 s3, s50, 10240
 s_add_u32 s55, s55, s3
 s_add_u32 s55, s55, 192937984
 s_add_u32 m0, s56, 0
 s_add_u32 s3, s55, s64
 buffer_load_dwordx4 v1, s[4:7], s3 offen sc1 lds
 s_add_u32 m0, s56, 1024
 s_add_u32 s3, s55, s64
 buffer_load_dwordx4 v24, s[4:7], s3 offen sc1 lds
 s_add_u32 m0, s56, 8192
 s_add_u32 s3, s55, s65
 buffer_load_dwordx4 v1, s[4:7], s3 offen sc1 lds
 s_add_u32 m0, s56, 9216
 s_add_u32 s3, s55, s65
 buffer_load_dwordx4 v24, s[4:7], s3 offen sc1 lds
 s_add_u32 m0, s56, 16384
 s_add_u32 s3, s55, s66
 buffer_load_dwordx4 v1, s[4:7], s3 offen sc1 lds
 s_add_u32 m0, s56, 17408
 s_add_u32 s3, s55, s66
 buffer_load_dwordx4 v24, s[4:7], s3 offen sc1 lds
 s_add_u32 m0, s56, 24576
 s_add_u32 s3, s55, s67
 buffer_load_dwordx4 v1, s[4:7], s3 offen sc1 lds
 s_add_u32 m0, s56, 25600
 s_add_u32 s3, s55, s67
 buffer_load_dwordx4 v24, s[4:7], s3 offen sc1 lds
 s_add_u32 m0, s56, 32768
 s_add_u32 s3, s55, s68
 buffer_load_dwordx4 v1, s[4:7], s3 offen sc1 lds
 s_add_u32 m0, s56, 33792
 s_add_u32 s3, s55, s68
 buffer_load_dwordx4 v24, s[4:7], s3 offen sc1 lds
 s_waitcnt vmcnt(0)
L_qkvv_pre:
 s_barrier
 s_mov_b32 s60, s54
 s_add_u32 s54, s54, 1
 s_mul_i32 s55, s54, 40960
 s_mul_i32 s3, s50, 10240
 s_add_u32 s55, s55, s3
 s_add_u32 s55, s55, 192937984
 ds_read_b128 v[32:35], v8 offset:0
 ds_read_b128 v[36:39], v9 offset:0
 ds_read_b128 v[40:43], v10 offset:0
 ds_read_b128 v[44:47], v11 offset:0
 s_waitcnt lgkmcnt(3)
 v_mfma_f32_32x32x16_bf16 v[64:79], v[32:35], a[0:3], 0
 ds_read_b128 v[48:51], v12 offset:0
 s_add_u32 m0, s56, 40960
 s_add_u32 s3, s55, s64
 buffer_load_dwordx4 v1, s[4:7], s3 offen sc1 lds
 s_waitcnt lgkmcnt(3)
 v_mfma_f32_32x32x16_bf16 v[64:79], v[36:39], a[4:7], v[64:79]
 ds_read_b128 v[52:55], v13 offset:0
 s_waitcnt lgkmcnt(3)
 v_mfma_f32_32x32x16_bf16 v[64:79], v[40:43], a[8:11], v[64:79]
 ds_read_b128 v[56:59], v14 offset:0
 s_waitcnt lgkmcnt(3)
 v_mfma_f32_32x32x16_bf16 v[64:79], v[44:47], a[12:15], v[64:79]
 ds_read_b128 v[60:63], v15 offset:0
 s_add_u32 m0, s56, 41984
 s_add_u32 s3, s55, s64
 buffer_load_dwordx4 v24, s[4:7], s3 offen sc1 lds
 s_waitcnt lgkmcnt(3)
 v_mfma_f32_32x32x16_bf16 v[64:79], v[48:51], a[16:19], v[64:79]
 ds_read_b128 v[32:35], v8 offset:8192
 s_waitcnt lgkmcnt(3)
 v_mfma_f32_32x32x16_bf16 v[64:79], v[52:55], a[20:23], v[64:79]
 ds_read_b128 v[36:39], v9 offset:8192
 s_waitcnt lgkmcnt(3)
 v_mfma_f32_32x32x16_bf16 v[64:79], v[56:59], a[24:27], v[64:79]
 ds_read_b128 v[40:43], v10 offset:8192
 s_add_u32 m0, s56, 49152
 s_add_u32 s3, s55, s65
 buffer_load_dwordx4 v1, s[4:7], s3 offen sc1 lds
 s_waitcnt lgkmcnt(3)
 v_mfma_f32_32x32x16_bf16 v[64:79], v[60:63], a[28:31], v[64:79]
 ds_read_b128 v[44:47], v11 offset:8192
 s_waitcnt lgkmcnt(3)
 v_mfma_f32_32x32x16_bf16 v[64:79], v[32:35], a[32:35], v[64:79]
 ds_read_b128 v[48:51], v12 offset:8192
 s_waitcnt lgkmcnt(3)
 v_mfma_f32_32x32x16_bf16 v[64:79], v[36:39], a[36:39], v[64:79]
 ds_read_b128 v[52:55], v13 offset:8192
 s_add_u32 m0, s56, 50176
 s_add_u32 s3, s55, s65
 buffer_load_dwordx4 v24, s[4:7], s3 offen sc1 lds
 s_waitcnt lgkmcnt(3)
 v_mfma_f32_32x32x16_bf16 v[64:79], v[40:43], a[40:43], v[64:79]
 ds_read_b128 v[56:59], v14 offset:8192
 s_waitcnt lgkmcnt(3)
 v_mfma_f32_32x32x16_bf16 v[64:79], v[44:47], a[44:47], v[64:79]
 ds_read_b128 v[60:63], v15 offset:8192
 s_waitcnt lgkmcnt(3)
 v_mfma_f32_32x32x16_bf16 v[64:79], v[48:51], a[48:51], v[64:79]
 ds_read_b128 v[32:35], v8 offset:16384
 s_add_u32 m0, s56, 57344
 s_add_u32 s3, s55, s66
 buffer_load_dwordx4 v1, s[4:7], s3 offen sc1 lds
 s_waitcnt lgkmcnt(3)
 v_mfma_f32_32x32x16_bf16 v[64:79], v[52:55], a[52:55], v[64:79]
 ds_read_b128 v[36:39], v9 offset:16384
 s_waitcnt lgkmcnt(3)
 v_mfma_f32_32x32x16_bf16 v[64:79], v[56:59], a[56:59], v[64:79]
 ds_read_b128 v[40:43], v10 offset:16384
 s_waitcnt lgkmcnt(3)
 v_mfma_f32_32x32x16_bf16 v[64:79], v[60:63], a[60:63], v[64:79]
 ds_read_b128 v[44:47], v11 offset:16384
 s_add_u32 m0, s56, 58368
 s_add_u32 s3, s55, s66
 buffer_load_dwordx4 v24, s[4:7], s3 offen sc1 lds
 s_waitcnt lgkmcnt(3)
 v_mfma_f32_32x32x16_bf16 v[64:79], v[32:35], a[64:67], v[64:79]
 ds_read_b128 v[48:51], v12 offset:16384
 s_waitcnt lgkmcnt(3)
 v_mfma_f32_32x32x16_bf16 v[64:79], v[36:39], a[68:71], v[64:79]
 ds_read_b128 v[52:55], v13 offset:16384
 s_waitcnt lgkmcnt(3)
 v_mfma_f32_32x32x16_bf16 v[64:79], v[40:43], a[72:75], v[64:79]
 ds_read_b128 v[56:59], v14 offset:16384
 s_add_u32 m0, s56, 65536
 s_add_u32 s3, s55, s67
 buffer_load_dwordx4 v1, s[4:7], s3 offen sc1 lds
 s_waitcnt lgkmcnt(3)
 v_mfma_f32_32x32x16_bf16 v[64:79], v[44:47], a[76:79], v[64:79]
 ds_read_b128 v[60:63], v15 offset:16384
 s_waitcnt vmcnt(7)
 s_cmp_eq_u32 s61, 0
 s_cbranch_scc1 L_pf_92
 s_lshl_b32 s3, s61, 2
 s_add_u32 s3, s3, s59
 s_sub_u32 s3, s3, 4
 v_mov_b32 v3, 1
 s_mov_b64 exec, 1
 buffer_atomic_add v3, v5, s[4:7], s3 offen
 s_mov_b64 exec, -1
 s_mov_b32 s61, 0
L_pf_92:
 s_waitcnt lgkmcnt(3)
 v_mfma_f32_32x32x16_bf16 v[64:79], v[48:51], a[80:83], v[64:79]
 ds_read_b128 v[32:35], v8 offset:24576
 s_waitcnt lgkmcnt(3)
 v_mfma_f32_32x32x16_bf16 v[64:79], v[52:55], a[84:87], v[64:79]
 ds_read_b128 v[36:39], v9 offset:24576
 s_add_u32 m0, s56, 66560
 s_add_u32 s3, s55, s67
 buffer_load_dwordx4 v24, s[4:7], s3 offen sc1 lds
 s_waitcnt lgkmcnt(3)
 v_mfma_f32_32x32x16_bf16 v[64:79], v[56:59], a[88:91], v[64:79]
 ds_read_b128 v[40:43], v10 offset:24576
 s_waitcnt lgkmcnt(3)
 v_mfma_f32_32x32x16_bf16 v[64:79], v[60:63], a[92:95], v[64:79]
 ds_read_b128 v[44:47], v11 offset:24576
 s_waitcnt lgkmcnt(3)
 v_mfma_f32_32x32x16_bf16 v[64:79], v[32:35], a[96:99], v[64:79]
 ds_read_b128 v[48:51], v12 offset:24576
 s_add_u32 m0, s56, 73728
 s_add_u32 s3, s55, s68
 buffer_load_dwordx4 v1, s[4:7], s3 offen sc1 lds
 s_waitcnt lgkmcnt(3)
 v_mfma_f32_32x32x16_bf16 v[64:79], v[36:39], a[100:103], v[64:79]
 ds_read_b128 v[52:55], v13 offset:24576
 s_waitcnt lgkmcnt(3)
 v_mfma_f32_32x32x16_bf16 v[64:79], v[40:43], a[104:107], v[64:79]
 ds_read_b128 v[56:59], v14 offset:24576
 s_waitcnt lgkmcnt(3)
 v_mfma_f32_32x32x16_bf16 v[64:79], v[44:47], a[108:111], v[64:79]
 ds_read_b128 v[60:63], v15 offset:24576
 s_add_u32 m0, s56, 74752
 s_add_u32 s3, s55, s68
 buffer_load_dwordx4 v24, s[4:7], s3 offen sc1 lds
 s_waitcnt lgkmcnt(3)
 v_mfma_f32_32x32x16_bf16 v[64:79], v[48:51], a[112:115], v[64:79]
 ds_read_b128 v[32:35], v8 offset:32768
 s_waitcnt lgkmcnt(3)
 v_mfma_f32_32x32x16_bf16 v[64:79], v[52:55], a[116:119], v[64:79]
 ds_read_b128 v[36:39], v9 offset:32768
 s_waitcnt lgkmcnt(3)
 v_mfma_f32_32x32x16_bf16 v[64:79], v[56:59], a[120:123], v[64:79]
 ds_read_b128 v[40:43], v10 offset:32768
 s_waitcnt lgkmcnt(3)
 v_mfma_f32_32x32x16_bf16 v[64:79], v[60:63], a[124:127], v[64:79]
 ds_read_b128 v[44:47], v11 offset:32768
 s_waitcnt lgkmcnt(3)
 v_mfma_f32_32x32x16_bf16 v[64:79], v[32:35], a[128:131], v[64:79]
 ds_read_b128 v[48:51], v12 offset:32768
 s_waitcnt lgkmcnt(3)
 v_mfma_f32_32x32x16_bf16 v[64:79], v[36:39], a[132:135], v[64:79]
 ds_read_b128 v[52:55], v13 offset:32768
 s_waitcnt lgkmcnt(3)
 v_mfma_f32_32x32x16_bf16 v[64:79], v[40:43], a[136:139], v[64:79]
 ds_read_b128 v[56:59], v14 offset:32768
 s_waitcnt lgkmcnt(3)
 v_mfma_f32_32x32x16_bf16 v[64:79], v[44:47], a[140:143], v[64:79]
 ds_read_b128 v[60:63], v15 offset:32768
 s_waitcnt lgkmcnt(3)
 v_mfma_f32_32x32x16_bf16 v[64:79], v[48:51], a[144:147], v[64:79]
 s_waitcnt lgkmcnt(2)
 v_mfma_f32_32x32x16_bf16 v[64:79], v[52:55], a[148:151], v[64:79]
 s_waitcnt lgkmcnt(1)
 v_mfma_f32_32x32x16_bf16 v[64:79], v[56:59], a[152:155], v[64:79]
 s_waitcnt lgkmcnt(0)
 v_mfma_f32_32x32x16_bf16 v[64:79], v[60:63], a[156:159], v[64:79]
 s_lshl_b32 s3, s60, 19
 s_add_u32 s3, s3, s58
 s_xor_b32 s3, s3, s82
 s_nop 8
 v_cvt_pk_bf16_f32 v80, v64, v65
 v_cvt_pk_bf16_f32 v81, v66, v67
 v_cvt_pk_bf16_f32 v82, v72, v73
 v_cvt_pk_bf16_f32 v83, v74, v75
 buffer_store_dwordx4 v[80:83], v4, s[4:7], s3 offen offset:0 sc1
 v_cvt_pk_bf16_f32 v84, v68, v69
 v_cvt_pk_bf16_f32 v85, v70, v71
 v_cvt_pk_bf16_f32 v86, v76, v77
 v_cvt_pk_bf16_f32 v87, v78, v79
 buffer_store_dwordx4 v[84:87], v4, s[4:7], s3 offen offset:512 sc1
 s_mov_b32 s61, s54
 s_cmp_lg_u32 s54, 1
 s_cbranch_scc1 L_f1_93
 s_waitcnt vmcnt(0)
 s_cmp_eq_u32 s61, 0
 s_cbranch_scc1 L_pf_94
 s_lshl_b32 s3, s61, 2
 s_add_u32 s3, s3, s59
 s_sub_u32 s3, s3, 4
 v_mov_b32 v3, 1
 s_mov_b64 exec, 1
 buffer_atomic_add v3, v5, s[4:7], s3 offen
 s_mov_b64 exec, -1
 s_mov_b32 s61, 0
L_pf_94:
 s_mov_b32 s8, s38
 s_and_b32 s9, s39, 0xffff
 s_mov_b32 s10, 2621440
 s_mov_b32 s11, 0x00020000
 s_mov_b32 s12, s40
 s_and_b32 s13, s41, 0xffff
 s_mov_b32 s14, 1280
 s_mov_b32 s15, 0x00020000
 v_lshlrev_b32 v130, 4, v0
 s_lshl_b32 s73, s70, 12
 s_add_u32 s74, s73, 2
 buffer_load_dwordx4 v[96:99], v130, s[8:11], s73 offen offset:0
 buffer_load_dwordx4 v[100:103], v130, s[8:11], s73 offen offset:1024
 buffer_load_dwordx4 v[112:115], v130, s[8:11], s74 offen offset:0
 buffer_load_dwordx4 v[116:119], v130, s[8:11], s74 offen offset:1024
 s_lshl_b32 s3, s70, 1
 buffer_load_ushort v128, off, s[12:15], s3
 s_branch L_f2_95
L_f1_93:
 s_waitcnt vmcnt(2)
L_f2_95:
 s_barrier
 s_mov_b32 s60, s54
 s_add_u32 s54, s54, 1
 s_mul_i32 s55, s54, 40960
 s_mul_i32 s3, s50, 10240
 s_add_u32 s55, s55, s3
 s_add_u32 s55, s55, 192937984
 ds_read_b128 v[32:35], v16 offset:0
 ds_read_b128 v[36:39], v17 offset:0
 ds_read_b128 v[40:43], v18 offset:0
 ds_read_b128 v[44:47], v19 offset:0
 s_waitcnt lgkmcnt(3)
 v_mfma_f32_32x32x16_bf16 v[64:79], v[32:35], a[0:3], 0
 ds_read_b128 v[48:51], v20 offset:0
 s_add_u32 m0, s56, 0
 s_add_u32 s3, s55, s64
 buffer_load_dwordx4 v1, s[4:7], s3 offen sc1 lds
 s_waitcnt lgkmcnt(3)
 v_mfma_f32_32x32x16_bf16 v[64:79], v[36:39], a[4:7], v[64:79]
 ds_read_b128 v[52:55], v21 offset:0
 s_waitcnt lgkmcnt(3)
 v_mfma_f32_32x32x16_bf16 v[64:79], v[40:43], a[8:11], v[64:79]
 ds_read_b128 v[56:59], v22 offset:0
 s_waitcnt lgkmcnt(3)
 v_mfma_f32_32x32x16_bf16 v[64:79], v[44:47], a[12:15], v[64:79]
 ds_read_b128 v[60:63], v23 offset:0
 s_add_u32 m0, s56, 1024
 s_add_u32 s3, s55, s64
 buffer_load_dwordx4 v24, s[4:7], s3 offen sc1 lds
 s_waitcnt lgkmcnt(3)
 v_mfma_f32_32x32x16_bf16 v[64:79], v[48:51], a[16:19], v[64:79]
 ds_read_b128 v[32:35], v16 offset:8192
 s_waitcnt lgkmcnt(3)
 v_mfma_f32_32x32x16_bf16 v[64:79], v[52:55], a[20:23], v[64:79]
 ds_read_b128 v[36:39], v17 offset:8192
 s_waitcnt lgkmcnt(3)
 v_mfma_f32_32x32x16_bf16 v[64:79], v[56:59], a[24:27], v[64:79]
 ds_read_b128 v[40:43], v18 offset:8192
 s_add_u32 m0, s56, 8192
 s_add_u32 s3, s55, s65
 buffer_load_dwordx4 v1, s[4:7], s3 offen sc1 lds
 s_waitcnt lgkmcnt(3)
 v_mfma_f32_32x32x16_bf16 v[64:79], v[60:63], a[28:31], v[64:79]
 ds_read_b128 v[44:47], v19 offset:8192
 s_waitcnt lgkmcnt(3)
 v_mfma_f32_32x32x16_bf16 v[64:79], v[32:35], a[32:35], v[64:79]
 ds_read_b128 v[48:51], v20 offset:8192
 s_waitcnt lgkmcnt(3)
 v_mfma_f32_32x32x16_bf16 v[64:79], v[36:39], a[36:39], v[64:79]
 ds_read_b128 v[52:55], v21 offset:8192
 s_add_u32 m0, s56, 9216
 s_add_u32 s3, s55, s65
 buffer_load_dwordx4 v24, s[4:7], s3 offen sc1 lds
 s_waitcnt lgkmcnt(3)
 v_mfma_f32_32x32x16_bf16 v[64:79], v[40:43], a[40:43], v[64:79]
 ds_read_b128 v[56:59], v22 offset:8192
 s_waitcnt lgkmcnt(3)
 v_mfma_f32_32x32x16_bf16 v[64:79], v[44:47], a[44:47], v[64:79]
 ds_read_b128 v[60:63], v23 offset:8192
 s_waitcnt lgkmcnt(3)
 v_mfma_f32_32x32x16_bf16 v[64:79], v[48:51], a[48:51], v[64:79]
 ds_read_b128 v[32:35], v16 offset:16384
 s_add_u32 m0, s56, 16384
 s_add_u32 s3, s55, s66
 buffer_load_dwordx4 v1, s[4:7], s3 offen sc1 lds
 s_waitcnt lgkmcnt(3)
 v_mfma_f32_32x32x16_bf16 v[64:79], v[52:55], a[52:55], v[64:79]
 ds_read_b128 v[36:39], v17 offset:16384
 s_waitcnt lgkmcnt(3)
 v_mfma_f32_32x32x16_bf16 v[64:79], v[56:59], a[56:59], v[64:79]
 ds_read_b128 v[40:43], v18 offset:16384
 s_waitcnt lgkmcnt(3)
 v_mfma_f32_32x32x16_bf16 v[64:79], v[60:63], a[60:63], v[64:79]
 ds_read_b128 v[44:47], v19 offset:16384
 s_add_u32 m0, s56, 17408
 s_add_u32 s3, s55, s66
 buffer_load_dwordx4 v24, s[4:7], s3 offen sc1 lds
 s_waitcnt lgkmcnt(3)
 v_mfma_f32_32x32x16_bf16 v[64:79], v[32:35], a[64:67], v[64:79]
 ds_read_b128 v[48:51], v20 offset:16384
 s_waitcnt lgkmcnt(3)
 v_mfma_f32_32x32x16_bf16 v[64:79], v[36:39], a[68:71], v[64:79]
 ds_read_b128 v[52:55], v21 offset:16384
 s_waitcnt lgkmcnt(3)
 v_mfma_f32_32x32x16_bf16 v[64:79], v[40:43], a[72:75], v[64:79]
 ds_read_b128 v[56:59], v22 offset:16384
 s_add_u32 m0, s56, 24576
 s_add_u32 s3, s55, s67
 buffer_load_dwordx4 v1, s[4:7], s3 offen sc1 lds
 s_waitcnt lgkmcnt(3)
 v_mfma_f32_32x32x16_bf16 v[64:79], v[44:47], a[76:79], v[64:79]
 ds_read_b128 v[60:63], v23 offset:16384
 s_waitcnt vmcnt(7)
 s_cmp_eq_u32 s61, 0
 s_cbranch_scc1 L_pf_96
 s_lshl_b32 s3, s61, 2
 s_add_u32 s3, s3, s59
 s_sub_u32 s3, s3, 4
 v_mov_b32 v3, 1
 s_mov_b64 exec, 1
 buffer_atomic_add v3, v5, s[4:7], s3 offen
 s_mov_b64 exec, -1
 s_mov_b32 s61, 0
L_pf_96:
 s_waitcnt lgkmcnt(3)
 v_mfma_f32_32x32x16_bf16 v[64:79], v[48:51], a[80:83], v[64:79]
 ds_read_b128 v[32:35], v16 offset:24576
 s_waitcnt lgkmcnt(3)
 v_mfma_f32_32x32x16_bf16 v[64:79], v[52:55], a[84:87], v[64:79]
 ds_read_b128 v[36:39], v17 offset:24576
 s_add_u32 m0, s56, 25600
 s_add_u32 s3, s55, s67
 buffer_load_dwordx4 v24, s[4:7], s3 offen sc1 lds
 s_waitcnt lgkmcnt(3)
 v_mfma_f32_32x32x16_bf16 v[64:79], v[56:59], a[88:91], v[64:79]
 ds_read_b128 v[40:43], v18 offset:24576
 s_waitcnt lgkmcnt(3)
 v_mfma_f32_32x32x16_bf16 v[64:79], v[60:63], a[92:95], v[64:79]
 ds_read_b128 v[44:47], v19 offset:24576
 s_waitcnt lgkmcnt(3)
 v_mfma_f32_32x32x16_bf16 v[64:79], v[32:35], a[96:99], v[64:79]
 ds_read_b128 v[48:51], v20 offset:24576
 s_add_u32 m0, s56, 32768
 s_add_u32 s3, s55, s68
 buffer_load_dwordx4 v1, s[4:7], s3 offen sc1 lds
 s_waitcnt lgkmcnt(3)
 v_mfma_f32_32x32x16_bf16 v[64:79], v[36:39], a[100:103], v[64:79]
 ds_read_b128 v[52:55], v21 offset:24576
 s_waitcnt lgkmcnt(3)
 v_mfma_f32_32x32x16_bf16 v[64:79], v[40:43], a[104:107], v[64:79]
 ds_read_b128 v[56:59], v22 offset:24576
 s_waitcnt lgkmcnt(3)
 v_mfma_f32_32x32x16_bf16 v[64:79], v[44:47], a[108:111], v[64:79]
 ds_read_b128 v[60:63], v23 offset:24576
 s_add_u32 m0, s56, 33792
 s_add_u32 s3, s55, s68
 buffer_load_dwordx4 v24, s[4:7], s3 offen sc1 lds
 s_waitcnt lgkmcnt(3)
 v_mfma_f32_32x32x16_bf16 v[64:79], v[48:51], a[112:115], v[64:79]
 ds_read_b128 v[32:35], v16 offset:32768
 s_waitcnt lgkmcnt(3)
 v_mfma_f32_32x32x16_bf16 v[64:79], v[52:55], a[116:119], v[64:79]
 ds_read_b128 v[36:39], v17 offset:32768
 s_waitcnt lgkmcnt(3)
 v_mfma_f32_32x32x16_bf16 v[64:79], v[56:59], a[120:123], v[64:79]
 ds_read_b128 v[40:43], v18 offset:32768
 s_waitcnt lgkmcnt(3)
 v_mfma_f32_32x32x16_bf16 v[64:79], v[60:63], a[124:127], v[64:79]
 ds_read_b128 v[44:47], v19 offset:32768
 s_waitcnt lgkmcnt(3)
 v_mfma_f32_32x32x16_bf16 v[64:79], v[32:35], a[128:131], v[64:79]
 ds_read_b128 v[48:51], v20 offset:32768
 s_waitcnt lgkmcnt(3)
 v_mfma_f32_32x32x16_bf16 v[64:79], v[36:39], a[132:135], v[64:79]
 ds_read_b128 v[52:55], v21 offset:32768
 s_waitcnt lgkmcnt(3)
 v_mfma_f32_32x32x16_bf16 v[64:79], v[40:43], a[136:139], v[64:79]
 ds_read_b128 v[56:59], v22 offset:32768
 s_waitcnt lgkmcnt(3)
 v_mfma_f32_32x32x16_bf16 v[64:79], v[44:47], a[140:143], v[64:79]
 ds_read_b128 v[60:63], v23 offset:32768
 s_waitcnt lgkmcnt(3)
 v_mfma_f32_32x32x16_bf16 v[64:79], v[48:51], a[144:147], v[64:79]
 s_waitcnt lgkmcnt(2)
 v_mfma_f32_32x32x16_bf16 v[64:79], v[52:55], a[148:151], v[64:79]
 s_waitcnt lgkmcnt(1)
 v_mfma_f32_32x32x16_bf16 v[64:79], v[56:59], a[152:155], v[64:79]
 s_waitcnt lgkmcnt(0)
 v_mfma_f32_32x32x16_bf16 v[64:79], v[60:63], a[156:159], v[64:79]
 s_lshl_b32 s3, s60, 19
 s_add_u32 s3, s3, s58
 s_xor_b32 s3, s3, s82
 s_nop 8
 v_cvt_pk_bf16_f32 v88, v64, v65
 v_cvt_pk_bf16_f32 v89, v66, v67
 v_cvt_pk_bf16_f32 v90, v72, v73
 v_cvt_pk_bf16_f32 v91, v74, v75
 buffer_store_dwordx4 v[88:91], v4, s[4:7], s3 offen offset:0 sc1
 v_cvt_pk_bf16_f32 v92, v68, v69
 v_cvt_pk_bf16_f32 v93, v70, v71
 v_cvt_pk_bf16_f32 v94, v76, v77
 v_cvt_pk_bf16_f32 v95, v78, v79
 buffer_store_dwordx4 v[92:95], v4, s[4:7], s3 offen offset:512 sc1
 s_mov_b32 s61, s54
 s_waitcnt vmcnt(2)
 s_cmp_lg_u32 s54, 4
 s_cbranch_scc1 L_cv_97
 s_waitcnt vmcnt(0)
 s_cmp_eq_u32 s61, 0
 s_cbranch_scc1 L_pf_98
 s_lshl_b32 s3, s61, 2
 s_add_u32 s3, s3, s59
 s_sub_u32 s3, s3, 4
 v_mov_b32 v3, 1
 s_mov_b64 exec, 1
 buffer_atomic_add v3, v5, s[4:7], s3 offen
 s_mov_b64 exec, -1
 s_mov_b32 s61, 0
L_pf_98:
 s_mul_i32 s71, s50, 13312
 s_add_u32 s71, s71, 81920
 s_mov_b32 s70, s75
 s_mov_b32 s69, 640
 s_getpc_b64 s[76:77]
L_ca_99:
 s_add_u32 s76, s76, L_conv0-L_ca_99
 s_addc_u32 s77, s77, -1
 s_swappc_b64 s[76:77], s[76:77]
 s_waitcnt vmcnt(0)
 s_barrier
 s_cmp_lg_u32 s50, 3
 s_cbranch_scc1 L_ar_100
 s_mov_b32 s96, s44
 s_and_b32 s97, s45, 0xffff
 s_mov_b32 s98, 256
 s_mov_b32 s99, 0x00020000
 v_mov_b32 v1, 1
 s_mov_b64 exec, 1
 buffer_atomic_add v1, off, s[96:99], 0 offset:8 sc0
 s_waitcnt vmcnt(0)
 v_cmp_eq_u32 vcc, 159, v1
 s_cbranch_vccz L_aw_101
 buffer_store_dword v1, off, s[96:99], 0 offset:136 sc1
L_aw_101:
 s_mov_b64 exec, -1
L_ar_100:
 s_cmp_lg_u32 s50, 0
 s_cbranch_scc1 L_ww_102
 s_mov_b32 s96, s44
 s_and_b32 s97, s45, 0xffff
 s_mov_b32 s98, 256
 s_mov_b32 s99, 0x00020000
 v_mov_b32 v24, 208
 s_mov_b32 s51, 0
 s_mov_b64 exec, 1
L_wb_103:
 buffer_load_dword v25, v24, s[96:99], 0 offen sc1
 s_waitcnt vmcnt(0)
 v_cmp_eq_u32 vcc, 0, v25
 s_cbranch_vccz L_wbd_104
 s_sleep 2
 s_add_u32 s51, s51, 1
 s_cmp_lt_u32 s51, 131072
 s_cbranch_scc1 L_wb_103
 s_branch L_bail
L_wbd_104:
 s_mov_b64 exec, -1
L_ww_102:
 s_barrier
 s_mov_b32 s70, s75
 s_mov_b32 s8, s38
 s_and_b32 s9, s39, 0xffff
 s_mov_b32 s10, 2621440
 s_mov_b32 s11, 0x00020000
 s_mov_b32 s12, s40
 s_and_b32 s13, s41, 0xffff
 s_mov_b32 s14, 1280
 s_mov_b32 s15, 0x00020000
 v_lshlrev_b32 v130, 4, v0
 s_lshl_b32 s73, s70, 12
 s_add_u32 s74, s73, 2
 buffer_load_dwordx4 v[96:99], v130, s[8:11], s73 offen offset:0
 buffer_load_dwordx4 v[100:103], v130, s[8:11], s73 offen offset:1024
 buffer_load_dwordx4 v[104:107], v130, s[8:11], s73 offen offset:2048
 buffer_load_dwordx4 v[108:111], v130, s[8:11], s73 offen offset:3072
 buffer_load_dwordx4 v[112:115], v130, s[8:11], s74 offen offset:0
 buffer_load_dwordx4 v[116:119], v130, s[8:11], s74 offen offset:1024
 buffer_load_dwordx4 v[120:123], v130, s[8:11], s74 offen offset:2048
 buffer_load_dwordx4 v[124:127], v130, s[8:11], s74 offen offset:3072
 s_lshl_b32 s3, s70, 1
 buffer_load_ushort v128, off, s[12:15], s3
 s_lshl_b32 s3, s70, 12
 s_add_u32 s3, s3, 198180864
 buffer_load_dwordx4 v[240:243], v130, s[4:7], s3 offen offset:0 sc1
 buffer_load_dwordx4 v[244:247], v130, s[4:7], s3 offen offset:1024 sc1
 buffer_load_dwordx4 v[248:251], v130, s[4:7], s3 offen offset:2048 sc1
 buffer_load_dwordx4 v[252:255], v130, s[4:7], s3 offen offset:3072 sc1
 v_lshrrev_b32 v1, 4, v0
 s_mov_b32 s3, 1280
 v_mul_lo_u32 v1, v1, s3
 v_and_b32 v3, 15, v0
 v_lshl_add_u32 v1, v3, 4, v1
 v_add_u32 v6, 5120, v1
 v_mov_b32 v24, v6
 v_and_b32 v2, 31, v0
 v_lshlrev_b32 v2, 8, v2
 v_lshrrev_b32 v4, 5, v0
 v_xor_b32 v4, v4, v3
 v_xor_b32 v8, 0, v4
 v_lshl_add_u32 v8, v8, 4, v2
 v_add_u32 v16, 40960, v8
 v_xor_b32 v9, 2, v4
 v_lshl_add_u32 v9, v9, 4, v2
 v_add_u32 v17, 40960, v9
 v_xor_b32 v10, 4, v4
 v_lshl_add_u32 v10, v10, 4, v2
 v_add_u32 v18, 40960, v10
 v_xor_b32 v11, 6, v4
 v_lshl_add_u32 v11, v11, 4, v2
 v_add_u32 v19, 40960, v11
 v_xor_b32 v12, 8, v4
 v_lshl_add_u32 v12, v12, 4, v2
 v_add_u32 v20, 40960, v12
 v_xor_b32 v13, 10, v4
 v_lshl_add_u32 v13, v13, 4, v2
 v_add_u32 v21, 40960, v13
 v_xor_b32 v14, 12, v4
 v_lshl_add_u32 v14, v14, 4, v2
 v_add_u32 v22, 40960, v14
 v_xor_b32 v15, 14, v4
 v_lshl_add_u32 v15, v15, 4, v2
 v_add_u32 v23, 40960, v15
 v_lshrrev_b32 v4, 5, v0
 v_lshlrev_b32 v4, 8, v4
 v_lshl_add_u32 v4, v3, 4, v4
 v_and_b32 v2, 16, v0
 v_lshl_add_u32 v4, v2, 6, v4
 s_lshl_b32 s3, s50, 11
 v_add_u32 v4, s3, v4
 v_mul_u32_u24 v5, 49152, v0
 v_mov_b32 v7, 163776
L_cv_97:
 s_cmp_lt_u32 s54, 10
 s_cbranch_scc1 L_qkvv_pre
 s_waitcnt vmcnt(0)
 s_cmp_eq_u32 s61, 0
 s_cbranch_scc1 L_pf_105
 s_lshl_b32 s3, s61, 2
 s_add_u32 s3, s3, s59
 s_sub_u32 s3, s3, 4
 v_mov_b32 v3, 1
 s_mov_b64 exec, 1
 buffer_atomic_add v3, v5, s[4:7], s3 offen
 s_mov_b64 exec, -1
 s_mov_b32 s61, 0
L_pf_105:
 s_mul_i32 s71, s50, 13312
 s_add_u32 s71, s71, 81920
 s_mov_b32 s70, s75
 s_mov_b32 s69, 640
 s_getpc_b64 s[76:77]
L_ca_106:
 s_add_u32 s76, s76, L_conv1-L_ca_106
 s_addc_u32 s77, s77, -1
 s_swappc_b64 s[76:77], s[76:77]
 s_waitcnt vmcnt(0)
 s_barrier
 s_cmp_lg_u32 s50, 3
 s_cbranch_scc1 L_ar_107
 s_mov_b32 s96, s44
 s_and_b32 s97, s45, 0xffff
 s_mov_b32 s98, 256
 s_mov_b32 s99, 0x00020000
 v_mov_b32 v1, 1
 s_mov_b64 exec, 1
 buffer_atomic_add v1, off, s[96:99], 0 offset:76 sc0
 s_waitcnt vmcnt(0)
 v_cmp_eq_u32 vcc, 127, v1
 s_cbranch_vccz L_aw_108
 buffer_store_dword v1, off, s[96:99], 0 offset:204 sc1
L_aw_108:
 s_mov_b64 exec, -1
L_ar_107:
 v_lshrrev_b32 v1, 4, v0
 s_mov_b32 s3, 1280
 v_mul_lo_u32 v1, v1, s3
 v_and_b32 v3, 15, v0
 v_lshl_add_u32 v1, v3, 4, v1
 v_add_u32 v6, 5120, v1
 v_mov_b32 v24, v6
 v_and_b32 v2, 31, v0
 v_lshlrev_b32 v2, 8, v2
 v_lshrrev_b32 v4, 5, v0
 v_xor_b32 v4, v4, v3
 v_xor_b32 v8, 0, v4
 v_lshl_add_u32 v8, v8, 4, v2
 v_add_u32 v16, 40960, v8
 v_xor_b32 v9, 2, v4
 v_lshl_add_u32 v9, v9, 4, v2
 v_add_u32 v17, 40960, v9
 v_xor_b32 v10, 4, v4
 v_lshl_add_u32 v10, v10, 4, v2
 v_add_u32 v18, 40960, v10
 v_xor_b32 v11, 6, v4
 v_lshl_add_u32 v11, v11, 4, v2
 v_add_u32 v19, 40960, v11
 v_xor_b32 v12, 8, v4
 v_lshl_add_u32 v12, v12, 4, v2
 v_add_u32 v20, 40960, v12
 v_xor_b32 v13, 10, v4
 v_lshl_add_u32 v13, v13, 4, v2
 v_add_u32 v21, 40960, v13
 v_xor_b32 v14, 12, v4
 v_lshl_add_u32 v14, v14, 4, v2
 v_add_u32 v22, 40960, v14
 v_xor_b32 v15, 14, v4
 v_lshl_add_u32 v15, v15, 4, v2
 v_add_u32 v23, 40960, v15
 v_lshrrev_b32 v4, 5, v0
 v_lshlrev_b32 v4, 8, v4
 v_lshl_add_u32 v4, v3, 4, v4
 v_and_b32 v2, 16, v0
 v_lshl_add_u32 v4, v2, 6, v4
 s_lshl_b32 s3, s50, 11
 v_add_u32 v4, s3, v4
 v_mul_u32_u24 v5, 49152, v0
 v_mov_b32 v7, 163776
 s_cmp_lg_u32 s50, 0
 s_cbranch_scc1 L_ww_109
 s_mov_b32 s96, s44
 s_and_b32 s97, s45, 0xffff
 s_mov_b32 s98, 256
 s_mov_b32 s99, 0x00020000
 v_mov_b32 v25, 200
 s_mov_b32 s51, 0
 s_mov_b64 exec, 1
L_wb_110:
 buffer_load_dword v26, v25, s[96:99], 0 offen sc1
 s_waitcnt vmcnt(0)
 v_cmp_eq_u32 vcc, 0, v26
 s_cbranch_vccz L_wbd_111
 s_sleep 2
 s_add_u32 s51, s51, 1
 s_cmp_lt_u32 s51, 131072
 s_cbranch_scc1 L_wb_110
 s_branch L_bail
L_wbd_111:
 s_mov_b64 exec, -1
L_ww_109:
 s_barrier
 s_mov_b32 s96, s44
 s_and_b32 s97, s45, 0xffff
 s_mov_b32 s98, 256
 s_mov_b32 s99, 0x00020000
 v_mov_b32 v25, 132
 s_mov_b32 s3, 144
 v_writelane_b32 v25, s3, 1
 s_mov_b32 s51, 0
 s_mov_b64 exec, 3
L_wb_112:
 buffer_load_dword v26, v25, s[96:99], 0 offen sc1
 s_waitcnt vmcnt(0)
 v_cmp_eq_u32 vcc, 0, v26
 s_cbranch_vccz L_wbd_113
 s_sleep 2
 s_add_u32 s51, s51, 1
 s_cmp_lt_u32 s51, 131072
 s_cbranch_scc1 L_wb_112
 s_branch L_bail
L_wbd_113:
 s_mov_b64 exec, -1
 v_readlane_b32 s81, v26, 1
 s_nop 3
 s_sub_u32 s81, s81, 1
 s_xor_b32 s78, s81, 0
 s_lshl_b32 s78, s78, 13
 s_xor_b32 s79, s78, 8192
 s_cmp_lt_u32 s62, 96
 s_cselect_b32 s3, s79, s78
 s_lshl_b32 s62, s62, 8
 s_lshr_b32 s100, s62, 13
 s_lshl_b32 s100, s100, 13
 s_add_u32 s62, s62, s100
 s_add_u32 s62, s62, s3
 s_add_u32 s62, s62, 229376
 s_add_u32 s63, s59, s78
 s_add_u32 s63, s63, 16344
 s_mov_b32 s72, 0
L_qkvv_block:
 s_lshl_b32 s55, s54, 2
 s_add_u32 s55, s55, s62
 s_sub_u32 s55, s55, 40
 s_cmp_lg_u32 s50, 0
 s_cselect_b32 s3, 268435456, s55
 v_mov_b32 v6, 8
 s_mov_b64 exec, 15
 v_mov_b32 v6, 0
 buffer_atomic_add v6, v5, s[4:7], s3 offen sc0
 s_mov_b64 exec, -1
 s_waitcnt vmcnt(0)
 s_cmp_eq_u32 s61, 0
 s_cbranch_scc1 L_pf_116
 s_lshl_b32 s3, s61, 2
 s_add_u32 s3, s3, s59
 s_sub_u32 s3, s3, 4
 v_mov_b32 v3, 1
 s_mov_b64 exec, 1
 buffer_atomic_add v3, v5, s[4:7], s3 offen
 s_mov_b64 exec, -1
 s_mov_b32 s61, 0
L_pf_116:
 s_cmp_lg_u32 s50, 0
 s_cbranch_scc1 L_w_114
 v_cmp_gt_u32 vcc, 8, v6
 s_cbranch_vccz L_w_114
 s_mov_b32 s51, 0
 s_mov_b64 exec, 15
 v_mov_b32 v28, 0
 buffer_atomic_add v28, v5, s[4:7], s55 offen sc0
 s_sleep 5
L_wc_117:
 v_mov_b32 v29, 0
 buffer_atomic_add v29, v5, s[4:7], s55 offen sc0
 s_waitcnt vmcnt(1)
 v_cmp_gt_u32 vcc, 8, v28
 s_cbranch_vccz L_wcd_118
 v_mov_b32 v28, 0
 buffer_atomic_add v28, v5, s[4:7], s55 offen sc0
 s_waitcnt vmcnt(1)
 v_cmp_gt_u32 vcc, 8, v29
 s_cbranch_vccz L_wcd_118
 s_add_u32 s51, s51, 1
 s_cmp_lt_u32 s51, 131072
 s_cbranch_scc1 L_wc_117
 s_branch L_bail
L_wcd_118:
 s_mov_b64 exec, -1
L_w_114:
 s_barrier
L_qkvv_loop:
 s_cmp_lg_u32 s54, 17
 s_cbranch_scc1 L_c2_119
 s_cmp_lg_u32 s50, 0
 s_cbranch_scc1 L_ww_120
 s_mov_b32 s96, s44
 s_and_b32 s97, s45, 0xffff
 s_mov_b32 s98, 256
 s_mov_b32 s99, 0x00020000
 v_mov_b32 v25, 140
 s_mov_b32 s51, 0
 s_mov_b64 exec, 1
L_wb_121:
 buffer_load_dword v26, v25, s[96:99], 0 offen sc1
 s_waitcnt vmcnt(0)
 v_cmp_eq_u32 vcc, 0, v26
 s_cbranch_vccz L_wbd_122
 s_sleep 2
 s_add_u32 s51, s51, 1
 s_cmp_lt_u32 s51, 131072
 s_cbranch_scc1 L_wb_121
 s_branch L_bail
L_wbd_122:
 s_mov_b64 exec, -1
L_ww_120:
 s_barrier
L_c2_119:
 s_sub_u32 s60, s54, 10
 s_cmp_lg_u32 s72, 0
 s_cbranch_scc1 L_hv_123
 s_mul_i32 s55, s60, 40960
 s_mul_i32 s3, s50, 10240
 s_add_u32 s55, s55, s3
 s_add_u32 s55, s55, 195559424
 s_add_u32 m0, s56, 40960
 s_add_u32 s3, s55, s64
 buffer_load_dwordx4 v1, s[4:7], s3 offen sc1 lds
 s_add_u32 m0, s56, 41984
 s_add_u32 s3, s55, s64
 buffer_load_dwordx4 v24, s[4:7], s3 offen sc1 lds
 s_add_u32 m0, s56, 49152
 s_add_u32 s3, s55, s65
 buffer_load_dwordx4 v1, s[4:7], s3 offen sc1 lds
 s_add_u32 m0, s56, 50176
 s_add_u32 s3, s55, s65
 buffer_load_dwordx4 v24, s[4:7], s3 offen sc1 lds
 s_add_u32 m0, s56, 57344
 s_add_u32 s3, s55, s66
 buffer_load_dwordx4 v1, s[4:7], s3 offen sc1 lds
 s_add_u32 m0, s56, 58368
 s_add_u32 s3, s55, s66
 buffer_load_dwordx4 v24, s[4:7], s3 offen sc1 lds
 s_add_u32 m0, s56, 65536
 s_add_u32 s3, s55, s67
 buffer_load_dwordx4 v1, s[4:7], s3 offen sc1 lds
 s_add_u32 m0, s56, 66560
 s_add_u32 s3, s55, s67
 buffer_load_dwordx4 v24, s[4:7], s3 offen sc1 lds
 s_add_u32 m0, s56, 73728
 s_add_u32 s3, s55, s68
 buffer_load_dwordx4 v1, s[4:7], s3 offen sc1 lds
 s_add_u32 m0, s56, 74752
 s_add_u32 s3, s55, s68
 buffer_load_dwordx4 v24, s[4:7], s3 offen sc1 lds
L_hv_123:
 s_mov_b32 s72, 0
 s_min_u32 s51, s54, 63
 s_mul_i32 s55, s51, 40960
 s_mul_i32 s3, s50, 10240
 s_add_u32 s55, s55, s3
 s_add_u32 s55, s55, 192937984
 s_waitcnt vmcnt(8)
 s_barrier
 ds_read_b128 v[32:35], v16 offset:0
 ds_read_b128 v[36:39], v17 offset:0
 ds_read_b128 v[40:43], v18 offset:0
 ds_read_b128 v[44:47], v19 offset:0
 s_waitcnt lgkmcnt(3)
 v_mfma_f32_32x32x16_bf16 v[64:79], v[32:35], a[0:3], 0
 ds_read_b128 v[48:51], v20 offset:0
 s_add_u32 m0, s56, 0
 s_add_u32 s3, s55, s64
 buffer_load_dwordx4 v1, s[4:7], s3 offen sc1 lds
 s_waitcnt lgkmcnt(3)
 v_mfma_f32_32x32x16_bf16 v[64:79], v[36:39], a[4:7], v[64:79]
 ds_read_b128 v[52:55], v21 offset:0
 s_waitcnt lgkmcnt(3)
 v_mfma_f32_32x32x16_bf16 v[64:79], v[40:43], a[8:11], v[64:79]
 ds_read_b128 v[56:59], v22 offset:0
 s_waitcnt lgkmcnt(3)
 v_mfma_f32_32x32x16_bf16 v[64:79], v[44:47], a[12:15], v[64:79]
 ds_read_b128 v[60:63], v23 offset:0
 s_add_u32 m0, s56, 1024
 s_add_u32 s3, s55, s64
 buffer_load_dwordx4 v24, s[4:7], s3 offen sc1 lds
 s_waitcnt lgkmcnt(3)
 v_mfma_f32_32x32x16_bf16 v[64:79], v[48:51], a[16:19], v[64:79]
 s_waitcnt vmcnt(8)
 s_barrier
 ds_read_b128 v[32:35], v16 offset:8192
 s_waitcnt lgkmcnt(3)
 v_mfma_f32_32x32x16_bf16 v[64:79], v[52:55], a[20:23], v[64:79]
 ds_read_b128 v[36:39], v17 offset:8192
 s_waitcnt lgkmcnt(3)
 v_mfma_f32_32x32x16_bf16 v[64:79], v[56:59], a[24:27], v[64:79]
 ds_read_b128 v[40:43], v18 offset:8192
 s_add_u32 m0, s56, 8192
 s_add_u32 s3, s55, s65
 buffer_load_dwordx4 v1, s[4:7], s3 offen sc1 lds
 s_waitcnt lgkmcnt(3)
 v_mfma_f32_32x32x16_bf16 v[64:79], v[60:63], a[28:31], v[64:79]
 ds_read_b128 v[44:47], v19 offset:8192
 s_waitcnt lgkmcnt(3)
 v_mfma_f32_32x32x16_bf16 v[64:79], v[32:35], a[32:35], v[64:79]
 ds_read_b128 v[48:51], v20 offset:8192
 s_waitcnt lgkmcnt(3)
 v_mfma_f32_32x32x16_bf16 v[64:79], v[36:39], a[36:39], v[64:79]
 ds_read_b128 v[52:55], v21 offset:8192
 s_add_u32 m0, s56, 9216
 s_add_u32 s3, s55, s65
 buffer_load_dwordx4 v24, s[4:7], s3 offen sc1 lds
 s_waitcnt lgkmcnt(3)
 v_mfma_f32_32x32x16_bf16 v[64:79], v[40:43], a[40:43], v[64:79]
 ds_read_b128 v[56:59], v22 offset:8192
 s_waitcnt lgkmcnt(3)
 v_mfma_f32_32x32x16_bf16 v[64:79], v[44:47], a[44:47], v[64:79]
 ds_read_b128 v[60:63], v23 offset:8192
 s_waitcnt lgkmcnt(3)
 v_mfma_f32_32x32x16_bf16 v[64:79], v[48:51], a[48:51], v[64:79]
 s_waitcnt vmcnt(8)
 s_barrier
 ds_read_b128 v[32:35], v16 offset:16384
 s_add_u32 m0, s56, 16384
 s_add_u32 s3, s55, s66
 buffer_load_dwordx4 v1, s[4:7], s3 offen sc1 lds
 s_waitcnt lgkmcnt(3)
 v_mfma_f32_32x32x16_bf16 v[64:79], v[52:55], a[52:55], v[64:79]
 ds_read_b128 v[36:39], v17 offset:16384
 s_waitcnt lgkmcnt(3)
 v_mfma_f32_32x32x16_bf16 v[64:79], v[56:59], a[56:59], v[64:79]
 ds_read_b128 v[40:43], v18 offset:16384
 s_waitcnt lgkmcnt(3)
 v_mfma_f32_32x32x16_bf16 v[64:79], v[60:63], a[60:63], v[64:79]
 ds_read_b128 v[44:47], v19 offset:16384
 s_add_u32 m0, s56, 17408
 s_add_u32 s3, s55, s66
 buffer_load_dwordx4 v24, s[4:7], s3 offen sc1 lds
 s_waitcnt lgkmcnt(3)
 v_mfma_f32_32x32x16_bf16 v[64:79], v[32:35], a[64:67], v[64:79]
 ds_read_b128 v[48:51], v20 offset:16384
 s_waitcnt lgkmcnt(3)
 v_mfma_f32_32x32x16_bf16 v[64:79], v[36:39], a[68:71], v[64:79]
 ds_read_b128 v[52:55], v21 offset:16384
 s_waitcnt lgkmcnt(3)
 v_mfma_f32_32x32x16_bf16 v[64:79], v[40:43], a[72:75], v[64:79]
 ds_read_b128 v[56:59], v22 offset:16384
 s_add_u32 m0, s56, 24576
 s_add_u32 s3, s55, s67
 buffer_load_dwordx4 v1, s[4:7], s3 offen sc1 lds
 s_waitcnt lgkmcnt(3)
 v_mfma_f32_32x32x16_bf16 v[64:79], v[44:47], a[76:79], v[64:79]
 ds_read_b128 v[60:63], v23 offset:16384
 s_waitcnt lgkmcnt(3)
 v_mfma_f32_32x32x16_bf16 v[64:79], v[48:51], a[80:83], v[64:79]
 s_waitcnt vmcnt(9)
 s_barrier
 ds_read_b128 v[32:35], v16 offset:24576
 s_waitcnt lgkmcnt(3)
 v_mfma_f32_32x32x16_bf16 v[64:79], v[52:55], a[84:87], v[64:79]
 ds_read_b128 v[36:39], v17 offset:24576
 s_add_u32 m0, s56, 25600
 s_add_u32 s3, s55, s67
 buffer_load_dwordx4 v24, s[4:7], s3 offen sc1 lds
 s_waitcnt lgkmcnt(3)
 v_mfma_f32_32x32x16_bf16 v[64:79], v[56:59], a[88:91], v[64:79]
 ds_read_b128 v[40:43], v18 offset:24576
 s_waitcnt lgkmcnt(3)
 v_mfma_f32_32x32x16_bf16 v[64:79], v[60:63], a[92:95], v[64:79]
 ds_read_b128 v[44:47], v19 offset:24576
 s_waitcnt lgkmcnt(3)
 v_mfma_f32_32x32x16_bf16 v[64:79], v[32:35], a[96:99], v[64:79]
 ds_read_b128 v[48:51], v20 offset:24576
 s_add_u32 m0, s56, 32768
 s_add_u32 s3, s55, s68
 buffer_load_dwordx4 v1, s[4:7], s3 offen sc1 lds
 s_waitcnt lgkmcnt(3)
 v_mfma_f32_32x32x16_bf16 v[64:79], v[36:39], a[100:103], v[64:79]
 ds_read_b128 v[52:55], v21 offset:24576
 s_waitcnt lgkmcnt(3)
 v_mfma_f32_32x32x16_bf16 v[64:79], v[40:43], a[104:107], v[64:79]
 ds_read_b128 v[56:59], v22 offset:24576
 s_waitcnt lgkmcnt(3)
 v_mfma_f32_32x32x16_bf16 v[64:79], v[44:47], a[108:111], v[64:79]
 ds_read_b128 v[60:63], v23 offset:24576
 s_add_u32 m0, s56, 33792
 s_add_u32 s3, s55, s68
 buffer_load_dwordx4 v24, s[4:7], s3 offen sc1 lds
 s_waitcnt lgkmcnt(3)
 v_mfma_f32_32x32x16_bf16 v[64:79], v[48:51], a[112:115], v[64:79]
 s_waitcnt vmcnt(10)
 s_barrier
 ds_read_b128 v[32:35], v16 offset:32768
 s_waitcnt lgkmcnt(3)
 v_mfma_f32_32x32x16_bf16 v[64:79], v[52:55], a[116:119], v[64:79]
 ds_read_b128 v[36:39], v17 offset:32768
 s_waitcnt lgkmcnt(3)
 v_mfma_f32_32x32x16_bf16 v[64:79], v[56:59], a[120:123], v[64:79]
 ds_read_b128 v[40:43], v18 offset:32768
 s_waitcnt lgkmcnt(3)
 v_mfma_f32_32x32x16_bf16 v[64:79], v[60:63], a[124:127], v[64:79]
 ds_read_b128 v[44:47], v19 offset:32768
 s_waitcnt lgkmcnt(3)
 v_mfma_f32_32x32x16_bf16 v[64:79], v[32:35], a[128:131], v[64:79]
 ds_read_b128 v[48:51], v20 offset:32768
 s_waitcnt lgkmcnt(3)
 v_mfma_f32_32x32x16_bf16 v[64:79], v[36:39], a[132:135], v[64:79]
 ds_read_b128 v[52:55], v21 offset:32768
 s_waitcnt lgkmcnt(3)
 v_mfma_f32_32x32x16_bf16 v[64:79], v[40:43], a[136:139], v[64:79]
 ds_read_b128 v[56:59], v22 offset:32768
 s_waitcnt lgkmcnt(3)
 v_mfma_f32_32x32x16_bf16 v[64:79], v[44:47], a[140:143], v[64:79]
 ds_read_b128 v[60:63], v23 offset:32768
 s_waitcnt lgkmcnt(3)
 v_mfma_f32_32x32x16_bf16 v[64:79], v[48:51], a[144:147], v[64:79]
 s_waitcnt lgkmcnt(2)
 v_mfma_f32_32x32x16_bf16 v[64:79], v[52:55], a[148:151], v[64:79]
 s_lshl_b32 s55, s54, 2
 s_add_u32 s55, s55, s62
 s_sub_u32 s55, s55, 36
 s_cmp_lg_u32 s50, 0
 s_cselect_b32 s55, 268435456, s55
 v_mov_b32 v6, 8
 s_mov_b64 exec, 15
 v_mov_b32 v6, 0
 buffer_atomic_add v6, v5, s[4:7], s55 offen sc0
 s_mov_b64 exec, -1
 s_waitcnt lgkmcnt(1)
 v_mfma_f32_32x32x16_bf16 v[64:79], v[56:59], a[152:155], v[64:79]
 s_waitcnt lgkmcnt(0)
 v_mfma_f32_32x32x16_bf16 v[64:79], v[60:63], a[156:159], v[64:79]
 s_lshl_b32 s3, s60, 19
 s_add_u32 s3, s3, s58
 s_xor_b32 s3, s3, s82
 s_add_u32 s3, s3, 33554432
 s_nop 8
 v_cvt_pk_bf16_f32 v88, v64, v65
 v_cvt_pk_bf16_f32 v89, v66, v67
 v_cvt_pk_bf16_f32 v90, v72, v73
 v_cvt_pk_bf16_f32 v91, v74, v75
 buffer_store_dwordx4 v[88:91], v4, s[4:7], s3 offen offset:0 sc1
 v_cvt_pk_bf16_f32 v92, v68, v69
 v_cvt_pk_bf16_f32 v93, v70, v71
 v_cvt_pk_bf16_f32 v94, v76, v77
 v_cvt_pk_bf16_f32 v95, v78, v79
 buffer_store_dwordx4 v[92:95], v4, s[4:7], s3 offen offset:512 sc1
 s_cmp_ge_u32 s54, 64
 s_cbranch_scc1 L_n0_124
 s_waitcnt vmcnt(3)
 s_barrier
 s_mov_b32 s60, s54
 ds_read_b128 v[32:35], v8 offset:0
 ds_read_b128 v[36:39], v9 offset:0
 ds_read_b128 v[40:43], v10 offset:0
 ds_read_b128 v[44:47], v11 offset:0
 s_waitcnt lgkmcnt(3)
 v_mfma_f32_32x32x16_bf16 v[64:79], v[32:35], a[0:3], 0
 ds_read_b128 v[48:51], v12 offset:0
 s_waitcnt lgkmcnt(3)
 v_mfma_f32_32x32x16_bf16 v[64:79], v[36:39], a[4:7], v[64:79]
 ds_read_b128 v[52:55], v13 offset:0
 s_waitcnt lgkmcnt(3)
 v_mfma_f32_32x32x16_bf16 v[64:79], v[40:43], a[8:11], v[64:79]
 ds_read_b128 v[56:59], v14 offset:0
 s_waitcnt lgkmcnt(3)
 v_mfma_f32_32x32x16_bf16 v[64:79], v[44:47], a[12:15], v[64:79]
 ds_read_b128 v[60:63], v15 offset:0
 s_waitcnt lgkmcnt(3)
 v_mfma_f32_32x32x16_bf16 v[64:79], v[48:51], a[16:19], v[64:79]
 ds_read_b128 v[32:35], v8 offset:8192
 s_waitcnt lgkmcnt(3)
 v_mfma_f32_32x32x16_bf16 v[64:79], v[52:55], a[20:23], v[64:79]
 ds_read_b128 v[36:39], v9 offset:8192
 s_waitcnt lgkmcnt(3)
 v_mfma_f32_32x32x16_bf16 v[64:79], v[56:59], a[24:27], v[64:79]
 ds_read_b128 v[40:43], v10 offset:8192
 s_waitcnt lgkmcnt(3)
 v_mfma_f32_32x32x16_bf16 v[64:79], v[60:63], a[28:31], v[64:79]
 ds_read_b128 v[44:47], v11 offset:8192
 s_waitcnt lgkmcnt(3)
 v_mfma_f32_32x32x16_bf16 v[64:79], v[32:35], a[32:35], v[64:79]
 ds_read_b128 v[48:51], v12 offset:8192
 s_waitcnt lgkmcnt(3)
 v_mfma_f32_32x32x16_bf16 v[64:79], v[36:39], a[36:39], v[64:79]
 ds_read_b128 v[52:55], v13 offset:8192
 s_waitcnt lgkmcnt(3)
 v_mfma_f32_32x32x16_bf16 v[64:79], v[40:43], a[40:43], v[64:79]
 ds_read_b128 v[56:59], v14 offset:8192
 s_waitcnt lgkmcnt(3)
 v_mfma_f32_32x32x16_bf16 v[64:79], v[44:47], a[44:47], v[64:79]
 ds_read_b128 v[60:63], v15 offset:8192
 s_waitcnt lgkmcnt(3)
 v_mfma_f32_32x32x16_bf16 v[64:79], v[48:51], a[48:51], v[64:79]
 ds_read_b128 v[32:35], v8 offset:16384
 s_waitcnt lgkmcnt(3)
 v_mfma_f32_32x32x16_bf16 v[64:79], v[52:55], a[52:55], v[64:79]
 ds_read_b128 v[36:39], v9 offset:16384
 s_waitcnt lgkmcnt(3)
 v_mfma_f32_32x32x16_bf16 v[64:79], v[56:59], a[56:59], v[64:79]
 ds_read_b128 v[40:43], v10 offset:16384
 s_waitcnt lgkmcnt(3)
 v_mfma_f32_32x32x16_bf16 v[64:79], v[60:63], a[60:63], v[64:79]
 ds_read_b128 v[44:47], v11 offset:16384
 s_waitcnt lgkmcnt(3)
 v_mfma_f32_32x32x16_bf16 v[64:79], v[32:35], a[64:67], v[64:79]
 ds_read_b128 v[48:51], v12 offset:16384
 s_waitcnt lgkmcnt(3)
 v_mfma_f32_32x32x16_bf16 v[64:79], v[36:39], a[68:71], v[64:79]
 ds_read_b128 v[52:55], v13 offset:16384
 s_waitcnt vmcnt(0)
 v_cmp_gt_u32 vcc, 8, v6
 s_cmp_lg_u32 s50, 0
 s_nop 1
 v_mov_b32 v2, vcc_lo
 s_cselect_b64 exec, 0, 1
 ds_write_b32 v7, v2 offset:16
 s_mov_b64 exec, -1
 s_lshl_b32 s3, s54, 2
 s_add_u32 s3, s3, s63
 v_mov_b32 v3, 1
 s_mov_b64 exec, 1
 buffer_atomic_add v3, v5, s[4:7], s3 offen
 s_mov_b64 exec, -1
 s_cmp_eq_u32 s61, 0
 s_cbranch_scc1 L_pf_125
 s_lshl_b32 s3, s61, 2
 s_add_u32 s3, s3, s59
 s_sub_u32 s3, s3, 4
 v_mov_b32 v3, 1
 s_mov_b64 exec, 1
 buffer_atomic_add v3, v5, s[4:7], s3 offen
 s_mov_b64 exec, -1
 s_mov_b32 s61, 0
L_pf_125:
 s_waitcnt lgkmcnt(3)
 v_mfma_f32_32x32x16_bf16 v[64:79], v[40:43], a[72:75], v[64:79]
 ds_read_b128 v[56:59], v14 offset:16384
 s_waitcnt lgkmcnt(3)
 v_mfma_f32_32x32x16_bf16 v[64:79], v[44:47], a[76:79], v[64:79]
 ds_read_b128 v[60:63], v15 offset:16384
 s_waitcnt lgkmcnt(3)
 v_mfma_f32_32x32x16_bf16 v[64:79], v[48:51], a[80:83], v[64:79]
 ds_read_b128 v[32:35], v8 offset:24576
 s_waitcnt lgkmcnt(3)
 v_mfma_f32_32x32x16_bf16 v[64:79], v[52:55], a[84:87], v[64:79]
 ds_read_b128 v[36:39], v9 offset:24576
 s_waitcnt lgkmcnt(3)
 v_mfma_f32_32x32x16_bf16 v[64:79], v[56:59], a[88:91], v[64:79]
 ds_read_b128 v[40:43], v10 offset:24576
 s_barrier
 ds_read_b32 v2, v7 offset:16
 s_waitcnt lgkmcnt(3)
 v_mfma_f32_32x32x16_bf16 v[64:79], v[60:63], a[92:95], v[64:79]
 ds_read_b128 v[44:47], v11 offset:24576
 s_waitcnt lgkmcnt(3)
 v_mfma_f32_32x32x16_bf16 v[64:79], v[32:35], a[96:99], v[64:79]
 ds_read_b128 v[48:51], v12 offset:24576
 s_waitcnt lgkmcnt(3)
 v_mfma_f32_32x32x16_bf16 v[64:79], v[36:39], a[100:103], v[64:79]
 ds_read_b128 v[52:55], v13 offset:24576
 s_waitcnt lgkmcnt(3)
 v_mfma_f32_32x32x16_bf16 v[64:79], v[40:43], a[104:107], v[64:79]
 ds_read_b128 v[56:59], v14 offset:24576
 s_waitcnt lgkmcnt(3)
 v_mfma_f32_32x32x16_bf16 v[64:79], v[44:47], a[108:111], v[64:79]
 ds_read_b128 v[60:63], v15 offset:24576
 v_readfirstlane_b32 s3, v2
 s_cmp_lg_u32 s3, 0
 s_cbranch_scc1 L_pf_126
 s_sub_u32 s72, s54, 9
 s_mul_i32 s55, s72, 40960
 s_mul_i32 s3, s50, 10240
 s_add_u32 s55, s55, s3
 s_add_u32 s55, s55, 195559424
 s_add_u32 m0, s56, 40960
 s_add_u32 s3, s55, s64
 buffer_load_dwordx4 v1, s[4:7], s3 offen sc1 lds
 s_branch L_pf_127
L_pf_126:
 s_mov_b64 exec, 15
 v_mov_b32 v6, 0
 buffer_atomic_add v6, v5, s[4:7], s55 offen sc0
 s_mov_b64 exec, -1
L_pf_127:
 s_waitcnt lgkmcnt(3)
 v_mfma_f32_32x32x16_bf16 v[64:79], v[48:51], a[112:115], v[64:79]
 ds_read_b128 v[32:35], v8 offset:32768
 s_cmp_eq_u32 s72, 0
 s_cbranch_scc1 L_pf_128
 s_add_u32 m0, s56, 41984
 s_add_u32 s3, s55, s64
 buffer_load_dwordx4 v24, s[4:7], s3 offen sc1 lds
L_pf_128:
 s_waitcnt lgkmcnt(3)
 v_mfma_f32_32x32x16_bf16 v[64:79], v[52:55], a[116:119], v[64:79]
 ds_read_b128 v[36:39], v9 offset:32768
 s_cmp_eq_u32 s72, 0
 s_cbranch_scc1 L_pf_129
 s_add_u32 m0, s56, 49152
 s_add_u32 s3, s55, s65
 buffer_load_dwordx4 v1, s[4:7], s3 offen sc1 lds
L_pf_129:
 s_waitcnt lgkmcnt(3)
 v_mfma_f32_32x32x16_bf16 v[64:79], v[56:59], a[120:123], v[64:79]
 ds_read_b128 v[40:43], v10 offset:32768
 s_cmp_eq_u32 s72, 0
 s_cbranch_scc1 L_pf_130
 s_add_u32 m0, s56, 50176
 s_add_u32 s3, s55, s65
 buffer_load_dwordx4 v24, s[4:7], s3 offen sc1 lds
L_pf_130:
 s_waitcnt lgkmcnt(3)
 v_mfma_f32_32x32x16_bf16 v[64:79], v[60:63], a[124:127], v[64:79]
 ds_read_b128 v[44:47], v11 offset:32768
 s_cmp_eq_u32 s72, 0
 s_cbranch_scc1 L_pf_131
 s_add_u32 m0, s56, 57344
 s_add_u32 s3, s55, s66
 buffer_load_dwordx4 v1, s[4:7], s3 offen sc1 lds
L_pf_131:
 s_waitcnt lgkmcnt(3)
 v_mfma_f32_32x32x16_bf16 v[64:79], v[32:35], a[128:131], v[64:79]
 ds_read_b128 v[48:51], v12 offset:32768
 s_cmp_eq_u32 s72, 0
 s_cbranch_scc1 L_pf_132
 s_add_u32 m0, s56, 58368
 s_add_u32 s3, s55, s66
 buffer_load_dwordx4 v24, s[4:7], s3 offen sc1 lds
L_pf_132:
 s_waitcnt lgkmcnt(3)
 v_mfma_f32_32x32x16_bf16 v[64:79], v[36:39], a[132:135], v[64:79]
 ds_read_b128 v[52:55], v13 offset:32768
 s_cmp_eq_u32 s72, 0
 s_cbranch_scc1 L_pf_133
 s_add_u32 m0, s56, 65536
 s_add_u32 s3, s55, s67
 buffer_load_dwordx4 v1, s[4:7], s3 offen sc1 lds
L_pf_133:
 s_waitcnt lgkmcnt(3)
 v_mfma_f32_32x32x16_bf16 v[64:79], v[40:43], a[136:139], v[64:79]
 ds_read_b128 v[56:59], v14 offset:32768
 s_cmp_eq_u32 s72, 0
 s_cbranch_scc1 L_pf_134
 s_add_u32 m0, s56, 66560
 s_add_u32 s3, s55, s67
 buffer_load_dwordx4 v24, s[4:7], s3 offen sc1 lds
L_pf_134:
 s_waitcnt lgkmcnt(3)
 v_mfma_f32_32x32x16_bf16 v[64:79], v[44:47], a[140:143], v[64:79]
 ds_read_b128 v[60:63], v15 offset:32768
 s_cmp_eq_u32 s72, 0
 s_cbranch_scc1 L_pf_135
 s_add_u32 m0, s56, 73728
 s_add_u32 s3, s55, s68
 buffer_load_dwordx4 v1, s[4:7], s3 offen sc1 lds
L_pf_135:
 s_waitcnt lgkmcnt(3)
 v_mfma_f32_32x32x16_bf16 v[64:79], v[48:51], a[144:147], v[64:79]
 s_cmp_eq_u32 s72, 0
 s_cbranch_scc1 L_pf_136
 s_add_u32 m0, s56, 74752
 s_add_u32 s3, s55, s68
 buffer_load_dwordx4 v24, s[4:7], s3 offen sc1 lds
L_pf_136:
 s_waitcnt lgkmcnt(2)
 v_mfma_f32_32x32x16_bf16 v[64:79], v[52:55], a[148:151], v[64:79]
 s_waitcnt lgkmcnt(1)
 v_mfma_f32_32x32x16_bf16 v[64:79], v[56:59], a[152:155], v[64:79]
 s_waitcnt lgkmcnt(0)
 v_mfma_f32_32x32x16_bf16 v[64:79], v[60:63], a[156:159], v[64:79]
 s_lshl_b32 s3, s60, 19
 s_add_u32 s3, s3, s58
 s_xor_b32 s3, s3, s82
 s_nop 8
 v_cvt_pk_bf16_f32 v80, v64, v65
 v_cvt_pk_bf16_f32 v81, v66, v67
 v_cvt_pk_bf16_f32 v82, v72, v73
 v_cvt_pk_bf16_f32 v83, v74, v75
 buffer_store_dwordx4 v[80:83], v4, s[4:7], s3 offen offset:0 sc1
 v_cvt_pk_bf16_f32 v84, v68, v69
 v_cvt_pk_bf16_f32 v85, v70, v71
 v_cvt_pk_bf16_f32 v86, v76, v77
 v_cvt_pk_bf16_f32 v87, v78, v79
 buffer_store_dwordx4 v[84:87], v4, s[4:7], s3 offen offset:512 sc1
 s_add_u32 s54, s54, 1
 s_mov_b32 s61, s54
 s_cmp_lg_u32 s72, 0
 s_cbranch_scc1 L_qkvv_loop
 s_cmp_lg_u32 s50, 0
 s_cbranch_scc1 L_w_137
 s_waitcnt vmcnt(2)
 v_cmp_gt_u32 vcc, 8, v6
 s_nop 1
 v_mov_b32 v3, vcc_lo
 ds_write_b32 v7, v3
 s_waitcnt lgkmcnt(0)
L_w_137:
 s_barrier
 ds_read_b32 v3, v7
 s_waitcnt lgkmcnt(0)
 v_readfirstlane_b32 s3, v3
 s_cmp_eq_u32 s3, 0
 s_cbranch_scc1 L_qkvv_loop
 s_branch L_qkvv_block
L_n0_124:
 s_waitcnt vmcnt(0)
 s_lshl_b32 s3, s54, 2
 s_add_u32 s3, s3, s63
 v_mov_b32 v3, 1
 s_mov_b64 exec, 1
 buffer_atomic_add v3, v5, s[4:7], s3 offen
 s_mov_b64 exec, -1
 s_add_u32 s54, s54, 1
 s_cmp_lt_u32 s54, 74
 s_cbranch_scc1 L_qkvv_block
 s_endpgm
L_wm:
 s_mov_b32 s96, s44
 s_and_b32 s97, s45, 0xffff
 s_mov_b32 s98, 256
 s_mov_b32 s99, 0x00020000
 v_mov_b32 v1, 132
 s_mov_b32 s3, 144
 v_writelane_b32 v1, s3, 1
 s_mov_b32 s51, 0
 s_mov_b64 exec, 3
L_wb_138:
 buffer_load_dword v2, v1, s[96:99], 0 offen sc1
 s_waitcnt vmcnt(0)
 v_cmp_eq_u32 vcc, 0, v2
 s_cbranch_vccz L_wbd_139
 s_sleep 2
 s_add_u32 s51, s51, 1
 s_cmp_lt_u32 s51, 131072
 s_cbranch_scc1 L_wb_138
 s_branch L_bail
L_wbd_139:
 s_mov_b64 exec, -1
 v_readlane_b32 s81, v2, 1
 s_nop 3
 s_sub_u32 s81, s81, 1
 s_mov_b32 s96, s44
 s_and_b32 s97, s45, 0xffff
 s_mov_b32 s98, 256
 s_mov_b32 s99, 0x00020000
 v_lshlrev_b32 v1, 5, v0
 s_mov_b32 s51, 0
L_gl_140:
 buffer_load_dword v2, v1, s[96:99], 0 offen sc1
 s_waitcnt vmcnt(0)
 v_readlane_b32 s3, v2, s48
 s_mov_b32 s80, 0
 s_nop 2
 s_cmp_ge_u32 s3, 32
 s_cbranch_scc1 L_gld_141
 s_mov_b32 s80, 0
 v_readlane_b32 s3, v2, 0
 s_nop 3
 s_add_u32 s80, s80, s3
 v_readlane_b32 s3, v2, 1
 s_nop 3
 s_add_u32 s80, s80, s3
 v_readlane_b32 s3, v2, 2
 s_nop 3
 s_add_u32 s80, s80, s3
 v_readlane_b32 s3, v2, 3
 s_nop 3
 s_add_u32 s80, s80, s3
 v_readlane_b32 s3, v2, 4
 s_nop 3
 s_add_u32 s80, s80, s3
 v_readlane_b32 s3, v2, 5
 s_nop 3
 s_add_u32 s80, s80, s3
 v_readlane_b32 s3, v2, 6
 s_nop 3
 s_add_u32 s80, s80, s3
 v_readlane_b32 s3, v2, 7
 s_nop 3
 s_add_u32 s80, s80, s3
 s_cmp_ge_u32 s80, 256
 s_cbranch_scc1 L_gld_141
 s_sleep 4
 s_add_u32 s51, s51, 1
 s_cmp_lt_u32 s51, 131072
 s_cbranch_scc1 L_gl_140
 s_branch L_bail
L_gld_141:
 s_xor_b32 s78, s81, 0
 s_lshl_b32 s78, s78, 13
 s_xor_b32 s79, s78, 8192
 s_and_b32 s52, s48, 1
 s_lshl_b32 s52, s52, 1
 s_add_u32 s52, s52, s49
 s_sub_u32 s52, s52, 30
 s_lshl_b32 s52, s52, 2
 s_add_u32 s52, s52, s50
 s_lshl_b32 s52, s52, 1
 v_lshlrev_b32 v1, 7, v0
 v_lshlrev_b32 v6, 8, v0
 s_add_u32 s54, s78, 32768
 s_cmp_lt_u32 s48, 2
 s_cselect_b32 s54, 16384, s54
 s_cselect_b32 s57, 0, 33554432
 s_cselect_b32 s56, 0, 8192
 s_lshl_b32 s3, s52, 8
 s_add_u32 s54, s54, s3
 v_add_u32 v3, s54, v6
 s_add_u32 s56, s56, s3
 s_add_u32 s56, s56, 0
 s_lshl_b32 s3, s52, 14
 s_add_u32 s57, s57, s3
 s_add_u32 s57, s57, 16777216
 s_mov_b32 s53, 0
 v_mov_b32 v4, 0
 v_mov_b32 v5, 0
 v_mov_b32 v7, 0
L_wm_loop:
 s_sub_i32 s55, s53, 2
 s_max_i32 s55, s55, 0
 v_cmp_gt_u32 vcc, s55, v7
 s_cbranch_vccz L_wg_142
 s_add_u32 s54, s56, 8
 s_mov_b32 s51, 0
 s_mov_b64 exec, 1
L_pl_144:
 buffer_load_dword v2, v4, s[4:7], s54 offen sc1
 s_waitcnt vmcnt(0)
 v_cmp_gt_u32 vcc, s55, v2
 s_cbranch_vccz L_pld_145
 s_sleep 2
 s_add_u32 s51, s51, 1
 s_cmp_lt_u32 s51, 131072
 s_cbranch_scc1 L_pl_144
 s_branch L_bail
L_pld_145:
 s_mov_b64 exec, -1
L_wg_142:
 s_lshl_b32 s54, s53, 2
 v_cmp_gt_u32 vcc, 12, v5
 s_and_b32 s3, vcc_lo, 3
 s_cbranch_scc0 L_wh_143
 s_mov_b32 s51, 0
 s_mov_b64 exec, 3
L_wc_146:
 v_mov_b32 v5, 0
 buffer_atomic_add v5, v3, s[4:7], s54 offen sc0
 s_waitcnt vmcnt(0)
 v_cmp_gt_u32 vcc, 12, v5
 s_cbranch_vccz L_wcd_147
 s_sleep 1
 s_add_u32 s51, s51, 1
 s_cmp_lt_u32 s51, 131072
 s_cbranch_scc1 L_wc_146
 s_branch L_bail
L_wcd_147:
 s_mov_b64 exec, -1
L_wh_143:
 s_lshl_b32 s58, s53, 19
 s_add_u32 s58, s58, s57
 s_add_u32 s3, s58, 0
 buffer_load_dword v8, v1, s[4:7], s3 offen sc1
 s_add_u32 s3, s58, 24576
 buffer_load_dword v9, v1, s[4:7], s3 offen sc1
 s_add_u32 s3, s58, 67108864
 buffer_load_dword v10, v1, s[4:7], s3 offen sc1
 s_add_u32 s3, s58, 67133440
 buffer_load_dword v11, v1, s[4:7], s3 offen sc1
 v_mov_b32 v5, 0
 s_mov_b64 exec, 3
 buffer_atomic_add v5, v3, s[4:7], s54 offen offset:4 sc0
 s_mov_b64 exec, -1
 buffer_load_dword v7, off, s[4:7], s56 offset:8 sc1
 s_add_u32 s55, s53, 1
 v_mov_b32 v2, s55
 s_waitcnt vmcnt(2)
 s_mov_b64 exec, 3
 s_cmp_lg_u32 s80, 0
 s_cbranch_scc1 L_lf_148
 buffer_store_dword v2, v6, s[4:7], s56 offen
 s_branch L_lf_149
L_lf_148:
 buffer_store_dword v2, v6, s[4:7], s56 offen sc1
L_lf_149:
 s_mov_b64 exec, -1
 s_waitcnt vmcnt(1)
 s_add_u32 s53, s53, 1
 s_cmp_lt_u32 s53, 64
 s_cbranch_scc1 L_wm_loop
 s_endpgm
L_wo:
 s_and_b32 s100, s64, 1
 s_lshl_b32 s100, s100, 13
 s_lshl_b32 s64, s64, 14
 s_add_u32 s64, s64, s100
 s_xor_b32 s64, s64, 8192
 s_and_b32 s100, s65, 1
 s_lshl_b32 s100, s100, 13
 s_lshl_b32 s65, s65, 14
 s_add_u32 s65, s65, s100
 s_xor_b32 s65, s65, 8192
 s_and_b32 s100, s66, 1
 s_lshl_b32 s100, s100, 13
 s_lshl_b32 s66, s66, 14
 s_add_u32 s66, s66, s100
 s_xor_b32 s66, s66, 8192
 s_and_b32 s100, s67, 1
 s_lshl_b32 s100, s100, 13
 s_lshl_b32 s67, s67, 14
 s_add_u32 s67, s67, s100
 s_xor_b32 s67, s67, 8192
 v_lshlrev_b32 v7, 4, v0
 s_lshl_b32 s3, s50, 3
 v_lshrrev_b32 v4, 4, v0
 v_add_u32 v4, s3, v4
 v_mul_u32_u24 v15, 272, v4
 v_mul_u32_u24 v4, 1280, v4
 v_and_b32 v3, 15, v0
 v_lshl_add_u32 v4, v3, 4, v4
 v_lshl_add_u32 v15, v3, 4, v15
 v_and_b32 v14, 31, v0
 v_mul_u32_u24 v14, 272, v14
 v_lshrrev_b32 v3, 5, v0
 v_lshl_add_u32 v14, v3, 3, v14
 s_lshl_b32 s3, s50, 6
 s_add_u32 s3, s3, 65536
 v_add_u32 v14, s3, v14
 v_add_u32 v15, 0x10000, v15
 s_lshl_b32 s3, s53, 8
 v_add_u32 v4, s3, v4
 s_mul_i32 s58, s52, 40960
 s_add_u32 s58, s58, 150994944
 s_mov_b32 s96, s44
 s_and_b32 s97, s45, 0xffff
 s_mov_b32 s98, 256
 s_mov_b32 s99, 0x00020000
 v_mov_b32 v12, 132
 s_mov_b32 s3, 144
 v_writelane_b32 v12, s3, 1
 s_mov_b32 s51, 0
 s_mov_b64 exec, 3
L_wb_150:
 buffer_load_dword v13, v12, s[96:99], 0 offen sc1
 s_waitcnt vmcnt(0)
 v_cmp_eq_u32 vcc, 0, v13
 s_cbranch_vccz L_wbd_151
 s_sleep 2
 s_add_u32 s51, s51, 1
 s_cmp_lt_u32 s51, 131072
 s_cbranch_scc1 L_wb_150
 s_branch L_bail
L_wbd_151:
 s_mov_b64 exec, -1
 v_readlane_b32 s81, v13, 1
 s_nop 3
 s_sub_u32 s81, s81, 1
 s_xor_b32 s78, s81, 0
 s_lshl_b32 s78, s78, 13
 s_xor_b32 s79, s78, 8192
 v_lshlrev_b32 v8, 9, v0
 v_and_b32 v3, 0xffffe000, v8
 v_add_u32 v8, v8, v3
 v_add_u32 v8, s78, v8
 s_mul_i32 s3, s52, 5
 s_add_u32 s3, s3, s53
 s_and_b32 s55, s3, 3
 s_mul_i32 s55, s55, 32768
 v_add_u32 v8, s55, v8
 s_lshl_b32 s3, s3, 9
 s_lshr_b32 s100, s3, 13
 s_lshl_b32 s100, s100, 13
 s_add_u32 s3, s3, s100
 s_add_u32 s3, s3, s79
 s_add_u32 s3, s3, 49152
 v_lshlrev_b32 v5, 8, v0
 v_add_u32 v5, s3, v5
 v_mov_b32 v6, 0
 v_and_b32 v10, 1, v0
 v_lshlrev_b32 v10, 2, v10
 v_add_u32 v10, 163776, v10
 s_lshl_b32 s56, s50, 11
 s_mov_b32 s54, 0
 s_mov_b32 s61, -1
 s_mov_b32 s63, 268435456
 s_mov_b32 s59, 0
 s_cmp_lg_u32 s50, 0
 s_cselect_b32 s68, 268435456, 0
 v_mov_b32 v2, s59
 v_writelane_b32 v2, s54, 0
 v_lshl_add_u32 v2, v2, 2, v5
 s_cmp_lt_u32 s54, 64
 s_cselect_b32 s3, 8, 0
 v_writelane_b32 v6, s3, 0
 s_cselect_b32 s3, 13, 0
 s_add_u32 s3, s3, s59
 s_cmp_ge_u32 s54, s3
 s_cselect_b32 s3, 8, 0
 v_writelane_b32 v6, s3, 1
 s_mov_b32 s72, 0
L_wo_block:
 s_cmp_lg_u32 s50, 0
 s_cbranch_scc1 L_w_152
 v_mov_b32 v13, 0
 s_mov_b32 s51, 0
 s_mov_b64 exec, 3
 v_mov_b32 v12, 0
 buffer_atomic_add v12, v2, s[4:7], 0 offen sc0
 s_sleep 5
L_wc_153:
 v_mov_b32 v13, 0
 buffer_atomic_add v13, v2, s[4:7], 0 offen sc0
 s_waitcnt vmcnt(1)
 v_cmp_gt_u32 vcc, v6, v12
 s_cbranch_vccz L_wcd_154
 v_mov_b32 v12, 0
 buffer_atomic_add v12, v2, s[4:7], 0 offen sc0
 s_waitcnt vmcnt(1)
 v_cmp_gt_u32 vcc, v6, v13
 s_cbranch_vccz L_wcd_154
 s_add_u32 s51, s51, 1
 s_cmp_lt_u32 s51, 131072
 s_cbranch_scc1 L_wc_153
 s_branch L_bail
L_wcd_154:
 s_mov_b64 exec, -1
 v_max_u32 v9, v12, v13
L_w_152:
 s_cmp_lg_u32 s50, 0
 s_cselect_b64 exec, 0, 3
 ds_write_b32 v10, v9 offset:8
 s_mov_b64 exec, -1
 s_waitcnt lgkmcnt(0)
 s_barrier
 ds_read_b32 v9, v10 offset:8
 s_waitcnt lgkmcnt(0)
L_wo_loop:
 s_cmp_lg_u32 s72, 0
 s_cbranch_scc1 L_wo_have
 s_lshl_b32 s3, s52, 16
 s_add_u32 s3, s3, s56
 s_add_u32 s3, s3, 83886080
 s_lshl_b32 s55, s54, 19
 s_add_u32 s55, s55, s3
 s_cmp_lt_u32 s54, 64
 s_cselect_b32 s55, s55, 268435456
 s_add_u32 m0, s56, 0
 s_add_u32 s3, s55, s64
 buffer_load_dwordx4 v7, s[4:7], s3 offen offset:0 sc1 lds
 s_add_u32 m0, s56, 0
 s_add_u32 s3, s55, s64
 buffer_load_dwordx4 v7, s[4:7], s3 offen offset:1024 sc1 lds
 s_add_u32 m0, s56, 8192
 s_add_u32 s3, s55, s65
 buffer_load_dwordx4 v7, s[4:7], s3 offen offset:0 sc1 lds
 s_add_u32 m0, s56, 8192
 s_add_u32 s3, s55, s65
 buffer_load_dwordx4 v7, s[4:7], s3 offen offset:1024 sc1 lds
 s_add_u32 m0, s56, 16384
 s_add_u32 s3, s55, s66
 buffer_load_dwordx4 v7, s[4:7], s3 offen offset:0 sc1 lds
 s_add_u32 m0, s56, 16384
 s_add_u32 s3, s55, s66
 buffer_load_dwordx4 v7, s[4:7], s3 offen offset:1024 sc1 lds
 s_add_u32 m0, s56, 24576
 s_add_u32 s3, s55, s67
 buffer_load_dwordx4 v7, s[4:7], s3 offen offset:0 sc1 lds
 s_add_u32 m0, s56, 24576
 s_add_u32 s3, s55, s67
 buffer_load_dwordx4 v7, s[4:7], s3 offen offset:1024 sc1 lds
L_wo_have:
 v_readlane_b32 s3, v9, 1
 s_nop 3
 s_cmp_ge_u32 s3, 8
 s_cselect_b32 s60, s59, -1
 s_addc_u32 s59, s59, 0
 s_mov_b32 s57, s54
 s_add_u32 s54, s54, 1
 s_lshl_b32 s3, s52, 16
 s_add_u32 s3, s3, s56
 s_add_u32 s3, s3, 117440512
 s_lshl_b32 s55, s60, 19
 s_add_u32 s55, s55, s3
 s_cmp_lt_u32 s60, 64
 s_cselect_b32 s55, s55, 268435456
 s_waitcnt vmcnt(6)
 s_barrier
 ds_read_b128 v[32:35], v7 offset:0
 ds_read_b128 v[36:39], v7 offset:1024
 ds_read_b128 v[40:43], v7 offset:2048
 ds_read_b128 v[44:47], v7 offset:3072
 s_waitcnt lgkmcnt(3)
 v_mfma_f32_32x32x16_bf16 v[64:79], a[0:3], v[32:35], 0
 ds_read_b128 v[48:51], v7 offset:4096
 s_add_u32 m0, s56, 32768
 s_add_u32 s3, s55, s64
 buffer_load_dwordx4 v7, s[4:7], s3 offen offset:0 sc1 lds
 s_waitcnt lgkmcnt(3)
 v_mfma_f32_32x32x16_bf16 v[64:79], a[4:7], v[36:39], v[64:79]
 ds_read_b128 v[52:55], v7 offset:5120
 s_waitcnt lgkmcnt(3)
 v_mfma_f32_32x32x16_bf16 v[64:79], a[8:11], v[40:43], v[64:79]
 ds_read_b128 v[56:59], v7 offset:6144
 s_add_u32 m0, s56, 32768
 s_add_u32 s3, s55, s64
 buffer_load_dwordx4 v7, s[4:7], s3 offen offset:1024 sc1 lds
 s_waitcnt lgkmcnt(3)
 v_mfma_f32_32x32x16_bf16 v[64:79], a[12:15], v[44:47], v[64:79]
 ds_read_b128 v[60:63], v7 offset:7168
 s_waitcnt lgkmcnt(3)
 v_mfma_f32_32x32x16_bf16 v[64:79], a[16:19], v[48:51], v[64:79]
 s_waitcnt vmcnt(6)
 s_barrier
 ds_read_b128 v[32:35], v7 offset:8192
 s_add_u32 m0, s56, 40960
 s_add_u32 s3, s55, s65
 buffer_load_dwordx4 v7, s[4:7], s3 offen offset:0 sc1 lds
 s_waitcnt lgkmcnt(3)
 v_mfma_f32_32x32x16_bf16 v[64:79], a[20:23], v[52:55], v[64:79]
 ds_read_b128 v[36:39], v7 offset:9216
 s_waitcnt lgkmcnt(3)
 v_mfma_f32_32x32x16_bf16 v[64:79], a[24:27], v[56:59], v[64:79]
 ds_read_b128 v[40:43], v7 offset:10240
 s_add_u32 m0, s56, 40960
 s_add_u32 s3, s55, s65
 buffer_load_dwordx4 v7, s[4:7], s3 offen offset:1024 sc1 lds
 s_waitcnt lgkmcnt(3)
 v_mfma_f32_32x32x16_bf16 v[64:79], a[28:31], v[60:63], v[64:79]
 ds_read_b128 v[44:47], v7 offset:11264
 s_waitcnt lgkmcnt(3)
 v_mfma_f32_32x32x16_bf16 v[64:79], a[32:35], v[32:35], v[64:79]
 ds_read_b128 v[48:51], v7 offset:12288
 s_add_u32 m0, s56, 49152
 s_add_u32 s3, s55, s66
 buffer_load_dwordx4 v7, s[4:7], s3 offen offset:0 sc1 lds
 s_waitcnt lgkmcnt(3)
 v_mfma_f32_32x32x16_bf16 v[64:79], a[36:39], v[36:39], v[64:79]
 ds_read_b128 v[52:55], v7 offset:13312
 s_waitcnt lgkmcnt(3)
 v_mfma_f32_32x32x16_bf16 v[64:79], a[40:43], v[40:43], v[64:79]
 ds_read_b128 v[56:59], v7 offset:14336
 s_add_u32 m0, s56, 49152
 s_add_u32 s3, s55, s66
 buffer_load_dwordx4 v7, s[4:7], s3 offen offset:1024 sc1 lds
 s_waitcnt lgkmcnt(3)
 v_mfma_f32_32x32x16_bf16 v[64:79], a[44:47], v[44:47], v[64:79]
 ds_read_b128 v[60:63], v7 offset:15360
 s_waitcnt lgkmcnt(3)
 v_mfma_f32_32x32x16_bf16 v[64:79], a[48:51], v[48:51], v[64:79]
 s_waitcnt vmcnt(8)
 s_barrier
 ds_read_b128 v[32:35], v7 offset:16384
 s_add_u32 m0, s56, 57344
 s_add_u32 s3, s55, s67
 buffer_load_dwordx4 v7, s[4:7], s3 offen offset:0 sc1 lds
 s_waitcnt lgkmcnt(3)
 v_mfma_f32_32x32x16_bf16 v[64:79], a[52:55], v[52:55], v[64:79]
 ds_read_b128 v[36:39], v7 offset:17408
 s_waitcnt lgkmcnt(3)
 v_mfma_f32_32x32x16_bf16 v[64:79], a[56:59], v[56:59], v[64:79]
 ds_read_b128 v[40:43], v7 offset:18432
 s_add_u32 m0, s56, 57344
 s_add_u32 s3, s55, s67
 buffer_load_dwordx4 v7, s[4:7], s3 offen offset:1024 sc1 lds
 v_mov_b32 v2, s59
 v_writelane_b32 v2, s54, 0
 v_lshl_add_u32 v2, v2, 2, v5
 s_cmp_lt_u32 s54, 64
 s_cselect_b32 s3, 8, 0
 v_writelane_b32 v6, s3, 0
 s_cselect_b32 s3, 13, 0
 s_add_u32 s3, s3, s59
 s_cmp_ge_u32 s54, s3
 s_cselect_b32 s3, 8, 0
 v_writelane_b32 v6, s3, 1
 v_mov_b32 v9, 0
 s_mov_b64 exec, 3
 buffer_atomic_add v9, v2, s[4:7], s68 offen sc0
 s_mov_b64 exec, -1
 s_waitcnt lgkmcnt(3)
 v_mfma_f32_32x32x16_bf16 v[64:79], a[60:63], v[60:63], v[64:79]
 ds_read_b128 v[44:47], v7 offset:19456
 s_waitcnt lgkmcnt(3)
 v_mfma_f32_32x32x16_bf16 v[64:79], a[64:67], v[32:35], v[64:79]
 ds_read_b128 v[48:51], v7 offset:20480
 s_add_u32 s3, s63, 0
 buffer_store_dwordx4 v[112:115], v4, s[4:7], s3 offen sc1
 s_waitcnt lgkmcnt(3)
 v_mfma_f32_32x32x16_bf16 v[64:79], a[68:71], v[36:39], v[64:79]
 ds_read_b128 v[52:55], v7 offset:21504
 s_waitcnt lgkmcnt(3)
 v_mfma_f32_32x32x16_bf16 v[64:79], a[72:75], v[40:43], v[64:79]
 ds_read_b128 v[56:59], v7 offset:22528
 s_waitcnt lgkmcnt(3)
 v_mfma_f32_32x32x16_bf16 v[64:79], a[76:79], v[44:47], v[64:79]
 ds_read_b128 v[60:63], v7 offset:23552
 s_waitcnt lgkmcnt(3)
 v_mfma_f32_32x32x16_bf16 v[64:79], a[80:83], v[48:51], v[64:79]
 s_waitcnt vmcnt(9)
 s_barrier
 ds_read_b128 v[32:35], v7 offset:24576
 s_add_u32 s3, s63, 5120
 buffer_store_dwordx4 v[116:119], v4, s[4:7], s3 offen sc1
 s_waitcnt lgkmcnt(3)
 v_mfma_f32_32x32x16_bf16 v[64:79], a[84:87], v[52:55], v[64:79]
 ds_read_b128 v[36:39], v7 offset:25600
 s_waitcnt lgkmcnt(3)
 v_mfma_f32_32x32x16_bf16 v[64:79], a[88:91], v[56:59], v[64:79]
 ds_read_b128 v[40:43], v7 offset:26624
 s_waitcnt lgkmcnt(3)
 v_mfma_f32_32x32x16_bf16 v[64:79], a[92:95], v[60:63], v[64:79]
 ds_read_b128 v[44:47], v7 offset:27648
 s_waitcnt lgkmcnt(3)
 v_mfma_f32_32x32x16_bf16 v[64:79], a[96:99], v[32:35], v[64:79]
 ds_read_b128 v[48:51], v7 offset:28672
 s_waitcnt lgkmcnt(3)
 v_mfma_f32_32x32x16_bf16 v[64:79], a[100:103], v[36:39], v[64:79]
 ds_read_b128 v[52:55], v7 offset:29696
 s_waitcnt lgkmcnt(3)
 v_mfma_f32_32x32x16_bf16 v[64:79], a[104:107], v[40:43], v[64:79]
 ds_read_b128 v[56:59], v7 offset:30720
 s_waitcnt lgkmcnt(3)
 v_mfma_f32_32x32x16_bf16 v[64:79], a[108:111], v[44:47], v[64:79]
 ds_read_b128 v[60:63], v7 offset:31744
 s_waitcnt lgkmcnt(3)
 v_mfma_f32_32x32x16_bf16 v[64:79], a[112:115], v[48:51], v[64:79]
 s_waitcnt lgkmcnt(2)
 v_mfma_f32_32x32x16_bf16 v[64:79], a[116:119], v[52:55], v[64:79]
 s_waitcnt lgkmcnt(1)
 v_mfma_f32_32x32x16_bf16 v[64:79], a[120:123], v[56:59], v[64:79]
 s_waitcnt lgkmcnt(0)
 v_mfma_f32_32x32x16_bf16 v[64:79], a[124:127], v[60:63], v[64:79]
 s_mul_i32 s62, s57, 327680
 s_add_u32 s62, s62, s58
 s_cmp_lt_u32 s57, 64
 s_cselect_b32 s62, s62, 268435456
 s_nop 8
 v_cvt_pk_bf16_f32 v64, v64, v65
 v_cvt_pk_bf16_f32 v65, v66, v67
 ds_write_b64 v14, v[64:65] offset:0
 v_cvt_pk_bf16_f32 v68, v68, v69
 v_cvt_pk_bf16_f32 v69, v70, v71
 ds_write_b64 v14, v[68:69] offset:16
 v_cvt_pk_bf16_f32 v72, v72, v73
 v_cvt_pk_bf16_f32 v73, v74, v75
 ds_write_b64 v14, v[72:73] offset:32
 v_cvt_pk_bf16_f32 v76, v76, v77
 v_cvt_pk_bf16_f32 v77, v78, v79
 ds_write_b64 v14, v[76:77] offset:48
 s_waitcnt vmcnt(2)
 s_cmp_lg_u32 s50, 0
 s_cselect_b64 exec, 0, 3
 ds_write_b32 v10, v9 offset:16
 s_mov_b64 exec, -1
 s_waitcnt lgkmcnt(0)
 s_barrier
 ds_read_b32 v9, v10 offset:16
 ds_read_b128 v[96:99], v15 offset:0
 ds_read_b128 v[100:103], v15 offset:1088
 ds_read_b128 v[32:35], v7 offset:32768
 ds_read_b128 v[36:39], v7 offset:33792
 ds_read_b128 v[40:43], v7 offset:34816
 ds_read_b128 v[44:47], v7 offset:35840
 s_waitcnt lgkmcnt(3)
 v_mfma_f32_32x32x16_bf16 v[80:95], a[0:3], v[32:35], 0
 ds_read_b128 v[48:51], v7 offset:36864
 s_add_u32 s3, s62, 0
 buffer_store_dwordx4 v[96:99], v4, s[4:7], s3 offen sc1
 s_waitcnt lgkmcnt(3)
 v_mfma_f32_32x32x16_bf16 v[80:95], a[4:7], v[36:39], v[80:95]
 ds_read_b128 v[52:55], v7 offset:37888
 v_cmp_gt_u32 vcc, v6, v9
 s_lshl_b32 s3, s52, 16
 s_add_u32 s3, s3, s56
 s_add_u32 s3, s3, 83886080
 s_lshl_b32 s55, s54, 19
 s_add_u32 s55, s55, s3
 s_cmp_lt_u32 s54, 64
 s_cselect_b32 s55, s55, 268435456
 s_cmp_eq_u64 vcc, 0
 s_cselect_b32 s72, 1, 0
 s_waitcnt lgkmcnt(3)
 v_mfma_f32_32x32x16_bf16 v[80:95], a[8:11], v[40:43], v[80:95]
 ds_read_b128 v[56:59], v7 offset:38912
 s_add_u32 s3, s62, 5120
 buffer_store_dwordx4 v[100:103], v4, s[4:7], s3 offen sc1
 s_cmp_eq_u32 s72, 0
 s_cbranch_scc1 L_pf_155
 s_add_u32 m0, s56, 0
 s_add_u32 s3, s55, s64
 buffer_load_dwordx4 v7, s[4:7], s3 offen offset:0 sc1 lds
L_pf_155:
 s_waitcnt lgkmcnt(3)
 v_mfma_f32_32x32x16_bf16 v[80:95], a[12:15], v[44:47], v[80:95]
 ds_read_b128 v[60:63], v7 offset:39936
 s_cmp_eq_u32 s72, 0
 s_cbranch_scc1 L_pf_156
 s_add_u32 m0, s56, 0
 s_add_u32 s3, s55, s64
 buffer_load_dwordx4 v7, s[4:7], s3 offen offset:1024 sc1 lds
L_pf_156:
 s_waitcnt lgkmcnt(3)
 v_mfma_f32_32x32x16_bf16 v[80:95], a[16:19], v[48:51], v[80:95]
 ds_read_b128 v[32:35], v7 offset:40960
 s_waitcnt lgkmcnt(3)
 v_mfma_f32_32x32x16_bf16 v[80:95], a[20:23], v[52:55], v[80:95]
 ds_read_b128 v[36:39], v7 offset:41984
 s_cmp_eq_u32 s72, 0
 s_cbranch_scc1 L_pf_157
 s_add_u32 m0, s56, 8192
 s_add_u32 s3, s55, s65
 buffer_load_dwordx4 v7, s[4:7], s3 offen offset:0 sc1 lds
L_pf_157:
 s_waitcnt lgkmcnt(3)
 v_mfma_f32_32x32x16_bf16 v[80:95], a[24:27], v[56:59], v[80:95]
 ds_read_b128 v[40:43], v7 offset:43008
 s_cmp_eq_u32 s72, 0
 s_cbranch_scc1 L_pf_158
 s_add_u32 m0, s56, 8192
 s_add_u32 s3, s55, s65
 buffer_load_dwordx4 v7, s[4:7], s3 offen offset:1024 sc1 lds
L_pf_158:
 s_waitcnt lgkmcnt(3)
 v_mfma_f32_32x32x16_bf16 v[80:95], a[28:31], v[60:63], v[80:95]
 ds_read_b128 v[44:47], v7 offset:44032
 s_waitcnt lgkmcnt(3)
 v_mfma_f32_32x32x16_bf16 v[80:95], a[32:35], v[32:35], v[80:95]
 ds_read_b128 v[48:51], v7 offset:45056
 s_cmp_eq_u32 s72, 0
 s_cbranch_scc1 L_pf_159
 s_add_u32 m0, s56, 16384
 s_add_u32 s3, s55, s66
 buffer_load_dwordx4 v7, s[4:7], s3 offen offset:0 sc1 lds
L_pf_159:
 s_waitcnt lgkmcnt(3)
 v_mfma_f32_32x32x16_bf16 v[80:95], a[36:39], v[36:39], v[80:95]
 ds_read_b128 v[52:55], v7 offset:46080
 s_cmp_eq_u32 s72, 0
 s_cbranch_scc1 L_pf_160
 s_add_u32 m0, s56, 16384
 s_add_u32 s3, s55, s66
 buffer_load_dwordx4 v7, s[4:7], s3 offen offset:1024 sc1 lds
L_pf_160:
 s_waitcnt lgkmcnt(3)
 v_mfma_f32_32x32x16_bf16 v[80:95], a[40:43], v[40:43], v[80:95]
 ds_read_b128 v[56:59], v7 offset:47104
 s_waitcnt lgkmcnt(3)
 v_mfma_f32_32x32x16_bf16 v[80:95], a[44:47], v[44:47], v[80:95]
 ds_read_b128 v[60:63], v7 offset:48128
 s_cmp_eq_u32 s72, 0
 s_cbranch_scc1 L_pf_161
 s_add_u32 m0, s56, 24576
 s_add_u32 s3, s55, s67
 buffer_load_dwordx4 v7, s[4:7], s3 offen offset:0 sc1 lds
L_pf_161:
 s_waitcnt lgkmcnt(3)
 v_mfma_f32_32x32x16_bf16 v[80:95], a[48:51], v[48:51], v[80:95]
 ds_read_b128 v[32:35], v7 offset:49152
 s_cmp_eq_u32 s72, 0
 s_cbranch_scc1 L_pf_162
 s_add_u32 m0, s56, 24576
 s_add_u32 s3, s55, s67
 buffer_load_dwordx4 v7, s[4:7], s3 offen offset:1024 sc1 lds
L_pf_162:
 s_waitcnt lgkmcnt(3)
 v_mfma_f32_32x32x16_bf16 v[80:95], a[52:55], v[52:55], v[80:95]
 ds_read_b128 v[36:39], v7 offset:50176
 v_mov_b32 v2, s59
 v_writelane_b32 v2, s54, 0
 v_lshl_add_u32 v2, v2, 2, v5
 s_cmp_lt_u32 s54, 64
 s_cselect_b32 s3, 8, 0
 v_writelane_b32 v6, s3, 0
 s_cselect_b32 s3, 13, 0
 s_add_u32 s3, s3, s59
 s_cmp_ge_u32 s54, s3
 s_cselect_b32 s3, 8, 0
 v_writelane_b32 v6, s3, 1
 v_mov_b32 v9, 0
 s_mov_b64 exec, 3
 buffer_atomic_add v9, v2, s[4:7], s68 offen sc0
 s_mov_b64 exec, -1
 s_waitcnt lgkmcnt(3)
 v_mfma_f32_32x32x16_bf16 v[80:95], a[56:59], v[56:59], v[80:95]
 ds_read_b128 v[40:43], v7 offset:51200
 s_waitcnt lgkmcnt(3)
 v_mfma_f32_32x32x16_bf16 v[80:95], a[60:63], v[60:63], v[80:95]
 ds_read_b128 v[44:47], v7 offset:52224
 s_waitcnt lgkmcnt(3)
 v_mfma_f32_32x32x16_bf16 v[80:95], a[64:67], v[32:35], v[80:95]
 ds_read_b128 v[48:51], v7 offset:53248
 s_waitcnt lgkmcnt(3)
 v_mfma_f32_32x32x16_bf16 v[80:95], a[68:71], v[36:39], v[80:95]
 ds_read_b128 v[52:55], v7 offset:54272
 s_waitcnt lgkmcnt(3)
 v_mfma_f32_32x32x16_bf16 v[80:95], a[72:75], v[40:43], v[80:95]
 ds_read_b128 v[56:59], v7 offset:55296
 s_waitcnt lgkmcnt(3)
 v_mfma_f32_32x32x16_bf16 v[80:95], a[76:79], v[44:47], v[80:95]
 ds_read_b128 v[60:63], v7 offset:56320
 s_waitcnt vmcnt(9)
 s_cmp_lg_u32 s72, 0
 s_cbranch_scc1 L_pf_163
 s_waitcnt vmcnt(1)
L_pf_163:
 s_barrier
 s_cmp_lg_u32 s50, 1
 s_cbranch_scc1 L_sg_164
 s_cmp_ge_u32 s57, 64
 s_cbranch_scc1 L_sg_164
 s_lshl_b32 s3, s57, 2
 s_add_u32 s3, s3, 98304
 v_mov_b32 v3, 1
 s_mov_b32 exec_hi, 0
 buffer_atomic_add v3, v8, s[4:7], s3 offen
 s_mov_b64 exec, -1
L_sg_164:
 s_waitcnt lgkmcnt(3)
 v_mfma_f32_32x32x16_bf16 v[80:95], a[80:83], v[48:51], v[80:95]
 ds_read_b128 v[32:35], v7 offset:57344
 s_waitcnt lgkmcnt(3)
 v_mfma_f32_32x32x16_bf16 v[80:95], a[84:87], v[52:55], v[80:95]
 ds_read_b128 v[36:39], v7 offset:58368
 s_waitcnt lgkmcnt(3)
 v_mfma_f32_32x32x16_bf16 v[80:95], a[88:91], v[56:59], v[80:95]
 ds_read_b128 v[40:43], v7 offset:59392
 s_waitcnt lgkmcnt(3)
 v_mfma_f32_32x32x16_bf16 v[80:95], a[92:95], v[60:63], v[80:95]
 ds_read_b128 v[44:47], v7 offset:60416
 s_waitcnt lgkmcnt(3)
 v_mfma_f32_32x32x16_bf16 v[80:95], a[96:99], v[32:35], v[80:95]
 ds_read_b128 v[48:51], v7 offset:61440
 s_waitcnt lgkmcnt(3)
 v_mfma_f32_32x32x16_bf16 v[80:95], a[100:103], v[36:39], v[80:95]
 ds_read_b128 v[52:55], v7 offset:62464
 s_waitcnt lgkmcnt(3)
 v_mfma_f32_32x32x16_bf16 v[80:95], a[104:107], v[40:43], v[80:95]
 ds_read_b128 v[56:59], v7 offset:63488
 s_waitcnt lgkmcnt(3)
 v_mfma_f32_32x32x16_bf16 v[80:95], a[108:111], v[44:47], v[80:95]
 ds_read_b128 v[60:63], v7 offset:64512
 s_waitcnt lgkmcnt(3)
 v_mfma_f32_32x32x16_bf16 v[80:95], a[112:115], v[48:51], v[80:95]
 s_waitcnt lgkmcnt(2)
 v_mfma_f32_32x32x16_bf16 v[80:95], a[116:119], v[52:55], v[80:95]
 s_waitcnt lgkmcnt(1)
 v_mfma_f32_32x32x16_bf16 v[80:95], a[120:123], v[56:59], v[80:95]
 s_waitcnt lgkmcnt(0)
 v_mfma_f32_32x32x16_bf16 v[80:95], a[124:127], v[60:63], v[80:95]
 s_mul_i32 s63, s60, 327680
 s_add_u32 s63, s63, s58
 s_add_u32 s63, s63, 20971520
 s_cmp_lt_u32 s60, 64
 s_cselect_b32 s63, s63, 268435456
 s_nop 8
 v_cvt_pk_bf16_f32 v80, v80, v81
 v_cvt_pk_bf16_f32 v81, v82, v83
 ds_write_b64 v14, v[80:81] offset:8704
 v_cvt_pk_bf16_f32 v84, v84, v85
 v_cvt_pk_bf16_f32 v85, v86, v87
 ds_write_b64 v14, v[84:85] offset:8720
 v_cvt_pk_bf16_f32 v88, v88, v89
 v_cvt_pk_bf16_f32 v89, v90, v91
 ds_write_b64 v14, v[88:89] offset:8736
 v_cvt_pk_bf16_f32 v92, v92, v93
 v_cvt_pk_bf16_f32 v93, v94, v95
 ds_write_b64 v14, v[92:93] offset:8752
 s_cmp_lg_u32 s50, 0
 s_cbranch_scc1 L_w0_165
 s_waitcnt vmcnt(0)
L_w0_165:
 s_cmp_lg_u32 s50, 0
 s_cselect_b64 exec, 0, 3
 ds_write_b32 v10, v9 offset:0
 s_mov_b64 exec, -1
 s_waitcnt lgkmcnt(0)
 s_barrier
 ds_read_b32 v9, v10 offset:0
 ds_read_b128 v[112:115], v15 offset:8704
 ds_read_b128 v[116:119], v15 offset:9792
 s_cmp_lg_u32 s50, 2
 s_cbranch_scc1 L_sg_166
 s_cmp_ge_u32 s61, 64
 s_cbranch_scc1 L_sg_166
 s_lshl_b32 s3, s61, 2
 s_add_u32 s3, s3, 98560
 v_mov_b32 v3, 1
 s_mov_b32 exec_hi, 0
 buffer_atomic_add v3, v8, s[4:7], s3 offen
 s_mov_b64 exec, -1
L_sg_166:
 s_mov_b32 s61, s60
 s_waitcnt lgkmcnt(0)
 v_cmp_gt_u32 vcc, v6, v9
 s_cmp_ge_u32 s54, 64
 s_cbranch_scc1 L_wo_tail
 s_cbranch_vccz L_wo_loop
 s_branch L_wo_block
L_wo_tail:
 s_add_u32 s3, s63, 0
 buffer_store_dwordx4 v[112:115], v4, s[4:7], s3 offen sc1
 s_add_u32 s3, s63, 5120
 buffer_store_dwordx4 v[116:119], v4, s[4:7], s3 offen sc1
 v_mov_b32 v2, s59
 v_writelane_b32 v2, s54, 0
 v_lshl_add_u32 v2, v2, 2, v5
 s_cmp_lt_u32 s54, 64
 s_cselect_b32 s3, 8, 0
 v_writelane_b32 v6, s3, 0
 s_cselect_b32 s3, 13, 0
 s_add_u32 s3, s3, s59
 s_cmp_ge_u32 s54, s3
 s_cselect_b32 s3, 8, 0
 v_writelane_b32 v6, s3, 1
 v_mov_b32 v9, 0
 s_mov_b64 exec, 3
 buffer_atomic_add v9, v2, s[4:7], s68 offen sc0
 s_mov_b64 exec, -1
 s_waitcnt vmcnt(1)
 s_barrier
 s_cmp_lg_u32 s50, 1
 s_cbranch_scc1 L_sg_167
 s_cmp_ge_u32 s61, 64
 s_cbranch_scc1 L_sg_167
 s_lshl_b32 s3, s61, 2
 s_add_u32 s3, s3, 98560
 v_mov_b32 v3, 1
 s_mov_b32 exec_hi, 0
 buffer_atomic_add v3, v8, s[4:7], s3 offen
 s_mov_b64 exec, -1
L_sg_167:
 s_cmp_ge_u32 s59, 64
 s_cbranch_scc1 L_bail
 s_cmp_lg_u32 s50, 0
 s_cbranch_scc1 L_w_168
 s_waitcnt vmcnt(0)
 v_cmp_gt_u32 vcc, v6, v9
 s_cbranch_vccz L_w_168
 v_mov_b32 v13, 0
 s_mov_b32 s51, 0
 s_mov_b64 exec, 3
 v_mov_b32 v12, 0
 buffer_atomic_add v12, v2, s[4:7], 0 offen sc0
 s_sleep 5
L_wc_169:
 v_mov_b32 v13, 0
 buffer_atomic_add v13, v2, s[4:7], 0 offen sc0
 s_waitcnt vmcnt(1)
 v_cmp_gt_u32 vcc, v6, v12
 s_cbranch_vccz L_wcd_170
 v_mov_b32 v12, 0
 buffer_atomic_add v12, v2, s[4:7], 0 offen sc0
 s_waitcnt vmcnt(1)
 v_cmp_gt_u32 vcc, v6, v13
 s_cbranch_vccz L_wcd_170
 s_add_u32 s51, s51, 1
 s_cmp_lt_u32 s51, 131072
 s_cbranch_scc1 L_wc_169
 s_branch L_bail
L_wcd_170:
 s_mov_b64 exec, -1
 v_max_u32 v9, v12, v13
L_w_168:
 s_barrier
 s_mov_b32 s61, s59
 s_add_u32 s59, s59, 1
 s_lshl_b32 s3, s52, 16
 s_add_u32 s3, s3, s56
 s_add_u32 s3, s3, 117440512
 s_lshl_b32 s55, s61, 19
 s_add_u32 s55, s55, s3
 s_cmp_lt_u32 s61, 64
 s_cselect_b32 s55, s55, 268435456
 s_add_u32 m0, s56, 32768
 s_add_u32 s3, s55, s64
 buffer_load_dwordx4 v7, s[4:7], s3 offen offset:0 sc1 lds
 s_add_u32 m0, s56, 32768
 s_add_u32 s3, s55, s64
 buffer_load_dwordx4 v7, s[4:7], s3 offen offset:1024 sc1 lds
 s_add_u32 m0, s56, 40960
 s_add_u32 s3, s55, s65
 buffer_load_dwordx4 v7, s[4:7], s3 offen offset:0 sc1 lds
 s_add_u32 m0, s56, 40960
 s_add_u32 s3, s55, s65
 buffer_load_dwordx4 v7, s[4:7], s3 offen offset:1024 sc1 lds
 s_add_u32 m0, s56, 49152
 s_add_u32 s3, s55, s66
 buffer_load_dwordx4 v7, s[4:7], s3 offen offset:0 sc1 lds
 s_add_u32 m0, s56, 49152
 s_add_u32 s3, s55, s66
 buffer_load_dwordx4 v7, s[4:7], s3 offen offset:1024 sc1 lds
 s_add_u32 m0, s56, 57344
 s_add_u32 s3, s55, s67
 buffer_load_dwordx4 v7, s[4:7], s3 offen offset:0 sc1 lds
 s_add_u32 m0, s56, 57344
 s_add_u32 s3, s55, s67
 buffer_load_dwordx4 v7, s[4:7], s3 offen offset:1024 sc1 lds
 s_waitcnt vmcnt(6)
 s_barrier
 ds_read_b128 v[32:35], v7 offset:32768
 ds_read_b128 v[36:39], v7 offset:33792
 ds_read_b128 v[40:43], v7 offset:34816
 ds_read_b128 v[44:47], v7 offset:35840
 s_waitcnt lgkmcnt(3)
 v_mfma_f32_32x32x16_bf16 v[80:95], a[0:3], v[32:35], 0
 ds_read_b128 v[48:51], v7 offset:36864
 s_waitcnt lgkmcnt(3)
 v_mfma_f32_32x32x16_bf16 v[80:95], a[4:7], v[36:39], v[80:95]
 ds_read_b128 v[52:55], v7 offset:37888
 s_waitcnt lgkmcnt(3)
 v_mfma_f32_32x32x16_bf16 v[80:95], a[8:11], v[40:43], v[80:95]
 ds_read_b128 v[56:59], v7 offset:38912
 s_waitcnt lgkmcnt(3)
 v_mfma_f32_32x32x16_bf16 v[80:95], a[12:15], v[44:47], v[80:95]
 ds_read_b128 v[60:63], v7 offset:39936
 s_waitcnt lgkmcnt(3)
 v_mfma_f32_32x32x16_bf16 v[80:95], a[16:19], v[48:51], v[80:95]
 s_waitcnt vmcnt(4)
 s_barrier
 ds_read_b128 v[32:35], v7 offset:40960
 s_waitcnt lgkmcnt(3)
 v_mfma_f32_32x32x16_bf16 v[80:95], a[20:23], v[52:55], v[80:95]
 ds_read_b128 v[36:39], v7 offset:41984
 s_waitcnt lgkmcnt(3)
 v_mfma_f32_32x32x16_bf16 v[80:95], a[24:27], v[56:59], v[80:95]
 ds_read_b128 v[40:43], v7 offset:43008
 s_waitcnt lgkmcnt(3)
 v_mfma_f32_32x32x16_bf16 v[80:95], a[28:31], v[60:63], v[80:95]
 ds_read_b128 v[44:47], v7 offset:44032
 s_waitcnt lgkmcnt(3)
 v_mfma_f32_32x32x16_bf16 v[80:95], a[32:35], v[32:35], v[80:95]
 ds_read_b128 v[48:51], v7 offset:45056
 s_waitcnt lgkmcnt(3)
 v_mfma_f32_32x32x16_bf16 v[80:95], a[36:39], v[36:39], v[80:95]
 ds_read_b128 v[52:55], v7 offset:46080
 s_waitcnt lgkmcnt(3)
 v_mfma_f32_32x32x16_bf16 v[80:95], a[40:43], v[40:43], v[80:95]
 ds_read_b128 v[56:59], v7 offset:47104
 s_waitcnt lgkmcnt(3)
 v_mfma_f32_32x32x16_bf16 v[80:95], a[44:47], v[44:47], v[80:95]
 ds_read_b128 v[60:63], v7 offset:48128
 s_waitcnt lgkmcnt(3)
 v_mfma_f32_32x32x16_bf16 v[80:95], a[48:51], v[48:51], v[80:95]
 s_waitcnt vmcnt(2)
 s_barrier
 ds_read_b128 v[32:35], v7 offset:49152
 s_waitcnt lgkmcnt(3)
 v_mfma_f32_32x32x16_bf16 v[80:95], a[52:55], v[52:55], v[80:95]
 ds_read_b128 v[36:39], v7 offset:50176
 s_waitcnt lgkmcnt(3)
 v_mfma_f32_32x32x16_bf16 v[80:95], a[56:59], v[56:59], v[80:95]
 ds_read_b128 v[40:43], v7 offset:51200
 s_waitcnt lgkmcnt(3)
 v_mfma_f32_32x32x16_bf16 v[80:95], a[60:63], v[60:63], v[80:95]
 ds_read_b128 v[44:47], v7 offset:52224
 s_waitcnt lgkmcnt(3)
 v_mfma_f32_32x32x16_bf16 v[80:95], a[64:67], v[32:35], v[80:95]
 ds_read_b128 v[48:51], v7 offset:53248
 s_waitcnt lgkmcnt(3)
 v_mfma_f32_32x32x16_bf16 v[80:95], a[68:71], v[36:39], v[80:95]
 ds_read_b128 v[52:55], v7 offset:54272
 s_waitcnt lgkmcnt(3)
 v_mfma_f32_32x32x16_bf16 v[80:95], a[72:75], v[40:43], v[80:95]
 ds_read_b128 v[56:59], v7 offset:55296
 s_waitcnt lgkmcnt(3)
 v_mfma_f32_32x32x16_bf16 v[80:95], a[76:79], v[44:47], v[80:95]
 ds_read_b128 v[60:63], v7 offset:56320
 s_waitcnt lgkmcnt(3)
 v_mfma_f32_32x32x16_bf16 v[80:95], a[80:83], v[48:51], v[80:95]
 s_waitcnt vmcnt(0)
 s_barrier
 ds_read_b128 v[32:35], v7 offset:57344
 s_waitcnt lgkmcnt(3)
 v_mfma_f32_32x32x16_bf16 v[80:95], a[84:87], v[52:55], v[80:95]
 ds_read_b128 v[36:39], v7 offset:58368
 s_waitcnt lgkmcnt(3)
 v_mfma_f32_32x32x16_bf16 v[80:95], a[88:91], v[56:59], v[80:95]
 ds_read_b128 v[40:43], v7 offset:59392
 s_waitcnt lgkmcnt(3)
 v_mfma_f32_32x32x16_bf16 v[80:95], a[92:95], v[60:63], v[80:95]
 ds_read_b128 v[44:47], v7 offset:60416
 s_waitcnt lgkmcnt(3)
 v_mfma_f32_32x32x16_bf16 v[80:95], a[96:99], v[32:35], v[80:95]
 ds_read_b128 v[48:51], v7 offset:61440
 s_waitcnt lgkmcnt(3)
 v_mfma_f32_32x32x16_bf16 v[80:95], a[100:103], v[36:39], v[80:95]
 ds_read_b128 v[52:55], v7 offset:62464
 s_waitcnt lgkmcnt(3)
 v_mfma_f32_32x32x16_bf16 v[80:95], a[104:107], v[40:43], v[80:95]
 ds_read_b128 v[56:59], v7 offset:63488
 s_waitcnt lgkmcnt(3)
 v_mfma_f32_32x32x16_bf16 v[80:95], a[108:111], v[44:47], v[80:95]
 ds_read_b128 v[60:63], v7 offset:64512
 s_waitcnt lgkmcnt(3)
 v_mfma_f32_32x32x16_bf16 v[80:95], a[112:115], v[48:51], v[80:95]
 s_waitcnt lgkmcnt(2)
 v_mfma_f32_32x32x16_bf16 v[80:95], a[116:119], v[52:55], v[80:95]
 s_waitcnt lgkmcnt(1)
 v_mfma_f32_32x32x16_bf16 v[80:95], a[120:123], v[56:59], v[80:95]
 s_waitcnt lgkmcnt(0)
 v_mfma_f32_32x32x16_bf16 v[80:95], a[124:127], v[60:63], v[80:95]
 s_mul_i32 s63, s61, 327680
 s_add_u32 s63, s63, s58
 s_add_u32 s63, s63, 20971520
 s_cmp_lt_u32 s61, 64
 s_cselect_b32 s63, s63, 268435456
 s_nop 8
 v_cvt_pk_bf16_f32 v80, v80, v81
 v_cvt_pk_bf16_f32 v81, v82, v83
 ds_write_b64 v14, v[80:81] offset:8704
 v_cvt_pk_bf16_f32 v84, v84, v85
 v_cvt_pk_bf16_f32 v85, v86, v87
 ds_write_b64 v14, v[84:85] offset:8720
 v_cvt_pk_bf16_f32 v88, v88, v89
 v_cvt_pk_bf16_f32 v89, v90, v91
 ds_write_b64 v14, v[88:89] offset:8736
 v_cvt_pk_bf16_f32 v92, v92, v93
 v_cvt_pk_bf16_f32 v93, v94, v95
 ds_write_b64 v14, v[92:93] offset:8752
 s_waitcnt lgkmcnt(0)
 s_barrier
 ds_read_b128 v[112:115], v15 offset:8704
 ds_read_b128 v[116:119], v15 offset:9792
 s_waitcnt lgkmcnt(0)
 s_branch L_wo_tail
L_t4:
 s_lshr_b32 s53, s50, 1
 s_and_b32 s61, s50, 1
 s_lshl_b32 s52, s52, 1
 s_add_u32 s52, s52, s61
 s_mov_b32 s54, 0
 v_lshlrev_b32 v1, 4, v0
 v_mov_b32 v72, 0
 s_lshl_b32 s3, s50, 2
 s_add_u32 s3, s3, 163776
 v_mov_b32 v73, s3
 ds_write_b32 v73, v72
 s_cmp_lg_u32 s50, 0
 s_cbranch_scc1 L_ww_171
 s_mov_b32 s96, s44
 s_and_b32 s97, s45, 0xffff
 s_mov_b32 s98, 256
 s_mov_b32 s99, 0x00020000
 v_mov_b32 v12, 136
 s_mov_b32 s51, 0
 s_mov_b64 exec, 1
L_wb_172:
 buffer_load_dword v13, v12, s[96:99], 0 offen sc1
 s_waitcnt vmcnt(0)
 v_cmp_eq_u32 vcc, 0, v13
 s_cbranch_vccz L_wbd_173
 s_sleep 2
 s_add_u32 s51, s51, 1
 s_cmp_lt_u32 s51, 131072
 s_cbranch_scc1 L_wb_172
 s_branch L_bail
L_wbd_173:
 s_mov_b64 exec, -1
L_ww_171:
 s_barrier
 s_mul_i32 s55, s52, 40960
 s_mul_i32 s56, s53, 20480
 s_add_u32 s55, s55, s56
 s_add_u32 s55, s55, 200802304
 s_mul_i32 s59, s61, 40960
 s_add_u32 s56, s56, s59
 v_and_b32 v36, 48, v0
 v_xor_b32 v36, v36, v1
 v_xor_b32 v37, 64, v36
 v_xor_b32 v38, 128, v36
 v_xor_b32 v39, 192, v36
 s_add_u32 m0, s56, 0
 s_add_u32 s3, s55, 0
 buffer_load_dwordx4 v36, s[4:7], s3 offen offset:0 sc1 lds
 buffer_load_dwordx4 v37, s[4:7], s3 offen offset:1024 sc1 lds
 buffer_load_dwordx4 v38, s[4:7], s3 offen offset:2048 sc1 lds
 buffer_load_dwordx4 v39, s[4:7], s3 offen offset:3072 sc1 lds
 s_add_u32 m0, s56, 4096
 s_add_u32 s3, s55, 4096
 buffer_load_dwordx4 v36, s[4:7], s3 offen offset:0 sc1 lds
 buffer_load_dwordx4 v37, s[4:7], s3 offen offset:1024 sc1 lds
 buffer_load_dwordx4 v38, s[4:7], s3 offen offset:2048 sc1 lds
 buffer_load_dwordx4 v39, s[4:7], s3 offen offset:3072 sc1 lds
 s_add_u32 m0, s56, 8192
 s_add_u32 s3, s55, 8192
 buffer_load_dwordx4 v36, s[4:7], s3 offen offset:0 sc1 lds
 buffer_load_dwordx4 v37, s[4:7], s3 offen offset:1024 sc1 lds
 buffer_load_dwordx4 v38, s[4:7], s3 offen offset:2048 sc1 lds
 buffer_load_dwordx4 v39, s[4:7], s3 offen offset:3072 sc1 lds
 s_add_u32 m0, s56, 12288
 s_add_u32 s3, s55, 12288
 buffer_load_dwordx4 v36, s[4:7], s3 offen offset:0 sc1 lds
 buffer_load_dwordx4 v37, s[4:7], s3 offen offset:1024 sc1 lds
 buffer_load_dwordx4 v38, s[4:7], s3 offen offset:2048 sc1 lds
 buffer_load_dwordx4 v39, s[4:7], s3 offen offset:3072 sc1 lds
 s_add_u32 m0, s56, 16384
 s_add_u32 s3, s55, 16384
 buffer_load_dwordx4 v36, s[4:7], s3 offen offset:0 sc1 lds
 buffer_load_dwordx4 v37, s[4:7], s3 offen offset:1024 sc1 lds
 buffer_load_dwordx4 v38, s[4:7], s3 offen offset:2048 sc1 lds
 buffer_load_dwordx4 v39, s[4:7], s3 offen offset:3072 sc1 lds
 s_waitcnt vmcnt(0) lgkmcnt(0)
 s_barrier
 s_cmp_eq_u32 s53, 0
 s_cbranch_scc1 L_e0_174
 s_mul_i32 s71, s61, 13312
 s_add_u32 s71, s71, 131072
 s_add_u32 s70, s52, 384
 s_mov_b32 s69, 32
 s_mov_b32 s96, s44
 s_and_b32 s97, s45, 0xffff
 s_mov_b32 s98, 256
 s_mov_b32 s99, 0x00020000
 v_mov_b32 v1, 208
 s_mov_b32 s51, 0
 s_mov_b64 exec, 1
L_wb_175:
 buffer_load_dword v2, v1, s[96:99], 0 offen sc1
 s_waitcnt vmcnt(0)
 v_cmp_eq_u32 vcc, 0, v2
 s_cbranch_vccz L_wbd_176
 s_sleep 2
 s_add_u32 s51, s51, 1
 s_cmp_lt_u32 s51, 131072
 s_cbranch_scc1 L_wb_175
 s_branch L_bail
L_wbd_176:
 s_mov_b64 exec, -1
 s_mov_b32 s8, s38
 s_and_b32 s9, s39, 0xffff
 s_mov_b32 s10, 2621440
 s_mov_b32 s11, 0x00020000
 s_mov_b32 s12, s40
 s_and_b32 s13, s41, 0xffff
 s_mov_b32 s14, 1280
 s_mov_b32 s15, 0x00020000
 v_lshlrev_b32 v130, 4, v0
 s_lshl_b32 s73, s70, 12
 s_add_u32 s74, s73, 2
 buffer_load_dwordx4 v[96:99], v130, s[8:11], s73 offen offset:0
 buffer_load_dwordx4 v[100:103], v130, s[8:11], s73 offen offset:1024
 buffer_load_dwordx4 v[104:107], v130, s[8:11], s73 offen offset:2048
 buffer_load_dwordx4 v[108:111], v130, s[8:11], s73 offen offset:3072
 buffer_load_dwordx4 v[112:115], v130, s[8:11], s74 offen offset:0
 buffer_load_dwordx4 v[116:119], v130, s[8:11], s74 offen offset:1024
 buffer_load_dwordx4 v[120:123], v130, s[8:11], s74 offen offset:2048
 buffer_load_dwordx4 v[124:127], v130, s[8:11], s74 offen offset:3072
 s_lshl_b32 s3, s70, 1
 buffer_load_ushort v128, off, s[12:15], s3
 s_lshl_b32 s3, s70, 12
 s_add_u32 s3, s3, 198180864
 buffer_load_dwordx4 v[240:243], v130, s[4:7], s3 offen offset:0 sc1
 buffer_load_dwordx4 v[244:247], v130, s[4:7], s3 offen offset:1024 sc1
 buffer_load_dwordx4 v[248:251], v130, s[4:7], s3 offen offset:2048 sc1
 buffer_load_dwordx4 v[252:255], v130, s[4:7], s3 offen offset:3072 sc1
 s_getpc_b64 s[76:77]
L_ca_177:
 s_add_u32 s76, s76, L_conv1-L_ca_177
 s_addc_u32 s77, s77, -1
 s_swappc_b64 s[76:77], s[76:77]
 s_waitcnt vmcnt(0)
 s_mov_b32 s96, s44
 s_and_b32 s97, s45, 0xffff
 s_mov_b32 s98, 256
 s_mov_b32 s99, 0x00020000
 v_mov_b32 v1, 1
 s_mov_b64 exec, 1
 buffer_atomic_add v1, off, s[96:99], 0 offset:76 sc0
 s_waitcnt vmcnt(0)
 v_cmp_eq_u32 vcc, 127, v1
 s_cbranch_vccz L_aw_178
 buffer_store_dword v1, off, s[96:99], 0 offset:204 sc1
L_aw_178:
 s_mov_b64 exec, -1
 s_mov_b32 s96, s44
 s_and_b32 s97, s45, 0xffff
 s_mov_b32 s98, 256
 s_mov_b32 s99, 0x00020000
 v_mov_b32 v1, 204
 s_mov_b32 s51, 0
 s_mov_b64 exec, 1
L_wb_179:
 buffer_load_dword v2, v1, s[96:99], 0 offen sc1
 s_waitcnt vmcnt(0)
 v_cmp_eq_u32 vcc, 0, v2
 s_cbranch_vccz L_wbd_180
 s_sleep 16
 s_add_u32 s51, s51, 1
 s_cmp_lt_u32 s51, 131072
 s_cbranch_scc1 L_wb_179
 s_branch L_bail
L_wbd_180:
 s_mov_b64 exec, -1
 v_lshlrev_b32 v1, 4, v0
 v_and_b32 v36, 48, v0
 v_xor_b32 v36, v36, v1
 v_xor_b32 v37, 64, v36
 v_xor_b32 v38, 128, v36
 v_xor_b32 v39, 192, v36
 s_add_u32 s3, s55, 1290240
 buffer_load_dwordx4 a[0:3], v36, s[4:7], s3 offen offset:0 sc1
 buffer_load_dwordx4 a[4:7], v37, s[4:7], s3 offen offset:1024 sc1
 buffer_load_dwordx4 a[8:11], v38, s[4:7], s3 offen offset:2048 sc1
 buffer_load_dwordx4 a[12:15], v39, s[4:7], s3 offen offset:3072 sc1
 s_add_u32 s3, s55, 1294336
 buffer_load_dwordx4 a[16:19], v36, s[4:7], s3 offen offset:0 sc1
 buffer_load_dwordx4 a[20:23], v37, s[4:7], s3 offen offset:1024 sc1
 buffer_load_dwordx4 a[24:27], v38, s[4:7], s3 offen offset:2048 sc1
 buffer_load_dwordx4 a[28:31], v39, s[4:7], s3 offen offset:3072 sc1
 s_add_u32 s3, s55, 1298432
 buffer_load_dwordx4 a[32:35], v36, s[4:7], s3 offen offset:0 sc1
 buffer_load_dwordx4 a[36:39], v37, s[4:7], s3 offen offset:1024 sc1
 buffer_load_dwordx4 a[40:43], v38, s[4:7], s3 offen offset:2048 sc1
 buffer_load_dwordx4 a[44:47], v39, s[4:7], s3 offen offset:3072 sc1
 s_add_u32 s3, s55, 1302528
 buffer_load_dwordx4 a[48:51], v36, s[4:7], s3 offen offset:0 sc1
 buffer_load_dwordx4 a[52:55], v37, s[4:7], s3 offen offset:1024 sc1
 buffer_load_dwordx4 a[56:59], v38, s[4:7], s3 offen offset:2048 sc1
 buffer_load_dwordx4 a[60:63], v39, s[4:7], s3 offen offset:3072 sc1
 s_add_u32 s3, s55, 1306624
 buffer_load_dwordx4 a[64:67], v36, s[4:7], s3 offen offset:0 sc1
 buffer_load_dwordx4 a[68:71], v37, s[4:7], s3 offen offset:1024 sc1
 buffer_load_dwordx4 a[72:75], v38, s[4:7], s3 offen offset:2048 sc1
 buffer_load_dwordx4 a[76:79], v39, s[4:7], s3 offen offset:3072 sc1
 s_add_u32 s3, s55, 1310720
 buffer_load_dwordx4 a[80:83], v36, s[4:7], s3 offen offset:0 sc1
 buffer_load_dwordx4 a[84:87], v37, s[4:7], s3 offen offset:1024 sc1
 buffer_load_dwordx4 a[88:91], v38, s[4:7], s3 offen offset:2048 sc1
 buffer_load_dwordx4 a[92:95], v39, s[4:7], s3 offen offset:3072 sc1
 s_add_u32 s3, s55, 1314816
 buffer_load_dwordx4 a[96:99], v36, s[4:7], s3 offen offset:0 sc1
 buffer_load_dwordx4 a[100:103], v37, s[4:7], s3 offen offset:1024 sc1
 buffer_load_dwordx4 a[104:107], v38, s[4:7], s3 offen offset:2048 sc1
 buffer_load_dwordx4 a[108:111], v39, s[4:7], s3 offen offset:3072 sc1
 s_add_u32 s3, s55, 1318912
 buffer_load_dwordx4 a[112:115], v36, s[4:7], s3 offen offset:0 sc1
 buffer_load_dwordx4 a[116:119], v37, s[4:7], s3 offen offset:1024 sc1
 buffer_load_dwordx4 a[120:123], v38, s[4:7], s3 offen offset:2048 sc1
 buffer_load_dwordx4 a[124:127], v39, s[4:7], s3 offen offset:3072 sc1
 s_add_u32 s3, s55, 1323008
 buffer_load_dwordx4 a[128:131], v36, s[4:7], s3 offen offset:0 sc1
 buffer_load_dwordx4 a[132:135], v37, s[4:7], s3 offen offset:1024 sc1
 buffer_load_dwordx4 a[136:139], v38, s[4:7], s3 offen offset:2048 sc1
 buffer_load_dwordx4 a[140:143], v39, s[4:7], s3 offen offset:3072 sc1
 s_add_u32 s3, s55, 1327104
 buffer_load_dwordx4 a[144:147], v36, s[4:7], s3 offen offset:0 sc1
 buffer_load_dwordx4 a[148:151], v37, s[4:7], s3 offen offset:1024 sc1
 buffer_load_dwordx4 a[152:155], v38, s[4:7], s3 offen offset:2048 sc1
 buffer_load_dwordx4 a[156:159], v39, s[4:7], s3 offen offset:3072 sc1
 s_waitcnt vmcnt(0)
L_e0_174:
 v_add_u32 v74, s59, v1
 v_and_b32 v72, 0xf0, v1
 v_lshl_add_u32 v72, v0, 8, v72
 v_add_u32 v72, s59, v72
 s_lshl_b32 s3, s61, 2
 s_add_u32 s3, s3, 163776
 v_mov_b32 v73, s3
 s_mov_b32 s8, s16
 s_and_b32 s9, s17, 0xffff
 s_mov_b32 s10, 2621440
 s_mov_b32 s11, 0x00020000
 s_mov_b32 s12, s42
 s_and_b32 s13, s43, 0xffff
 s_mov_b32 s14, 2621440
 s_mov_b32 s15, 0x00020000
 v_lshlrev_b32 v1, 4, v0
 v_lshlrev_b32 v2, 3, v0
 v_cmp_lt_u32 vcc, 31, v0
 v_mov_b32 v3, 268435456
 s_nop 1
 v_cndmask_b32 v6, v1, v3, vcc
 v_cndmask_b32 v7, v2, v3, vcc
 s_and_b32 s3, s52, 15
 v_lshrrev_b32 v4, 3, v0
 v_lshlrev_b32 v4, 2, v4
 v_and_b32 v10, 3, v0
 v_add_u32 v4, v4, v10
 v_xor_b32 v4, s3, v4
 v_lshlrev_b32 v4, 4, v4
 v_and_b32 v10, 4, v0
 v_lshl_add_u32 v4, v10, 1, v4
 v_cndmask_b32 v8, v4, v3, vcc
 s_mov_b32 s96, s44
 s_and_b32 s97, s45, 0xffff
 s_mov_b32 s98, 256
 s_mov_b32 s99, 0x00020000
 v_mov_b32 v12, 132
 s_mov_b32 s3, 144
 v_writelane_b32 v12, s3, 1
 s_mov_b32 s51, 0
 s_mov_b64 exec, 3
L_wb_181:
 buffer_load_dword v13, v12, s[96:99], 0 offen sc1
 s_waitcnt vmcnt(0)
 v_cmp_eq_u32 vcc, 0, v13
 s_cbranch_vccz L_wbd_182
 s_sleep 2
 s_add_u32 s51, s51, 1
 s_cmp_lt_u32 s51, 131072
 s_cbranch_scc1 L_wb_181
 s_branch L_bail
L_wbd_182:
 s_mov_b64 exec, -1
 v_readlane_b32 s81, v13, 1
 s_nop 3
 s_sub_u32 s81, s81, 1
 s_xor_b32 s78, s81, 0
 s_lshl_b32 s78, s78, 13
 s_xor_b32 s79, s78, 8192
 s_lshl_b32 s3, s52, 9
 s_lshr_b32 s100, s3, 13
 s_lshl_b32 s100, s100, 13
 s_add_u32 s3, s3, s100
 s_lshl_b32 s55, s53, 8
 s_add_u32 s3, s3, s55
 s_add_u32 s3, s3, s78
 s_add_u32 s3, s3, 98304
 v_mul_u32_u24 v5, 32768, v0
 v_add_u32 v5, s3, v5
 v_lshlrev_b32 v68, 8, v0
 v_and_b32 v10, 0xffffe000, v68
 v_add_u32 v68, v68, v10
 v_add_u32 v69, s79, v68
 v_add_u32 v68, s79, v68
 v_cmp_lt_u32 vcc, 55, v0
 s_nop 1
 v_cndmask_b32 v68, v68, v69, vcc
 s_mov_b32 s57, 0x3acccccd
 s_mov_b32 s58, 0x3727c5ac
 s_mov_b32 s62, 0x3f80
 s_mov_b32 s63, 0x3f800000
 v_mov_b32 v24, 0
 v_mov_b32 v25, 0
 v_mov_b32 v26, 0
 v_mov_b32 v27, 0
 v_mov_b32 v28, 0
 v_mov_b32 v29, 0
 v_mov_b32 v30, 0
 v_mov_b32 v31, 0
 v_mov_b32 v32, 0
 v_mov_b32 v33, 0
 v_mov_b32 v34, 0
 v_mov_b32 v35, 0
 s_mul_i32 s60, s52, 1280
 s_add_u32 s3, s60, 0
 s_cmp_eq_u32 s53, 0
 s_cselect_b32 s3, s3, 268435456
 buffer_load_dwordx2 v[176:177], v2, s[8:11], s3 offen offset:0
 buffer_load_dwordx2 v[178:179], v2, s[8:11], s3 offen offset:512
 buffer_load_dwordx2 v[180:181], v7, s[8:11], s3 offen offset:1024
 s_lshl_b32 s55, s54, 2
 v_mov_b32 v75, 0
 s_mov_b64 exec, 15
 buffer_atomic_add v75, v5, s[4:7], s55 offen offset:0 sc0
 s_mov_b64 exec, -1
 s_waitcnt vmcnt(0)
L_t4_loop:
 s_mov_b32 s51, 0
L_tw_183:
 v_cmp_gt_u32 vcc, 10, v75
 s_and_b32 s3, vcc_lo, 15
 s_cbranch_scc0 L_twd_184
 s_sleep 2
 s_lshl_b32 s55, s54, 2
 v_mov_b32 v75, 0
 s_mov_b64 exec, 15
 buffer_atomic_add v75, v5, s[4:7], s55 offen offset:0 sc0
 s_mov_b64 exec, -1
 s_waitcnt vmcnt(0)
 s_add_u32 s51, s51, 1
 s_cmp_lt_u32 s51, 131072
 s_cbranch_scc1 L_tw_183
 s_branch L_bail
L_twd_184:
 s_lshl_b32 s55, s53, 6
 s_add_u32 s55, s55, s54
 s_mul_i32 s55, s55, 327680
 s_mul_i32 s3, s52, 1280
 s_add_u32 s55, s55, s3
 s_add_u32 s55, s55, 150994944
 buffer_load_dwordx2 v[92:93], v2, s[4:7], s55 offen offset:0 sc1 nt
 buffer_load_dwordx2 v[94:95], v2, s[4:7], s55 offen offset:512 sc1 nt
 buffer_load_dwordx2 v[96:97], v7, s[4:7], s55 offen offset:1024 sc1 nt
 s_add_u32 s55, s55, 40960
 buffer_load_dwordx2 v[98:99], v2, s[4:7], s55 offen offset:0 sc1 nt
 buffer_load_dwordx2 v[100:101], v2, s[4:7], s55 offen offset:512 sc1 nt
 buffer_load_dwordx2 v[102:103], v7, s[4:7], s55 offen offset:1024 sc1 nt
 s_add_u32 s55, s55, 40960
 buffer_load_dwordx2 v[104:105], v2, s[4:7], s55 offen offset:0 sc1 nt
 buffer_load_dwordx2 v[106:107], v2, s[4:7], s55 offen offset:512 sc1 nt
 buffer_load_dwordx2 v[108:109], v7, s[4:7], s55 offen offset:1024 sc1 nt
 s_add_u32 s55, s55, 40960
 buffer_load_dwordx2 v[110:111], v2, s[4:7], s55 offen offset:0 sc1 nt
 buffer_load_dwordx2 v[112:113], v2, s[4:7], s55 offen offset:512 sc1 nt
 buffer_load_dwordx2 v[114:115], v7, s[4:7], s55 offen offset:1024 sc1 nt
 s_add_u32 s55, s55, 40960
 buffer_load_dwordx2 v[116:117], v2, s[4:7], s55 offen offset:0 sc1 nt
 buffer_load_dwordx2 v[118:119], v2, s[4:7], s55 offen offset:512 sc1 nt
 buffer_load_dwordx2 v[120:121], v7, s[4:7], s55 offen offset:1024 sc1 nt
 s_add_u32 s55, s55, 40960
 buffer_load_dwordx2 v[122:123], v2, s[4:7], s55 offen offset:0 sc1 nt
 buffer_load_dwordx2 v[124:125], v2, s[4:7], s55 offen offset:512 sc1 nt
 buffer_load_dwordx2 v[126:127], v7, s[4:7], s55 offen offset:1024 sc1 nt
 s_add_u32 s55, s55, 40960
 buffer_load_dwordx2 v[128:129], v2, s[4:7], s55 offen offset:0 sc1 nt
 buffer_load_dwordx2 v[130:131], v2, s[4:7], s55 offen offset:512 sc1 nt
 buffer_load_dwordx2 v[132:133], v7, s[4:7], s55 offen offset:1024 sc1 nt
 s_add_u32 s55, s55, 40960
 buffer_load_dwordx2 v[134:135], v2, s[4:7], s55 offen offset:0 sc1 nt
 buffer_load_dwordx2 v[136:137], v2, s[4:7], s55 offen offset:512 sc1 nt
 buffer_load_dwordx2 v[138:139], v7, s[4:7], s55 offen offset:1024 sc1 nt
 s_add_u32 s55, s55, 40960
 s_and_b32 s3, s54, 39
 s_cmp_lg_u32 s3, 32
 s_cbranch_scc1 L_yhd_186
 s_bfe_u32 s55, s54, 0x20003
 s_mov_b32 s51, 0
L_yh_185:
 ds_read_b32 v36, v73 offset:8
 s_waitcnt lgkmcnt(0)
 v_cmp_ge_u32 vcc, s55, v36
 s_cbranch_vccz L_yhd_186
 s_sleep 8
 s_add_u32 s51, s51, 1
 s_cmp_lt_u32 s51, 131072
 s_cbranch_scc1 L_yh_185
 s_branch L_bail
L_yhd_186:
 s_and_b32 s3, s54, 7
 s_lshl_b32 s3, s3, 3
 s_bfe_u32 s55, s54, 0x20003
 s_lshl_b32 s55, s55, 1
 s_add_u32 s3, s3, s55
 v_xor_b32 v36, s3, v72
 v_xor_b32 v37, 64, v36
 v_xor_b32 v38, 128, v36
 v_xor_b32 v39, 192, v36
 ds_read_u16_d16_hi v24, v36 offset:0
 ds_read_u16_d16_hi v25, v37 offset:0
 ds_read_u16_d16_hi v26, v38 offset:0
 ds_read_u16_d16_hi v27, v39 offset:0
 ds_read_u16_d16_hi v28, v36 offset:16384
 ds_read_u16_d16_hi v29, v37 offset:16384
 ds_read_u16_d16_hi v30, v38 offset:16384
 ds_read_u16_d16_hi v31, v39 offset:16384
 s_mov_b32 exec_hi, 0
 ds_read_u16_d16_hi v32, v36 offset:32768
 ds_read_u16_d16_hi v33, v37 offset:32768
 ds_read_u16_d16_hi v34, v38 offset:32768
 ds_read_u16_d16_hi v35, v39 offset:32768
 s_mov_b32 exec_hi, -1
 v_lshlrev_b32 v12, 16, v176
 v_and_b32 v13, 0xffff0000, v176
 v_lshlrev_b32 v14, 16, v177
 v_and_b32 v15, 0xffff0000, v177
 v_lshlrev_b32 v16, 16, v178
 v_and_b32 v17, 0xffff0000, v178
 v_lshlrev_b32 v18, 16, v179
 v_and_b32 v19, 0xffff0000, v179
 v_lshlrev_b32 v20, 16, v180
 v_and_b32 v21, 0xffff0000, v180
 v_lshlrev_b32 v22, 16, v181
 v_and_b32 v23, 0xffff0000, v181
 s_add_u32 s3, s60, 40960
 s_cmp_eq_u32 s53, 0
 s_cselect_b32 s3, s3, 268435456
 buffer_load_dwordx2 v[176:177], v2, s[8:11], s3 offen offset:0
 buffer_load_dwordx2 v[178:179], v2, s[8:11], s3 offen offset:512
 buffer_load_dwordx2 v[180:181], v7, s[8:11], s3 offen offset:1024
 s_and_b32 s56, s54, 15
 s_lshl_b32 s3, s61, 4
 s_add_u32 s56, s56, s3
 s_mul_i32 s56, s56, 1536
 s_add_u32 s56, s56, 81920
 v_add_u32 v3, s56, v2
 s_cmp_eq_u32 s53, 0
 s_cbranch_scc1 L_l0_187
 ds_read_b64 v[48:49], v3 offset:0
 ds_read_b64 v[50:51], v3 offset:512
 ds_read_b64 v[52:53], v3 offset:1024
 s_waitcnt lgkmcnt(0)
 v_lshlrev_b32 v12, 16, v48
 v_and_b32 v13, 0xffff0000, v48
 v_lshlrev_b32 v14, 16, v49
 v_and_b32 v15, 0xffff0000, v49
 v_lshlrev_b32 v16, 16, v50
 v_and_b32 v17, 0xffff0000, v50
 v_lshlrev_b32 v18, 16, v51
 v_and_b32 v19, 0xffff0000, v51
 v_lshlrev_b32 v20, 16, v52
 v_and_b32 v21, 0xffff0000, v52
 v_lshlrev_b32 v22, 16, v53
 v_and_b32 v23, 0xffff0000, v53
 s_add_u32 s3, s54, 1
 v_mov_b32 v10, s3
 ds_write_b32 v73, v10
L_l0_187:
 s_waitcnt vmcnt(24)
 v_lshlrev_b32 v80, 16, v92
 v_and_b32 v81, 0xffff0000, v92
 v_lshlrev_b32 v82, 16, v93
 v_and_b32 v83, 0xffff0000, v93
 v_lshlrev_b32 v84, 16, v94
 v_and_b32 v85, 0xffff0000, v94
 v_lshlrev_b32 v86, 16, v95
 v_and_b32 v87, 0xffff0000, v95
 v_lshlrev_b32 v88, 16, v96
 v_and_b32 v89, 0xffff0000, v96
 v_lshlrev_b32 v90, 16, v97
 v_and_b32 v91, 0xffff0000, v97
 s_waitcnt vmcnt(21)
 v_dot2c_f32_bf16 v80, s62, v98
 v_dot2c_f32_bf16 v81, s63, v98
 v_dot2c_f32_bf16 v82, s62, v99
 v_dot2c_f32_bf16 v83, s63, v99
 v_dot2c_f32_bf16 v84, s62, v100
 v_dot2c_f32_bf16 v85, s63, v100
 v_dot2c_f32_bf16 v86, s62, v101
 v_dot2c_f32_bf16 v87, s63, v101
 v_dot2c_f32_bf16 v88, s62, v102
 v_dot2c_f32_bf16 v89, s63, v102
 v_dot2c_f32_bf16 v90, s62, v103
 v_dot2c_f32_bf16 v91, s63, v103
 s_waitcnt vmcnt(18)
 v_dot2c_f32_bf16 v80, s62, v104
 v_dot2c_f32_bf16 v81, s63, v104
 v_dot2c_f32_bf16 v82, s62, v105
 v_dot2c_f32_bf16 v83, s63, v105
 v_dot2c_f32_bf16 v84, s62, v106
 v_dot2c_f32_bf16 v85, s63, v106
 v_dot2c_f32_bf16 v86, s62, v107
 v_dot2c_f32_bf16 v87, s63, v107
 v_dot2c_f32_bf16 v88, s62, v108
 v_dot2c_f32_bf16 v89, s63, v108
 v_dot2c_f32_bf16 v90, s62, v109
 v_dot2c_f32_bf16 v91, s63, v109
 s_waitcnt vmcnt(15)
 v_dot2c_f32_bf16 v80, s62, v110
 v_dot2c_f32_bf16 v81, s63, v110
 v_dot2c_f32_bf16 v82, s62, v111
 v_dot2c_f32_bf16 v83, s63, v111
 v_dot2c_f32_bf16 v84, s62, v112
 v_dot2c_f32_bf16 v85, s63, v112
 v_dot2c_f32_bf16 v86, s62, v113
 v_dot2c_f32_bf16 v87, s63, v113
 v_dot2c_f32_bf16 v88, s62, v114
 v_dot2c_f32_bf16 v89, s63, v114
 v_dot2c_f32_bf16 v90, s62, v115
 v_dot2c_f32_bf16 v91, s63, v115
 s_waitcnt vmcnt(12)
 v_dot2c_f32_bf16 v80, s62, v116
 v_dot2c_f32_bf16 v81, s63, v116
 v_dot2c_f32_bf16 v82, s62, v117
 v_dot2c_f32_bf16 v83, s63, v117
 v_dot2c_f32_bf16 v84, s62, v118
 v_dot2c_f32_bf16 v85, s63, v118
 v_dot2c_f32_bf16 v86, s62, v119
 v_dot2c_f32_bf16 v87, s63, v119
 v_dot2c_f32_bf16 v88, s62, v120
 v_dot2c_f32_bf16 v89, s63, v120
 v_dot2c_f32_bf16 v90, s62, v121
 v_dot2c_f32_bf16 v91, s63, v121
 s_waitcnt vmcnt(9)
 v_dot2c_f32_bf16 v80, s62, v122
 v_dot2c_f32_bf16 v81, s63, v122
 v_dot2c_f32_bf16 v82, s62, v123
 v_dot2c_f32_bf16 v83, s63, v123
 v_dot2c_f32_bf16 v84, s62, v124
 v_dot2c_f32_bf16 v85, s63, v124
 v_dot2c_f32_bf16 v86, s62, v125
 v_dot2c_f32_bf16 v87, s63, v125
 v_dot2c_f32_bf16 v88, s62, v126
 v_dot2c_f32_bf16 v89, s63, v126
 v_dot2c_f32_bf16 v90, s62, v127
 v_dot2c_f32_bf16 v91, s63, v127
 s_waitcnt vmcnt(6)
 v_dot2c_f32_bf16 v80, s62, v128
 v_dot2c_f32_bf16 v81, s63, v128
 v_dot2c_f32_bf16 v82, s62, v129
 v_dot2c_f32_bf16 v83, s63, v129
 v_dot2c_f32_bf16 v84, s62, v130
 v_dot2c_f32_bf16 v85, s63, v130
 v_dot2c_f32_bf16 v86, s62, v131
 v_dot2c_f32_bf16 v87, s63, v131
 v_dot2c_f32_bf16 v88, s62, v132
 v_dot2c_f32_bf16 v89, s63, v132
 v_dot2c_f32_bf16 v90, s62, v133
 v_dot2c_f32_bf16 v91, s63, v133
 s_waitcnt vmcnt(3)
 v_dot2c_f32_bf16 v80, s62, v134
 v_dot2c_f32_bf16 v81, s63, v134
 v_dot2c_f32_bf16 v82, s62, v135
 v_dot2c_f32_bf16 v83, s63, v135
 v_dot2c_f32_bf16 v84, s62, v136
 v_dot2c_f32_bf16 v85, s63, v136
 v_dot2c_f32_bf16 v86, s62, v137
 v_dot2c_f32_bf16 v87, s63, v137
 v_dot2c_f32_bf16 v88, s62, v138
 v_dot2c_f32_bf16 v89, s63, v138
 v_dot2c_f32_bf16 v90, s62, v139
 v_dot2c_f32_bf16 v91, s63, v139
 s_waitcnt lgkmcnt(0)
 s_nop 1
 v_cvt_pk_bf16_f32 v9, v80, v81
 v_lshlrev_b32 v80, 16, v9
 v_and_b32 v81, 0xffff0000, v9
 v_cvt_pk_bf16_f32 v9, v82, v83
 v_lshlrev_b32 v82, 16, v9
 v_and_b32 v83, 0xffff0000, v9
 v_cvt_pk_bf16_f32 v9, v84, v85
 v_lshlrev_b32 v84, 16, v9
 v_and_b32 v85, 0xffff0000, v9
 v_cvt_pk_bf16_f32 v9, v86, v87
 v_lshlrev_b32 v86, 16, v9
 v_and_b32 v87, 0xffff0000, v9
 v_cvt_pk_bf16_f32 v9, v88, v89
 v_lshlrev_b32 v88, 16, v9
 v_and_b32 v89, 0xffff0000, v9
 v_cvt_pk_bf16_f32 v9, v90, v91
 v_lshlrev_b32 v90, 16, v9
 v_and_b32 v91, 0xffff0000, v9
 v_pk_add_f32 v[12:13], v[12:13], v[80:81]
 v_pk_add_f32 v[14:15], v[14:15], v[82:83]
 v_pk_add_f32 v[16:17], v[16:17], v[84:85]
 v_pk_add_f32 v[18:19], v[18:19], v[86:87]
 v_pk_add_f32 v[20:21], v[20:21], v[88:89]
 v_pk_add_f32 v[22:23], v[22:23], v[90:91]
 v_cvt_pk_bf16_f32 v9, v12, v13
 v_lshlrev_b32 v12, 16, v9
 v_and_b32 v13, 0xffff0000, v9
 v_cvt_pk_bf16_f32 v9, v14, v15
 v_lshlrev_b32 v14, 16, v9
 v_and_b32 v15, 0xffff0000, v9
 v_cvt_pk_bf16_f32 v9, v16, v17
 v_lshlrev_b32 v16, 16, v9
 v_and_b32 v17, 0xffff0000, v9
 v_cvt_pk_bf16_f32 v9, v18, v19
 v_lshlrev_b32 v18, 16, v9
 v_and_b32 v19, 0xffff0000, v9
 v_cvt_pk_bf16_f32 v9, v20, v21
 v_lshlrev_b32 v20, 16, v9
 v_and_b32 v21, 0xffff0000, v9
 v_cvt_pk_bf16_f32 v9, v22, v23
 v_lshlrev_b32 v22, 16, v9
 v_and_b32 v23, 0xffff0000, v9
 v_readfirstlane_b32 s3, v12
 s_nop 1
 v_subrev_f32 v36, s3, v12
 v_subrev_f32 v37, s3, v13
 v_subrev_f32 v38, s3, v14
 v_subrev_f32 v39, s3, v15
 v_subrev_f32 v40, s3, v16
 v_subrev_f32 v41, s3, v17
 v_subrev_f32 v42, s3, v18
 v_subrev_f32 v43, s3, v19
 v_mov_b32 v44, 0
 v_mov_b32 v45, 0
 v_mov_b32 v46, 0
 v_mov_b32 v47, 0
 s_mov_b32 exec_hi, 0
 v_subrev_f32 v44, s3, v20
 v_subrev_f32 v45, s3, v21
 v_subrev_f32 v46, s3, v22
 v_subrev_f32 v47, s3, v23
 s_mov_b32 exec_hi, -1
 v_pk_mul_f32 v[10:11], v[36:37], v[36:37]
 v_pk_fma_f32 v[10:11], v[38:39], v[38:39], v[10:11]
 v_pk_fma_f32 v[10:11], v[40:41], v[40:41], v[10:11]
 v_pk_fma_f32 v[10:11], v[42:43], v[42:43], v[10:11]
 v_pk_fma_f32 v[10:11], v[44:45], v[44:45], v[10:11]
 v_pk_fma_f32 v[10:11], v[46:47], v[46:47], v[10:11]
 v_pk_add_f32 v[36:37], v[36:37], v[38:39]
 v_pk_add_f32 v[36:37], v[36:37], v[40:41]
 v_pk_add_f32 v[36:37], v[36:37], v[42:43]
 v_pk_add_f32 v[36:37], v[36:37], v[44:45]
 v_pk_add_f32 v[36:37], v[36:37], v[46:47]
 v_add_f32 v11, v10, v11
 v_add_f32 v10, v36, v37
 s_nop 0
 v_add_f32_dpp v11, v11, v11 quad_perm:[1,0,3,2] row_mask:0xf bank_mask:0xf
 v_add_f32_dpp v10, v10, v10 quad_perm:[1,0,3,2] row_mask:0xf bank_mask:0xf
 s_nop 0
 v_add_f32_dpp v11, v11, v11 quad_perm:[2,3,0,1] row_mask:0xf bank_mask:0xf
 v_add_f32_dpp v10, v10, v10 quad_perm:[2,3,0,1] row_mask:0xf bank_mask:0xf
 s_nop 0
 v_add_f32_dpp v11, v11, v11 row_half_mirror row_mask:0xf bank_mask:0xf
 v_add_f32_dpp v10, v10, v10 row_half_mirror row_mask:0xf bank_mask:0xf
 s_nop 0
 v_add_f32_dpp v11, v11, v11 row_mirror row_mask:0xf bank_mask:0xf
 v_add_f32_dpp v10, v10, v10 row_mirror row_mask:0xf bank_mask:0xf
 v_mov_b32 v37, v11
 v_mov_b32 v36, v10
 s_nop 0
 v_permlane16_swap_b32 v11, v37
 v_permlane16_swap_b32 v10, v36
 v_pk_add_f32 v[10:11], v[10:11], v[36:37]
 v_mov_b32 v37, v11
 v_mov_b32 v36, v10
 s_nop 0
 v_permlane32_swap_b32 v11, v37
 v_permlane32_swap_b32 v10, v36
 v_pk_add_f32 v[10:11], v[10:11], v[36:37]
 v_mul_f32 v10, s57, v10
 v_mul_f32 v11, s57, v11
 v_fma_f32 v11, -v10, v10, v11
 v_max_f32 v11, 0, v11
 v_add_f32 v10, s3, v10
 v_cvt_pk_bf16_f32 v9, v10, v11
 v_lshlrev_b32 v10, 16, v9
 v_and_b32 v11, 0xffff0000, v9
 v_add_f32 v11, s58, v11
 v_cvt_pk_bf16_f32 v11, v11, v11
 v_and_b32 v11, 0xffff0000, v11
 v_sqrt_f32 v11, v11
 s_nop 0
 v_pk_add_f32 v[36:37], v[12:13], v[10:11] op_sel_hi:[1,0] neg_lo:[0,1] neg_hi:[0,1]
 v_pk_add_f32 v[38:39], v[14:15], v[10:11] op_sel_hi:[1,0] neg_lo:[0,1] neg_hi:[0,1]
 v_pk_add_f32 v[40:41], v[16:17], v[10:11] op_sel_hi:[1,0] neg_lo:[0,1] neg_hi:[0,1]
 v_pk_add_f32 v[42:43], v[18:19], v[10:11] op_sel_hi:[1,0] neg_lo:[0,1] neg_hi:[0,1]
 v_pk_add_f32 v[44:45], v[20:21], v[10:11] op_sel_hi:[1,0] neg_lo:[0,1] neg_hi:[0,1]
 v_pk_add_f32 v[46:47], v[22:23], v[10:11] op_sel_hi:[1,0] neg_lo:[0,1] neg_hi:[0,1]
 v_cvt_pk_bf16_f32 v11, v11, v11
 v_and_b32 v11, 0xffff0000, v11
 v_rcp_f32 v11, v11
 v_cvt_pk_bf16_f32 v9, v36, v37
 v_lshlrev_b32 v36, 16, v9
 v_and_b32 v37, 0xffff0000, v9
 v_cvt_pk_bf16_f32 v9, v38, v39
 v_lshlrev_b32 v38, 16, v9
 v_and_b32 v39, 0xffff0000, v9
 v_cvt_pk_bf16_f32 v9, v40, v41
 v_lshlrev_b32 v40, 16, v9
 v_and_b32 v41, 0xffff0000, v9
 v_cvt_pk_bf16_f32 v9, v42, v43
 v_lshlrev_b32 v42, 16, v9
 v_and_b32 v43, 0xffff0000, v9
 v_cvt_pk_bf16_f32 v9, v44, v45
 v_lshlrev_b32 v44, 16, v9
 v_and_b32 v45, 0xffff0000, v9
 v_cvt_pk_bf16_f32 v9, v46, v47
 v_lshlrev_b32 v46, 16, v9
 v_and_b32 v47, 0xffff0000, v9
 v_pk_mul_f32 v[36:37], v[36:37], v[10:11] op_sel:[0,1] op_sel_hi:[1,1]
 v_pk_mul_f32 v[38:39], v[38:39], v[10:11] op_sel:[0,1] op_sel_hi:[1,1]
 v_pk_mul_f32 v[40:41], v[40:41], v[10:11] op_sel:[0,1] op_sel_hi:[1,1]
 v_pk_mul_f32 v[42:43], v[42:43], v[10:11] op_sel:[0,1] op_sel_hi:[1,1]
 v_pk_mul_f32 v[44:45], v[44:45], v[10:11] op_sel:[0,1] op_sel_hi:[1,1]
 v_pk_mul_f32 v[46:47], v[46:47], v[10:11] op_sel:[0,1] op_sel_hi:[1,1]
 v_cvt_pk_bf16_f32 v9, v36, v37
 v_lshlrev_b32 v36, 16, v9
 v_and_b32 v37, 0xffff0000, v9
 v_cvt_pk_bf16_f32 v9, v38, v39
 v_lshlrev_b32 v38, 16, v9
 v_and_b32 v39, 0xffff0000, v9
 v_cvt_pk_bf16_f32 v9, v40, v41
 v_lshlrev_b32 v40, 16, v9
 v_and_b32 v41, 0xffff0000, v9
 v_cvt_pk_bf16_f32 v9, v42, v43
 v_lshlrev_b32 v42, 16, v9
 v_and_b32 v43, 0xffff0000, v9
 v_cvt_pk_bf16_f32 v9, v44, v45
 v_lshlrev_b32 v44, 16, v9
 v_and_b32 v45, 0xffff0000, v9
 v_cvt_pk_bf16_f32 v9, v46, v47
 v_lshlrev_b32 v46, 16, v9
 v_and_b32 v47, 0xffff0000, v9
 v_pk_mul_f32 v[36:37], v[36:37], v[24:25]
 v_pk_mul_f32 v[38:39], v[38:39], v[26:27]
 v_pk_mul_f32 v[40:41], v[40:41], v[28:29]
 v_pk_mul_f32 v[42:43], v[42:43], v[30:31]
 v_pk_mul_f32 v[44:45], v[44:45], v[32:33]
 v_pk_mul_f32 v[46:47], v[46:47], v[34:35]
 v_cvt_pk_bf16_f32 v9, v36, v37
 v_lshlrev_b32 v36, 16, v9
 v_and_b32 v37, 0xffff0000, v9
 v_cvt_pk_bf16_f32 v9, v38, v39
 v_lshlrev_b32 v38, 16, v9
 v_and_b32 v39, 0xffff0000, v9
 v_cvt_pk_bf16_f32 v9, v40, v41
 v_lshlrev_b32 v40, 16, v9
 v_and_b32 v41, 0xffff0000, v9
 v_cvt_pk_bf16_f32 v9, v42, v43
 v_lshlrev_b32 v42, 16, v9
 v_and_b32 v43, 0xffff0000, v9
 v_cvt_pk_bf16_f32 v9, v44, v45
 v_lshlrev_b32 v44, 16, v9
 v_and_b32 v45, 0xffff0000, v9
 v_cvt_pk_bf16_f32 v9, v46, v47
 v_lshlrev_b32 v46, 16, v9
 v_and_b32 v47, 0xffff0000, v9
 v_pk_add_f32 v[12:13], v[12:13], v[36:37]
 v_pk_add_f32 v[14:15], v[14:15], v[38:39]
 v_pk_add_f32 v[16:17], v[16:17], v[40:41]
 v_pk_add_f32 v[18:19], v[18:19], v[42:43]
 v_pk_add_f32 v[20:21], v[20:21], v[44:45]
 v_pk_add_f32 v[22:23], v[22:23], v[46:47]
 v_cvt_pk_bf16_f32 v60, v12, v13
 v_cvt_pk_bf16_f32 v61, v14, v15
 v_cvt_pk_bf16_f32 v62, v16, v17
 v_cvt_pk_bf16_f32 v63, v18, v19
 v_cvt_pk_bf16_f32 v64, v20, v21
 v_cvt_pk_bf16_f32 v65, v22, v23
 s_cmp_lg_u32 s53, 0
 s_cbranch_scc1 L_l1_188
 s_cmp_lt_u32 s54, 16
 s_cbranch_scc1 L_rgd_191
 s_sub_u32 s55, s54, 15
 s_mov_b32 s51, 0
L_rg_190:
 ds_read_b32 v10, v73
 s_waitcnt lgkmcnt(0)
 v_cmp_gt_u32 vcc, s55, v10
 s_cbranch_vccz L_rgd_191
 s_sleep 8
 s_add_u32 s51, s51, 1
 s_cmp_lt_u32 s51, 131072
 s_cbranch_scc1 L_rg_190
 s_branch L_bail
L_rgd_191:
 ds_write_b64 v3, v[60:61] offset:0
 ds_write_b64 v3, v[62:63] offset:512
 ds_write_b64 v3, v[64:65] offset:1024
 v_lshlrev_b32 v12, 16, v60
 v_and_b32 v13, 0xffff0000, v60
 v_lshlrev_b32 v14, 16, v61
 v_and_b32 v15, 0xffff0000, v61
 v_lshlrev_b32 v16, 16, v62
 v_and_b32 v17, 0xffff0000, v62
 v_lshlrev_b32 v18, 16, v63
 v_and_b32 v19, 0xffff0000, v63
 v_lshlrev_b32 v20, 16, v64
 v_and_b32 v21, 0xffff0000, v64
 v_lshlrev_b32 v22, 16, v65
 v_and_b32 v23, 0xffff0000, v65
 s_nop 0
 v_readfirstlane_b32 s3, v12
 s_nop 1
 v_subrev_f32 v36, s3, v12
 v_subrev_f32 v37, s3, v13
 v_subrev_f32 v38, s3, v14
 v_subrev_f32 v39, s3, v15
 v_subrev_f32 v40, s3, v16
 v_subrev_f32 v41, s3, v17
 v_subrev_f32 v42, s3, v18
 v_subrev_f32 v43, s3, v19
 v_mov_b32 v44, 0
 v_mov_b32 v45, 0
 v_mov_b32 v46, 0
 v_mov_b32 v47, 0
 s_mov_b32 exec_hi, 0
 v_subrev_f32 v44, s3, v20
 v_subrev_f32 v45, s3, v21
 v_subrev_f32 v46, s3, v22
 v_subrev_f32 v47, s3, v23
 s_mov_b32 exec_hi, -1
 v_pk_mul_f32 v[10:11], v[36:37], v[36:37]
 v_pk_fma_f32 v[10:11], v[38:39], v[38:39], v[10:11]
 v_pk_fma_f32 v[10:11], v[40:41], v[40:41], v[10:11]
 v_pk_fma_f32 v[10:11], v[42:43], v[42:43], v[10:11]
 v_pk_fma_f32 v[10:11], v[44:45], v[44:45], v[10:11]
 v_pk_fma_f32 v[10:11], v[46:47], v[46:47], v[10:11]
 v_pk_add_f32 v[36:37], v[36:37], v[38:39]
 v_pk_add_f32 v[36:37], v[36:37], v[40:41]
 v_pk_add_f32 v[36:37], v[36:37], v[42:43]
 v_pk_add_f32 v[36:37], v[36:37], v[44:45]
 v_pk_add_f32 v[36:37], v[36:37], v[46:47]
 v_add_f32 v11, v10, v11
 v_add_f32 v10, v36, v37
 s_nop 0
 v_add_f32_dpp v11, v11, v11 quad_perm:[1,0,3,2] row_mask:0xf bank_mask:0xf
 v_add_f32_dpp v10, v10, v10 quad_perm:[1,0,3,2] row_mask:0xf bank_mask:0xf
 s_nop 0
 v_add_f32_dpp v11, v11, v11 quad_perm:[2,3,0,1] row_mask:0xf bank_mask:0xf
 v_add_f32_dpp v10, v10, v10 quad_perm:[2,3,0,1] row_mask:0xf bank_mask:0xf
 s_nop 0
 v_add_f32_dpp v11, v11, v11 row_half_mirror row_mask:0xf bank_mask:0xf
 v_add_f32_dpp v10, v10, v10 row_half_mirror row_mask:0xf bank_mask:0xf
 s_nop 0
 v_add_f32_dpp v11, v11, v11 row_mirror row_mask:0xf bank_mask:0xf
 v_add_f32_dpp v10, v10, v10 row_mirror row_mask:0xf bank_mask:0xf
 v_mov_b32 v37, v11
 v_mov_b32 v36, v10
 s_nop 0
 v_permlane16_swap_b32 v11, v37
 v_permlane16_swap_b32 v10, v36
 v_pk_add_f32 v[10:11], v[10:11], v[36:37]
 v_mov_b32 v37, v11
 v_mov_b32 v36, v10
 s_nop 0
 v_permlane32_swap_b32 v11, v37
 v_permlane32_swap_b32 v10, v36
 v_pk_add_f32 v[10:11], v[10:11], v[36:37]
 v_mul_f32 v10, s57, v10
 v_mul_f32 v11, s57, v11
 v_fma_f32 v11, -v10, v10, v11
 v_max_f32 v11, 0, v11
 v_add_f32 v10, s3, v10
 v_cvt_pk_bf16_f32 v9, v10, v11
 v_lshlrev_b32 v10, 16, v9
 v_and_b32 v11, 0xffff0000, v9
 v_add_f32 v11, s58, v11
 v_cvt_pk_bf16_f32 v11, v11, v11
 v_and_b32 v11, 0xffff0000, v11
 v_sqrt_f32 v11, v11
 s_nop 0
 v_pk_add_f32 v[36:37], v[12:13], v[10:11] op_sel_hi:[1,0] neg_lo:[0,1] neg_hi:[0,1]
 v_pk_add_f32 v[38:39], v[14:15], v[10:11] op_sel_hi:[1,0] neg_lo:[0,1] neg_hi:[0,1]
 v_pk_add_f32 v[40:41], v[16:17], v[10:11] op_sel_hi:[1,0] neg_lo:[0,1] neg_hi:[0,1]
 v_pk_add_f32 v[42:43], v[18:19], v[10:11] op_sel_hi:[1,0] neg_lo:[0,1] neg_hi:[0,1]
 v_pk_add_f32 v[44:45], v[20:21], v[10:11] op_sel_hi:[1,0] neg_lo:[0,1] neg_hi:[0,1]
 v_pk_add_f32 v[46:47], v[22:23], v[10:11] op_sel_hi:[1,0] neg_lo:[0,1] neg_hi:[0,1]
 v_cvt_pk_bf16_f32 v11, v11, v11
 v_and_b32 v11, 0xffff0000, v11
 v_rcp_f32 v11, v11
 v_cvt_pk_bf16_f32 v9, v36, v37
 v_lshlrev_b32 v36, 16, v9
 v_and_b32 v37, 0xffff0000, v9
 v_cvt_pk_bf16_f32 v9, v38, v39
 v_lshlrev_b32 v38, 16, v9
 v_and_b32 v39, 0xffff0000, v9
 v_cvt_pk_bf16_f32 v9, v40, v41
 v_lshlrev_b32 v40, 16, v9
 v_and_b32 v41, 0xffff0000, v9
 v_cvt_pk_bf16_f32 v9, v42, v43
 v_lshlrev_b32 v42, 16, v9
 v_and_b32 v43, 0xffff0000, v9
 v_cvt_pk_bf16_f32 v9, v44, v45
 v_lshlrev_b32 v44, 16, v9
 v_and_b32 v45, 0xffff0000, v9
 v_cvt_pk_bf16_f32 v9, v46, v47
 v_lshlrev_b32 v46, 16, v9
 v_and_b32 v47, 0xffff0000, v9
 v_pk_mul_f32 v[36:37], v[36:37], v[10:11] op_sel:[0,1] op_sel_hi:[1,1]
 v_pk_mul_f32 v[38:39], v[38:39], v[10:11] op_sel:[0,1] op_sel_hi:[1,1]
 v_pk_mul_f32 v[40:41], v[40:41], v[10:11] op_sel:[0,1] op_sel_hi:[1,1]
 v_pk_mul_f32 v[42:43], v[42:43], v[10:11] op_sel:[0,1] op_sel_hi:[1,1]
 v_pk_mul_f32 v[44:45], v[44:45], v[10:11] op_sel:[0,1] op_sel_hi:[1,1]
 v_pk_mul_f32 v[46:47], v[46:47], v[10:11] op_sel:[0,1] op_sel_hi:[1,1]
 v_cvt_pk_bf16_f32 v48, v36, v37
 v_cvt_pk_bf16_f32 v49, v38, v39
 v_cvt_pk_bf16_f32 v50, v40, v41
 v_cvt_pk_bf16_f32 v51, v42, v43
 v_cvt_pk_bf16_f32 v52, v44, v45
 v_cvt_pk_bf16_f32 v53, v46, v47
 s_add_u32 s3, s60, 195559424
 buffer_store_dwordx2 v[48:49], v4, s[4:7], s3 offen offset:0 sc1
 buffer_store_dwordx2 v[50:51], v4, s[4:7], s3 offen offset:512 sc1
 buffer_store_dwordx2 v[52:53], v8, s[4:7], s3 offen offset:1024 sc1
 s_lshl_b32 s55, s54, 2
 v_mov_b32 v75, 0
 s_mov_b64 exec, 15
 buffer_atomic_add v75, v5, s[4:7], s55 offen offset:4 sc0
 s_mov_b64 exec, -1
 s_waitcnt vmcnt(1) lgkmcnt(0)
 s_and_b32 s55, s52, 3
 s_mul_i32 s55, s55, 49152
 s_lshl_b32 s3, s54, 2
 s_add_u32 s3, s3, s55
 s_add_u32 s3, s3, 229376
 v_mov_b32 v3, 1
 s_mov_b64 exec, -1
 buffer_atomic_add v3, v68, s[4:7], s3 offen
 s_mov_b64 exec, -1
 s_add_u32 s3, s3, 32768
 v_mov_b32 v3, 1
 s_mov_b32 exec_hi, 0
 buffer_atomic_add v3, v69, s[4:7], s3 offen
 s_mov_b64 exec, -1
 s_waitcnt vmcnt(2)
 s_branch L_le_189
L_l1_188:
 buffer_store_dwordx2 v[60:61], v2, s[12:15], s60 offen offset:0 nt
 buffer_store_dwordx2 v[62:63], v2, s[12:15], s60 offen offset:512 nt
 buffer_store_dwordx2 v[64:65], v7, s[12:15], s60 offen offset:1024 nt
 s_lshl_b32 s55, s54, 2
 v_mov_b32 v75, 0
 s_mov_b64 exec, 15
 buffer_atomic_add v75, v5, s[4:7], s55 offen offset:4 sc0
 s_mov_b64 exec, -1
 s_cmp_lg_u32 s54, 7
 s_cbranch_scc1 L_yn_193
 ds_write_b16 v74, a0 offset:0
 ds_write_b16 v74, a2 offset:8
 ds_write_b16 v74, a4 offset:1024
 ds_write_b16 v74, a6 offset:1032
 ds_write_b16 v74, a8 offset:2048
 ds_write_b16 v74, a10 offset:2056
 ds_write_b16 v74, a12 offset:3072
 ds_write_b16 v74, a14 offset:3080
 ds_write_b16 v74, a16 offset:4096
 ds_write_b16 v74, a18 offset:4104
 ds_write_b16 v74, a20 offset:5120
 ds_write_b16 v74, a22 offset:5128
 ds_write_b16 v74, a24 offset:6144
 ds_write_b16 v74, a26 offset:6152
 ds_write_b16 v74, a28 offset:7168
 ds_write_b16 v74, a30 offset:7176
 ds_write_b16 v74, a32 offset:8192
 ds_write_b16 v74, a34 offset:8200
 ds_write_b16 v74, a36 offset:9216
 ds_write_b16 v74, a38 offset:9224
 ds_write_b16 v74, a40 offset:10240
 ds_write_b16 v74, a42 offset:10248
 ds_write_b16 v74, a44 offset:11264
 ds_write_b16 v74, a46 offset:11272
 ds_write_b16 v74, a48 offset:12288
 ds_write_b16 v74, a50 offset:12296
 ds_write_b16 v74, a52 offset:13312
 ds_write_b16 v74, a54 offset:13320
 ds_write_b16 v74, a56 offset:14336
 ds_write_b16 v74, a58 offset:14344
 ds_write_b16 v74, a60 offset:15360
 ds_write_b16 v74, a62 offset:15368
 ds_write_b16 v74, a64 offset:16384
 ds_write_b16 v74, a66 offset:16392
 ds_write_b16 v74, a68 offset:17408
 ds_write_b16 v74, a70 offset:17416
 ds_write_b16 v74, a72 offset:18432
 ds_write_b16 v74, a74 offset:18440
 ds_write_b16 v74, a76 offset:19456
 ds_write_b16 v74, a78 offset:19464
 ds_write_b16 v74, a80 offset:20480
 ds_write_b16 v74, a82 offset:20488
 ds_write_b16 v74, a84 offset:21504
 ds_write_b16 v74, a86 offset:21512
 ds_write_b16 v74, a88 offset:22528
 ds_write_b16 v74, a90 offset:22536
 ds_write_b16 v74, a92 offset:23552
 ds_write_b16 v74, a94 offset:23560
 ds_write_b16 v74, a96 offset:24576
 ds_write_b16 v74, a98 offset:24584
 ds_write_b16 v74, a100 offset:25600
 ds_write_b16 v74, a102 offset:25608
 ds_write_b16 v74, a104 offset:26624
 ds_write_b16 v74, a106 offset:26632
 ds_write_b16 v74, a108 offset:27648
 ds_write_b16 v74, a110 offset:27656
 ds_write_b16 v74, a112 offset:28672
 ds_write_b16 v74, a114 offset:28680
 ds_write_b16 v74, a116 offset:29696
 ds_write_b16 v74, a118 offset:29704
 ds_write_b16 v74, a120 offset:30720
 ds_write_b16 v74, a122 offset:30728
 ds_write_b16 v74, a124 offset:31744
 ds_write_b16 v74, a126 offset:31752
 ds_write_b16 v74, a128 offset:32768
 ds_write_b16 v74, a130 offset:32776
 ds_write_b16 v74, a132 offset:33792
 ds_write_b16 v74, a134 offset:33800
 ds_write_b16 v74, a136 offset:34816
 ds_write_b16 v74, a138 offset:34824
 ds_write_b16 v74, a140 offset:35840
 ds_write_b16 v74, a142 offset:35848
 ds_write_b16 v74, a144 offset:36864
 ds_write_b16 v74, a146 offset:36872
 ds_write_b16 v74, a148 offset:37888
 ds_write_b16 v74, a150 offset:37896
 ds_write_b16 v74, a152 offset:38912
 ds_write_b16 v74, a154 offset:38920
 ds_write_b16 v74, a156 offset:39936
 ds_write_b16 v74, a158 offset:39944
 v_mov_b32 v10, 1
 ds_write_b32 v73, v10 offset:8
 s_branch L_yc_192
L_yn_193:
 s_cmp_lg_u32 s54, 15
 s_cbranch_scc1 L_yn_194
 ds_write_b16_d16_hi v74, a0 offset:2
 ds_write_b16_d16_hi v74, a2 offset:10
 ds_write_b16_d16_hi v74, a4 offset:1026
 ds_write_b16_d16_hi v74, a6 offset:1034
 ds_write_b16_d16_hi v74, a8 offset:2050
 ds_write_b16_d16_hi v74, a10 offset:2058
 ds_write_b16_d16_hi v74, a12 offset:3074
 ds_write_b16_d16_hi v74, a14 offset:3082
 ds_write_b16_d16_hi v74, a16 offset:4098
 ds_write_b16_d16_hi v74, a18 offset:4106
 ds_write_b16_d16_hi v74, a20 offset:5122
 ds_write_b16_d16_hi v74, a22 offset:5130
 ds_write_b16_d16_hi v74, a24 offset:6146
 ds_write_b16_d16_hi v74, a26 offset:6154
 ds_write_b16_d16_hi v74, a28 offset:7170
 ds_write_b16_d16_hi v74, a30 offset:7178
 ds_write_b16_d16_hi v74, a32 offset:8194
 ds_write_b16_d16_hi v74, a34 offset:8202
 ds_write_b16_d16_hi v74, a36 offset:9218
 ds_write_b16_d16_hi v74, a38 offset:9226
 ds_write_b16_d16_hi v74, a40 offset:10242
 ds_write_b16_d16_hi v74, a42 offset:10250
 ds_write_b16_d16_hi v74, a44 offset:11266
 ds_write_b16_d16_hi v74, a46 offset:11274
 ds_write_b16_d16_hi v74, a48 offset:12290
 ds_write_b16_d16_hi v74, a50 offset:12298
 ds_write_b16_d16_hi v74, a52 offset:13314
 ds_write_b16_d16_hi v74, a54 offset:13322
 ds_write_b16_d16_hi v74, a56 offset:14338
 ds_write_b16_d16_hi v74, a58 offset:14346
 ds_write_b16_d16_hi v74, a60 offset:15362
 ds_write_b16_d16_hi v74, a62 offset:15370
 ds_write_b16_d16_hi v74, a64 offset:16386
 ds_write_b16_d16_hi v74, a66 offset:16394
 ds_write_b16_d16_hi v74, a68 offset:17410
 ds_write_b16_d16_hi v74, a70 offset:17418
 ds_write_b16_d16_hi v74, a72 offset:18434
 ds_write_b16_d16_hi v74, a74 offset:18442
 ds_write_b16_d16_hi v74, a76 offset:19458
 ds_write_b16_d16_hi v74, a78 offset:19466
 ds_write_b16_d16_hi v74, a80 offset:20482
 ds_write_b16_d16_hi v74, a82 offset:20490
 ds_write_b16_d16_hi v74, a84 offset:21506
 ds_write_b16_d16_hi v74, a86 offset:21514
 ds_write_b16_d16_hi v74, a88 offset:22530
 ds_write_b16_d16_hi v74, a90 offset:22538
 ds_write_b16_d16_hi v74, a92 offset:23554
 ds_write_b16_d16_hi v74, a94 offset:23562
 ds_write_b16_d16_hi v74, a96 offset:24578
 ds_write_b16_d16_hi v74, a98 offset:24586
 ds_write_b16_d16_hi v74, a100 offset:25602
 ds_write_b16_d16_hi v74, a102 offset:25610
 ds_write_b16_d16_hi v74, a104 offset:26626
 ds_write_b16_d16_hi v74, a106 offset:26634
 ds_write_b16_d16_hi v74, a108 offset:27650
 ds_write_b16_d16_hi v74, a110 offset:27658
 ds_write_b16_d16_hi v74, a112 offset:28674
 ds_write_b16_d16_hi v74, a114 offset:28682
 ds_write_b16_d16_hi v74, a116 offset:29698
 ds_write_b16_d16_hi v74, a118 offset:29706
 ds_write_b16_d16_hi v74, a120 offset:30722
 ds_write_b16_d16_hi v74, a122 offset:30730
 ds_write_b16_d16_hi v74, a124 offset:31746
 ds_write_b16_d16_hi v74, a126 offset:31754
 ds_write_b16_d16_hi v74, a128 offset:32770
 ds_write_b16_d16_hi v74, a130 offset:32778
 ds_write_b16_d16_hi v74, a132 offset:33794
 ds_write_b16_d16_hi v74, a134 offset:33802
 ds_write_b16_d16_hi v74, a136 offset:34818
 ds_write_b16_d16_hi v74, a138 offset:34826
 ds_write_b16_d16_hi v74, a140 offset:35842
 ds_write_b16_d16_hi v74, a142 offset:35850
 ds_write_b16_d16_hi v74, a144 offset:36866
 ds_write_b16_d16_hi v74, a146 offset:36874
 ds_write_b16_d16_hi v74, a148 offset:37890
 ds_write_b16_d16_hi v74, a150 offset:37898
 ds_write_b16_d16_hi v74, a152 offset:38914
 ds_write_b16_d16_hi v74, a154 offset:38922
 ds_write_b16_d16_hi v74, a156 offset:39938
 ds_write_b16_d16_hi v74, a158 offset:39946
 v_mov_b32 v10, 2
 ds_write_b32 v73, v10 offset:8
 s_branch L_yc_192
L_yn_194:
 s_cmp_lg_u32 s54, 23
 s_cbranch_scc1 L_yn_195
 ds_write_b16 v74, a1 offset:4
 ds_write_b16 v74, a3 offset:12
 ds_write_b16 v74, a5 offset:1028
 ds_write_b16 v74, a7 offset:1036
 ds_write_b16 v74, a9 offset:2052
 ds_write_b16 v74, a11 offset:2060
 ds_write_b16 v74, a13 offset:3076
 ds_write_b16 v74, a15 offset:3084
 ds_write_b16 v74, a17 offset:4100
 ds_write_b16 v74, a19 offset:4108
 ds_write_b16 v74, a21 offset:5124
 ds_write_b16 v74, a23 offset:5132
 ds_write_b16 v74, a25 offset:6148
 ds_write_b16 v74, a27 offset:6156
 ds_write_b16 v74, a29 offset:7172
 ds_write_b16 v74, a31 offset:7180
 ds_write_b16 v74, a33 offset:8196
 ds_write_b16 v74, a35 offset:8204
 ds_write_b16 v74, a37 offset:9220
 ds_write_b16 v74, a39 offset:9228
 ds_write_b16 v74, a41 offset:10244
 ds_write_b16 v74, a43 offset:10252
 ds_write_b16 v74, a45 offset:11268
 ds_write_b16 v74, a47 offset:11276
 ds_write_b16 v74, a49 offset:12292
 ds_write_b16 v74, a51 offset:12300
 ds_write_b16 v74, a53 offset:13316
 ds_write_b16 v74, a55 offset:13324
 ds_write_b16 v74, a57 offset:14340
 ds_write_b16 v74, a59 offset:14348
 ds_write_b16 v74, a61 offset:15364
 ds_write_b16 v74, a63 offset:15372
 ds_write_b16 v74, a65 offset:16388
 ds_write_b16 v74, a67 offset:16396
 ds_write_b16 v74, a69 offset:17412
 ds_write_b16 v74, a71 offset:17420
 ds_write_b16 v74, a73 offset:18436
 ds_write_b16 v74, a75 offset:18444
 ds_write_b16 v74, a77 offset:19460
 ds_write_b16 v74, a79 offset:19468
 ds_write_b16 v74, a81 offset:20484
 ds_write_b16 v74, a83 offset:20492
 ds_write_b16 v74, a85 offset:21508
 ds_write_b16 v74, a87 offset:21516
 ds_write_b16 v74, a89 offset:22532
 ds_write_b16 v74, a91 offset:22540
 ds_write_b16 v74, a93 offset:23556
 ds_write_b16 v74, a95 offset:23564
 ds_write_b16 v74, a97 offset:24580
 ds_write_b16 v74, a99 offset:24588
 ds_write_b16 v74, a101 offset:25604
 ds_write_b16 v74, a103 offset:25612
 ds_write_b16 v74, a105 offset:26628
 ds_write_b16 v74, a107 offset:26636
 ds_write_b16 v74, a109 offset:27652
 ds_write_b16 v74, a111 offset:27660
 ds_write_b16 v74, a113 offset:28676
 ds_write_b16 v74, a115 offset:28684
 ds_write_b16 v74, a117 offset:29700
 ds_write_b16 v74, a119 offset:29708
 ds_write_b16 v74, a121 offset:30724
 ds_write_b16 v74, a123 offset:30732
 ds_write_b16 v74, a125 offset:31748
 ds_write_b16 v74, a127 offset:31756
 ds_write_b16 v74, a129 offset:32772
 ds_write_b16 v74, a131 offset:32780
 ds_write_b16 v74, a133 offset:33796
 ds_write_b16 v74, a135 offset:33804
 ds_write_b16 v74, a137 offset:34820
 ds_write_b16 v74, a139 offset:34828
 ds_write_b16 v74, a141 offset:35844
 ds_write_b16 v74, a143 offset:35852
 ds_write_b16 v74, a145 offset:36868
 ds_write_b16 v74, a147 offset:36876
 ds_write_b16 v74, a149 offset:37892
 ds_write_b16 v74, a151 offset:37900
 ds_write_b16 v74, a153 offset:38916
 ds_write_b16 v74, a155 offset:38924
 ds_write_b16 v74, a157 offset:39940
 ds_write_b16 v74, a159 offset:39948
 v_mov_b32 v10, 3
 ds_write_b32 v73, v10 offset:8
 s_branch L_yc_192
L_yn_195:
 s_cmp_lg_u32 s54, 31
 s_cbranch_scc1 L_yc_192
 ds_write_b16_d16_hi v74, a1 offset:6
 ds_write_b16_d16_hi v74, a3 offset:14
 ds_write_b16_d16_hi v74, a5 offset:1030
 ds_write_b16_d16_hi v74, a7 offset:1038
 ds_write_b16_d16_hi v74, a9 offset:2054
 ds_write_b16_d16_hi v74, a11 offset:2062
 ds_write_b16_d16_hi v74, a13 offset:3078
 ds_write_b16_d16_hi v74, a15 offset:3086
 ds_write_b16_d16_hi v74, a17 offset:4102
 ds_write_b16_d16_hi v74, a19 offset:4110
 ds_write_b16_d16_hi v74, a21 offset:5126
 ds_write_b16_d16_hi v74, a23 offset:5134
 ds_write_b16_d16_hi v74, a25 offset:6150
 ds_write_b16_d16_hi v74, a27 offset:6158
 ds_write_b16_d16_hi v74, a29 offset:7174
 ds_write_b16_d16_hi v74, a31 offset:7182
 ds_write_b16_d16_hi v74, a33 offset:8198
 ds_write_b16_d16_hi v74, a35 offset:8206
 ds_write_b16_d16_hi v74, a37 offset:9222
 ds_write_b16_d16_hi v74, a39 offset:9230
 ds_write_b16_d16_hi v74, a41 offset:10246
 ds_write_b16_d16_hi v74, a43 offset:10254
 ds_write_b16_d16_hi v74, a45 offset:11270
 ds_write_b16_d16_hi v74, a47 offset:11278
 ds_write_b16_d16_hi v74, a49 offset:12294
 ds_write_b16_d16_hi v74, a51 offset:12302
 ds_write_b16_d16_hi v74, a53 offset:13318
 ds_write_b16_d16_hi v74, a55 offset:13326
 ds_write_b16_d16_hi v74, a57 offset:14342
 ds_write_b16_d16_hi v74, a59 offset:14350
 ds_write_b16_d16_hi v74, a61 offset:15366
 ds_write_b16_d16_hi v74, a63 offset:15374
 ds_write_b16_d16_hi v74, a65 offset:16390
 ds_write_b16_d16_hi v74, a67 offset:16398
 ds_write_b16_d16_hi v74, a69 offset:17414
 ds_write_b16_d16_hi v74, a71 offset:17422
 ds_write_b16_d16_hi v74, a73 offset:18438
 ds_write_b16_d16_hi v74, a75 offset:18446
 ds_write_b16_d16_hi v74, a77 offset:19462
 ds_write_b16_d16_hi v74, a79 offset:19470
 ds_write_b16_d16_hi v74, a81 offset:20486
 ds_write_b16_d16_hi v74, a83 offset:20494
 ds_write_b16_d16_hi v74, a85 offset:21510
 ds_write_b16_d16_hi v74, a87 offset:21518
 ds_write_b16_d16_hi v74, a89 offset:22534
 ds_write_b16_d16_hi v74, a91 offset:22542
 ds_write_b16_d16_hi v74, a93 offset:23558
 ds_write_b16_d16_hi v74, a95 offset:23566
 ds_write_b16_d16_hi v74, a97 offset:24582
 ds_write_b16_d16_hi v74, a99 offset:24590
 ds_write_b16_d16_hi v74, a101 offset:25606
 ds_write_b16_d16_hi v74, a103 offset:25614
 ds_write_b16_d16_hi v74, a105 offset:26630
 ds_write_b16_d16_hi v74, a107 offset:26638
 ds_write_b16_d16_hi v74, a109 offset:27654
 ds_write_b16_d16_hi v74, a111 offset:27662
 ds_write_b16_d16_hi v74, a113 offset:28678
 ds_write_b16_d16_hi v74, a115 offset:28686
 ds_write_b16_d16_hi v74, a117 offset:29702
 ds_write_b16_d16_hi v74, a119 offset:29710
 ds_write_b16_d16_hi v74, a121 offset:30726
 ds_write_b16_d16_hi v74, a123 offset:30734
 ds_write_b16_d16_hi v74, a125 offset:31750
 ds_write_b16_d16_hi v74, a127 offset:31758
 ds_write_b16_d16_hi v74, a129 offset:32774
 ds_write_b16_d16_hi v74, a131 offset:32782
 ds_write_b16_d16_hi v74, a133 offset:33798
 ds_write_b16_d16_hi v74, a135 offset:33806
 ds_write_b16_d16_hi v74, a137 offset:34822
 ds_write_b16_d16_hi v74, a139 offset:34830
 ds_write_b16_d16_hi v74, a141 offset:35846
 ds_write_b16_d16_hi v74, a143 offset:35854
 ds_write_b16_d16_hi v74, a145 offset:36870
 ds_write_b16_d16_hi v74, a147 offset:36878
 ds_write_b16_d16_hi v74, a149 offset:37894
 ds_write_b16_d16_hi v74, a151 offset:37902
 ds_write_b16_d16_hi v74, a153 offset:38918
 ds_write_b16_d16_hi v74, a155 offset:38926
 ds_write_b16_d16_hi v74, a157 offset:39942
 ds_write_b16_d16_hi v74, a159 offset:39950
 v_mov_b32 v10, 4
 ds_write_b32 v73, v10 offset:8
L_yc_192:
 s_waitcnt vmcnt(0)
L_le_189:
 s_add_u32 s54, s54, 1
 s_add_u32 s60, s60, 40960
 s_cmp_lt_u32 s54, 64
 s_cbranch_scc1 L_t4_loop
 s_cmp_lg_u32 s50, 3
 s_cbranch_scc1 L_bail
 s_endpgm
L_bail:
 s_endpgm
L_ch:
 s_and_b32 s3, s48, 1
 s_lshl_b32 s3, s3, 4
 s_add_u32 s52, s3, s49
 s_mov_b32 s8, s20
 s_and_b32 s9, s21, 0xffff
 s_mov_b32 s10, 5242880
 s_mov_b32 s11, 0x00020000
 s_cmp_lt_u32 s50, 2
 s_cselect_b32 s8, s20, s22
 s_cselect_b32 s9, s21, s23
 s_and_b32 s9, s9, 0xffff
 v_lshrrev_b32 v2, 4, v0
 v_and_b32 v14, 1, v2
 v_lshlrev_b32 v14, 1, v14
 v_xor_b32 v14, v14, v0
 s_lshr_b32 s3, s50, 1
 s_lshl_b32 s3, s3, 3
 v_xor_b32 v14, s3, v14
 v_and_b32 v14, 15, v14
 s_mov_b32 s3, 8192
 v_mul_lo_u32 v2, v2, s3
 v_lshl_add_u32 v2, v14, 4, v2
 v_xor_b32 v3, 64, v2
 s_and_b32 s3, s50, 1
 s_mul_i32 s76, s3, 262144
 s_lshl_b32 s3, s52, 8
 s_add_u32 s76, s76, s3
 s_lshl_b32 s78, s50, 13
 s_add_u32 m0, s78, 0
 s_nop 0
 buffer_load_dwordx4 v2, s[8:11], s76 offen lds
 s_add_u32 s76, s76, 32768
 s_add_u32 m0, s78, 1024
 s_nop 0
 buffer_load_dwordx4 v2, s[8:11], s76 offen lds
 s_add_u32 s76, s76, 32768
 s_add_u32 m0, s78, 2048
 s_nop 0
 buffer_load_dwordx4 v3, s[8:11], s76 offen lds
 s_add_u32 s76, s76, 32768
 s_add_u32 m0, s78, 3072
 s_nop 0
 buffer_load_dwordx4 v3, s[8:11], s76 offen lds
 s_add_u32 s76, s76, 32768
 s_add_u32 m0, s78, 4096
 s_nop 0
 buffer_load_dwordx4 v2, s[8:11], s76 offen lds
 s_add_u32 s76, s76, 32768
 s_add_u32 m0, s78, 5120
 s_nop 0
 buffer_load_dwordx4 v2, s[8:11], s76 offen lds
 s_add_u32 s76, s76, 32768
 s_add_u32 m0, s78, 6144
 s_nop 0
 buffer_load_dwordx4 v3, s[8:11], s76 offen lds
 s_add_u32 s76, s76, 32768
 s_add_u32 m0, s78, 7168
 s_nop 0
 buffer_load_dwordx4 v3, s[8:11], s76 offen lds
 s_add_u32 s76, s76, 294912
 s_add_u32 m0, s78, 32768
 s_nop 0
 buffer_load_dwordx4 v2, s[8:11], s76 offen lds
 s_add_u32 s76, s76, 32768
 s_add_u32 m0, s78, 33792
 s_nop 0
 buffer_load_dwordx4 v2, s[8:11], s76 offen lds
 s_add_u32 s76, s76, 32768
 s_add_u32 m0, s78, 34816
 s_nop 0
 buffer_load_dwordx4 v3, s[8:11], s76 offen lds
 s_add_u32 s76, s76, 32768
 s_add_u32 m0, s78, 35840
 s_nop 0
 buffer_load_dwordx4 v3, s[8:11], s76 offen lds
 s_add_u32 s76, s76, 32768
 s_add_u32 m0, s78, 36864
 s_nop 0
 buffer_load_dwordx4 v2, s[8:11], s76 offen lds
 s_add_u32 s76, s76, 32768
 s_add_u32 m0, s78, 37888
 s_nop 0
 buffer_load_dwordx4 v2, s[8:11], s76 offen lds
 s_add_u32 s76, s76, 32768
 s_add_u32 m0, s78, 38912
 s_nop 0
 buffer_load_dwordx4 v3, s[8:11], s76 offen lds
 s_add_u32 s76, s76, 32768
 s_add_u32 m0, s78, 39936
 s_nop 0
 buffer_load_dwordx4 v3, s[8:11], s76 offen lds
 s_add_u32 s76, s76, 294912
 s_add_u32 m0, s78, 65536
 s_nop 0
 buffer_load_dwordx4 v2, s[8:11], s76 offen lds
 s_add_u32 s76, s76, 32768
 s_add_u32 m0, s78, 66560
 s_nop 0
 buffer_load_dwordx4 v2, s[8:11], s76 offen lds
 s_add_u32 s76, s76, 32768
 s_add_u32 m0, s78, 67584
 s_nop 0
 buffer_load_dwordx4 v3, s[8:11], s76 offen lds
 s_add_u32 s76, s76, 32768
 s_add_u32 m0, s78, 68608
 s_nop 0
 buffer_load_dwordx4 v3, s[8:11], s76 offen lds
 s_add_u32 s76, s76, 32768
 s_add_u32 m0, s78, 69632
 s_nop 0
 buffer_load_dwordx4 v2, s[8:11], s76 offen lds
 s_add_u32 s76, s76, 32768
 s_add_u32 m0, s78, 70656
 s_nop 0
 buffer_load_dwordx4 v2, s[8:11], s76 offen lds
 s_add_u32 s76, s76, 32768
 s_add_u32 m0, s78, 71680
 s_nop 0
 buffer_load_dwordx4 v3, s[8:11], s76 offen lds
 s_add_u32 s76, s76, 32768
 s_add_u32 m0, s78, 72704
 s_nop 0
 buffer_load_dwordx4 v3, s[8:11], s76 offen lds
 s_add_u32 s76, s76, 294912
 s_add_u32 m0, s78, 98304
 s_nop 0
 buffer_load_dwordx4 v2, s[8:11], s76 offen lds
 s_add_u32 s76, s76, 32768
 s_add_u32 m0, s78, 99328
 s_nop 0
 buffer_load_dwordx4 v2, s[8:11], s76 offen lds
 s_add_u32 s76, s76, 32768
 s_add_u32 m0, s78, 100352
 s_nop 0
 buffer_load_dwordx4 v3, s[8:11], s76 offen lds
 s_add_u32 s76, s76, 32768
 s_add_u32 m0, s78, 101376
 s_nop 0
 buffer_load_dwordx4 v3, s[8:11], s76 offen lds
 s_add_u32 s76, s76, 32768
 s_add_u32 m0, s78, 102400
 s_nop 0
 buffer_load_dwordx4 v2, s[8:11], s76 offen lds
 s_add_u32 s76, s76, 32768
 s_add_u32 m0, s78, 103424
 s_nop 0
 buffer_load_dwordx4 v2, s[8:11], s76 offen lds
 s_add_u32 s76, s76, 32768
 s_add_u32 m0, s78, 104448
 s_nop 0
 buffer_load_dwordx4 v3, s[8:11], s76 offen lds
 s_add_u32 s76, s76, 32768
 s_add_u32 m0, s78, 105472
 s_nop 0
 buffer_load_dwordx4 v3, s[8:11], s76 offen lds
 s_add_u32 s76, s76, 294912
 s_add_u32 m0, s78, 131072
 s_nop 0
 buffer_load_dwordx4 v2, s[8:11], s76 offen lds
 s_add_u32 s76, s76, 32768
 s_add_u32 m0, s78, 132096
 s_nop 0
 buffer_load_dwordx4 v2, s[8:11], s76 offen lds
 s_add_u32 s76, s76, 32768
 s_add_u32 m0, s78, 133120
 s_nop 0
 buffer_load_dwordx4 v3, s[8:11], s76 offen lds
 s_add_u32 s76, s76, 32768
 s_add_u32 m0, s78, 134144
 s_nop 0
 buffer_load_dwordx4 v3, s[8:11], s76 offen lds
 s_add_u32 s76, s76, 32768
 s_add_u32 m0, s78, 135168
 s_nop 0
 buffer_load_dwordx4 v2, s[8:11], s76 offen lds
 s_add_u32 s76, s76, 32768
 s_add_u32 m0, s78, 136192
 s_nop 0
 buffer_load_dwordx4 v2, s[8:11], s76 offen lds
 s_add_u32 s76, s76, 32768
 s_add_u32 m0, s78, 137216
 s_nop 0
 buffer_load_dwordx4 v3, s[8:11], s76 offen lds
 s_add_u32 s76, s76, 32768
 s_add_u32 m0, s78, 138240
 s_nop 0
 buffer_load_dwordx4 v3, s[8:11], s76 offen lds
 s_add_u32 s76, s76, 294912
 v_bfe_u32 v14, v0, 2, 1
 v_lshlrev_b32 v4, 8, v14
 v_lshl_add_u32 v4, v14, 5, v4
 v_bfe_u32 v14, v0, 4, 1
 v_lshl_add_u32 v4, v14, 11, v4
 v_lshl_add_u32 v4, v14, 6, v4
 v_bfe_u32 v14, v0, 5, 1
 v_lshl_add_u32 v4, v14, 12, v4
 v_and_b32 v14, 3, v0
 v_lshl_add_u32 v4, v14, 3, v4
 v_bfe_u32 v14, v0, 3, 1
 v_mul_u32_u24 v14, 16512, v14
 v_xor_b32 v4, v4, v14
 s_lshl_b32 s3, s50, 6
 v_xor_b32 v4, s3, v4
 v_xor_b32 v5, 32, v4
 s_waitcnt vmcnt(32)
 s_barrier
 v_add_u32 v6, 0, v4
 v_add_u32 v7, 0, v5
 ds_read_b64_tr_b16 v[224:225], v6 offset:0
 ds_read_b64_tr_b16 v[226:227], v6 offset:512
 ds_read_b64_tr_b16 v[228:229], v6 offset:1024
 ds_read_b64_tr_b16 v[230:231], v6 offset:1536
 ds_read_b64_tr_b16 v[232:233], v7 offset:0
 ds_read_b64_tr_b16 v[234:235], v7 offset:512
 ds_read_b64_tr_b16 v[236:237], v7 offset:1024
 ds_read_b64_tr_b16 v[238:239], v7 offset:1536
 ds_read_b64_tr_b16 v[240:241], v6 offset:8192
 ds_read_b64_tr_b16 v[242:243], v6 offset:8704
 ds_read_b64_tr_b16 v[244:245], v6 offset:9216
 ds_read_b64_tr_b16 v[246:247], v6 offset:9728
 ds_read_b64_tr_b16 v[248:249], v7 offset:8192
 ds_read_b64_tr_b16 v[250:251], v7 offset:8704
 ds_read_b64_tr_b16 v[252:253], v7 offset:9216
 ds_read_b64_tr_b16 v[254:255], v7 offset:9728
 s_waitcnt lgkmcnt(0)
 s_barrier
 s_add_u32 m0, s78, 0
 s_nop 0
 buffer_load_dwordx4 v2, s[8:11], s76 offen lds
 s_add_u32 s76, s76, 32768
 s_add_u32 m0, s78, 1024
 s_nop 0
 buffer_load_dwordx4 v2, s[8:11], s76 offen lds
 s_add_u32 s76, s76, 32768
 s_add_u32 m0, s78, 2048
 s_nop 0
 buffer_load_dwordx4 v3, s[8:11], s76 offen lds
 s_add_u32 s76, s76, 32768
 s_add_u32 m0, s78, 3072
 s_nop 0
 buffer_load_dwordx4 v3, s[8:11], s76 offen lds
 s_add_u32 s76, s76, 32768
 s_add_u32 m0, s78, 4096
 s_nop 0
 buffer_load_dwordx4 v2, s[8:11], s76 offen lds
 s_add_u32 s76, s76, 32768
 s_add_u32 m0, s78, 5120
 s_nop 0
 buffer_load_dwordx4 v2, s[8:11], s76 offen lds
 s_add_u32 s76, s76, 32768
 s_add_u32 m0, s78, 6144
 s_nop 0
 buffer_load_dwordx4 v3, s[8:11], s76 offen lds
 s_add_u32 s76, s76, 32768
 s_add_u32 m0, s78, 7168
 s_nop 0
 buffer_load_dwordx4 v3, s[8:11], s76 offen lds
 s_add_u32 s76, s76, 294912
 s_waitcnt vmcnt(32)
 s_barrier
 v_add_u32 v6, 32768, v4
 v_add_u32 v7, 32768, v5
 ds_read_b64_tr_b16 v[192:193], v6 offset:0
 ds_read_b64_tr_b16 v[194:195], v6 offset:512
 ds_read_b64_tr_b16 v[196:197], v6 offset:1024
 ds_read_b64_tr_b16 v[198:199], v6 offset:1536
 ds_read_b64_tr_b16 v[200:201], v7 offset:0
 ds_read_b64_tr_b16 v[202:203], v7 offset:512
 ds_read_b64_tr_b16 v[204:205], v7 offset:1024
 ds_read_b64_tr_b16 v[206:207], v7 offset:1536
 ds_read_b64_tr_b16 v[208:209], v6 offset:8192
 ds_read_b64_tr_b16 v[210:211], v6 offset:8704
 ds_read_b64_tr_b16 v[212:213], v6 offset:9216
 ds_read_b64_tr_b16 v[214:215], v6 offset:9728
 ds_read_b64_tr_b16 v[216:217], v7 offset:8192
 ds_read_b64_tr_b16 v[218:219], v7 offset:8704
 ds_read_b64_tr_b16 v[220:221], v7 offset:9216
 ds_read_b64_tr_b16 v[222:223], v7 offset:9728
 s_waitcnt lgkmcnt(0)
 s_barrier
 s_add_u32 m0, s78, 32768
 s_nop 0
 buffer_load_dwordx4 v2, s[8:11], s76 offen lds
 s_add_u32 s76, s76, 32768
 s_add_u32 m0, s78, 33792
 s_nop 0
 buffer_load_dwordx4 v2, s[8:11], s76 offen lds
 s_add_u32 s76, s76, 32768
 s_add_u32 m0, s78, 34816
 s_nop 0
 buffer_load_dwordx4 v3, s[8:11], s76 offen lds
 s_add_u32 s76, s76, 32768
 s_add_u32 m0, s78, 35840
 s_nop 0
 buffer_load_dwordx4 v3, s[8:11], s76 offen lds
 s_add_u32 s76, s76, 32768
 s_add_u32 m0, s78, 36864
 s_nop 0
 buffer_load_dwordx4 v2, s[8:11], s76 offen lds
 s_add_u32 s76, s76, 32768
 s_add_u32 m0, s78, 37888
 s_nop 0
 buffer_load_dwordx4 v2, s[8:11], s76 offen lds
 s_add_u32 s76, s76, 32768
 s_add_u32 m0, s78, 38912
 s_nop 0
 buffer_load_dwordx4 v3, s[8:11], s76 offen lds
 s_add_u32 s76, s76, 32768
 s_add_u32 m0, s78, 39936
 s_nop 0
 buffer_load_dwordx4 v3, s[8:11], s76 offen lds
 s_add_u32 s76, s76, 294912
 s_waitcnt vmcnt(32)
 s_barrier
 v_add_u32 v6, 65536, v4
 v_add_u32 v7, 65536, v5
 ds_read_b64_tr_b16 a[0:1], v6 offset:0
 ds_read_b64_tr_b16 a[2:3], v6 offset:512
 ds_read_b64_tr_b16 a[4:5], v6 offset:1024
 ds_read_b64_tr_b16 a[6:7], v6 offset:1536
 ds_read_b64_tr_b16 a[8:9], v7 offset:0
 ds_read_b64_tr_b16 a[10:11], v7 offset:512
 ds_read_b64_tr_b16 a[12:13], v7 offset:1024
 ds_read_b64_tr_b16 a[14:15], v7 offset:1536
 ds_read_b64_tr_b16 a[16:17], v6 offset:8192
 ds_read_b64_tr_b16 a[18:19], v6 offset:8704
 ds_read_b64_tr_b16 a[20:21], v6 offset:9216
 ds_read_b64_tr_b16 a[22:23], v6 offset:9728
 ds_read_b64_tr_b16 a[24:25], v7 offset:8192
 ds_read_b64_tr_b16 a[26:27], v7 offset:8704
 ds_read_b64_tr_b16 a[28:29], v7 offset:9216
 ds_read_b64_tr_b16 a[30:31], v7 offset:9728
 s_waitcnt lgkmcnt(0)
 s_barrier
 s_add_u32 m0, s78, 65536
 s_nop 0
 buffer_load_dwordx4 v2, s[8:11], s76 offen lds
 s_add_u32 s76, s76, 32768
 s_add_u32 m0, s78, 66560
 s_nop 0
 buffer_load_dwordx4 v2, s[8:11], s76 offen lds
 s_add_u32 s76, s76, 32768
 s_add_u32 m0, s78, 67584
 s_nop 0
 buffer_load_dwordx4 v3, s[8:11], s76 offen lds
 s_add_u32 s76, s76, 32768
 s_add_u32 m0, s78, 68608
 s_nop 0
 buffer_load_dwordx4 v3, s[8:11], s76 offen lds
 s_add_u32 s76, s76, 32768
 s_add_u32 m0, s78, 69632
 s_nop 0
 buffer_load_dwordx4 v2, s[8:11], s76 offen lds
 s_add_u32 s76, s76, 32768
 s_add_u32 m0, s78, 70656
 s_nop 0
 buffer_load_dwordx4 v2, s[8:11], s76 offen lds
 s_add_u32 s76, s76, 32768
 s_add_u32 m0, s78, 71680
 s_nop 0
 buffer_load_dwordx4 v3, s[8:11], s76 offen lds
 s_add_u32 s76, s76, 32768
 s_add_u32 m0, s78, 72704
 s_nop 0
 buffer_load_dwordx4 v3, s[8:11], s76 offen lds
 s_add_u32 s76, s76, 294912
 s_waitcnt vmcnt(32)
 s_barrier
 v_add_u32 v6, 98304, v4
 v_add_u32 v7, 98304, v5
 ds_read_b64_tr_b16 a[32:33], v6 offset:0
 ds_read_b64_tr_b16 a[34:35], v6 offset:512
 ds_read_b64_tr_b16 a[36:37], v6 offset:1024
 ds_read_b64_tr_b16 a[38:39], v6 offset:1536
 ds_read_b64_tr_b16 a[40:41], v7 offset:0
 ds_read_b64_tr_b16 a[42:43], v7 offset:512
 ds_read_b64_tr_b16 a[44:45], v7 offset:1024
 ds_read_b64_tr_b16 a[46:47], v7 offset:1536
 ds_read_b64_tr_b16 a[48:49], v6 offset:8192
 ds_read_b64_tr_b16 a[50:51], v6 offset:8704
 ds_read_b64_tr_b16 a[52:53], v6 offset:9216
 ds_read_b64_tr_b16 a[54:55], v6 offset:9728
 ds_read_b64_tr_b16 a[56:57], v7 offset:8192
 ds_read_b64_tr_b16 a[58:59], v7 offset:8704
 ds_read_b64_tr_b16 a[60:61], v7 offset:9216
 ds_read_b64_tr_b16 a[62:63], v7 offset:9728
 s_waitcnt lgkmcnt(0)
 s_barrier
 s_add_u32 m0, s78, 98304
 s_nop 0
 buffer_load_dwordx4 v2, s[8:11], s76 offen lds
 s_add_u32 s76, s76, 32768
 s_add_u32 m0, s78, 99328
 s_nop 0
 buffer_load_dwordx4 v2, s[8:11], s76 offen lds
 s_add_u32 s76, s76, 32768
 s_add_u32 m0, s78, 100352
 s_nop 0
 buffer_load_dwordx4 v3, s[8:11], s76 offen lds
 s_add_u32 s76, s76, 32768
 s_add_u32 m0, s78, 101376
 s_nop 0
 buffer_load_dwordx4 v3, s[8:11], s76 offen lds
 s_add_u32 s76, s76, 32768
 s_add_u32 m0, s78, 102400
 s_nop 0
 buffer_load_dwordx4 v2, s[8:11], s76 offen lds
 s_add_u32 s76, s76, 32768
 s_add_u32 m0, s78, 103424
 s_nop 0
 buffer_load_dwordx4 v2, s[8:11], s76 offen lds
 s_add_u32 s76, s76, 32768
 s_add_u32 m0, s78, 104448
 s_nop 0
 buffer_load_dwordx4 v3, s[8:11], s76 offen lds
 s_add_u32 s76, s76, 32768
 s_add_u32 m0, s78, 105472
 s_nop 0
 buffer_load_dwordx4 v3, s[8:11], s76 offen lds
 s_add_u32 s76, s76, 294912
 s_waitcnt vmcnt(32)
 s_barrier
 v_add_u32 v6, 131072, v4
 v_add_u32 v7, 131072, v5
 ds_read_b64_tr_b16 a[64:65], v6 offset:0
 ds_read_b64_tr_b16 a[66:67], v6 offset:512
 ds_read_b64_tr_b16 a[68:69], v6 offset:1024
 ds_read_b64_tr_b16 a[70:71], v6 offset:1536
 ds_read_b64_tr_b16 a[72:73], v7 offset:0
 ds_read_b64_tr_b16 a[74:75], v7 offset:512
 ds_read_b64_tr_b16 a[76:77], v7 offset:1024
 ds_read_b64_tr_b16 a[78:79], v7 offset:1536
 ds_read_b64_tr_b16 a[80:81], v6 offset:8192
 ds_read_b64_tr_b16 a[82:83], v6 offset:8704
 ds_read_b64_tr_b16 a[84:85], v6 offset:9216
 ds_read_b64_tr_b16 a[86:87], v6 offset:9728
 ds_read_b64_tr_b16 a[88:89], v7 offset:8192
 ds_read_b64_tr_b16 a[90:91], v7 offset:8704
 ds_read_b64_tr_b16 a[92:93], v7 offset:9216
 ds_read_b64_tr_b16 a[94:95], v7 offset:9728
 s_waitcnt lgkmcnt(0)
 s_barrier
 s_add_u32 m0, s78, 131072
 s_nop 0
 buffer_load_dwordx4 v2, s[8:11], s76 offen lds
 s_add_u32 s76, s76, 32768
 s_add_u32 m0, s78, 132096
 s_nop 0
 buffer_load_dwordx4 v2, s[8:11], s76 offen lds
 s_add_u32 s76, s76, 32768
 s_add_u32 m0, s78, 133120
 s_nop 0
 buffer_load_dwordx4 v3, s[8:11], s76 offen lds
 s_add_u32 s76, s76, 32768
 s_add_u32 m0, s78, 134144
 s_nop 0
 buffer_load_dwordx4 v3, s[8:11], s76 offen lds
 s_add_u32 s76, s76, 32768
 s_add_u32 m0, s78, 135168
 s_nop 0
 buffer_load_dwordx4 v2, s[8:11], s76 offen lds
 s_add_u32 s76, s76, 32768
 s_add_u32 m0, s78, 136192
 s_nop 0
 buffer_load_dwordx4 v2, s[8:11], s76 offen lds
 s_add_u32 s76, s76, 32768
 s_add_u32 m0, s78, 137216
 s_nop 0
 buffer_load_dwordx4 v3, s[8:11], s76 offen lds
 s_add_u32 s76, s76, 32768
 s_add_u32 m0, s78, 138240
 s_nop 0
 buffer_load_dwordx4 v3, s[8:11], s76 offen lds
 s_add_u32 s76, s76, 294912
 s_waitcnt vmcnt(32)
 s_barrier
 v_add_u32 v6, 0, v4
 v_add_u32 v7, 0, v5
 ds_read_b64_tr_b16 a[96:97], v6 offset:0
 ds_read_b64_tr_b16 a[98:99], v6 offset:512
 ds_read_b64_tr_b16 a[100:101], v6 offset:1024
 ds_read_b64_tr_b16 a[102:103], v6 offset:1536
 ds_read_b64_tr_b16 a[104:105], v7 offset:0
 ds_read_b64_tr_b16 a[106:107], v7 offset:512
 ds_read_b64_tr_b16 a[108:109], v7 offset:1024
 ds_read_b64_tr_b16 a[110:111], v7 offset:1536
 ds_read_b64_tr_b16 a[112:113], v6 offset:8192
 ds_read_b64_tr_b16 a[114:115], v6 offset:8704
 ds_read_b64_tr_b16 a[116:117], v6 offset:9216
 ds_read_b64_tr_b16 a[118:119], v6 offset:9728
 ds_read_b64_tr_b16 a[120:121], v7 offset:8192
 ds_read_b64_tr_b16 a[122:123], v7 offset:8704
 ds_read_b64_tr_b16 a[124:125], v7 offset:9216
 ds_read_b64_tr_b16 a[126:127], v7 offset:9728
 s_waitcnt lgkmcnt(0)
 s_barrier
 s_mov_b32 s8, s26
 s_and_b32 s9, s27, 0xffff
 s_mov_b32 s10, 5242880
 s_mov_b32 s11, 0x00020000
 v_lshrrev_b32 v2, 4, v0
 v_and_b32 v14, 1, v2
 v_lshlrev_b32 v14, 1, v14
 v_xor_b32 v14, v14, v0
 s_and_b32 s3, s50, 1
 s_lshl_b32 s3, s3, 3
 v_xor_b32 v14, s3, v14
 v_and_b32 v14, 15, v14
 s_mov_b32 s3, 1280
 v_mul_lo_u32 v2, v2, s3
 v_lshl_add_u32 v2, v14, 4, v2
 v_xor_b32 v3, 64, v2
 s_lshl_b32 s3, s52, 2
 s_add_u32 s3, s3, s50
 s_mul_i32 s76, s3, 40960
 s_add_u32 m0, s78, 0
 s_nop 0
 buffer_load_dwordx4 v2, s[8:11], s76 offen lds
 s_add_u32 s76, s76, 5120
 s_add_u32 m0, s78, 1024
 s_nop 0
 buffer_load_dwordx4 v2, s[8:11], s76 offen lds
 s_add_u32 s76, s76, 5120
 s_add_u32 m0, s78, 2048
 s_nop 0
 buffer_load_dwordx4 v2, s[8:11], s76 offen lds
 s_add_u32 s76, s76, 5120
 s_add_u32 m0, s78, 3072
 s_nop 0
 buffer_load_dwordx4 v2, s[8:11], s76 offen lds
 s_add_u32 s76, s76, 5120
 s_add_u32 m0, s78, 4096
 s_nop 0
 buffer_load_dwordx4 v3, s[8:11], s76 offen lds
 s_add_u32 s76, s76, 5120
 s_add_u32 m0, s78, 5120
 s_nop 0
 buffer_load_dwordx4 v3, s[8:11], s76 offen lds
 s_add_u32 s76, s76, 5120
 s_add_u32 m0, s78, 6144
 s_nop 0
 buffer_load_dwordx4 v3, s[8:11], s76 offen lds
 s_add_u32 s76, s76, 5120
 s_add_u32 m0, s78, 7168
 s_nop 0
 buffer_load_dwordx4 v3, s[8:11], s76 offen lds
 s_add_u32 s76, s76, 4294931712
 s_waitcnt vmcnt(32)
 s_barrier
 v_add_u32 v6, 32768, v4
 v_add_u32 v7, 32768, v5
 ds_read_b64_tr_b16 a[128:129], v6 offset:0
 ds_read_b64_tr_b16 a[130:131], v6 offset:512
 ds_read_b64_tr_b16 a[132:133], v6 offset:1024
 ds_read_b64_tr_b16 a[134:135], v6 offset:1536
 ds_read_b64_tr_b16 a[136:137], v7 offset:0
 ds_read_b64_tr_b16 a[138:139], v7 offset:512
 ds_read_b64_tr_b16 a[140:141], v7 offset:1024
 ds_read_b64_tr_b16 a[142:143], v7 offset:1536
 ds_read_b64_tr_b16 a[144:145], v6 offset:8192
 ds_read_b64_tr_b16 a[146:147], v6 offset:8704
 ds_read_b64_tr_b16 a[148:149], v6 offset:9216
 ds_read_b64_tr_b16 a[150:151], v6 offset:9728
 ds_read_b64_tr_b16 a[152:153], v7 offset:8192
 ds_read_b64_tr_b16 a[154:155], v7 offset:8704
 ds_read_b64_tr_b16 a[156:157], v7 offset:9216
 ds_read_b64_tr_b16 a[158:159], v7 offset:9728
 s_waitcnt lgkmcnt(0)
 s_barrier
 s_add_u32 m0, s78, 32768
 s_nop 0
 buffer_load_dwordx4 v2, s[8:11], s76 offen lds
 s_add_u32 s76, s76, 5120
 s_add_u32 m0, s78, 33792
 s_nop 0
 buffer_load_dwordx4 v2, s[8:11], s76 offen lds
 s_add_u32 s76, s76, 5120
 s_add_u32 m0, s78, 34816
 s_nop 0
 buffer_load_dwordx4 v2, s[8:11], s76 offen lds
 s_add_u32 s76, s76, 5120
 s_add_u32 m0, s78, 35840
 s_nop 0
 buffer_load_dwordx4 v2, s[8:11], s76 offen lds
 s_add_u32 s76, s76, 5120
 s_add_u32 m0, s78, 36864
 s_nop 0
 buffer_load_dwordx4 v3, s[8:11], s76 offen lds
 s_add_u32 s76, s76, 5120
 s_add_u32 m0, s78, 37888
 s_nop 0
 buffer_load_dwordx4 v3, s[8:11], s76 offen lds
 s_add_u32 s76, s76, 5120
 s_add_u32 m0, s78, 38912
 s_nop 0
 buffer_load_dwordx4 v3, s[8:11], s76 offen lds
 s_add_u32 s76, s76, 5120
 s_add_u32 m0, s78, 39936
 s_nop 0
 buffer_load_dwordx4 v3, s[8:11], s76 offen lds
 s_add_u32 s76, s76, 4294931712
 s_waitcnt vmcnt(32)
 s_barrier
 v_add_u32 v6, 65536, v4
 v_add_u32 v7, 65536, v5
 ds_read_b64_tr_b16 a[160:161], v6 offset:0
 ds_read_b64_tr_b16 a[162:163], v6 offset:512
 ds_read_b64_tr_b16 a[164:165], v6 offset:1024
 ds_read_b64_tr_b16 a[166:167], v6 offset:1536
 ds_read_b64_tr_b16 a[168:169], v7 offset:0
 ds_read_b64_tr_b16 a[170:171], v7 offset:512
 ds_read_b64_tr_b16 a[172:173], v7 offset:1024
 ds_read_b64_tr_b16 a[174:175], v7 offset:1536
 ds_read_b64_tr_b16 a[176:177], v6 offset:8192
 ds_read_b64_tr_b16 a[178:179], v6 offset:8704
 ds_read_b64_tr_b16 a[180:181], v6 offset:9216
 ds_read_b64_tr_b16 a[182:183], v6 offset:9728
 ds_read_b64_tr_b16 a[184:185], v7 offset:8192
 ds_read_b64_tr_b16 a[186:187], v7 offset:8704
 ds_read_b64_tr_b16 a[188:189], v7 offset:9216
 ds_read_b64_tr_b16 a[190:191], v7 offset:9728
 s_waitcnt lgkmcnt(0)
 s_barrier
 s_add_u32 m0, s78, 65536
 s_nop 0
 buffer_load_dwordx4 v2, s[8:11], s76 offen lds
 s_add_u32 s76, s76, 5120
 s_add_u32 m0, s78, 66560
 s_nop 0
 buffer_load_dwordx4 v2, s[8:11], s76 offen lds
 s_add_u32 s76, s76, 5120
 s_add_u32 m0, s78, 67584
 s_nop 0
 buffer_load_dwordx4 v2, s[8:11], s76 offen lds
 s_add_u32 s76, s76, 5120
 s_add_u32 m0, s78, 68608
 s_nop 0
 buffer_load_dwordx4 v2, s[8:11], s76 offen lds
 s_add_u32 s76, s76, 5120
 s_add_u32 m0, s78, 69632
 s_nop 0
 buffer_load_dwordx4 v3, s[8:11], s76 offen lds
 s_add_u32 s76, s76, 5120
 s_add_u32 m0, s78, 70656
 s_nop 0
 buffer_load_dwordx4 v3, s[8:11], s76 offen lds
 s_add_u32 s76, s76, 5120
 s_add_u32 m0, s78, 71680
 s_nop 0
 buffer_load_dwordx4 v3, s[8:11], s76 offen lds
 s_add_u32 s76, s76, 5120
 s_add_u32 m0, s78, 72704
 s_nop 0
 buffer_load_dwordx4 v3, s[8:11], s76 offen lds
 s_add_u32 s76, s76, 4294931712
 s_waitcnt vmcnt(32)
 s_barrier
 v_add_u32 v6, 98304, v4
 v_add_u32 v7, 98304, v5
 ds_read_b64_tr_b16 a[192:193], v6 offset:0
 ds_read_b64_tr_b16 a[194:195], v6 offset:512
 ds_read_b64_tr_b16 a[196:197], v6 offset:1024
 ds_read_b64_tr_b16 a[198:199], v6 offset:1536
 ds_read_b64_tr_b16 a[200:201], v7 offset:0
 ds_read_b64_tr_b16 a[202:203], v7 offset:512
 ds_read_b64_tr_b16 a[204:205], v7 offset:1024
 ds_read_b64_tr_b16 a[206:207], v7 offset:1536
 ds_read_b64_tr_b16 a[208:209], v6 offset:8192
 ds_read_b64_tr_b16 a[210:211], v6 offset:8704
 ds_read_b64_tr_b16 a[212:213], v6 offset:9216
 ds_read_b64_tr_b16 a[214:215], v6 offset:9728
 ds_read_b64_tr_b16 a[216:217], v7 offset:8192
 ds_read_b64_tr_b16 a[218:219], v7 offset:8704
 ds_read_b64_tr_b16 a[220:221], v7 offset:9216
 ds_read_b64_tr_b16 a[222:223], v7 offset:9728
 s_waitcnt lgkmcnt(0)
 s_barrier
 s_add_u32 m0, s78, 98304
 s_nop 0
 buffer_load_dwordx4 v2, s[8:11], s76 offen lds
 s_add_u32 s76, s76, 5120
 s_add_u32 m0, s78, 99328
 s_nop 0
 buffer_load_dwordx4 v2, s[8:11], s76 offen lds
 s_add_u32 s76, s76, 5120
 s_add_u32 m0, s78, 100352
 s_nop 0
 buffer_load_dwordx4 v2, s[8:11], s76 offen lds
 s_add_u32 s76, s76, 5120
 s_add_u32 m0, s78, 101376
 s_nop 0
 buffer_load_dwordx4 v2, s[8:11], s76 offen lds
 s_add_u32 s76, s76, 5120
 s_add_u32 m0, s78, 102400
 s_nop 0
 buffer_load_dwordx4 v3, s[8:11], s76 offen lds
 s_add_u32 s76, s76, 5120
 s_add_u32 m0, s78, 103424
 s_nop 0
 buffer_load_dwordx4 v3, s[8:11], s76 offen lds
 s_add_u32 s76, s76, 5120
 s_add_u32 m0, s78, 104448
 s_nop 0
 buffer_load_dwordx4 v3, s[8:11], s76 offen lds
 s_add_u32 s76, s76, 5120
 s_add_u32 m0, s78, 105472
 s_nop 0
 buffer_load_dwordx4 v3, s[8:11], s76 offen lds
 s_add_u32 s76, s76, 4294931712
 s_waitcnt vmcnt(32)
 s_barrier
 v_add_u32 v6, 131072, v4
 v_add_u32 v7, 131072, v5
 ds_read_b64_tr_b16 a[224:225], v6 offset:0
 ds_read_b64_tr_b16 a[226:227], v6 offset:512
 ds_read_b64_tr_b16 a[228:229], v6 offset:1024
 ds_read_b64_tr_b16 a[230:231], v6 offset:1536
 ds_read_b64_tr_b16 a[232:233], v7 offset:0
 ds_read_b64_tr_b16 a[234:235], v7 offset:512
 ds_read_b64_tr_b16 a[236:237], v7 offset:1024
 ds_read_b64_tr_b16 a[238:239], v7 offset:1536
 ds_read_b64_tr_b16 a[240:241], v6 offset:8192
 ds_read_b64_tr_b16 a[242:243], v6 offset:8704
 ds_read_b64_tr_b16 a[244:245], v6 offset:9216
 ds_read_b64_tr_b16 a[246:247], v6 offset:9728
 ds_read_b64_tr_b16 a[248:249], v7 offset:8192
 ds_read_b64_tr_b16 a[250:251], v7 offset:8704
 ds_read_b64_tr_b16 a[252:253], v7 offset:9216
 ds_read_b64_tr_b16 a[254:255], v7 offset:9728
 s_waitcnt lgkmcnt(0)
 s_barrier
 s_add_u32 m0, s78, 131072
 s_nop 0
 buffer_load_dwordx4 v2, s[8:11], s76 offen lds
 s_add_u32 s76, s76, 5120
 s_add_u32 m0, s78, 132096
 s_nop 0
 buffer_load_dwordx4 v2, s[8:11], s76 offen lds
 s_add_u32 s76, s76, 5120
 s_add_u32 m0, s78, 133120
 s_nop 0
 buffer_load_dwordx4 v2, s[8:11], s76 offen lds
 s_add_u32 s76, s76, 5120
 s_add_u32 m0, s78, 134144
 s_nop 0
 buffer_load_dwordx4 v2, s[8:11], s76 offen lds
 s_add_u32 s76, s76, 5120
 s_add_u32 m0, s78, 135168
 s_nop 0
 buffer_load_dwordx4 v3, s[8:11], s76 offen lds
 s_add_u32 s76, s76, 5120
 s_add_u32 m0, s78, 136192
 s_nop 0
 buffer_load_dwordx4 v3, s[8:11], s76 offen lds
 s_add_u32 s76, s76, 5120
 s_add_u32 m0, s78, 137216
 s_nop 0
 buffer_load_dwordx4 v3, s[8:11], s76 offen lds
 s_add_u32 s76, s76, 5120
 s_add_u32 m0, s78, 138240
 s_nop 0
 buffer_load_dwordx4 v3, s[8:11], s76 offen lds
 s_add_u32 s76, s76, 4294931712
 v_bfe_u32 v14, v0, 2, 1
 v_lshlrev_b32 v4, 8, v14
 v_lshl_add_u32 v4, v14, 5, v4
 v_bfe_u32 v14, v0, 4, 1
 v_lshl_add_u32 v4, v14, 12, v4
 v_lshl_add_u32 v4, v14, 6, v4
 v_bfe_u32 v14, v0, 5, 1
 v_lshl_add_u32 v4, v14, 10, v4
 v_and_b32 v14, 3, v0
 v_lshl_add_u32 v4, v14, 3, v4
 v_bfe_u32 v14, v0, 3, 1
 v_mul_u32_u24 v14, 32, v14
 v_xor_b32 v4, v4, v14
 s_mov_b32 s96, s44
 s_and_b32 s97, s45, 0xffff
 s_mov_b32 s98, 256
 s_mov_b32 s99, 0x00020000
 v_mov_b32 v8, 132
 s_mov_b32 s3, 144
 v_writelane_b32 v8, s3, 1
 s_mov_b32 s51, 0
 s_mov_b64 exec, 3
L_wb_197:
 buffer_load_dword v9, v8, s[96:99], 0 offen sc1
 s_waitcnt vmcnt(0)
 v_cmp_eq_u32 vcc, 0, v9
 s_cbranch_vccz L_wbd_198
 s_sleep 2
 s_add_u32 s51, s51, 1
 s_cmp_lt_u32 s51, 131072
 s_cbranch_scc1 L_wb_197
 s_branch L_bail
L_wbd_198:
 s_mov_b64 exec, -1
 v_readlane_b32 s81, v9, 1
 s_nop 3
 s_sub_u32 s81, s81, 1
 s_mov_b32 s96, s44
 s_and_b32 s97, s45, 0xffff
 s_mov_b32 s98, 256
 s_mov_b32 s99, 0x00020000
 v_lshlrev_b32 v8, 5, v0
 s_mov_b32 s51, 0
L_gl_199:
 buffer_load_dword v9, v8, s[96:99], 0 offen sc1
 s_waitcnt vmcnt(0)
 v_readlane_b32 s3, v9, s48
 s_mov_b32 s80, 0
 s_nop 2
 s_cmp_ge_u32 s3, 32
 s_cbranch_scc1 L_gld_200
 s_mov_b32 s80, 0
 v_readlane_b32 s3, v9, 0
 s_nop 3
 s_add_u32 s80, s80, s3
 v_readlane_b32 s3, v9, 1
 s_nop 3
 s_add_u32 s80, s80, s3
 v_readlane_b32 s3, v9, 2
 s_nop 3
 s_add_u32 s80, s80, s3
 v_readlane_b32 s3, v9, 3
 s_nop 3
 s_add_u32 s80, s80, s3
 v_readlane_b32 s3, v9, 4
 s_nop 3
 s_add_u32 s80, s80, s3
 v_readlane_b32 s3, v9, 5
 s_nop 3
 s_add_u32 s80, s80, s3
 v_readlane_b32 s3, v9, 6
 s_nop 3
 s_add_u32 s80, s80, s3
 v_readlane_b32 s3, v9, 7
 s_nop 3
 s_add_u32 s80, s80, s3
 s_cmp_ge_u32 s80, 256
 s_cbranch_scc1 L_gld_200
 s_sleep 4
 s_add_u32 s51, s51, 1
 s_cmp_lt_u32 s51, 131072
 s_cbranch_scc1 L_gl_199
 s_branch L_bail
L_gld_200:
 s_waitcnt vmcnt(0)
 s_barrier
 s_mul_i32 s76, s50, 10
 s_and_b32 s3, s50, 1
 s_mul_i32 s3, s3, 2
 s_add_u32 s76, s76, s3
 s_add_u32 s76, s76, 0
 s_and_b32 s3, s76, 7
 s_lshl_b32 s3, s3, 5
 v_xor_b32 v6, s3, v4
 s_lshr_b32 s3, s76, 3
 s_lshl_b32 s3, s3, 15
 v_add_u32 v6, s3, v6
 v_xor_b32 v7, 128, v6
 ds_read_b64_tr_b16 v[32:33], v6 offset:0
 ds_read_b64_tr_b16 v[34:35], v6 offset:512
 ds_read_b64_tr_b16 v[36:37], v6 offset:2048
 ds_read_b64_tr_b16 v[38:39], v6 offset:2560
 ds_read_b64_tr_b16 v[48:49], v7 offset:8192
 ds_read_b64_tr_b16 v[50:51], v7 offset:8704
 ds_read_b64_tr_b16 v[52:53], v7 offset:10240
 ds_read_b64_tr_b16 v[54:55], v7 offset:10752
 ds_read_b64_tr_b16 v[64:65], v6 offset:16384
 ds_read_b64_tr_b16 v[66:67], v6 offset:16896
 ds_read_b64_tr_b16 v[68:69], v6 offset:18432
 ds_read_b64_tr_b16 v[70:71], v6 offset:18944
 ds_read_b64_tr_b16 v[136:137], v7 offset:24576
 ds_read_b64_tr_b16 v[138:139], v7 offset:25088
 ds_read_b64_tr_b16 v[140:141], v7 offset:26624
 ds_read_b64_tr_b16 v[142:143], v7 offset:27136
 s_mul_i32 s76, s50, 10
 s_and_b32 s3, s50, 1
 s_mul_i32 s3, s3, 2
 s_add_u32 s76, s76, s3
 s_add_u32 s76, s76, 2
 s_and_b32 s3, s76, 7
 s_lshl_b32 s3, s3, 5
 v_xor_b32 v6, s3, v4
 s_lshr_b32 s3, s76, 3
 s_lshl_b32 s3, s3, 15
 v_add_u32 v6, s3, v6
 v_xor_b32 v7, 128, v6
 ds_read_b64_tr_b16 v[40:41], v6 offset:0
 ds_read_b64_tr_b16 v[42:43], v6 offset:512
 ds_read_b64_tr_b16 v[44:45], v6 offset:2048
 ds_read_b64_tr_b16 v[46:47], v6 offset:2560
 ds_read_b64_tr_b16 v[56:57], v7 offset:8192
 ds_read_b64_tr_b16 v[58:59], v7 offset:8704
 ds_read_b64_tr_b16 v[60:61], v7 offset:10240
 ds_read_b64_tr_b16 v[62:63], v7 offset:10752
 ds_read_b64_tr_b16 v[128:129], v6 offset:16384
 ds_read_b64_tr_b16 v[130:131], v6 offset:16896
 ds_read_b64_tr_b16 v[132:133], v6 offset:18432
 ds_read_b64_tr_b16 v[134:135], v6 offset:18944
 ds_read_b64_tr_b16 v[144:145], v7 offset:24576
 ds_read_b64_tr_b16 v[146:147], v7 offset:25088
 ds_read_b64_tr_b16 v[148:149], v7 offset:26624
 ds_read_b64_tr_b16 v[150:151], v7 offset:27136
 s_mul_i32 s76, s50, 10
 s_and_b32 s3, s50, 1
 s_mul_i32 s3, s3, 2
 s_add_u32 s76, s76, s3
 s_add_u32 s76, s76, 4
 s_and_b32 s3, s76, 7
 s_lshl_b32 s3, s3, 5
 v_xor_b32 v6, s3, v4
 s_lshr_b32 s3, s76, 3
 s_lshl_b32 s3, s3, 15
 v_add_u32 v6, s3, v6
 v_xor_b32 v7, 128, v6
 ds_read_b64_tr_b16 v[152:153], v6 offset:0
 ds_read_b64_tr_b16 v[154:155], v6 offset:512
 ds_read_b64_tr_b16 v[156:157], v6 offset:2048
 ds_read_b64_tr_b16 v[158:159], v6 offset:2560
 ds_read_b64_tr_b16 v[168:169], v7 offset:8192
 ds_read_b64_tr_b16 v[170:171], v7 offset:8704
 ds_read_b64_tr_b16 v[172:173], v7 offset:10240
 ds_read_b64_tr_b16 v[174:175], v7 offset:10752
 ds_read_b64_tr_b16 v[184:185], v6 offset:16384
 ds_read_b64_tr_b16 v[186:187], v6 offset:16896
 ds_read_b64_tr_b16 v[188:189], v6 offset:18432
 ds_read_b64_tr_b16 v[190:191], v6 offset:18944
 ds_read_b64_tr_b16 v[80:81], v7 offset:24576
 ds_read_b64_tr_b16 v[82:83], v7 offset:25088
 ds_read_b64_tr_b16 v[84:85], v7 offset:26624
 ds_read_b64_tr_b16 v[86:87], v7 offset:27136
 s_mul_i32 s76, s50, 10
 s_and_b32 s3, s50, 1
 s_mul_i32 s3, s3, 2
 s_add_u32 s76, s76, s3
 s_add_u32 s76, s76, 6
 s_and_b32 s3, s76, 7
 s_lshl_b32 s3, s3, 5
 v_xor_b32 v6, s3, v4
 s_lshr_b32 s3, s76, 3
 s_lshl_b32 s3, s3, 15
 v_add_u32 v6, s3, v6
 v_xor_b32 v7, 128, v6
 ds_read_b64_tr_b16 v[160:161], v6 offset:0
 ds_read_b64_tr_b16 v[162:163], v6 offset:512
 ds_read_b64_tr_b16 v[164:165], v6 offset:2048
 ds_read_b64_tr_b16 v[166:167], v6 offset:2560
 ds_read_b64_tr_b16 v[176:177], v7 offset:8192
 ds_read_b64_tr_b16 v[178:179], v7 offset:8704
 ds_read_b64_tr_b16 v[180:181], v7 offset:10240
 ds_read_b64_tr_b16 v[182:183], v7 offset:10752
 ds_read_b64_tr_b16 v[72:73], v6 offset:16384
 ds_read_b64_tr_b16 v[74:75], v6 offset:16896
 ds_read_b64_tr_b16 v[76:77], v6 offset:18432
 ds_read_b64_tr_b16 v[78:79], v6 offset:18944
 ds_read_b64_tr_b16 v[88:89], v7 offset:24576
 ds_read_b64_tr_b16 v[90:91], v7 offset:25088
 ds_read_b64_tr_b16 v[92:93], v7 offset:26624
 ds_read_b64_tr_b16 v[94:95], v7 offset:27136
 s_mul_i32 s76, s50, 10
 s_and_b32 s3, s50, 1
 s_mul_i32 s3, s3, -8
 s_add_u32 s76, s76, s3
 s_add_u32 s76, s76, 8
 s_and_b32 s3, s76, 7
 s_lshl_b32 s3, s3, 5
 v_xor_b32 v6, s3, v4
 s_lshr_b32 s3, s76, 3
 s_lshl_b32 s3, s3, 15
 v_add_u32 v6, s3, v6
 v_xor_b32 v7, 128, v6
 ds_read_b64_tr_b16 v[96:97], v6 offset:0
 ds_read_b64_tr_b16 v[98:99], v6 offset:512
 ds_read_b64_tr_b16 v[100:101], v6 offset:2048
 ds_read_b64_tr_b16 v[102:103], v6 offset:2560
 ds_read_b64_tr_b16 v[104:105], v7 offset:8192
 ds_read_b64_tr_b16 v[106:107], v7 offset:8704
 ds_read_b64_tr_b16 v[108:109], v7 offset:10240
 ds_read_b64_tr_b16 v[110:111], v7 offset:10752
 ds_read_b64_tr_b16 v[112:113], v6 offset:16384
 ds_read_b64_tr_b16 v[114:115], v6 offset:16896
 ds_read_b64_tr_b16 v[116:117], v6 offset:18432
 ds_read_b64_tr_b16 v[118:119], v6 offset:18944
 ds_read_b64_tr_b16 v[120:121], v7 offset:24576
 ds_read_b64_tr_b16 v[122:123], v7 offset:25088
 ds_read_b64_tr_b16 v[124:125], v7 offset:26624
 ds_read_b64_tr_b16 v[126:127], v7 offset:27136
 v_lshlrev_b32 v1, 4, v0
 s_lshl_b32 s3, s50, 15
 s_add_u32 s3, s3, 32768
 v_add_u32 v15, s3, v1
 s_waitcnt lgkmcnt(0)
 s_barrier
 ds_write_b128 v15, v[224:227] offset:0
 ds_write_b128 v15, v[228:231] offset:1024
 ds_write_b128 v15, v[232:235] offset:2048
 ds_write_b128 v15, v[236:239] offset:3072
 ds_write_b128 v15, v[240:243] offset:4096
 ds_write_b128 v15, v[244:247] offset:5120
 ds_write_b128 v15, v[248:251] offset:6144
 ds_write_b128 v15, v[252:255] offset:7168
 ds_write_b128 v15, v[32:35] offset:8192
 ds_write_b128 v15, v[36:39] offset:9216
 ds_write_b128 v15, v[40:43] offset:10240
 ds_write_b128 v15, v[44:47] offset:11264
 ds_write_b128 v15, v[48:51] offset:12288
 ds_write_b128 v15, v[52:55] offset:13312
 ds_write_b128 v15, v[56:59] offset:14336
 ds_write_b128 v15, v[60:63] offset:15360
 ds_write_b128 v15, v[64:67] offset:16384
 ds_write_b128 v15, v[68:71] offset:17408
 ds_write_b128 v15, v[72:75] offset:18432
 ds_write_b128 v15, v[76:79] offset:19456
 ds_write_b128 v15, v[80:83] offset:20480
 ds_write_b128 v15, v[84:87] offset:21504
 ds_write_b128 v15, v[88:91] offset:22528
 ds_write_b128 v15, v[92:95] offset:23552
 ds_write_b128 v15, v[96:99] offset:24576
 ds_write_b128 v15, v[100:103] offset:25600
 ds_write_b128 v15, v[104:107] offset:26624
 ds_write_b128 v15, v[108:111] offset:27648
 ds_write_b128 v15, v[112:115] offset:28672
 ds_write_b128 v15, v[116:119] offset:29696
 ds_write_b128 v15, v[120:123] offset:30720
 ds_write_b128 v15, v[124:127] offset:31744
 s_xor_b32 s3, s81, 0
 s_and_b32 s3, s3, 1
 s_lshl_b32 s3, s3, 13
 s_add_u32 s56, s3, 4194304
 s_and_b32 s3, s48, 2
 s_lshl_b32 s3, s3, 15
 s_add_u32 s56, s56, s3
 s_xor_b32 s3, s81, 1
 s_and_b32 s3, s3, 1
 s_lshl_b32 s3, s3, 13
 s_add_u32 s57, s3, 6291456
 s_and_b32 s3, s48, 2
 s_lshl_b32 s3, s3, 15
 s_add_u32 s57, s57, s3
 s_xor_b32 s3, s81, 0
 s_and_b32 s3, s3, 1
 s_lshl_b32 s3, s3, 13
 s_add_u32 s58, s3, 8388608
 s_and_b32 s3, s48, 2
 s_lshl_b32 s3, s3, 15
 s_add_u32 s58, s58, s3
 s_xor_b32 s3, s81, 1
 s_and_b32 s3, s3, 1
 s_lshl_b32 s3, s3, 13
 s_add_u32 s59, s3, 10485760
 s_and_b32 s3, s48, 2
 s_lshl_b32 s3, s3, 15
 s_add_u32 s59, s59, s3
 v_lshrrev_b32 v2, 5, v0
 v_lshlrev_b32 v2, 15, v2
 v_bfe_u32 v14, v0, 2, 2
 v_lshl_add_u32 v2, v14, 8, v2
 v_bfe_u32 v14, v0, 4, 1
 v_lshl_add_u32 v2, v14, 6, v2
 v_and_b32 v14, 3, v0
 v_lshl_add_u32 v2, v14, 4, v2
 s_lshr_b32 s76, s50, 1
 s_and_b32 s77, s50, 1
 s_lshl_b32 s3, s76, 14
 v_add_u32 v2, s3, v2
 s_lshl_b32 s3, s77, 7
 s_add_u32 s3, s3, 2048
 v_add_u32 v3, s3, v2
 s_mul_i32 s3, s77, 3072
 v_add_u32 v2, s3, v2
 s_mul_i32 s76, s76, 5120
 s_add_u32 s3, s3, s76
 v_add_u32 v4, s3, v1
 s_lshl_b32 s3, s77, 3
 s_add_u32 s3, s3, s76
 s_add_u32 s3, s3, 2048
 v_add_u32 v5, s3, v1
 v_and_b32 v14, 2, v0
 v_cmp_eq_u32 vcc, 0, v14
 v_mov_b32 v17, 0xeeee
 v_mov_b32 v14, 0x4444
 s_nop 0
 v_cndmask_b32 v17, v17, v14, vcc
 s_lshl_b32 s78, s48, 4
 s_add_u32 s78, s78, s49
 s_lshl_b32 s32, s78, 8
 s_add_u32 s32, s32, 0
 s_mul_i32 s76, s78, 24576
 s_lshl_b32 s3, s50, 10
 s_add_u32 s77, s76, s3
 s_add_u32 s60, s77, 1736704
 s_add_u32 s61, s77, 1742848
 s_add_u32 s62, s77, 1748992
 s_add_u32 s63, s77, 1755136
 s_lshr_b32 s3, s50, 1
 s_lshl_b32 s3, s3, 10
 s_add_u32 s76, s76, s3
 s_and_b32 s3, s50, 1
 s_lshl_b32 s3, s3, 3
 s_add_u32 s76, s76, s3
 s_add_u32 s64, s76, 1740800
 s_add_u32 s65, s76, 1746944
 s_add_u32 s66, s76, 1753088
 s_add_u32 s67, s76, 1759232
 s_mul_i32 s76, s48, 327680
 s_lshl_b32 s3, s49, 8
 s_add_u32 s77, s76, s3
 s_lshr_b32 s3, s50, 1
 s_mul_i32 s3, s3, 81920
 s_add_u32 s77, s77, s3
 s_and_b32 s3, s50, 1
 s_mul_i32 s3, s3, 49152
 s_add_u32 s3, s3, s77
 s_add_u32 s68, s3, 425984
 s_add_u32 s69, s3, 442368
 s_and_b32 s3, s50, 1
 s_lshl_b32 s3, s3, 3
 s_add_u32 s3, s3, s77
 s_add_u32 s70, s3, 458752
 s_and_b32 s3, s50, 1
 s_mul_i32 s3, s3, 49152
 s_add_u32 s3, s3, s77
 s_add_u32 s71, s3, 589824
 s_add_u32 s72, s3, 606208
 s_and_b32 s3, s50, 1
 s_lshl_b32 s3, s3, 3
 s_add_u32 s3, s3, s77
 s_add_u32 s73, s3, 622592
 s_lshl_b32 s78, s49, 1
 s_and_b32 s3, s50, 1
 s_add_u32 s78, s78, s3
 s_lshr_b32 s55, s50, 1
 s_and_b32 s77, s49, 1
 s_lshl_b32 s77, s77, 2
 s_add_u32 s77, s77, s50
 s_add_u32 s3, s32, 128
 s_cmp_eq_u32 s77, 2
 s_cselect_b32 s17, s3, 268435456
 s_lshr_b32 s3, s49, 1
 s_add_u32 s3, s3, 32
 s_cmp_eq_u32 s77, 1
 s_cselect_b32 s78, s3, s78
 s_cselect_b32 s55, 1, s55
 s_lshl_b32 s3, s78, 12
 s_add_u32 s3, s3, s76
 s_add_u32 s74, s3, 425984
 s_add_u32 s75, s3, 589824
 v_add_u32 v12, 4096, v1
 v_lshrrev_b32 v14, 4, v0
 v_and_b32 v10, 15, v0
 v_lshlrev_b32 v6, 5, v10
 v_lshl_add_u32 v6, v14, 3, v6
 s_lshl_b32 s3, s50, 10
 v_add_u32 v6, s3, v6
 v_lshlrev_b32 v10, 4, v10
 v_lshl_add_u32 v10, v14, 12, v10
 v_lshlrev_b32 v7, 3, v0
 v_add_u32 v8, s3, v7
 s_lshl_b32 s3, s50, 11
 v_add_u32 v16, s3, v1
 s_lshr_b32 s3, s50, 1
 s_lshl_b32 s3, s3, 10
 s_and_b32 s77, s50, 1
 s_lshl_b32 s77, s77, 5
 s_add_u32 s3, s3, s77
 v_add_u32 v9, s3, v1
 v_lshlrev_b32 v11, 6, v14
 v_bfe_u32 v13, v0, 2, 1
 v_lshl_add_u32 v11, v13, 5, v11
 v_and_b32 v18, 1, v0
 v_lshl_add_u32 v11, v18, 4, v11
 s_lshl_b32 s3, s78, 8
 s_cmp_ge_u32 s78, 20
 s_cselect_b32 s77, 11264, 0
 s_add_u32 s3, s3, s77
 s_and_b32 s77, s48, 1
 s_lshl_b32 s77, s77, 15
 s_add_u32 s3, s3, s77
 s_cmp_eq_u32 s55, 0
 s_cselect_b32 s3, 268435456, s3
 v_add_u32 v11, s3, v11
 s_mov_b32 s8, s18
 s_and_b32 s9, s19, 0xffff
 s_mov_b32 s10, 10240
 s_mov_b32 s11, 0x00020000
 v_mul_u32_u24 v18, 1280, v18
 v_lshl_add_u32 v18, v13, 6, v18
 v_lshl_add_u32 v18, v14, 3, v18
 s_and_b32 s3, s78, 3
 s_mul_i32 s3, s3, 2560
 s_lshr_b32 s76, s78, 2
 s_lshl_b32 s76, s76, 7
 s_add_u32 s3, s3, s76
 s_add_u32 s3, s3, s77
 v_add_u32 v18, s3, v18
 buffer_load_dwordx2 v[20:21], v18, s[8:11], 0 offen
 buffer_load_dwordx2 v[22:23], v18, s[8:11], 0 offen offset:32
 buffer_load_dword v14, off, s[4:7], s32 sc1
 s_mov_b32 s28, 0x33333333
 s_mov_b32 s29, 0x33333333
 s_mov_b32 s30, 0x00330033
 s_mov_b32 s31, 0x00330033
 s_mov_b32 s79, 0x3e0293ee
 s_and_b32 s100, s52, 1
 s_lshl_b32 s100, s100, 13
 s_lshl_b32 s54, s52, 14
 s_add_u32 s54, s54, s100
 s_lshr_b32 s3, s48, 1
 s_mul_i32 s3, s3, 33554432
 s_add_u32 s54, s54, s3
 s_add_u32 s54, s54, 16777216
 s_waitcnt vmcnt(0) lgkmcnt(0)
 s_mov_b64 exec, s[30:31]
 buffer_store_dwordx4 v[20:23], v11, s[4:7], s56 offen sc1
 s_mov_b64 exec, -1
 v_mov_b32 v32, -1
 v_mov_b32 v28, 0x3f803f80
 v_mov_b32 v36, 0
 v_mov_b32 v33, -1
 v_mov_b32 v29, 0x3f803f80
 v_mov_b32 v37, 0
 v_mov_b32 v34, -1
 v_mov_b32 v30, 0x3f803f80
 v_mov_b32 v38, 0
 v_mov_b32 v35, -1
 v_mov_b32 v31, 0x3f803f80
 v_mov_b32 v39, 0
 v_mov_b32 v88, 0
 v_mov_b32 v89, 0
 v_mov_b32 v90, 0
 v_mov_b32 v91, 0
 v_mov_b32 v92, 0
 v_mov_b32 v93, 0
 v_mov_b32 v94, 0
 v_mov_b32 v95, 0
 v_mov_b32 v96, 0
 v_mov_b32 v97, 0
 v_mov_b32 v98, 0
 v_mov_b32 v99, 0
 v_mov_b32 v100, 0
 v_mov_b32 v101, 0
 v_mov_b32 v102, 0
 v_mov_b32 v103, 0
 v_and_b32 v18, 7, v0
 v_lshrrev_b32 v13, 1, v0
 v_xor_b32 v13, v13, v0
 v_and_b32 v13, 8, v13
 v_or_b32 v18, v18, v13
 v_mov_b32 v24, 0
 v_cmp_eq_u32 vcc, 0, v18
 v_mov_b32 v13, 0x3f80
 s_nop 1
 v_cndmask_b32 v24, v24, v13, vcc
 v_cmp_eq_u32 vcc, 1, v18
 v_mov_b32 v13, 0x3f800000
 s_nop 1
 v_cndmask_b32 v24, v24, v13, vcc
 v_mov_b32 v25, 0
 v_cmp_eq_u32 vcc, 2, v18
 v_mov_b32 v13, 0x3f80
 s_nop 1
 v_cndmask_b32 v25, v25, v13, vcc
 v_cmp_eq_u32 vcc, 3, v18
 v_mov_b32 v13, 0x3f800000
 s_nop 1
 v_cndmask_b32 v25, v25, v13, vcc
 v_mov_b32 v26, 0
 v_cmp_eq_u32 vcc, 4, v18
 v_mov_b32 v13, 0x3f80
 s_nop 1
 v_cndmask_b32 v26, v26, v13, vcc
 v_cmp_eq_u32 vcc, 5, v18
 v_mov_b32 v13, 0x3f800000
 s_nop 1
 v_cndmask_b32 v26, v26, v13, vcc
 v_mov_b32 v27, 0
 v_cmp_eq_u32 vcc, 6, v18
 v_mov_b32 v13, 0x3f80
 s_nop 1
 v_cndmask_b32 v27, v27, v13, vcc
 v_cmp_eq_u32 vcc, 7, v18
 v_mov_b32 v13, 0x3f800000
 s_nop 1
 v_cndmask_b32 v27, v27, v13, vcc
 s_waitcnt vmcnt(0)
 v_and_b32 v18, 7, v0
 v_mov_b32 v20, 0
 v_cmp_eq_u32 vcc, 0, v18
 v_mov_b32 v13, 0x3f80
 s_nop 1
 v_cndmask_b32 v20, v20, v13, vcc
 v_cmp_eq_u32 vcc, 1, v18
 v_mov_b32 v13, 0x3f800000
 s_nop 1
 v_cndmask_b32 v20, v20, v13, vcc
 v_mov_b32 v21, 0
 v_cmp_eq_u32 vcc, 2, v18
 v_mov_b32 v13, 0x3f80
 s_nop 1
 v_cndmask_b32 v21, v21, v13, vcc
 v_cmp_eq_u32 vcc, 3, v18
 v_mov_b32 v13, 0x3f800000
 s_nop 1
 v_cndmask_b32 v21, v21, v13, vcc
 v_mov_b32 v22, 0
 v_cmp_eq_u32 vcc, 4, v18
 v_mov_b32 v13, 0x3f80
 s_nop 1
 v_cndmask_b32 v22, v22, v13, vcc
 v_cmp_eq_u32 vcc, 5, v18
 v_mov_b32 v13, 0x3f800000
 s_nop 1
 v_cndmask_b32 v22, v22, v13, vcc
 v_mov_b32 v23, 0
 v_cmp_eq_u32 vcc, 6, v18
 v_mov_b32 v13, 0x3f80
 s_nop 1
 v_cndmask_b32 v23, v23, v13, vcc
 v_cmp_eq_u32 vcc, 7, v18
 v_mov_b32 v13, 0x3f800000
 s_nop 1
 v_cndmask_b32 v23, v23, v13, vcc
 v_mov_b32 v18, 0
 v_mov_b32 v19, 0
 v_and_b32 v0, -33, v1
 v_mov_b32 v13, 1
 s_mov_b32 s53, -1
 s_mov_b32 s51, 0
 s_cmp_lg_u32 s50, 0
 s_cbranch_scc1 L_k0_201
 s_add_u32 s76, s53, 1
L_fl_202:
 v_cmp_ge_u32 vcc, s76, v14
 s_cbranch_vccz L_fld_203
 buffer_load_dword v14, off, s[4:7], s32 sc1
 s_waitcnt vmcnt(0)
 s_add_u32 s51, s51, 1
 s_cmp_lt_u32 s51, 131072
 s_cbranch_scc1 L_fl_202
 s_branch L_bail
L_fld_203:
 s_lshl_b32 s16, s76, 19
 s_add_u32 s16, s16, s54
 s_mov_b32 m0, 10240
 s_nop 0
 buffer_load_dwordx4 v1, s[4:7], s16 offen offset:0 sc1 lds
 buffer_load_dwordx4 v1, s[4:7], s16 offen offset:1024 sc1 lds
 buffer_load_dwordx4 v1, s[4:7], s16 offen offset:2048 sc1 lds
 buffer_load_dwordx4 v1, s[4:7], s16 offen offset:3072 sc1 lds
 s_mov_b32 m0, 14336
 s_nop 0
 buffer_load_dwordx4 v12, s[4:7], s16 offen offset:0 sc1 lds
 buffer_load_dwordx4 v12, s[4:7], s16 offen offset:1024 sc1 lds
 buffer_load_dwordx4 v12, s[4:7], s16 offen offset:2048 sc1 lds
 buffer_load_dwordx4 v12, s[4:7], s16 offen offset:3072 sc1 lds
 s_add_u32 s16, s16, 67108864
 s_mov_b32 m0, 18432
 s_nop 0
 buffer_load_dwordx4 v1, s[4:7], s16 offen offset:0 sc1 lds
 buffer_load_dwordx4 v1, s[4:7], s16 offen offset:1024 sc1 lds
 buffer_load_dwordx4 v1, s[4:7], s16 offen offset:2048 sc1 lds
 buffer_load_dwordx4 v1, s[4:7], s16 offen offset:3072 sc1 lds
 s_mov_b32 m0, 22528
 s_nop 0
 buffer_load_dwordx4 v12, s[4:7], s16 offen offset:0 sc1 lds
 buffer_load_dwordx4 v12, s[4:7], s16 offen offset:1024 sc1 lds
 buffer_load_dwordx4 v12, s[4:7], s16 offen offset:2048 sc1 lds
 buffer_load_dwordx4 v12, s[4:7], s16 offen offset:3072 sc1 lds
L_k0_201:
 s_mov_b32 s53, 0
 s_cmp_lg_u32 s80, 0
 s_cbranch_scc1 L_ch_loops
.p2align 8
L_ch_loopf:
 s_mov_b32 s51, 0
 buffer_load_dwordx4 v[40:43], v2, s[4:7], s56 offen offset:0 sc1
 buffer_load_dwordx4 v[44:47], v2, s[4:7], s56 offen offset:128 sc1
 buffer_load_dwordx4 v[48:51], v2, s[4:7], s56 offen offset:1024 sc1
 buffer_load_dwordx4 v[52:55], v2, s[4:7], s56 offen offset:1152 sc1
 buffer_load_dwordx4 v[56:59], v3, s[4:7], s56 offen offset:0 sc1
L_xm_204:
 s_waitcnt vmcnt(4)
 v_mfma_f32_16x16x32_bf16 v[60:63], v[24:27], v[40:43], 0
 s_waitcnt vmcnt(3)
 v_mfma_f32_16x16x32_bf16 v[64:67], v[24:27], v[44:47], 0
 s_waitcnt vmcnt(2)
 v_mfma_f32_16x16x32_bf16 v[68:71], v[24:27], v[48:51], 0
 v_max3_u32 v14, v40, v44, v48
 v_cvt_pk_bf16_f32 v60, v60, v61
 v_cvt_pk_bf16_f32 v61, v62, v63
 ds_write_b64 v4, v[60:61] offset:0
 s_waitcnt vmcnt(1)
 v_mfma_f32_16x16x32_bf16 v[72:75], v[24:27], v[52:55], 0
 v_cvt_pk_bf16_f32 v64, v64, v65
 v_cvt_pk_bf16_f32 v65, v66, v67
 ds_write_b64 v4, v[64:65] offset:8
 s_waitcnt vmcnt(0)
 v_mfma_f32_16x16x32_bf16 v[76:79], v[24:27], v[56:59], 0
 v_max3_u32 v14, v14, v52, v56
 v_cmp_eq_u32 vcc, -1, v14
 v_cvt_pk_bf16_f32 v68, v68, v69
 v_cvt_pk_bf16_f32 v69, v70, v71
 ds_write_b64 v4, v[68:69] offset:1024
 s_cbranch_vccnz L_rt_205
 v_cvt_pk_bf16_f32 v72, v72, v73
 v_cvt_pk_bf16_f32 v73, v74, v75
 ds_write_b64 v4, v[72:73] offset:1032
 s_nop 0
 v_cvt_pk_bf16_f32 v76, v76, v77
 v_cvt_pk_bf16_f32 v77, v78, v79
 ds_write_b64 v5, v[76:77] offset:0
 s_waitcnt lgkmcnt(0)
 s_barrier
L_ch_b1f0:
 ds_read_b128 v[72:75], v0 offset:0
 ds_read_b128 v[76:79], v0 offset:32
 ds_read_b128 v[80:83], v0 offset:1024
 s_waitcnt lgkmcnt(2)
 v_smfmac_f32_16x16x64_bf16 v[88:91], v[72:75], v[224:231], v17
 ds_read_b128 v[84:87], v0 offset:1056
 v_smfmac_f32_16x16x64_bf16 v[92:95], v[72:75], v[232:239], v17
 ds_read_b128 v[96:99], v0 offset:2048
 s_waitcnt lgkmcnt(3)
 v_smfmac_f32_16x16x64_bf16 v[88:91], v[76:79], v[240:247], v17
 ds_read_b128 v[100:103], v0 offset:2080
 v_smfmac_f32_16x16x64_bf16 v[92:95], v[76:79], v[248:255], v17
 ds_read_b128 v[112:115], v0 offset:3072
 s_waitcnt lgkmcnt(4)
 v_smfmac_f32_16x16x64_bf16 v[88:91], v[80:83], v[192:199], v17
 ds_read_b128 v[40:43], v1 offset:10240
 v_smfmac_f32_16x16x64_bf16 v[92:95], v[80:83], v[200:207], v17
 ds_read_b128 v[116:119], v0 offset:3104
 s_waitcnt lgkmcnt(5)
 v_smfmac_f32_16x16x64_bf16 v[88:91], v[84:87], v[208:215], v17
 ds_read_b128 v[44:47], v1 offset:11264
 v_smfmac_f32_16x16x64_bf16 v[92:95], v[84:87], v[216:223], v17
 ds_read_b128 v[72:75], v0 offset:4096
 s_waitcnt lgkmcnt(6)
 v_smfmac_f32_16x16x64_bf16 v[88:91], v[96:99], a[0:7], v17
 ds_read_b128 v[48:51], v1 offset:12288
 v_smfmac_f32_16x16x64_bf16 v[92:95], v[96:99], a[8:15], v17
 ds_read_b128 v[76:79], v0 offset:4128
 s_waitcnt lgkmcnt(7)
 v_smfmac_f32_16x16x64_bf16 v[88:91], v[100:103], a[16:23], v17
 ds_read_b128 v[52:55], v1 offset:13312
 v_smfmac_f32_16x16x64_bf16 v[92:95], v[100:103], a[24:31], v17
 ds_read_b128 v[80:83], v0 offset:5120
 s_waitcnt lgkmcnt(8)
 v_smfmac_f32_16x16x64_bf16 v[88:91], v[112:115], a[32:39], v17
 ds_read_b128 v[56:59], v1 offset:14336
 v_smfmac_f32_16x16x64_bf16 v[92:95], v[112:115], a[40:47], v17
 ds_read_b128 v[84:87], v0 offset:5152
 s_waitcnt lgkmcnt(8)
 v_smfmac_f32_16x16x64_bf16 v[88:91], v[116:119], a[48:55], v17
 ds_read_b128 v[60:63], v1 offset:15360
 v_smfmac_f32_16x16x64_bf16 v[92:95], v[116:119], a[56:63], v17
 ds_read_b128 v[96:99], v0 offset:6144
 s_waitcnt lgkmcnt(8)
 v_smfmac_f32_16x16x64_bf16 v[88:91], v[72:75], a[64:71], v17
 ds_read_b128 v[64:67], v1 offset:16384
 v_smfmac_f32_16x16x64_bf16 v[92:95], v[72:75], a[72:79], v17
 ds_read_b128 v[100:103], v0 offset:6176
 s_waitcnt lgkmcnt(8)
 v_smfmac_f32_16x16x64_bf16 v[88:91], v[76:79], a[80:87], v17
 ds_read_b128 v[68:71], v1 offset:17408
 v_smfmac_f32_16x16x64_bf16 v[92:95], v[76:79], a[88:95], v17
 ds_read_b128 v[112:115], v0 offset:7168
 s_waitcnt lgkmcnt(8)
 v_smfmac_f32_16x16x64_bf16 v[88:91], v[80:83], a[96:103], v17
 ds_read_b128 v[104:107], v16 offset:18432
 v_smfmac_f32_16x16x64_bf16 v[92:95], v[80:83], a[104:111], v17
 ds_read_b128 v[116:119], v0 offset:7200
 s_waitcnt lgkmcnt(8)
 v_smfmac_f32_16x16x64_bf16 v[88:91], v[84:87], a[112:119], v17
 ds_read_b128 v[108:111], v16 offset:19456
 v_smfmac_f32_16x16x64_bf16 v[92:95], v[84:87], a[120:127], v17
 ds_read_b128 v[72:75], v0 offset:8192
 s_waitcnt lgkmcnt(8)
 v_smfmac_f32_16x16x64_bf16 v[88:91], v[96:99], a[128:135], v17
 ds_read_b128 v[224:227], v15 offset:8192
 v_smfmac_f32_16x16x64_bf16 v[92:95], v[96:99], a[136:143], v17
 ds_read_b128 v[76:79], v0 offset:8224
 s_waitcnt lgkmcnt(8)
 v_smfmac_f32_16x16x64_bf16 v[88:91], v[100:103], a[144:151], v17
 ds_read_b128 v[228:231], v15 offset:9216
 v_smfmac_f32_16x16x64_bf16 v[92:95], v[100:103], a[152:159], v17
 ds_read_b128 v[80:83], v0 offset:9216
 s_waitcnt lgkmcnt(8)
 v_smfmac_f32_16x16x64_bf16 v[88:91], v[112:115], a[160:167], v17
 ds_read_b128 v[232:235], v15 offset:10240
 v_smfmac_f32_16x16x64_bf16 v[92:95], v[112:115], a[168:175], v17
 ds_read_b128 v[84:87], v0 offset:9248
 s_waitcnt lgkmcnt(8)
 v_smfmac_f32_16x16x64_bf16 v[88:91], v[116:119], a[176:183], v17
 ds_read_b128 v[236:239], v15 offset:11264
 v_smfmac_f32_16x16x64_bf16 v[92:95], v[116:119], a[184:191], v17
 ds_read_b128 v[240:243], v15 offset:12288
 s_waitcnt lgkmcnt(8)
 v_smfmac_f32_16x16x64_bf16 v[88:91], v[72:75], a[192:199], v17
 ds_read_b128 v[244:247], v15 offset:13312
 v_smfmac_f32_16x16x64_bf16 v[92:95], v[72:75], a[200:207], v17
 ds_read_b128 v[248:251], v15 offset:14336
 s_waitcnt lgkmcnt(8)
 v_smfmac_f32_16x16x64_bf16 v[88:91], v[76:79], a[208:215], v17
 ds_read_b128 v[252:255], v15 offset:15360
 v_smfmac_f32_16x16x64_bf16 v[92:95], v[76:79], a[216:223], v17
 s_waitcnt lgkmcnt(7)
 v_smfmac_f32_16x16x64_bf16 v[88:91], v[80:83], a[224:231], v17
 v_smfmac_f32_16x16x64_bf16 v[92:95], v[80:83], a[232:239], v17
 s_waitcnt lgkmcnt(5)
 v_smfmac_f32_16x16x64_bf16 v[88:91], v[84:87], a[240:247], v17
 v_smfmac_f32_16x16x64_bf16 v[92:95], v[84:87], a[248:255], v17
 s_nop 2
 v_cvt_pk_bf16_f32 v120, v88, v89
 v_cvt_pk_bf16_f32 v121, v90, v91
 ds_write_b64 v6, v[120:121] offset:26624
 s_nop 1
 v_cvt_pk_bf16_f32 v122, v92, v93
 v_cvt_pk_bf16_f32 v123, v94, v95
 ds_write_b64 v6, v[122:123] offset:27136
 s_waitcnt lgkmcnt(0)
 s_barrier
 ds_read_b64_tr_b16 v[72:73], v7 offset:26624
 ds_read_b64_tr_b16 v[74:75], v7 offset:27136
 ds_read_b64_tr_b16 v[76:77], v7 offset:27648
 ds_read_b64_tr_b16 v[78:79], v7 offset:28160
 ds_read_b64_tr_b16 v[80:81], v7 offset:28672
 ds_read_b64_tr_b16 v[82:83], v7 offset:29184
 ds_read_b64_tr_b16 v[84:85], v7 offset:29696
 ds_read_b64_tr_b16 v[86:87], v7 offset:30208
 ds_read_b64_tr_b16 v[112:113], v8 offset:26624
 ds_read_b64_tr_b16 v[114:115], v8 offset:27136
 s_waitcnt lgkmcnt(8)
 v_mfma_f32_16x16x32_bf16 v[92:95], v[40:43], v[72:75], 0
 v_mfma_f32_16x16x32_bf16 v[96:99], v[56:59], v[72:75], 0
 v_mfma_f32_16x16x32_bf16 v[88:91], v[72:75], v[72:75], 0
 s_waitcnt lgkmcnt(6)
 v_mfma_f32_16x16x32_bf16 v[92:95], v[44:47], v[76:79], v[92:95]
 v_mfma_f32_16x16x32_bf16 v[96:99], v[60:63], v[76:79], v[96:99]
 v_mfma_f32_16x16x32_bf16 v[88:91], v[76:79], v[76:79], v[88:91]
 s_waitcnt lgkmcnt(4)
 v_mfma_f32_16x16x32_bf16 v[92:95], v[48:51], v[80:83], v[92:95]
 buffer_load_dwordx2 v[124:125], v1, s[4:7], s64 offen sc1
 v_mfma_f32_16x16x32_bf16 v[96:99], v[64:67], v[80:83], v[96:99]
 v_mfma_f32_16x16x32_bf16 v[88:91], v[80:83], v[80:83], v[88:91]
 s_waitcnt lgkmcnt(0)
 buffer_store_dwordx4 v[112:115], v1, s[4:7], s60 offen
 s_waitcnt lgkmcnt(2)
 v_mfma_f32_16x16x32_bf16 v[92:95], v[52:55], v[84:87], v[92:95]
 v_mfma_f32_16x16x32_bf16 v[96:99], v[68:71], v[84:87], v[96:99]
 v_mfma_f32_16x16x32_bf16 v[88:91], v[84:87], v[84:87], v[88:91]
 v_mfma_f32_32x32x8_bf16 v[40:55], v[18:19], v[18:19], 0
 v_max3_f32 v126, v92, v93, v94
 ds_read_b128 v[80:83], v15 offset:16384
 ds_read_b128 v[84:87], v15 offset:17408
 v_max3_f32 v126, v126, v95, v96
 v_max3_f32 v126, v126, v97, v98
 v_max3_f32 v126, v126, v99, v90
 v_max_f32 v126, v126, v91
 v_mov_b32 v127, v126
 v_mov_b64 v[56:57], 0
 v_mov_b64 v[58:59], 0
 v_permlane16_swap_b32 v126, v127
 v_max_f32 v126, v126, v127
 v_mov_b32 v127, v126
 s_nop 1
 v_permlane32_swap_b32 v126, v127
 v_max_f32 v126, v126, v127
 v_mul_f32 v126, s79, v126
 v_fma_f32 v92, v92, s79, -v126
 v_fma_f32 v93, v93, s79, -v126
 v_fma_f32 v94, v94, s79, -v126
 v_fma_f32 v95, v95, s79, -v126
 v_fma_f32 v96, v96, s79, -v126
 v_fma_f32 v97, v97, s79, -v126
 v_fma_f32 v98, v98, s79, -v126
 v_fma_f32 v99, v99, s79, -v126
 v_exp_f32 v92, v92
 v_exp_f32 v93, v93
 v_exp_f32 v94, v94
 v_exp_f32 v95, v95
 v_exp_f32 v96, v96
 v_exp_f32 v97, v97
 v_exp_f32 v98, v98
 v_exp_f32 v99, v99
 v_fma_f32 v90, v90, s79, -v126
 v_cvt_pk_bf16_f32 v100, v92, v93
 v_cvt_pk_bf16_f32 v101, v94, v95
 v_cvt_pk_bf16_f32 v102, v96, v97
 v_cvt_pk_bf16_f32 v103, v98, v99
 v_fma_f32 v91, v91, s79, -v126
 v_exp_f32 v90, v90
 v_mfma_f32_16x16x32_bf16 v[120:123], v[28:31], v[100:103], 0
 v_exp_f32 v91, v91
 v_mfma_f32_16x16x32_bf16 v[112:115], v[104:107], v[100:103], 0
 v_cvt_pk_bf16_f32 v36, v90, v91
 v_cvt_pk_bf16_f32 v39, v90, v91
 v_mfma_f32_16x16x32_bf16 v[116:119], v[108:111], v[100:103], 0
 s_waitcnt vmcnt(0)
 v_mfma_f32_16x16x16_bf16 v[120:123], v[28:29], v[36:37], v[120:123]
L_pv_206:
 v_cmp_eq_u32 vcc, -1, v124
 s_cbranch_vccnz L_rt_207
 v_mfma_f32_16x16x16_bf16 v[112:115], v[124:125], v[36:37], v[112:115]
 v_mfma_f32_16x16x16_bf16 v[116:119], v[124:125], v[38:39], v[116:119]
 v_rcp_f32 v120, v120
 ds_read_b128 v[88:91], v15 offset:18432
 ds_read_b128 v[92:95], v15 offset:19456
 ds_read_b128 v[96:99], v15 offset:20480
 ds_read_b128 v[100:103], v15 offset:21504
 s_mov_b64 exec, s[28:29]
 v_pk_mul_f32 v[112:113], v[112:113], v[120:121] op_sel_hi:[1,0]
 v_pk_mul_f32 v[114:115], v[114:115], v[120:121] op_sel_hi:[1,0]
 v_cvt_pk_bf16_f32 v112, v112, v113
 v_cvt_pk_bf16_f32 v113, v114, v115
 v_pk_mul_f32 v[116:117], v[116:117], v[120:121] op_sel_hi:[1,0]
 v_pk_mul_f32 v[118:119], v[118:119], v[120:121] op_sel_hi:[1,0]
 v_cvt_pk_bf16_f32 v114, v116, v117
 v_cvt_pk_bf16_f32 v115, v118, v119
 ds_write_b128 v9, v[112:115] offset:30720
 s_mov_b64 exec, -1
 s_waitcnt lgkmcnt(0)
 s_barrier
 ds_read_b128 v[60:63], v0 offset:30720
 ds_read_b128 v[64:67], v0 offset:30752
 ds_read_b128 v[68:71], v0 offset:31744
 ds_read_b128 v[72:75], v0 offset:31776
 s_waitcnt lgkmcnt(3)
 v_smfmac_f32_16x16x64_bf16 v[40:43], v[60:63], v[224:231], v17
 ds_read_b128 v[224:227], v15 offset:22528
 v_smfmac_f32_16x16x64_bf16 v[44:47], v[60:63], v[232:239], v17
 ds_read_b128 v[228:231], v15 offset:23552
 s_waitcnt lgkmcnt(4)
 v_smfmac_f32_16x16x64_bf16 v[40:43], v[64:67], v[240:247], v17
 ds_read_b128 v[232:235], v15 offset:24576
 v_smfmac_f32_16x16x64_bf16 v[44:47], v[64:67], v[248:255], v17
 ds_read_b128 v[236:239], v15 offset:25600
 s_waitcnt lgkmcnt(5)
 v_smfmac_f32_16x16x64_bf16 v[40:43], v[68:71], v[80:87], v17
 ds_read_b128 v[240:243], v15 offset:26624
 v_smfmac_f32_16x16x64_bf16 v[44:47], v[68:71], v[128:135], v17
 ds_read_b128 v[244:247], v15 offset:27648
 s_waitcnt lgkmcnt(6)
 v_smfmac_f32_16x16x64_bf16 v[40:43], v[72:75], v[136:143], v17
 ds_read_b128 v[248:251], v15 offset:28672
 v_smfmac_f32_16x16x64_bf16 v[44:47], v[72:75], v[144:151], v17
 ds_read_b128 v[252:255], v15 offset:29696
 v_smfmac_f32_16x16x64_bf16 v[48:51], v[60:63], v[152:159], v17
 ds_read_b128 v[80:83], v15 offset:30720
 v_cvt_pk_bf16_f32 v116, v40, v41
 v_cvt_pk_bf16_f32 v117, v42, v43
 v_or_b32 v116, 1, v116
 v_smfmac_f32_16x16x64_bf16 v[52:55], v[60:63], v[160:167], v17
 ds_read_b128 v[84:87], v15 offset:31744
 v_cvt_pk_bf16_f32 v118, v44, v45
 v_cvt_pk_bf16_f32 v119, v46, v47
 v_or_b32 v118, 1, v118
 buffer_store_dwordx4 v[116:119], v10, s[4:7], s68 offen
 v_smfmac_f32_16x16x64_bf16 v[48:51], v[64:67], v[168:175], v17
 v_smfmac_f32_16x16x64_bf16 v[52:55], v[64:67], v[176:183], v17
 v_smfmac_f32_16x16x64_bf16 v[48:51], v[68:71], v[184:191], v17
 v_smfmac_f32_16x16x64_bf16 v[52:55], v[68:71], v[88:95], v17
 v_smfmac_f32_16x16x64_bf16 v[48:51], v[72:75], v[96:103], v17
 s_waitcnt lgkmcnt(8)
 v_smfmac_f32_16x16x64_bf16 v[52:55], v[72:75], v[224:231], v17
 s_waitcnt lgkmcnt(6)
 v_smfmac_f32_16x16x64_bf16 v[56:59], v[60:63], v[232:239], v17
 v_cvt_pk_bf16_f32 v120, v48, v49
 v_cvt_pk_bf16_f32 v121, v50, v51
 v_or_b32 v120, 1, v120
 s_waitcnt lgkmcnt(4)
 v_smfmac_f32_16x16x64_bf16 v[56:59], v[64:67], v[240:247], v17
 v_cvt_pk_bf16_f32 v122, v52, v53
 v_cvt_pk_bf16_f32 v123, v54, v55
 v_or_b32 v122, 1, v122
 buffer_store_dwordx4 v[120:123], v10, s[4:7], s69 offen
 s_waitcnt lgkmcnt(2)
 v_smfmac_f32_16x16x64_bf16 v[56:59], v[68:71], v[248:255], v17
 s_waitcnt lgkmcnt(0)
 v_smfmac_f32_16x16x64_bf16 v[56:59], v[72:75], v[80:87], v17
 s_nop 7
 v_cvt_pk_bf16_f32 v124, v56, v57
 v_cvt_pk_bf16_f32 v125, v58, v59
 v_or_b32 v124, 1, v124
 buffer_store_dwordx2 v[124:125], v10, s[4:7], s70 offen
 ds_read_b128 v[224:227], v15 offset:0
 ds_read_b128 v[228:231], v15 offset:1024
 ds_read_b128 v[232:235], v15 offset:2048
 ds_read_b128 v[236:239], v15 offset:3072
 ds_read_b128 v[240:243], v15 offset:4096
 ds_read_b128 v[244:247], v15 offset:5120
 ds_read_b128 v[248:251], v15 offset:6144
 ds_read_b128 v[252:255], v15 offset:7168
 v_mov_b64 v[88:89], 0
 v_mov_b64 v[90:91], 0
 v_mov_b64 v[92:93], 0
 v_mov_b64 v[94:95], 0
 s_cmp_eq_u32 s55, 0
 s_cbranch_scc1 L_nr_208
 s_nop 15
 s_nop 15
 s_nop 15
 s_nop 15
 s_nop 15
L_pp_210:
 buffer_load_dwordx4 v[40:43], v1, s[4:7], s74 offen offset:0 sc1
 buffer_load_dwordx4 v[44:47], v1, s[4:7], s74 offen offset:1024 sc1
 buffer_load_dwordx4 v[48:51], v1, s[4:7], s74 offen offset:2048 sc1
 buffer_load_dwordx4 v[52:55], v1, s[4:7], s74 offen offset:3072 sc1
 s_waitcnt vmcnt(3)
 v_mfma_f32_16x16x32_bf16 v[56:59], v[40:43], v[20:23], 0
 v_and_b32 v14, v40, v42
 s_waitcnt vmcnt(2)
 v_mfma_f32_16x16x32_bf16 v[56:59], v[44:47], v[20:23], v[56:59]
 v_bitop3_b32 v14, v14, v44, v46 bitop3:0x80
 s_waitcnt vmcnt(1)
 v_mfma_f32_16x16x32_bf16 v[56:59], v[48:51], v[20:23], v[56:59]
 v_bitop3_b32 v14, v14, v48, v50 bitop3:0x80
 s_waitcnt vmcnt(0)
 v_mfma_f32_16x16x32_bf16 v[56:59], v[52:55], v[20:23], v[56:59]
 v_bitop3_b32 v14, v14, v52, v54 bitop3:0x80
 v_and_b32 v14, 1, v14
 v_cmp_ne_u32 vcc, 1, v14
 s_cbranch_vccnz L_rt_211
 s_nop 2
 v_cvt_pk_bf16_f32 v60, v56, v57
 v_cvt_pk_bf16_f32 v61, v58, v59
 s_nop 0
 v_mov_b32_dpp v62, v60 quad_perm:[2,3,2,3] row_mask:0xf bank_mask:0xf
 v_mov_b32_dpp v63, v61 quad_perm:[2,3,2,3] row_mask:0xf bank_mask:0xf
 s_mov_b64 exec, s[30:31]
 buffer_store_dwordx4 v[60:63], v11, s[4:7], s57 offen sc1
 s_mov_b64 exec, 1
 buffer_store_dword v13, off, s[4:7], s17
 s_mov_b64 exec, s[30:31]
 buffer_store_dwordx4 v[32:35], v11, s[4:7], s59 offen sc1
 s_mov_b64 exec, -1
 s_barrier
 s_nop 15
 s_nop 15
 s_nop 15
 s_nop 15
 s_nop 15
 s_nop 15
 s_nop 15
L_rj_209:
 v_add_u32 v13, 1, v13
 s_add_u32 s53, s53, 1
.p2align 3
 s_mov_b32 s51, 0
 buffer_load_dwordx4 v[40:43], v2, s[4:7], s57 offen offset:0 sc1
 buffer_load_dwordx4 v[44:47], v2, s[4:7], s57 offen offset:128 sc1
 buffer_load_dwordx4 v[48:51], v2, s[4:7], s57 offen offset:1024 sc1
 buffer_load_dwordx4 v[52:55], v2, s[4:7], s57 offen offset:1152 sc1
 buffer_load_dwordx4 v[56:59], v3, s[4:7], s57 offen offset:0 sc1
L_xm_212:
 s_waitcnt vmcnt(4)
 v_mfma_f32_16x16x32_bf16 v[60:63], v[24:27], v[40:43], 0
 s_waitcnt vmcnt(3)
 v_mfma_f32_16x16x32_bf16 v[64:67], v[24:27], v[44:47], 0
 s_waitcnt vmcnt(2)
 v_mfma_f32_16x16x32_bf16 v[68:71], v[24:27], v[48:51], 0
 v_max3_u32 v14, v40, v44, v48
 v_cvt_pk_bf16_f32 v60, v60, v61
 v_cvt_pk_bf16_f32 v61, v62, v63
 ds_write_b64 v4, v[60:61] offset:0
 s_waitcnt vmcnt(1)
 v_mfma_f32_16x16x32_bf16 v[72:75], v[24:27], v[52:55], 0
 v_cvt_pk_bf16_f32 v64, v64, v65
 v_cvt_pk_bf16_f32 v65, v66, v67
 ds_write_b64 v4, v[64:65] offset:8
 s_waitcnt vmcnt(0)
 v_mfma_f32_16x16x32_bf16 v[76:79], v[24:27], v[56:59], 0
 v_max3_u32 v14, v14, v52, v56
 v_cmp_eq_u32 vcc, -1, v14
 v_cvt_pk_bf16_f32 v68, v68, v69
 v_cvt_pk_bf16_f32 v69, v70, v71
 ds_write_b64 v4, v[68:69] offset:1024
 s_cbranch_vccnz L_rt_213
 v_cvt_pk_bf16_f32 v72, v72, v73
 v_cvt_pk_bf16_f32 v73, v74, v75
 ds_write_b64 v4, v[72:73] offset:1032
 s_nop 0
 v_cvt_pk_bf16_f32 v76, v76, v77
 v_cvt_pk_bf16_f32 v77, v78, v79
 ds_write_b64 v5, v[76:77] offset:0
 s_waitcnt lgkmcnt(0)
 s_barrier
L_ch_b1f1:
 ds_read_b128 v[72:75], v0 offset:0
 ds_read_b128 v[76:79], v0 offset:32
 ds_read_b128 v[80:83], v0 offset:1024
 s_waitcnt lgkmcnt(2)
 v_smfmac_f32_16x16x64_bf16 v[88:91], v[72:75], v[224:231], v17
 ds_read_b128 v[84:87], v0 offset:1056
 v_smfmac_f32_16x16x64_bf16 v[92:95], v[72:75], v[232:239], v17
 ds_read_b128 v[96:99], v0 offset:2048
 s_waitcnt lgkmcnt(3)
 v_smfmac_f32_16x16x64_bf16 v[88:91], v[76:79], v[240:247], v17
 ds_read_b128 v[100:103], v0 offset:2080
 v_smfmac_f32_16x16x64_bf16 v[92:95], v[76:79], v[248:255], v17
 ds_read_b128 v[112:115], v0 offset:3072
 s_waitcnt lgkmcnt(4)
 v_smfmac_f32_16x16x64_bf16 v[88:91], v[80:83], v[192:199], v17
 ds_read_b128 v[40:43], v1 offset:10240
 v_smfmac_f32_16x16x64_bf16 v[92:95], v[80:83], v[200:207], v17
 ds_read_b128 v[116:119], v0 offset:3104
 s_waitcnt lgkmcnt(5)
 v_smfmac_f32_16x16x64_bf16 v[88:91], v[84:87], v[208:215], v17
 ds_read_b128 v[44:47], v1 offset:11264
 v_smfmac_f32_16x16x64_bf16 v[92:95], v[84:87], v[216:223], v17
 ds_read_b128 v[72:75], v0 offset:4096
 s_waitcnt lgkmcnt(6)
 v_smfmac_f32_16x16x64_bf16 v[88:91], v[96:99], a[0:7], v17
 ds_read_b128 v[48:51], v1 offset:12288
 v_smfmac_f32_16x16x64_bf16 v[92:95], v[96:99], a[8:15], v17
 ds_read_b128 v[76:79], v0 offset:4128
 s_waitcnt lgkmcnt(7)
 v_smfmac_f32_16x16x64_bf16 v[88:91], v[100:103], a[16:23], v17
 ds_read_b128 v[52:55], v1 offset:13312
 v_smfmac_f32_16x16x64_bf16 v[92:95], v[100:103], a[24:31], v17
 ds_read_b128 v[80:83], v0 offset:5120
 s_waitcnt lgkmcnt(8)
 v_smfmac_f32_16x16x64_bf16 v[88:91], v[112:115], a[32:39], v17
 ds_read_b128 v[56:59], v1 offset:14336
 v_smfmac_f32_16x16x64_bf16 v[92:95], v[112:115], a[40:47], v17
 ds_read_b128 v[84:87], v0 offset:5152
 s_waitcnt lgkmcnt(8)
 v_smfmac_f32_16x16x64_bf16 v[88:91], v[116:119], a[48:55], v17
 ds_read_b128 v[60:63], v1 offset:15360
 v_smfmac_f32_16x16x64_bf16 v[92:95], v[116:119], a[56:63], v17
 ds_read_b128 v[96:99], v0 offset:6144
 s_waitcnt lgkmcnt(8)
 v_smfmac_f32_16x16x64_bf16 v[88:91], v[72:75], a[64:71], v17
 ds_read_b128 v[64:67], v1 offset:16384
 v_smfmac_f32_16x16x64_bf16 v[92:95], v[72:75], a[72:79], v17
 ds_read_b128 v[100:103], v0 offset:6176
 s_waitcnt lgkmcnt(8)
 v_smfmac_f32_16x16x64_bf16 v[88:91], v[76:79], a[80:87], v17
 ds_read_b128 v[68:71], v1 offset:17408
 v_smfmac_f32_16x16x64_bf16 v[92:95], v[76:79], a[88:95], v17
 ds_read_b128 v[112:115], v0 offset:7168
 s_waitcnt lgkmcnt(8)
 v_smfmac_f32_16x16x64_bf16 v[88:91], v[80:83], a[96:103], v17
 ds_read_b128 v[104:107], v16 offset:18432
 v_smfmac_f32_16x16x64_bf16 v[92:95], v[80:83], a[104:111], v17
 ds_read_b128 v[116:119], v0 offset:7200
 s_waitcnt lgkmcnt(8)
 v_smfmac_f32_16x16x64_bf16 v[88:91], v[84:87], a[112:119], v17
 ds_read_b128 v[108:111], v16 offset:19456
 v_smfmac_f32_16x16x64_bf16 v[92:95], v[84:87], a[120:127], v17
 ds_read_b128 v[72:75], v0 offset:8192
 s_waitcnt lgkmcnt(8)
 v_smfmac_f32_16x16x64_bf16 v[88:91], v[96:99], a[128:135], v17
 ds_read_b128 v[224:227], v15 offset:8192
 v_smfmac_f32_16x16x64_bf16 v[92:95], v[96:99], a[136:143], v17
 ds_read_b128 v[76:79], v0 offset:8224
 s_waitcnt lgkmcnt(8)
 v_smfmac_f32_16x16x64_bf16 v[88:91], v[100:103], a[144:151], v17
 ds_read_b128 v[228:231], v15 offset:9216
 v_smfmac_f32_16x16x64_bf16 v[92:95], v[100:103], a[152:159], v17
 ds_read_b128 v[80:83], v0 offset:9216
 s_waitcnt lgkmcnt(8)
 v_smfmac_f32_16x16x64_bf16 v[88:91], v[112:115], a[160:167], v17
 ds_read_b128 v[232:235], v15 offset:10240
 v_smfmac_f32_16x16x64_bf16 v[92:95], v[112:115], a[168:175], v17
 ds_read_b128 v[84:87], v0 offset:9248
 s_waitcnt lgkmcnt(8)
 v_smfmac_f32_16x16x64_bf16 v[88:91], v[116:119], a[176:183], v17
 ds_read_b128 v[236:239], v15 offset:11264
 v_smfmac_f32_16x16x64_bf16 v[92:95], v[116:119], a[184:191], v17
 ds_read_b128 v[240:243], v15 offset:12288
 s_waitcnt lgkmcnt(8)
 v_smfmac_f32_16x16x64_bf16 v[88:91], v[72:75], a[192:199], v17
 ds_read_b128 v[244:247], v15 offset:13312
 v_smfmac_f32_16x16x64_bf16 v[92:95], v[72:75], a[200:207], v17
 ds_read_b128 v[248:251], v15 offset:14336
 s_waitcnt lgkmcnt(8)
 v_smfmac_f32_16x16x64_bf16 v[88:91], v[76:79], a[208:215], v17
 ds_read_b128 v[252:255], v15 offset:15360
 v_smfmac_f32_16x16x64_bf16 v[92:95], v[76:79], a[216:223], v17
 s_waitcnt lgkmcnt(7)
 v_smfmac_f32_16x16x64_bf16 v[88:91], v[80:83], a[224:231], v17
 v_smfmac_f32_16x16x64_bf16 v[92:95], v[80:83], a[232:239], v17
 s_waitcnt lgkmcnt(5)
 v_smfmac_f32_16x16x64_bf16 v[88:91], v[84:87], a[240:247], v17
 v_smfmac_f32_16x16x64_bf16 v[92:95], v[84:87], a[248:255], v17
 s_nop 2
 v_cvt_pk_bf16_f32 v120, v88, v89
 v_cvt_pk_bf16_f32 v121, v90, v91
 ds_write_b64 v6, v[120:121] offset:26624
 s_nop 1
 v_cvt_pk_bf16_f32 v122, v92, v93
 v_cvt_pk_bf16_f32 v123, v94, v95
 ds_write_b64 v6, v[122:123] offset:27136
 s_waitcnt lgkmcnt(0)
 s_barrier
 ds_read_b64_tr_b16 v[72:73], v7 offset:26624
 ds_read_b64_tr_b16 v[74:75], v7 offset:27136
 ds_read_b64_tr_b16 v[76:77], v7 offset:27648
 ds_read_b64_tr_b16 v[78:79], v7 offset:28160
 ds_read_b64_tr_b16 v[80:81], v7 offset:28672
 ds_read_b64_tr_b16 v[82:83], v7 offset:29184
 ds_read_b64_tr_b16 v[84:85], v7 offset:29696
 ds_read_b64_tr_b16 v[86:87], v7 offset:30208
 ds_read_b64_tr_b16 v[112:113], v8 offset:26624
 ds_read_b64_tr_b16 v[114:115], v8 offset:27136
 s_waitcnt lgkmcnt(8)
 v_mfma_f32_16x16x32_bf16 v[92:95], v[40:43], v[72:75], 0
 v_mfma_f32_16x16x32_bf16 v[96:99], v[56:59], v[72:75], 0
 v_mfma_f32_16x16x32_bf16 v[88:91], v[72:75], v[72:75], 0
 s_waitcnt lgkmcnt(6)
 v_mfma_f32_16x16x32_bf16 v[92:95], v[44:47], v[76:79], v[92:95]
 v_mfma_f32_16x16x32_bf16 v[96:99], v[60:63], v[76:79], v[96:99]
 v_mfma_f32_16x16x32_bf16 v[88:91], v[76:79], v[76:79], v[88:91]
 s_waitcnt lgkmcnt(4)
 v_mfma_f32_16x16x32_bf16 v[92:95], v[48:51], v[80:83], v[92:95]
 buffer_load_dwordx2 v[124:125], v1, s[4:7], s65 offen sc1
 v_mfma_f32_16x16x32_bf16 v[96:99], v[64:67], v[80:83], v[96:99]
 v_mfma_f32_16x16x32_bf16 v[88:91], v[80:83], v[80:83], v[88:91]
 s_waitcnt lgkmcnt(0)
 buffer_store_dwordx4 v[112:115], v1, s[4:7], s61 offen
 s_waitcnt lgkmcnt(2)
 v_mfma_f32_16x16x32_bf16 v[92:95], v[52:55], v[84:87], v[92:95]
 v_mfma_f32_16x16x32_bf16 v[96:99], v[68:71], v[84:87], v[96:99]
 v_mfma_f32_16x16x32_bf16 v[88:91], v[84:87], v[84:87], v[88:91]
 v_mfma_f32_32x32x8_bf16 v[40:55], v[18:19], v[18:19], 0
 v_max3_f32 v126, v92, v93, v94
 ds_read_b128 v[80:83], v15 offset:16384
 ds_read_b128 v[84:87], v15 offset:17408
 v_max3_f32 v126, v126, v95, v96
 v_max3_f32 v126, v126, v97, v98
 v_max3_f32 v126, v126, v99, v90
 v_max_f32 v126, v126, v91
 v_mov_b32 v127, v126
 v_mov_b64 v[56:57], 0
 v_mov_b64 v[58:59], 0
 v_permlane16_swap_b32 v126, v127
 v_max_f32 v126, v126, v127
 v_mov_b32 v127, v126
 s_nop 1
 v_permlane32_swap_b32 v126, v127
 v_max_f32 v126, v126, v127
 v_mul_f32 v126, s79, v126
 v_fma_f32 v92, v92, s79, -v126
 v_fma_f32 v93, v93, s79, -v126
 v_fma_f32 v94, v94, s79, -v126
 v_fma_f32 v95, v95, s79, -v126
 v_fma_f32 v96, v96, s79, -v126
 v_fma_f32 v97, v97, s79, -v126
 v_fma_f32 v98, v98, s79, -v126
 v_fma_f32 v99, v99, s79, -v126
 v_exp_f32 v92, v92
 v_exp_f32 v93, v93
 v_exp_f32 v94, v94
 v_exp_f32 v95, v95
 v_exp_f32 v96, v96
 v_exp_f32 v97, v97
 v_exp_f32 v98, v98
 v_exp_f32 v99, v99
 v_fma_f32 v90, v90, s79, -v126
 v_cvt_pk_bf16_f32 v100, v92, v93
 v_cvt_pk_bf16_f32 v101, v94, v95
 v_cvt_pk_bf16_f32 v102, v96, v97
 v_cvt_pk_bf16_f32 v103, v98, v99
 v_fma_f32 v91, v91, s79, -v126
 v_exp_f32 v90, v90
 v_mfma_f32_16x16x32_bf16 v[120:123], v[28:31], v[100:103], 0
 v_exp_f32 v91, v91
 v_mfma_f32_16x16x32_bf16 v[112:115], v[104:107], v[100:103], 0
 v_cvt_pk_bf16_f32 v36, v90, v91
 v_cvt_pk_bf16_f32 v39, v90, v91
 v_mfma_f32_16x16x32_bf16 v[116:119], v[108:111], v[100:103], 0
 s_waitcnt vmcnt(0)
 v_mfma_f32_16x16x16_bf16 v[120:123], v[28:29], v[36:37], v[120:123]
L_pv_214:
 v_cmp_eq_u32 vcc, -1, v124
 s_cbranch_vccnz L_rt_215
 v_mfma_f32_16x16x16_bf16 v[112:115], v[124:125], v[36:37], v[112:115]
 v_mfma_f32_16x16x16_bf16 v[116:119], v[124:125], v[38:39], v[116:119]
 v_rcp_f32 v120, v120
 ds_read_b128 v[88:91], v15 offset:18432
 ds_read_b128 v[92:95], v15 offset:19456
 ds_read_b128 v[96:99], v15 offset:20480
 ds_read_b128 v[100:103], v15 offset:21504
 s_mov_b64 exec, s[28:29]
 v_pk_mul_f32 v[112:113], v[112:113], v[120:121] op_sel_hi:[1,0]
 v_pk_mul_f32 v[114:115], v[114:115], v[120:121] op_sel_hi:[1,0]
 v_cvt_pk_bf16_f32 v112, v112, v113
 v_cvt_pk_bf16_f32 v113, v114, v115
 v_pk_mul_f32 v[116:117], v[116:117], v[120:121] op_sel_hi:[1,0]
 v_pk_mul_f32 v[118:119], v[118:119], v[120:121] op_sel_hi:[1,0]
 v_cvt_pk_bf16_f32 v114, v116, v117
 v_cvt_pk_bf16_f32 v115, v118, v119
 ds_write_b128 v9, v[112:115] offset:30720
 s_mov_b64 exec, -1
 s_waitcnt lgkmcnt(0)
 s_barrier
 ds_read_b128 v[60:63], v0 offset:30720
 ds_read_b128 v[64:67], v0 offset:30752
 ds_read_b128 v[68:71], v0 offset:31744
 ds_read_b128 v[72:75], v0 offset:31776
 s_waitcnt lgkmcnt(3)
 v_smfmac_f32_16x16x64_bf16 v[40:43], v[60:63], v[224:231], v17
 ds_read_b128 v[224:227], v15 offset:22528
 v_smfmac_f32_16x16x64_bf16 v[44:47], v[60:63], v[232:239], v17
 ds_read_b128 v[228:231], v15 offset:23552
 s_waitcnt lgkmcnt(4)
 v_smfmac_f32_16x16x64_bf16 v[40:43], v[64:67], v[240:247], v17
 ds_read_b128 v[232:235], v15 offset:24576
 v_smfmac_f32_16x16x64_bf16 v[44:47], v[64:67], v[248:255], v17
 ds_read_b128 v[236:239], v15 offset:25600
 s_waitcnt lgkmcnt(5)
 v_smfmac_f32_16x16x64_bf16 v[40:43], v[68:71], v[80:87], v17
 ds_read_b128 v[240:243], v15 offset:26624
 v_smfmac_f32_16x16x64_bf16 v[44:47], v[68:71], v[128:135], v17
 ds_read_b128 v[244:247], v15 offset:27648
 s_waitcnt lgkmcnt(6)
 v_smfmac_f32_16x16x64_bf16 v[40:43], v[72:75], v[136:143], v17
 ds_read_b128 v[248:251], v15 offset:28672
 v_smfmac_f32_16x16x64_bf16 v[44:47], v[72:75], v[144:151], v17
 ds_read_b128 v[252:255], v15 offset:29696
 v_smfmac_f32_16x16x64_bf16 v[48:51], v[60:63], v[152:159], v17
 ds_read_b128 v[80:83], v15 offset:30720
 v_cvt_pk_bf16_f32 v116, v40, v41
 v_cvt_pk_bf16_f32 v117, v42, v43
 v_or_b32 v116, 1, v116
 v_smfmac_f32_16x16x64_bf16 v[52:55], v[60:63], v[160:167], v17
 ds_read_b128 v[84:87], v15 offset:31744
 v_cvt_pk_bf16_f32 v118, v44, v45
 v_cvt_pk_bf16_f32 v119, v46, v47
 v_or_b32 v118, 1, v118
 buffer_store_dwordx4 v[116:119], v10, s[4:7], s71 offen
 v_smfmac_f32_16x16x64_bf16 v[48:51], v[64:67], v[168:175], v17
 v_smfmac_f32_16x16x64_bf16 v[52:55], v[64:67], v[176:183], v17
 v_smfmac_f32_16x16x64_bf16 v[48:51], v[68:71], v[184:191], v17
 v_smfmac_f32_16x16x64_bf16 v[52:55], v[68:71], v[88:95], v17
 v_smfmac_f32_16x16x64_bf16 v[48:51], v[72:75], v[96:103], v17
 s_waitcnt lgkmcnt(8)
 v_smfmac_f32_16x16x64_bf16 v[52:55], v[72:75], v[224:231], v17
 s_waitcnt lgkmcnt(6)
 v_smfmac_f32_16x16x64_bf16 v[56:59], v[60:63], v[232:239], v17
 v_cvt_pk_bf16_f32 v120, v48, v49
 v_cvt_pk_bf16_f32 v121, v50, v51
 v_or_b32 v120, 1, v120
 s_waitcnt lgkmcnt(4)
 v_smfmac_f32_16x16x64_bf16 v[56:59], v[64:67], v[240:247], v17
 v_cvt_pk_bf16_f32 v122, v52, v53
 v_cvt_pk_bf16_f32 v123, v54, v55
 v_or_b32 v122, 1, v122
 buffer_store_dwordx4 v[120:123], v10, s[4:7], s72 offen
 s_waitcnt lgkmcnt(2)
 v_smfmac_f32_16x16x64_bf16 v[56:59], v[68:71], v[248:255], v17
 s_waitcnt lgkmcnt(0)
 v_smfmac_f32_16x16x64_bf16 v[56:59], v[72:75], v[80:87], v17
 s_nop 7
 v_cvt_pk_bf16_f32 v124, v56, v57
 v_cvt_pk_bf16_f32 v125, v58, v59
 v_or_b32 v124, 1, v124
 buffer_store_dwordx2 v[124:125], v10, s[4:7], s73 offen
 ds_read_b128 v[224:227], v15 offset:0
 ds_read_b128 v[228:231], v15 offset:1024
 ds_read_b128 v[232:235], v15 offset:2048
 ds_read_b128 v[236:239], v15 offset:3072
 ds_read_b128 v[240:243], v15 offset:4096
 ds_read_b128 v[244:247], v15 offset:5120
 ds_read_b128 v[248:251], v15 offset:6144
 ds_read_b128 v[252:255], v15 offset:7168
 v_mov_b64 v[88:89], 0
 v_mov_b64 v[90:91], 0
 v_mov_b64 v[92:93], 0
 v_mov_b64 v[94:95], 0
 s_cmp_eq_u32 s55, 0
 s_cbranch_scc1 L_nr_216
 s_nop 15
 s_nop 15
 s_nop 15
 s_nop 15
 s_nop 15
L_pp_218:
 buffer_load_dwordx4 v[40:43], v1, s[4:7], s75 offen offset:0 sc1
 buffer_load_dwordx4 v[44:47], v1, s[4:7], s75 offen offset:1024 sc1
 buffer_load_dwordx4 v[48:51], v1, s[4:7], s75 offen offset:2048 sc1
 buffer_load_dwordx4 v[52:55], v1, s[4:7], s75 offen offset:3072 sc1
 s_waitcnt vmcnt(3)
 v_mfma_f32_16x16x32_bf16 v[56:59], v[40:43], v[20:23], 0
 v_and_b32 v14, v40, v42
 s_waitcnt vmcnt(2)
 v_mfma_f32_16x16x32_bf16 v[56:59], v[44:47], v[20:23], v[56:59]
 v_bitop3_b32 v14, v14, v44, v46 bitop3:0x80
 s_waitcnt vmcnt(1)
 v_mfma_f32_16x16x32_bf16 v[56:59], v[48:51], v[20:23], v[56:59]
 v_bitop3_b32 v14, v14, v48, v50 bitop3:0x80
 s_waitcnt vmcnt(0)
 v_mfma_f32_16x16x32_bf16 v[56:59], v[52:55], v[20:23], v[56:59]
 v_bitop3_b32 v14, v14, v52, v54 bitop3:0x80
 v_and_b32 v14, 1, v14
 v_cmp_ne_u32 vcc, 1, v14
 s_cbranch_vccnz L_rt_219
 s_nop 2
 v_cvt_pk_bf16_f32 v60, v56, v57
 v_cvt_pk_bf16_f32 v61, v58, v59
 s_nop 0
 v_mov_b32_dpp v62, v60 quad_perm:[2,3,2,3] row_mask:0xf bank_mask:0xf
 v_mov_b32_dpp v63, v61 quad_perm:[2,3,2,3] row_mask:0xf bank_mask:0xf
 s_mov_b64 exec, s[30:31]
 buffer_store_dwordx4 v[60:63], v11, s[4:7], s58 offen sc1
 s_mov_b64 exec, 1
 buffer_store_dword v13, off, s[4:7], s17
 s_mov_b64 exec, s[30:31]
 buffer_store_dwordx4 v[32:35], v11, s[4:7], s56 offen sc1
 s_mov_b64 exec, -1
 s_barrier
 s_nop 15
 s_nop 15
 s_nop 15
 s_nop 15
 s_nop 15
 s_nop 15
 s_nop 15
L_rj_217:
 v_add_u32 v13, 1, v13
 s_add_u32 s53, s53, 1
.p2align 3
 s_mov_b32 s51, 0
 buffer_load_dwordx4 v[40:43], v2, s[4:7], s58 offen offset:0 sc1
 buffer_load_dwordx4 v[44:47], v2, s[4:7], s58 offen offset:128 sc1
 buffer_load_dwordx4 v[48:51], v2, s[4:7], s58 offen offset:1024 sc1
 buffer_load_dwordx4 v[52:55], v2, s[4:7], s58 offen offset:1152 sc1
 buffer_load_dwordx4 v[56:59], v3, s[4:7], s58 offen offset:0 sc1
L_xm_220:
 s_waitcnt vmcnt(4)
 v_mfma_f32_16x16x32_bf16 v[60:63], v[24:27], v[40:43], 0
 s_waitcnt vmcnt(3)
 v_mfma_f32_16x16x32_bf16 v[64:67], v[24:27], v[44:47], 0
 s_waitcnt vmcnt(2)
 v_mfma_f32_16x16x32_bf16 v[68:71], v[24:27], v[48:51], 0
 v_max3_u32 v14, v40, v44, v48
 v_cvt_pk_bf16_f32 v60, v60, v61
 v_cvt_pk_bf16_f32 v61, v62, v63
 ds_write_b64 v4, v[60:61] offset:0
 s_waitcnt vmcnt(1)
 v_mfma_f32_16x16x32_bf16 v[72:75], v[24:27], v[52:55], 0
 v_cvt_pk_bf16_f32 v64, v64, v65
 v_cvt_pk_bf16_f32 v65, v66, v67
 ds_write_b64 v4, v[64:65] offset:8
 s_waitcnt vmcnt(0)
 v_mfma_f32_16x16x32_bf16 v[76:79], v[24:27], v[56:59], 0
 v_max3_u32 v14, v14, v52, v56
 v_cmp_eq_u32 vcc, -1, v14
 v_cvt_pk_bf16_f32 v68, v68, v69
 v_cvt_pk_bf16_f32 v69, v70, v71
 ds_write_b64 v4, v[68:69] offset:1024
 s_cbranch_vccnz L_rt_221
 v_cvt_pk_bf16_f32 v72, v72, v73
 v_cvt_pk_bf16_f32 v73, v74, v75
 ds_write_b64 v4, v[72:73] offset:1032
 s_nop 0
 v_cvt_pk_bf16_f32 v76, v76, v77
 v_cvt_pk_bf16_f32 v77, v78, v79
 ds_write_b64 v5, v[76:77] offset:0
 s_waitcnt lgkmcnt(0)
 s_barrier
L_ch_b1f2:
 ds_read_b128 v[72:75], v0 offset:0
 ds_read_b128 v[76:79], v0 offset:32
 ds_read_b128 v[80:83], v0 offset:1024
 s_waitcnt lgkmcnt(2)
 v_smfmac_f32_16x16x64_bf16 v[88:91], v[72:75], v[224:231], v17
 ds_read_b128 v[84:87], v0 offset:1056
 v_smfmac_f32_16x16x64_bf16 v[92:95], v[72:75], v[232:239], v17
 ds_read_b128 v[96:99], v0 offset:2048
 s_waitcnt lgkmcnt(3)
 v_smfmac_f32_16x16x64_bf16 v[88:91], v[76:79], v[240:247], v17
 ds_read_b128 v[100:103], v0 offset:2080
 v_smfmac_f32_16x16x64_bf16 v[92:95], v[76:79], v[248:255], v17
 ds_read_b128 v[112:115], v0 offset:3072
 s_waitcnt lgkmcnt(4)
 v_smfmac_f32_16x16x64_bf16 v[88:91], v[80:83], v[192:199], v17
 ds_read_b128 v[40:43], v1 offset:10240
 v_smfmac_f32_16x16x64_bf16 v[92:95], v[80:83], v[200:207], v17
 ds_read_b128 v[116:119], v0 offset:3104
 s_waitcnt lgkmcnt(5)
 v_smfmac_f32_16x16x64_bf16 v[88:91], v[84:87], v[208:215], v17
 ds_read_b128 v[44:47], v1 offset:11264
 v_smfmac_f32_16x16x64_bf16 v[92:95], v[84:87], v[216:223], v17
 ds_read_b128 v[72:75], v0 offset:4096
 s_waitcnt lgkmcnt(6)
 v_smfmac_f32_16x16x64_bf16 v[88:91], v[96:99], a[0:7], v17
 ds_read_b128 v[48:51], v1 offset:12288
 v_smfmac_f32_16x16x64_bf16 v[92:95], v[96:99], a[8:15], v17
 ds_read_b128 v[76:79], v0 offset:4128
 s_waitcnt lgkmcnt(7)
 v_smfmac_f32_16x16x64_bf16 v[88:91], v[100:103], a[16:23], v17
 ds_read_b128 v[52:55], v1 offset:13312
 v_smfmac_f32_16x16x64_bf16 v[92:95], v[100:103], a[24:31], v17
 ds_read_b128 v[80:83], v0 offset:5120
 s_waitcnt lgkmcnt(8)
 v_smfmac_f32_16x16x64_bf16 v[88:91], v[112:115], a[32:39], v17
 ds_read_b128 v[56:59], v1 offset:14336
 v_smfmac_f32_16x16x64_bf16 v[92:95], v[112:115], a[40:47], v17
 ds_read_b128 v[84:87], v0 offset:5152
 s_waitcnt lgkmcnt(8)
 v_smfmac_f32_16x16x64_bf16 v[88:91], v[116:119], a[48:55], v17
 ds_read_b128 v[60:63], v1 offset:15360
 v_smfmac_f32_16x16x64_bf16 v[92:95], v[116:119], a[56:63], v17
 ds_read_b128 v[96:99], v0 offset:6144
 s_waitcnt lgkmcnt(8)
 v_smfmac_f32_16x16x64_bf16 v[88:91], v[72:75], a[64:71], v17
 ds_read_b128 v[64:67], v1 offset:16384
 v_smfmac_f32_16x16x64_bf16 v[92:95], v[72:75], a[72:79], v17
 ds_read_b128 v[100:103], v0 offset:6176
 s_waitcnt lgkmcnt(8)
 v_smfmac_f32_16x16x64_bf16 v[88:91], v[76:79], a[80:87], v17
 ds_read_b128 v[68:71], v1 offset:17408
 v_smfmac_f32_16x16x64_bf16 v[92:95], v[76:79], a[88:95], v17
 ds_read_b128 v[112:115], v0 offset:7168
 s_waitcnt lgkmcnt(8)
 v_smfmac_f32_16x16x64_bf16 v[88:91], v[80:83], a[96:103], v17
 ds_read_b128 v[104:107], v16 offset:18432
 v_smfmac_f32_16x16x64_bf16 v[92:95], v[80:83], a[104:111], v17
 ds_read_b128 v[116:119], v0 offset:7200
 s_waitcnt lgkmcnt(8)
 v_smfmac_f32_16x16x64_bf16 v[88:91], v[84:87], a[112:119], v17
 ds_read_b128 v[108:111], v16 offset:19456
 v_smfmac_f32_16x16x64_bf16 v[92:95], v[84:87], a[120:127], v17
 ds_read_b128 v[72:75], v0 offset:8192
 s_waitcnt lgkmcnt(8)
 v_smfmac_f32_16x16x64_bf16 v[88:91], v[96:99], a[128:135], v17
 ds_read_b128 v[224:227], v15 offset:8192
 v_smfmac_f32_16x16x64_bf16 v[92:95], v[96:99], a[136:143], v17
 ds_read_b128 v[76:79], v0 offset:8224
 s_waitcnt lgkmcnt(8)
 v_smfmac_f32_16x16x64_bf16 v[88:91], v[100:103], a[144:151], v17
 ds_read_b128 v[228:231], v15 offset:9216
 v_smfmac_f32_16x16x64_bf16 v[92:95], v[100:103], a[152:159], v17
 ds_read_b128 v[80:83], v0 offset:9216
 s_waitcnt lgkmcnt(8)
 v_smfmac_f32_16x16x64_bf16 v[88:91], v[112:115], a[160:167], v17
 ds_read_b128 v[232:235], v15 offset:10240
 v_smfmac_f32_16x16x64_bf16 v[92:95], v[112:115], a[168:175], v17
 ds_read_b128 v[84:87], v0 offset:9248
 s_waitcnt lgkmcnt(8)
 v_smfmac_f32_16x16x64_bf16 v[88:91], v[116:119], a[176:183], v17
 ds_read_b128 v[236:239], v15 offset:11264
 v_smfmac_f32_16x16x64_bf16 v[92:95], v[116:119], a[184:191], v17
 ds_read_b128 v[240:243], v15 offset:12288
 s_waitcnt lgkmcnt(8)
 v_smfmac_f32_16x16x64_bf16 v[88:91], v[72:75], a[192:199], v17
 ds_read_b128 v[244:247], v15 offset:13312
 v_smfmac_f32_16x16x64_bf16 v[92:95], v[72:75], a[200:207], v17
 ds_read_b128 v[248:251], v15 offset:14336
 s_waitcnt lgkmcnt(8)
 v_smfmac_f32_16x16x64_bf16 v[88:91], v[76:79], a[208:215], v17
 ds_read_b128 v[252:255], v15 offset:15360
 v_smfmac_f32_16x16x64_bf16 v[92:95], v[76:79], a[216:223], v17
 s_waitcnt lgkmcnt(7)
 v_smfmac_f32_16x16x64_bf16 v[88:91], v[80:83], a[224:231], v17
 v_smfmac_f32_16x16x64_bf16 v[92:95], v[80:83], a[232:239], v17
 s_waitcnt lgkmcnt(5)
 v_smfmac_f32_16x16x64_bf16 v[88:91], v[84:87], a[240:247], v17
 v_smfmac_f32_16x16x64_bf16 v[92:95], v[84:87], a[248:255], v17
 s_nop 2
 v_cvt_pk_bf16_f32 v120, v88, v89
 v_cvt_pk_bf16_f32 v121, v90, v91
 ds_write_b64 v6, v[120:121] offset:26624
 s_nop 1
 v_cvt_pk_bf16_f32 v122, v92, v93
 v_cvt_pk_bf16_f32 v123, v94, v95
 ds_write_b64 v6, v[122:123] offset:27136
 s_waitcnt lgkmcnt(0)
 s_barrier
 ds_read_b64_tr_b16 v[72:73], v7 offset:26624
 ds_read_b64_tr_b16 v[74:75], v7 offset:27136
 ds_read_b64_tr_b16 v[76:77], v7 offset:27648
 ds_read_b64_tr_b16 v[78:79], v7 offset:28160
 ds_read_b64_tr_b16 v[80:81], v7 offset:28672
 ds_read_b64_tr_b16 v[82:83], v7 offset:29184
 ds_read_b64_tr_b16 v[84:85], v7 offset:29696
 ds_read_b64_tr_b16 v[86:87], v7 offset:30208
 ds_read_b64_tr_b16 v[112:113], v8 offset:26624
 ds_read_b64_tr_b16 v[114:115], v8 offset:27136
 s_waitcnt lgkmcnt(8)
 v_mfma_f32_16x16x32_bf16 v[92:95], v[40:43], v[72:75], 0
 v_mfma_f32_16x16x32_bf16 v[96:99], v[56:59], v[72:75], 0
 v_mfma_f32_16x16x32_bf16 v[88:91], v[72:75], v[72:75], 0
 s_waitcnt lgkmcnt(6)
 v_mfma_f32_16x16x32_bf16 v[92:95], v[44:47], v[76:79], v[92:95]
 v_mfma_f32_16x16x32_bf16 v[96:99], v[60:63], v[76:79], v[96:99]
 v_mfma_f32_16x16x32_bf16 v[88:91], v[76:79], v[76:79], v[88:91]
 s_waitcnt lgkmcnt(4)
 v_mfma_f32_16x16x32_bf16 v[92:95], v[48:51], v[80:83], v[92:95]
 buffer_load_dwordx2 v[124:125], v1, s[4:7], s66 offen sc1
 v_mfma_f32_16x16x32_bf16 v[96:99], v[64:67], v[80:83], v[96:99]
 v_mfma_f32_16x16x32_bf16 v[88:91], v[80:83], v[80:83], v[88:91]
 s_waitcnt lgkmcnt(0)
 buffer_store_dwordx4 v[112:115], v1, s[4:7], s62 offen
 s_waitcnt lgkmcnt(2)
 v_mfma_f32_16x16x32_bf16 v[92:95], v[52:55], v[84:87], v[92:95]
 v_mfma_f32_16x16x32_bf16 v[96:99], v[68:71], v[84:87], v[96:99]
 v_mfma_f32_16x16x32_bf16 v[88:91], v[84:87], v[84:87], v[88:91]
 v_mfma_f32_32x32x8_bf16 v[40:55], v[18:19], v[18:19], 0
 v_max3_f32 v126, v92, v93, v94
 ds_read_b128 v[80:83], v15 offset:16384
 ds_read_b128 v[84:87], v15 offset:17408
 v_max3_f32 v126, v126, v95, v96
 v_max3_f32 v126, v126, v97, v98
 v_max3_f32 v126, v126, v99, v90
 v_max_f32 v126, v126, v91
 v_mov_b32 v127, v126
 v_mov_b64 v[56:57], 0
 v_mov_b64 v[58:59], 0
 v_permlane16_swap_b32 v126, v127
 v_max_f32 v126, v126, v127
 v_mov_b32 v127, v126
 s_nop 1
 v_permlane32_swap_b32 v126, v127
 v_max_f32 v126, v126, v127
 v_mul_f32 v126, s79, v126
 v_fma_f32 v92, v92, s79, -v126
 v_fma_f32 v93, v93, s79, -v126
 v_fma_f32 v94, v94, s79, -v126
 v_fma_f32 v95, v95, s79, -v126
 v_fma_f32 v96, v96, s79, -v126
 v_fma_f32 v97, v97, s79, -v126
 v_fma_f32 v98, v98, s79, -v126
 v_fma_f32 v99, v99, s79, -v126
 v_exp_f32 v92, v92
 v_exp_f32 v93, v93
 v_exp_f32 v94, v94
 v_exp_f32 v95, v95
 v_exp_f32 v96, v96
 v_exp_f32 v97, v97
 v_exp_f32 v98, v98
 v_exp_f32 v99, v99
 v_fma_f32 v90, v90, s79, -v126
 v_cvt_pk_bf16_f32 v100, v92, v93
 v_cvt_pk_bf16_f32 v101, v94, v95
 v_cvt_pk_bf16_f32 v102, v96, v97
 v_cvt_pk_bf16_f32 v103, v98, v99
 v_fma_f32 v91, v91, s79, -v126
 v_exp_f32 v90, v90
 v_mfma_f32_16x16x32_bf16 v[120:123], v[28:31], v[100:103], 0
 v_exp_f32 v91, v91
 v_mfma_f32_16x16x32_bf16 v[112:115], v[104:107], v[100:103], 0
 v_cvt_pk_bf16_f32 v36, v90, v91
 v_cvt_pk_bf16_f32 v39, v90, v91
 v_mfma_f32_16x16x32_bf16 v[116:119], v[108:111], v[100:103], 0
 s_waitcnt vmcnt(0)
 v_mfma_f32_16x16x16_bf16 v[120:123], v[28:29], v[36:37], v[120:123]
L_pv_222:
 v_cmp_eq_u32 vcc, -1, v124
 s_cbranch_vccnz L_rt_223
 v_mfma_f32_16x16x16_bf16 v[112:115], v[124:125], v[36:37], v[112:115]
 v_mfma_f32_16x16x16_bf16 v[116:119], v[124:125], v[38:39], v[116:119]
 v_rcp_f32 v120, v120
 ds_read_b128 v[88:91], v15 offset:18432
 ds_read_b128 v[92:95], v15 offset:19456
 ds_read_b128 v[96:99], v15 offset:20480
 ds_read_b128 v[100:103], v15 offset:21504
 s_mov_b64 exec, s[28:29]
 v_pk_mul_f32 v[112:113], v[112:113], v[120:121] op_sel_hi:[1,0]
 v_pk_mul_f32 v[114:115], v[114:115], v[120:121] op_sel_hi:[1,0]
 v_cvt_pk_bf16_f32 v112, v112, v113
 v_cvt_pk_bf16_f32 v113, v114, v115
 v_pk_mul_f32 v[116:117], v[116:117], v[120:121] op_sel_hi:[1,0]
 v_pk_mul_f32 v[118:119], v[118:119], v[120:121] op_sel_hi:[1,0]
 v_cvt_pk_bf16_f32 v114, v116, v117
 v_cvt_pk_bf16_f32 v115, v118, v119
 ds_write_b128 v9, v[112:115] offset:30720
 s_mov_b64 exec, -1
 s_waitcnt lgkmcnt(0)
 s_barrier
 ds_read_b128 v[60:63], v0 offset:30720
 ds_read_b128 v[64:67], v0 offset:30752
 ds_read_b128 v[68:71], v0 offset:31744
 ds_read_b128 v[72:75], v0 offset:31776
 s_waitcnt lgkmcnt(3)
 v_smfmac_f32_16x16x64_bf16 v[40:43], v[60:63], v[224:231], v17
 ds_read_b128 v[224:227], v15 offset:22528
 v_smfmac_f32_16x16x64_bf16 v[44:47], v[60:63], v[232:239], v17
 ds_read_b128 v[228:231], v15 offset:23552
 s_waitcnt lgkmcnt(4)
 v_smfmac_f32_16x16x64_bf16 v[40:43], v[64:67], v[240:247], v17
 ds_read_b128 v[232:235], v15 offset:24576
 v_smfmac_f32_16x16x64_bf16 v[44:47], v[64:67], v[248:255], v17
 ds_read_b128 v[236:239], v15 offset:25600
 s_waitcnt lgkmcnt(5)
 v_smfmac_f32_16x16x64_bf16 v[40:43], v[68:71], v[80:87], v17
 ds_read_b128 v[240:243], v15 offset:26624
 v_smfmac_f32_16x16x64_bf16 v[44:47], v[68:71], v[128:135], v17
 ds_read_b128 v[244:247], v15 offset:27648
 s_waitcnt lgkmcnt(6)
 v_smfmac_f32_16x16x64_bf16 v[40:43], v[72:75], v[136:143], v17
 ds_read_b128 v[248:251], v15 offset:28672
 v_smfmac_f32_16x16x64_bf16 v[44:47], v[72:75], v[144:151], v17
 ds_read_b128 v[252:255], v15 offset:29696
 v_smfmac_f32_16x16x64_bf16 v[48:51], v[60:63], v[152:159], v17
 ds_read_b128 v[80:83], v15 offset:30720
 v_cvt_pk_bf16_f32 v116, v40, v41
 v_cvt_pk_bf16_f32 v117, v42, v43
 v_and_b32 v116, -2, v116
 v_smfmac_f32_16x16x64_bf16 v[52:55], v[60:63], v[160:167], v17
 ds_read_b128 v[84:87], v15 offset:31744
 v_cvt_pk_bf16_f32 v118, v44, v45
 v_cvt_pk_bf16_f32 v119, v46, v47
 v_and_b32 v118, -2, v118
 buffer_store_dwordx4 v[116:119], v10, s[4:7], s68 offen
 v_smfmac_f32_16x16x64_bf16 v[48:51], v[64:67], v[168:175], v17
 v_smfmac_f32_16x16x64_bf16 v[52:55], v[64:67], v[176:183], v17
 v_smfmac_f32_16x16x64_bf16 v[48:51], v[68:71], v[184:191], v17
 v_smfmac_f32_16x16x64_bf16 v[52:55], v[68:71], v[88:95], v17
 v_smfmac_f32_16x16x64_bf16 v[48:51], v[72:75], v[96:103], v17
 s_waitcnt lgkmcnt(8)
 v_smfmac_f32_16x16x64_bf16 v[52:55], v[72:75], v[224:231], v17
 s_waitcnt lgkmcnt(6)
 v_smfmac_f32_16x16x64_bf16 v[56:59], v[60:63], v[232:239], v17
 v_cvt_pk_bf16_f32 v120, v48, v49
 v_cvt_pk_bf16_f32 v121, v50, v51
 v_and_b32 v120, -2, v120
 s_waitcnt lgkmcnt(4)
 v_smfmac_f32_16x16x64_bf16 v[56:59], v[64:67], v[240:247], v17
 v_cvt_pk_bf16_f32 v122, v52, v53
 v_cvt_pk_bf16_f32 v123, v54, v55
 v_and_b32 v122, -2, v122
 buffer_store_dwordx4 v[120:123], v10, s[4:7], s69 offen
 s_waitcnt lgkmcnt(2)
 v_smfmac_f32_16x16x64_bf16 v[56:59], v[68:71], v[248:255], v17
 s_waitcnt lgkmcnt(0)
 v_smfmac_f32_16x16x64_bf16 v[56:59], v[72:75], v[80:87], v17
 s_nop 7
 v_cvt_pk_bf16_f32 v124, v56, v57
 v_cvt_pk_bf16_f32 v125, v58, v59
 v_and_b32 v124, -2, v124
 buffer_store_dwordx2 v[124:125], v10, s[4:7], s70 offen
 ds_read_b128 v[224:227], v15 offset:0
 ds_read_b128 v[228:231], v15 offset:1024
 ds_read_b128 v[232:235], v15 offset:2048
 ds_read_b128 v[236:239], v15 offset:3072
 ds_read_b128 v[240:243], v15 offset:4096
 ds_read_b128 v[244:247], v15 offset:5120
 ds_read_b128 v[248:251], v15 offset:6144
 ds_read_b128 v[252:255], v15 offset:7168
 v_mov_b64 v[88:89], 0
 v_mov_b64 v[90:91], 0
 v_mov_b64 v[92:93], 0
 v_mov_b64 v[94:95], 0
 s_cmp_eq_u32 s55, 0
 s_cbranch_scc1 L_nr_224
 s_nop 15
 s_nop 15
 s_nop 15
 s_nop 15
 s_nop 15
L_pp_226:
 buffer_load_dwordx4 v[40:43], v1, s[4:7], s74 offen offset:0 sc1
 buffer_load_dwordx4 v[44:47], v1, s[4:7], s74 offen offset:1024 sc1
 buffer_load_dwordx4 v[48:51], v1, s[4:7], s74 offen offset:2048 sc1
 buffer_load_dwordx4 v[52:55], v1, s[4:7], s74 offen offset:3072 sc1
 s_waitcnt vmcnt(3)
 v_mfma_f32_16x16x32_bf16 v[56:59], v[40:43], v[20:23], 0
 v_or_b32 v14, v40, v42
 s_waitcnt vmcnt(2)
 v_mfma_f32_16x16x32_bf16 v[56:59], v[44:47], v[20:23], v[56:59]
 v_or3_b32 v14, v14, v44, v46
 s_waitcnt vmcnt(1)
 v_mfma_f32_16x16x32_bf16 v[56:59], v[48:51], v[20:23], v[56:59]
 v_or3_b32 v14, v14, v48, v50
 s_waitcnt vmcnt(0)
 v_mfma_f32_16x16x32_bf16 v[56:59], v[52:55], v[20:23], v[56:59]
 v_or3_b32 v14, v14, v52, v54
 v_and_b32 v14, 1, v14
 v_cmp_ne_u32 vcc, 0, v14
 s_cbranch_vccnz L_rt_227
 s_nop 2
 v_cvt_pk_bf16_f32 v60, v56, v57
 v_cvt_pk_bf16_f32 v61, v58, v59
 s_nop 0
 v_mov_b32_dpp v62, v60 quad_perm:[2,3,2,3] row_mask:0xf bank_mask:0xf
 v_mov_b32_dpp v63, v61 quad_perm:[2,3,2,3] row_mask:0xf bank_mask:0xf
 s_mov_b64 exec, s[30:31]
 buffer_store_dwordx4 v[60:63], v11, s[4:7], s59 offen sc1
 s_mov_b64 exec, 1
 buffer_store_dword v13, off, s[4:7], s17
 s_mov_b64 exec, s[30:31]
 buffer_store_dwordx4 v[32:35], v11, s[4:7], s57 offen sc1
 s_mov_b64 exec, -1
 s_barrier
 s_nop 15
 s_nop 15
 s_nop 15
 s_nop 15
 s_nop 15
 s_nop 15
 s_nop 15
L_rj_225:
 v_add_u32 v13, 1, v13
 s_add_u32 s53, s53, 1
.p2align 3
 s_mov_b32 s51, 0
 buffer_load_dwordx4 v[40:43], v2, s[4:7], s59 offen offset:0 sc1
 buffer_load_dwordx4 v[44:47], v2, s[4:7], s59 offen offset:128 sc1
 buffer_load_dwordx4 v[48:51], v2, s[4:7], s59 offen offset:1024 sc1
 buffer_load_dwordx4 v[52:55], v2, s[4:7], s59 offen offset:1152 sc1
 buffer_load_dwordx4 v[56:59], v3, s[4:7], s59 offen offset:0 sc1
L_xm_228:
 s_waitcnt vmcnt(4)
 v_mfma_f32_16x16x32_bf16 v[60:63], v[24:27], v[40:43], 0
 s_waitcnt vmcnt(3)
 v_mfma_f32_16x16x32_bf16 v[64:67], v[24:27], v[44:47], 0
 s_waitcnt vmcnt(2)
 v_mfma_f32_16x16x32_bf16 v[68:71], v[24:27], v[48:51], 0
 v_max3_u32 v14, v40, v44, v48
 v_cvt_pk_bf16_f32 v60, v60, v61
 v_cvt_pk_bf16_f32 v61, v62, v63
 ds_write_b64 v4, v[60:61] offset:0
 s_waitcnt vmcnt(1)
 v_mfma_f32_16x16x32_bf16 v[72:75], v[24:27], v[52:55], 0
 v_cvt_pk_bf16_f32 v64, v64, v65
 v_cvt_pk_bf16_f32 v65, v66, v67
 ds_write_b64 v4, v[64:65] offset:8
 s_waitcnt vmcnt(0)
 v_mfma_f32_16x16x32_bf16 v[76:79], v[24:27], v[56:59], 0
 v_max3_u32 v14, v14, v52, v56
 v_cmp_eq_u32 vcc, -1, v14
 v_cvt_pk_bf16_f32 v68, v68, v69
 v_cvt_pk_bf16_f32 v69, v70, v71
 ds_write_b64 v4, v[68:69] offset:1024
 s_cbranch_vccnz L_rt_229
 v_cvt_pk_bf16_f32 v72, v72, v73
 v_cvt_pk_bf16_f32 v73, v74, v75
 ds_write_b64 v4, v[72:73] offset:1032
 s_nop 0
 v_cvt_pk_bf16_f32 v76, v76, v77
 v_cvt_pk_bf16_f32 v77, v78, v79
 ds_write_b64 v5, v[76:77] offset:0
 s_waitcnt lgkmcnt(0)
 s_barrier
L_ch_b1f3:
 ds_read_b128 v[72:75], v0 offset:0
 ds_read_b128 v[76:79], v0 offset:32
 ds_read_b128 v[80:83], v0 offset:1024
 s_waitcnt lgkmcnt(2)
 v_smfmac_f32_16x16x64_bf16 v[88:91], v[72:75], v[224:231], v17
 ds_read_b128 v[84:87], v0 offset:1056
 v_smfmac_f32_16x16x64_bf16 v[92:95], v[72:75], v[232:239], v17
 ds_read_b128 v[96:99], v0 offset:2048
 s_waitcnt lgkmcnt(3)
 v_smfmac_f32_16x16x64_bf16 v[88:91], v[76:79], v[240:247], v17
 ds_read_b128 v[100:103], v0 offset:2080
 v_smfmac_f32_16x16x64_bf16 v[92:95], v[76:79], v[248:255], v17
 ds_read_b128 v[112:115], v0 offset:3072
 s_waitcnt lgkmcnt(4)
 v_smfmac_f32_16x16x64_bf16 v[88:91], v[80:83], v[192:199], v17
 ds_read_b128 v[40:43], v1 offset:10240
 v_smfmac_f32_16x16x64_bf16 v[92:95], v[80:83], v[200:207], v17
 ds_read_b128 v[116:119], v0 offset:3104
 s_waitcnt lgkmcnt(5)
 v_smfmac_f32_16x16x64_bf16 v[88:91], v[84:87], v[208:215], v17
 ds_read_b128 v[44:47], v1 offset:11264
 v_smfmac_f32_16x16x64_bf16 v[92:95], v[84:87], v[216:223], v17
 ds_read_b128 v[72:75], v0 offset:4096
 s_waitcnt lgkmcnt(6)
 v_smfmac_f32_16x16x64_bf16 v[88:91], v[96:99], a[0:7], v17
 ds_read_b128 v[48:51], v1 offset:12288
 v_smfmac_f32_16x16x64_bf16 v[92:95], v[96:99], a[8:15], v17
 ds_read_b128 v[76:79], v0 offset:4128
 s_waitcnt lgkmcnt(7)
 v_smfmac_f32_16x16x64_bf16 v[88:91], v[100:103], a[16:23], v17
 ds_read_b128 v[52:55], v1 offset:13312
 v_smfmac_f32_16x16x64_bf16 v[92:95], v[100:103], a[24:31], v17
 ds_read_b128 v[80:83], v0 offset:5120
 s_waitcnt lgkmcnt(8)
 v_smfmac_f32_16x16x64_bf16 v[88:91], v[112:115], a[32:39], v17
 ds_read_b128 v[56:59], v1 offset:14336
 v_smfmac_f32_16x16x64_bf16 v[92:95], v[112:115], a[40:47], v17
 ds_read_b128 v[84:87], v0 offset:5152
 s_waitcnt lgkmcnt(8)
 v_smfmac_f32_16x16x64_bf16 v[88:91], v[116:119], a[48:55], v17
 ds_read_b128 v[60:63], v1 offset:15360
 v_smfmac_f32_16x16x64_bf16 v[92:95], v[116:119], a[56:63], v17
 ds_read_b128 v[96:99], v0 offset:6144
 s_waitcnt lgkmcnt(8)
 v_smfmac_f32_16x16x64_bf16 v[88:91], v[72:75], a[64:71], v17
 ds_read_b128 v[64:67], v1 offset:16384
 v_smfmac_f32_16x16x64_bf16 v[92:95], v[72:75], a[72:79], v17
 ds_read_b128 v[100:103], v0 offset:6176
 s_waitcnt lgkmcnt(8)
 v_smfmac_f32_16x16x64_bf16 v[88:91], v[76:79], a[80:87], v17
 ds_read_b128 v[68:71], v1 offset:17408
 v_smfmac_f32_16x16x64_bf16 v[92:95], v[76:79], a[88:95], v17
 ds_read_b128 v[112:115], v0 offset:7168
 s_waitcnt lgkmcnt(8)
 v_smfmac_f32_16x16x64_bf16 v[88:91], v[80:83], a[96:103], v17
 ds_read_b128 v[104:107], v16 offset:18432
 v_smfmac_f32_16x16x64_bf16 v[92:95], v[80:83], a[104:111], v17
 ds_read_b128 v[116:119], v0 offset:7200
 s_waitcnt lgkmcnt(8)
 v_smfmac_f32_16x16x64_bf16 v[88:91], v[84:87], a[112:119], v17
 ds_read_b128 v[108:111], v16 offset:19456
 v_smfmac_f32_16x16x64_bf16 v[92:95], v[84:87], a[120:127], v17
 ds_read_b128 v[72:75], v0 offset:8192
 s_waitcnt lgkmcnt(8)
 v_smfmac_f32_16x16x64_bf16 v[88:91], v[96:99], a[128:135], v17
 ds_read_b128 v[224:227], v15 offset:8192
 v_smfmac_f32_16x16x64_bf16 v[92:95], v[96:99], a[136:143], v17
 ds_read_b128 v[76:79], v0 offset:8224
 s_waitcnt lgkmcnt(8)
 v_smfmac_f32_16x16x64_bf16 v[88:91], v[100:103], a[144:151], v17
 ds_read_b128 v[228:231], v15 offset:9216
 v_smfmac_f32_16x16x64_bf16 v[92:95], v[100:103], a[152:159], v17
 ds_read_b128 v[80:83], v0 offset:9216
 s_waitcnt lgkmcnt(8)
 v_smfmac_f32_16x16x64_bf16 v[88:91], v[112:115], a[160:167], v17
 ds_read_b128 v[232:235], v15 offset:10240
 v_smfmac_f32_16x16x64_bf16 v[92:95], v[112:115], a[168:175], v17
 ds_read_b128 v[84:87], v0 offset:9248
 s_waitcnt lgkmcnt(8)
 v_smfmac_f32_16x16x64_bf16 v[88:91], v[116:119], a[176:183], v17
 ds_read_b128 v[236:239], v15 offset:11264
 v_smfmac_f32_16x16x64_bf16 v[92:95], v[116:119], a[184:191], v17
 ds_read_b128 v[240:243], v15 offset:12288
 s_waitcnt lgkmcnt(8)
 v_smfmac_f32_16x16x64_bf16 v[88:91], v[72:75], a[192:199], v17
 ds_read_b128 v[244:247], v15 offset:13312
 v_smfmac_f32_16x16x64_bf16 v[92:95], v[72:75], a[200:207], v17
 ds_read_b128 v[248:251], v15 offset:14336
 s_waitcnt lgkmcnt(8)
 v_smfmac_f32_16x16x64_bf16 v[88:91], v[76:79], a[208:215], v17
 ds_read_b128 v[252:255], v15 offset:15360
 v_smfmac_f32_16x16x64_bf16 v[92:95], v[76:79], a[216:223], v17
 s_waitcnt lgkmcnt(7)
 v_smfmac_f32_16x16x64_bf16 v[88:91], v[80:83], a[224:231], v17
 v_smfmac_f32_16x16x64_bf16 v[92:95], v[80:83], a[232:239], v17
 s_waitcnt lgkmcnt(5)
 v_smfmac_f32_16x16x64_bf16 v[88:91], v[84:87], a[240:247], v17
 v_smfmac_f32_16x16x64_bf16 v[92:95], v[84:87], a[248:255], v17
 s_nop 2
 v_cvt_pk_bf16_f32 v120, v88, v89
 v_cvt_pk_bf16_f32 v121, v90, v91
 ds_write_b64 v6, v[120:121] offset:26624
 s_nop 1
 v_cvt_pk_bf16_f32 v122, v92, v93
 v_cvt_pk_bf16_f32 v123, v94, v95
 ds_write_b64 v6, v[122:123] offset:27136
 s_waitcnt lgkmcnt(0)
 s_barrier
 ds_read_b64_tr_b16 v[72:73], v7 offset:26624
 ds_read_b64_tr_b16 v[74:75], v7 offset:27136
 ds_read_b64_tr_b16 v[76:77], v7 offset:27648
 ds_read_b64_tr_b16 v[78:79], v7 offset:28160
 ds_read_b64_tr_b16 v[80:81], v7 offset:28672
 ds_read_b64_tr_b16 v[82:83], v7 offset:29184
 ds_read_b64_tr_b16 v[84:85], v7 offset:29696
 ds_read_b64_tr_b16 v[86:87], v7 offset:30208
 ds_read_b64_tr_b16 v[112:113], v8 offset:26624
 ds_read_b64_tr_b16 v[114:115], v8 offset:27136
 s_waitcnt lgkmcnt(8)
 v_mfma_f32_16x16x32_bf16 v[92:95], v[40:43], v[72:75], 0
 v_mfma_f32_16x16x32_bf16 v[96:99], v[56:59], v[72:75], 0
 v_mfma_f32_16x16x32_bf16 v[88:91], v[72:75], v[72:75], 0
 s_waitcnt lgkmcnt(6)
 v_mfma_f32_16x16x32_bf16 v[92:95], v[44:47], v[76:79], v[92:95]
 v_mfma_f32_16x16x32_bf16 v[96:99], v[60:63], v[76:79], v[96:99]
 v_mfma_f32_16x16x32_bf16 v[88:91], v[76:79], v[76:79], v[88:91]
 s_waitcnt lgkmcnt(4)
 v_mfma_f32_16x16x32_bf16 v[92:95], v[48:51], v[80:83], v[92:95]
 buffer_load_dwordx2 v[124:125], v1, s[4:7], s67 offen sc1
 v_mfma_f32_16x16x32_bf16 v[96:99], v[64:67], v[80:83], v[96:99]
 v_mfma_f32_16x16x32_bf16 v[88:91], v[80:83], v[80:83], v[88:91]
 s_waitcnt lgkmcnt(0)
 buffer_store_dwordx4 v[112:115], v1, s[4:7], s63 offen
 s_waitcnt lgkmcnt(2)
 v_mfma_f32_16x16x32_bf16 v[92:95], v[52:55], v[84:87], v[92:95]
 v_mfma_f32_16x16x32_bf16 v[96:99], v[68:71], v[84:87], v[96:99]
 v_mfma_f32_16x16x32_bf16 v[88:91], v[84:87], v[84:87], v[88:91]
 s_cmp_eq_u32 s53, 63
 s_cbranch_scc1 L_ch_last
 v_mfma_f32_32x32x8_bf16 v[40:55], v[18:19], v[18:19], 0
 v_max3_f32 v126, v92, v93, v94
 ds_read_b128 v[80:83], v15 offset:16384
 ds_read_b128 v[84:87], v15 offset:17408
 v_max3_f32 v126, v126, v95, v96
 v_max3_f32 v126, v126, v97, v98
 v_max3_f32 v126, v126, v99, v90
 v_max_f32 v126, v126, v91
 v_mov_b32 v127, v126
 v_mov_b64 v[56:57], 0
 v_mov_b64 v[58:59], 0
 v_permlane16_swap_b32 v126, v127
 v_max_f32 v126, v126, v127
 v_mov_b32 v127, v126
 s_nop 1
 v_permlane32_swap_b32 v126, v127
 v_max_f32 v126, v126, v127
 v_mul_f32 v126, s79, v126
 v_fma_f32 v92, v92, s79, -v126
 v_fma_f32 v93, v93, s79, -v126
 v_fma_f32 v94, v94, s79, -v126
 v_fma_f32 v95, v95, s79, -v126
 v_fma_f32 v96, v96, s79, -v126
 v_fma_f32 v97, v97, s79, -v126
 v_fma_f32 v98, v98, s79, -v126
 v_fma_f32 v99, v99, s79, -v126
 v_exp_f32 v92, v92
 v_exp_f32 v93, v93
 v_exp_f32 v94, v94
 v_exp_f32 v95, v95
 v_exp_f32 v96, v96
 v_exp_f32 v97, v97
 v_exp_f32 v98, v98
 v_exp_f32 v99, v99
 v_fma_f32 v90, v90, s79, -v126
 v_cvt_pk_bf16_f32 v100, v92, v93
 v_cvt_pk_bf16_f32 v101, v94, v95
 v_cvt_pk_bf16_f32 v102, v96, v97
 v_cvt_pk_bf16_f32 v103, v98, v99
 v_fma_f32 v91, v91, s79, -v126
 v_exp_f32 v90, v90
 v_mfma_f32_16x16x32_bf16 v[120:123], v[28:31], v[100:103], 0
 v_exp_f32 v91, v91
 v_mfma_f32_16x16x32_bf16 v[112:115], v[104:107], v[100:103], 0
 v_cvt_pk_bf16_f32 v36, v90, v91
 v_cvt_pk_bf16_f32 v39, v90, v91
 v_mfma_f32_16x16x32_bf16 v[116:119], v[108:111], v[100:103], 0
 s_waitcnt vmcnt(0)
 v_mfma_f32_16x16x16_bf16 v[120:123], v[28:29], v[36:37], v[120:123]
L_pv_230:
 v_cmp_eq_u32 vcc, -1, v124
 s_cbranch_vccnz L_rt_231
 v_mfma_f32_16x16x16_bf16 v[112:115], v[124:125], v[36:37], v[112:115]
 v_mfma_f32_16x16x16_bf16 v[116:119], v[124:125], v[38:39], v[116:119]
 v_rcp_f32 v120, v120
 ds_read_b128 v[88:91], v15 offset:18432
 ds_read_b128 v[92:95], v15 offset:19456
 ds_read_b128 v[96:99], v15 offset:20480
 ds_read_b128 v[100:103], v15 offset:21504
 s_mov_b64 exec, s[28:29]
 v_pk_mul_f32 v[112:113], v[112:113], v[120:121] op_sel_hi:[1,0]
 v_pk_mul_f32 v[114:115], v[114:115], v[120:121] op_sel_hi:[1,0]
 v_cvt_pk_bf16_f32 v112, v112, v113
 v_cvt_pk_bf16_f32 v113, v114, v115
 v_pk_mul_f32 v[116:117], v[116:117], v[120:121] op_sel_hi:[1,0]
 v_pk_mul_f32 v[118:119], v[118:119], v[120:121] op_sel_hi:[1,0]
 v_cvt_pk_bf16_f32 v114, v116, v117
 v_cvt_pk_bf16_f32 v115, v118, v119
 ds_write_b128 v9, v[112:115] offset:30720
 s_mov_b64 exec, -1
 s_waitcnt lgkmcnt(0)
 s_barrier
 ds_read_b128 v[60:63], v0 offset:30720
 ds_read_b128 v[64:67], v0 offset:30752
 ds_read_b128 v[68:71], v0 offset:31744
 ds_read_b128 v[72:75], v0 offset:31776
 s_waitcnt lgkmcnt(3)
 v_smfmac_f32_16x16x64_bf16 v[40:43], v[60:63], v[224:231], v17
 ds_read_b128 v[224:227], v15 offset:22528
 v_smfmac_f32_16x16x64_bf16 v[44:47], v[60:63], v[232:239], v17
 ds_read_b128 v[228:231], v15 offset:23552
 s_waitcnt lgkmcnt(4)
 v_smfmac_f32_16x16x64_bf16 v[40:43], v[64:67], v[240:247], v17
 ds_read_b128 v[232:235], v15 offset:24576
 v_smfmac_f32_16x16x64_bf16 v[44:47], v[64:67], v[248:255], v17
 ds_read_b128 v[236:239], v15 offset:25600
 s_waitcnt lgkmcnt(5)
 v_smfmac_f32_16x16x64_bf16 v[40:43], v[68:71], v[80:87], v17
 ds_read_b128 v[240:243], v15 offset:26624
 v_smfmac_f32_16x16x64_bf16 v[44:47], v[68:71], v[128:135], v17
 ds_read_b128 v[244:247], v15 offset:27648
 s_waitcnt lgkmcnt(6)
 v_smfmac_f32_16x16x64_bf16 v[40:43], v[72:75], v[136:143], v17
 ds_read_b128 v[248:251], v15 offset:28672
 v_smfmac_f32_16x16x64_bf16 v[44:47], v[72:75], v[144:151], v17
 ds_read_b128 v[252:255], v15 offset:29696
 v_smfmac_f32_16x16x64_bf16 v[48:51], v[60:63], v[152:159], v17
 ds_read_b128 v[80:83], v15 offset:30720
 v_cvt_pk_bf16_f32 v116, v40, v41
 v_cvt_pk_bf16_f32 v117, v42, v43
 v_and_b32 v116, -2, v116
 v_smfmac_f32_16x16x64_bf16 v[52:55], v[60:63], v[160:167], v17
 ds_read_b128 v[84:87], v15 offset:31744
 v_cvt_pk_bf16_f32 v118, v44, v45
 v_cvt_pk_bf16_f32 v119, v46, v47
 v_and_b32 v118, -2, v118
 buffer_store_dwordx4 v[116:119], v10, s[4:7], s71 offen
 v_smfmac_f32_16x16x64_bf16 v[48:51], v[64:67], v[168:175], v17
 v_smfmac_f32_16x16x64_bf16 v[52:55], v[64:67], v[176:183], v17
 v_smfmac_f32_16x16x64_bf16 v[48:51], v[68:71], v[184:191], v17
 v_smfmac_f32_16x16x64_bf16 v[52:55], v[68:71], v[88:95], v17
 v_smfmac_f32_16x16x64_bf16 v[48:51], v[72:75], v[96:103], v17
 s_waitcnt lgkmcnt(8)
 v_smfmac_f32_16x16x64_bf16 v[52:55], v[72:75], v[224:231], v17
 s_waitcnt lgkmcnt(6)
 v_smfmac_f32_16x16x64_bf16 v[56:59], v[60:63], v[232:239], v17
 v_cvt_pk_bf16_f32 v120, v48, v49
 v_cvt_pk_bf16_f32 v121, v50, v51
 v_and_b32 v120, -2, v120
 s_waitcnt lgkmcnt(4)
 v_smfmac_f32_16x16x64_bf16 v[56:59], v[64:67], v[240:247], v17
 v_cvt_pk_bf16_f32 v122, v52, v53
 v_cvt_pk_bf16_f32 v123, v54, v55
 v_and_b32 v122, -2, v122
 buffer_store_dwordx4 v[120:123], v10, s[4:7], s72 offen
 s_waitcnt lgkmcnt(2)
 v_smfmac_f32_16x16x64_bf16 v[56:59], v[68:71], v[248:255], v17
 s_waitcnt lgkmcnt(0)
 v_smfmac_f32_16x16x64_bf16 v[56:59], v[72:75], v[80:87], v17
 s_nop 7
 v_cvt_pk_bf16_f32 v124, v56, v57
 v_cvt_pk_bf16_f32 v125, v58, v59
 v_and_b32 v124, -2, v124
 buffer_store_dwordx2 v[124:125], v10, s[4:7], s73 offen
 ds_read_b128 v[224:227], v15 offset:0
 ds_read_b128 v[228:231], v15 offset:1024
 ds_read_b128 v[232:235], v15 offset:2048
 ds_read_b128 v[236:239], v15 offset:3072
 ds_read_b128 v[240:243], v15 offset:4096
 ds_read_b128 v[244:247], v15 offset:5120
 ds_read_b128 v[248:251], v15 offset:6144
 ds_read_b128 v[252:255], v15 offset:7168
 v_mov_b64 v[88:89], 0
 v_mov_b64 v[90:91], 0
 v_mov_b64 v[92:93], 0
 v_mov_b64 v[94:95], 0
 s_cmp_eq_u32 s55, 0
 s_cbranch_scc1 L_nr_232
 s_nop 15
 s_nop 15
 s_nop 15
 s_nop 15
 s_nop 15
L_pp_234:
 buffer_load_dwordx4 v[40:43], v1, s[4:7], s75 offen offset:0 sc1
 buffer_load_dwordx4 v[44:47], v1, s[4:7], s75 offen offset:1024 sc1
 buffer_load_dwordx4 v[48:51], v1, s[4:7], s75 offen offset:2048 sc1
 buffer_load_dwordx4 v[52:55], v1, s[4:7], s75 offen offset:3072 sc1
 s_waitcnt vmcnt(3)
 v_mfma_f32_16x16x32_bf16 v[56:59], v[40:43], v[20:23], 0
 v_or_b32 v14, v40, v42
 s_waitcnt vmcnt(2)
 v_mfma_f32_16x16x32_bf16 v[56:59], v[44:47], v[20:23], v[56:59]
 v_or3_b32 v14, v14, v44, v46
 s_waitcnt vmcnt(1)
 v_mfma_f32_16x16x32_bf16 v[56:59], v[48:51], v[20:23], v[56:59]
 v_or3_b32 v14, v14, v48, v50
 s_waitcnt vmcnt(0)
 v_mfma_f32_16x16x32_bf16 v[56:59], v[52:55], v[20:23], v[56:59]
 v_or3_b32 v14, v14, v52, v54
 v_and_b32 v14, 1, v14
 v_cmp_ne_u32 vcc, 0, v14
 s_cbranch_vccnz L_rt_235
 s_nop 2
 v_cvt_pk_bf16_f32 v60, v56, v57
 v_cvt_pk_bf16_f32 v61, v58, v59
 s_nop 0
 v_mov_b32_dpp v62, v60 quad_perm:[2,3,2,3] row_mask:0xf bank_mask:0xf
 v_mov_b32_dpp v63, v61 quad_perm:[2,3,2,3] row_mask:0xf bank_mask:0xf
 s_mov_b64 exec, s[30:31]
 buffer_store_dwordx4 v[60:63], v11, s[4:7], s56 offen sc1
 s_mov_b64 exec, 1
 buffer_store_dword v13, off, s[4:7], s17
 s_mov_b64 exec, s[30:31]
 buffer_store_dwordx4 v[32:35], v11, s[4:7], s58 offen sc1
 s_mov_b64 exec, -1
 s_barrier
 s_nop 15
 s_nop 15
 s_nop 15
 s_nop 15
 s_nop 15
 s_nop 15
 s_nop 15
L_rj_233:
 v_add_u32 v13, 1, v13
 s_add_u32 s53, s53, 1
 s_branch L_ch_loopf
L_rt_205:
 s_nop 7
 buffer_load_dwordx4 v[40:43], v2, s[4:7], s56 offen offset:0 sc1
 buffer_load_dwordx4 v[44:47], v2, s[4:7], s56 offen offset:128 sc1
 buffer_load_dwordx4 v[48:51], v2, s[4:7], s56 offen offset:1024 sc1
 buffer_load_dwordx4 v[52:55], v2, s[4:7], s56 offen offset:1152 sc1
 buffer_load_dwordx4 v[56:59], v3, s[4:7], s56 offen offset:0 sc1
 s_add_u32 s51, s51, 1
 s_cmp_lt_u32 s51, 131072
 s_cbranch_scc1 L_xm_204
 s_branch L_bail
L_rt_207:
 buffer_load_dwordx2 v[124:125], v1, s[4:7], s64 offen sc1
 s_waitcnt vmcnt(0)
 s_add_u32 s51, s51, 1
 s_cmp_lt_u32 s51, 131072
 s_cbranch_scc1 L_pv_206
 s_branch L_bail
L_rt_211:
 s_add_u32 s51, s51, 1
 s_cmp_lt_u32 s51, 131072
 s_cbranch_scc1 L_pp_210
 s_branch L_bail
L_nr_208:
 s_cmp_lg_u32 s50, 0
 s_cbranch_scc1 L_id_236
 buffer_store_dwordx4 v[32:35], v1, s[4:7], s62 offen offset:0
 buffer_store_dwordx4 v[32:35], v1, s[4:7], s62 offen offset:1024
 buffer_store_dwordx4 v[32:35], v1, s[4:7], s62 offen offset:2048
 buffer_store_dwordx4 v[32:35], v1, s[4:7], s62 offen offset:3072
 buffer_load_dword v14, off, s[4:7], s32 sc1
 s_waitcnt vmcnt(0)
 s_barrier
 s_add_u32 s76, s53, 1
L_fl_237:
 v_cmp_ge_u32 vcc, s76, v14
 s_cbranch_vccz L_fld_238
 buffer_load_dword v14, off, s[4:7], s32 sc1
 s_waitcnt vmcnt(0)
 s_add_u32 s51, s51, 1
 s_cmp_lt_u32 s51, 131072
 s_cbranch_scc1 L_fl_237
 s_branch L_bail
L_fld_238:
 s_lshl_b32 s16, s76, 19
 s_add_u32 s16, s16, s54
 s_mov_b32 m0, 10240
 s_nop 0
 buffer_load_dwordx4 v1, s[4:7], s16 offen offset:0 sc1 lds
 buffer_load_dwordx4 v1, s[4:7], s16 offen offset:1024 sc1 lds
 buffer_load_dwordx4 v1, s[4:7], s16 offen offset:2048 sc1 lds
 buffer_load_dwordx4 v1, s[4:7], s16 offen offset:3072 sc1 lds
 s_mov_b32 m0, 14336
 s_nop 0
 buffer_load_dwordx4 v12, s[4:7], s16 offen offset:0 sc1 lds
 buffer_load_dwordx4 v12, s[4:7], s16 offen offset:1024 sc1 lds
 buffer_load_dwordx4 v12, s[4:7], s16 offen offset:2048 sc1 lds
 buffer_load_dwordx4 v12, s[4:7], s16 offen offset:3072 sc1 lds
 s_add_u32 s16, s16, 67108864
 s_mov_b32 m0, 18432
 s_nop 0
 buffer_load_dwordx4 v1, s[4:7], s16 offen offset:0 sc1 lds
 buffer_load_dwordx4 v1, s[4:7], s16 offen offset:1024 sc1 lds
 buffer_load_dwordx4 v1, s[4:7], s16 offen offset:2048 sc1 lds
 buffer_load_dwordx4 v1, s[4:7], s16 offen offset:3072 sc1 lds
 s_mov_b32 m0, 22528
 s_nop 0
 buffer_load_dwordx4 v12, s[4:7], s16 offen offset:0 sc1 lds
 buffer_load_dwordx4 v12, s[4:7], s16 offen offset:1024 sc1 lds
 buffer_load_dwordx4 v12, s[4:7], s16 offen offset:2048 sc1 lds
 buffer_load_dwordx4 v12, s[4:7], s16 offen offset:3072 sc1 lds
 s_nop 15
 s_nop 15
 s_branch L_rj_209
L_id_236:
 s_barrier
 s_nop 15
 s_nop 15
 s_nop 15
 s_nop 15
 s_nop 15
 s_nop 15
 s_nop 15
 s_branch L_rj_209
L_rt_213:
 s_nop 7
 buffer_load_dwordx4 v[40:43], v2, s[4:7], s57 offen offset:0 sc1
 buffer_load_dwordx4 v[44:47], v2, s[4:7], s57 offen offset:128 sc1
 buffer_load_dwordx4 v[48:51], v2, s[4:7], s57 offen offset:1024 sc1
 buffer_load_dwordx4 v[52:55], v2, s[4:7], s57 offen offset:1152 sc1
 buffer_load_dwordx4 v[56:59], v3, s[4:7], s57 offen offset:0 sc1
 s_add_u32 s51, s51, 1
 s_cmp_lt_u32 s51, 131072
 s_cbranch_scc1 L_xm_212
 s_branch L_bail
L_rt_215:
 buffer_load_dwordx2 v[124:125], v1, s[4:7], s65 offen sc1
 s_waitcnt vmcnt(0)
 s_add_u32 s51, s51, 1
 s_cmp_lt_u32 s51, 131072
 s_cbranch_scc1 L_pv_214
 s_branch L_bail
L_rt_219:
 s_add_u32 s51, s51, 1
 s_cmp_lt_u32 s51, 131072
 s_cbranch_scc1 L_pp_218
 s_branch L_bail
L_nr_216:
 s_cmp_lg_u32 s50, 0
 s_cbranch_scc1 L_id_239
 buffer_store_dwordx4 v[32:35], v1, s[4:7], s63 offen offset:0
 buffer_store_dwordx4 v[32:35], v1, s[4:7], s63 offen offset:1024
 buffer_store_dwordx4 v[32:35], v1, s[4:7], s63 offen offset:2048
 buffer_store_dwordx4 v[32:35], v1, s[4:7], s63 offen offset:3072
 buffer_load_dword v14, off, s[4:7], s32 sc1
 s_waitcnt vmcnt(0)
 s_barrier
 s_add_u32 s76, s53, 1
L_fl_240:
 v_cmp_ge_u32 vcc, s76, v14
 s_cbranch_vccz L_fld_241
 buffer_load_dword v14, off, s[4:7], s32 sc1
 s_waitcnt vmcnt(0)
 s_add_u32 s51, s51, 1
 s_cmp_lt_u32 s51, 131072
 s_cbranch_scc1 L_fl_240
 s_branch L_bail
L_fld_241:
 s_lshl_b32 s16, s76, 19
 s_add_u32 s16, s16, s54
 s_mov_b32 m0, 10240
 s_nop 0
 buffer_load_dwordx4 v1, s[4:7], s16 offen offset:0 sc1 lds
 buffer_load_dwordx4 v1, s[4:7], s16 offen offset:1024 sc1 lds
 buffer_load_dwordx4 v1, s[4:7], s16 offen offset:2048 sc1 lds
 buffer_load_dwordx4 v1, s[4:7], s16 offen offset:3072 sc1 lds
 s_mov_b32 m0, 14336
 s_nop 0
 buffer_load_dwordx4 v12, s[4:7], s16 offen offset:0 sc1 lds
 buffer_load_dwordx4 v12, s[4:7], s16 offen offset:1024 sc1 lds
 buffer_load_dwordx4 v12, s[4:7], s16 offen offset:2048 sc1 lds
 buffer_load_dwordx4 v12, s[4:7], s16 offen offset:3072 sc1 lds
 s_add_u32 s16, s16, 67108864
 s_mov_b32 m0, 18432
 s_nop 0
 buffer_load_dwordx4 v1, s[4:7], s16 offen offset:0 sc1 lds
 buffer_load_dwordx4 v1, s[4:7], s16 offen offset:1024 sc1 lds
 buffer_load_dwordx4 v1, s[4:7], s16 offen offset:2048 sc1 lds
 buffer_load_dwordx4 v1, s[4:7], s16 offen offset:3072 sc1 lds
 s_mov_b32 m0, 22528
 s_nop 0
 buffer_load_dwordx4 v12, s[4:7], s16 offen offset:0 sc1 lds
 buffer_load_dwordx4 v12, s[4:7], s16 offen offset:1024 sc1 lds
 buffer_load_dwordx4 v12, s[4:7], s16 offen offset:2048 sc1 lds
 buffer_load_dwordx4 v12, s[4:7], s16 offen offset:3072 sc1 lds
 s_nop 15
 s_nop 15
 s_branch L_rj_217
L_id_239:
 s_barrier
 s_nop 15
 s_nop 15
 s_nop 15
 s_nop 15
 s_nop 15
 s_nop 15
 s_nop 15
 s_branch L_rj_217
L_rt_221:
 s_nop 7
 buffer_load_dwordx4 v[40:43], v2, s[4:7], s58 offen offset:0 sc1
 buffer_load_dwordx4 v[44:47], v2, s[4:7], s58 offen offset:128 sc1
 buffer_load_dwordx4 v[48:51], v2, s[4:7], s58 offen offset:1024 sc1
 buffer_load_dwordx4 v[52:55], v2, s[4:7], s58 offen offset:1152 sc1
 buffer_load_dwordx4 v[56:59], v3, s[4:7], s58 offen offset:0 sc1
 s_add_u32 s51, s51, 1
 s_cmp_lt_u32 s51, 131072
 s_cbranch_scc1 L_xm_220
 s_branch L_bail
L_rt_223:
 buffer_load_dwordx2 v[124:125], v1, s[4:7], s66 offen sc1
 s_waitcnt vmcnt(0)
 s_add_u32 s51, s51, 1
 s_cmp_lt_u32 s51, 131072
 s_cbranch_scc1 L_pv_222
 s_branch L_bail
L_rt_227:
 s_add_u32 s51, s51, 1
 s_cmp_lt_u32 s51, 131072
 s_cbranch_scc1 L_pp_226
 s_branch L_bail
L_nr_224:
 s_cmp_lg_u32 s50, 0
 s_cbranch_scc1 L_id_242
 buffer_store_dwordx4 v[32:35], v1, s[4:7], s60 offen offset:0
 buffer_store_dwordx4 v[32:35], v1, s[4:7], s60 offen offset:1024
 buffer_store_dwordx4 v[32:35], v1, s[4:7], s60 offen offset:2048
 buffer_store_dwordx4 v[32:35], v1, s[4:7], s60 offen offset:3072
 buffer_load_dword v14, off, s[4:7], s32 sc1
 s_waitcnt vmcnt(0)
 s_barrier
 s_add_u32 s76, s53, 1
L_fl_243:
 v_cmp_ge_u32 vcc, s76, v14
 s_cbranch_vccz L_fld_244
 buffer_load_dword v14, off, s[4:7], s32 sc1
 s_waitcnt vmcnt(0)
 s_add_u32 s51, s51, 1
 s_cmp_lt_u32 s51, 131072
 s_cbranch_scc1 L_fl_243
 s_branch L_bail
L_fld_244:
 s_lshl_b32 s16, s76, 19
 s_add_u32 s16, s16, s54
 s_mov_b32 m0, 10240
 s_nop 0
 buffer_load_dwordx4 v1, s[4:7], s16 offen offset:0 sc1 lds
 buffer_load_dwordx4 v1, s[4:7], s16 offen offset:1024 sc1 lds
 buffer_load_dwordx4 v1, s[4:7], s16 offen offset:2048 sc1 lds
 buffer_load_dwordx4 v1, s[4:7], s16 offen offset:3072 sc1 lds
 s_mov_b32 m0, 14336
 s_nop 0
 buffer_load_dwordx4 v12, s[4:7], s16 offen offset:0 sc1 lds
 buffer_load_dwordx4 v12, s[4:7], s16 offen offset:1024 sc1 lds
 buffer_load_dwordx4 v12, s[4:7], s16 offen offset:2048 sc1 lds
 buffer_load_dwordx4 v12, s[4:7], s16 offen offset:3072 sc1 lds
 s_add_u32 s16, s16, 67108864
 s_mov_b32 m0, 18432
 s_nop 0
 buffer_load_dwordx4 v1, s[4:7], s16 offen offset:0 sc1 lds
 buffer_load_dwordx4 v1, s[4:7], s16 offen offset:1024 sc1 lds
 buffer_load_dwordx4 v1, s[4:7], s16 offen offset:2048 sc1 lds
 buffer_load_dwordx4 v1, s[4:7], s16 offen offset:3072 sc1 lds
 s_mov_b32 m0, 22528
 s_nop 0
 buffer_load_dwordx4 v12, s[4:7], s16 offen offset:0 sc1 lds
 buffer_load_dwordx4 v12, s[4:7], s16 offen offset:1024 sc1 lds
 buffer_load_dwordx4 v12, s[4:7], s16 offen offset:2048 sc1 lds
 buffer_load_dwordx4 v12, s[4:7], s16 offen offset:3072 sc1 lds
 s_nop 15
 s_nop 15
 s_branch L_rj_225
L_id_242:
 s_barrier
 s_nop 15
 s_nop 15
 s_nop 15
 s_nop 15
 s_nop 15
 s_nop 15
 s_nop 15
 s_branch L_rj_225
L_rt_229:
 s_nop 7
 buffer_load_dwordx4 v[40:43], v2, s[4:7], s59 offen offset:0 sc1
 buffer_load_dwordx4 v[44:47], v2, s[4:7], s59 offen offset:128 sc1
 buffer_load_dwordx4 v[48:51], v2, s[4:7], s59 offen offset:1024 sc1
 buffer_load_dwordx4 v[52:55], v2, s[4:7], s59 offen offset:1152 sc1
 buffer_load_dwordx4 v[56:59], v3, s[4:7], s59 offen offset:0 sc1
 s_add_u32 s51, s51, 1
 s_cmp_lt_u32 s51, 131072
 s_cbranch_scc1 L_xm_228
 s_branch L_bail
L_rt_231:
 buffer_load_dwordx2 v[124:125], v1, s[4:7], s67 offen sc1
 s_waitcnt vmcnt(0)
 s_add_u32 s51, s51, 1
 s_cmp_lt_u32 s51, 131072
 s_cbranch_scc1 L_pv_230
 s_branch L_bail
L_rt_235:
 s_add_u32 s51, s51, 1
 s_cmp_lt_u32 s51, 131072
 s_cbranch_scc1 L_pp_234
 s_branch L_bail
L_nr_232:
 s_cmp_lg_u32 s50, 0
 s_cbranch_scc1 L_id_245
 buffer_store_dwordx4 v[32:35], v1, s[4:7], s61 offen offset:0
 buffer_store_dwordx4 v[32:35], v1, s[4:7], s61 offen offset:1024
 buffer_store_dwordx4 v[32:35], v1, s[4:7], s61 offen offset:2048
 buffer_store_dwordx4 v[32:35], v1, s[4:7], s61 offen offset:3072
 buffer_load_dword v14, off, s[4:7], s32 sc1
 s_waitcnt vmcnt(0)
 s_barrier
 s_add_u32 s76, s53, 1
L_fl_246:
 v_cmp_ge_u32 vcc, s76, v14
 s_cbranch_vccz L_fld_247
 buffer_load_dword v14, off, s[4:7], s32 sc1
 s_waitcnt vmcnt(0)
 s_add_u32 s51, s51, 1
 s_cmp_lt_u32 s51, 131072
 s_cbranch_scc1 L_fl_246
 s_branch L_bail
L_fld_247:
 s_lshl_b32 s16, s76, 19
 s_add_u32 s16, s16, s54
 s_mov_b32 m0, 10240
 s_nop 0
 buffer_load_dwordx4 v1, s[4:7], s16 offen offset:0 sc1 lds
 buffer_load_dwordx4 v1, s[4:7], s16 offen offset:1024 sc1 lds
 buffer_load_dwordx4 v1, s[4:7], s16 offen offset:2048 sc1 lds
 buffer_load_dwordx4 v1, s[4:7], s16 offen offset:3072 sc1 lds
 s_mov_b32 m0, 14336
 s_nop 0
 buffer_load_dwordx4 v12, s[4:7], s16 offen offset:0 sc1 lds
 buffer_load_dwordx4 v12, s[4:7], s16 offen offset:1024 sc1 lds
 buffer_load_dwordx4 v12, s[4:7], s16 offen offset:2048 sc1 lds
 buffer_load_dwordx4 v12, s[4:7], s16 offen offset:3072 sc1 lds
 s_add_u32 s16, s16, 67108864
 s_mov_b32 m0, 18432
 s_nop 0
 buffer_load_dwordx4 v1, s[4:7], s16 offen offset:0 sc1 lds
 buffer_load_dwordx4 v1, s[4:7], s16 offen offset:1024 sc1 lds
 buffer_load_dwordx4 v1, s[4:7], s16 offen offset:2048 sc1 lds
 buffer_load_dwordx4 v1, s[4:7], s16 offen offset:3072 sc1 lds
 s_mov_b32 m0, 22528
 s_nop 0
 buffer_load_dwordx4 v12, s[4:7], s16 offen offset:0 sc1 lds
 buffer_load_dwordx4 v12, s[4:7], s16 offen offset:1024 sc1 lds
 buffer_load_dwordx4 v12, s[4:7], s16 offen offset:2048 sc1 lds
 buffer_load_dwordx4 v12, s[4:7], s16 offen offset:3072 sc1 lds
 s_nop 15
 s_nop 15
 s_branch L_rj_233
L_id_245:
 s_barrier
 s_nop 15
 s_nop 15
 s_nop 15
 s_nop 15
 s_nop 15
 s_nop 15
 s_nop 15
 s_branch L_rj_233
.p2align 8
L_ch_loops:
 s_mov_b32 s51, 0
 buffer_load_dwordx4 v[40:43], v2, s[4:7], s56 offen offset:0 sc1
 buffer_load_dwordx4 v[44:47], v2, s[4:7], s56 offen offset:128 sc1
 buffer_load_dwordx4 v[48:51], v2, s[4:7], s56 offen offset:1024 sc1
 buffer_load_dwordx4 v[52:55], v2, s[4:7], s56 offen offset:1152 sc1
 buffer_load_dwordx4 v[56:59], v3, s[4:7], s56 offen offset:0 sc1
L_xm_248:
 s_waitcnt vmcnt(4)
 v_mfma_f32_16x16x32_bf16 v[60:63], v[24:27], v[40:43], 0
 s_waitcnt vmcnt(3)
 v_mfma_f32_16x16x32_bf16 v[64:67], v[24:27], v[44:47], 0
 s_waitcnt vmcnt(2)
 v_mfma_f32_16x16x32_bf16 v[68:71], v[24:27], v[48:51], 0
 v_max3_u32 v14, v40, v44, v48
 v_cvt_pk_bf16_f32 v60, v60, v61
 v_cvt_pk_bf16_f32 v61, v62, v63
 ds_write_b64 v4, v[60:61] offset:0
 s_waitcnt vmcnt(1)
 v_mfma_f32_16x16x32_bf16 v[72:75], v[24:27], v[52:55], 0
 v_cvt_pk_bf16_f32 v64, v64, v65
 v_cvt_pk_bf16_f32 v65, v66, v67
 ds_write_b64 v4, v[64:65] offset:8
 s_waitcnt vmcnt(0)
 v_mfma_f32_16x16x32_bf16 v[76:79], v[24:27], v[56:59], 0
 v_max3_u32 v14, v14, v52, v56
 v_cmp_eq_u32 vcc, -1, v14
 v_cvt_pk_bf16_f32 v68, v68, v69
 v_cvt_pk_bf16_f32 v69, v70, v71
 ds_write_b64 v4, v[68:69] offset:1024
 s_cbranch_vccnz L_rt_249
 v_cvt_pk_bf16_f32 v72, v72, v73
 v_cvt_pk_bf16_f32 v73, v74, v75
 ds_write_b64 v4, v[72:73] offset:1032
 s_nop 0
 v_cvt_pk_bf16_f32 v76, v76, v77
 v_cvt_pk_bf16_f32 v77, v78, v79
 ds_write_b64 v5, v[76:77] offset:0
 s_waitcnt lgkmcnt(0)
 s_barrier
L_ch_b1s0:
 ds_read_b128 v[72:75], v0 offset:0
 ds_read_b128 v[76:79], v0 offset:32
 ds_read_b128 v[80:83], v0 offset:1024
 s_waitcnt lgkmcnt(2)
 v_smfmac_f32_16x16x64_bf16 v[88:91], v[72:75], v[224:231], v17
 ds_read_b128 v[84:87], v0 offset:1056
 v_smfmac_f32_16x16x64_bf16 v[92:95], v[72:75], v[232:239], v17
 ds_read_b128 v[96:99], v0 offset:2048
 s_waitcnt lgkmcnt(3)
 v_smfmac_f32_16x16x64_bf16 v[88:91], v[76:79], v[240:247], v17
 ds_read_b128 v[100:103], v0 offset:2080
 v_smfmac_f32_16x16x64_bf16 v[92:95], v[76:79], v[248:255], v17
 ds_read_b128 v[112:115], v0 offset:3072
 s_waitcnt lgkmcnt(4)
 v_smfmac_f32_16x16x64_bf16 v[88:91], v[80:83], v[192:199], v17
 ds_read_b128 v[40:43], v1 offset:10240
 v_smfmac_f32_16x16x64_bf16 v[92:95], v[80:83], v[200:207], v17
 ds_read_b128 v[116:119], v0 offset:3104
 s_waitcnt lgkmcnt(5)
 v_smfmac_f32_16x16x64_bf16 v[88:91], v[84:87], v[208:215], v17
 ds_read_b128 v[44:47], v1 offset:11264
 v_smfmac_f32_16x16x64_bf16 v[92:95], v[84:87], v[216:223], v17
 ds_read_b128 v[72:75], v0 offset:4096
 s_waitcnt lgkmcnt(6)
 v_smfmac_f32_16x16x64_bf16 v[88:91], v[96:99], a[0:7], v17
 ds_read_b128 v[48:51], v1 offset:12288
 v_smfmac_f32_16x16x64_bf16 v[92:95], v[96:99], a[8:15], v17
 ds_read_b128 v[76:79], v0 offset:4128
 s_waitcnt lgkmcnt(7)
 v_smfmac_f32_16x16x64_bf16 v[88:91], v[100:103], a[16:23], v17
 ds_read_b128 v[52:55], v1 offset:13312
 v_smfmac_f32_16x16x64_bf16 v[92:95], v[100:103], a[24:31], v17
 ds_read_b128 v[80:83], v0 offset:5120
 s_waitcnt lgkmcnt(8)
 v_smfmac_f32_16x16x64_bf16 v[88:91], v[112:115], a[32:39], v17
 ds_read_b128 v[56:59], v1 offset:14336
 v_smfmac_f32_16x16x64_bf16 v[92:95], v[112:115], a[40:47], v17
 ds_read_b128 v[84:87], v0 offset:5152
 s_waitcnt lgkmcnt(8)
 v_smfmac_f32_16x16x64_bf16 v[88:91], v[116:119], a[48:55], v17
 ds_read_b128 v[60:63], v1 offset:15360
 v_smfmac_f32_16x16x64_bf16 v[92:95], v[116:119], a[56:63], v17
 ds_read_b128 v[96:99], v0 offset:6144
 s_waitcnt lgkmcnt(8)
 v_smfmac_f32_16x16x64_bf16 v[88:91], v[72:75], a[64:71], v17
 ds_read_b128 v[64:67], v1 offset:16384
 v_smfmac_f32_16x16x64_bf16 v[92:95], v[72:75], a[72:79], v17
 ds_read_b128 v[100:103], v0 offset:6176
 s_waitcnt lgkmcnt(8)
 v_smfmac_f32_16x16x64_bf16 v[88:91], v[76:79], a[80:87], v17
 ds_read_b128 v[68:71], v1 offset:17408
 v_smfmac_f32_16x16x64_bf16 v[92:95], v[76:79], a[88:95], v17
 ds_read_b128 v[112:115], v0 offset:7168
 s_waitcnt lgkmcnt(8)
 v_smfmac_f32_16x16x64_bf16 v[88:91], v[80:83], a[96:103], v17
 ds_read_b128 v[104:107], v16 offset:18432
 v_smfmac_f32_16x16x64_bf16 v[92:95], v[80:83], a[104:111], v17
 ds_read_b128 v[116:119], v0 offset:7200
 s_waitcnt lgkmcnt(8)
 v_smfmac_f32_16x16x64_bf16 v[88:91], v[84:87], a[112:119], v17
 ds_read_b128 v[108:111], v16 offset:19456
 v_smfmac_f32_16x16x64_bf16 v[92:95], v[84:87], a[120:127], v17
 ds_read_b128 v[72:75], v0 offset:8192
 s_waitcnt lgkmcnt(8)
 v_smfmac_f32_16x16x64_bf16 v[88:91], v[96:99], a[128:135], v17
 ds_read_b128 v[224:227], v15 offset:8192
 v_smfmac_f32_16x16x64_bf16 v[92:95], v[96:99], a[136:143], v17
 ds_read_b128 v[76:79], v0 offset:8224
 s_waitcnt lgkmcnt(8)
 v_smfmac_f32_16x16x64_bf16 v[88:91], v[100:103], a[144:151], v17
 ds_read_b128 v[228:231], v15 offset:9216
 v_smfmac_f32_16x16x64_bf16 v[92:95], v[100:103], a[152:159], v17
 ds_read_b128 v[80:83], v0 offset:9216
 s_waitcnt lgkmcnt(8)
 v_smfmac_f32_16x16x64_bf16 v[88:91], v[112:115], a[160:167], v17
 ds_read_b128 v[232:235], v15 offset:10240
 v_smfmac_f32_16x16x64_bf16 v[92:95], v[112:115], a[168:175], v17
 ds_read_b128 v[84:87], v0 offset:9248
 s_waitcnt lgkmcnt(8)
 v_smfmac_f32_16x16x64_bf16 v[88:91], v[116:119], a[176:183], v17
 ds_read_b128 v[236:239], v15 offset:11264
 v_smfmac_f32_16x16x64_bf16 v[92:95], v[116:119], a[184:191], v17
 ds_read_b128 v[240:243], v15 offset:12288
 s_waitcnt lgkmcnt(8)
 v_smfmac_f32_16x16x64_bf16 v[88:91], v[72:75], a[192:199], v17
 ds_read_b128 v[244:247], v15 offset:13312
 v_smfmac_f32_16x16x64_bf16 v[92:95], v[72:75], a[200:207], v17
 ds_read_b128 v[248:251], v15 offset:14336
 s_waitcnt lgkmcnt(8)
 v_smfmac_f32_16x16x64_bf16 v[88:91], v[76:79], a[208:215], v17
 ds_read_b128 v[252:255], v15 offset:15360
 v_smfmac_f32_16x16x64_bf16 v[92:95], v[76:79], a[216:223], v17
 s_waitcnt lgkmcnt(7)
 v_smfmac_f32_16x16x64_bf16 v[88:91], v[80:83], a[224:231], v17
 v_smfmac_f32_16x16x64_bf16 v[92:95], v[80:83], a[232:239], v17
 s_waitcnt lgkmcnt(5)
 v_smfmac_f32_16x16x64_bf16 v[88:91], v[84:87], a[240:247], v17
 v_smfmac_f32_16x16x64_bf16 v[92:95], v[84:87], a[248:255], v17
 s_nop 2
 v_cvt_pk_bf16_f32 v120, v88, v89
 v_cvt_pk_bf16_f32 v121, v90, v91
 ds_write_b64 v6, v[120:121] offset:26624
 s_nop 1
 v_cvt_pk_bf16_f32 v122, v92, v93
 v_cvt_pk_bf16_f32 v123, v94, v95
 ds_write_b64 v6, v[122:123] offset:27136
 s_waitcnt lgkmcnt(0)
 s_barrier
 ds_read_b64_tr_b16 v[72:73], v7 offset:26624
 ds_read_b64_tr_b16 v[74:75], v7 offset:27136
 ds_read_b64_tr_b16 v[76:77], v7 offset:27648
 ds_read_b64_tr_b16 v[78:79], v7 offset:28160
 ds_read_b64_tr_b16 v[80:81], v7 offset:28672
 ds_read_b64_tr_b16 v[82:83], v7 offset:29184
 ds_read_b64_tr_b16 v[84:85], v7 offset:29696
 ds_read_b64_tr_b16 v[86:87], v7 offset:30208
 ds_read_b64_tr_b16 v[112:113], v8 offset:26624
 ds_read_b64_tr_b16 v[114:115], v8 offset:27136
 s_waitcnt lgkmcnt(8)
 v_mfma_f32_16x16x32_bf16 v[92:95], v[40:43], v[72:75], 0
 v_mfma_f32_16x16x32_bf16 v[96:99], v[56:59], v[72:75], 0
 v_mfma_f32_16x16x32_bf16 v[88:91], v[72:75], v[72:75], 0
 s_waitcnt lgkmcnt(6)
 v_mfma_f32_16x16x32_bf16 v[92:95], v[44:47], v[76:79], v[92:95]
 v_mfma_f32_16x16x32_bf16 v[96:99], v[60:63], v[76:79], v[96:99]
 v_mfma_f32_16x16x32_bf16 v[88:91], v[76:79], v[76:79], v[88:91]
 s_waitcnt lgkmcnt(4)
 v_mfma_f32_16x16x32_bf16 v[92:95], v[48:51], v[80:83], v[92:95]
 buffer_load_dwordx2 v[124:125], v1, s[4:7], s64 offen sc1
 v_mfma_f32_16x16x32_bf16 v[96:99], v[64:67], v[80:83], v[96:99]
 v_mfma_f32_16x16x32_bf16 v[88:91], v[80:83], v[80:83], v[88:91]
 s_waitcnt lgkmcnt(0)
 buffer_store_dwordx4 v[112:115], v1, s[4:7], s60 offen sc1
 s_waitcnt lgkmcnt(2)
 v_mfma_f32_16x16x32_bf16 v[92:95], v[52:55], v[84:87], v[92:95]
 v_mfma_f32_16x16x32_bf16 v[96:99], v[68:71], v[84:87], v[96:99]
 v_mfma_f32_16x16x32_bf16 v[88:91], v[84:87], v[84:87], v[88:91]
 v_mfma_f32_32x32x8_bf16 v[40:55], v[18:19], v[18:19], 0
 v_max3_f32 v126, v92, v93, v94
 ds_read_b128 v[80:83], v15 offset:16384
 ds_read_b128 v[84:87], v15 offset:17408
 v_max3_f32 v126, v126, v95, v96
 v_max3_f32 v126, v126, v97, v98
 v_max3_f32 v126, v126, v99, v90
 v_max_f32 v126, v126, v91
 v_mov_b32 v127, v126
 v_mov_b64 v[56:57], 0
 v_mov_b64 v[58:59], 0
 v_permlane16_swap_b32 v126, v127
 v_max_f32 v126, v126, v127
 v_mov_b32 v127, v126
 s_nop 1
 v_permlane32_swap_b32 v126, v127
 v_max_f32 v126, v126, v127
 v_mul_f32 v126, s79, v126
 v_fma_f32 v92, v92, s79, -v126
 v_fma_f32 v93, v93, s79, -v126
 v_fma_f32 v94, v94, s79, -v126
 v_fma_f32 v95, v95, s79, -v126
 v_fma_f32 v96, v96, s79, -v126
 v_fma_f32 v97, v97, s79, -v126
 v_fma_f32 v98, v98, s79, -v126
 v_fma_f32 v99, v99, s79, -v126
 v_exp_f32 v92, v92
 v_exp_f32 v93, v93
 v_exp_f32 v94, v94
 v_exp_f32 v95, v95
 v_exp_f32 v96, v96
 v_exp_f32 v97, v97
 v_exp_f32 v98, v98
 v_exp_f32 v99, v99
 v_fma_f32 v90, v90, s79, -v126
 v_cvt_pk_bf16_f32 v100, v92, v93
 v_cvt_pk_bf16_f32 v101, v94, v95
 v_cvt_pk_bf16_f32 v102, v96, v97
 v_cvt_pk_bf16_f32 v103, v98, v99
 v_fma_f32 v91, v91, s79, -v126
 v_exp_f32 v90, v90
 v_mfma_f32_16x16x32_bf16 v[120:123], v[28:31], v[100:103], 0
 v_exp_f32 v91, v91
 v_mfma_f32_16x16x32_bf16 v[112:115], v[104:107], v[100:103], 0
 v_cvt_pk_bf16_f32 v36, v90, v91
 v_cvt_pk_bf16_f32 v39, v90, v91
 v_mfma_f32_16x16x32_bf16 v[116:119], v[108:111], v[100:103], 0
 s_waitcnt vmcnt(0)
 v_mfma_f32_16x16x16_bf16 v[120:123], v[28:29], v[36:37], v[120:123]
L_pv_250:
 v_cmp_eq_u32 vcc, -1, v124
 s_cbranch_vccnz L_rt_251
 v_mfma_f32_16x16x16_bf16 v[112:115], v[124:125], v[36:37], v[112:115]
 v_mfma_f32_16x16x16_bf16 v[116:119], v[124:125], v[38:39], v[116:119]
 v_rcp_f32 v120, v120
 ds_read_b128 v[88:91], v15 offset:18432
 ds_read_b128 v[92:95], v15 offset:19456
 ds_read_b128 v[96:99], v15 offset:20480
 ds_read_b128 v[100:103], v15 offset:21504
 s_mov_b64 exec, s[28:29]
 v_pk_mul_f32 v[112:113], v[112:113], v[120:121] op_sel_hi:[1,0]
 v_pk_mul_f32 v[114:115], v[114:115], v[120:121] op_sel_hi:[1,0]
 v_cvt_pk_bf16_f32 v112, v112, v113
 v_cvt_pk_bf16_f32 v113, v114, v115
 v_pk_mul_f32 v[116:117], v[116:117], v[120:121] op_sel_hi:[1,0]
 v_pk_mul_f32 v[118:119], v[118:119], v[120:121] op_sel_hi:[1,0]
 v_cvt_pk_bf16_f32 v114, v116, v117
 v_cvt_pk_bf16_f32 v115, v118, v119
 ds_write_b128 v9, v[112:115] offset:30720
 s_mov_b64 exec, -1
 s_waitcnt lgkmcnt(0)
 s_barrier
 ds_read_b128 v[60:63], v0 offset:30720
 ds_read_b128 v[64:67], v0 offset:30752
 ds_read_b128 v[68:71], v0 offset:31744
 ds_read_b128 v[72:75], v0 offset:31776
 s_waitcnt lgkmcnt(3)
 v_smfmac_f32_16x16x64_bf16 v[40:43], v[60:63], v[224:231], v17
 ds_read_b128 v[224:227], v15 offset:22528
 v_smfmac_f32_16x16x64_bf16 v[44:47], v[60:63], v[232:239], v17
 ds_read_b128 v[228:231], v15 offset:23552
 s_waitcnt lgkmcnt(4)
 v_smfmac_f32_16x16x64_bf16 v[40:43], v[64:67], v[240:247], v17
 ds_read_b128 v[232:235], v15 offset:24576
 v_smfmac_f32_16x16x64_bf16 v[44:47], v[64:67], v[248:255], v17
 ds_read_b128 v[236:239], v15 offset:25600
 s_waitcnt lgkmcnt(5)
 v_smfmac_f32_16x16x64_bf16 v[40:43], v[68:71], v[80:87], v17
 ds_read_b128 v[240:243], v15 offset:26624
 v_smfmac_f32_16x16x64_bf16 v[44:47], v[68:71], v[128:135], v17
 ds_read_b128 v[244:247], v15 offset:27648
 s_waitcnt lgkmcnt(6)
 v_smfmac_f32_16x16x64_bf16 v[40:43], v[72:75], v[136:143], v17
 ds_read_b128 v[248:251], v15 offset:28672
 v_smfmac_f32_16x16x64_bf16 v[44:47], v[72:75], v[144:151], v17
 ds_read_b128 v[252:255], v15 offset:29696
 v_smfmac_f32_16x16x64_bf16 v[48:51], v[60:63], v[152:159], v17
 ds_read_b128 v[80:83], v15 offset:30720
 v_cvt_pk_bf16_f32 v116, v40, v41
 v_cvt_pk_bf16_f32 v117, v42, v43
 v_or_b32 v116, 1, v116
 v_smfmac_f32_16x16x64_bf16 v[52:55], v[60:63], v[160:167], v17
 ds_read_b128 v[84:87], v15 offset:31744
 v_cvt_pk_bf16_f32 v118, v44, v45
 v_cvt_pk_bf16_f32 v119, v46, v47
 v_or_b32 v118, 1, v118
 buffer_store_dwordx4 v[116:119], v10, s[4:7], s68 offen sc1
 v_smfmac_f32_16x16x64_bf16 v[48:51], v[64:67], v[168:175], v17
 v_smfmac_f32_16x16x64_bf16 v[52:55], v[64:67], v[176:183], v17
 v_smfmac_f32_16x16x64_bf16 v[48:51], v[68:71], v[184:191], v17
 v_smfmac_f32_16x16x64_bf16 v[52:55], v[68:71], v[88:95], v17
 v_smfmac_f32_16x16x64_bf16 v[48:51], v[72:75], v[96:103], v17
 s_waitcnt lgkmcnt(8)
 v_smfmac_f32_16x16x64_bf16 v[52:55], v[72:75], v[224:231], v17
 s_waitcnt lgkmcnt(6)
 v_smfmac_f32_16x16x64_bf16 v[56:59], v[60:63], v[232:239], v17
 v_cvt_pk_bf16_f32 v120, v48, v49
 v_cvt_pk_bf16_f32 v121, v50, v51
 v_or_b32 v120, 1, v120
 s_waitcnt lgkmcnt(4)
 v_smfmac_f32_16x16x64_bf16 v[56:59], v[64:67], v[240:247], v17
 v_cvt_pk_bf16_f32 v122, v52, v53
 v_cvt_pk_bf16_f32 v123, v54, v55
 v_or_b32 v122, 1, v122
 buffer_store_dwordx4 v[120:123], v10, s[4:7], s69 offen sc1
 s_waitcnt lgkmcnt(2)
 v_smfmac_f32_16x16x64_bf16 v[56:59], v[68:71], v[248:255], v17
 s_waitcnt lgkmcnt(0)
 v_smfmac_f32_16x16x64_bf16 v[56:59], v[72:75], v[80:87], v17
 s_nop 7
 v_cvt_pk_bf16_f32 v124, v56, v57
 v_cvt_pk_bf16_f32 v125, v58, v59
 v_or_b32 v124, 1, v124
 buffer_store_dwordx2 v[124:125], v10, s[4:7], s70 offen sc1
 ds_read_b128 v[224:227], v15 offset:0
 ds_read_b128 v[228:231], v15 offset:1024
 ds_read_b128 v[232:235], v15 offset:2048
 ds_read_b128 v[236:239], v15 offset:3072
 ds_read_b128 v[240:243], v15 offset:4096
 ds_read_b128 v[244:247], v15 offset:5120
 ds_read_b128 v[248:251], v15 offset:6144
 ds_read_b128 v[252:255], v15 offset:7168
 v_mov_b64 v[88:89], 0
 v_mov_b64 v[90:91], 0
 v_mov_b64 v[92:93], 0
 v_mov_b64 v[94:95], 0
 s_cmp_eq_u32 s55, 0
 s_cbranch_scc1 L_nr_252
 s_nop 15
 s_nop 15
 s_nop 15
 s_nop 15
 s_nop 15
L_pp_254:
 buffer_load_dwordx4 v[40:43], v1, s[4:7], s74 offen offset:0 sc1
 buffer_load_dwordx4 v[44:47], v1, s[4:7], s74 offen offset:1024 sc1
 buffer_load_dwordx4 v[48:51], v1, s[4:7], s74 offen offset:2048 sc1
 buffer_load_dwordx4 v[52:55], v1, s[4:7], s74 offen offset:3072 sc1
 s_waitcnt vmcnt(3)
 v_mfma_f32_16x16x32_bf16 v[56:59], v[40:43], v[20:23], 0
 v_and_b32 v14, v40, v42
 s_waitcnt vmcnt(2)
 v_mfma_f32_16x16x32_bf16 v[56:59], v[44:47], v[20:23], v[56:59]
 v_bitop3_b32 v14, v14, v44, v46 bitop3:0x80
 s_waitcnt vmcnt(1)
 v_mfma_f32_16x16x32_bf16 v[56:59], v[48:51], v[20:23], v[56:59]
 v_bitop3_b32 v14, v14, v48, v50 bitop3:0x80
 s_waitcnt vmcnt(0)
 v_mfma_f32_16x16x32_bf16 v[56:59], v[52:55], v[20:23], v[56:59]
 v_bitop3_b32 v14, v14, v52, v54 bitop3:0x80
 v_and_b32 v14, 1, v14
 v_cmp_ne_u32 vcc, 1, v14
 s_cbranch_vccnz L_rt_255
 s_nop 2
 v_cvt_pk_bf16_f32 v60, v56, v57
 v_cvt_pk_bf16_f32 v61, v58, v59
 s_nop 0
 v_mov_b32_dpp v62, v60 quad_perm:[2,3,2,3] row_mask:0xf bank_mask:0xf
 v_mov_b32_dpp v63, v61 quad_perm:[2,3,2,3] row_mask:0xf bank_mask:0xf
 s_mov_b64 exec, s[30:31]
 buffer_store_dwordx4 v[60:63], v11, s[4:7], s57 offen sc1
 s_mov_b64 exec, 1
 buffer_store_dword v13, off, s[4:7], s17 sc1
 s_mov_b64 exec, s[30:31]
 buffer_store_dwordx4 v[32:35], v11, s[4:7], s59 offen sc1
 s_mov_b64 exec, -1
 s_barrier
 s_nop 15
 s_nop 15
 s_nop 15
 s_nop 15
 s_nop 15
 s_nop 15
 s_nop 15
L_rj_253:
 v_add_u32 v13, 1, v13
 s_add_u32 s53, s53, 1
.p2align 3
 s_mov_b32 s51, 0
 buffer_load_dwordx4 v[40:43], v2, s[4:7], s57 offen offset:0 sc1
 buffer_load_dwordx4 v[44:47], v2, s[4:7], s57 offen offset:128 sc1
 buffer_load_dwordx4 v[48:51], v2, s[4:7], s57 offen offset:1024 sc1
 buffer_load_dwordx4 v[52:55], v2, s[4:7], s57 offen offset:1152 sc1
 buffer_load_dwordx4 v[56:59], v3, s[4:7], s57 offen offset:0 sc1
L_xm_256:
 s_waitcnt vmcnt(4)
 v_mfma_f32_16x16x32_bf16 v[60:63], v[24:27], v[40:43], 0
 s_waitcnt vmcnt(3)
 v_mfma_f32_16x16x32_bf16 v[64:67], v[24:27], v[44:47], 0
 s_waitcnt vmcnt(2)
 v_mfma_f32_16x16x32_bf16 v[68:71], v[24:27], v[48:51], 0
 v_max3_u32 v14, v40, v44, v48
 v_cvt_pk_bf16_f32 v60, v60, v61
 v_cvt_pk_bf16_f32 v61, v62, v63
 ds_write_b64 v4, v[60:61] offset:0
 s_waitcnt vmcnt(1)
 v_mfma_f32_16x16x32_bf16 v[72:75], v[24:27], v[52:55], 0
 v_cvt_pk_bf16_f32 v64, v64, v65
 v_cvt_pk_bf16_f32 v65, v66, v67
 ds_write_b64 v4, v[64:65] offset:8
 s_waitcnt vmcnt(0)
 v_mfma_f32_16x16x32_bf16 v[76:79], v[24:27], v[56:59], 0
 v_max3_u32 v14, v14, v52, v56
 v_cmp_eq_u32 vcc, -1, v14
 v_cvt_pk_bf16_f32 v68, v68, v69
 v_cvt_pk_bf16_f32 v69, v70, v71
 ds_write_b64 v4, v[68:69] offset:1024
 s_cbranch_vccnz L_rt_257
 v_cvt_pk_bf16_f32 v72, v72, v73
 v_cvt_pk_bf16_f32 v73, v74, v75
 ds_write_b64 v4, v[72:73] offset:1032
 s_nop 0
 v_cvt_pk_bf16_f32 v76, v76, v77
 v_cvt_pk_bf16_f32 v77, v78, v79
 ds_write_b64 v5, v[76:77] offset:0
 s_waitcnt lgkmcnt(0)
 s_barrier
L_ch_b1s1:
 ds_read_b128 v[72:75], v0 offset:0
 ds_read_b128 v[76:79], v0 offset:32
 ds_read_b128 v[80:83], v0 offset:1024
 s_waitcnt lgkmcnt(2)
 v_smfmac_f32_16x16x64_bf16 v[88:91], v[72:75], v[224:231], v17
 ds_read_b128 v[84:87], v0 offset:1056
 v_smfmac_f32_16x16x64_bf16 v[92:95], v[72:75], v[232:239], v17
 ds_read_b128 v[96:99], v0 offset:2048
 s_waitcnt lgkmcnt(3)
 v_smfmac_f32_16x16x64_bf16 v[88:91], v[76:79], v[240:247], v17
 ds_read_b128 v[100:103], v0 offset:2080
 v_smfmac_f32_16x16x64_bf16 v[92:95], v[76:79], v[248:255], v17
 ds_read_b128 v[112:115], v0 offset:3072
 s_waitcnt lgkmcnt(4)
 v_smfmac_f32_16x16x64_bf16 v[88:91], v[80:83], v[192:199], v17
 ds_read_b128 v[40:43], v1 offset:10240
 v_smfmac_f32_16x16x64_bf16 v[92:95], v[80:83], v[200:207], v17
 ds_read_b128 v[116:119], v0 offset:3104
 s_waitcnt lgkmcnt(5)
 v_smfmac_f32_16x16x64_bf16 v[88:91], v[84:87], v[208:215], v17
 ds_read_b128 v[44:47], v1 offset:11264
 v_smfmac_f32_16x16x64_bf16 v[92:95], v[84:87], v[216:223], v17
 ds_read_b128 v[72:75], v0 offset:4096
 s_waitcnt lgkmcnt(6)
 v_smfmac_f32_16x16x64_bf16 v[88:91], v[96:99], a[0:7], v17
 ds_read_b128 v[48:51], v1 offset:12288
 v_smfmac_f32_16x16x64_bf16 v[92:95], v[96:99], a[8:15], v17
 ds_read_b128 v[76:79], v0 offset:4128
 s_waitcnt lgkmcnt(7)
 v_smfmac_f32_16x16x64_bf16 v[88:91], v[100:103], a[16:23], v17
 ds_read_b128 v[52:55], v1 offset:13312
 v_smfmac_f32_16x16x64_bf16 v[92:95], v[100:103], a[24:31], v17
 ds_read_b128 v[80:83], v0 offset:5120
 s_waitcnt lgkmcnt(8)
 v_smfmac_f32_16x16x64_bf16 v[88:91], v[112:115], a[32:39], v17
 ds_read_b128 v[56:59], v1 offset:14336
 v_smfmac_f32_16x16x64_bf16 v[92:95], v[112:115], a[40:47], v17
 ds_read_b128 v[84:87], v0 offset:5152
 s_waitcnt lgkmcnt(8)
 v_smfmac_f32_16x16x64_bf16 v[88:91], v[116:119], a[48:55], v17
 ds_read_b128 v[60:63], v1 offset:15360
 v_smfmac_f32_16x16x64_bf16 v[92:95], v[116:119], a[56:63], v17
 ds_read_b128 v[96:99], v0 offset:6144
 s_waitcnt lgkmcnt(8)
 v_smfmac_f32_16x16x64_bf16 v[88:91], v[72:75], a[64:71], v17
 ds_read_b128 v[64:67], v1 offset:16384
 v_smfmac_f32_16x16x64_bf16 v[92:95], v[72:75], a[72:79], v17
 ds_read_b128 v[100:103], v0 offset:6176
 s_waitcnt lgkmcnt(8)
 v_smfmac_f32_16x16x64_bf16 v[88:91], v[76:79], a[80:87], v17
 ds_read_b128 v[68:71], v1 offset:17408
 v_smfmac_f32_16x16x64_bf16 v[92:95], v[76:79], a[88:95], v17
 ds_read_b128 v[112:115], v0 offset:7168
 s_waitcnt lgkmcnt(8)
 v_smfmac_f32_16x16x64_bf16 v[88:91], v[80:83], a[96:103], v17
 ds_read_b128 v[104:107], v16 offset:18432
 v_smfmac_f32_16x16x64_bf16 v[92:95], v[80:83], a[104:111], v17
 ds_read_b128 v[116:119], v0 offset:7200
 s_waitcnt lgkmcnt(8)
 v_smfmac_f32_16x16x64_bf16 v[88:91], v[84:87], a[112:119], v17
 ds_read_b128 v[108:111], v16 offset:19456
 v_smfmac_f32_16x16x64_bf16 v[92:95], v[84:87], a[120:127], v17
 ds_read_b128 v[72:75], v0 offset:8192
 s_waitcnt lgkmcnt(8)
 v_smfmac_f32_16x16x64_bf16 v[88:91], v[96:99], a[128:135], v17
 ds_read_b128 v[224:227], v15 offset:8192
 v_smfmac_f32_16x16x64_bf16 v[92:95], v[96:99], a[136:143], v17
 ds_read_b128 v[76:79], v0 offset:8224
 s_waitcnt lgkmcnt(8)
 v_smfmac_f32_16x16x64_bf16 v[88:91], v[100:103], a[144:151], v17
 ds_read_b128 v[228:231], v15 offset:9216
 v_smfmac_f32_16x16x64_bf16 v[92:95], v[100:103], a[152:159], v17
 ds_read_b128 v[80:83], v0 offset:9216
 s_waitcnt lgkmcnt(8)
 v_smfmac_f32_16x16x64_bf16 v[88:91], v[112:115], a[160:167], v17
 ds_read_b128 v[232:235], v15 offset:10240
 v_smfmac_f32_16x16x64_bf16 v[92:95], v[112:115], a[168:175], v17
 ds_read_b128 v[84:87], v0 offset:9248
 s_waitcnt lgkmcnt(8)
 v_smfmac_f32_16x16x64_bf16 v[88:91], v[116:119], a[176:183], v17
 ds_read_b128 v[236:239], v15 offset:11264
 v_smfmac_f32_16x16x64_bf16 v[92:95], v[116:119], a[184:191], v17
 ds_read_b128 v[240:243], v15 offset:12288
 s_waitcnt lgkmcnt(8)
 v_smfmac_f32_16x16x64_bf16 v[88:91], v[72:75], a[192:199], v17
 ds_read_b128 v[244:247], v15 offset:13312
 v_smfmac_f32_16x16x64_bf16 v[92:95], v[72:75], a[200:207], v17
 ds_read_b128 v[248:251], v15 offset:14336
 s_waitcnt lgkmcnt(8)
 v_smfmac_f32_16x16x64_bf16 v[88:91], v[76:79], a[208:215], v17
 ds_read_b128 v[252:255], v15 offset:15360
 v_smfmac_f32_16x16x64_bf16 v[92:95], v[76:79], a[216:223], v17
 s_waitcnt lgkmcnt(7)
 v_smfmac_f32_16x16x64_bf16 v[88:91], v[80:83], a[224:231], v17
 v_smfmac_f32_16x16x64_bf16 v[92:95], v[80:83], a[232:239], v17
 s_waitcnt lgkmcnt(5)
 v_smfmac_f32_16x16x64_bf16 v[88:91], v[84:87], a[240:247], v17
 v_smfmac_f32_16x16x64_bf16 v[92:95], v[84:87], a[248:255], v17
 s_nop 2
 v_cvt_pk_bf16_f32 v120, v88, v89
 v_cvt_pk_bf16_f32 v121, v90, v91
 ds_write_b64 v6, v[120:121] offset:26624
 s_nop 1
 v_cvt_pk_bf16_f32 v122, v92, v93
 v_cvt_pk_bf16_f32 v123, v94, v95
 ds_write_b64 v6, v[122:123] offset:27136
 s_waitcnt lgkmcnt(0)
 s_barrier
 ds_read_b64_tr_b16 v[72:73], v7 offset:26624
 ds_read_b64_tr_b16 v[74:75], v7 offset:27136
 ds_read_b64_tr_b16 v[76:77], v7 offset:27648
 ds_read_b64_tr_b16 v[78:79], v7 offset:28160
 ds_read_b64_tr_b16 v[80:81], v7 offset:28672
 ds_read_b64_tr_b16 v[82:83], v7 offset:29184
 ds_read_b64_tr_b16 v[84:85], v7 offset:29696
 ds_read_b64_tr_b16 v[86:87], v7 offset:30208
 ds_read_b64_tr_b16 v[112:113], v8 offset:26624
 ds_read_b64_tr_b16 v[114:115], v8 offset:27136
 s_waitcnt lgkmcnt(8)
 v_mfma_f32_16x16x32_bf16 v[92:95], v[40:43], v[72:75], 0
 v_mfma_f32_16x16x32_bf16 v[96:99], v[56:59], v[72:75], 0
 v_mfma_f32_16x16x32_bf16 v[88:91], v[72:75], v[72:75], 0
 s_waitcnt lgkmcnt(6)
 v_mfma_f32_16x16x32_bf16 v[92:95], v[44:47], v[76:79], v[92:95]
 v_mfma_f32_16x16x32_bf16 v[96:99], v[60:63], v[76:79], v[96:99]
 v_mfma_f32_16x16x32_bf16 v[88:91], v[76:79], v[76:79], v[88:91]
 s_waitcnt lgkmcnt(4)
 v_mfma_f32_16x16x32_bf16 v[92:95], v[48:51], v[80:83], v[92:95]
 buffer_load_dwordx2 v[124:125], v1, s[4:7], s65 offen sc1
 v_mfma_f32_16x16x32_bf16 v[96:99], v[64:67], v[80:83], v[96:99]
 v_mfma_f32_16x16x32_bf16 v[88:91], v[80:83], v[80:83], v[88:91]
 s_waitcnt lgkmcnt(0)
 buffer_store_dwordx4 v[112:115], v1, s[4:7], s61 offen sc1
 s_waitcnt lgkmcnt(2)
 v_mfma_f32_16x16x32_bf16 v[92:95], v[52:55], v[84:87], v[92:95]
 v_mfma_f32_16x16x32_bf16 v[96:99], v[68:71], v[84:87], v[96:99]
 v_mfma_f32_16x16x32_bf16 v[88:91], v[84:87], v[84:87], v[88:91]
 v_mfma_f32_32x32x8_bf16 v[40:55], v[18:19], v[18:19], 0
 v_max3_f32 v126, v92, v93, v94
 ds_read_b128 v[80:83], v15 offset:16384
 ds_read_b128 v[84:87], v15 offset:17408
 v_max3_f32 v126, v126, v95, v96
 v_max3_f32 v126, v126, v97, v98
 v_max3_f32 v126, v126, v99, v90
 v_max_f32 v126, v126, v91
 v_mov_b32 v127, v126
 v_mov_b64 v[56:57], 0
 v_mov_b64 v[58:59], 0
 v_permlane16_swap_b32 v126, v127
 v_max_f32 v126, v126, v127
 v_mov_b32 v127, v126
 s_nop 1
 v_permlane32_swap_b32 v126, v127
 v_max_f32 v126, v126, v127
 v_mul_f32 v126, s79, v126
 v_fma_f32 v92, v92, s79, -v126
 v_fma_f32 v93, v93, s79, -v126
 v_fma_f32 v94, v94, s79, -v126
 v_fma_f32 v95, v95, s79, -v126
 v_fma_f32 v96, v96, s79, -v126
 v_fma_f32 v97, v97, s79, -v126
 v_fma_f32 v98, v98, s79, -v126
 v_fma_f32 v99, v99, s79, -v126
 v_exp_f32 v92, v92
 v_exp_f32 v93, v93
 v_exp_f32 v94, v94
 v_exp_f32 v95, v95
 v_exp_f32 v96, v96
 v_exp_f32 v97, v97
 v_exp_f32 v98, v98
 v_exp_f32 v99, v99
 v_fma_f32 v90, v90, s79, -v126
 v_cvt_pk_bf16_f32 v100, v92, v93
 v_cvt_pk_bf16_f32 v101, v94, v95
 v_cvt_pk_bf16_f32 v102, v96, v97
 v_cvt_pk_bf16_f32 v103, v98, v99
 v_fma_f32 v91, v91, s79, -v126
 v_exp_f32 v90, v90
 v_mfma_f32_16x16x32_bf16 v[120:123], v[28:31], v[100:103], 0
 v_exp_f32 v91, v91
 v_mfma_f32_16x16x32_bf16 v[112:115], v[104:107], v[100:103], 0
 v_cvt_pk_bf16_f32 v36, v90, v91
 v_cvt_pk_bf16_f32 v39, v90, v91
 v_mfma_f32_16x16x32_bf16 v[116:119], v[108:111], v[100:103], 0
 s_waitcnt vmcnt(0)
 v_mfma_f32_16x16x16_bf16 v[120:123], v[28:29], v[36:37], v[120:123]
L_pv_258:
 v_cmp_eq_u32 vcc, -1, v124
 s_cbranch_vccnz L_rt_259
 v_mfma_f32_16x16x16_bf16 v[112:115], v[124:125], v[36:37], v[112:115]
 v_mfma_f32_16x16x16_bf16 v[116:119], v[124:125], v[38:39], v[116:119]
 v_rcp_f32 v120, v120
 ds_read_b128 v[88:91], v15 offset:18432
 ds_read_b128 v[92:95], v15 offset:19456
 ds_read_b128 v[96:99], v15 offset:20480
 ds_read_b128 v[100:103], v15 offset:21504
 s_mov_b64 exec, s[28:29]
 v_pk_mul_f32 v[112:113], v[112:113], v[120:121] op_sel_hi:[1,0]
 v_pk_mul_f32 v[114:115], v[114:115], v[120:121] op_sel_hi:[1,0]
 v_cvt_pk_bf16_f32 v112, v112, v113
 v_cvt_pk_bf16_f32 v113, v114, v115
 v_pk_mul_f32 v[116:117], v[116:117], v[120:121] op_sel_hi:[1,0]
 v_pk_mul_f32 v[118:119], v[118:119], v[120:121] op_sel_hi:[1,0]
 v_cvt_pk_bf16_f32 v114, v116, v117
 v_cvt_pk_bf16_f32 v115, v118, v119
 ds_write_b128 v9, v[112:115] offset:30720
 s_mov_b64 exec, -1
 s_waitcnt lgkmcnt(0)
 s_barrier
 ds_read_b128 v[60:63], v0 offset:30720
 ds_read_b128 v[64:67], v0 offset:30752
 ds_read_b128 v[68:71], v0 offset:31744
 ds_read_b128 v[72:75], v0 offset:31776
 s_waitcnt lgkmcnt(3)
 v_smfmac_f32_16x16x64_bf16 v[40:43], v[60:63], v[224:231], v17
 ds_read_b128 v[224:227], v15 offset:22528
 v_smfmac_f32_16x16x64_bf16 v[44:47], v[60:63], v[232:239], v17
 ds_read_b128 v[228:231], v15 offset:23552
 s_waitcnt lgkmcnt(4)
 v_smfmac_f32_16x16x64_bf16 v[40:43], v[64:67], v[240:247], v17
 ds_read_b128 v[232:235], v15 offset:24576
 v_smfmac_f32_16x16x64_bf16 v[44:47], v[64:67], v[248:255], v17
 ds_read_b128 v[236:239], v15 offset:25600
 s_waitcnt lgkmcnt(5)
 v_smfmac_f32_16x16x64_bf16 v[40:43], v[68:71], v[80:87], v17
 ds_read_b128 v[240:243], v15 offset:26624
 v_smfmac_f32_16x16x64_bf16 v[44:47], v[68:71], v[128:135], v17
 ds_read_b128 v[244:247], v15 offset:27648
 s_waitcnt lgkmcnt(6)
 v_smfmac_f32_16x16x64_bf16 v[40:43], v[72:75], v[136:143], v17
 ds_read_b128 v[248:251], v15 offset:28672
 v_smfmac_f32_16x16x64_bf16 v[44:47], v[72:75], v[144:151], v17
 ds_read_b128 v[252:255], v15 offset:29696
 v_smfmac_f32_16x16x64_bf16 v[48:51], v[60:63], v[152:159], v17
 ds_read_b128 v[80:83], v15 offset:30720
 v_cvt_pk_bf16_f32 v116, v40, v41
 v_cvt_pk_bf16_f32 v117, v42, v43
 v_or_b32 v116, 1, v116
 v_smfmac_f32_16x16x64_bf16 v[52:55], v[60:63], v[160:167], v17
 ds_read_b128 v[84:87], v15 offset:31744
 v_cvt_pk_bf16_f32 v118, v44, v45
 v_cvt_pk_bf16_f32 v119, v46, v47
 v_or_b32 v118, 1, v118
 buffer_store_dwordx4 v[116:119], v10, s[4:7], s71 offen sc1
 v_smfmac_f32_16x16x64_bf16 v[48:51], v[64:67], v[168:175], v17
 v_smfmac_f32_16x16x64_bf16 v[52:55], v[64:67], v[176:183], v17
 v_smfmac_f32_16x16x64_bf16 v[48:51], v[68:71], v[184:191], v17
 v_smfmac_f32_16x16x64_bf16 v[52:55], v[68:71], v[88:95], v17
 v_smfmac_f32_16x16x64_bf16 v[48:51], v[72:75], v[96:103], v17
 s_waitcnt lgkmcnt(8)
 v_smfmac_f32_16x16x64_bf16 v[52:55], v[72:75], v[224:231], v17
 s_waitcnt lgkmcnt(6)
 v_smfmac_f32_16x16x64_bf16 v[56:59], v[60:63], v[232:239], v17
 v_cvt_pk_bf16_f32 v120, v48, v49
 v_cvt_pk_bf16_f32 v121, v50, v51
 v_or_b32 v120, 1, v120
 s_waitcnt lgkmcnt(4)
 v_smfmac_f32_16x16x64_bf16 v[56:59], v[64:67], v[240:247], v17
 v_cvt_pk_bf16_f32 v122, v52, v53
 v_cvt_pk_bf16_f32 v123, v54, v55
 v_or_b32 v122, 1, v122
 buffer_store_dwordx4 v[120:123], v10, s[4:7], s72 offen sc1
 s_waitcnt lgkmcnt(2)
 v_smfmac_f32_16x16x64_bf16 v[56:59], v[68:71], v[248:255], v17
 s_waitcnt lgkmcnt(0)
 v_smfmac_f32_16x16x64_bf16 v[56:59], v[72:75], v[80:87], v17
 s_nop 7
 v_cvt_pk_bf16_f32 v124, v56, v57
 v_cvt_pk_bf16_f32 v125, v58, v59
 v_or_b32 v124, 1, v124
 buffer_store_dwordx2 v[124:125], v10, s[4:7], s73 offen sc1
 ds_read_b128 v[224:227], v15 offset:0
 ds_read_b128 v[228:231], v15 offset:1024
 ds_read_b128 v[232:235], v15 offset:2048
 ds_read_b128 v[236:239], v15 offset:3072
 ds_read_b128 v[240:243], v15 offset:4096
 ds_read_b128 v[244:247], v15 offset:5120
 ds_read_b128 v[248:251], v15 offset:6144
 ds_read_b128 v[252:255], v15 offset:7168
 v_mov_b64 v[88:89], 0
 v_mov_b64 v[90:91], 0
 v_mov_b64 v[92:93], 0
 v_mov_b64 v[94:95], 0
 s_cmp_eq_u32 s55, 0
 s_cbranch_scc1 L_nr_260
 s_nop 15
 s_nop 15
 s_nop 15
 s_nop 15
 s_nop 15
L_pp_262:
 buffer_load_dwordx4 v[40:43], v1, s[4:7], s75 offen offset:0 sc1
 buffer_load_dwordx4 v[44:47], v1, s[4:7], s75 offen offset:1024 sc1
 buffer_load_dwordx4 v[48:51], v1, s[4:7], s75 offen offset:2048 sc1
 buffer_load_dwordx4 v[52:55], v1, s[4:7], s75 offen offset:3072 sc1
 s_waitcnt vmcnt(3)
 v_mfma_f32_16x16x32_bf16 v[56:59], v[40:43], v[20:23], 0
 v_and_b32 v14, v40, v42
 s_waitcnt vmcnt(2)
 v_mfma_f32_16x16x32_bf16 v[56:59], v[44:47], v[20:23], v[56:59]
 v_bitop3_b32 v14, v14, v44, v46 bitop3:0x80
 s_waitcnt vmcnt(1)
 v_mfma_f32_16x16x32_bf16 v[56:59], v[48:51], v[20:23], v[56:59]
 v_bitop3_b32 v14, v14, v48, v50 bitop3:0x80
 s_waitcnt vmcnt(0)
 v_mfma_f32_16x16x32_bf16 v[56:59], v[52:55], v[20:23], v[56:59]
 v_bitop3_b32 v14, v14, v52, v54 bitop3:0x80
 v_and_b32 v14, 1, v14
 v_cmp_ne_u32 vcc, 1, v14
 s_cbranch_vccnz L_rt_263
 s_nop 2
 v_cvt_pk_bf16_f32 v60, v56, v57
 v_cvt_pk_bf16_f32 v61, v58, v59
 s_nop 0
 v_mov_b32_dpp v62, v60 quad_perm:[2,3,2,3] row_mask:0xf bank_mask:0xf
 v_mov_b32_dpp v63, v61 quad_perm:[2,3,2,3] row_mask:0xf bank_mask:0xf
 s_mov_b64 exec, s[30:31]
 buffer_store_dwordx4 v[60:63], v11, s[4:7], s58 offen sc1
 s_mov_b64 exec, 1
 buffer_store_dword v13, off, s[4:7], s17 sc1
 s_mov_b64 exec, s[30:31]
 buffer_store_dwordx4 v[32:35], v11, s[4:7], s56 offen sc1
 s_mov_b64 exec, -1
 s_barrier
 s_nop 15
 s_nop 15
 s_nop 15
 s_nop 15
 s_nop 15
 s_nop 15
 s_nop 15
L_rj_261:
 v_add_u32 v13, 1, v13
 s_add_u32 s53, s53, 1
.p2align 3
 s_mov_b32 s51, 0
 buffer_load_dwordx4 v[40:43], v2, s[4:7], s58 offen offset:0 sc1
 buffer_load_dwordx4 v[44:47], v2, s[4:7], s58 offen offset:128 sc1
 buffer_load_dwordx4 v[48:51], v2, s[4:7], s58 offen offset:1024 sc1
 buffer_load_dwordx4 v[52:55], v2, s[4:7], s58 offen offset:1152 sc1
 buffer_load_dwordx4 v[56:59], v3, s[4:7], s58 offen offset:0 sc1
L_xm_264:
 s_waitcnt vmcnt(4)
 v_mfma_f32_16x16x32_bf16 v[60:63], v[24:27], v[40:43], 0
 s_waitcnt vmcnt(3)
 v_mfma_f32_16x16x32_bf16 v[64:67], v[24:27], v[44:47], 0
 s_waitcnt vmcnt(2)
 v_mfma_f32_16x16x32_bf16 v[68:71], v[24:27], v[48:51], 0
 v_max3_u32 v14, v40, v44, v48
 v_cvt_pk_bf16_f32 v60, v60, v61
 v_cvt_pk_bf16_f32 v61, v62, v63
 ds_write_b64 v4, v[60:61] offset:0
 s_waitcnt vmcnt(1)
 v_mfma_f32_16x16x32_bf16 v[72:75], v[24:27], v[52:55], 0
 v_cvt_pk_bf16_f32 v64, v64, v65
 v_cvt_pk_bf16_f32 v65, v66, v67
 ds_write_b64 v4, v[64:65] offset:8
 s_waitcnt vmcnt(0)
 v_mfma_f32_16x16x32_bf16 v[76:79], v[24:27], v[56:59], 0
 v_max3_u32 v14, v14, v52, v56
 v_cmp_eq_u32 vcc, -1, v14
 v_cvt_pk_bf16_f32 v68, v68, v69
 v_cvt_pk_bf16_f32 v69, v70, v71
 ds_write_b64 v4, v[68:69] offset:1024
 s_cbranch_vccnz L_rt_265
 v_cvt_pk_bf16_f32 v72, v72, v73
 v_cvt_pk_bf16_f32 v73, v74, v75
 ds_write_b64 v4, v[72:73] offset:1032
 s_nop 0
 v_cvt_pk_bf16_f32 v76, v76, v77
 v_cvt_pk_bf16_f32 v77, v78, v79
 ds_write_b64 v5, v[76:77] offset:0
 s_waitcnt lgkmcnt(0)
 s_barrier
L_ch_b1s2:
 ds_read_b128 v[72:75], v0 offset:0
 ds_read_b128 v[76:79], v0 offset:32
 ds_read_b128 v[80:83], v0 offset:1024
 s_waitcnt lgkmcnt(2)
 v_smfmac_f32_16x16x64_bf16 v[88:91], v[72:75], v[224:231], v17
 ds_read_b128 v[84:87], v0 offset:1056
 v_smfmac_f32_16x16x64_bf16 v[92:95], v[72:75], v[232:239], v17
 ds_read_b128 v[96:99], v0 offset:2048
 s_waitcnt lgkmcnt(3)
 v_smfmac_f32_16x16x64_bf16 v[88:91], v[76:79], v[240:247], v17
 ds_read_b128 v[100:103], v0 offset:2080
 v_smfmac_f32_16x16x64_bf16 v[92:95], v[76:79], v[248:255], v17
 ds_read_b128 v[112:115], v0 offset:3072
 s_waitcnt lgkmcnt(4)
 v_smfmac_f32_16x16x64_bf16 v[88:91], v[80:83], v[192:199], v17
 ds_read_b128 v[40:43], v1 offset:10240
 v_smfmac_f32_16x16x64_bf16 v[92:95], v[80:83], v[200:207], v17
 ds_read_b128 v[116:119], v0 offset:3104
 s_waitcnt lgkmcnt(5)
 v_smfmac_f32_16x16x64_bf16 v[88:91], v[84:87], v[208:215], v17
 ds_read_b128 v[44:47], v1 offset:11264
 v_smfmac_f32_16x16x64_bf16 v[92:95], v[84:87], v[216:223], v17
 ds_read_b128 v[72:75], v0 offset:4096
 s_waitcnt lgkmcnt(6)
 v_smfmac_f32_16x16x64_bf16 v[88:91], v[96:99], a[0:7], v17
 ds_read_b128 v[48:51], v1 offset:12288
 v_smfmac_f32_16x16x64_bf16 v[92:95], v[96:99], a[8:15], v17
 ds_read_b128 v[76:79], v0 offset:4128
 s_waitcnt lgkmcnt(7)
 v_smfmac_f32_16x16x64_bf16 v[88:91], v[100:103], a[16:23], v17
 ds_read_b128 v[52:55], v1 offset:13312
 v_smfmac_f32_16x16x64_bf16 v[92:95], v[100:103], a[24:31], v17
 ds_read_b128 v[80:83], v0 offset:5120
 s_waitcnt lgkmcnt(8)
 v_smfmac_f32_16x16x64_bf16 v[88:91], v[112:115], a[32:39], v17
 ds_read_b128 v[56:59], v1 offset:14336
 v_smfmac_f32_16x16x64_bf16 v[92:95], v[112:115], a[40:47], v17
 ds_read_b128 v[84:87], v0 offset:5152
 s_waitcnt lgkmcnt(8)
 v_smfmac_f32_16x16x64_bf16 v[88:91], v[116:119], a[48:55], v17
 ds_read_b128 v[60:63], v1 offset:15360
 v_smfmac_f32_16x16x64_bf16 v[92:95], v[116:119], a[56:63], v17
 ds_read_b128 v[96:99], v0 offset:6144
 s_waitcnt lgkmcnt(8)
 v_smfmac_f32_16x16x64_bf16 v[88:91], v[72:75], a[64:71], v17
 ds_read_b128 v[64:67], v1 offset:16384
 v_smfmac_f32_16x16x64_bf16 v[92:95], v[72:75], a[72:79], v17
 ds_read_b128 v[100:103], v0 offset:6176
 s_waitcnt lgkmcnt(8)
 v_smfmac_f32_16x16x64_bf16 v[88:91], v[76:79], a[80:87], v17
 ds_read_b128 v[68:71], v1 offset:17408
 v_smfmac_f32_16x16x64_bf16 v[92:95], v[76:79], a[88:95], v17
 ds_read_b128 v[112:115], v0 offset:7168
 s_waitcnt lgkmcnt(8)
 v_smfmac_f32_16x16x64_bf16 v[88:91], v[80:83], a[96:103], v17
 ds_read_b128 v[104:107], v16 offset:18432
 v_smfmac_f32_16x16x64_bf16 v[92:95], v[80:83], a[104:111], v17
 ds_read_b128 v[116:119], v0 offset:7200
 s_waitcnt lgkmcnt(8)
 v_smfmac_f32_16x16x64_bf16 v[88:91], v[84:87], a[112:119], v17
 ds_read_b128 v[108:111], v16 offset:19456
 v_smfmac_f32_16x16x64_bf16 v[92:95], v[84:87], a[120:127], v17
 ds_read_b128 v[72:75], v0 offset:8192
 s_waitcnt lgkmcnt(8)
 v_smfmac_f32_16x16x64_bf16 v[88:91], v[96:99], a[128:135], v17
 ds_read_b128 v[224:227], v15 offset:8192
 v_smfmac_f32_16x16x64_bf16 v[92:95], v[96:99], a[136:143], v17
 ds_read_b128 v[76:79], v0 offset:8224
 s_waitcnt lgkmcnt(8)
 v_smfmac_f32_16x16x64_bf16 v[88:91], v[100:103], a[144:151], v17
 ds_read_b128 v[228:231], v15 offset:9216
 v_smfmac_f32_16x16x64_bf16 v[92:95], v[100:103], a[152:159], v17
 ds_read_b128 v[80:83], v0 offset:9216
 s_waitcnt lgkmcnt(8)
 v_smfmac_f32_16x16x64_bf16 v[88:91], v[112:115], a[160:167], v17
 ds_read_b128 v[232:235], v15 offset:10240
 v_smfmac_f32_16x16x64_bf16 v[92:95], v[112:115], a[168:175], v17
 ds_read_b128 v[84:87], v0 offset:9248
 s_waitcnt lgkmcnt(8)
 v_smfmac_f32_16x16x64_bf16 v[88:91], v[116:119], a[176:183], v17
 ds_read_b128 v[236:239], v15 offset:11264
 v_smfmac_f32_16x16x64_bf16 v[92:95], v[116:119], a[184:191], v17
 ds_read_b128 v[240:243], v15 offset:12288
 s_waitcnt lgkmcnt(8)
 v_smfmac_f32_16x16x64_bf16 v[88:91], v[72:75], a[192:199], v17
 ds_read_b128 v[244:247], v15 offset:13312
 v_smfmac_f32_16x16x64_bf16 v[92:95], v[72:75], a[200:207], v17
 ds_read_b128 v[248:251], v15 offset:14336
 s_waitcnt lgkmcnt(8)
 v_smfmac_f32_16x16x64_bf16 v[88:91], v[76:79], a[208:215], v17
 ds_read_b128 v[252:255], v15 offset:15360
 v_smfmac_f32_16x16x64_bf16 v[92:95], v[76:79], a[216:223], v17
 s_waitcnt lgkmcnt(7)
 v_smfmac_f32_16x16x64_bf16 v[88:91], v[80:83], a[224:231], v17
 v_smfmac_f32_16x16x64_bf16 v[92:95], v[80:83], a[232:239], v17
 s_waitcnt lgkmcnt(5)
 v_smfmac_f32_16x16x64_bf16 v[88:91], v[84:87], a[240:247], v17
 v_smfmac_f32_16x16x64_bf16 v[92:95], v[84:87], a[248:255], v17
 s_nop 2
 v_cvt_pk_bf16_f32 v120, v88, v89
 v_cvt_pk_bf16_f32 v121, v90, v91
 ds_write_b64 v6, v[120:121] offset:26624
 s_nop 1
 v_cvt_pk_bf16_f32 v122, v92, v93
 v_cvt_pk_bf16_f32 v123, v94, v95
 ds_write_b64 v6, v[122:123] offset:27136
 s_waitcnt lgkmcnt(0)
 s_barrier
 ds_read_b64_tr_b16 v[72:73], v7 offset:26624
 ds_read_b64_tr_b16 v[74:75], v7 offset:27136
 ds_read_b64_tr_b16 v[76:77], v7 offset:27648
 ds_read_b64_tr_b16 v[78:79], v7 offset:28160
 ds_read_b64_tr_b16 v[80:81], v7 offset:28672
 ds_read_b64_tr_b16 v[82:83], v7 offset:29184
 ds_read_b64_tr_b16 v[84:85], v7 offset:29696
 ds_read_b64_tr_b16 v[86:87], v7 offset:30208
 ds_read_b64_tr_b16 v[112:113], v8 offset:26624
 ds_read_b64_tr_b16 v[114:115], v8 offset:27136
 s_waitcnt lgkmcnt(8)
 v_mfma_f32_16x16x32_bf16 v[92:95], v[40:43], v[72:75], 0
 v_mfma_f32_16x16x32_bf16 v[96:99], v[56:59], v[72:75], 0
 v_mfma_f32_16x16x32_bf16 v[88:91], v[72:75], v[72:75], 0
 s_waitcnt lgkmcnt(6)
 v_mfma_f32_16x16x32_bf16 v[92:95], v[44:47], v[76:79], v[92:95]
 v_mfma_f32_16x16x32_bf16 v[96:99], v[60:63], v[76:79], v[96:99]
 v_mfma_f32_16x16x32_bf16 v[88:91], v[76:79], v[76:79], v[88:91]
 s_waitcnt lgkmcnt(4)
 v_mfma_f32_16x16x32_bf16 v[92:95], v[48:51], v[80:83], v[92:95]
 buffer_load_dwordx2 v[124:125], v1, s[4:7], s66 offen sc1
 v_mfma_f32_16x16x32_bf16 v[96:99], v[64:67], v[80:83], v[96:99]
 v_mfma_f32_16x16x32_bf16 v[88:91], v[80:83], v[80:83], v[88:91]
 s_waitcnt lgkmcnt(0)
 buffer_store_dwordx4 v[112:115], v1, s[4:7], s62 offen sc1
 s_waitcnt lgkmcnt(2)
 v_mfma_f32_16x16x32_bf16 v[92:95], v[52:55], v[84:87], v[92:95]
 v_mfma_f32_16x16x32_bf16 v[96:99], v[68:71], v[84:87], v[96:99]
 v_mfma_f32_16x16x32_bf16 v[88:91], v[84:87], v[84:87], v[88:91]
 v_mfma_f32_32x32x8_bf16 v[40:55], v[18:19], v[18:19], 0
 v_max3_f32 v126, v92, v93, v94
 ds_read_b128 v[80:83], v15 offset:16384
 ds_read_b128 v[84:87], v15 offset:17408
 v_max3_f32 v126, v126, v95, v96
 v_max3_f32 v126, v126, v97, v98
 v_max3_f32 v126, v126, v99, v90
 v_max_f32 v126, v126, v91
 v_mov_b32 v127, v126
 v_mov_b64 v[56:57], 0
 v_mov_b64 v[58:59], 0
 v_permlane16_swap_b32 v126, v127
 v_max_f32 v126, v126, v127
 v_mov_b32 v127, v126
 s_nop 1
 v_permlane32_swap_b32 v126, v127
 v_max_f32 v126, v126, v127
 v_mul_f32 v126, s79, v126
 v_fma_f32 v92, v92, s79, -v126
 v_fma_f32 v93, v93, s79, -v126
 v_fma_f32 v94, v94, s79, -v126
 v_fma_f32 v95, v95, s79, -v126
 v_fma_f32 v96, v96, s79, -v126
 v_fma_f32 v97, v97, s79, -v126
 v_fma_f32 v98, v98, s79, -v126
 v_fma_f32 v99, v99, s79, -v126
 v_exp_f32 v92, v92
 v_exp_f32 v93, v93
 v_exp_f32 v94, v94
 v_exp_f32 v95, v95
 v_exp_f32 v96, v96
 v_exp_f32 v97, v97
 v_exp_f32 v98, v98
 v_exp_f32 v99, v99
 v_fma_f32 v90, v90, s79, -v126
 v_cvt_pk_bf16_f32 v100, v92, v93
 v_cvt_pk_bf16_f32 v101, v94, v95
 v_cvt_pk_bf16_f32 v102, v96, v97
 v_cvt_pk_bf16_f32 v103, v98, v99
 v_fma_f32 v91, v91, s79, -v126
 v_exp_f32 v90, v90
 v_mfma_f32_16x16x32_bf16 v[120:123], v[28:31], v[100:103], 0
 v_exp_f32 v91, v91
 v_mfma_f32_16x16x32_bf16 v[112:115], v[104:107], v[100:103], 0
 v_cvt_pk_bf16_f32 v36, v90, v91
 v_cvt_pk_bf16_f32 v39, v90, v91
 v_mfma_f32_16x16x32_bf16 v[116:119], v[108:111], v[100:103], 0
 s_waitcnt vmcnt(0)
 v_mfma_f32_16x16x16_bf16 v[120:123], v[28:29], v[36:37], v[120:123]
L_pv_266:
 v_cmp_eq_u32 vcc, -1, v124
 s_cbranch_vccnz L_rt_267
 v_mfma_f32_16x16x16_bf16 v[112:115], v[124:125], v[36:37], v[112:115]
 v_mfma_f32_16x16x16_bf16 v[116:119], v[124:125], v[38:39], v[116:119]
 v_rcp_f32 v120, v120
 ds_read_b128 v[88:91], v15 offset:18432
 ds_read_b128 v[92:95], v15 offset:19456
 ds_read_b128 v[96:99], v15 offset:20480
 ds_read_b128 v[100:103], v15 offset:21504
 s_mov_b64 exec, s[28:29]
 v_pk_mul_f32 v[112:113], v[112:113], v[120:121] op_sel_hi:[1,0]
 v_pk_mul_f32 v[114:115], v[114:115], v[120:121] op_sel_hi:[1,0]
 v_cvt_pk_bf16_f32 v112, v112, v113
 v_cvt_pk_bf16_f32 v113, v114, v115
 v_pk_mul_f32 v[116:117], v[116:117], v[120:121] op_sel_hi:[1,0]
 v_pk_mul_f32 v[118:119], v[118:119], v[120:121] op_sel_hi:[1,0]
 v_cvt_pk_bf16_f32 v114, v116, v117
 v_cvt_pk_bf16_f32 v115, v118, v119
 ds_write_b128 v9, v[112:115] offset:30720
 s_mov_b64 exec, -1
 s_waitcnt lgkmcnt(0)
 s_barrier
 ds_read_b128 v[60:63], v0 offset:30720
 ds_read_b128 v[64:67], v0 offset:30752
 ds_read_b128 v[68:71], v0 offset:31744
 ds_read_b128 v[72:75], v0 offset:31776
 s_waitcnt lgkmcnt(3)
 v_smfmac_f32_16x16x64_bf16 v[40:43], v[60:63], v[224:231], v17
 ds_read_b128 v[224:227], v15 offset:22528
 v_smfmac_f32_16x16x64_bf16 v[44:47], v[60:63], v[232:239], v17
 ds_read_b128 v[228:231], v15 offset:23552
 s_waitcnt lgkmcnt(4)
 v_smfmac_f32_16x16x64_bf16 v[40:43], v[64:67], v[240:247], v17
 ds_read_b128 v[232:235], v15 offset:24576
 v_smfmac_f32_16x16x64_bf16 v[44:47], v[64:67], v[248:255], v17
 ds_read_b128 v[236:239], v15 offset:25600
 s_waitcnt lgkmcnt(5)
 v_smfmac_f32_16x16x64_bf16 v[40:43], v[68:71], v[80:87], v17
 ds_read_b128 v[240:243], v15 offset:26624
 v_smfmac_f32_16x16x64_bf16 v[44:47], v[68:71], v[128:135], v17
 ds_read_b128 v[244:247], v15 offset:27648
 s_waitcnt lgkmcnt(6)
 v_smfmac_f32_16x16x64_bf16 v[40:43], v[72:75], v[136:143], v17
 ds_read_b128 v[248:251], v15 offset:28672
 v_smfmac_f32_16x16x64_bf16 v[44:47], v[72:75], v[144:151], v17
 ds_read_b128 v[252:255], v15 offset:29696
 v_smfmac_f32_16x16x64_bf16 v[48:51], v[60:63], v[152:159], v17
 ds_read_b128 v[80:83], v15 offset:30720
 v_cvt_pk_bf16_f32 v116, v40, v41
 v_cvt_pk_bf16_f32 v117, v42, v43
 v_and_b32 v116, -2, v116
 v_smfmac_f32_16x16x64_bf16 v[52:55], v[60:63], v[160:167], v17
 ds_read_b128 v[84:87], v15 offset:31744
 v_cvt_pk_bf16_f32 v118, v44, v45
 v_cvt_pk_bf16_f32 v119, v46, v47
 v_and_b32 v118, -2, v118
 buffer_store_dwordx4 v[116:119], v10, s[4:7], s68 offen sc1
 v_smfmac_f32_16x16x64_bf16 v[48:51], v[64:67], v[168:175], v17
 v_smfmac_f32_16x16x64_bf16 v[52:55], v[64:67], v[176:183], v17
 v_smfmac_f32_16x16x64_bf16 v[48:51], v[68:71], v[184:191], v17
 v_smfmac_f32_16x16x64_bf16 v[52:55], v[68:71], v[88:95], v17
 v_smfmac_f32_16x16x64_bf16 v[48:51], v[72:75], v[96:103], v17
 s_waitcnt lgkmcnt(8)
 v_smfmac_f32_16x16x64_bf16 v[52:55], v[72:75], v[224:231], v17
 s_waitcnt lgkmcnt(6)
 v_smfmac_f32_16x16x64_bf16 v[56:59], v[60:63], v[232:239], v17
 v_cvt_pk_bf16_f32 v120, v48, v49
 v_cvt_pk_bf16_f32 v121, v50, v51
 v_and_b32 v120, -2, v120
 s_waitcnt lgkmcnt(4)
 v_smfmac_f32_16x16x64_bf16 v[56:59], v[64:67], v[240:247], v17
 v_cvt_pk_bf16_f32 v122, v52, v53
 v_cvt_pk_bf16_f32 v123, v54, v55
 v_and_b32 v122, -2, v122
 buffer_store_dwordx4 v[120:123], v10, s[4:7], s69 offen sc1
 s_waitcnt lgkmcnt(2)
 v_smfmac_f32_16x16x64_bf16 v[56:59], v[68:71], v[248:255], v17
 s_waitcnt lgkmcnt(0)
 v_smfmac_f32_16x16x64_bf16 v[56:59], v[72:75], v[80:87], v17
 s_nop 7
 v_cvt_pk_bf16_f32 v124, v56, v57
 v_cvt_pk_bf16_f32 v125, v58, v59
 v_and_b32 v124, -2, v124
 buffer_store_dwordx2 v[124:125], v10, s[4:7], s70 offen sc1
 ds_read_b128 v[224:227], v15 offset:0
 ds_read_b128 v[228:231], v15 offset:1024
 ds_read_b128 v[232:235], v15 offset:2048
 ds_read_b128 v[236:239], v15 offset:3072
 ds_read_b128 v[240:243], v15 offset:4096
 ds_read_b128 v[244:247], v15 offset:5120
 ds_read_b128 v[248:251], v15 offset:6144
 ds_read_b128 v[252:255], v15 offset:7168
 v_mov_b64 v[88:89], 0
 v_mov_b64 v[90:91], 0
 v_mov_b64 v[92:93], 0
 v_mov_b64 v[94:95], 0
 s_cmp_eq_u32 s55, 0
 s_cbranch_scc1 L_nr_268
 s_nop 15
 s_nop 15
 s_nop 15
 s_nop 15
 s_nop 15
L_pp_270:
 buffer_load_dwordx4 v[40:43], v1, s[4:7], s74 offen offset:0 sc1
 buffer_load_dwordx4 v[44:47], v1, s[4:7], s74 offen offset:1024 sc1
 buffer_load_dwordx4 v[48:51], v1, s[4:7], s74 offen offset:2048 sc1
 buffer_load_dwordx4 v[52:55], v1, s[4:7], s74 offen offset:3072 sc1
 s_waitcnt vmcnt(3)
 v_mfma_f32_16x16x32_bf16 v[56:59], v[40:43], v[20:23], 0
 v_or_b32 v14, v40, v42
 s_waitcnt vmcnt(2)
 v_mfma_f32_16x16x32_bf16 v[56:59], v[44:47], v[20:23], v[56:59]
 v_or3_b32 v14, v14, v44, v46
 s_waitcnt vmcnt(1)
 v_mfma_f32_16x16x32_bf16 v[56:59], v[48:51], v[20:23], v[56:59]
 v_or3_b32 v14, v14, v48, v50
 s_waitcnt vmcnt(0)
 v_mfma_f32_16x16x32_bf16 v[56:59], v[52:55], v[20:23], v[56:59]
 v_or3_b32 v14, v14, v52, v54
 v_and_b32 v14, 1, v14
 v_cmp_ne_u32 vcc, 0, v14
 s_cbranch_vccnz L_rt_271
 s_nop 2
 v_cvt_pk_bf16_f32 v60, v56, v57
 v_cvt_pk_bf16_f32 v61, v58, v59
 s_nop 0
 v_mov_b32_dpp v62, v60 quad_perm:[2,3,2,3] row_mask:0xf bank_mask:0xf
 v_mov_b32_dpp v63, v61 quad_perm:[2,3,2,3] row_mask:0xf bank_mask:0xf
 s_mov_b64 exec, s[30:31]
 buffer_store_dwordx4 v[60:63], v11, s[4:7], s59 offen sc1
 s_mov_b64 exec, 1
 buffer_store_dword v13, off, s[4:7], s17 sc1
 s_mov_b64 exec, s[30:31]
 buffer_store_dwordx4 v[32:35], v11, s[4:7], s57 offen sc1
 s_mov_b64 exec, -1
 s_barrier
 s_nop 15
 s_nop 15
 s_nop 15
 s_nop 15
 s_nop 15
 s_nop 15
 s_nop 15
L_rj_269:
 v_add_u32 v13, 1, v13
 s_add_u32 s53, s53, 1
.p2align 3
 s_mov_b32 s51, 0
 buffer_load_dwordx4 v[40:43], v2, s[4:7], s59 offen offset:0 sc1
 buffer_load_dwordx4 v[44:47], v2, s[4:7], s59 offen offset:128 sc1
 buffer_load_dwordx4 v[48:51], v2, s[4:7], s59 offen offset:1024 sc1
 buffer_load_dwordx4 v[52:55], v2, s[4:7], s59 offen offset:1152 sc1
 buffer_load_dwordx4 v[56:59], v3, s[4:7], s59 offen offset:0 sc1
L_xm_272:
 s_waitcnt vmcnt(4)
 v_mfma_f32_16x16x32_bf16 v[60:63], v[24:27], v[40:43], 0
 s_waitcnt vmcnt(3)
 v_mfma_f32_16x16x32_bf16 v[64:67], v[24:27], v[44:47], 0
 s_waitcnt vmcnt(2)
 v_mfma_f32_16x16x32_bf16 v[68:71], v[24:27], v[48:51], 0
 v_max3_u32 v14, v40, v44, v48
 v_cvt_pk_bf16_f32 v60, v60, v61
 v_cvt_pk_bf16_f32 v61, v62, v63
 ds_write_b64 v4, v[60:61] offset:0
 s_waitcnt vmcnt(1)
 v_mfma_f32_16x16x32_bf16 v[72:75], v[24:27], v[52:55], 0
 v_cvt_pk_bf16_f32 v64, v64, v65
 v_cvt_pk_bf16_f32 v65, v66, v67
 ds_write_b64 v4, v[64:65] offset:8
 s_waitcnt vmcnt(0)
 v_mfma_f32_16x16x32_bf16 v[76:79], v[24:27], v[56:59], 0
 v_max3_u32 v14, v14, v52, v56
 v_cmp_eq_u32 vcc, -1, v14
 v_cvt_pk_bf16_f32 v68, v68, v69
 v_cvt_pk_bf16_f32 v69, v70, v71
 ds_write_b64 v4, v[68:69] offset:1024
 s_cbranch_vccnz L_rt_273
 v_cvt_pk_bf16_f32 v72, v72, v73
 v_cvt_pk_bf16_f32 v73, v74, v75
 ds_write_b64 v4, v[72:73] offset:1032
 s_nop 0
 v_cvt_pk_bf16_f32 v76, v76, v77
 v_cvt_pk_bf16_f32 v77, v78, v79
 ds_write_b64 v5, v[76:77] offset:0
 s_waitcnt lgkmcnt(0)
 s_barrier
L_ch_b1s3:
 ds_read_b128 v[72:75], v0 offset:0
 ds_read_b128 v[76:79], v0 offset:32
 ds_read_b128 v[80:83], v0 offset:1024
 s_waitcnt lgkmcnt(2)
 v_smfmac_f32_16x16x64_bf16 v[88:91], v[72:75], v[224:231], v17
 ds_read_b128 v[84:87], v0 offset:1056
 v_smfmac_f32_16x16x64_bf16 v[92:95], v[72:75], v[232:239], v17
 ds_read_b128 v[96:99], v0 offset:2048
 s_waitcnt lgkmcnt(3)
 v_smfmac_f32_16x16x64_bf16 v[88:91], v[76:79], v[240:247], v17
 ds_read_b128 v[100:103], v0 offset:2080
 v_smfmac_f32_16x16x64_bf16 v[92:95], v[76:79], v[248:255], v17
 ds_read_b128 v[112:115], v0 offset:3072
 s_waitcnt lgkmcnt(4)
 v_smfmac_f32_16x16x64_bf16 v[88:91], v[80:83], v[192:199], v17
 ds_read_b128 v[40:43], v1 offset:10240
 v_smfmac_f32_16x16x64_bf16 v[92:95], v[80:83], v[200:207], v17
 ds_read_b128 v[116:119], v0 offset:3104
 s_waitcnt lgkmcnt(5)
 v_smfmac_f32_16x16x64_bf16 v[88:91], v[84:87], v[208:215], v17
 ds_read_b128 v[44:47], v1 offset:11264
 v_smfmac_f32_16x16x64_bf16 v[92:95], v[84:87], v[216:223], v17
 ds_read_b128 v[72:75], v0 offset:4096
 s_waitcnt lgkmcnt(6)
 v_smfmac_f32_16x16x64_bf16 v[88:91], v[96:99], a[0:7], v17
 ds_read_b128 v[48:51], v1 offset:12288
 v_smfmac_f32_16x16x64_bf16 v[92:95], v[96:99], a[8:15], v17
 ds_read_b128 v[76:79], v0 offset:4128
 s_waitcnt lgkmcnt(7)
 v_smfmac_f32_16x16x64_bf16 v[88:91], v[100:103], a[16:23], v17
 ds_read_b128 v[52:55], v1 offset:13312
 v_smfmac_f32_16x16x64_bf16 v[92:95], v[100:103], a[24:31], v17
 ds_read_b128 v[80:83], v0 offset:5120
 s_waitcnt lgkmcnt(8)
 v_smfmac_f32_16x16x64_bf16 v[88:91], v[112:115], a[32:39], v17
 ds_read_b128 v[56:59], v1 offset:14336
 v_smfmac_f32_16x16x64_bf16 v[92:95], v[112:115], a[40:47], v17
 ds_read_b128 v[84:87], v0 offset:5152
 s_waitcnt lgkmcnt(8)
 v_smfmac_f32_16x16x64_bf16 v[88:91], v[116:119], a[48:55], v17
 ds_read_b128 v[60:63], v1 offset:15360
 v_smfmac_f32_16x16x64_bf16 v[92:95], v[116:119], a[56:63], v17
 ds_read_b128 v[96:99], v0 offset:6144
 s_waitcnt lgkmcnt(8)
 v_smfmac_f32_16x16x64_bf16 v[88:91], v[72:75], a[64:71], v17
 ds_read_b128 v[64:67], v1 offset:16384
 v_smfmac_f32_16x16x64_bf16 v[92:95], v[72:75], a[72:79], v17
 ds_read_b128 v[100:103], v0 offset:6176
 s_waitcnt lgkmcnt(8)
 v_smfmac_f32_16x16x64_bf16 v[88:91], v[76:79], a[80:87], v17
 ds_read_b128 v[68:71], v1 offset:17408
 v_smfmac_f32_16x16x64_bf16 v[92:95], v[76:79], a[88:95], v17
 ds_read_b128 v[112:115], v0 offset:7168
 s_waitcnt lgkmcnt(8)
 v_smfmac_f32_16x16x64_bf16 v[88:91], v[80:83], a[96:103], v17
 ds_read_b128 v[104:107], v16 offset:18432
 v_smfmac_f32_16x16x64_bf16 v[92:95], v[80:83], a[104:111], v17
 ds_read_b128 v[116:119], v0 offset:7200
 s_waitcnt lgkmcnt(8)
 v_smfmac_f32_16x16x64_bf16 v[88:91], v[84:87], a[112:119], v17
 ds_read_b128 v[108:111], v16 offset:19456
 v_smfmac_f32_16x16x64_bf16 v[92:95], v[84:87], a[120:127], v17
 ds_read_b128 v[72:75], v0 offset:8192
 s_waitcnt lgkmcnt(8)
 v_smfmac_f32_16x16x64_bf16 v[88:91], v[96:99], a[128:135], v17
 ds_read_b128 v[224:227], v15 offset:8192
 v_smfmac_f32_16x16x64_bf16 v[92:95], v[96:99], a[136:143], v17
 ds_read_b128 v[76:79], v0 offset:8224
 s_waitcnt lgkmcnt(8)
 v_smfmac_f32_16x16x64_bf16 v[88:91], v[100:103], a[144:151], v17
 ds_read_b128 v[228:231], v15 offset:9216
 v_smfmac_f32_16x16x64_bf16 v[92:95], v[100:103], a[152:159], v17
 ds_read_b128 v[80:83], v0 offset:9216
 s_waitcnt lgkmcnt(8)
 v_smfmac_f32_16x16x64_bf16 v[88:91], v[112:115], a[160:167], v17
 ds_read_b128 v[232:235], v15 offset:10240
 v_smfmac_f32_16x16x64_bf16 v[92:95], v[112:115], a[168:175], v17
 ds_read_b128 v[84:87], v0 offset:9248
 s_waitcnt lgkmcnt(8)
 v_smfmac_f32_16x16x64_bf16 v[88:91], v[116:119], a[176:183], v17
 ds_read_b128 v[236:239], v15 offset:11264
 v_smfmac_f32_16x16x64_bf16 v[92:95], v[116:119], a[184:191], v17
 ds_read_b128 v[240:243], v15 offset:12288
 s_waitcnt lgkmcnt(8)
 v_smfmac_f32_16x16x64_bf16 v[88:91], v[72:75], a[192:199], v17
 ds_read_b128 v[244:247], v15 offset:13312
 v_smfmac_f32_16x16x64_bf16 v[92:95], v[72:75], a[200:207], v17
 ds_read_b128 v[248:251], v15 offset:14336
 s_waitcnt lgkmcnt(8)
 v_smfmac_f32_16x16x64_bf16 v[88:91], v[76:79], a[208:215], v17
 ds_read_b128 v[252:255], v15 offset:15360
 v_smfmac_f32_16x16x64_bf16 v[92:95], v[76:79], a[216:223], v17
 s_waitcnt lgkmcnt(7)
 v_smfmac_f32_16x16x64_bf16 v[88:91], v[80:83], a[224:231], v17
 v_smfmac_f32_16x16x64_bf16 v[92:95], v[80:83], a[232:239], v17
 s_waitcnt lgkmcnt(5)
 v_smfmac_f32_16x16x64_bf16 v[88:91], v[84:87], a[240:247], v17
 v_smfmac_f32_16x16x64_bf16 v[92:95], v[84:87], a[248:255], v17
 s_nop 2
 v_cvt_pk_bf16_f32 v120, v88, v89
 v_cvt_pk_bf16_f32 v121, v90, v91
 ds_write_b64 v6, v[120:121] offset:26624
 s_nop 1
 v_cvt_pk_bf16_f32 v122, v92, v93
 v_cvt_pk_bf16_f32 v123, v94, v95
 ds_write_b64 v6, v[122:123] offset:27136
 s_waitcnt lgkmcnt(0)
 s_barrier
 ds_read_b64_tr_b16 v[72:73], v7 offset:26624
 ds_read_b64_tr_b16 v[74:75], v7 offset:27136
 ds_read_b64_tr_b16 v[76:77], v7 offset:27648
 ds_read_b64_tr_b16 v[78:79], v7 offset:28160
 ds_read_b64_tr_b16 v[80:81], v7 offset:28672
 ds_read_b64_tr_b16 v[82:83], v7 offset:29184
 ds_read_b64_tr_b16 v[84:85], v7 offset:29696
 ds_read_b64_tr_b16 v[86:87], v7 offset:30208
 ds_read_b64_tr_b16 v[112:113], v8 offset:26624
 ds_read_b64_tr_b16 v[114:115], v8 offset:27136
 s_waitcnt lgkmcnt(8)
 v_mfma_f32_16x16x32_bf16 v[92:95], v[40:43], v[72:75], 0
 v_mfma_f32_16x16x32_bf16 v[96:99], v[56:59], v[72:75], 0
 v_mfma_f32_16x16x32_bf16 v[88:91], v[72:75], v[72:75], 0
 s_waitcnt lgkmcnt(6)
 v_mfma_f32_16x16x32_bf16 v[92:95], v[44:47], v[76:79], v[92:95]
 v_mfma_f32_16x16x32_bf16 v[96:99], v[60:63], v[76:79], v[96:99]
 v_mfma_f32_16x16x32_bf16 v[88:91], v[76:79], v[76:79], v[88:91]
 s_waitcnt lgkmcnt(4)
 v_mfma_f32_16x16x32_bf16 v[92:95], v[48:51], v[80:83], v[92:95]
 buffer_load_dwordx2 v[124:125], v1, s[4:7], s67 offen sc1
 v_mfma_f32_16x16x32_bf16 v[96:99], v[64:67], v[80:83], v[96:99]
 v_mfma_f32_16x16x32_bf16 v[88:91], v[80:83], v[80:83], v[88:91]
 s_waitcnt lgkmcnt(0)
 buffer_store_dwordx4 v[112:115], v1, s[4:7], s63 offen sc1
 s_waitcnt lgkmcnt(2)
 v_mfma_f32_16x16x32_bf16 v[92:95], v[52:55], v[84:87], v[92:95]
 v_mfma_f32_16x16x32_bf16 v[96:99], v[68:71], v[84:87], v[96:99]
 v_mfma_f32_16x16x32_bf16 v[88:91], v[84:87], v[84:87], v[88:91]
 s_cmp_eq_u32 s53, 63
 s_cbranch_scc1 L_ch_last
 v_mfma_f32_32x32x8_bf16 v[40:55], v[18:19], v[18:19], 0
 v_max3_f32 v126, v92, v93, v94
 ds_read_b128 v[80:83], v15 offset:16384
 ds_read_b128 v[84:87], v15 offset:17408
 v_max3_f32 v126, v126, v95, v96
 v_max3_f32 v126, v126, v97, v98
 v_max3_f32 v126, v126, v99, v90
 v_max_f32 v126, v126, v91
 v_mov_b32 v127, v126
 v_mov_b64 v[56:57], 0
 v_mov_b64 v[58:59], 0
 v_permlane16_swap_b32 v126, v127
 v_max_f32 v126, v126, v127
 v_mov_b32 v127, v126
 s_nop 1
 v_permlane32_swap_b32 v126, v127
 v_max_f32 v126, v126, v127
 v_mul_f32 v126, s79, v126
 v_fma_f32 v92, v92, s79, -v126
 v_fma_f32 v93, v93, s79, -v126
 v_fma_f32 v94, v94, s79, -v126
 v_fma_f32 v95, v95, s79, -v126
 v_fma_f32 v96, v96, s79, -v126
 v_fma_f32 v97, v97, s79, -v126
 v_fma_f32 v98, v98, s79, -v126
 v_fma_f32 v99, v99, s79, -v126
 v_exp_f32 v92, v92
 v_exp_f32 v93, v93
 v_exp_f32 v94, v94
 v_exp_f32 v95, v95
 v_exp_f32 v96, v96
 v_exp_f32 v97, v97
 v_exp_f32 v98, v98
 v_exp_f32 v99, v99
 v_fma_f32 v90, v90, s79, -v126
 v_cvt_pk_bf16_f32 v100, v92, v93
 v_cvt_pk_bf16_f32 v101, v94, v95
 v_cvt_pk_bf16_f32 v102, v96, v97
 v_cvt_pk_bf16_f32 v103, v98, v99
 v_fma_f32 v91, v91, s79, -v126
 v_exp_f32 v90, v90
 v_mfma_f32_16x16x32_bf16 v[120:123], v[28:31], v[100:103], 0
 v_exp_f32 v91, v91
 v_mfma_f32_16x16x32_bf16 v[112:115], v[104:107], v[100:103], 0
 v_cvt_pk_bf16_f32 v36, v90, v91
 v_cvt_pk_bf16_f32 v39, v90, v91
 v_mfma_f32_16x16x32_bf16 v[116:119], v[108:111], v[100:103], 0
 s_waitcnt vmcnt(0)
 v_mfma_f32_16x16x16_bf16 v[120:123], v[28:29], v[36:37], v[120:123]
L_pv_274:
 v_cmp_eq_u32 vcc, -1, v124
 s_cbranch_vccnz L_rt_275
 v_mfma_f32_16x16x16_bf16 v[112:115], v[124:125], v[36:37], v[112:115]
 v_mfma_f32_16x16x16_bf16 v[116:119], v[124:125], v[38:39], v[116:119]
 v_rcp_f32 v120, v120
 ds_read_b128 v[88:91], v15 offset:18432
 ds_read_b128 v[92:95], v15 offset:19456
 ds_read_b128 v[96:99], v15 offset:20480
 ds_read_b128 v[100:103], v15 offset:21504
 s_mov_b64 exec, s[28:29]
 v_pk_mul_f32 v[112:113], v[112:113], v[120:121] op_sel_hi:[1,0]
 v_pk_mul_f32 v[114:115], v[114:115], v[120:121] op_sel_hi:[1,0]
 v_cvt_pk_bf16_f32 v112, v112, v113
 v_cvt_pk_bf16_f32 v113, v114, v115
 v_pk_mul_f32 v[116:117], v[116:117], v[120:121] op_sel_hi:[1,0]
 v_pk_mul_f32 v[118:119], v[118:119], v[120:121] op_sel_hi:[1,0]
 v_cvt_pk_bf16_f32 v114, v116, v117
 v_cvt_pk_bf16_f32 v115, v118, v119
 ds_write_b128 v9, v[112:115] offset:30720
 s_mov_b64 exec, -1
 s_waitcnt lgkmcnt(0)
 s_barrier
 ds_read_b128 v[60:63], v0 offset:30720
 ds_read_b128 v[64:67], v0 offset:30752
 ds_read_b128 v[68:71], v0 offset:31744
 ds_read_b128 v[72:75], v0 offset:31776
 s_waitcnt lgkmcnt(3)
 v_smfmac_f32_16x16x64_bf16 v[40:43], v[60:63], v[224:231], v17
 ds_read_b128 v[224:227], v15 offset:22528
 v_smfmac_f32_16x16x64_bf16 v[44:47], v[60:63], v[232:239], v17
 ds_read_b128 v[228:231], v15 offset:23552
 s_waitcnt lgkmcnt(4)
 v_smfmac_f32_16x16x64_bf16 v[40:43], v[64:67], v[240:247], v17
 ds_read_b128 v[232:235], v15 offset:24576
 v_smfmac_f32_16x16x64_bf16 v[44:47], v[64:67], v[248:255], v17
 ds_read_b128 v[236:239], v15 offset:25600
 s_waitcnt lgkmcnt(5)
 v_smfmac_f32_16x16x64_bf16 v[40:43], v[68:71], v[80:87], v17
 ds_read_b128 v[240:243], v15 offset:26624
 v_smfmac_f32_16x16x64_bf16 v[44:47], v[68:71], v[128:135], v17
 ds_read_b128 v[244:247], v15 offset:27648
 s_waitcnt lgkmcnt(6)
 v_smfmac_f32_16x16x64_bf16 v[40:43], v[72:75], v[136:143], v17
 ds_read_b128 v[248:251], v15 offset:28672
 v_smfmac_f32_16x16x64_bf16 v[44:47], v[72:75], v[144:151], v17
 ds_read_b128 v[252:255], v15 offset:29696
 v_smfmac_f32_16x16x64_bf16 v[48:51], v[60:63], v[152:159], v17
 ds_read_b128 v[80:83], v15 offset:30720
 v_cvt_pk_bf16_f32 v116, v40, v41
 v_cvt_pk_bf16_f32 v117, v42, v43
 v_and_b32 v116, -2, v116
 v_smfmac_f32_16x16x64_bf16 v[52:55], v[60:63], v[160:167], v17
 ds_read_b128 v[84:87], v15 offset:31744
 v_cvt_pk_bf16_f32 v118, v44, v45
 v_cvt_pk_bf16_f32 v119, v46, v47
 v_and_b32 v118, -2, v118
 buffer_store_dwordx4 v[116:119], v10, s[4:7], s71 offen sc1
 v_smfmac_f32_16x16x64_bf16 v[48:51], v[64:67], v[168:175], v17
 v_smfmac_f32_16x16x64_bf16 v[52:55], v[64:67], v[176:183], v17
 v_smfmac_f32_16x16x64_bf16 v[48:51], v[68:71], v[184:191], v17
 v_smfmac_f32_16x16x64_bf16 v[52:55], v[68:71], v[88:95], v17
 v_smfmac_f32_16x16x64_bf16 v[48:51], v[72:75], v[96:103], v17
 s_waitcnt lgkmcnt(8)
 v_smfmac_f32_16x16x64_bf16 v[52:55], v[72:75], v[224:231], v17
 s_waitcnt lgkmcnt(6)
 v_smfmac_f32_16x16x64_bf16 v[56:59], v[60:63], v[232:239], v17
 v_cvt_pk_bf16_f32 v120, v48, v49
 v_cvt_pk_bf16_f32 v121, v50, v51
 v_and_b32 v120, -2, v120
 s_waitcnt lgkmcnt(4)
 v_smfmac_f32_16x16x64_bf16 v[56:59], v[64:67], v[240:247], v17
 v_cvt_pk_bf16_f32 v122, v52, v53
 v_cvt_pk_bf16_f32 v123, v54, v55
 v_and_b32 v122, -2, v122
 buffer_store_dwordx4 v[120:123], v10, s[4:7], s72 offen sc1
 s_waitcnt lgkmcnt(2)
 v_smfmac_f32_16x16x64_bf16 v[56:59], v[68:71], v[248:255], v17
 s_waitcnt lgkmcnt(0)
 v_smfmac_f32_16x16x64_bf16 v[56:59], v[72:75], v[80:87], v17
 s_nop 7
 v_cvt_pk_bf16_f32 v124, v56, v57
 v_cvt_pk_bf16_f32 v125, v58, v59
 v_and_b32 v124, -2, v124
 buffer_store_dwordx2 v[124:125], v10, s[4:7], s73 offen sc1
 ds_read_b128 v[224:227], v15 offset:0
 ds_read_b128 v[228:231], v15 offset:1024
 ds_read_b128 v[232:235], v15 offset:2048
 ds_read_b128 v[236:239], v15 offset:3072
 ds_read_b128 v[240:243], v15 offset:4096
 ds_read_b128 v[244:247], v15 offset:5120
 ds_read_b128 v[248:251], v15 offset:6144
 ds_read_b128 v[252:255], v15 offset:7168
 v_mov_b64 v[88:89], 0
 v_mov_b64 v[90:91], 0
 v_mov_b64 v[92:93], 0
 v_mov_b64 v[94:95], 0
 s_cmp_eq_u32 s55, 0
 s_cbranch_scc1 L_nr_276
 s_nop 15
 s_nop 15
 s_nop 15
 s_nop 15
 s_nop 15
L_pp_278:
 buffer_load_dwordx4 v[40:43], v1, s[4:7], s75 offen offset:0 sc1
 buffer_load_dwordx4 v[44:47], v1, s[4:7], s75 offen offset:1024 sc1
 buffer_load_dwordx4 v[48:51], v1, s[4:7], s75 offen offset:2048 sc1
 buffer_load_dwordx4 v[52:55], v1, s[4:7], s75 offen offset:3072 sc1
 s_waitcnt vmcnt(3)
 v_mfma_f32_16x16x32_bf16 v[56:59], v[40:43], v[20:23], 0
 v_or_b32 v14, v40, v42
 s_waitcnt vmcnt(2)
 v_mfma_f32_16x16x32_bf16 v[56:59], v[44:47], v[20:23], v[56:59]
 v_or3_b32 v14, v14, v44, v46
 s_waitcnt vmcnt(1)
 v_mfma_f32_16x16x32_bf16 v[56:59], v[48:51], v[20:23], v[56:59]
 v_or3_b32 v14, v14, v48, v50
 s_waitcnt vmcnt(0)
 v_mfma_f32_16x16x32_bf16 v[56:59], v[52:55], v[20:23], v[56:59]
 v_or3_b32 v14, v14, v52, v54
 v_and_b32 v14, 1, v14
 v_cmp_ne_u32 vcc, 0, v14
 s_cbranch_vccnz L_rt_279
 s_nop 2
 v_cvt_pk_bf16_f32 v60, v56, v57
 v_cvt_pk_bf16_f32 v61, v58, v59
 s_nop 0
 v_mov_b32_dpp v62, v60 quad_perm:[2,3,2,3] row_mask:0xf bank_mask:0xf
 v_mov_b32_dpp v63, v61 quad_perm:[2,3,2,3] row_mask:0xf bank_mask:0xf
 s_mov_b64 exec, s[30:31]
 buffer_store_dwordx4 v[60:63], v11, s[4:7], s56 offen sc1
 s_mov_b64 exec, 1
 buffer_store_dword v13, off, s[4:7], s17 sc1
 s_mov_b64 exec, s[30:31]
 buffer_store_dwordx4 v[32:35], v11, s[4:7], s58 offen sc1
 s_mov_b64 exec, -1
 s_barrier
 s_nop 15
 s_nop 15
 s_nop 15
 s_nop 15
 s_nop 15
 s_nop 15
 s_nop 15
L_rj_277:
 v_add_u32 v13, 1, v13
 s_add_u32 s53, s53, 1
 s_branch L_ch_loops
L_rt_249:
 s_nop 7
 buffer_load_dwordx4 v[40:43], v2, s[4:7], s56 offen offset:0 sc1
 buffer_load_dwordx4 v[44:47], v2, s[4:7], s56 offen offset:128 sc1
 buffer_load_dwordx4 v[48:51], v2, s[4:7], s56 offen offset:1024 sc1
 buffer_load_dwordx4 v[52:55], v2, s[4:7], s56 offen offset:1152 sc1
 buffer_load_dwordx4 v[56:59], v3, s[4:7], s56 offen offset:0 sc1
 s_add_u32 s51, s51, 1
 s_cmp_lt_u32 s51, 131072
 s_cbranch_scc1 L_xm_248
 s_branch L_bail
L_rt_251:
 buffer_load_dwordx2 v[124:125], v1, s[4:7], s64 offen sc1
 s_waitcnt vmcnt(0)
 s_add_u32 s51, s51, 1
 s_cmp_lt_u32 s51, 131072
 s_cbranch_scc1 L_pv_250
 s_branch L_bail
L_rt_255:
 s_add_u32 s51, s51, 1
 s_cmp_lt_u32 s51, 131072
 s_cbranch_scc1 L_pp_254
 s_branch L_bail
L_nr_252:
 s_cmp_lg_u32 s50, 0
 s_cbranch_scc1 L_id_280
 buffer_store_dwordx4 v[32:35], v1, s[4:7], s62 offen offset:0 sc1
 buffer_store_dwordx4 v[32:35], v1, s[4:7], s62 offen offset:1024 sc1
 buffer_store_dwordx4 v[32:35], v1, s[4:7], s62 offen offset:2048 sc1
 buffer_store_dwordx4 v[32:35], v1, s[4:7], s62 offen offset:3072 sc1
 buffer_load_dword v14, off, s[4:7], s32 sc1
 s_waitcnt vmcnt(0)
 s_barrier
 s_add_u32 s76, s53, 1
L_fl_281:
 v_cmp_ge_u32 vcc, s76, v14
 s_cbranch_vccz L_fld_282
 buffer_load_dword v14, off, s[4:7], s32 sc1
 s_waitcnt vmcnt(0)
 s_add_u32 s51, s51, 1
 s_cmp_lt_u32 s51, 131072
 s_cbranch_scc1 L_fl_281
 s_branch L_bail
L_fld_282:
 s_lshl_b32 s16, s76, 19
 s_add_u32 s16, s16, s54
 s_mov_b32 m0, 10240
 s_nop 0
 buffer_load_dwordx4 v1, s[4:7], s16 offen offset:0 sc1 lds
 buffer_load_dwordx4 v1, s[4:7], s16 offen offset:1024 sc1 lds
 buffer_load_dwordx4 v1, s[4:7], s16 offen offset:2048 sc1 lds
 buffer_load_dwordx4 v1, s[4:7], s16 offen offset:3072 sc1 lds
 s_mov_b32 m0, 14336
 s_nop 0
 buffer_load_dwordx4 v12, s[4:7], s16 offen offset:0 sc1 lds
 buffer_load_dwordx4 v12, s[4:7], s16 offen offset:1024 sc1 lds
 buffer_load_dwordx4 v12, s[4:7], s16 offen offset:2048 sc1 lds
 buffer_load_dwordx4 v12, s[4:7], s16 offen offset:3072 sc1 lds
 s_add_u32 s16, s16, 67108864
 s_mov_b32 m0, 18432
 s_nop 0
 buffer_load_dwordx4 v1, s[4:7], s16 offen offset:0 sc1 lds
 buffer_load_dwordx4 v1, s[4:7], s16 offen offset:1024 sc1 lds
 buffer_load_dwordx4 v1, s[4:7], s16 offen offset:2048 sc1 lds
 buffer_load_dwordx4 v1, s[4:7], s16 offen offset:3072 sc1 lds
 s_mov_b32 m0, 22528
 s_nop 0
 buffer_load_dwordx4 v12, s[4:7], s16 offen offset:0 sc1 lds
 buffer_load_dwordx4 v12, s[4:7], s16 offen offset:1024 sc1 lds
 buffer_load_dwordx4 v12, s[4:7], s16 offen offset:2048 sc1 lds
 buffer_load_dwordx4 v12, s[4:7], s16 offen offset:3072 sc1 lds
 s_nop 15
 s_nop 15
 s_branch L_rj_253
L_id_280:
 s_barrier
 s_nop 15
 s_nop 15
 s_nop 15
 s_nop 15
 s_nop 15
 s_nop 15
 s_nop 15
 s_branch L_rj_253
L_rt_257:
 s_nop 7
 buffer_load_dwordx4 v[40:43], v2, s[4:7], s57 offen offset:0 sc1
 buffer_load_dwordx4 v[44:47], v2, s[4:7], s57 offen offset:128 sc1
 buffer_load_dwordx4 v[48:51], v2, s[4:7], s57 offen offset:1024 sc1
 buffer_load_dwordx4 v[52:55], v2, s[4:7], s57 offen offset:1152 sc1
 buffer_load_dwordx4 v[56:59], v3, s[4:7], s57 offen offset:0 sc1
 s_add_u32 s51, s51, 1
 s_cmp_lt_u32 s51, 131072
 s_cbranch_scc1 L_xm_256
 s_branch L_bail
L_rt_259:
 buffer_load_dwordx2 v[124:125], v1, s[4:7], s65 offen sc1
 s_waitcnt vmcnt(0)
 s_add_u32 s51, s51, 1
 s_cmp_lt_u32 s51, 131072
 s_cbranch_scc1 L_pv_258
 s_branch L_bail
L_rt_263:
 s_add_u32 s51, s51, 1
 s_cmp_lt_u32 s51, 131072
 s_cbranch_scc1 L_pp_262
 s_branch L_bail
L_nr_260:
 s_cmp_lg_u32 s50, 0
 s_cbranch_scc1 L_id_283
 buffer_store_dwordx4 v[32:35], v1, s[4:7], s63 offen offset:0 sc1
 buffer_store_dwordx4 v[32:35], v1, s[4:7], s63 offen offset:1024 sc1
 buffer_store_dwordx4 v[32:35], v1, s[4:7], s63 offen offset:2048 sc1
 buffer_store_dwordx4 v[32:35], v1, s[4:7], s63 offen offset:3072 sc1
 buffer_load_dword v14, off, s[4:7], s32 sc1
 s_waitcnt vmcnt(0)
 s_barrier
 s_add_u32 s76, s53, 1
L_fl_284:
 v_cmp_ge_u32 vcc, s76, v14
 s_cbranch_vccz L_fld_285
 buffer_load_dword v14, off, s[4:7], s32 sc1
 s_waitcnt vmcnt(0)
 s_add_u32 s51, s51, 1
 s_cmp_lt_u32 s51, 131072
 s_cbranch_scc1 L_fl_284
 s_branch L_bail
L_fld_285:
 s_lshl_b32 s16, s76, 19
 s_add_u32 s16, s16, s54
 s_mov_b32 m0, 10240
 s_nop 0
 buffer_load_dwordx4 v1, s[4:7], s16 offen offset:0 sc1 lds
 buffer_load_dwordx4 v1, s[4:7], s16 offen offset:1024 sc1 lds
 buffer_load_dwordx4 v1, s[4:7], s16 offen offset:2048 sc1 lds
 buffer_load_dwordx4 v1, s[4:7], s16 offen offset:3072 sc1 lds
 s_mov_b32 m0, 14336
 s_nop 0
 buffer_load_dwordx4 v12, s[4:7], s16 offen offset:0 sc1 lds
 buffer_load_dwordx4 v12, s[4:7], s16 offen offset:1024 sc1 lds
 buffer_load_dwordx4 v12, s[4:7], s16 offen offset:2048 sc1 lds
 buffer_load_dwordx4 v12, s[4:7], s16 offen offset:3072 sc1 lds
 s_add_u32 s16, s16, 67108864
 s_mov_b32 m0, 18432
 s_nop 0
 buffer_load_dwordx4 v1, s[4:7], s16 offen offset:0 sc1 lds
 buffer_load_dwordx4 v1, s[4:7], s16 offen offset:1024 sc1 lds
 buffer_load_dwordx4 v1, s[4:7], s16 offen offset:2048 sc1 lds
 buffer_load_dwordx4 v1, s[4:7], s16 offen offset:3072 sc1 lds
 s_mov_b32 m0, 22528
 s_nop 0
 buffer_load_dwordx4 v12, s[4:7], s16 offen offset:0 sc1 lds
 buffer_load_dwordx4 v12, s[4:7], s16 offen offset:1024 sc1 lds
 buffer_load_dwordx4 v12, s[4:7], s16 offen offset:2048 sc1 lds
 buffer_load_dwordx4 v12, s[4:7], s16 offen offset:3072 sc1 lds
 s_nop 15
 s_nop 15
 s_branch L_rj_261
L_id_283:
 s_barrier
 s_nop 15
 s_nop 15
 s_nop 15
 s_nop 15
 s_nop 15
 s_nop 15
 s_nop 15
 s_branch L_rj_261
L_rt_265:
 s_nop 7
 buffer_load_dwordx4 v[40:43], v2, s[4:7], s58 offen offset:0 sc1
 buffer_load_dwordx4 v[44:47], v2, s[4:7], s58 offen offset:128 sc1
 buffer_load_dwordx4 v[48:51], v2, s[4:7], s58 offen offset:1024 sc1
 buffer_load_dwordx4 v[52:55], v2, s[4:7], s58 offen offset:1152 sc1
 buffer_load_dwordx4 v[56:59], v3, s[4:7], s58 offen offset:0 sc1
 s_add_u32 s51, s51, 1
 s_cmp_lt_u32 s51, 131072
 s_cbranch_scc1 L_xm_264
 s_branch L_bail
L_rt_267:
 buffer_load_dwordx2 v[124:125], v1, s[4:7], s66 offen sc1
 s_waitcnt vmcnt(0)
 s_add_u32 s51, s51, 1
 s_cmp_lt_u32 s51, 131072
 s_cbranch_scc1 L_pv_266
 s_branch L_bail
L_rt_271:
 s_add_u32 s51, s51, 1
 s_cmp_lt_u32 s51, 131072
 s_cbranch_scc1 L_pp_270
 s_branch L_bail
L_nr_268:
 s_cmp_lg_u32 s50, 0
 s_cbranch_scc1 L_id_286
 buffer_store_dwordx4 v[32:35], v1, s[4:7], s60 offen offset:0 sc1
 buffer_store_dwordx4 v[32:35], v1, s[4:7], s60 offen offset:1024 sc1
 buffer_store_dwordx4 v[32:35], v1, s[4:7], s60 offen offset:2048 sc1
 buffer_store_dwordx4 v[32:35], v1, s[4:7], s60 offen offset:3072 sc1
 buffer_load_dword v14, off, s[4:7], s32 sc1
 s_waitcnt vmcnt(0)
 s_barrier
 s_add_u32 s76, s53, 1
L_fl_287:
 v_cmp_ge_u32 vcc, s76, v14
 s_cbranch_vccz L_fld_288
 buffer_load_dword v14, off, s[4:7], s32 sc1
 s_waitcnt vmcnt(0)
 s_add_u32 s51, s51, 1
 s_cmp_lt_u32 s51, 131072
 s_cbranch_scc1 L_fl_287
 s_branch L_bail
L_fld_288:
 s_lshl_b32 s16, s76, 19
 s_add_u32 s16, s16, s54
 s_mov_b32 m0, 10240
 s_nop 0
 buffer_load_dwordx4 v1, s[4:7], s16 offen offset:0 sc1 lds
 buffer_load_dwordx4 v1, s[4:7], s16 offen offset:1024 sc1 lds
 buffer_load_dwordx4 v1, s[4:7], s16 offen offset:2048 sc1 lds
 buffer_load_dwordx4 v1, s[4:7], s16 offen offset:3072 sc1 lds
 s_mov_b32 m0, 14336
 s_nop 0
 buffer_load_dwordx4 v12, s[4:7], s16 offen offset:0 sc1 lds
 buffer_load_dwordx4 v12, s[4:7], s16 offen offset:1024 sc1 lds
 buffer_load_dwordx4 v12, s[4:7], s16 offen offset:2048 sc1 lds
 buffer_load_dwordx4 v12, s[4:7], s16 offen offset:3072 sc1 lds
 s_add_u32 s16, s16, 67108864
 s_mov_b32 m0, 18432
 s_nop 0
 buffer_load_dwordx4 v1, s[4:7], s16 offen offset:0 sc1 lds
 buffer_load_dwordx4 v1, s[4:7], s16 offen offset:1024 sc1 lds
 buffer_load_dwordx4 v1, s[4:7], s16 offen offset:2048 sc1 lds
 buffer_load_dwordx4 v1, s[4:7], s16 offen offset:3072 sc1 lds
 s_mov_b32 m0, 22528
 s_nop 0
 buffer_load_dwordx4 v12, s[4:7], s16 offen offset:0 sc1 lds
 buffer_load_dwordx4 v12, s[4:7], s16 offen offset:1024 sc1 lds
 buffer_load_dwordx4 v12, s[4:7], s16 offen offset:2048 sc1 lds
 buffer_load_dwordx4 v12, s[4:7], s16 offen offset:3072 sc1 lds
 s_nop 15
 s_nop 15
 s_branch L_rj_269
L_id_286:
 s_barrier
 s_nop 15
 s_nop 15
 s_nop 15
 s_nop 15
 s_nop 15
 s_nop 15
 s_nop 15
 s_branch L_rj_269
L_rt_273:
 s_nop 7
 buffer_load_dwordx4 v[40:43], v2, s[4:7], s59 offen offset:0 sc1
 buffer_load_dwordx4 v[44:47], v2, s[4:7], s59 offen offset:128 sc1
 buffer_load_dwordx4 v[48:51], v2, s[4:7], s59 offen offset:1024 sc1
 buffer_load_dwordx4 v[52:55], v2, s[4:7], s59 offen offset:1152 sc1
 buffer_load_dwordx4 v[56:59], v3, s[4:7], s59 offen offset:0 sc1
 s_add_u32 s51, s51, 1
 s_cmp_lt_u32 s51, 131072
 s_cbranch_scc1 L_xm_272
 s_branch L_bail
L_rt_275:
 buffer_load_dwordx2 v[124:125], v1, s[4:7], s67 offen sc1
 s_waitcnt vmcnt(0)
 s_add_u32 s51, s51, 1
 s_cmp_lt_u32 s51, 131072
 s_cbranch_scc1 L_pv_274
 s_branch L_bail
L_rt_279:
 s_add_u32 s51, s51, 1
 s_cmp_lt_u32 s51, 131072
 s_cbranch_scc1 L_pp_278
 s_branch L_bail
L_nr_276:
 s_cmp_lg_u32 s50, 0
 s_cbranch_scc1 L_id_289
 buffer_store_dwordx4 v[32:35], v1, s[4:7], s61 offen offset:0 sc1
 buffer_store_dwordx4 v[32:35], v1, s[4:7], s61 offen offset:1024 sc1
 buffer_store_dwordx4 v[32:35], v1, s[4:7], s61 offen offset:2048 sc1
 buffer_store_dwordx4 v[32:35], v1, s[4:7], s61 offen offset:3072 sc1
 buffer_load_dword v14, off, s[4:7], s32 sc1
 s_waitcnt vmcnt(0)
 s_barrier
 s_add_u32 s76, s53, 1
L_fl_290:
 v_cmp_ge_u32 vcc, s76, v14
 s_cbranch_vccz L_fld_291
 buffer_load_dword v14, off, s[4:7], s32 sc1
 s_waitcnt vmcnt(0)
 s_add_u32 s51, s51, 1
 s_cmp_lt_u32 s51, 131072
 s_cbranch_scc1 L_fl_290
 s_branch L_bail
L_fld_291:
 s_lshl_b32 s16, s76, 19
 s_add_u32 s16, s16, s54
 s_mov_b32 m0, 10240
 s_nop 0
 buffer_load_dwordx4 v1, s[4:7], s16 offen offset:0 sc1 lds
 buffer_load_dwordx4 v1, s[4:7], s16 offen offset:1024 sc1 lds
 buffer_load_dwordx4 v1, s[4:7], s16 offen offset:2048 sc1 lds
 buffer_load_dwordx4 v1, s[4:7], s16 offen offset:3072 sc1 lds
 s_mov_b32 m0, 14336
 s_nop 0
 buffer_load_dwordx4 v12, s[4:7], s16 offen offset:0 sc1 lds
 buffer_load_dwordx4 v12, s[4:7], s16 offen offset:1024 sc1 lds
 buffer_load_dwordx4 v12, s[4:7], s16 offen offset:2048 sc1 lds
 buffer_load_dwordx4 v12, s[4:7], s16 offen offset:3072 sc1 lds
 s_add_u32 s16, s16, 67108864
 s_mov_b32 m0, 18432
 s_nop 0
 buffer_load_dwordx4 v1, s[4:7], s16 offen offset:0 sc1 lds
 buffer_load_dwordx4 v1, s[4:7], s16 offen offset:1024 sc1 lds
 buffer_load_dwordx4 v1, s[4:7], s16 offen offset:2048 sc1 lds
 buffer_load_dwordx4 v1, s[4:7], s16 offen offset:3072 sc1 lds
 s_mov_b32 m0, 22528
 s_nop 0
 buffer_load_dwordx4 v12, s[4:7], s16 offen offset:0 sc1 lds
 buffer_load_dwordx4 v12, s[4:7], s16 offen offset:1024 sc1 lds
 buffer_load_dwordx4 v12, s[4:7], s16 offen offset:2048 sc1 lds
 buffer_load_dwordx4 v12, s[4:7], s16 offen offset:3072 sc1 lds
 s_nop 15
 s_nop 15
 s_branch L_rj_277
L_id_289:
 s_barrier
 s_nop 15
 s_nop 15
 s_nop 15
 s_nop 15
 s_nop 15
 s_nop 15
 s_nop 15
 s_branch L_rj_277
L_ch_last:
 s_endpgm
L_vr:
 s_and_b32 s3, s48, 1
 s_lshl_b32 s3, s3, 3
 s_add_u32 s52, s3, s49
 s_sub_u32 s52, s52, 16
 s_lshl_b32 s52, s52, 1
 s_lshr_b32 s3, s48, 1
 s_lshl_b32 s3, s3, 5
 s_add_u32 s17, s3, s52
 s_lshl_b32 s17, s17, 8
 s_add_u32 s17, s17, 128
 s_lshr_b32 s3, s50, 1
 s_add_u32 s52, s52, s3
 s_mov_b32 s8, s24
 s_and_b32 s9, s25, 0xffff
 s_mov_b32 s10, 5242880
 s_mov_b32 s11, 0x00020000
 v_lshrrev_b32 v2, 4, v0
 v_and_b32 v7, 1, v2
 v_lshlrev_b32 v7, 1, v7
 v_xor_b32 v7, v7, v0
 s_and_b32 s3, s50, 1
 s_lshl_b32 s3, s3, 3
 v_xor_b32 v7, s3, v7
 v_and_b32 v7, 15, v7
 s_mov_b32 s3, 8192
 v_mul_lo_u32 v2, v2, s3
 v_lshl_add_u32 v2, v7, 4, v2
 v_xor_b32 v3, 64, v2
 s_and_b32 s3, s50, 1
 s_mul_i32 s76, s3, 262144
 s_lshl_b32 s3, s52, 8
 s_add_u32 s76, s76, s3
 s_lshl_b32 s64, s50, 13
 s_add_u32 m0, s64, 0
 s_nop 0
 buffer_load_dwordx4 v2, s[8:11], s76 offen lds
 s_add_u32 s76, s76, 32768
 s_add_u32 m0, s64, 1024
 s_nop 0
 buffer_load_dwordx4 v2, s[8:11], s76 offen lds
 s_add_u32 s76, s76, 32768
 s_add_u32 m0, s64, 2048
 s_nop 0
 buffer_load_dwordx4 v3, s[8:11], s76 offen lds
 s_add_u32 s76, s76, 32768
 s_add_u32 m0, s64, 3072
 s_nop 0
 buffer_load_dwordx4 v3, s[8:11], s76 offen lds
 s_add_u32 s76, s76, 32768
 s_add_u32 m0, s64, 4096
 s_nop 0
 buffer_load_dwordx4 v2, s[8:11], s76 offen lds
 s_add_u32 s76, s76, 32768
 s_add_u32 m0, s64, 5120
 s_nop 0
 buffer_load_dwordx4 v2, s[8:11], s76 offen lds
 s_add_u32 s76, s76, 32768
 s_add_u32 m0, s64, 6144
 s_nop 0
 buffer_load_dwordx4 v3, s[8:11], s76 offen lds
 s_add_u32 s76, s76, 32768
 s_add_u32 m0, s64, 7168
 s_nop 0
 buffer_load_dwordx4 v3, s[8:11], s76 offen lds
 s_add_u32 s76, s76, 294912
 s_add_u32 m0, s64, 32768
 s_nop 0
 buffer_load_dwordx4 v2, s[8:11], s76 offen lds
 s_add_u32 s76, s76, 32768
 s_add_u32 m0, s64, 33792
 s_nop 0
 buffer_load_dwordx4 v2, s[8:11], s76 offen lds
 s_add_u32 s76, s76, 32768
 s_add_u32 m0, s64, 34816
 s_nop 0
 buffer_load_dwordx4 v3, s[8:11], s76 offen lds
 s_add_u32 s76, s76, 32768
 s_add_u32 m0, s64, 35840
 s_nop 0
 buffer_load_dwordx4 v3, s[8:11], s76 offen lds
 s_add_u32 s76, s76, 32768
 s_add_u32 m0, s64, 36864
 s_nop 0
 buffer_load_dwordx4 v2, s[8:11], s76 offen lds
 s_add_u32 s76, s76, 32768
 s_add_u32 m0, s64, 37888
 s_nop 0
 buffer_load_dwordx4 v2, s[8:11], s76 offen lds
 s_add_u32 s76, s76, 32768
 s_add_u32 m0, s64, 38912
 s_nop 0
 buffer_load_dwordx4 v3, s[8:11], s76 offen lds
 s_add_u32 s76, s76, 32768
 s_add_u32 m0, s64, 39936
 s_nop 0
 buffer_load_dwordx4 v3, s[8:11], s76 offen lds
 s_add_u32 s76, s76, 294912
 s_add_u32 m0, s64, 65536
 s_nop 0
 buffer_load_dwordx4 v2, s[8:11], s76 offen lds
 s_add_u32 s76, s76, 32768
 s_add_u32 m0, s64, 66560
 s_nop 0
 buffer_load_dwordx4 v2, s[8:11], s76 offen lds
 s_add_u32 s76, s76, 32768
 s_add_u32 m0, s64, 67584
 s_nop 0
 buffer_load_dwordx4 v3, s[8:11], s76 offen lds
 s_add_u32 s76, s76, 32768
 s_add_u32 m0, s64, 68608
 s_nop 0
 buffer_load_dwordx4 v3, s[8:11], s76 offen lds
 s_add_u32 s76, s76, 32768
 s_add_u32 m0, s64, 69632
 s_nop 0
 buffer_load_dwordx4 v2, s[8:11], s76 offen lds
 s_add_u32 s76, s76, 32768
 s_add_u32 m0, s64, 70656
 s_nop 0
 buffer_load_dwordx4 v2, s[8:11], s76 offen lds
 s_add_u32 s76, s76, 32768
 s_add_u32 m0, s64, 71680
 s_nop 0
 buffer_load_dwordx4 v3, s[8:11], s76 offen lds
 s_add_u32 s76, s76, 32768
 s_add_u32 m0, s64, 72704
 s_nop 0
 buffer_load_dwordx4 v3, s[8:11], s76 offen lds
 s_add_u32 s76, s76, 294912
 s_add_u32 m0, s64, 98304
 s_nop 0
 buffer_load_dwordx4 v2, s[8:11], s76 offen lds
 s_add_u32 s76, s76, 32768
 s_add_u32 m0, s64, 99328
 s_nop 0
 buffer_load_dwordx4 v2, s[8:11], s76 offen lds
 s_add_u32 s76, s76, 32768
 s_add_u32 m0, s64, 100352
 s_nop 0
 buffer_load_dwordx4 v3, s[8:11], s76 offen lds
 s_add_u32 s76, s76, 32768
 s_add_u32 m0, s64, 101376
 s_nop 0
 buffer_load_dwordx4 v3, s[8:11], s76 offen lds
 s_add_u32 s76, s76, 32768
 s_add_u32 m0, s64, 102400
 s_nop 0
 buffer_load_dwordx4 v2, s[8:11], s76 offen lds
 s_add_u32 s76, s76, 32768
 s_add_u32 m0, s64, 103424
 s_nop 0
 buffer_load_dwordx4 v2, s[8:11], s76 offen lds
 s_add_u32 s76, s76, 32768
 s_add_u32 m0, s64, 104448
 s_nop 0
 buffer_load_dwordx4 v3, s[8:11], s76 offen lds
 s_add_u32 s76, s76, 32768
 s_add_u32 m0, s64, 105472
 s_nop 0
 buffer_load_dwordx4 v3, s[8:11], s76 offen lds
 s_add_u32 s76, s76, 294912
 s_add_u32 m0, s64, 131072
 s_nop 0
 buffer_load_dwordx4 v2, s[8:11], s76 offen lds
 s_add_u32 s76, s76, 32768
 s_add_u32 m0, s64, 132096
 s_nop 0
 buffer_load_dwordx4 v2, s[8:11], s76 offen lds
 s_add_u32 s76, s76, 32768
 s_add_u32 m0, s64, 133120
 s_nop 0
 buffer_load_dwordx4 v3, s[8:11], s76 offen lds
 s_add_u32 s76, s76, 32768
 s_add_u32 m0, s64, 134144
 s_nop 0
 buffer_load_dwordx4 v3, s[8:11], s76 offen lds
 s_add_u32 s76, s76, 32768
 s_add_u32 m0, s64, 135168
 s_nop 0
 buffer_load_dwordx4 v2, s[8:11], s76 offen lds
 s_add_u32 s76, s76, 32768
 s_add_u32 m0, s64, 136192
 s_nop 0
 buffer_load_dwordx4 v2, s[8:11], s76 offen lds
 s_add_u32 s76, s76, 32768
 s_add_u32 m0, s64, 137216
 s_nop 0
 buffer_load_dwordx4 v3, s[8:11], s76 offen lds
 s_add_u32 s76, s76, 32768
 s_add_u32 m0, s64, 138240
 s_nop 0
 buffer_load_dwordx4 v3, s[8:11], s76 offen lds
 s_add_u32 s76, s76, 294912
 v_bfe_u32 v7, v0, 2, 1
 v_lshlrev_b32 v20, 8, v7
 v_lshl_add_u32 v20, v7, 5, v20
 v_bfe_u32 v7, v0, 4, 1
 v_lshl_add_u32 v20, v7, 11, v20
 v_lshl_add_u32 v20, v7, 6, v20
 v_bfe_u32 v7, v0, 5, 1
 v_lshl_add_u32 v20, v7, 12, v20
 v_and_b32 v7, 3, v0
 v_lshl_add_u32 v20, v7, 3, v20
 v_bfe_u32 v7, v0, 3, 1
 v_mul_u32_u24 v7, 32, v7
 v_xor_b32 v20, v20, v7
 s_and_b32 s3, s50, 1
 s_lshl_b32 s3, s3, 7
 v_xor_b32 v20, s3, v20
 s_lshr_b32 s3, s50, 1
 s_lshl_b32 s3, s3, 14
 v_add_u32 v20, s3, v20
 v_xor_b32 v21, 64, v20
 v_xor_b32 v22, 8320, v20
 v_xor_b32 v23, 8384, v20
 s_waitcnt vmcnt(32)
 s_barrier
 v_add_u32 v24, 0, v20
 v_add_u32 v25, 0, v21
 v_add_u32 v26, 0, v22
 v_add_u32 v27, 0, v23
 ds_read_b64_tr_b16 v[192:193], v24 offset:0
 ds_read_b64_tr_b16 v[194:195], v24 offset:512
 ds_read_b64_tr_b16 v[196:197], v24 offset:1024
 ds_read_b64_tr_b16 v[198:199], v24 offset:1536
 ds_read_b64_tr_b16 v[200:201], v25 offset:0
 ds_read_b64_tr_b16 v[202:203], v25 offset:512
 ds_read_b64_tr_b16 v[204:205], v25 offset:1024
 ds_read_b64_tr_b16 v[206:207], v25 offset:1536
 ds_read_b64_tr_b16 v[208:209], v26 offset:0
 ds_read_b64_tr_b16 v[210:211], v26 offset:512
 ds_read_b64_tr_b16 v[212:213], v26 offset:1024
 ds_read_b64_tr_b16 v[214:215], v26 offset:1536
 ds_read_b64_tr_b16 v[216:217], v27 offset:0
 ds_read_b64_tr_b16 v[218:219], v27 offset:512
 ds_read_b64_tr_b16 v[220:221], v27 offset:1024
 ds_read_b64_tr_b16 v[222:223], v27 offset:1536
 s_waitcnt lgkmcnt(0)
 s_barrier
 s_add_u32 m0, s64, 0
 s_nop 0
 buffer_load_dwordx4 v2, s[8:11], s76 offen lds
 s_add_u32 s76, s76, 32768
 s_add_u32 m0, s64, 1024
 s_nop 0
 buffer_load_dwordx4 v2, s[8:11], s76 offen lds
 s_add_u32 s76, s76, 32768
 s_add_u32 m0, s64, 2048
 s_nop 0
 buffer_load_dwordx4 v3, s[8:11], s76 offen lds
 s_add_u32 s76, s76, 32768
 s_add_u32 m0, s64, 3072
 s_nop 0
 buffer_load_dwordx4 v3, s[8:11], s76 offen lds
 s_add_u32 s76, s76, 32768
 s_add_u32 m0, s64, 4096
 s_nop 0
 buffer_load_dwordx4 v2, s[8:11], s76 offen lds
 s_add_u32 s76, s76, 32768
 s_add_u32 m0, s64, 5120
 s_nop 0
 buffer_load_dwordx4 v2, s[8:11], s76 offen lds
 s_add_u32 s76, s76, 32768
 s_add_u32 m0, s64, 6144
 s_nop 0
 buffer_load_dwordx4 v3, s[8:11], s76 offen lds
 s_add_u32 s76, s76, 32768
 s_add_u32 m0, s64, 7168
 s_nop 0
 buffer_load_dwordx4 v3, s[8:11], s76 offen lds
 s_add_u32 s76, s76, 294912
 s_waitcnt vmcnt(32)
 s_barrier
 v_add_u32 v24, 32768, v20
 v_add_u32 v25, 32768, v21
 v_add_u32 v26, 32768, v22
 v_add_u32 v27, 32768, v23
 ds_read_b64_tr_b16 v[224:225], v24 offset:0
 ds_read_b64_tr_b16 v[226:227], v24 offset:512
 ds_read_b64_tr_b16 v[228:229], v24 offset:1024
 ds_read_b64_tr_b16 v[230:231], v24 offset:1536
 ds_read_b64_tr_b16 v[232:233], v25 offset:0
 ds_read_b64_tr_b16 v[234:235], v25 offset:512
 ds_read_b64_tr_b16 v[236:237], v25 offset:1024
 ds_read_b64_tr_b16 v[238:239], v25 offset:1536
 ds_read_b64_tr_b16 v[240:241], v26 offset:0
 ds_read_b64_tr_b16 v[242:243], v26 offset:512
 ds_read_b64_tr_b16 v[244:245], v26 offset:1024
 ds_read_b64_tr_b16 v[246:247], v26 offset:1536
 ds_read_b64_tr_b16 v[248:249], v27 offset:0
 ds_read_b64_tr_b16 v[250:251], v27 offset:512
 ds_read_b64_tr_b16 v[252:253], v27 offset:1024
 ds_read_b64_tr_b16 v[254:255], v27 offset:1536
 s_waitcnt lgkmcnt(0)
 s_barrier
 s_add_u32 m0, s64, 32768
 s_nop 0
 buffer_load_dwordx4 v2, s[8:11], s76 offen lds
 s_add_u32 s76, s76, 32768
 s_add_u32 m0, s64, 33792
 s_nop 0
 buffer_load_dwordx4 v2, s[8:11], s76 offen lds
 s_add_u32 s76, s76, 32768
 s_add_u32 m0, s64, 34816
 s_nop 0
 buffer_load_dwordx4 v3, s[8:11], s76 offen lds
 s_add_u32 s76, s76, 32768
 s_add_u32 m0, s64, 35840
 s_nop 0
 buffer_load_dwordx4 v3, s[8:11], s76 offen lds
 s_add_u32 s76, s76, 32768
 s_add_u32 m0, s64, 36864
 s_nop 0
 buffer_load_dwordx4 v2, s[8:11], s76 offen lds
 s_add_u32 s76, s76, 32768
 s_add_u32 m0, s64, 37888
 s_nop 0
 buffer_load_dwordx4 v2, s[8:11], s76 offen lds
 s_add_u32 s76, s76, 32768
 s_add_u32 m0, s64, 38912
 s_nop 0
 buffer_load_dwordx4 v3, s[8:11], s76 offen lds
 s_add_u32 s76, s76, 32768
 s_add_u32 m0, s64, 39936
 s_nop 0
 buffer_load_dwordx4 v3, s[8:11], s76 offen lds
 s_add_u32 s76, s76, 294912
 s_waitcnt vmcnt(32)
 s_barrier
 v_add_u32 v24, 65536, v20
 v_add_u32 v25, 65536, v21
 v_add_u32 v26, 65536, v22
 v_add_u32 v27, 65536, v23
 ds_read_b64_tr_b16 a[0:1], v24 offset:0
 ds_read_b64_tr_b16 a[2:3], v24 offset:512
 ds_read_b64_tr_b16 a[4:5], v24 offset:1024
 ds_read_b64_tr_b16 a[6:7], v24 offset:1536
 ds_read_b64_tr_b16 a[8:9], v25 offset:0
 ds_read_b64_tr_b16 a[10:11], v25 offset:512
 ds_read_b64_tr_b16 a[12:13], v25 offset:1024
 ds_read_b64_tr_b16 a[14:15], v25 offset:1536
 ds_read_b64_tr_b16 a[16:17], v26 offset:0
 ds_read_b64_tr_b16 a[18:19], v26 offset:512
 ds_read_b64_tr_b16 a[20:21], v26 offset:1024
 ds_read_b64_tr_b16 a[22:23], v26 offset:1536
 ds_read_b64_tr_b16 a[24:25], v27 offset:0
 ds_read_b64_tr_b16 a[26:27], v27 offset:512
 ds_read_b64_tr_b16 a[28:29], v27 offset:1024
 ds_read_b64_tr_b16 a[30:31], v27 offset:1536
 s_waitcnt lgkmcnt(0)
 s_barrier
 s_add_u32 m0, s64, 65536
 s_nop 0
 buffer_load_dwordx4 v2, s[8:11], s76 offen lds
 s_add_u32 s76, s76, 32768
 s_add_u32 m0, s64, 66560
 s_nop 0
 buffer_load_dwordx4 v2, s[8:11], s76 offen lds
 s_add_u32 s76, s76, 32768
 s_add_u32 m0, s64, 67584
 s_nop 0
 buffer_load_dwordx4 v3, s[8:11], s76 offen lds
 s_add_u32 s76, s76, 32768
 s_add_u32 m0, s64, 68608
 s_nop 0
 buffer_load_dwordx4 v3, s[8:11], s76 offen lds
 s_add_u32 s76, s76, 32768
 s_add_u32 m0, s64, 69632
 s_nop 0
 buffer_load_dwordx4 v2, s[8:11], s76 offen lds
 s_add_u32 s76, s76, 32768
 s_add_u32 m0, s64, 70656
 s_nop 0
 buffer_load_dwordx4 v2, s[8:11], s76 offen lds
 s_add_u32 s76, s76, 32768
 s_add_u32 m0, s64, 71680
 s_nop 0
 buffer_load_dwordx4 v3, s[8:11], s76 offen lds
 s_add_u32 s76, s76, 32768
 s_add_u32 m0, s64, 72704
 s_nop 0
 buffer_load_dwordx4 v3, s[8:11], s76 offen lds
 s_add_u32 s76, s76, 294912
 s_waitcnt vmcnt(32)
 s_barrier
 v_add_u32 v24, 98304, v20
 v_add_u32 v25, 98304, v21
 v_add_u32 v26, 98304, v22
 v_add_u32 v27, 98304, v23
 ds_read_b64_tr_b16 a[32:33], v24 offset:0
 ds_read_b64_tr_b16 a[34:35], v24 offset:512
 ds_read_b64_tr_b16 a[36:37], v24 offset:1024
 ds_read_b64_tr_b16 a[38:39], v24 offset:1536
 ds_read_b64_tr_b16 a[40:41], v25 offset:0
 ds_read_b64_tr_b16 a[42:43], v25 offset:512
 ds_read_b64_tr_b16 a[44:45], v25 offset:1024
 ds_read_b64_tr_b16 a[46:47], v25 offset:1536
 ds_read_b64_tr_b16 a[48:49], v26 offset:0
 ds_read_b64_tr_b16 a[50:51], v26 offset:512
 ds_read_b64_tr_b16 a[52:53], v26 offset:1024
 ds_read_b64_tr_b16 a[54:55], v26 offset:1536
 ds_read_b64_tr_b16 a[56:57], v27 offset:0
 ds_read_b64_tr_b16 a[58:59], v27 offset:512
 ds_read_b64_tr_b16 a[60:61], v27 offset:1024
 ds_read_b64_tr_b16 a[62:63], v27 offset:1536
 s_waitcnt lgkmcnt(0)
 s_barrier
 s_add_u32 m0, s64, 98304
 s_nop 0
 buffer_load_dwordx4 v2, s[8:11], s76 offen lds
 s_add_u32 s76, s76, 32768
 s_add_u32 m0, s64, 99328
 s_nop 0
 buffer_load_dwordx4 v2, s[8:11], s76 offen lds
 s_add_u32 s76, s76, 32768
 s_add_u32 m0, s64, 100352
 s_nop 0
 buffer_load_dwordx4 v3, s[8:11], s76 offen lds
 s_add_u32 s76, s76, 32768
 s_add_u32 m0, s64, 101376
 s_nop 0
 buffer_load_dwordx4 v3, s[8:11], s76 offen lds
 s_add_u32 s76, s76, 32768
 s_add_u32 m0, s64, 102400
 s_nop 0
 buffer_load_dwordx4 v2, s[8:11], s76 offen lds
 s_add_u32 s76, s76, 32768
 s_add_u32 m0, s64, 103424
 s_nop 0
 buffer_load_dwordx4 v2, s[8:11], s76 offen lds
 s_add_u32 s76, s76, 32768
 s_add_u32 m0, s64, 104448
 s_nop 0
 buffer_load_dwordx4 v3, s[8:11], s76 offen lds
 s_add_u32 s76, s76, 32768
 s_add_u32 m0, s64, 105472
 s_nop 0
 buffer_load_dwordx4 v3, s[8:11], s76 offen lds
 s_add_u32 s76, s76, 294912
 s_waitcnt vmcnt(32)
 s_barrier
 v_add_u32 v24, 131072, v20
 v_add_u32 v25, 131072, v21
 v_add_u32 v26, 131072, v22
 v_add_u32 v27, 131072, v23
 ds_read_b64_tr_b16 a[64:65], v24 offset:0
 ds_read_b64_tr_b16 a[66:67], v24 offset:512
 ds_read_b64_tr_b16 a[68:69], v24 offset:1024
 ds_read_b64_tr_b16 a[70:71], v24 offset:1536
 ds_read_b64_tr_b16 a[72:73], v25 offset:0
 ds_read_b64_tr_b16 a[74:75], v25 offset:512
 ds_read_b64_tr_b16 a[76:77], v25 offset:1024
 ds_read_b64_tr_b16 a[78:79], v25 offset:1536
 ds_read_b64_tr_b16 a[80:81], v26 offset:0
 ds_read_b64_tr_b16 a[82:83], v26 offset:512
 ds_read_b64_tr_b16 a[84:85], v26 offset:1024
 ds_read_b64_tr_b16 a[86:87], v26 offset:1536
 ds_read_b64_tr_b16 a[88:89], v27 offset:0
 ds_read_b64_tr_b16 a[90:91], v27 offset:512
 ds_read_b64_tr_b16 a[92:93], v27 offset:1024
 ds_read_b64_tr_b16 a[94:95], v27 offset:1536
 s_waitcnt lgkmcnt(0)
 s_barrier
 s_add_u32 m0, s64, 131072
 s_nop 0
 buffer_load_dwordx4 v2, s[8:11], s76 offen lds
 s_add_u32 s76, s76, 32768
 s_add_u32 m0, s64, 132096
 s_nop 0
 buffer_load_dwordx4 v2, s[8:11], s76 offen lds
 s_add_u32 s76, s76, 32768
 s_add_u32 m0, s64, 133120
 s_nop 0
 buffer_load_dwordx4 v3, s[8:11], s76 offen lds
 s_add_u32 s76, s76, 32768
 s_add_u32 m0, s64, 134144
 s_nop 0
 buffer_load_dwordx4 v3, s[8:11], s76 offen lds
 s_add_u32 s76, s76, 32768
 s_add_u32 m0, s64, 135168
 s_nop 0
 buffer_load_dwordx4 v2, s[8:11], s76 offen lds
 s_add_u32 s76, s76, 32768
 s_add_u32 m0, s64, 136192
 s_nop 0
 buffer_load_dwordx4 v2, s[8:11], s76 offen lds
 s_add_u32 s76, s76, 32768
 s_add_u32 m0, s64, 137216
 s_nop 0
 buffer_load_dwordx4 v3, s[8:11], s76 offen lds
 s_add_u32 s76, s76, 32768
 s_add_u32 m0, s64, 138240
 s_nop 0
 buffer_load_dwordx4 v3, s[8:11], s76 offen lds
 s_add_u32 s76, s76, 294912
 s_waitcnt vmcnt(32)
 s_barrier
 v_add_u32 v24, 0, v20
 v_add_u32 v25, 0, v21
 v_add_u32 v26, 0, v22
 v_add_u32 v27, 0, v23
 ds_read_b64_tr_b16 a[96:97], v24 offset:0
 ds_read_b64_tr_b16 a[98:99], v24 offset:512
 ds_read_b64_tr_b16 a[100:101], v24 offset:1024
 ds_read_b64_tr_b16 a[102:103], v24 offset:1536
 ds_read_b64_tr_b16 a[104:105], v25 offset:0
 ds_read_b64_tr_b16 a[106:107], v25 offset:512
 ds_read_b64_tr_b16 a[108:109], v25 offset:1024
 ds_read_b64_tr_b16 a[110:111], v25 offset:1536
 ds_read_b64_tr_b16 a[112:113], v26 offset:0
 ds_read_b64_tr_b16 a[114:115], v26 offset:512
 ds_read_b64_tr_b16 a[116:117], v26 offset:1024
 ds_read_b64_tr_b16 a[118:119], v26 offset:1536
 ds_read_b64_tr_b16 a[120:121], v27 offset:0
 ds_read_b64_tr_b16 a[122:123], v27 offset:512
 ds_read_b64_tr_b16 a[124:125], v27 offset:1024
 ds_read_b64_tr_b16 a[126:127], v27 offset:1536
 s_waitcnt lgkmcnt(0)
 s_waitcnt vmcnt(24)
 s_barrier
 v_add_u32 v24, 32768, v20
 v_add_u32 v25, 32768, v21
 v_add_u32 v26, 32768, v22
 v_add_u32 v27, 32768, v23
 ds_read_b64_tr_b16 a[128:129], v24 offset:0
 ds_read_b64_tr_b16 a[130:131], v24 offset:512
 ds_read_b64_tr_b16 a[132:133], v24 offset:1024
 ds_read_b64_tr_b16 a[134:135], v24 offset:1536
 ds_read_b64_tr_b16 a[136:137], v25 offset:0
 ds_read_b64_tr_b16 a[138:139], v25 offset:512
 ds_read_b64_tr_b16 a[140:141], v25 offset:1024
 ds_read_b64_tr_b16 a[142:143], v25 offset:1536
 ds_read_b64_tr_b16 a[144:145], v26 offset:0
 ds_read_b64_tr_b16 a[146:147], v26 offset:512
 ds_read_b64_tr_b16 a[148:149], v26 offset:1024
 ds_read_b64_tr_b16 a[150:151], v26 offset:1536
 ds_read_b64_tr_b16 a[152:153], v27 offset:0
 ds_read_b64_tr_b16 a[154:155], v27 offset:512
 ds_read_b64_tr_b16 a[156:157], v27 offset:1024
 ds_read_b64_tr_b16 a[158:159], v27 offset:1536
 s_waitcnt lgkmcnt(0)
 s_waitcnt vmcnt(16)
 s_barrier
 v_add_u32 v24, 65536, v20
 v_add_u32 v25, 65536, v21
 v_add_u32 v26, 65536, v22
 v_add_u32 v27, 65536, v23
 ds_read_b64_tr_b16 a[160:161], v24 offset:0
 ds_read_b64_tr_b16 a[162:163], v24 offset:512
 ds_read_b64_tr_b16 a[164:165], v24 offset:1024
 ds_read_b64_tr_b16 a[166:167], v24 offset:1536
 ds_read_b64_tr_b16 a[168:169], v25 offset:0
 ds_read_b64_tr_b16 a[170:171], v25 offset:512
 ds_read_b64_tr_b16 a[172:173], v25 offset:1024
 ds_read_b64_tr_b16 a[174:175], v25 offset:1536
 ds_read_b64_tr_b16 a[176:177], v26 offset:0
 ds_read_b64_tr_b16 a[178:179], v26 offset:512
 ds_read_b64_tr_b16 a[180:181], v26 offset:1024
 ds_read_b64_tr_b16 a[182:183], v26 offset:1536
 ds_read_b64_tr_b16 a[184:185], v27 offset:0
 ds_read_b64_tr_b16 a[186:187], v27 offset:512
 ds_read_b64_tr_b16 a[188:189], v27 offset:1024
 ds_read_b64_tr_b16 a[190:191], v27 offset:1536
 s_waitcnt lgkmcnt(0)
 s_waitcnt vmcnt(8)
 s_barrier
 v_add_u32 v24, 98304, v20
 v_add_u32 v25, 98304, v21
 v_add_u32 v26, 98304, v22
 v_add_u32 v27, 98304, v23
 ds_read_b64_tr_b16 a[192:193], v24 offset:0
 ds_read_b64_tr_b16 a[194:195], v24 offset:512
 ds_read_b64_tr_b16 a[196:197], v24 offset:1024
 ds_read_b64_tr_b16 a[198:199], v24 offset:1536
 ds_read_b64_tr_b16 a[200:201], v25 offset:0
 ds_read_b64_tr_b16 a[202:203], v25 offset:512
 ds_read_b64_tr_b16 a[204:205], v25 offset:1024
 ds_read_b64_tr_b16 a[206:207], v25 offset:1536
 ds_read_b64_tr_b16 a[208:209], v26 offset:0
 ds_read_b64_tr_b16 a[210:211], v26 offset:512
 ds_read_b64_tr_b16 a[212:213], v26 offset:1024
 ds_read_b64_tr_b16 a[214:215], v26 offset:1536
 ds_read_b64_tr_b16 a[216:217], v27 offset:0
 ds_read_b64_tr_b16 a[218:219], v27 offset:512
 ds_read_b64_tr_b16 a[220:221], v27 offset:1024
 ds_read_b64_tr_b16 a[222:223], v27 offset:1536
 s_waitcnt lgkmcnt(0)
 s_waitcnt vmcnt(0)
 s_barrier
 v_add_u32 v24, 131072, v20
 v_add_u32 v25, 131072, v21
 v_add_u32 v26, 131072, v22
 v_add_u32 v27, 131072, v23
 ds_read_b64_tr_b16 a[224:225], v24 offset:0
 ds_read_b64_tr_b16 a[226:227], v24 offset:512
 ds_read_b64_tr_b16 a[228:229], v24 offset:1024
 ds_read_b64_tr_b16 a[230:231], v24 offset:1536
 ds_read_b64_tr_b16 a[232:233], v25 offset:0
 ds_read_b64_tr_b16 a[234:235], v25 offset:512
 ds_read_b64_tr_b16 a[236:237], v25 offset:1024
 ds_read_b64_tr_b16 a[238:239], v25 offset:1536
 ds_read_b64_tr_b16 a[240:241], v26 offset:0
 ds_read_b64_tr_b16 a[242:243], v26 offset:512
 ds_read_b64_tr_b16 a[244:245], v26 offset:1024
 ds_read_b64_tr_b16 a[246:247], v26 offset:1536
 ds_read_b64_tr_b16 a[248:249], v27 offset:0
 ds_read_b64_tr_b16 a[250:251], v27 offset:512
 ds_read_b64_tr_b16 a[252:253], v27 offset:1024
 ds_read_b64_tr_b16 a[254:255], v27 offset:1536
 s_waitcnt lgkmcnt(0)
 s_mov_b32 s96, s44
 s_and_b32 s97, s45, 0xffff
 s_mov_b32 s98, 256
 s_mov_b32 s99, 0x00020000
 v_mov_b32 v8, 132
 s_mov_b32 s3, 144
 v_writelane_b32 v8, s3, 1
 s_mov_b32 s51, 0
 s_mov_b64 exec, 3
L_wb_292:
 buffer_load_dword v9, v8, s[96:99], 0 offen sc1
 s_waitcnt vmcnt(0)
 v_cmp_eq_u32 vcc, 0, v9
 s_cbranch_vccz L_wbd_293
 s_sleep 2
 s_add_u32 s51, s51, 1
 s_cmp_lt_u32 s51, 131072
 s_cbranch_scc1 L_wb_292
 s_branch L_bail
L_wbd_293:
 s_mov_b64 exec, -1
 v_readlane_b32 s81, v9, 1
 s_nop 3
 s_sub_u32 s81, s81, 1
 s_mov_b32 s96, s44
 s_and_b32 s97, s45, 0xffff
 s_mov_b32 s98, 256
 s_mov_b32 s99, 0x00020000
 v_lshlrev_b32 v8, 5, v0
 s_mov_b32 s51, 0
L_gl_294:
 buffer_load_dword v9, v8, s[96:99], 0 offen sc1
 s_waitcnt vmcnt(0)
 v_readlane_b32 s3, v9, s48
 s_mov_b32 s80, 0
 s_nop 2
 s_cmp_ge_u32 s3, 32
 s_cbranch_scc1 L_gld_295
 s_mov_b32 s80, 0
 v_readlane_b32 s3, v9, 0
 s_nop 3
 s_add_u32 s80, s80, s3
 v_readlane_b32 s3, v9, 1
 s_nop 3
 s_add_u32 s80, s80, s3
 v_readlane_b32 s3, v9, 2
 s_nop 3
 s_add_u32 s80, s80, s3
 v_readlane_b32 s3, v9, 3
 s_nop 3
 s_add_u32 s80, s80, s3
 v_readlane_b32 s3, v9, 4
 s_nop 3
 s_add_u32 s80, s80, s3
 v_readlane_b32 s3, v9, 5
 s_nop 3
 s_add_u32 s80, s80, s3
 v_readlane_b32 s3, v9, 6
 s_nop 3
 s_add_u32 s80, s80, s3
 v_readlane_b32 s3, v9, 7
 s_nop 3
 s_add_u32 s80, s80, s3
 s_cmp_ge_u32 s80, 256
 s_cbranch_scc1 L_gld_295
 s_sleep 4
 s_add_u32 s51, s51, 1
 s_cmp_lt_u32 s51, 131072
 s_cbranch_scc1 L_gl_294
 s_branch L_bail
L_gld_295:
 s_barrier
 v_lshlrev_b32 v1, 4, v0
 v_add_u32 v6, 4096, v1
 s_xor_b32 s3, s81, 0
 s_and_b32 s3, s3, 1
 s_lshl_b32 s3, s3, 13
 s_add_u32 s56, s3, 4194304
 s_and_b32 s3, s48, 2
 s_lshl_b32 s3, s3, 15
 s_add_u32 s56, s56, s3
 s_xor_b32 s3, s81, 1
 s_and_b32 s3, s3, 1
 s_lshl_b32 s3, s3, 13
 s_add_u32 s57, s3, 6291456
 s_and_b32 s3, s48, 2
 s_lshl_b32 s3, s3, 15
 s_add_u32 s57, s57, s3
 s_xor_b32 s3, s81, 0
 s_and_b32 s3, s3, 1
 s_lshl_b32 s3, s3, 13
 s_add_u32 s58, s3, 8388608
 s_and_b32 s3, s48, 2
 s_lshl_b32 s3, s3, 15
 s_add_u32 s58, s58, s3
 s_xor_b32 s3, s81, 1
 s_and_b32 s3, s3, 1
 s_lshl_b32 s3, s3, 13
 s_add_u32 s59, s3, 10485760
 s_and_b32 s3, s48, 2
 s_lshl_b32 s3, s3, 15
 s_add_u32 s59, s59, s3
 v_lshrrev_b32 v2, 5, v0
 v_lshlrev_b32 v2, 15, v2
 v_bfe_u32 v7, v0, 2, 2
 v_lshl_add_u32 v2, v7, 8, v2
 v_bfe_u32 v7, v0, 4, 1
 v_lshl_add_u32 v2, v7, 6, v2
 v_and_b32 v7, 3, v0
 v_lshl_add_u32 v2, v7, 4, v2
 s_lshr_b32 s76, s50, 1
 s_and_b32 s77, s50, 1
 s_lshl_b32 s3, s76, 14
 v_add_u32 v2, s3, v2
 s_lshl_b32 s3, s77, 7
 s_add_u32 s3, s3, 2048
 v_add_u32 v3, s3, v2
 s_mul_i32 s3, s77, 3072
 v_add_u32 v2, s3, v2
 s_mul_i32 s76, s76, 5120
 s_add_u32 s3, s3, s76
 v_add_u32 v4, s3, v1
 s_lshl_b32 s3, s77, 3
 s_add_u32 s3, s3, s76
 s_add_u32 s3, s3, 2048
 v_add_u32 v5, s3, v1
 v_and_b32 v7, 2, v0
 v_cmp_eq_u32 vcc, 0, v7
 v_mov_b32 v8, 0xeeee
 v_mov_b32 v7, 0x4444
 s_nop 0
 v_cndmask_b32 v8, v8, v7, vcc
 s_lshr_b32 s3, s48, 1
 s_lshl_b32 s3, s3, 5
 s_add_u32 s64, s3, s52
 s_lshl_b32 s32, s64, 8
 s_add_u32 s32, s32, 0
 s_mul_i32 s76, s64, 24576
 s_add_u32 s60, s76, 1736704
 s_add_u32 s61, s76, 1742848
 s_add_u32 s62, s76, 1748992
 s_add_u32 s63, s76, 1755136
 s_add_u32 s3, s32, 8
 s_cmp_eq_u32 s50, 0
 s_cselect_b32 s35, s3, 268435456
 s_and_b32 s77, s50, 1
 s_lshr_b32 s76, s50, 1
 s_lshl_b32 s3, s77, 10
 v_add_u32 v18, s3, v6
 s_lshl_b32 s3, s50, 10
 v_add_u32 v16, s3, v1
 s_lshl_b32 s3, s76, 11
 v_add_u32 v17, s3, v1
 s_mul_i32 s69, s76, 24576
 s_add_u32 s69, s69, 18432
 v_add_u32 v15, s69, v1
 v_add_u32 v19, 16384, v15
 s_lshl_b32 s71, s77, 12
 s_add_u32 s68, s69, s71
 s_add_u32 s68, s68, 8192
 v_add_u32 v14, s68, v1
 s_lshl_b32 s3, s77, 14
 s_add_u32 s69, s69, s3
 s_mul_i32 s70, s77, 67108864
 s_and_b32 s100, s52, 1
 s_lshl_b32 s100, s100, 13
 s_lshl_b32 s54, s52, 14
 s_add_u32 s54, s54, s100
 s_lshr_b32 s3, s48, 1
 s_mul_i32 s3, s3, 33554432
 s_add_u32 s54, s54, s3
 s_add_u32 s54, s54, 16777216
 s_xor_b32 s78, s81, 0
 s_lshl_b32 s78, s78, 13
 s_xor_b32 s79, s78, 8192
 s_lshr_b32 s3, s48, 1
 s_lshl_b32 s67, s3, 8
 s_add_u32 s67, s67, s79
 s_add_u32 s67, s67, 49152
 s_lshr_b32 s3, s52, 2
 s_mul_i32 s3, s3, 2560
 v_lshl_add_u32 v12, v0, 9, s3
 v_and_b32 v7, 0xffffe000, v12
 v_add_u32 v12, v12, v7
 v_lshrrev_b32 v7, 4, v0
 v_lshlrev_b32 v11, 9, v7
 v_and_b32 v10, 15, v0
 v_lshl_add_u32 v11, v10, 4, v11
 s_lshl_b32 s3, s77, 8
 v_add_u32 v11, s3, v11
 s_lshl_b32 s3, s77, 4
 v_add_u32 v10, s3, v10
 v_lshlrev_b32 v7, 2, v7
 v_mov_b32 v148, 0xff61b1e6
 v_add_u32 v149, 0, v7
 v_cmp_gt_u32 vcc, v149, v10
 s_nop 1
 v_cndmask_b32 v108, 0, v148, vcc
 v_add_u32 v149, 1, v7
 v_cmp_gt_u32 vcc, v149, v10
 s_nop 1
 v_cndmask_b32 v109, 0, v148, vcc
 v_add_u32 v149, 2, v7
 v_cmp_gt_u32 vcc, v149, v10
 s_nop 1
 v_cndmask_b32 v110, 0, v148, vcc
 v_add_u32 v149, 3, v7
 v_cmp_gt_u32 vcc, v149, v10
 s_nop 1
 v_cndmask_b32 v111, 0, v148, vcc
 v_add_u32 v149, 16, v7
 v_cmp_gt_u32 vcc, v149, v10
 s_nop 1
 v_cndmask_b32 v112, 0, v148, vcc
 v_add_u32 v149, 17, v7
 v_cmp_gt_u32 vcc, v149, v10
 s_nop 1
 v_cndmask_b32 v113, 0, v148, vcc
 v_add_u32 v149, 18, v7
 v_cmp_gt_u32 vcc, v149, v10
 s_nop 1
 v_cndmask_b32 v114, 0, v148, vcc
 v_add_u32 v149, 19, v7
 v_cmp_gt_u32 vcc, v149, v10
 s_nop 1
 v_cndmask_b32 v115, 0, v148, vcc
 v_mov_b32 v32, -1
 v_mov_b32 v120, 0
 v_mov_b32 v33, -1
 v_mov_b32 v121, 0
 v_mov_b32 v34, -1
 v_mov_b32 v122, 0
 v_mov_b32 v35, -1
 v_mov_b32 v123, 0
 v_mov_b32 v80, 0
 v_mov_b32 v81, 0
 v_mov_b32 v82, 0
 v_mov_b32 v83, 0
 v_mov_b32 v84, 0
 v_mov_b32 v85, 0
 v_mov_b32 v86, 0
 v_mov_b32 v87, 0
 v_mov_b32 v88, 0
 v_mov_b32 v89, 0
 v_mov_b32 v90, 0
 v_mov_b32 v91, 0
 v_mov_b32 v92, 0
 v_mov_b32 v93, 0
 v_mov_b32 v94, 0
 v_mov_b32 v95, 0
 v_and_b32 v9, 7, v0
 v_lshrrev_b32 v10, 1, v0
 v_xor_b32 v10, v10, v0
 v_and_b32 v10, 8, v10
 v_or_b32 v9, v9, v10
 v_mov_b32 v24, 0
 v_cmp_eq_u32 vcc, 0, v9
 v_mov_b32 v10, 0x3f80
 s_nop 1
 v_cndmask_b32 v24, v24, v10, vcc
 v_cmp_eq_u32 vcc, 1, v9
 v_mov_b32 v10, 0x3f800000
 s_nop 1
 v_cndmask_b32 v24, v24, v10, vcc
 v_mov_b32 v25, 0
 v_cmp_eq_u32 vcc, 2, v9
 v_mov_b32 v10, 0x3f80
 s_nop 1
 v_cndmask_b32 v25, v25, v10, vcc
 v_cmp_eq_u32 vcc, 3, v9
 v_mov_b32 v10, 0x3f800000
 s_nop 1
 v_cndmask_b32 v25, v25, v10, vcc
 v_mov_b32 v26, 0
 v_cmp_eq_u32 vcc, 4, v9
 v_mov_b32 v10, 0x3f80
 s_nop 1
 v_cndmask_b32 v26, v26, v10, vcc
 v_cmp_eq_u32 vcc, 5, v9
 v_mov_b32 v10, 0x3f800000
 s_nop 1
 v_cndmask_b32 v26, v26, v10, vcc
 v_mov_b32 v27, 0
 v_cmp_eq_u32 vcc, 6, v9
 v_mov_b32 v10, 0x3f80
 s_nop 1
 v_cndmask_b32 v27, v27, v10, vcc
 v_cmp_eq_u32 vcc, 7, v9
 v_mov_b32 v10, 0x3f800000
 s_nop 1
 v_cndmask_b32 v27, v27, v10, vcc
 v_mov_b32 v9, 0
 v_and_b32 v23, -33, v1
 s_mov_b32 s65, 0x3db504f3
 s_mov_b32 s66, 0x3fb8aa3b
 s_mov_b32 s53, 0
 s_mov_b32 s33, 268435456
 s_mov_b32 s34, 268435456
 s_sub_u32 s67, s67, 4
 v_mov_b32 v124, 0
 v_mov_b32 v125, 0
 v_mov_b32 v126, 0
 v_mov_b32 v127, 0
 v_mov_b32 v128, 0
 v_mov_b32 v129, 0
 v_mov_b32 v130, 0
 v_mov_b32 v131, 0
 v_mov_b32 v132, 0
 v_mov_b32 v133, 0
 v_mov_b32 v134, 0
 v_mov_b32 v135, 0
 v_mov_b32 v136, 0
 v_mov_b32 v137, 0
 v_mov_b32 v138, 0
 v_mov_b32 v139, 0
 s_cmp_lg_u32 s80, 0
 s_cbranch_scc1 L_vr_ents
 s_branch L_vr_entf
.p2align 6
L_vr_loopf:
 s_mov_b32 s51, 0
 buffer_load_dword v7, off, s[4:7], s17 sc1
 s_waitcnt vmcnt(0)
L_go_296:
 v_cmp_gt_u32 vcc, s53, v7
 s_cbranch_vccnz L_rt_297
L_vr_entf:
 s_mov_b32 s51, 0
 s_nop 15
 s_nop 15
 s_nop 15
 s_nop 15
 buffer_load_dwordx4 v[40:43], v2, s[4:7], s56 offen offset:0 sc1
 buffer_load_dwordx4 v[44:47], v2, s[4:7], s56 offen offset:128 sc1
 buffer_load_dwordx4 v[48:51], v2, s[4:7], s56 offen offset:1024 sc1
 buffer_load_dwordx4 v[52:55], v2, s[4:7], s56 offen offset:1152 sc1
 buffer_load_dwordx4 v[56:59], v3, s[4:7], s56 offen offset:0 sc1
L_xm_298:
 s_waitcnt vmcnt(4)
 v_mfma_f32_16x16x32_bf16 v[60:63], v[24:27], v[40:43], 0
 s_waitcnt vmcnt(3)
 v_mfma_f32_16x16x32_bf16 v[64:67], v[24:27], v[44:47], 0
 s_waitcnt vmcnt(2)
 v_mfma_f32_16x16x32_bf16 v[68:71], v[24:27], v[48:51], 0
 v_max3_u32 v7, v40, v44, v48
 v_cvt_pk_bf16_f32 v60, v60, v61
 v_cvt_pk_bf16_f32 v61, v62, v63
 ds_write_b64 v4, v[60:61] offset:0
 s_waitcnt vmcnt(1)
 v_mfma_f32_16x16x32_bf16 v[72:75], v[24:27], v[52:55], 0
 v_cvt_pk_bf16_f32 v64, v64, v65
 v_cvt_pk_bf16_f32 v65, v66, v67
 ds_write_b64 v4, v[64:65] offset:8
 s_waitcnt vmcnt(0)
 v_mfma_f32_16x16x32_bf16 v[76:79], v[24:27], v[56:59], 0
 v_max3_u32 v7, v7, v52, v56
 v_cmp_eq_u32 vcc, -1, v7
 v_cvt_pk_bf16_f32 v68, v68, v69
 v_cvt_pk_bf16_f32 v69, v70, v71
 ds_write_b64 v4, v[68:69] offset:1024
 s_cbranch_vccnz L_rt_299
 v_cvt_pk_bf16_f32 v72, v72, v73
 v_cvt_pk_bf16_f32 v73, v74, v75
 ds_write_b64 v4, v[72:73] offset:1032
 s_nop 0
 v_cvt_pk_bf16_f32 v76, v76, v77
 v_cvt_pk_bf16_f32 v77, v78, v79
 ds_write_b64 v5, v[76:77] offset:0
 s_waitcnt lgkmcnt(0)
 s_barrier
 ds_read_b128 v[56:59], v23 offset:0
 ds_read_b128 v[60:63], v23 offset:32
 ds_read_b128 v[64:67], v23 offset:1024
 s_cmp_ge_u32 s34, 268435456
 s_cbranch_scc1 L_ns_300
 v_mov_b32 v10, 1
 s_mov_b64 exec, 31
 buffer_atomic_add v10, v12, s[4:7], s34 offen
 s_mov_b64 exec, -1
 L_ns_300:
 buffer_load_dword v13, off, s[4:7], s32 sc1
 s_waitcnt lgkmcnt(2)
 v_smfmac_f32_16x16x64_bf16 v[80:83], v[56:59], v[192:199], v8
 ds_read_b128 v[68:71], v23 offset:1056
 v_smfmac_f32_16x16x64_bf16 v[84:87], v[56:59], v[200:207], v8
 ds_read_b128 v[72:75], v23 offset:2048
 s_waitcnt lgkmcnt(3)
 v_smfmac_f32_16x16x64_bf16 v[80:83], v[60:63], v[208:215], v8
 ds_read_b128 v[76:79], v23 offset:2080
 v_smfmac_f32_16x16x64_bf16 v[84:87], v[60:63], v[216:223], v8
 ds_read_b128 v[180:183], v23 offset:3072
 s_waitcnt lgkmcnt(4)
 v_smfmac_f32_16x16x64_bf16 v[80:83], v[64:67], v[224:231], v8
 ds_read_b128 v[40:43], v14 offset:49152
 v_smfmac_f32_16x16x64_bf16 v[84:87], v[64:67], v[232:239], v8
 ds_read_b128 v[184:187], v23 offset:3104
 s_waitcnt lgkmcnt(5)
 v_smfmac_f32_16x16x64_bf16 v[80:83], v[68:71], v[240:247], v8
 ds_read_b128 v[44:47], v14 offset:50176
 v_smfmac_f32_16x16x64_bf16 v[84:87], v[68:71], v[248:255], v8
 ds_read_b128 v[56:59], v23 offset:4096
 s_waitcnt lgkmcnt(6)
 v_smfmac_f32_16x16x64_bf16 v[80:83], v[72:75], a[0:7], v8
 ds_read_b128 v[48:51], v14 offset:51200
 v_smfmac_f32_16x16x64_bf16 v[84:87], v[72:75], a[8:15], v8
 ds_read_b128 v[60:63], v23 offset:4128
 s_waitcnt lgkmcnt(7)
 v_smfmac_f32_16x16x64_bf16 v[80:83], v[76:79], a[16:23], v8
 ds_read_b128 v[52:55], v14 offset:52224
 v_smfmac_f32_16x16x64_bf16 v[84:87], v[76:79], a[24:31], v8
 ds_read_b128 v[64:67], v23 offset:5120
 s_waitcnt lgkmcnt(8)
 v_smfmac_f32_16x16x64_bf16 v[80:83], v[180:183], a[32:39], v8
 ds_read_b128 v[148:151], v15 offset:49152
 v_smfmac_f32_16x16x64_bf16 v[84:87], v[180:183], a[40:47], v8
 ds_read_b128 v[68:71], v23 offset:5152
 s_waitcnt lgkmcnt(8)
 v_smfmac_f32_16x16x64_bf16 v[80:83], v[184:187], a[48:55], v8
 ds_read_b128 v[152:155], v15 offset:50176
 v_smfmac_f32_16x16x64_bf16 v[84:87], v[184:187], a[56:63], v8
 ds_read_b128 v[72:75], v23 offset:6144
 s_waitcnt lgkmcnt(8)
 v_smfmac_f32_16x16x64_bf16 v[80:83], v[56:59], a[64:71], v8
 ds_read_b128 v[156:159], v15 offset:51200
 v_smfmac_f32_16x16x64_bf16 v[84:87], v[56:59], a[72:79], v8
 ds_read_b128 v[76:79], v23 offset:6176
 s_waitcnt lgkmcnt(8)
 v_smfmac_f32_16x16x64_bf16 v[80:83], v[60:63], a[80:87], v8
 ds_read_b128 v[160:163], v15 offset:52224
 v_smfmac_f32_16x16x64_bf16 v[84:87], v[60:63], a[88:95], v8
 ds_read_b128 v[180:183], v23 offset:7168
 s_waitcnt lgkmcnt(8)
 v_smfmac_f32_16x16x64_bf16 v[80:83], v[64:67], a[96:103], v8
 ds_read_b128 v[164:167], v15 offset:53248
 v_smfmac_f32_16x16x64_bf16 v[84:87], v[64:67], a[104:111], v8
 ds_read_b128 v[184:187], v23 offset:7200
 s_waitcnt lgkmcnt(8)
 v_smfmac_f32_16x16x64_bf16 v[80:83], v[68:71], a[112:119], v8
 ds_read_b128 v[168:171], v15 offset:54272
 v_smfmac_f32_16x16x64_bf16 v[84:87], v[68:71], a[120:127], v8
 ds_read_b128 v[56:59], v23 offset:8192
 s_waitcnt lgkmcnt(8)
 v_smfmac_f32_16x16x64_bf16 v[80:83], v[72:75], a[128:135], v8
 ds_read_b128 v[172:175], v15 offset:55296
 v_smfmac_f32_16x16x64_bf16 v[84:87], v[72:75], a[136:143], v8
 ds_read_b128 v[60:63], v23 offset:8224
 s_waitcnt lgkmcnt(8)
 v_smfmac_f32_16x16x64_bf16 v[80:83], v[76:79], a[144:151], v8
 ds_read_b128 v[176:179], v15 offset:56320
 v_smfmac_f32_16x16x64_bf16 v[84:87], v[76:79], a[152:159], v8
 ds_read_b128 v[64:67], v23 offset:9216
 s_waitcnt lgkmcnt(8)
 v_smfmac_f32_16x16x64_bf16 v[80:83], v[180:183], a[160:167], v8
 ds_read_b128 v[140:143], v17 offset:14336
 v_smfmac_f32_16x16x64_bf16 v[84:87], v[180:183], a[168:175], v8
 ds_read_b128 v[68:71], v23 offset:9248
 s_waitcnt lgkmcnt(8)
 v_smfmac_f32_16x16x64_bf16 v[80:83], v[184:187], a[176:183], v8
 ds_read_b128 v[144:147], v17 offset:15360
 v_smfmac_f32_16x16x64_bf16 v[84:87], v[184:187], a[184:191], v8
 s_waitcnt lgkmcnt(7)
 v_smfmac_f32_16x16x64_bf16 v[80:83], v[56:59], a[192:199], v8
 v_smfmac_f32_16x16x64_bf16 v[84:87], v[56:59], a[200:207], v8
 s_waitcnt lgkmcnt(5)
 v_smfmac_f32_16x16x64_bf16 v[80:83], v[60:63], a[208:215], v8
 v_smfmac_f32_16x16x64_bf16 v[84:87], v[60:63], a[216:223], v8
 s_waitcnt lgkmcnt(3)
 v_smfmac_f32_16x16x64_bf16 v[80:83], v[64:67], a[224:231], v8
 v_smfmac_f32_16x16x64_bf16 v[84:87], v[64:67], a[232:239], v8
 s_waitcnt lgkmcnt(1)
 v_smfmac_f32_16x16x64_bf16 v[80:83], v[68:71], a[240:247], v8
 v_smfmac_f32_16x16x64_bf16 v[84:87], v[68:71], a[248:255], v8
 s_lshl_b32 s16, s53, 19
 s_add_u32 s16, s16, s54
 s_xor_b32 s72, s16, 8192
 s_add_u32 s72, s72, s71
 s_add_u32 s16, s16, s70
 v_cvt_pk_bf16_f32 v36, v80, v81
 v_cvt_pk_bf16_f32 v37, v82, v83
 s_nop 2
 v_cvt_pk_bf16_f32 v38, v84, v85
 v_cvt_pk_bf16_f32 v39, v86, v87
 buffer_store_dwordx4 v[36:39], v18, s[4:7], s60 offen
 ds_write_b128 v16, v[36:39] offset:10240
 s_waitcnt vmcnt(1) lgkmcnt(1)
L_wf_301:
 v_cmp_ge_u32 vcc, s53, v13
 s_cbranch_vccnz L_rt_302
 v_mfma_f32_16x16x32_bf16 v[100:103], v[148:151], v[40:43], v[108:111]
 s_add_u32 m0, s68, 0
 s_nop 0
 buffer_load_dwordx4 v1, s[4:7], s72 offen offset:0 sc1 nt lds
 ds_read_b128 v[56:59], v19 offset:49152
 v_mfma_f32_16x16x32_bf16 v[104:107], v[164:167], v[40:43], v[112:115]
 ds_read_b128 v[60:63], v19 offset:50176
 v_mfma_f32_16x16x32_bf16 v[96:99], v[124:127], v[40:43], 0
 ds_read_b128 v[64:67], v19 offset:51200
 v_mfma_f32_16x16x32_bf16 v[100:103], v[152:155], v[44:47], v[100:103]
 ds_read_b128 v[68:71], v19 offset:52224
 buffer_load_dwordx4 v1, s[4:7], s72 offen offset:1024 sc1 nt lds
 v_mfma_f32_16x16x32_bf16 v[104:107], v[168:171], v[44:47], v[104:107]
 ds_read_b128 v[72:75], v19 offset:53248
 v_mfma_f32_16x16x32_bf16 v[96:99], v[128:131], v[44:47], v[96:99]
 ds_read_b128 v[76:79], v19 offset:54272
 v_mfma_f32_16x16x32_bf16 v[100:103], v[156:159], v[48:51], v[100:103]
 ds_read_b128 v[180:183], v19 offset:55296
 v_mfma_f32_16x16x32_bf16 v[104:107], v[172:175], v[48:51], v[104:107]
 buffer_load_dwordx4 v1, s[4:7], s72 offen offset:2048 sc1 nt lds
 ds_read_b128 v[184:187], v19 offset:56320
 v_mfma_f32_16x16x32_bf16 v[96:99], v[132:135], v[48:51], v[96:99]
 v_mfma_f32_16x16x32_bf16 v[100:103], v[160:163], v[52:55], v[100:103]
 v_mfma_f32_16x16x32_bf16 v[104:107], v[176:179], v[52:55], v[104:107]
 v_mfma_f32_16x16x32_bf16 v[96:99], v[136:139], v[52:55], v[96:99]
 v_mov_b32 v80, 0
 v_mov_b32 v81, 0
 buffer_load_dwordx4 v1, s[4:7], s72 offen offset:3072 sc1 nt lds
 v_mov_b32 v82, 0
 v_mov_b32 v83, 0
 v_mov_b32 v84, 0
 v_mov_b32 v85, 0
 v_mov_b32 v86, 0
 v_mov_b32 v87, 0
 v_cvt_pk_bf16_f32 v7, v100, v101
 s_add_u32 m0, s69, 0
 s_nop 0
 buffer_load_dwordx4 v1, s[4:7], s16 offen offset:0 sc1 lds
 v_lshlrev_b32 v100, 16, v7
 v_and_b32 v101, 0xffff0000, v7
 v_cvt_pk_bf16_f32 v7, v102, v103
 v_lshlrev_b32 v102, 16, v7
 v_and_b32 v103, 0xffff0000, v7
 v_cvt_pk_bf16_f32 v7, v104, v105
 v_lshlrev_b32 v104, 16, v7
 buffer_load_dwordx4 v1, s[4:7], s16 offen offset:1024 sc1 lds
 v_and_b32 v105, 0xffff0000, v7
 v_cvt_pk_bf16_f32 v7, v106, v107
 v_lshlrev_b32 v106, 16, v7
 v_and_b32 v107, 0xffff0000, v7
 v_cvt_pk_bf16_f32 v7, v98, v99
 v_lshlrev_b32 v98, 16, v7
 v_and_b32 v99, 0xffff0000, v7
 buffer_load_dwordx4 v1, s[4:7], s16 offen offset:2048 sc1 lds
 v_pk_mul_f32 v[100:101], v[100:101], s[64:65] op_sel:[0,1] op_sel_hi:[1,1]
 v_pk_mul_f32 v[102:103], v[102:103], s[64:65] op_sel:[0,1] op_sel_hi:[1,1]
 v_pk_mul_f32 v[104:105], v[104:105], s[64:65] op_sel:[0,1] op_sel_hi:[1,1]
 v_pk_mul_f32 v[106:107], v[106:107], s[64:65] op_sel:[0,1] op_sel_hi:[1,1]
 v_pk_mul_f32 v[98:99], v[98:99], s[64:65] op_sel:[0,1] op_sel_hi:[1,1]
 v_cvt_pk_bf16_f32 v7, v100, v101
 v_lshlrev_b32 v100, 16, v7
 buffer_load_dwordx4 v1, s[4:7], s16 offen offset:3072 sc1 lds
 v_and_b32 v101, 0xffff0000, v7
 v_cvt_pk_bf16_f32 v7, v102, v103
 v_lshlrev_b32 v102, 16, v7
 v_and_b32 v103, 0xffff0000, v7
 v_cvt_pk_bf16_f32 v7, v104, v105
 v_lshlrev_b32 v104, 16, v7
 v_and_b32 v105, 0xffff0000, v7
 s_add_u32 m0, s69, 4096
 s_nop 0
 buffer_load_dwordx4 v6, s[4:7], s16 offen offset:0 sc1 lds
 v_cvt_pk_bf16_f32 v7, v106, v107
 v_lshlrev_b32 v106, 16, v7
 v_and_b32 v107, 0xffff0000, v7
 v_cvt_pk_bf16_f32 v7, v98, v99
 v_lshlrev_b32 v98, 16, v7
 v_and_b32 v99, 0xffff0000, v7
 v_max_f32 v20, v100, v101
 buffer_load_dwordx4 v6, s[4:7], s16 offen offset:1024 sc1 lds
 v_max3_f32 v20, v20, v102, v103
 v_max3_f32 v20, v20, v104, v105
 v_max3_f32 v20, v20, v106, v107
 v_max3_f32 v20, v20, v98, v99
 v_mov_b32 v22, v20
 s_nop 1
 v_permlane16_swap_b32 v20, v22
 buffer_load_dwordx4 v6, s[4:7], s16 offen offset:2048 sc1 lds
 v_max_f32 v20, v20, v22
 v_mov_b32 v22, v20
 s_nop 1
 v_permlane32_swap_b32 v20, v22
 v_max_f32 v20, v20, v22
 v_mul_f32 v22, s66, v20
 v_fma_f32 v100, v100, s66, -v22
 buffer_load_dwordx4 v6, s[4:7], s16 offen offset:3072 sc1 lds
 v_fma_f32 v101, v101, s66, -v22
 v_fma_f32 v102, v102, s66, -v22
 v_fma_f32 v103, v103, s66, -v22
 v_fma_f32 v104, v104, s66, -v22
 v_fma_f32 v105, v105, s66, -v22
 v_fma_f32 v106, v106, s66, -v22
 v_fma_f32 v107, v107, s66, -v22
 buffer_store_dwordx4 v[32:35], v18, s[4:7], s63 offen
 v_fma_f32 v98, v98, s66, -v22
 v_fma_f32 v99, v99, s66, -v22
 v_exp_f32 v100, v100
 v_exp_f32 v101, v101
 v_exp_f32 v102, v102
 v_exp_f32 v103, v103
 v_exp_f32 v104, v104
 buffer_load_dwordx4 v[124:127], v1, s[4:7], s60 offen offset:0 sc1
 v_exp_f32 v105, v105
 v_exp_f32 v106, v106
 v_exp_f32 v107, v107
 v_exp_f32 v98, v98
 v_exp_f32 v99, v99
 v_add_f32 v28, v100, v101
 v_add_f32 v28, v28, v102
 buffer_load_dwordx4 v[128:131], v1, s[4:7], s60 offen offset:1024 sc1
 v_add_f32 v28, v28, v103
 v_add_f32 v28, v28, v104
 v_add_f32 v28, v28, v105
 v_add_f32 v28, v28, v106
 v_add_f32 v28, v28, v107
 v_add_f32 v28, v28, v98
 v_add_f32 v28, v28, v99
 buffer_load_dwordx4 v[132:135], v1, s[4:7], s60 offen offset:2048 sc1
 v_mov_b32 v22, v28
 s_nop 1
 v_permlane16_swap_b32 v28, v22
 v_add_f32 v28, v28, v22
 v_mov_b32 v22, v28
 s_nop 1
 v_permlane32_swap_b32 v28, v22
 buffer_load_dwordx4 v[136:139], v1, s[4:7], s60 offen offset:3072 sc1
 v_add_f32 v28, v28, v22
 v_rcp_f32 v28, v28
 s_nop 0
 v_pk_mul_f32 v[100:101], v[100:101], v[28:29] op_sel_hi:[1,0]
 v_pk_mul_f32 v[102:103], v[102:103], v[28:29] op_sel_hi:[1,0]
 v_pk_mul_f32 v[104:105], v[104:105], v[28:29] op_sel_hi:[1,0]
 v_pk_mul_f32 v[106:107], v[106:107], v[28:29] op_sel_hi:[1,0]
 v_pk_mul_f32 v[98:99], v[98:99], v[28:29] op_sel_hi:[1,0]
 v_cvt_pk_bf16_f32 v116, v100, v101
 v_cvt_pk_bf16_f32 v117, v102, v103
 v_cvt_pk_bf16_f32 v118, v104, v105
 v_cvt_pk_bf16_f32 v119, v106, v107
 v_cvt_pk_bf16_f32 v120, v98, v99
 v_cvt_pk_bf16_f32 v123, v98, v99
 s_waitcnt lgkmcnt(0)
 v_mfma_f32_16x16x32_bf16 v[148:151], v[56:59], v[116:119], 0
 v_mfma_f32_16x16x32_bf16 v[152:155], v[60:63], v[116:119], 0
 v_mfma_f32_16x16x16_bf16 v[148:151], v[140:141], v[120:121], v[148:151]
 v_mfma_f32_16x16x32_bf16 v[156:159], v[64:67], v[116:119], 0
 v_mfma_f32_16x16x16_bf16 v[152:155], v[140:141], v[122:123], v[152:155]
 v_mfma_f32_16x16x32_bf16 v[160:163], v[68:71], v[116:119], 0
 v_mfma_f32_16x16x16_bf16 v[156:159], v[142:143], v[120:121], v[156:159]
 v_mfma_f32_16x16x32_bf16 v[164:167], v[72:75], v[116:119], 0
 v_mfma_f32_16x16x16_bf16 v[160:163], v[142:143], v[122:123], v[160:163]
 v_cvt_pk_bf16_f32 v40, v148, v149
 v_cvt_pk_bf16_f32 v41, v150, v151
 v_cvt_pk_bf16_f32 v42, v152, v153
 v_cvt_pk_bf16_f32 v43, v154, v155
 buffer_store_dwordx4 v[40:43], v11, s[4:7], s33 offen offset:0 sc1
 v_mfma_f32_16x16x32_bf16 v[168:171], v[76:79], v[116:119], 0
 v_mfma_f32_16x16x16_bf16 v[164:167], v[144:145], v[120:121], v[164:167]
 v_mfma_f32_16x16x32_bf16 v[172:175], v[180:183], v[116:119], 0
 v_mfma_f32_16x16x16_bf16 v[168:171], v[144:145], v[122:123], v[168:171]
 v_cvt_pk_bf16_f32 v44, v156, v157
 v_cvt_pk_bf16_f32 v45, v158, v159
 v_cvt_pk_bf16_f32 v46, v160, v161
 v_cvt_pk_bf16_f32 v47, v162, v163
 buffer_store_dwordx4 v[44:47], v11, s[4:7], s33 offen offset:2048 sc1
 s_add_u32 s33, s33, 4096
 v_mfma_f32_16x16x32_bf16 v[176:179], v[184:187], v[116:119], 0
 v_mfma_f32_16x16x16_bf16 v[172:175], v[146:147], v[120:121], v[172:175]
 v_mfma_f32_16x16x16_bf16 v[176:179], v[146:147], v[122:123], v[176:179]
 v_cvt_pk_bf16_f32 v48, v164, v165
 v_cvt_pk_bf16_f32 v49, v166, v167
 v_cvt_pk_bf16_f32 v50, v168, v169
 v_cvt_pk_bf16_f32 v51, v170, v171
 buffer_store_dwordx4 v[48:51], v11, s[4:7], s33 offen offset:0 sc1
 s_nop 3
 v_cvt_pk_bf16_f32 v52, v172, v173
 v_cvt_pk_bf16_f32 v53, v174, v175
 v_cvt_pk_bf16_f32 v54, v176, v177
 v_cvt_pk_bf16_f32 v55, v178, v179
 buffer_store_dwordx4 v[52:55], v11, s[4:7], s33 offen offset:2048 sc1
 s_cmp_ge_u32 s33, 268435456
 s_cselect_b32 s34, 268435456, s67
 s_add_u32 s67, s67, 4
 s_lshl_b32 s33, s53, 19
 s_add_u32 s33, s33, s54
 s_xor_b32 s33, s33, 8192
 s_add_u32 s33, s33, 67108864
 s_add_u32 s53, s53, 1
 v_mov_b32 v10, s53
 s_mov_b64 exec, 1
 buffer_store_dword v10, off, s[4:7], s35
 s_mov_b64 exec, -1
 s_waitcnt vmcnt(5)
L_pk_303:
 v_max3_u32 v7, v124, v128, v132
 v_max_u32 v7, v7, v136
 v_cmp_eq_u32 vcc, -1, v7
 s_cbranch_vccnz L_rt_304
 s_mov_b32 s51, 0
 buffer_load_dword v7, off, s[4:7], s17 sc1
 s_waitcnt vmcnt(0)
L_go_305:
 v_cmp_gt_u32 vcc, s53, v7
 s_cbranch_vccnz L_rt_306
 s_mov_b32 s51, 0
 s_nop 15
 s_nop 15
 s_nop 15
 s_nop 15
 buffer_load_dwordx4 v[40:43], v2, s[4:7], s57 offen offset:0 sc1
 buffer_load_dwordx4 v[44:47], v2, s[4:7], s57 offen offset:128 sc1
 buffer_load_dwordx4 v[48:51], v2, s[4:7], s57 offen offset:1024 sc1
 buffer_load_dwordx4 v[52:55], v2, s[4:7], s57 offen offset:1152 sc1
 buffer_load_dwordx4 v[56:59], v3, s[4:7], s57 offen offset:0 sc1
L_xm_307:
 s_waitcnt vmcnt(4)
 v_mfma_f32_16x16x32_bf16 v[60:63], v[24:27], v[40:43], 0
 s_waitcnt vmcnt(3)
 v_mfma_f32_16x16x32_bf16 v[64:67], v[24:27], v[44:47], 0
 s_waitcnt vmcnt(2)
 v_mfma_f32_16x16x32_bf16 v[68:71], v[24:27], v[48:51], 0
 v_max3_u32 v7, v40, v44, v48
 v_cvt_pk_bf16_f32 v60, v60, v61
 v_cvt_pk_bf16_f32 v61, v62, v63
 ds_write_b64 v4, v[60:61] offset:0
 s_waitcnt vmcnt(1)
 v_mfma_f32_16x16x32_bf16 v[72:75], v[24:27], v[52:55], 0
 v_cvt_pk_bf16_f32 v64, v64, v65
 v_cvt_pk_bf16_f32 v65, v66, v67
 ds_write_b64 v4, v[64:65] offset:8
 s_waitcnt vmcnt(0)
 v_mfma_f32_16x16x32_bf16 v[76:79], v[24:27], v[56:59], 0
 v_max3_u32 v7, v7, v52, v56
 v_cmp_eq_u32 vcc, -1, v7
 v_cvt_pk_bf16_f32 v68, v68, v69
 v_cvt_pk_bf16_f32 v69, v70, v71
 ds_write_b64 v4, v[68:69] offset:1024
 s_cbranch_vccnz L_rt_308
 v_cvt_pk_bf16_f32 v72, v72, v73
 v_cvt_pk_bf16_f32 v73, v74, v75
 ds_write_b64 v4, v[72:73] offset:1032
 s_nop 0
 v_cvt_pk_bf16_f32 v76, v76, v77
 v_cvt_pk_bf16_f32 v77, v78, v79
 ds_write_b64 v5, v[76:77] offset:0
 s_waitcnt lgkmcnt(0)
 s_barrier
 ds_read_b128 v[56:59], v23 offset:0
 ds_read_b128 v[60:63], v23 offset:32
 ds_read_b128 v[64:67], v23 offset:1024
 s_cmp_ge_u32 s34, 268435456
 s_cbranch_scc1 L_ns_309
 v_mov_b32 v10, 1
 s_mov_b64 exec, 31
 buffer_atomic_add v10, v12, s[4:7], s34 offen
 s_mov_b64 exec, -1
 L_ns_309:
 buffer_load_dword v13, off, s[4:7], s32 sc1
 s_waitcnt lgkmcnt(2)
 v_smfmac_f32_16x16x64_bf16 v[80:83], v[56:59], v[192:199], v8
 ds_read_b128 v[68:71], v23 offset:1056
 v_smfmac_f32_16x16x64_bf16 v[84:87], v[56:59], v[200:207], v8
 ds_read_b128 v[72:75], v23 offset:2048
 s_waitcnt lgkmcnt(3)
 v_smfmac_f32_16x16x64_bf16 v[80:83], v[60:63], v[208:215], v8
 ds_read_b128 v[76:79], v23 offset:2080
 v_smfmac_f32_16x16x64_bf16 v[84:87], v[60:63], v[216:223], v8
 ds_read_b128 v[180:183], v23 offset:3072
 s_waitcnt lgkmcnt(4)
 v_smfmac_f32_16x16x64_bf16 v[80:83], v[64:67], v[224:231], v8
 ds_read_b128 v[40:43], v14 offset:0
 v_smfmac_f32_16x16x64_bf16 v[84:87], v[64:67], v[232:239], v8
 ds_read_b128 v[184:187], v23 offset:3104
 s_waitcnt lgkmcnt(5)
 v_smfmac_f32_16x16x64_bf16 v[80:83], v[68:71], v[240:247], v8
 ds_read_b128 v[44:47], v14 offset:1024
 v_smfmac_f32_16x16x64_bf16 v[84:87], v[68:71], v[248:255], v8
 ds_read_b128 v[56:59], v23 offset:4096
 s_waitcnt lgkmcnt(6)
 v_smfmac_f32_16x16x64_bf16 v[80:83], v[72:75], a[0:7], v8
 ds_read_b128 v[48:51], v14 offset:2048
 v_smfmac_f32_16x16x64_bf16 v[84:87], v[72:75], a[8:15], v8
 ds_read_b128 v[60:63], v23 offset:4128
 s_waitcnt lgkmcnt(7)
 v_smfmac_f32_16x16x64_bf16 v[80:83], v[76:79], a[16:23], v8
 ds_read_b128 v[52:55], v14 offset:3072
 v_smfmac_f32_16x16x64_bf16 v[84:87], v[76:79], a[24:31], v8
 ds_read_b128 v[64:67], v23 offset:5120
 s_waitcnt lgkmcnt(8)
 v_smfmac_f32_16x16x64_bf16 v[80:83], v[180:183], a[32:39], v8
 ds_read_b128 v[148:151], v15 offset:0
 v_smfmac_f32_16x16x64_bf16 v[84:87], v[180:183], a[40:47], v8
 ds_read_b128 v[68:71], v23 offset:5152
 s_waitcnt lgkmcnt(8)
 v_smfmac_f32_16x16x64_bf16 v[80:83], v[184:187], a[48:55], v8
 ds_read_b128 v[152:155], v15 offset:1024
 v_smfmac_f32_16x16x64_bf16 v[84:87], v[184:187], a[56:63], v8
 ds_read_b128 v[72:75], v23 offset:6144
 s_waitcnt lgkmcnt(8)
 v_smfmac_f32_16x16x64_bf16 v[80:83], v[56:59], a[64:71], v8
 ds_read_b128 v[156:159], v15 offset:2048
 v_smfmac_f32_16x16x64_bf16 v[84:87], v[56:59], a[72:79], v8
 ds_read_b128 v[76:79], v23 offset:6176
 s_waitcnt lgkmcnt(8)
 v_smfmac_f32_16x16x64_bf16 v[80:83], v[60:63], a[80:87], v8
 ds_read_b128 v[160:163], v15 offset:3072
 v_smfmac_f32_16x16x64_bf16 v[84:87], v[60:63], a[88:95], v8
 ds_read_b128 v[180:183], v23 offset:7168
 s_waitcnt lgkmcnt(8)
 v_smfmac_f32_16x16x64_bf16 v[80:83], v[64:67], a[96:103], v8
 ds_read_b128 v[164:167], v15 offset:4096
 v_smfmac_f32_16x16x64_bf16 v[84:87], v[64:67], a[104:111], v8
 ds_read_b128 v[184:187], v23 offset:7200
 s_waitcnt lgkmcnt(8)
 v_smfmac_f32_16x16x64_bf16 v[80:83], v[68:71], a[112:119], v8
 ds_read_b128 v[168:171], v15 offset:5120
 v_smfmac_f32_16x16x64_bf16 v[84:87], v[68:71], a[120:127], v8
 ds_read_b128 v[56:59], v23 offset:8192
 s_waitcnt lgkmcnt(8)
 v_smfmac_f32_16x16x64_bf16 v[80:83], v[72:75], a[128:135], v8
 ds_read_b128 v[172:175], v15 offset:6144
 v_smfmac_f32_16x16x64_bf16 v[84:87], v[72:75], a[136:143], v8
 ds_read_b128 v[60:63], v23 offset:8224
 s_waitcnt lgkmcnt(8)
 v_smfmac_f32_16x16x64_bf16 v[80:83], v[76:79], a[144:151], v8
 ds_read_b128 v[176:179], v15 offset:7168
 v_smfmac_f32_16x16x64_bf16 v[84:87], v[76:79], a[152:159], v8
 ds_read_b128 v[64:67], v23 offset:9216
 s_waitcnt lgkmcnt(8)
 v_smfmac_f32_16x16x64_bf16 v[80:83], v[180:183], a[160:167], v8
 ds_read_b128 v[140:143], v17 offset:10240
 v_smfmac_f32_16x16x64_bf16 v[84:87], v[180:183], a[168:175], v8
 ds_read_b128 v[68:71], v23 offset:9248
 s_waitcnt lgkmcnt(8)
 v_smfmac_f32_16x16x64_bf16 v[80:83], v[184:187], a[176:183], v8
 ds_read_b128 v[144:147], v17 offset:11264
 v_smfmac_f32_16x16x64_bf16 v[84:87], v[184:187], a[184:191], v8
 s_waitcnt lgkmcnt(7)
 v_smfmac_f32_16x16x64_bf16 v[80:83], v[56:59], a[192:199], v8
 v_smfmac_f32_16x16x64_bf16 v[84:87], v[56:59], a[200:207], v8
 s_waitcnt lgkmcnt(5)
 v_smfmac_f32_16x16x64_bf16 v[80:83], v[60:63], a[208:215], v8
 v_smfmac_f32_16x16x64_bf16 v[84:87], v[60:63], a[216:223], v8
 s_waitcnt lgkmcnt(3)
 v_smfmac_f32_16x16x64_bf16 v[80:83], v[64:67], a[224:231], v8
 v_smfmac_f32_16x16x64_bf16 v[84:87], v[64:67], a[232:239], v8
 s_waitcnt lgkmcnt(1)
 v_smfmac_f32_16x16x64_bf16 v[80:83], v[68:71], a[240:247], v8
 v_smfmac_f32_16x16x64_bf16 v[84:87], v[68:71], a[248:255], v8
 s_lshl_b32 s16, s53, 19
 s_add_u32 s16, s16, s54
 s_xor_b32 s72, s16, 8192
 s_add_u32 s72, s72, s71
 s_add_u32 s16, s16, s70
 v_cvt_pk_bf16_f32 v36, v80, v81
 v_cvt_pk_bf16_f32 v37, v82, v83
 s_nop 2
 v_cvt_pk_bf16_f32 v38, v84, v85
 v_cvt_pk_bf16_f32 v39, v86, v87
 buffer_store_dwordx4 v[36:39], v18, s[4:7], s61 offen
 ds_write_b128 v16, v[36:39] offset:14336
 s_waitcnt vmcnt(1) lgkmcnt(1)
L_wf_310:
 v_cmp_ge_u32 vcc, s53, v13
 s_cbranch_vccnz L_rt_311
 v_mfma_f32_16x16x32_bf16 v[100:103], v[148:151], v[40:43], v[108:111]
 s_add_u32 m0, s68, 49152
 s_nop 0
 buffer_load_dwordx4 v1, s[4:7], s72 offen offset:0 sc1 nt lds
 ds_read_b128 v[56:59], v19 offset:0
 v_mfma_f32_16x16x32_bf16 v[104:107], v[164:167], v[40:43], v[112:115]
 ds_read_b128 v[60:63], v19 offset:1024
 v_mfma_f32_16x16x32_bf16 v[96:99], v[124:127], v[40:43], 0
 ds_read_b128 v[64:67], v19 offset:2048
 v_mfma_f32_16x16x32_bf16 v[100:103], v[152:155], v[44:47], v[100:103]
 ds_read_b128 v[68:71], v19 offset:3072
 buffer_load_dwordx4 v1, s[4:7], s72 offen offset:1024 sc1 nt lds
 v_mfma_f32_16x16x32_bf16 v[104:107], v[168:171], v[44:47], v[104:107]
 ds_read_b128 v[72:75], v19 offset:4096
 v_mfma_f32_16x16x32_bf16 v[96:99], v[128:131], v[44:47], v[96:99]
 ds_read_b128 v[76:79], v19 offset:5120
 v_mfma_f32_16x16x32_bf16 v[100:103], v[156:159], v[48:51], v[100:103]
 ds_read_b128 v[180:183], v19 offset:6144
 v_mfma_f32_16x16x32_bf16 v[104:107], v[172:175], v[48:51], v[104:107]
 buffer_load_dwordx4 v1, s[4:7], s72 offen offset:2048 sc1 nt lds
 ds_read_b128 v[184:187], v19 offset:7168
 v_mfma_f32_16x16x32_bf16 v[96:99], v[132:135], v[48:51], v[96:99]
 v_mfma_f32_16x16x32_bf16 v[100:103], v[160:163], v[52:55], v[100:103]
 v_mfma_f32_16x16x32_bf16 v[104:107], v[176:179], v[52:55], v[104:107]
 v_mfma_f32_16x16x32_bf16 v[96:99], v[136:139], v[52:55], v[96:99]
 v_mov_b32 v80, 0
 v_mov_b32 v81, 0
 buffer_load_dwordx4 v1, s[4:7], s72 offen offset:3072 sc1 nt lds
 v_mov_b32 v82, 0
 v_mov_b32 v83, 0
 v_mov_b32 v84, 0
 v_mov_b32 v85, 0
 v_mov_b32 v86, 0
 v_mov_b32 v87, 0
 v_cvt_pk_bf16_f32 v7, v100, v101
 s_add_u32 m0, s69, 49152
 s_nop 0
 buffer_load_dwordx4 v1, s[4:7], s16 offen offset:0 sc1 lds
 v_lshlrev_b32 v100, 16, v7
 v_and_b32 v101, 0xffff0000, v7
 v_cvt_pk_bf16_f32 v7, v102, v103
 v_lshlrev_b32 v102, 16, v7
 v_and_b32 v103, 0xffff0000, v7
 v_cvt_pk_bf16_f32 v7, v104, v105
 v_lshlrev_b32 v104, 16, v7
 buffer_load_dwordx4 v1, s[4:7], s16 offen offset:1024 sc1 lds
 v_and_b32 v105, 0xffff0000, v7
 v_cvt_pk_bf16_f32 v7, v106, v107
 v_lshlrev_b32 v106, 16, v7
 v_and_b32 v107, 0xffff0000, v7
 v_cvt_pk_bf16_f32 v7, v98, v99
 v_lshlrev_b32 v98, 16, v7
 v_and_b32 v99, 0xffff0000, v7
 buffer_load_dwordx4 v1, s[4:7], s16 offen offset:2048 sc1 lds
 v_pk_mul_f32 v[100:101], v[100:101], s[64:65] op_sel:[0,1] op_sel_hi:[1,1]
 v_pk_mul_f32 v[102:103], v[102:103], s[64:65] op_sel:[0,1] op_sel_hi:[1,1]
 v_pk_mul_f32 v[104:105], v[104:105], s[64:65] op_sel:[0,1] op_sel_hi:[1,1]
 v_pk_mul_f32 v[106:107], v[106:107], s[64:65] op_sel:[0,1] op_sel_hi:[1,1]
 v_pk_mul_f32 v[98:99], v[98:99], s[64:65] op_sel:[0,1] op_sel_hi:[1,1]
 v_cvt_pk_bf16_f32 v7, v100, v101
 v_lshlrev_b32 v100, 16, v7
 buffer_load_dwordx4 v1, s[4:7], s16 offen offset:3072 sc1 lds
 v_and_b32 v101, 0xffff0000, v7
 v_cvt_pk_bf16_f32 v7, v102, v103
 v_lshlrev_b32 v102, 16, v7
 v_and_b32 v103, 0xffff0000, v7
 v_cvt_pk_bf16_f32 v7, v104, v105
 v_lshlrev_b32 v104, 16, v7
 v_and_b32 v105, 0xffff0000, v7
 s_add_u32 m0, s69, 53248
 s_nop 0
 buffer_load_dwordx4 v6, s[4:7], s16 offen offset:0 sc1 lds
 v_cvt_pk_bf16_f32 v7, v106, v107
 v_lshlrev_b32 v106, 16, v7
 v_and_b32 v107, 0xffff0000, v7
 v_cvt_pk_bf16_f32 v7, v98, v99
 v_lshlrev_b32 v98, 16, v7
 v_and_b32 v99, 0xffff0000, v7
 v_max_f32 v20, v100, v101
 buffer_load_dwordx4 v6, s[4:7], s16 offen offset:1024 sc1 lds
 v_max3_f32 v20, v20, v102, v103
 v_max3_f32 v20, v20, v104, v105
 v_max3_f32 v20, v20, v106, v107
 v_max3_f32 v20, v20, v98, v99
 v_mov_b32 v22, v20
 s_nop 1
 v_permlane16_swap_b32 v20, v22
 buffer_load_dwordx4 v6, s[4:7], s16 offen offset:2048 sc1 lds
 v_max_f32 v20, v20, v22
 v_mov_b32 v22, v20
 s_nop 1
 v_permlane32_swap_b32 v20, v22
 v_max_f32 v20, v20, v22
 v_mul_f32 v22, s66, v20
 v_fma_f32 v100, v100, s66, -v22
 buffer_load_dwordx4 v6, s[4:7], s16 offen offset:3072 sc1 lds
 v_fma_f32 v101, v101, s66, -v22
 v_fma_f32 v102, v102, s66, -v22
 v_fma_f32 v103, v103, s66, -v22
 v_fma_f32 v104, v104, s66, -v22
 v_fma_f32 v105, v105, s66, -v22
 v_fma_f32 v106, v106, s66, -v22
 v_fma_f32 v107, v107, s66, -v22
 buffer_store_dwordx4 v[32:35], v18, s[4:7], s60 offen
 v_fma_f32 v98, v98, s66, -v22
 v_fma_f32 v99, v99, s66, -v22
 v_exp_f32 v100, v100
 v_exp_f32 v101, v101
 v_exp_f32 v102, v102
 v_exp_f32 v103, v103
 v_exp_f32 v104, v104
 buffer_load_dwordx4 v[124:127], v1, s[4:7], s61 offen offset:0 sc1
 v_exp_f32 v105, v105
 v_exp_f32 v106, v106
 v_exp_f32 v107, v107
 v_exp_f32 v98, v98
 v_exp_f32 v99, v99
 v_add_f32 v28, v100, v101
 v_add_f32 v28, v28, v102
 buffer_load_dwordx4 v[128:131], v1, s[4:7], s61 offen offset:1024 sc1
 v_add_f32 v28, v28, v103
 v_add_f32 v28, v28, v104
 v_add_f32 v28, v28, v105
 v_add_f32 v28, v28, v106
 v_add_f32 v28, v28, v107
 v_add_f32 v28, v28, v98
 v_add_f32 v28, v28, v99
 buffer_load_dwordx4 v[132:135], v1, s[4:7], s61 offen offset:2048 sc1
 v_mov_b32 v22, v28
 s_nop 1
 v_permlane16_swap_b32 v28, v22
 v_add_f32 v28, v28, v22
 v_mov_b32 v22, v28
 s_nop 1
 v_permlane32_swap_b32 v28, v22
 buffer_load_dwordx4 v[136:139], v1, s[4:7], s61 offen offset:3072 sc1
 v_add_f32 v28, v28, v22
 v_rcp_f32 v28, v28
 s_nop 0
 v_pk_mul_f32 v[100:101], v[100:101], v[28:29] op_sel_hi:[1,0]
 v_pk_mul_f32 v[102:103], v[102:103], v[28:29] op_sel_hi:[1,0]
 v_pk_mul_f32 v[104:105], v[104:105], v[28:29] op_sel_hi:[1,0]
 v_pk_mul_f32 v[106:107], v[106:107], v[28:29] op_sel_hi:[1,0]
 v_pk_mul_f32 v[98:99], v[98:99], v[28:29] op_sel_hi:[1,0]
 v_cvt_pk_bf16_f32 v116, v100, v101
 v_cvt_pk_bf16_f32 v117, v102, v103
 v_cvt_pk_bf16_f32 v118, v104, v105
 v_cvt_pk_bf16_f32 v119, v106, v107
 v_cvt_pk_bf16_f32 v120, v98, v99
 v_cvt_pk_bf16_f32 v123, v98, v99
 s_waitcnt lgkmcnt(0)
 v_mfma_f32_16x16x32_bf16 v[148:151], v[56:59], v[116:119], 0
 v_mfma_f32_16x16x32_bf16 v[152:155], v[60:63], v[116:119], 0
 v_mfma_f32_16x16x16_bf16 v[148:151], v[140:141], v[120:121], v[148:151]
 v_mfma_f32_16x16x32_bf16 v[156:159], v[64:67], v[116:119], 0
 v_mfma_f32_16x16x16_bf16 v[152:155], v[140:141], v[122:123], v[152:155]
 v_mfma_f32_16x16x32_bf16 v[160:163], v[68:71], v[116:119], 0
 v_mfma_f32_16x16x16_bf16 v[156:159], v[142:143], v[120:121], v[156:159]
 v_mfma_f32_16x16x32_bf16 v[164:167], v[72:75], v[116:119], 0
 v_mfma_f32_16x16x16_bf16 v[160:163], v[142:143], v[122:123], v[160:163]
 v_cvt_pk_bf16_f32 v40, v148, v149
 v_cvt_pk_bf16_f32 v41, v150, v151
 v_cvt_pk_bf16_f32 v42, v152, v153
 v_cvt_pk_bf16_f32 v43, v154, v155
 buffer_store_dwordx4 v[40:43], v11, s[4:7], s33 offen offset:0 sc1
 v_mfma_f32_16x16x32_bf16 v[168:171], v[76:79], v[116:119], 0
 v_mfma_f32_16x16x16_bf16 v[164:167], v[144:145], v[120:121], v[164:167]
 v_mfma_f32_16x16x32_bf16 v[172:175], v[180:183], v[116:119], 0
 v_mfma_f32_16x16x16_bf16 v[168:171], v[144:145], v[122:123], v[168:171]
 v_cvt_pk_bf16_f32 v44, v156, v157
 v_cvt_pk_bf16_f32 v45, v158, v159
 v_cvt_pk_bf16_f32 v46, v160, v161
 v_cvt_pk_bf16_f32 v47, v162, v163
 buffer_store_dwordx4 v[44:47], v11, s[4:7], s33 offen offset:2048 sc1
 s_add_u32 s33, s33, 4096
 v_mfma_f32_16x16x32_bf16 v[176:179], v[184:187], v[116:119], 0
 v_mfma_f32_16x16x16_bf16 v[172:175], v[146:147], v[120:121], v[172:175]
 v_mfma_f32_16x16x16_bf16 v[176:179], v[146:147], v[122:123], v[176:179]
 v_cvt_pk_bf16_f32 v48, v164, v165
 v_cvt_pk_bf16_f32 v49, v166, v167
 v_cvt_pk_bf16_f32 v50, v168, v169
 v_cvt_pk_bf16_f32 v51, v170, v171
 buffer_store_dwordx4 v[48:51], v11, s[4:7], s33 offen offset:0 sc1
 s_nop 3
 v_cvt_pk_bf16_f32 v52, v172, v173
 v_cvt_pk_bf16_f32 v53, v174, v175
 v_cvt_pk_bf16_f32 v54, v176, v177
 v_cvt_pk_bf16_f32 v55, v178, v179
 buffer_store_dwordx4 v[52:55], v11, s[4:7], s33 offen offset:2048 sc1
 s_cmp_ge_u32 s33, 268435456
 s_cselect_b32 s34, 268435456, s67
 s_add_u32 s67, s67, 4
 s_lshl_b32 s33, s53, 19
 s_add_u32 s33, s33, s54
 s_xor_b32 s33, s33, 8192
 s_add_u32 s33, s33, 67108864
 s_add_u32 s53, s53, 1
 v_mov_b32 v10, s53
 s_mov_b64 exec, 1
 buffer_store_dword v10, off, s[4:7], s35
 s_mov_b64 exec, -1
 s_waitcnt vmcnt(5)
L_pk_312:
 v_max3_u32 v7, v124, v128, v132
 v_max_u32 v7, v7, v136
 v_cmp_eq_u32 vcc, -1, v7
 s_cbranch_vccnz L_rt_313
 s_mov_b32 s51, 0
 buffer_load_dword v7, off, s[4:7], s17 sc1
 s_waitcnt vmcnt(0)
L_go_314:
 v_cmp_gt_u32 vcc, s53, v7
 s_cbranch_vccnz L_rt_315
 s_mov_b32 s51, 0
 s_nop 15
 s_nop 15
 s_nop 15
 s_nop 15
 buffer_load_dwordx4 v[40:43], v2, s[4:7], s58 offen offset:0 sc1
 buffer_load_dwordx4 v[44:47], v2, s[4:7], s58 offen offset:128 sc1
 buffer_load_dwordx4 v[48:51], v2, s[4:7], s58 offen offset:1024 sc1
 buffer_load_dwordx4 v[52:55], v2, s[4:7], s58 offen offset:1152 sc1
 buffer_load_dwordx4 v[56:59], v3, s[4:7], s58 offen offset:0 sc1
L_xm_316:
 s_waitcnt vmcnt(4)
 v_mfma_f32_16x16x32_bf16 v[60:63], v[24:27], v[40:43], 0
 s_waitcnt vmcnt(3)
 v_mfma_f32_16x16x32_bf16 v[64:67], v[24:27], v[44:47], 0
 s_waitcnt vmcnt(2)
 v_mfma_f32_16x16x32_bf16 v[68:71], v[24:27], v[48:51], 0
 v_max3_u32 v7, v40, v44, v48
 v_cvt_pk_bf16_f32 v60, v60, v61
 v_cvt_pk_bf16_f32 v61, v62, v63
 ds_write_b64 v4, v[60:61] offset:0
 s_waitcnt vmcnt(1)
 v_mfma_f32_16x16x32_bf16 v[72:75], v[24:27], v[52:55], 0
 v_cvt_pk_bf16_f32 v64, v64, v65
 v_cvt_pk_bf16_f32 v65, v66, v67
 ds_write_b64 v4, v[64:65] offset:8
 s_waitcnt vmcnt(0)
 v_mfma_f32_16x16x32_bf16 v[76:79], v[24:27], v[56:59], 0
 v_max3_u32 v7, v7, v52, v56
 v_cmp_eq_u32 vcc, -1, v7
 v_cvt_pk_bf16_f32 v68, v68, v69
 v_cvt_pk_bf16_f32 v69, v70, v71
 ds_write_b64 v4, v[68:69] offset:1024
 s_cbranch_vccnz L_rt_317
 v_cvt_pk_bf16_f32 v72, v72, v73
 v_cvt_pk_bf16_f32 v73, v74, v75
 ds_write_b64 v4, v[72:73] offset:1032
 s_nop 0
 v_cvt_pk_bf16_f32 v76, v76, v77
 v_cvt_pk_bf16_f32 v77, v78, v79
 ds_write_b64 v5, v[76:77] offset:0
 s_waitcnt lgkmcnt(0)
 s_barrier
 ds_read_b128 v[56:59], v23 offset:0
 ds_read_b128 v[60:63], v23 offset:32
 ds_read_b128 v[64:67], v23 offset:1024
 s_cmp_ge_u32 s34, 268435456
 s_cbranch_scc1 L_ns_318
 v_mov_b32 v10, 1
 s_mov_b64 exec, 31
 buffer_atomic_add v10, v12, s[4:7], s34 offen
 s_mov_b64 exec, -1
 L_ns_318:
 buffer_load_dword v13, off, s[4:7], s32 sc1
 s_waitcnt lgkmcnt(2)
 v_smfmac_f32_16x16x64_bf16 v[80:83], v[56:59], v[192:199], v8
 ds_read_b128 v[68:71], v23 offset:1056
 v_smfmac_f32_16x16x64_bf16 v[84:87], v[56:59], v[200:207], v8
 ds_read_b128 v[72:75], v23 offset:2048
 s_waitcnt lgkmcnt(3)
 v_smfmac_f32_16x16x64_bf16 v[80:83], v[60:63], v[208:215], v8
 ds_read_b128 v[76:79], v23 offset:2080
 v_smfmac_f32_16x16x64_bf16 v[84:87], v[60:63], v[216:223], v8
 ds_read_b128 v[180:183], v23 offset:3072
 s_waitcnt lgkmcnt(4)
 v_smfmac_f32_16x16x64_bf16 v[80:83], v[64:67], v[224:231], v8
 ds_read_b128 v[40:43], v14 offset:49152
 v_smfmac_f32_16x16x64_bf16 v[84:87], v[64:67], v[232:239], v8
 ds_read_b128 v[184:187], v23 offset:3104
 s_waitcnt lgkmcnt(5)
 v_smfmac_f32_16x16x64_bf16 v[80:83], v[68:71], v[240:247], v8
 ds_read_b128 v[44:47], v14 offset:50176
 v_smfmac_f32_16x16x64_bf16 v[84:87], v[68:71], v[248:255], v8
 ds_read_b128 v[56:59], v23 offset:4096
 s_waitcnt lgkmcnt(6)
 v_smfmac_f32_16x16x64_bf16 v[80:83], v[72:75], a[0:7], v8
 ds_read_b128 v[48:51], v14 offset:51200
 v_smfmac_f32_16x16x64_bf16 v[84:87], v[72:75], a[8:15], v8
 ds_read_b128 v[60:63], v23 offset:4128
 s_waitcnt lgkmcnt(7)
 v_smfmac_f32_16x16x64_bf16 v[80:83], v[76:79], a[16:23], v8
 ds_read_b128 v[52:55], v14 offset:52224
 v_smfmac_f32_16x16x64_bf16 v[84:87], v[76:79], a[24:31], v8
 ds_read_b128 v[64:67], v23 offset:5120
 s_waitcnt lgkmcnt(8)
 v_smfmac_f32_16x16x64_bf16 v[80:83], v[180:183], a[32:39], v8
 ds_read_b128 v[148:151], v15 offset:49152
 v_smfmac_f32_16x16x64_bf16 v[84:87], v[180:183], a[40:47], v8
 ds_read_b128 v[68:71], v23 offset:5152
 s_waitcnt lgkmcnt(8)
 v_smfmac_f32_16x16x64_bf16 v[80:83], v[184:187], a[48:55], v8
 ds_read_b128 v[152:155], v15 offset:50176
 v_smfmac_f32_16x16x64_bf16 v[84:87], v[184:187], a[56:63], v8
 ds_read_b128 v[72:75], v23 offset:6144
 s_waitcnt lgkmcnt(8)
 v_smfmac_f32_16x16x64_bf16 v[80:83], v[56:59], a[64:71], v8
 ds_read_b128 v[156:159], v15 offset:51200
 v_smfmac_f32_16x16x64_bf16 v[84:87], v[56:59], a[72:79], v8
 ds_read_b128 v[76:79], v23 offset:6176
 s_waitcnt lgkmcnt(8)
 v_smfmac_f32_16x16x64_bf16 v[80:83], v[60:63], a[80:87], v8
 ds_read_b128 v[160:163], v15 offset:52224
 v_smfmac_f32_16x16x64_bf16 v[84:87], v[60:63], a[88:95], v8
 ds_read_b128 v[180:183], v23 offset:7168
 s_waitcnt lgkmcnt(8)
 v_smfmac_f32_16x16x64_bf16 v[80:83], v[64:67], a[96:103], v8
 ds_read_b128 v[164:167], v15 offset:53248
 v_smfmac_f32_16x16x64_bf16 v[84:87], v[64:67], a[104:111], v8
 ds_read_b128 v[184:187], v23 offset:7200
 s_waitcnt lgkmcnt(8)
 v_smfmac_f32_16x16x64_bf16 v[80:83], v[68:71], a[112:119], v8
 ds_read_b128 v[168:171], v15 offset:54272
 v_smfmac_f32_16x16x64_bf16 v[84:87], v[68:71], a[120:127], v8
 ds_read_b128 v[56:59], v23 offset:8192
 s_waitcnt lgkmcnt(8)
 v_smfmac_f32_16x16x64_bf16 v[80:83], v[72:75], a[128:135], v8
 ds_read_b128 v[172:175], v15 offset:55296
 v_smfmac_f32_16x16x64_bf16 v[84:87], v[72:75], a[136:143], v8
 ds_read_b128 v[60:63], v23 offset:8224
 s_waitcnt lgkmcnt(8)
 v_smfmac_f32_16x16x64_bf16 v[80:83], v[76:79], a[144:151], v8
 ds_read_b128 v[176:179], v15 offset:56320
 v_smfmac_f32_16x16x64_bf16 v[84:87], v[76:79], a[152:159], v8
 ds_read_b128 v[64:67], v23 offset:9216
 s_waitcnt lgkmcnt(8)
 v_smfmac_f32_16x16x64_bf16 v[80:83], v[180:183], a[160:167], v8
 ds_read_b128 v[140:143], v17 offset:14336
 v_smfmac_f32_16x16x64_bf16 v[84:87], v[180:183], a[168:175], v8
 ds_read_b128 v[68:71], v23 offset:9248
 s_waitcnt lgkmcnt(8)
 v_smfmac_f32_16x16x64_bf16 v[80:83], v[184:187], a[176:183], v8
 ds_read_b128 v[144:147], v17 offset:15360
 v_smfmac_f32_16x16x64_bf16 v[84:87], v[184:187], a[184:191], v8
 s_waitcnt lgkmcnt(7)
 v_smfmac_f32_16x16x64_bf16 v[80:83], v[56:59], a[192:199], v8
 v_smfmac_f32_16x16x64_bf16 v[84:87], v[56:59], a[200:207], v8
 s_waitcnt lgkmcnt(5)
 v_smfmac_f32_16x16x64_bf16 v[80:83], v[60:63], a[208:215], v8
 v_smfmac_f32_16x16x64_bf16 v[84:87], v[60:63], a[216:223], v8
 s_waitcnt lgkmcnt(3)
 v_smfmac_f32_16x16x64_bf16 v[80:83], v[64:67], a[224:231], v8
 v_smfmac_f32_16x16x64_bf16 v[84:87], v[64:67], a[232:239], v8
 s_waitcnt lgkmcnt(1)
 v_smfmac_f32_16x16x64_bf16 v[80:83], v[68:71], a[240:247], v8
 v_smfmac_f32_16x16x64_bf16 v[84:87], v[68:71], a[248:255], v8
 s_lshl_b32 s16, s53, 19
 s_add_u32 s16, s16, s54
 s_xor_b32 s72, s16, 8192
 s_add_u32 s72, s72, s71
 s_add_u32 s16, s16, s70
 v_cvt_pk_bf16_f32 v36, v80, v81
 v_cvt_pk_bf16_f32 v37, v82, v83
 s_nop 2
 v_cvt_pk_bf16_f32 v38, v84, v85
 v_cvt_pk_bf16_f32 v39, v86, v87
 buffer_store_dwordx4 v[36:39], v18, s[4:7], s62 offen
 ds_write_b128 v16, v[36:39] offset:10240
 s_waitcnt vmcnt(1) lgkmcnt(1)
L_wf_319:
 v_cmp_ge_u32 vcc, s53, v13
 s_cbranch_vccnz L_rt_320
 v_mfma_f32_16x16x32_bf16 v[100:103], v[148:151], v[40:43], v[108:111]
 s_add_u32 m0, s68, 0
 s_nop 0
 buffer_load_dwordx4 v1, s[4:7], s72 offen offset:0 sc1 nt lds
 ds_read_b128 v[56:59], v19 offset:49152
 v_mfma_f32_16x16x32_bf16 v[104:107], v[164:167], v[40:43], v[112:115]
 ds_read_b128 v[60:63], v19 offset:50176
 v_mfma_f32_16x16x32_bf16 v[96:99], v[124:127], v[40:43], 0
 ds_read_b128 v[64:67], v19 offset:51200
 v_mfma_f32_16x16x32_bf16 v[100:103], v[152:155], v[44:47], v[100:103]
 ds_read_b128 v[68:71], v19 offset:52224
 buffer_load_dwordx4 v1, s[4:7], s72 offen offset:1024 sc1 nt lds
 v_mfma_f32_16x16x32_bf16 v[104:107], v[168:171], v[44:47], v[104:107]
 ds_read_b128 v[72:75], v19 offset:53248
 v_mfma_f32_16x16x32_bf16 v[96:99], v[128:131], v[44:47], v[96:99]
 ds_read_b128 v[76:79], v19 offset:54272
 v_mfma_f32_16x16x32_bf16 v[100:103], v[156:159], v[48:51], v[100:103]
 ds_read_b128 v[180:183], v19 offset:55296
 v_mfma_f32_16x16x32_bf16 v[104:107], v[172:175], v[48:51], v[104:107]
 buffer_load_dwordx4 v1, s[4:7], s72 offen offset:2048 sc1 nt lds
 ds_read_b128 v[184:187], v19 offset:56320
 v_mfma_f32_16x16x32_bf16 v[96:99], v[132:135], v[48:51], v[96:99]
 v_mfma_f32_16x16x32_bf16 v[100:103], v[160:163], v[52:55], v[100:103]
 v_mfma_f32_16x16x32_bf16 v[104:107], v[176:179], v[52:55], v[104:107]
 v_mfma_f32_16x16x32_bf16 v[96:99], v[136:139], v[52:55], v[96:99]
 v_mov_b32 v80, 0
 v_mov_b32 v81, 0
 buffer_load_dwordx4 v1, s[4:7], s72 offen offset:3072 sc1 nt lds
 v_mov_b32 v82, 0
 v_mov_b32 v83, 0
 v_mov_b32 v84, 0
 v_mov_b32 v85, 0
 v_mov_b32 v86, 0
 v_mov_b32 v87, 0
 v_cvt_pk_bf16_f32 v7, v100, v101
 s_add_u32 m0, s69, 0
 s_nop 0
 buffer_load_dwordx4 v1, s[4:7], s16 offen offset:0 sc1 lds
 v_lshlrev_b32 v100, 16, v7
 v_and_b32 v101, 0xffff0000, v7
 v_cvt_pk_bf16_f32 v7, v102, v103
 v_lshlrev_b32 v102, 16, v7
 v_and_b32 v103, 0xffff0000, v7
 v_cvt_pk_bf16_f32 v7, v104, v105
 v_lshlrev_b32 v104, 16, v7
 buffer_load_dwordx4 v1, s[4:7], s16 offen offset:1024 sc1 lds
 v_and_b32 v105, 0xffff0000, v7
 v_cvt_pk_bf16_f32 v7, v106, v107
 v_lshlrev_b32 v106, 16, v7
 v_and_b32 v107, 0xffff0000, v7
 v_cvt_pk_bf16_f32 v7, v98, v99
 v_lshlrev_b32 v98, 16, v7
 v_and_b32 v99, 0xffff0000, v7
 buffer_load_dwordx4 v1, s[4:7], s16 offen offset:2048 sc1 lds
 v_pk_mul_f32 v[100:101], v[100:101], s[64:65] op_sel:[0,1] op_sel_hi:[1,1]
 v_pk_mul_f32 v[102:103], v[102:103], s[64:65] op_sel:[0,1] op_sel_hi:[1,1]
 v_pk_mul_f32 v[104:105], v[104:105], s[64:65] op_sel:[0,1] op_sel_hi:[1,1]
 v_pk_mul_f32 v[106:107], v[106:107], s[64:65] op_sel:[0,1] op_sel_hi:[1,1]
 v_pk_mul_f32 v[98:99], v[98:99], s[64:65] op_sel:[0,1] op_sel_hi:[1,1]
 v_cvt_pk_bf16_f32 v7, v100, v101
 v_lshlrev_b32 v100, 16, v7
 buffer_load_dwordx4 v1, s[4:7], s16 offen offset:3072 sc1 lds
 v_and_b32 v101, 0xffff0000, v7
 v_cvt_pk_bf16_f32 v7, v102, v103
 v_lshlrev_b32 v102, 16, v7
 v_and_b32 v103, 0xffff0000, v7
 v_cvt_pk_bf16_f32 v7, v104, v105
 v_lshlrev_b32 v104, 16, v7
 v_and_b32 v105, 0xffff0000, v7
 s_add_u32 m0, s69, 4096
 s_nop 0
 buffer_load_dwordx4 v6, s[4:7], s16 offen offset:0 sc1 lds
 v_cvt_pk_bf16_f32 v7, v106, v107
 v_lshlrev_b32 v106, 16, v7
 v_and_b32 v107, 0xffff0000, v7
 v_cvt_pk_bf16_f32 v7, v98, v99
 v_lshlrev_b32 v98, 16, v7
 v_and_b32 v99, 0xffff0000, v7
 v_max_f32 v20, v100, v101
 buffer_load_dwordx4 v6, s[4:7], s16 offen offset:1024 sc1 lds
 v_max3_f32 v20, v20, v102, v103
 v_max3_f32 v20, v20, v104, v105
 v_max3_f32 v20, v20, v106, v107
 v_max3_f32 v20, v20, v98, v99
 v_mov_b32 v22, v20
 s_nop 1
 v_permlane16_swap_b32 v20, v22
 buffer_load_dwordx4 v6, s[4:7], s16 offen offset:2048 sc1 lds
 v_max_f32 v20, v20, v22
 v_mov_b32 v22, v20
 s_nop 1
 v_permlane32_swap_b32 v20, v22
 v_max_f32 v20, v20, v22
 v_mul_f32 v22, s66, v20
 v_fma_f32 v100, v100, s66, -v22
 buffer_load_dwordx4 v6, s[4:7], s16 offen offset:3072 sc1 lds
 v_fma_f32 v101, v101, s66, -v22
 v_fma_f32 v102, v102, s66, -v22
 v_fma_f32 v103, v103, s66, -v22
 v_fma_f32 v104, v104, s66, -v22
 v_fma_f32 v105, v105, s66, -v22
 v_fma_f32 v106, v106, s66, -v22
 v_fma_f32 v107, v107, s66, -v22
 buffer_store_dwordx4 v[32:35], v18, s[4:7], s61 offen
 v_fma_f32 v98, v98, s66, -v22
 v_fma_f32 v99, v99, s66, -v22
 v_exp_f32 v100, v100
 v_exp_f32 v101, v101
 v_exp_f32 v102, v102
 v_exp_f32 v103, v103
 v_exp_f32 v104, v104
 buffer_load_dwordx4 v[124:127], v1, s[4:7], s62 offen offset:0 sc1
 v_exp_f32 v105, v105
 v_exp_f32 v106, v106
 v_exp_f32 v107, v107
 v_exp_f32 v98, v98
 v_exp_f32 v99, v99
 v_add_f32 v28, v100, v101
 v_add_f32 v28, v28, v102
 buffer_load_dwordx4 v[128:131], v1, s[4:7], s62 offen offset:1024 sc1
 v_add_f32 v28, v28, v103
 v_add_f32 v28, v28, v104
 v_add_f32 v28, v28, v105
 v_add_f32 v28, v28, v106
 v_add_f32 v28, v28, v107
 v_add_f32 v28, v28, v98
 v_add_f32 v28, v28, v99
 buffer_load_dwordx4 v[132:135], v1, s[4:7], s62 offen offset:2048 sc1
 v_mov_b32 v22, v28
 s_nop 1
 v_permlane16_swap_b32 v28, v22
 v_add_f32 v28, v28, v22
 v_mov_b32 v22, v28
 s_nop 1
 v_permlane32_swap_b32 v28, v22
 buffer_load_dwordx4 v[136:139], v1, s[4:7], s62 offen offset:3072 sc1
 v_add_f32 v28, v28, v22
 v_rcp_f32 v28, v28
 s_nop 0
 v_pk_mul_f32 v[100:101], v[100:101], v[28:29] op_sel_hi:[1,0]
 v_pk_mul_f32 v[102:103], v[102:103], v[28:29] op_sel_hi:[1,0]
 v_pk_mul_f32 v[104:105], v[104:105], v[28:29] op_sel_hi:[1,0]
 v_pk_mul_f32 v[106:107], v[106:107], v[28:29] op_sel_hi:[1,0]
 v_pk_mul_f32 v[98:99], v[98:99], v[28:29] op_sel_hi:[1,0]
 v_cvt_pk_bf16_f32 v116, v100, v101
 v_cvt_pk_bf16_f32 v117, v102, v103
 v_cvt_pk_bf16_f32 v118, v104, v105
 v_cvt_pk_bf16_f32 v119, v106, v107
 v_cvt_pk_bf16_f32 v120, v98, v99
 v_cvt_pk_bf16_f32 v123, v98, v99
 s_waitcnt lgkmcnt(0)
 v_mfma_f32_16x16x32_bf16 v[148:151], v[56:59], v[116:119], 0
 v_mfma_f32_16x16x32_bf16 v[152:155], v[60:63], v[116:119], 0
 v_mfma_f32_16x16x16_bf16 v[148:151], v[140:141], v[120:121], v[148:151]
 v_mfma_f32_16x16x32_bf16 v[156:159], v[64:67], v[116:119], 0
 v_mfma_f32_16x16x16_bf16 v[152:155], v[140:141], v[122:123], v[152:155]
 v_mfma_f32_16x16x32_bf16 v[160:163], v[68:71], v[116:119], 0
 v_mfma_f32_16x16x16_bf16 v[156:159], v[142:143], v[120:121], v[156:159]
 v_mfma_f32_16x16x32_bf16 v[164:167], v[72:75], v[116:119], 0
 v_mfma_f32_16x16x16_bf16 v[160:163], v[142:143], v[122:123], v[160:163]
 v_cvt_pk_bf16_f32 v40, v148, v149
 v_cvt_pk_bf16_f32 v41, v150, v151
 v_cvt_pk_bf16_f32 v42, v152, v153
 v_cvt_pk_bf16_f32 v43, v154, v155
 buffer_store_dwordx4 v[40:43], v11, s[4:7], s33 offen offset:0 sc1
 v_mfma_f32_16x16x32_bf16 v[168:171], v[76:79], v[116:119], 0
 v_mfma_f32_16x16x16_bf16 v[164:167], v[144:145], v[120:121], v[164:167]
 v_mfma_f32_16x16x32_bf16 v[172:175], v[180:183], v[116:119], 0
 v_mfma_f32_16x16x16_bf16 v[168:171], v[144:145], v[122:123], v[168:171]
 v_cvt_pk_bf16_f32 v44, v156, v157
 v_cvt_pk_bf16_f32 v45, v158, v159
 v_cvt_pk_bf16_f32 v46, v160, v161
 v_cvt_pk_bf16_f32 v47, v162, v163
 buffer_store_dwordx4 v[44:47], v11, s[4:7], s33 offen offset:2048 sc1
 s_add_u32 s33, s33, 4096
 v_mfma_f32_16x16x32_bf16 v[176:179], v[184:187], v[116:119], 0
 v_mfma_f32_16x16x16_bf16 v[172:175], v[146:147], v[120:121], v[172:175]
 v_mfma_f32_16x16x16_bf16 v[176:179], v[146:147], v[122:123], v[176:179]
 v_cvt_pk_bf16_f32 v48, v164, v165
 v_cvt_pk_bf16_f32 v49, v166, v167
 v_cvt_pk_bf16_f32 v50, v168, v169
 v_cvt_pk_bf16_f32 v51, v170, v171
 buffer_store_dwordx4 v[48:51], v11, s[4:7], s33 offen offset:0 sc1
 s_nop 3
 v_cvt_pk_bf16_f32 v52, v172, v173
 v_cvt_pk_bf16_f32 v53, v174, v175
 v_cvt_pk_bf16_f32 v54, v176, v177
 v_cvt_pk_bf16_f32 v55, v178, v179
 buffer_store_dwordx4 v[52:55], v11, s[4:7], s33 offen offset:2048 sc1
 s_cmp_ge_u32 s33, 268435456
 s_cselect_b32 s34, 268435456, s67
 s_add_u32 s67, s67, 4
 s_lshl_b32 s33, s53, 19
 s_add_u32 s33, s33, s54
 s_xor_b32 s33, s33, 8192
 s_add_u32 s33, s33, 67108864
 s_add_u32 s53, s53, 1
 v_mov_b32 v10, s53
 s_mov_b64 exec, 1
 buffer_store_dword v10, off, s[4:7], s35
 s_mov_b64 exec, -1
 s_waitcnt vmcnt(5)
L_pk_321:
 v_max3_u32 v7, v124, v128, v132
 v_max_u32 v7, v7, v136
 v_cmp_eq_u32 vcc, -1, v7
 s_cbranch_vccnz L_rt_322
 s_mov_b32 s51, 0
 buffer_load_dword v7, off, s[4:7], s17 sc1
 s_waitcnt vmcnt(0)
L_go_323:
 v_cmp_gt_u32 vcc, s53, v7
 s_cbranch_vccnz L_rt_324
 s_mov_b32 s51, 0
 s_nop 15
 s_nop 15
 s_nop 15
 s_nop 15
 buffer_load_dwordx4 v[40:43], v2, s[4:7], s59 offen offset:0 sc1
 buffer_load_dwordx4 v[44:47], v2, s[4:7], s59 offen offset:128 sc1
 buffer_load_dwordx4 v[48:51], v2, s[4:7], s59 offen offset:1024 sc1
 buffer_load_dwordx4 v[52:55], v2, s[4:7], s59 offen offset:1152 sc1
 buffer_load_dwordx4 v[56:59], v3, s[4:7], s59 offen offset:0 sc1
L_xm_325:
 s_waitcnt vmcnt(4)
 v_mfma_f32_16x16x32_bf16 v[60:63], v[24:27], v[40:43], 0
 s_waitcnt vmcnt(3)
 v_mfma_f32_16x16x32_bf16 v[64:67], v[24:27], v[44:47], 0
 s_waitcnt vmcnt(2)
 v_mfma_f32_16x16x32_bf16 v[68:71], v[24:27], v[48:51], 0
 v_max3_u32 v7, v40, v44, v48
 v_cvt_pk_bf16_f32 v60, v60, v61
 v_cvt_pk_bf16_f32 v61, v62, v63
 ds_write_b64 v4, v[60:61] offset:0
 s_waitcnt vmcnt(1)
 v_mfma_f32_16x16x32_bf16 v[72:75], v[24:27], v[52:55], 0
 v_cvt_pk_bf16_f32 v64, v64, v65
 v_cvt_pk_bf16_f32 v65, v66, v67
 ds_write_b64 v4, v[64:65] offset:8
 s_waitcnt vmcnt(0)
 v_mfma_f32_16x16x32_bf16 v[76:79], v[24:27], v[56:59], 0
 v_max3_u32 v7, v7, v52, v56
 v_cmp_eq_u32 vcc, -1, v7
 v_cvt_pk_bf16_f32 v68, v68, v69
 v_cvt_pk_bf16_f32 v69, v70, v71
 ds_write_b64 v4, v[68:69] offset:1024
 s_cbranch_vccnz L_rt_326
 v_cvt_pk_bf16_f32 v72, v72, v73
 v_cvt_pk_bf16_f32 v73, v74, v75
 ds_write_b64 v4, v[72:73] offset:1032
 s_nop 0
 v_cvt_pk_bf16_f32 v76, v76, v77
 v_cvt_pk_bf16_f32 v77, v78, v79
 ds_write_b64 v5, v[76:77] offset:0
 s_waitcnt lgkmcnt(0)
 s_barrier
 ds_read_b128 v[56:59], v23 offset:0
 ds_read_b128 v[60:63], v23 offset:32
 ds_read_b128 v[64:67], v23 offset:1024
 s_cmp_ge_u32 s34, 268435456
 s_cbranch_scc1 L_ns_327
 v_mov_b32 v10, 1
 s_mov_b64 exec, 31
 buffer_atomic_add v10, v12, s[4:7], s34 offen
 s_mov_b64 exec, -1
 L_ns_327:
 buffer_load_dword v13, off, s[4:7], s32 sc1
 s_waitcnt lgkmcnt(2)
 v_smfmac_f32_16x16x64_bf16 v[80:83], v[56:59], v[192:199], v8
 ds_read_b128 v[68:71], v23 offset:1056
 v_smfmac_f32_16x16x64_bf16 v[84:87], v[56:59], v[200:207], v8
 ds_read_b128 v[72:75], v23 offset:2048
 s_waitcnt lgkmcnt(3)
 v_smfmac_f32_16x16x64_bf16 v[80:83], v[60:63], v[208:215], v8
 ds_read_b128 v[76:79], v23 offset:2080
 v_smfmac_f32_16x16x64_bf16 v[84:87], v[60:63], v[216:223], v8
 ds_read_b128 v[180:183], v23 offset:3072
 s_waitcnt lgkmcnt(4)
 v_smfmac_f32_16x16x64_bf16 v[80:83], v[64:67], v[224:231], v8
 ds_read_b128 v[40:43], v14 offset:0
 v_smfmac_f32_16x16x64_bf16 v[84:87], v[64:67], v[232:239], v8
 ds_read_b128 v[184:187], v23 offset:3104
 s_waitcnt lgkmcnt(5)
 v_smfmac_f32_16x16x64_bf16 v[80:83], v[68:71], v[240:247], v8
 ds_read_b128 v[44:47], v14 offset:1024
 v_smfmac_f32_16x16x64_bf16 v[84:87], v[68:71], v[248:255], v8
 ds_read_b128 v[56:59], v23 offset:4096
 s_waitcnt lgkmcnt(6)
 v_smfmac_f32_16x16x64_bf16 v[80:83], v[72:75], a[0:7], v8
 ds_read_b128 v[48:51], v14 offset:2048
 v_smfmac_f32_16x16x64_bf16 v[84:87], v[72:75], a[8:15], v8
 ds_read_b128 v[60:63], v23 offset:4128
 s_waitcnt lgkmcnt(7)
 v_smfmac_f32_16x16x64_bf16 v[80:83], v[76:79], a[16:23], v8
 ds_read_b128 v[52:55], v14 offset:3072
 v_smfmac_f32_16x16x64_bf16 v[84:87], v[76:79], a[24:31], v8
 ds_read_b128 v[64:67], v23 offset:5120
 s_waitcnt lgkmcnt(8)
 v_smfmac_f32_16x16x64_bf16 v[80:83], v[180:183], a[32:39], v8
 ds_read_b128 v[148:151], v15 offset:0
 v_smfmac_f32_16x16x64_bf16 v[84:87], v[180:183], a[40:47], v8
 ds_read_b128 v[68:71], v23 offset:5152
 s_waitcnt lgkmcnt(8)
 v_smfmac_f32_16x16x64_bf16 v[80:83], v[184:187], a[48:55], v8
 ds_read_b128 v[152:155], v15 offset:1024
 v_smfmac_f32_16x16x64_bf16 v[84:87], v[184:187], a[56:63], v8
 ds_read_b128 v[72:75], v23 offset:6144
 s_waitcnt lgkmcnt(8)
 v_smfmac_f32_16x16x64_bf16 v[80:83], v[56:59], a[64:71], v8
 ds_read_b128 v[156:159], v15 offset:2048
 v_smfmac_f32_16x16x64_bf16 v[84:87], v[56:59], a[72:79], v8
 ds_read_b128 v[76:79], v23 offset:6176
 s_waitcnt lgkmcnt(8)
 v_smfmac_f32_16x16x64_bf16 v[80:83], v[60:63], a[80:87], v8
 ds_read_b128 v[160:163], v15 offset:3072
 v_smfmac_f32_16x16x64_bf16 v[84:87], v[60:63], a[88:95], v8
 ds_read_b128 v[180:183], v23 offset:7168
 s_waitcnt lgkmcnt(8)
 v_smfmac_f32_16x16x64_bf16 v[80:83], v[64:67], a[96:103], v8
 ds_read_b128 v[164:167], v15 offset:4096
 v_smfmac_f32_16x16x64_bf16 v[84:87], v[64:67], a[104:111], v8
 ds_read_b128 v[184:187], v23 offset:7200
 s_waitcnt lgkmcnt(8)
 v_smfmac_f32_16x16x64_bf16 v[80:83], v[68:71], a[112:119], v8
 ds_read_b128 v[168:171], v15 offset:5120
 v_smfmac_f32_16x16x64_bf16 v[84:87], v[68:71], a[120:127], v8
 ds_read_b128 v[56:59], v23 offset:8192
 s_waitcnt lgkmcnt(8)
 v_smfmac_f32_16x16x64_bf16 v[80:83], v[72:75], a[128:135], v8
 ds_read_b128 v[172:175], v15 offset:6144
 v_smfmac_f32_16x16x64_bf16 v[84:87], v[72:75], a[136:143], v8
 ds_read_b128 v[60:63], v23 offset:8224
 s_waitcnt lgkmcnt(8)
 v_smfmac_f32_16x16x64_bf16 v[80:83], v[76:79], a[144:151], v8
 ds_read_b128 v[176:179], v15 offset:7168
 v_smfmac_f32_16x16x64_bf16 v[84:87], v[76:79], a[152:159], v8
 ds_read_b128 v[64:67], v23 offset:9216
 s_waitcnt lgkmcnt(8)
 v_smfmac_f32_16x16x64_bf16 v[80:83], v[180:183], a[160:167], v8
 ds_read_b128 v[140:143], v17 offset:10240
 v_smfmac_f32_16x16x64_bf16 v[84:87], v[180:183], a[168:175], v8
 ds_read_b128 v[68:71], v23 offset:9248
 s_waitcnt lgkmcnt(8)
 v_smfmac_f32_16x16x64_bf16 v[80:83], v[184:187], a[176:183], v8
 ds_read_b128 v[144:147], v17 offset:11264
 v_smfmac_f32_16x16x64_bf16 v[84:87], v[184:187], a[184:191], v8
 s_waitcnt lgkmcnt(7)
 v_smfmac_f32_16x16x64_bf16 v[80:83], v[56:59], a[192:199], v8
 v_smfmac_f32_16x16x64_bf16 v[84:87], v[56:59], a[200:207], v8
 s_waitcnt lgkmcnt(5)
 v_smfmac_f32_16x16x64_bf16 v[80:83], v[60:63], a[208:215], v8
 v_smfmac_f32_16x16x64_bf16 v[84:87], v[60:63], a[216:223], v8
 s_waitcnt lgkmcnt(3)
 v_smfmac_f32_16x16x64_bf16 v[80:83], v[64:67], a[224:231], v8
 v_smfmac_f32_16x16x64_bf16 v[84:87], v[64:67], a[232:239], v8
 s_waitcnt lgkmcnt(1)
 v_smfmac_f32_16x16x64_bf16 v[80:83], v[68:71], a[240:247], v8
 v_smfmac_f32_16x16x64_bf16 v[84:87], v[68:71], a[248:255], v8
 s_lshl_b32 s16, s53, 19
 s_add_u32 s16, s16, s54
 s_xor_b32 s72, s16, 8192
 s_add_u32 s72, s72, s71
 s_add_u32 s16, s16, s70
 v_cvt_pk_bf16_f32 v36, v80, v81
 v_cvt_pk_bf16_f32 v37, v82, v83
 s_nop 2
 v_cvt_pk_bf16_f32 v38, v84, v85
 v_cvt_pk_bf16_f32 v39, v86, v87
 buffer_store_dwordx4 v[36:39], v18, s[4:7], s63 offen
 ds_write_b128 v16, v[36:39] offset:14336
 s_waitcnt vmcnt(1) lgkmcnt(1)
L_wf_328:
 v_cmp_ge_u32 vcc, s53, v13
 s_cbranch_vccnz L_rt_329
 v_mfma_f32_16x16x32_bf16 v[100:103], v[148:151], v[40:43], v[108:111]
 s_add_u32 m0, s68, 49152
 s_nop 0
 buffer_load_dwordx4 v1, s[4:7], s72 offen offset:0 sc1 nt lds
 ds_read_b128 v[56:59], v19 offset:0
 v_mfma_f32_16x16x32_bf16 v[104:107], v[164:167], v[40:43], v[112:115]
 ds_read_b128 v[60:63], v19 offset:1024
 v_mfma_f32_16x16x32_bf16 v[96:99], v[124:127], v[40:43], 0
 ds_read_b128 v[64:67], v19 offset:2048
 v_mfma_f32_16x16x32_bf16 v[100:103], v[152:155], v[44:47], v[100:103]
 ds_read_b128 v[68:71], v19 offset:3072
 buffer_load_dwordx4 v1, s[4:7], s72 offen offset:1024 sc1 nt lds
 v_mfma_f32_16x16x32_bf16 v[104:107], v[168:171], v[44:47], v[104:107]
 ds_read_b128 v[72:75], v19 offset:4096
 v_mfma_f32_16x16x32_bf16 v[96:99], v[128:131], v[44:47], v[96:99]
 ds_read_b128 v[76:79], v19 offset:5120
 v_mfma_f32_16x16x32_bf16 v[100:103], v[156:159], v[48:51], v[100:103]
 ds_read_b128 v[180:183], v19 offset:6144
 v_mfma_f32_16x16x32_bf16 v[104:107], v[172:175], v[48:51], v[104:107]
 buffer_load_dwordx4 v1, s[4:7], s72 offen offset:2048 sc1 nt lds
 ds_read_b128 v[184:187], v19 offset:7168
 v_mfma_f32_16x16x32_bf16 v[96:99], v[132:135], v[48:51], v[96:99]
 v_mfma_f32_16x16x32_bf16 v[100:103], v[160:163], v[52:55], v[100:103]
 v_mfma_f32_16x16x32_bf16 v[104:107], v[176:179], v[52:55], v[104:107]
 v_mfma_f32_16x16x32_bf16 v[96:99], v[136:139], v[52:55], v[96:99]
 v_mov_b32 v80, 0
 v_mov_b32 v81, 0
 buffer_load_dwordx4 v1, s[4:7], s72 offen offset:3072 sc1 nt lds
 v_mov_b32 v82, 0
 v_mov_b32 v83, 0
 v_mov_b32 v84, 0
 v_mov_b32 v85, 0
 v_mov_b32 v86, 0
 v_mov_b32 v87, 0
 v_cvt_pk_bf16_f32 v7, v100, v101
 s_add_u32 m0, s69, 49152
 s_nop 0
 buffer_load_dwordx4 v1, s[4:7], s16 offen offset:0 sc1 lds
 v_lshlrev_b32 v100, 16, v7
 v_and_b32 v101, 0xffff0000, v7
 v_cvt_pk_bf16_f32 v7, v102, v103
 v_lshlrev_b32 v102, 16, v7
 v_and_b32 v103, 0xffff0000, v7
 v_cvt_pk_bf16_f32 v7, v104, v105
 v_lshlrev_b32 v104, 16, v7
 buffer_load_dwordx4 v1, s[4:7], s16 offen offset:1024 sc1 lds
 v_and_b32 v105, 0xffff0000, v7
 v_cvt_pk_bf16_f32 v7, v106, v107
 v_lshlrev_b32 v106, 16, v7
 v_and_b32 v107, 0xffff0000, v7
 v_cvt_pk_bf16_f32 v7, v98, v99
 v_lshlrev_b32 v98, 16, v7
 v_and_b32 v99, 0xffff0000, v7
 buffer_load_dwordx4 v1, s[4:7], s16 offen offset:2048 sc1 lds
 v_pk_mul_f32 v[100:101], v[100:101], s[64:65] op_sel:[0,1] op_sel_hi:[1,1]
 v_pk_mul_f32 v[102:103], v[102:103], s[64:65] op_sel:[0,1] op_sel_hi:[1,1]
 v_pk_mul_f32 v[104:105], v[104:105], s[64:65] op_sel:[0,1] op_sel_hi:[1,1]
 v_pk_mul_f32 v[106:107], v[106:107], s[64:65] op_sel:[0,1] op_sel_hi:[1,1]
 v_pk_mul_f32 v[98:99], v[98:99], s[64:65] op_sel:[0,1] op_sel_hi:[1,1]
 v_cvt_pk_bf16_f32 v7, v100, v101
 v_lshlrev_b32 v100, 16, v7
 buffer_load_dwordx4 v1, s[4:7], s16 offen offset:3072 sc1 lds
 v_and_b32 v101, 0xffff0000, v7
 v_cvt_pk_bf16_f32 v7, v102, v103
 v_lshlrev_b32 v102, 16, v7
 v_and_b32 v103, 0xffff0000, v7
 v_cvt_pk_bf16_f32 v7, v104, v105
 v_lshlrev_b32 v104, 16, v7
 v_and_b32 v105, 0xffff0000, v7
 s_add_u32 m0, s69, 53248
 s_nop 0
 buffer_load_dwordx4 v6, s[4:7], s16 offen offset:0 sc1 lds
 v_cvt_pk_bf16_f32 v7, v106, v107
 v_lshlrev_b32 v106, 16, v7
 v_and_b32 v107, 0xffff0000, v7
 v_cvt_pk_bf16_f32 v7, v98, v99
 v_lshlrev_b32 v98, 16, v7
 v_and_b32 v99, 0xffff0000, v7
 v_max_f32 v20, v100, v101
 buffer_load_dwordx4 v6, s[4:7], s16 offen offset:1024 sc1 lds
 v_max3_f32 v20, v20, v102, v103
 v_max3_f32 v20, v20, v104, v105
 v_max3_f32 v20, v20, v106, v107
 v_max3_f32 v20, v20, v98, v99
 v_mov_b32 v22, v20
 s_nop 1
 v_permlane16_swap_b32 v20, v22
 buffer_load_dwordx4 v6, s[4:7], s16 offen offset:2048 sc1 lds
 v_max_f32 v20, v20, v22
 v_mov_b32 v22, v20
 s_nop 1
 v_permlane32_swap_b32 v20, v22
 v_max_f32 v20, v20, v22
 v_mul_f32 v22, s66, v20
 v_fma_f32 v100, v100, s66, -v22
 buffer_load_dwordx4 v6, s[4:7], s16 offen offset:3072 sc1 lds
 v_fma_f32 v101, v101, s66, -v22
 v_fma_f32 v102, v102, s66, -v22
 v_fma_f32 v103, v103, s66, -v22
 v_fma_f32 v104, v104, s66, -v22
 v_fma_f32 v105, v105, s66, -v22
 v_fma_f32 v106, v106, s66, -v22
 v_fma_f32 v107, v107, s66, -v22
 buffer_store_dwordx4 v[32:35], v18, s[4:7], s62 offen
 v_fma_f32 v98, v98, s66, -v22
 v_fma_f32 v99, v99, s66, -v22
 v_exp_f32 v100, v100
 v_exp_f32 v101, v101
 v_exp_f32 v102, v102
 v_exp_f32 v103, v103
 v_exp_f32 v104, v104
 buffer_load_dwordx4 v[124:127], v1, s[4:7], s63 offen offset:0 sc1
 v_exp_f32 v105, v105
 v_exp_f32 v106, v106
 v_exp_f32 v107, v107
 v_exp_f32 v98, v98
 v_exp_f32 v99, v99
 v_add_f32 v28, v100, v101
 v_add_f32 v28, v28, v102
 buffer_load_dwordx4 v[128:131], v1, s[4:7], s63 offen offset:1024 sc1
 v_add_f32 v28, v28, v103
 v_add_f32 v28, v28, v104
 v_add_f32 v28, v28, v105
 v_add_f32 v28, v28, v106
 v_add_f32 v28, v28, v107
 v_add_f32 v28, v28, v98
 v_add_f32 v28, v28, v99
 buffer_load_dwordx4 v[132:135], v1, s[4:7], s63 offen offset:2048 sc1
 v_mov_b32 v22, v28
 s_nop 1
 v_permlane16_swap_b32 v28, v22
 v_add_f32 v28, v28, v22
 v_mov_b32 v22, v28
 s_nop 1
 v_permlane32_swap_b32 v28, v22
 buffer_load_dwordx4 v[136:139], v1, s[4:7], s63 offen offset:3072 sc1
 v_add_f32 v28, v28, v22
 v_rcp_f32 v28, v28
 s_nop 0
 v_pk_mul_f32 v[100:101], v[100:101], v[28:29] op_sel_hi:[1,0]
 v_pk_mul_f32 v[102:103], v[102:103], v[28:29] op_sel_hi:[1,0]
 v_pk_mul_f32 v[104:105], v[104:105], v[28:29] op_sel_hi:[1,0]
 v_pk_mul_f32 v[106:107], v[106:107], v[28:29] op_sel_hi:[1,0]
 v_pk_mul_f32 v[98:99], v[98:99], v[28:29] op_sel_hi:[1,0]
 v_cvt_pk_bf16_f32 v116, v100, v101
 v_cvt_pk_bf16_f32 v117, v102, v103
 v_cvt_pk_bf16_f32 v118, v104, v105
 v_cvt_pk_bf16_f32 v119, v106, v107
 v_cvt_pk_bf16_f32 v120, v98, v99
 v_cvt_pk_bf16_f32 v123, v98, v99
 s_waitcnt lgkmcnt(0)
 v_mfma_f32_16x16x32_bf16 v[148:151], v[56:59], v[116:119], 0
 v_mfma_f32_16x16x32_bf16 v[152:155], v[60:63], v[116:119], 0
 v_mfma_f32_16x16x16_bf16 v[148:151], v[140:141], v[120:121], v[148:151]
 v_mfma_f32_16x16x32_bf16 v[156:159], v[64:67], v[116:119], 0
 v_mfma_f32_16x16x16_bf16 v[152:155], v[140:141], v[122:123], v[152:155]
 v_mfma_f32_16x16x32_bf16 v[160:163], v[68:71], v[116:119], 0
 v_mfma_f32_16x16x16_bf16 v[156:159], v[142:143], v[120:121], v[156:159]
 v_mfma_f32_16x16x32_bf16 v[164:167], v[72:75], v[116:119], 0
 v_mfma_f32_16x16x16_bf16 v[160:163], v[142:143], v[122:123], v[160:163]
 v_cvt_pk_bf16_f32 v40, v148, v149
 v_cvt_pk_bf16_f32 v41, v150, v151
 v_cvt_pk_bf16_f32 v42, v152, v153
 v_cvt_pk_bf16_f32 v43, v154, v155
 buffer_store_dwordx4 v[40:43], v11, s[4:7], s33 offen offset:0 sc1
 v_mfma_f32_16x16x32_bf16 v[168:171], v[76:79], v[116:119], 0
 v_mfma_f32_16x16x16_bf16 v[164:167], v[144:145], v[120:121], v[164:167]
 v_mfma_f32_16x16x32_bf16 v[172:175], v[180:183], v[116:119], 0
 v_mfma_f32_16x16x16_bf16 v[168:171], v[144:145], v[122:123], v[168:171]
 v_cvt_pk_bf16_f32 v44, v156, v157
 v_cvt_pk_bf16_f32 v45, v158, v159
 v_cvt_pk_bf16_f32 v46, v160, v161
 v_cvt_pk_bf16_f32 v47, v162, v163
 buffer_store_dwordx4 v[44:47], v11, s[4:7], s33 offen offset:2048 sc1
 s_add_u32 s33, s33, 4096
 v_mfma_f32_16x16x32_bf16 v[176:179], v[184:187], v[116:119], 0
 v_mfma_f32_16x16x16_bf16 v[172:175], v[146:147], v[120:121], v[172:175]
 v_mfma_f32_16x16x16_bf16 v[176:179], v[146:147], v[122:123], v[176:179]
 v_cvt_pk_bf16_f32 v48, v164, v165
 v_cvt_pk_bf16_f32 v49, v166, v167
 v_cvt_pk_bf16_f32 v50, v168, v169
 v_cvt_pk_bf16_f32 v51, v170, v171
 buffer_store_dwordx4 v[48:51], v11, s[4:7], s33 offen offset:0 sc1
 s_nop 3
 v_cvt_pk_bf16_f32 v52, v172, v173
 v_cvt_pk_bf16_f32 v53, v174, v175
 v_cvt_pk_bf16_f32 v54, v176, v177
 v_cvt_pk_bf16_f32 v55, v178, v179
 buffer_store_dwordx4 v[52:55], v11, s[4:7], s33 offen offset:2048 sc1
 s_cmp_ge_u32 s33, 268435456
 s_cselect_b32 s34, 268435456, s67
 s_add_u32 s67, s67, 4
 s_lshl_b32 s33, s53, 19
 s_add_u32 s33, s33, s54
 s_xor_b32 s33, s33, 8192
 s_add_u32 s33, s33, 67108864
 s_add_u32 s53, s53, 1
 v_mov_b32 v10, s53
 s_mov_b64 exec, 1
 buffer_store_dword v10, off, s[4:7], s35
 s_mov_b64 exec, -1
 s_waitcnt vmcnt(5)
L_pk_330:
 v_max3_u32 v7, v124, v128, v132
 v_max_u32 v7, v7, v136
 v_cmp_eq_u32 vcc, -1, v7
 s_cbranch_vccnz L_rt_331
 s_cmp_eq_u32 s53, 64
 s_cbranch_scc1 L_vr_last
 s_branch L_vr_loopf
L_rt_297:
 s_nop 7
 buffer_load_dword v7, off, s[4:7], s17 sc1
 s_waitcnt vmcnt(0)
 s_add_u32 s51, s51, 1
 s_cmp_lt_u32 s51, 131072
 s_cbranch_scc1 L_go_296
 s_branch L_bail
L_rt_299:
 s_nop 7
 buffer_load_dwordx4 v[40:43], v2, s[4:7], s56 offen offset:0 sc1
 buffer_load_dwordx4 v[44:47], v2, s[4:7], s56 offen offset:128 sc1
 buffer_load_dwordx4 v[48:51], v2, s[4:7], s56 offen offset:1024 sc1
 buffer_load_dwordx4 v[52:55], v2, s[4:7], s56 offen offset:1152 sc1
 buffer_load_dwordx4 v[56:59], v3, s[4:7], s56 offen offset:0 sc1
 s_add_u32 s51, s51, 1
 s_cmp_lt_u32 s51, 131072
 s_cbranch_scc1 L_xm_298
 s_branch L_bail
L_rt_302:
 s_sleep 1
 buffer_load_dword v13, off, s[4:7], s32 sc1
 s_waitcnt vmcnt(0)
 s_add_u32 s51, s51, 1
 s_cmp_lt_u32 s51, 131072
 s_cbranch_scc1 L_wf_301
 s_branch L_bail
L_rt_304:
 s_nop 7
 buffer_load_dwordx4 v[124:127], v1, s[4:7], s60 offen offset:0 sc1
 buffer_load_dwordx4 v[128:131], v1, s[4:7], s60 offen offset:1024 sc1
 buffer_load_dwordx4 v[132:135], v1, s[4:7], s60 offen offset:2048 sc1
 buffer_load_dwordx4 v[136:139], v1, s[4:7], s60 offen offset:3072 sc1
 s_waitcnt vmcnt(0)
 s_add_u32 s51, s51, 1
 s_cmp_lt_u32 s51, 131072
 s_cbranch_scc1 L_pk_303
 s_branch L_bail
L_rt_306:
 s_nop 7
 buffer_load_dword v7, off, s[4:7], s17 sc1
 s_waitcnt vmcnt(0)
 s_add_u32 s51, s51, 1
 s_cmp_lt_u32 s51, 131072
 s_cbranch_scc1 L_go_305
 s_branch L_bail
L_rt_308:
 s_nop 7
 buffer_load_dwordx4 v[40:43], v2, s[4:7], s57 offen offset:0 sc1
 buffer_load_dwordx4 v[44:47], v2, s[4:7], s57 offen offset:128 sc1
 buffer_load_dwordx4 v[48:51], v2, s[4:7], s57 offen offset:1024 sc1
 buffer_load_dwordx4 v[52:55], v2, s[4:7], s57 offen offset:1152 sc1
 buffer_load_dwordx4 v[56:59], v3, s[4:7], s57 offen offset:0 sc1
 s_add_u32 s51, s51, 1
 s_cmp_lt_u32 s51, 131072
 s_cbranch_scc1 L_xm_307
 s_branch L_bail
L_rt_311:
 s_sleep 1
 buffer_load_dword v13, off, s[4:7], s32 sc1
 s_waitcnt vmcnt(0)
 s_add_u32 s51, s51, 1
 s_cmp_lt_u32 s51, 131072
 s_cbranch_scc1 L_wf_310
 s_branch L_bail
L_rt_313:
 s_nop 7
 buffer_load_dwordx4 v[124:127], v1, s[4:7], s61 offen offset:0 sc1
 buffer_load_dwordx4 v[128:131], v1, s[4:7], s61 offen offset:1024 sc1
 buffer_load_dwordx4 v[132:135], v1, s[4:7], s61 offen offset:2048 sc1
 buffer_load_dwordx4 v[136:139], v1, s[4:7], s61 offen offset:3072 sc1
 s_waitcnt vmcnt(0)
 s_add_u32 s51, s51, 1
 s_cmp_lt_u32 s51, 131072
 s_cbranch_scc1 L_pk_312
 s_branch L_bail
L_rt_315:
 s_nop 7
 buffer_load_dword v7, off, s[4:7], s17 sc1
 s_waitcnt vmcnt(0)
 s_add_u32 s51, s51, 1
 s_cmp_lt_u32 s51, 131072
 s_cbranch_scc1 L_go_314
 s_branch L_bail
L_rt_317:
 s_nop 7
 buffer_load_dwordx4 v[40:43], v2, s[4:7], s58 offen offset:0 sc1
 buffer_load_dwordx4 v[44:47], v2, s[4:7], s58 offen offset:128 sc1
 buffer_load_dwordx4 v[48:51], v2, s[4:7], s58 offen offset:1024 sc1
 buffer_load_dwordx4 v[52:55], v2, s[4:7], s58 offen offset:1152 sc1
 buffer_load_dwordx4 v[56:59], v3, s[4:7], s58 offen offset:0 sc1
 s_add_u32 s51, s51, 1
 s_cmp_lt_u32 s51, 131072
 s_cbranch_scc1 L_xm_316
 s_branch L_bail
L_rt_320:
 s_sleep 1
 buffer_load_dword v13, off, s[4:7], s32 sc1
 s_waitcnt vmcnt(0)
 s_add_u32 s51, s51, 1
 s_cmp_lt_u32 s51, 131072
 s_cbranch_scc1 L_wf_319
 s_branch L_bail
L_rt_322:
 s_nop 7
 buffer_load_dwordx4 v[124:127], v1, s[4:7], s62 offen offset:0 sc1
 buffer_load_dwordx4 v[128:131], v1, s[4:7], s62 offen offset:1024 sc1
 buffer_load_dwordx4 v[132:135], v1, s[4:7], s62 offen offset:2048 sc1
 buffer_load_dwordx4 v[136:139], v1, s[4:7], s62 offen offset:3072 sc1
 s_waitcnt vmcnt(0)
 s_add_u32 s51, s51, 1
 s_cmp_lt_u32 s51, 131072
 s_cbranch_scc1 L_pk_321
 s_branch L_bail
L_rt_324:
 s_nop 7
 buffer_load_dword v7, off, s[4:7], s17 sc1
 s_waitcnt vmcnt(0)
 s_add_u32 s51, s51, 1
 s_cmp_lt_u32 s51, 131072
 s_cbranch_scc1 L_go_323
 s_branch L_bail
L_rt_326:
 s_nop 7
 buffer_load_dwordx4 v[40:43], v2, s[4:7], s59 offen offset:0 sc1
 buffer_load_dwordx4 v[44:47], v2, s[4:7], s59 offen offset:128 sc1
 buffer_load_dwordx4 v[48:51], v2, s[4:7], s59 offen offset:1024 sc1
 buffer_load_dwordx4 v[52:55], v2, s[4:7], s59 offen offset:1152 sc1
 buffer_load_dwordx4 v[56:59], v3, s[4:7], s59 offen offset:0 sc1
 s_add_u32 s51, s51, 1
 s_cmp_lt_u32 s51, 131072
 s_cbranch_scc1 L_xm_325
 s_branch L_bail
L_rt_329:
 s_sleep 1
 buffer_load_dword v13, off, s[4:7], s32 sc1
 s_waitcnt vmcnt(0)
 s_add_u32 s51, s51, 1
 s_cmp_lt_u32 s51, 131072
 s_cbranch_scc1 L_wf_328
 s_branch L_bail
L_rt_331:
 s_nop 7
 buffer_load_dwordx4 v[124:127], v1, s[4:7], s63 offen offset:0 sc1
 buffer_load_dwordx4 v[128:131], v1, s[4:7], s63 offen offset:1024 sc1
 buffer_load_dwordx4 v[132:135], v1, s[4:7], s63 offen offset:2048 sc1
 buffer_load_dwordx4 v[136:139], v1, s[4:7], s63 offen offset:3072 sc1
 s_waitcnt vmcnt(0)
 s_add_u32 s51, s51, 1
 s_cmp_lt_u32 s51, 131072
 s_cbranch_scc1 L_pk_330
 s_branch L_bail
.p2align 6
L_vr_loops:
 s_mov_b32 s51, 0
 buffer_load_dword v7, off, s[4:7], s17 sc1
 s_waitcnt vmcnt(0)
L_go_332:
 v_cmp_gt_u32 vcc, s53, v7
 s_cbranch_vccnz L_rt_333
L_vr_ents:
 s_mov_b32 s51, 0
 s_nop 15
 s_nop 15
 s_nop 15
 s_nop 15
 buffer_load_dwordx4 v[40:43], v2, s[4:7], s56 offen offset:0 sc1
 buffer_load_dwordx4 v[44:47], v2, s[4:7], s56 offen offset:128 sc1
 buffer_load_dwordx4 v[48:51], v2, s[4:7], s56 offen offset:1024 sc1
 buffer_load_dwordx4 v[52:55], v2, s[4:7], s56 offen offset:1152 sc1
 buffer_load_dwordx4 v[56:59], v3, s[4:7], s56 offen offset:0 sc1
L_xm_334:
 s_waitcnt vmcnt(4)
 v_mfma_f32_16x16x32_bf16 v[60:63], v[24:27], v[40:43], 0
 s_waitcnt vmcnt(3)
 v_mfma_f32_16x16x32_bf16 v[64:67], v[24:27], v[44:47], 0
 s_waitcnt vmcnt(2)
 v_mfma_f32_16x16x32_bf16 v[68:71], v[24:27], v[48:51], 0
 v_max3_u32 v7, v40, v44, v48
 v_cvt_pk_bf16_f32 v60, v60, v61
 v_cvt_pk_bf16_f32 v61, v62, v63
 ds_write_b64 v4, v[60:61] offset:0
 s_waitcnt vmcnt(1)
 v_mfma_f32_16x16x32_bf16 v[72:75], v[24:27], v[52:55], 0
 v_cvt_pk_bf16_f32 v64, v64, v65
 v_cvt_pk_bf16_f32 v65, v66, v67
 ds_write_b64 v4, v[64:65] offset:8
 s_waitcnt vmcnt(0)
 v_mfma_f32_16x16x32_bf16 v[76:79], v[24:27], v[56:59], 0
 v_max3_u32 v7, v7, v52, v56
 v_cmp_eq_u32 vcc, -1, v7
 v_cvt_pk_bf16_f32 v68, v68, v69
 v_cvt_pk_bf16_f32 v69, v70, v71
 ds_write_b64 v4, v[68:69] offset:1024
 s_cbranch_vccnz L_rt_335
 v_cvt_pk_bf16_f32 v72, v72, v73
 v_cvt_pk_bf16_f32 v73, v74, v75
 ds_write_b64 v4, v[72:73] offset:1032
 s_nop 0
 v_cvt_pk_bf16_f32 v76, v76, v77
 v_cvt_pk_bf16_f32 v77, v78, v79
 ds_write_b64 v5, v[76:77] offset:0
 s_waitcnt lgkmcnt(0)
 s_barrier
 ds_read_b128 v[56:59], v23 offset:0
 ds_read_b128 v[60:63], v23 offset:32
 ds_read_b128 v[64:67], v23 offset:1024
 s_cmp_ge_u32 s34, 268435456
 s_cbranch_scc1 L_ns_336
 v_mov_b32 v10, 1
 s_mov_b64 exec, 31
 buffer_atomic_add v10, v12, s[4:7], s34 offen
 s_mov_b64 exec, -1
 L_ns_336:
 buffer_load_dword v13, off, s[4:7], s32 sc1
 s_waitcnt lgkmcnt(2)
 v_smfmac_f32_16x16x64_bf16 v[80:83], v[56:59], v[192:199], v8
 ds_read_b128 v[68:71], v23 offset:1056
 v_smfmac_f32_16x16x64_bf16 v[84:87], v[56:59], v[200:207], v8
 ds_read_b128 v[72:75], v23 offset:2048
 s_waitcnt lgkmcnt(3)
 v_smfmac_f32_16x16x64_bf16 v[80:83], v[60:63], v[208:215], v8
 ds_read_b128 v[76:79], v23 offset:2080
 v_smfmac_f32_16x16x64_bf16 v[84:87], v[60:63], v[216:223], v8
 ds_read_b128 v[180:183], v23 offset:3072
 s_waitcnt lgkmcnt(4)
 v_smfmac_f32_16x16x64_bf16 v[80:83], v[64:67], v[224:231], v8
 ds_read_b128 v[40:43], v14 offset:49152
 v_smfmac_f32_16x16x64_bf16 v[84:87], v[64:67], v[232:239], v8
 ds_read_b128 v[184:187], v23 offset:3104
 s_waitcnt lgkmcnt(5)
 v_smfmac_f32_16x16x64_bf16 v[80:83], v[68:71], v[240:247], v8
 ds_read_b128 v[44:47], v14 offset:50176
 v_smfmac_f32_16x16x64_bf16 v[84:87], v[68:71], v[248:255], v8
 ds_read_b128 v[56:59], v23 offset:4096
 s_waitcnt lgkmcnt(6)
 v_smfmac_f32_16x16x64_bf16 v[80:83], v[72:75], a[0:7], v8
 ds_read_b128 v[48:51], v14 offset:51200
 v_smfmac_f32_16x16x64_bf16 v[84:87], v[72:75], a[8:15], v8
 ds_read_b128 v[60:63], v23 offset:4128
 s_waitcnt lgkmcnt(7)
 v_smfmac_f32_16x16x64_bf16 v[80:83], v[76:79], a[16:23], v8
 ds_read_b128 v[52:55], v14 offset:52224
 v_smfmac_f32_16x16x64_bf16 v[84:87], v[76:79], a[24:31], v8
 ds_read_b128 v[64:67], v23 offset:5120
 s_waitcnt lgkmcnt(8)
 v_smfmac_f32_16x16x64_bf16 v[80:83], v[180:183], a[32:39], v8
 ds_read_b128 v[148:151], v15 offset:49152
 v_smfmac_f32_16x16x64_bf16 v[84:87], v[180:183], a[40:47], v8
 ds_read_b128 v[68:71], v23 offset:5152
 s_waitcnt lgkmcnt(8)
 v_smfmac_f32_16x16x64_bf16 v[80:83], v[184:187], a[48:55], v8
 ds_read_b128 v[152:155], v15 offset:50176
 v_smfmac_f32_16x16x64_bf16 v[84:87], v[184:187], a[56:63], v8
 ds_read_b128 v[72:75], v23 offset:6144
 s_waitcnt lgkmcnt(8)
 v_smfmac_f32_16x16x64_bf16 v[80:83], v[56:59], a[64:71], v8
 ds_read_b128 v[156:159], v15 offset:51200
 v_smfmac_f32_16x16x64_bf16 v[84:87], v[56:59], a[72:79], v8
 ds_read_b128 v[76:79], v23 offset:6176
 s_waitcnt lgkmcnt(8)
 v_smfmac_f32_16x16x64_bf16 v[80:83], v[60:63], a[80:87], v8
 ds_read_b128 v[160:163], v15 offset:52224
 v_smfmac_f32_16x16x64_bf16 v[84:87], v[60:63], a[88:95], v8
 ds_read_b128 v[180:183], v23 offset:7168
 s_waitcnt lgkmcnt(8)
 v_smfmac_f32_16x16x64_bf16 v[80:83], v[64:67], a[96:103], v8
 ds_read_b128 v[164:167], v15 offset:53248
 v_smfmac_f32_16x16x64_bf16 v[84:87], v[64:67], a[104:111], v8
 ds_read_b128 v[184:187], v23 offset:7200
 s_waitcnt lgkmcnt(8)
 v_smfmac_f32_16x16x64_bf16 v[80:83], v[68:71], a[112:119], v8
 ds_read_b128 v[168:171], v15 offset:54272
 v_smfmac_f32_16x16x64_bf16 v[84:87], v[68:71], a[120:127], v8
 ds_read_b128 v[56:59], v23 offset:8192
 s_waitcnt lgkmcnt(8)
 v_smfmac_f32_16x16x64_bf16 v[80:83], v[72:75], a[128:135], v8
 ds_read_b128 v[172:175], v15 offset:55296
 v_smfmac_f32_16x16x64_bf16 v[84:87], v[72:75], a[136:143], v8
 ds_read_b128 v[60:63], v23 offset:8224
 s_waitcnt lgkmcnt(8)
 v_smfmac_f32_16x16x64_bf16 v[80:83], v[76:79], a[144:151], v8
 ds_read_b128 v[176:179], v15 offset:56320
 v_smfmac_f32_16x16x64_bf16 v[84:87], v[76:79], a[152:159], v8
 ds_read_b128 v[64:67], v23 offset:9216
 s_waitcnt lgkmcnt(8)
 v_smfmac_f32_16x16x64_bf16 v[80:83], v[180:183], a[160:167], v8
 ds_read_b128 v[140:143], v17 offset:14336
 v_smfmac_f32_16x16x64_bf16 v[84:87], v[180:183], a[168:175], v8
 ds_read_b128 v[68:71], v23 offset:9248
 s_waitcnt lgkmcnt(8)
 v_smfmac_f32_16x16x64_bf16 v[80:83], v[184:187], a[176:183], v8
 ds_read_b128 v[144:147], v17 offset:15360
 v_smfmac_f32_16x16x64_bf16 v[84:87], v[184:187], a[184:191], v8
 s_waitcnt lgkmcnt(7)
 v_smfmac_f32_16x16x64_bf16 v[80:83], v[56:59], a[192:199], v8
 v_smfmac_f32_16x16x64_bf16 v[84:87], v[56:59], a[200:207], v8
 s_waitcnt lgkmcnt(5)
 v_smfmac_f32_16x16x64_bf16 v[80:83], v[60:63], a[208:215], v8
 v_smfmac_f32_16x16x64_bf16 v[84:87], v[60:63], a[216:223], v8
 s_waitcnt lgkmcnt(3)
 v_smfmac_f32_16x16x64_bf16 v[80:83], v[64:67], a[224:231], v8
 v_smfmac_f32_16x16x64_bf16 v[84:87], v[64:67], a[232:239], v8
 s_waitcnt lgkmcnt(1)
 v_smfmac_f32_16x16x64_bf16 v[80:83], v[68:71], a[240:247], v8
 v_smfmac_f32_16x16x64_bf16 v[84:87], v[68:71], a[248:255], v8
 s_lshl_b32 s16, s53, 19
 s_add_u32 s16, s16, s54
 s_xor_b32 s72, s16, 8192
 s_add_u32 s72, s72, s71
 s_add_u32 s16, s16, s70
 v_cvt_pk_bf16_f32 v36, v80, v81
 v_cvt_pk_bf16_f32 v37, v82, v83
 s_nop 2
 v_cvt_pk_bf16_f32 v38, v84, v85
 v_cvt_pk_bf16_f32 v39, v86, v87
 buffer_store_dwordx4 v[36:39], v18, s[4:7], s60 offen sc1
 ds_write_b128 v16, v[36:39] offset:10240
 s_waitcnt vmcnt(1) lgkmcnt(1)
L_wf_337:
 v_cmp_ge_u32 vcc, s53, v13
 s_cbranch_vccnz L_rt_338
 v_mfma_f32_16x16x32_bf16 v[100:103], v[148:151], v[40:43], v[108:111]
 s_add_u32 m0, s68, 0
 s_nop 0
 buffer_load_dwordx4 v1, s[4:7], s72 offen offset:0 sc1 nt lds
 ds_read_b128 v[56:59], v19 offset:49152
 v_mfma_f32_16x16x32_bf16 v[104:107], v[164:167], v[40:43], v[112:115]
 ds_read_b128 v[60:63], v19 offset:50176
 v_mfma_f32_16x16x32_bf16 v[96:99], v[124:127], v[40:43], 0
 ds_read_b128 v[64:67], v19 offset:51200
 v_mfma_f32_16x16x32_bf16 v[100:103], v[152:155], v[44:47], v[100:103]
 ds_read_b128 v[68:71], v19 offset:52224
 buffer_load_dwordx4 v1, s[4:7], s72 offen offset:1024 sc1 nt lds
 v_mfma_f32_16x16x32_bf16 v[104:107], v[168:171], v[44:47], v[104:107]
 ds_read_b128 v[72:75], v19 offset:53248
 v_mfma_f32_16x16x32_bf16 v[96:99], v[128:131], v[44:47], v[96:99]
 ds_read_b128 v[76:79], v19 offset:54272
 v_mfma_f32_16x16x32_bf16 v[100:103], v[156:159], v[48:51], v[100:103]
 ds_read_b128 v[180:183], v19 offset:55296
 v_mfma_f32_16x16x32_bf16 v[104:107], v[172:175], v[48:51], v[104:107]
 buffer_load_dwordx4 v1, s[4:7], s72 offen offset:2048 sc1 nt lds
 ds_read_b128 v[184:187], v19 offset:56320
 v_mfma_f32_16x16x32_bf16 v[96:99], v[132:135], v[48:51], v[96:99]
 v_mfma_f32_16x16x32_bf16 v[100:103], v[160:163], v[52:55], v[100:103]
 v_mfma_f32_16x16x32_bf16 v[104:107], v[176:179], v[52:55], v[104:107]
 v_mfma_f32_16x16x32_bf16 v[96:99], v[136:139], v[52:55], v[96:99]
 v_mov_b32 v80, 0
 v_mov_b32 v81, 0
 buffer_load_dwordx4 v1, s[4:7], s72 offen offset:3072 sc1 nt lds
 v_mov_b32 v82, 0
 v_mov_b32 v83, 0
 v_mov_b32 v84, 0
 v_mov_b32 v85, 0
 v_mov_b32 v86, 0
 v_mov_b32 v87, 0
 v_cvt_pk_bf16_f32 v7, v100, v101
 s_add_u32 m0, s69, 0
 s_nop 0
 buffer_load_dwordx4 v1, s[4:7], s16 offen offset:0 sc1 lds
 v_lshlrev_b32 v100, 16, v7
 v_and_b32 v101, 0xffff0000, v7
 v_cvt_pk_bf16_f32 v7, v102, v103
 v_lshlrev_b32 v102, 16, v7
 v_and_b32 v103, 0xffff0000, v7
 v_cvt_pk_bf16_f32 v7, v104, v105
 v_lshlrev_b32 v104, 16, v7
 buffer_load_dwordx4 v1, s[4:7], s16 offen offset:1024 sc1 lds
 v_and_b32 v105, 0xffff0000, v7
 v_cvt_pk_bf16_f32 v7, v106, v107
 v_lshlrev_b32 v106, 16, v7
 v_and_b32 v107, 0xffff0000, v7
 v_cvt_pk_bf16_f32 v7, v98, v99
 v_lshlrev_b32 v98, 16, v7
 v_and_b32 v99, 0xffff0000, v7
 buffer_load_dwordx4 v1, s[4:7], s16 offen offset:2048 sc1 lds
 v_pk_mul_f32 v[100:101], v[100:101], s[64:65] op_sel:[0,1] op_sel_hi:[1,1]
 v_pk_mul_f32 v[102:103], v[102:103], s[64:65] op_sel:[0,1] op_sel_hi:[1,1]
 v_pk_mul_f32 v[104:105], v[104:105], s[64:65] op_sel:[0,1] op_sel_hi:[1,1]
 v_pk_mul_f32 v[106:107], v[106:107], s[64:65] op_sel:[0,1] op_sel_hi:[1,1]
 v_pk_mul_f32 v[98:99], v[98:99], s[64:65] op_sel:[0,1] op_sel_hi:[1,1]
 v_cvt_pk_bf16_f32 v7, v100, v101
 v_lshlrev_b32 v100, 16, v7
 buffer_load_dwordx4 v1, s[4:7], s16 offen offset:3072 sc1 lds
 v_and_b32 v101, 0xffff0000, v7
 v_cvt_pk_bf16_f32 v7, v102, v103
 v_lshlrev_b32 v102, 16, v7
 v_and_b32 v103, 0xffff0000, v7
 v_cvt_pk_bf16_f32 v7, v104, v105
 v_lshlrev_b32 v104, 16, v7
 v_and_b32 v105, 0xffff0000, v7
 s_add_u32 m0, s69, 4096
 s_nop 0
 buffer_load_dwordx4 v6, s[4:7], s16 offen offset:0 sc1 lds
 v_cvt_pk_bf16_f32 v7, v106, v107
 v_lshlrev_b32 v106, 16, v7
 v_and_b32 v107, 0xffff0000, v7
 v_cvt_pk_bf16_f32 v7, v98, v99
 v_lshlrev_b32 v98, 16, v7
 v_and_b32 v99, 0xffff0000, v7
 v_max_f32 v20, v100, v101
 buffer_load_dwordx4 v6, s[4:7], s16 offen offset:1024 sc1 lds
 v_max3_f32 v20, v20, v102, v103
 v_max3_f32 v20, v20, v104, v105
 v_max3_f32 v20, v20, v106, v107
 v_max3_f32 v20, v20, v98, v99
 v_mov_b32 v22, v20
 s_nop 1
 v_permlane16_swap_b32 v20, v22
 buffer_load_dwordx4 v6, s[4:7], s16 offen offset:2048 sc1 lds
 v_max_f32 v20, v20, v22
 v_mov_b32 v22, v20
 s_nop 1
 v_permlane32_swap_b32 v20, v22
 v_max_f32 v20, v20, v22
 v_mul_f32 v22, s66, v20
 v_fma_f32 v100, v100, s66, -v22
 buffer_load_dwordx4 v6, s[4:7], s16 offen offset:3072 sc1 lds
 v_fma_f32 v101, v101, s66, -v22
 v_fma_f32 v102, v102, s66, -v22
 v_fma_f32 v103, v103, s66, -v22
 v_fma_f32 v104, v104, s66, -v22
 v_fma_f32 v105, v105, s66, -v22
 v_fma_f32 v106, v106, s66, -v22
 v_fma_f32 v107, v107, s66, -v22
 buffer_store_dwordx4 v[32:35], v18, s[4:7], s63 offen sc1
 v_fma_f32 v98, v98, s66, -v22
 v_fma_f32 v99, v99, s66, -v22
 v_exp_f32 v100, v100
 v_exp_f32 v101, v101
 v_exp_f32 v102, v102
 v_exp_f32 v103, v103
 v_exp_f32 v104, v104
 buffer_load_dwordx4 v[124:127], v1, s[4:7], s60 offen offset:0 sc1
 v_exp_f32 v105, v105
 v_exp_f32 v106, v106
 v_exp_f32 v107, v107
 v_exp_f32 v98, v98
 v_exp_f32 v99, v99
 v_add_f32 v28, v100, v101
 v_add_f32 v28, v28, v102
 buffer_load_dwordx4 v[128:131], v1, s[4:7], s60 offen offset:1024 sc1
 v_add_f32 v28, v28, v103
 v_add_f32 v28, v28, v104
 v_add_f32 v28, v28, v105
 v_add_f32 v28, v28, v106
 v_add_f32 v28, v28, v107
 v_add_f32 v28, v28, v98
 v_add_f32 v28, v28, v99
 buffer_load_dwordx4 v[132:135], v1, s[4:7], s60 offen offset:2048 sc1
 v_mov_b32 v22, v28
 s_nop 1
 v_permlane16_swap_b32 v28, v22
 v_add_f32 v28, v28, v22
 v_mov_b32 v22, v28
 s_nop 1
 v_permlane32_swap_b32 v28, v22
 buffer_load_dwordx4 v[136:139], v1, s[4:7], s60 offen offset:3072 sc1
 v_add_f32 v28, v28, v22
 v_rcp_f32 v28, v28
 s_nop 0
 v_pk_mul_f32 v[100:101], v[100:101], v[28:29] op_sel_hi:[1,0]
 v_pk_mul_f32 v[102:103], v[102:103], v[28:29] op_sel_hi:[1,0]
 v_pk_mul_f32 v[104:105], v[104:105], v[28:29] op_sel_hi:[1,0]
 v_pk_mul_f32 v[106:107], v[106:107], v[28:29] op_sel_hi:[1,0]
 v_pk_mul_f32 v[98:99], v[98:99], v[28:29] op_sel_hi:[1,0]
 v_cvt_pk_bf16_f32 v116, v100, v101
 v_cvt_pk_bf16_f32 v117, v102, v103
 v_cvt_pk_bf16_f32 v118, v104, v105
 v_cvt_pk_bf16_f32 v119, v106, v107
 v_cvt_pk_bf16_f32 v120, v98, v99
 v_cvt_pk_bf16_f32 v123, v98, v99
 s_waitcnt lgkmcnt(0)
 v_mfma_f32_16x16x32_bf16 v[148:151], v[56:59], v[116:119], 0
 v_mfma_f32_16x16x32_bf16 v[152:155], v[60:63], v[116:119], 0
 v_mfma_f32_16x16x16_bf16 v[148:151], v[140:141], v[120:121], v[148:151]
 v_mfma_f32_16x16x32_bf16 v[156:159], v[64:67], v[116:119], 0
 v_mfma_f32_16x16x16_bf16 v[152:155], v[140:141], v[122:123], v[152:155]
 v_mfma_f32_16x16x32_bf16 v[160:163], v[68:71], v[116:119], 0
 v_mfma_f32_16x16x16_bf16 v[156:159], v[142:143], v[120:121], v[156:159]
 v_mfma_f32_16x16x32_bf16 v[164:167], v[72:75], v[116:119], 0
 v_mfma_f32_16x16x16_bf16 v[160:163], v[142:143], v[122:123], v[160:163]
 v_cvt_pk_bf16_f32 v40, v148, v149
 v_cvt_pk_bf16_f32 v41, v150, v151
 v_cvt_pk_bf16_f32 v42, v152, v153
 v_cvt_pk_bf16_f32 v43, v154, v155
 buffer_store_dwordx4 v[40:43], v11, s[4:7], s33 offen offset:0 sc1
 v_mfma_f32_16x16x32_bf16 v[168:171], v[76:79], v[116:119], 0
 v_mfma_f32_16x16x16_bf16 v[164:167], v[144:145], v[120:121], v[164:167]
 v_mfma_f32_16x16x32_bf16 v[172:175], v[180:183], v[116:119], 0
 v_mfma_f32_16x16x16_bf16 v[168:171], v[144:145], v[122:123], v[168:171]
 v_cvt_pk_bf16_f32 v44, v156, v157
 v_cvt_pk_bf16_f32 v45, v158, v159
 v_cvt_pk_bf16_f32 v46, v160, v161
 v_cvt_pk_bf16_f32 v47, v162, v163
 buffer_store_dwordx4 v[44:47], v11, s[4:7], s33 offen offset:2048 sc1
 s_add_u32 s33, s33, 4096
 v_mfma_f32_16x16x32_bf16 v[176:179], v[184:187], v[116:119], 0
 v_mfma_f32_16x16x16_bf16 v[172:175], v[146:147], v[120:121], v[172:175]
 v_mfma_f32_16x16x16_bf16 v[176:179], v[146:147], v[122:123], v[176:179]
 v_cvt_pk_bf16_f32 v48, v164, v165
 v_cvt_pk_bf16_f32 v49, v166, v167
 v_cvt_pk_bf16_f32 v50, v168, v169
 v_cvt_pk_bf16_f32 v51, v170, v171
 buffer_store_dwordx4 v[48:51], v11, s[4:7], s33 offen offset:0 sc1
 s_nop 3
 v_cvt_pk_bf16_f32 v52, v172, v173
 v_cvt_pk_bf16_f32 v53, v174, v175
 v_cvt_pk_bf16_f32 v54, v176, v177
 v_cvt_pk_bf16_f32 v55, v178, v179
 buffer_store_dwordx4 v[52:55], v11, s[4:7], s33 offen offset:2048 sc1
 s_cmp_ge_u32 s33, 268435456
 s_cselect_b32 s34, 268435456, s67
 s_add_u32 s67, s67, 4
 s_lshl_b32 s33, s53, 19
 s_add_u32 s33, s33, s54
 s_xor_b32 s33, s33, 8192
 s_add_u32 s33, s33, 67108864
 s_add_u32 s53, s53, 1
 v_mov_b32 v10, s53
 s_mov_b64 exec, 1
 buffer_store_dword v10, off, s[4:7], s35 sc1
 s_mov_b64 exec, -1
 s_waitcnt vmcnt(5)
L_pk_339:
 v_max3_u32 v7, v124, v128, v132
 v_max_u32 v7, v7, v136
 v_cmp_eq_u32 vcc, -1, v7
 s_cbranch_vccnz L_rt_340
 s_mov_b32 s51, 0
 buffer_load_dword v7, off, s[4:7], s17 sc1
 s_waitcnt vmcnt(0)
L_go_341:
 v_cmp_gt_u32 vcc, s53, v7
 s_cbranch_vccnz L_rt_342
 s_mov_b32 s51, 0
 s_nop 15
 s_nop 15
 s_nop 15
 s_nop 15
 buffer_load_dwordx4 v[40:43], v2, s[4:7], s57 offen offset:0 sc1
 buffer_load_dwordx4 v[44:47], v2, s[4:7], s57 offen offset:128 sc1
 buffer_load_dwordx4 v[48:51], v2, s[4:7], s57 offen offset:1024 sc1
 buffer_load_dwordx4 v[52:55], v2, s[4:7], s57 offen offset:1152 sc1
 buffer_load_dwordx4 v[56:59], v3, s[4:7], s57 offen offset:0 sc1
L_xm_343:
 s_waitcnt vmcnt(4)
 v_mfma_f32_16x16x32_bf16 v[60:63], v[24:27], v[40:43], 0
 s_waitcnt vmcnt(3)
 v_mfma_f32_16x16x32_bf16 v[64:67], v[24:27], v[44:47], 0
 s_waitcnt vmcnt(2)
 v_mfma_f32_16x16x32_bf16 v[68:71], v[24:27], v[48:51], 0
 v_max3_u32 v7, v40, v44, v48
 v_cvt_pk_bf16_f32 v60, v60, v61
 v_cvt_pk_bf16_f32 v61, v62, v63
 ds_write_b64 v4, v[60:61] offset:0
 s_waitcnt vmcnt(1)
 v_mfma_f32_16x16x32_bf16 v[72:75], v[24:27], v[52:55], 0
 v_cvt_pk_bf16_f32 v64, v64, v65
 v_cvt_pk_bf16_f32 v65, v66, v67
 ds_write_b64 v4, v[64:65] offset:8
 s_waitcnt vmcnt(0)
 v_mfma_f32_16x16x32_bf16 v[76:79], v[24:27], v[56:59], 0
 v_max3_u32 v7, v7, v52, v56
 v_cmp_eq_u32 vcc, -1, v7
 v_cvt_pk_bf16_f32 v68, v68, v69
 v_cvt_pk_bf16_f32 v69, v70, v71
 ds_write_b64 v4, v[68:69] offset:1024
 s_cbranch_vccnz L_rt_344
 v_cvt_pk_bf16_f32 v72, v72, v73
 v_cvt_pk_bf16_f32 v73, v74, v75
 ds_write_b64 v4, v[72:73] offset:1032
 s_nop 0
 v_cvt_pk_bf16_f32 v76, v76, v77
 v_cvt_pk_bf16_f32 v77, v78, v79
 ds_write_b64 v5, v[76:77] offset:0
 s_waitcnt lgkmcnt(0)
 s_barrier
 ds_read_b128 v[56:59], v23 offset:0
 ds_read_b128 v[60:63], v23 offset:32
 ds_read_b128 v[64:67], v23 offset:1024
 s_cmp_ge_u32 s34, 268435456
 s_cbranch_scc1 L_ns_345
 v_mov_b32 v10, 1
 s_mov_b64 exec, 31
 buffer_atomic_add v10, v12, s[4:7], s34 offen
 s_mov_b64 exec, -1
 L_ns_345:
 buffer_load_dword v13, off, s[4:7], s32 sc1
 s_waitcnt lgkmcnt(2)
 v_smfmac_f32_16x16x64_bf16 v[80:83], v[56:59], v[192:199], v8
 ds_read_b128 v[68:71], v23 offset:1056
 v_smfmac_f32_16x16x64_bf16 v[84:87], v[56:59], v[200:207], v8
 ds_read_b128 v[72:75], v23 offset:2048
 s_waitcnt lgkmcnt(3)
 v_smfmac_f32_16x16x64_bf16 v[80:83], v[60:63], v[208:215], v8
 ds_read_b128 v[76:79], v23 offset:2080
 v_smfmac_f32_16x16x64_bf16 v[84:87], v[60:63], v[216:223], v8
 ds_read_b128 v[180:183], v23 offset:3072
 s_waitcnt lgkmcnt(4)
 v_smfmac_f32_16x16x64_bf16 v[80:83], v[64:67], v[224:231], v8
 ds_read_b128 v[40:43], v14 offset:0
 v_smfmac_f32_16x16x64_bf16 v[84:87], v[64:67], v[232:239], v8
 ds_read_b128 v[184:187], v23 offset:3104
 s_waitcnt lgkmcnt(5)
 v_smfmac_f32_16x16x64_bf16 v[80:83], v[68:71], v[240:247], v8
 ds_read_b128 v[44:47], v14 offset:1024
 v_smfmac_f32_16x16x64_bf16 v[84:87], v[68:71], v[248:255], v8
 ds_read_b128 v[56:59], v23 offset:4096
 s_waitcnt lgkmcnt(6)
 v_smfmac_f32_16x16x64_bf16 v[80:83], v[72:75], a[0:7], v8
 ds_read_b128 v[48:51], v14 offset:2048
 v_smfmac_f32_16x16x64_bf16 v[84:87], v[72:75], a[8:15], v8
 ds_read_b128 v[60:63], v23 offset:4128
 s_waitcnt lgkmcnt(7)
 v_smfmac_f32_16x16x64_bf16 v[80:83], v[76:79], a[16:23], v8
 ds_read_b128 v[52:55], v14 offset:3072
 v_smfmac_f32_16x16x64_bf16 v[84:87], v[76:79], a[24:31], v8
 ds_read_b128 v[64:67], v23 offset:5120
 s_waitcnt lgkmcnt(8)
 v_smfmac_f32_16x16x64_bf16 v[80:83], v[180:183], a[32:39], v8
 ds_read_b128 v[148:151], v15 offset:0
 v_smfmac_f32_16x16x64_bf16 v[84:87], v[180:183], a[40:47], v8
 ds_read_b128 v[68:71], v23 offset:5152
 s_waitcnt lgkmcnt(8)
 v_smfmac_f32_16x16x64_bf16 v[80:83], v[184:187], a[48:55], v8
 ds_read_b128 v[152:155], v15 offset:1024
 v_smfmac_f32_16x16x64_bf16 v[84:87], v[184:187], a[56:63], v8
 ds_read_b128 v[72:75], v23 offset:6144
 s_waitcnt lgkmcnt(8)
 v_smfmac_f32_16x16x64_bf16 v[80:83], v[56:59], a[64:71], v8
 ds_read_b128 v[156:159], v15 offset:2048
 v_smfmac_f32_16x16x64_bf16 v[84:87], v[56:59], a[72:79], v8
 ds_read_b128 v[76:79], v23 offset:6176
 s_waitcnt lgkmcnt(8)
 v_smfmac_f32_16x16x64_bf16 v[80:83], v[60:63], a[80:87], v8
 ds_read_b128 v[160:163], v15 offset:3072
 v_smfmac_f32_16x16x64_bf16 v[84:87], v[60:63], a[88:95], v8
 ds_read_b128 v[180:183], v23 offset:7168
 s_waitcnt lgkmcnt(8)
 v_smfmac_f32_16x16x64_bf16 v[80:83], v[64:67], a[96:103], v8
 ds_read_b128 v[164:167], v15 offset:4096
 v_smfmac_f32_16x16x64_bf16 v[84:87], v[64:67], a[104:111], v8
 ds_read_b128 v[184:187], v23 offset:7200
 s_waitcnt lgkmcnt(8)
 v_smfmac_f32_16x16x64_bf16 v[80:83], v[68:71], a[112:119], v8
 ds_read_b128 v[168:171], v15 offset:5120
 v_smfmac_f32_16x16x64_bf16 v[84:87], v[68:71], a[120:127], v8
 ds_read_b128 v[56:59], v23 offset:8192
 s_waitcnt lgkmcnt(8)
 v_smfmac_f32_16x16x64_bf16 v[80:83], v[72:75], a[128:135], v8
 ds_read_b128 v[172:175], v15 offset:6144
 v_smfmac_f32_16x16x64_bf16 v[84:87], v[72:75], a[136:143], v8
 ds_read_b128 v[60:63], v23 offset:8224
 s_waitcnt lgkmcnt(8)
 v_smfmac_f32_16x16x64_bf16 v[80:83], v[76:79], a[144:151], v8
 ds_read_b128 v[176:179], v15 offset:7168
 v_smfmac_f32_16x16x64_bf16 v[84:87], v[76:79], a[152:159], v8
 ds_read_b128 v[64:67], v23 offset:9216
 s_waitcnt lgkmcnt(8)
 v_smfmac_f32_16x16x64_bf16 v[80:83], v[180:183], a[160:167], v8
 ds_read_b128 v[140:143], v17 offset:10240
 v_smfmac_f32_16x16x64_bf16 v[84:87], v[180:183], a[168:175], v8
 ds_read_b128 v[68:71], v23 offset:9248
 s_waitcnt lgkmcnt(8)
 v_smfmac_f32_16x16x64_bf16 v[80:83], v[184:187], a[176:183], v8
 ds_read_b128 v[144:147], v17 offset:11264
 v_smfmac_f32_16x16x64_bf16 v[84:87], v[184:187], a[184:191], v8
 s_waitcnt lgkmcnt(7)
 v_smfmac_f32_16x16x64_bf16 v[80:83], v[56:59], a[192:199], v8
 v_smfmac_f32_16x16x64_bf16 v[84:87], v[56:59], a[200:207], v8
 s_waitcnt lgkmcnt(5)
 v_smfmac_f32_16x16x64_bf16 v[80:83], v[60:63], a[208:215], v8
 v_smfmac_f32_16x16x64_bf16 v[84:87], v[60:63], a[216:223], v8
 s_waitcnt lgkmcnt(3)
 v_smfmac_f32_16x16x64_bf16 v[80:83], v[64:67], a[224:231], v8
 v_smfmac_f32_16x16x64_bf16 v[84:87], v[64:67], a[232:239], v8
 s_waitcnt lgkmcnt(1)
 v_smfmac_f32_16x16x64_bf16 v[80:83], v[68:71], a[240:247], v8
 v_smfmac_f32_16x16x64_bf16 v[84:87], v[68:71], a[248:255], v8
 s_lshl_b32 s16, s53, 19
 s_add_u32 s16, s16, s54
 s_xor_b32 s72, s16, 8192
 s_add_u32 s72, s72, s71
 s_add_u32 s16, s16, s70
 v_cvt_pk_bf16_f32 v36, v80, v81
 v_cvt_pk_bf16_f32 v37, v82, v83
 s_nop 2
 v_cvt_pk_bf16_f32 v38, v84, v85
 v_cvt_pk_bf16_f32 v39, v86, v87
 buffer_store_dwordx4 v[36:39], v18, s[4:7], s61 offen sc1
 ds_write_b128 v16, v[36:39] offset:14336
 s_waitcnt vmcnt(1) lgkmcnt(1)
L_wf_346:
 v_cmp_ge_u32 vcc, s53, v13
 s_cbranch_vccnz L_rt_347
 v_mfma_f32_16x16x32_bf16 v[100:103], v[148:151], v[40:43], v[108:111]
 s_add_u32 m0, s68, 49152
 s_nop 0
 buffer_load_dwordx4 v1, s[4:7], s72 offen offset:0 sc1 nt lds
 ds_read_b128 v[56:59], v19 offset:0
 v_mfma_f32_16x16x32_bf16 v[104:107], v[164:167], v[40:43], v[112:115]
 ds_read_b128 v[60:63], v19 offset:1024
 v_mfma_f32_16x16x32_bf16 v[96:99], v[124:127], v[40:43], 0
 ds_read_b128 v[64:67], v19 offset:2048
 v_mfma_f32_16x16x32_bf16 v[100:103], v[152:155], v[44:47], v[100:103]
 ds_read_b128 v[68:71], v19 offset:3072
 buffer_load_dwordx4 v1, s[4:7], s72 offen offset:1024 sc1 nt lds
 v_mfma_f32_16x16x32_bf16 v[104:107], v[168:171], v[44:47], v[104:107]
 ds_read_b128 v[72:75], v19 offset:4096
 v_mfma_f32_16x16x32_bf16 v[96:99], v[128:131], v[44:47], v[96:99]
 ds_read_b128 v[76:79], v19 offset:5120
 v_mfma_f32_16x16x32_bf16 v[100:103], v[156:159], v[48:51], v[100:103]
 ds_read_b128 v[180:183], v19 offset:6144
 v_mfma_f32_16x16x32_bf16 v[104:107], v[172:175], v[48:51], v[104:107]
 buffer_load_dwordx4 v1, s[4:7], s72 offen offset:2048 sc1 nt lds
 ds_read_b128 v[184:187], v19 offset:7168
 v_mfma_f32_16x16x32_bf16 v[96:99], v[132:135], v[48:51], v[96:99]
 v_mfma_f32_16x16x32_bf16 v[100:103], v[160:163], v[52:55], v[100:103]
 v_mfma_f32_16x16x32_bf16 v[104:107], v[176:179], v[52:55], v[104:107]
 v_mfma_f32_16x16x32_bf16 v[96:99], v[136:139], v[52:55], v[96:99]
 v_mov_b32 v80, 0
 v_mov_b32 v81, 0
 buffer_load_dwordx4 v1, s[4:7], s72 offen offset:3072 sc1 nt lds
 v_mov_b32 v82, 0
 v_mov_b32 v83, 0
 v_mov_b32 v84, 0
 v_mov_b32 v85, 0
 v_mov_b32 v86, 0
 v_mov_b32 v87, 0
 v_cvt_pk_bf16_f32 v7, v100, v101
 s_add_u32 m0, s69, 49152
 s_nop 0
 buffer_load_dwordx4 v1, s[4:7], s16 offen offset:0 sc1 lds
 v_lshlrev_b32 v100, 16, v7
 v_and_b32 v101, 0xffff0000, v7
 v_cvt_pk_bf16_f32 v7, v102, v103
 v_lshlrev_b32 v102, 16, v7
 v_and_b32 v103, 0xffff0000, v7
 v_cvt_pk_bf16_f32 v7, v104, v105
 v_lshlrev_b32 v104, 16, v7
 buffer_load_dwordx4 v1, s[4:7], s16 offen offset:1024 sc1 lds
 v_and_b32 v105, 0xffff0000, v7
 v_cvt_pk_bf16_f32 v7, v106, v107
 v_lshlrev_b32 v106, 16, v7
 v_and_b32 v107, 0xffff0000, v7
 v_cvt_pk_bf16_f32 v7, v98, v99
 v_lshlrev_b32 v98, 16, v7
 v_and_b32 v99, 0xffff0000, v7
 buffer_load_dwordx4 v1, s[4:7], s16 offen offset:2048 sc1 lds
 v_pk_mul_f32 v[100:101], v[100:101], s[64:65] op_sel:[0,1] op_sel_hi:[1,1]
 v_pk_mul_f32 v[102:103], v[102:103], s[64:65] op_sel:[0,1] op_sel_hi:[1,1]
 v_pk_mul_f32 v[104:105], v[104:105], s[64:65] op_sel:[0,1] op_sel_hi:[1,1]
 v_pk_mul_f32 v[106:107], v[106:107], s[64:65] op_sel:[0,1] op_sel_hi:[1,1]
 v_pk_mul_f32 v[98:99], v[98:99], s[64:65] op_sel:[0,1] op_sel_hi:[1,1]
 v_cvt_pk_bf16_f32 v7, v100, v101
 v_lshlrev_b32 v100, 16, v7
 buffer_load_dwordx4 v1, s[4:7], s16 offen offset:3072 sc1 lds
 v_and_b32 v101, 0xffff0000, v7
 v_cvt_pk_bf16_f32 v7, v102, v103
 v_lshlrev_b32 v102, 16, v7
 v_and_b32 v103, 0xffff0000, v7
 v_cvt_pk_bf16_f32 v7, v104, v105
 v_lshlrev_b32 v104, 16, v7
 v_and_b32 v105, 0xffff0000, v7
 s_add_u32 m0, s69, 53248
 s_nop 0
 buffer_load_dwordx4 v6, s[4:7], s16 offen offset:0 sc1 lds
 v_cvt_pk_bf16_f32 v7, v106, v107
 v_lshlrev_b32 v106, 16, v7
 v_and_b32 v107, 0xffff0000, v7
 v_cvt_pk_bf16_f32 v7, v98, v99
 v_lshlrev_b32 v98, 16, v7
 v_and_b32 v99, 0xffff0000, v7
 v_max_f32 v20, v100, v101
 buffer_load_dwordx4 v6, s[4:7], s16 offen offset:1024 sc1 lds
 v_max3_f32 v20, v20, v102, v103
 v_max3_f32 v20, v20, v104, v105
 v_max3_f32 v20, v20, v106, v107
 v_max3_f32 v20, v20, v98, v99
 v_mov_b32 v22, v20
 s_nop 1
 v_permlane16_swap_b32 v20, v22
 buffer_load_dwordx4 v6, s[4:7], s16 offen offset:2048 sc1 lds
 v_max_f32 v20, v20, v22
 v_mov_b32 v22, v20
 s_nop 1
 v_permlane32_swap_b32 v20, v22
 v_max_f32 v20, v20, v22
 v_mul_f32 v22, s66, v20
 v_fma_f32 v100, v100, s66, -v22
 buffer_load_dwordx4 v6, s[4:7], s16 offen offset:3072 sc1 lds
 v_fma_f32 v101, v101, s66, -v22
 v_fma_f32 v102, v102, s66, -v22
 v_fma_f32 v103, v103, s66, -v22
 v_fma_f32 v104, v104, s66, -v22
 v_fma_f32 v105, v105, s66, -v22
 v_fma_f32 v106, v106, s66, -v22
 v_fma_f32 v107, v107, s66, -v22
 buffer_store_dwordx4 v[32:35], v18, s[4:7], s60 offen sc1
 v_fma_f32 v98, v98, s66, -v22
 v_fma_f32 v99, v99, s66, -v22
 v_exp_f32 v100, v100
 v_exp_f32 v101, v101
 v_exp_f32 v102, v102
 v_exp_f32 v103, v103
 v_exp_f32 v104, v104
 buffer_load_dwordx4 v[124:127], v1, s[4:7], s61 offen offset:0 sc1
 v_exp_f32 v105, v105
 v_exp_f32 v106, v106
 v_exp_f32 v107, v107
 v_exp_f32 v98, v98
 v_exp_f32 v99, v99
 v_add_f32 v28, v100, v101
 v_add_f32 v28, v28, v102
 buffer_load_dwordx4 v[128:131], v1, s[4:7], s61 offen offset:1024 sc1
 v_add_f32 v28, v28, v103
 v_add_f32 v28, v28, v104
 v_add_f32 v28, v28, v105
 v_add_f32 v28, v28, v106
 v_add_f32 v28, v28, v107
 v_add_f32 v28, v28, v98
 v_add_f32 v28, v28, v99
 buffer_load_dwordx4 v[132:135], v1, s[4:7], s61 offen offset:2048 sc1
 v_mov_b32 v22, v28
 s_nop 1
 v_permlane16_swap_b32 v28, v22
 v_add_f32 v28, v28, v22
 v_mov_b32 v22, v28
 s_nop 1
 v_permlane32_swap_b32 v28, v22
 buffer_load_dwordx4 v[136:139], v1, s[4:7], s61 offen offset:3072 sc1
 v_add_f32 v28, v28, v22
 v_rcp_f32 v28, v28
 s_nop 0
 v_pk_mul_f32 v[100:101], v[100:101], v[28:29] op_sel_hi:[1,0]
 v_pk_mul_f32 v[102:103], v[102:103], v[28:29] op_sel_hi:[1,0]
 v_pk_mul_f32 v[104:105], v[104:105], v[28:29] op_sel_hi:[1,0]
 v_pk_mul_f32 v[106:107], v[106:107], v[28:29] op_sel_hi:[1,0]
 v_pk_mul_f32 v[98:99], v[98:99], v[28:29] op_sel_hi:[1,0]
 v_cvt_pk_bf16_f32 v116, v100, v101
 v_cvt_pk_bf16_f32 v117, v102, v103
 v_cvt_pk_bf16_f32 v118, v104, v105
 v_cvt_pk_bf16_f32 v119, v106, v107
 v_cvt_pk_bf16_f32 v120, v98, v99
 v_cvt_pk_bf16_f32 v123, v98, v99
 s_waitcnt lgkmcnt(0)
 v_mfma_f32_16x16x32_bf16 v[148:151], v[56:59], v[116:119], 0
 v_mfma_f32_16x16x32_bf16 v[152:155], v[60:63], v[116:119], 0
 v_mfma_f32_16x16x16_bf16 v[148:151], v[140:141], v[120:121], v[148:151]
 v_mfma_f32_16x16x32_bf16 v[156:159], v[64:67], v[116:119], 0
 v_mfma_f32_16x16x16_bf16 v[152:155], v[140:141], v[122:123], v[152:155]
 v_mfma_f32_16x16x32_bf16 v[160:163], v[68:71], v[116:119], 0
 v_mfma_f32_16x16x16_bf16 v[156:159], v[142:143], v[120:121], v[156:159]
 v_mfma_f32_16x16x32_bf16 v[164:167], v[72:75], v[116:119], 0
 v_mfma_f32_16x16x16_bf16 v[160:163], v[142:143], v[122:123], v[160:163]
 v_cvt_pk_bf16_f32 v40, v148, v149
 v_cvt_pk_bf16_f32 v41, v150, v151
 v_cvt_pk_bf16_f32 v42, v152, v153
 v_cvt_pk_bf16_f32 v43, v154, v155
 buffer_store_dwordx4 v[40:43], v11, s[4:7], s33 offen offset:0 sc1
 v_mfma_f32_16x16x32_bf16 v[168:171], v[76:79], v[116:119], 0
 v_mfma_f32_16x16x16_bf16 v[164:167], v[144:145], v[120:121], v[164:167]
 v_mfma_f32_16x16x32_bf16 v[172:175], v[180:183], v[116:119], 0
 v_mfma_f32_16x16x16_bf16 v[168:171], v[144:145], v[122:123], v[168:171]
 v_cvt_pk_bf16_f32 v44, v156, v157
 v_cvt_pk_bf16_f32 v45, v158, v159
 v_cvt_pk_bf16_f32 v46, v160, v161
 v_cvt_pk_bf16_f32 v47, v162, v163
 buffer_store_dwordx4 v[44:47], v11, s[4:7], s33 offen offset:2048 sc1
 s_add_u32 s33, s33, 4096
 v_mfma_f32_16x16x32_bf16 v[176:179], v[184:187], v[116:119], 0
 v_mfma_f32_16x16x16_bf16 v[172:175], v[146:147], v[120:121], v[172:175]
 v_mfma_f32_16x16x16_bf16 v[176:179], v[146:147], v[122:123], v[176:179]
 v_cvt_pk_bf16_f32 v48, v164, v165
 v_cvt_pk_bf16_f32 v49, v166, v167
 v_cvt_pk_bf16_f32 v50, v168, v169
 v_cvt_pk_bf16_f32 v51, v170, v171
 buffer_store_dwordx4 v[48:51], v11, s[4:7], s33 offen offset:0 sc1
 s_nop 3
 v_cvt_pk_bf16_f32 v52, v172, v173
 v_cvt_pk_bf16_f32 v53, v174, v175
 v_cvt_pk_bf16_f32 v54, v176, v177
 v_cvt_pk_bf16_f32 v55, v178, v179
 buffer_store_dwordx4 v[52:55], v11, s[4:7], s33 offen offset:2048 sc1
 s_cmp_ge_u32 s33, 268435456
 s_cselect_b32 s34, 268435456, s67
 s_add_u32 s67, s67, 4
 s_lshl_b32 s33, s53, 19
 s_add_u32 s33, s33, s54
 s_xor_b32 s33, s33, 8192
 s_add_u32 s33, s33, 67108864
 s_add_u32 s53, s53, 1
 v_mov_b32 v10, s53
 s_mov_b64 exec, 1
 buffer_store_dword v10, off, s[4:7], s35 sc1
 s_mov_b64 exec, -1
 s_waitcnt vmcnt(5)
L_pk_348:
 v_max3_u32 v7, v124, v128, v132
 v_max_u32 v7, v7, v136
 v_cmp_eq_u32 vcc, -1, v7
 s_cbranch_vccnz L_rt_349
 s_mov_b32 s51, 0
 buffer_load_dword v7, off, s[4:7], s17 sc1
 s_waitcnt vmcnt(0)
L_go_350:
 v_cmp_gt_u32 vcc, s53, v7
 s_cbranch_vccnz L_rt_351
 s_mov_b32 s51, 0
 s_nop 15
 s_nop 15
 s_nop 15
 s_nop 15
 buffer_load_dwordx4 v[40:43], v2, s[4:7], s58 offen offset:0 sc1
 buffer_load_dwordx4 v[44:47], v2, s[4:7], s58 offen offset:128 sc1
 buffer_load_dwordx4 v[48:51], v2, s[4:7], s58 offen offset:1024 sc1
 buffer_load_dwordx4 v[52:55], v2, s[4:7], s58 offen offset:1152 sc1
 buffer_load_dwordx4 v[56:59], v3, s[4:7], s58 offen offset:0 sc1
L_xm_352:
 s_waitcnt vmcnt(4)
 v_mfma_f32_16x16x32_bf16 v[60:63], v[24:27], v[40:43], 0
 s_waitcnt vmcnt(3)
 v_mfma_f32_16x16x32_bf16 v[64:67], v[24:27], v[44:47], 0
 s_waitcnt vmcnt(2)
 v_mfma_f32_16x16x32_bf16 v[68:71], v[24:27], v[48:51], 0
 v_max3_u32 v7, v40, v44, v48
 v_cvt_pk_bf16_f32 v60, v60, v61
 v_cvt_pk_bf16_f32 v61, v62, v63
 ds_write_b64 v4, v[60:61] offset:0
 s_waitcnt vmcnt(1)
 v_mfma_f32_16x16x32_bf16 v[72:75], v[24:27], v[52:55], 0
 v_cvt_pk_bf16_f32 v64, v64, v65
 v_cvt_pk_bf16_f32 v65, v66, v67
 ds_write_b64 v4, v[64:65] offset:8
 s_waitcnt vmcnt(0)
 v_mfma_f32_16x16x32_bf16 v[76:79], v[24:27], v[56:59], 0
 v_max3_u32 v7, v7, v52, v56
 v_cmp_eq_u32 vcc, -1, v7
 v_cvt_pk_bf16_f32 v68, v68, v69
 v_cvt_pk_bf16_f32 v69, v70, v71
 ds_write_b64 v4, v[68:69] offset:1024
 s_cbranch_vccnz L_rt_353
 v_cvt_pk_bf16_f32 v72, v72, v73
 v_cvt_pk_bf16_f32 v73, v74, v75
 ds_write_b64 v4, v[72:73] offset:1032
 s_nop 0
 v_cvt_pk_bf16_f32 v76, v76, v77
 v_cvt_pk_bf16_f32 v77, v78, v79
 ds_write_b64 v5, v[76:77] offset:0
 s_waitcnt lgkmcnt(0)
 s_barrier
 ds_read_b128 v[56:59], v23 offset:0
 ds_read_b128 v[60:63], v23 offset:32
 ds_read_b128 v[64:67], v23 offset:1024
 s_cmp_ge_u32 s34, 268435456
 s_cbranch_scc1 L_ns_354
 v_mov_b32 v10, 1
 s_mov_b64 exec, 31
 buffer_atomic_add v10, v12, s[4:7], s34 offen
 s_mov_b64 exec, -1
 L_ns_354:
 buffer_load_dword v13, off, s[4:7], s32 sc1
 s_waitcnt lgkmcnt(2)
 v_smfmac_f32_16x16x64_bf16 v[80:83], v[56:59], v[192:199], v8
 ds_read_b128 v[68:71], v23 offset:1056
 v_smfmac_f32_16x16x64_bf16 v[84:87], v[56:59], v[200:207], v8
 ds_read_b128 v[72:75], v23 offset:2048
 s_waitcnt lgkmcnt(3)
 v_smfmac_f32_16x16x64_bf16 v[80:83], v[60:63], v[208:215], v8
 ds_read_b128 v[76:79], v23 offset:2080
 v_smfmac_f32_16x16x64_bf16 v[84:87], v[60:63], v[216:223], v8
 ds_read_b128 v[180:183], v23 offset:3072
 s_waitcnt lgkmcnt(4)
 v_smfmac_f32_16x16x64_bf16 v[80:83], v[64:67], v[224:231], v8
 ds_read_b128 v[40:43], v14 offset:49152
 v_smfmac_f32_16x16x64_bf16 v[84:87], v[64:67], v[232:239], v8
 ds_read_b128 v[184:187], v23 offset:3104
 s_waitcnt lgkmcnt(5)
 v_smfmac_f32_16x16x64_bf16 v[80:83], v[68:71], v[240:247], v8
 ds_read_b128 v[44:47], v14 offset:50176
 v_smfmac_f32_16x16x64_bf16 v[84:87], v[68:71], v[248:255], v8
 ds_read_b128 v[56:59], v23 offset:4096
 s_waitcnt lgkmcnt(6)
 v_smfmac_f32_16x16x64_bf16 v[80:83], v[72:75], a[0:7], v8
 ds_read_b128 v[48:51], v14 offset:51200
 v_smfmac_f32_16x16x64_bf16 v[84:87], v[72:75], a[8:15], v8
 ds_read_b128 v[60:63], v23 offset:4128
 s_waitcnt lgkmcnt(7)
 v_smfmac_f32_16x16x64_bf16 v[80:83], v[76:79], a[16:23], v8
 ds_read_b128 v[52:55], v14 offset:52224
 v_smfmac_f32_16x16x64_bf16 v[84:87], v[76:79], a[24:31], v8
 ds_read_b128 v[64:67], v23 offset:5120
 s_waitcnt lgkmcnt(8)
 v_smfmac_f32_16x16x64_bf16 v[80:83], v[180:183], a[32:39], v8
 ds_read_b128 v[148:151], v15 offset:49152
 v_smfmac_f32_16x16x64_bf16 v[84:87], v[180:183], a[40:47], v8
 ds_read_b128 v[68:71], v23 offset:5152
 s_waitcnt lgkmcnt(8)
 v_smfmac_f32_16x16x64_bf16 v[80:83], v[184:187], a[48:55], v8
 ds_read_b128 v[152:155], v15 offset:50176
 v_smfmac_f32_16x16x64_bf16 v[84:87], v[184:187], a[56:63], v8
 ds_read_b128 v[72:75], v23 offset:6144
 s_waitcnt lgkmcnt(8)
 v_smfmac_f32_16x16x64_bf16 v[80:83], v[56:59], a[64:71], v8
 ds_read_b128 v[156:159], v15 offset:51200
 v_smfmac_f32_16x16x64_bf16 v[84:87], v[56:59], a[72:79], v8
 ds_read_b128 v[76:79], v23 offset:6176
 s_waitcnt lgkmcnt(8)
 v_smfmac_f32_16x16x64_bf16 v[80:83], v[60:63], a[80:87], v8
 ds_read_b128 v[160:163], v15 offset:52224
 v_smfmac_f32_16x16x64_bf16 v[84:87], v[60:63], a[88:95], v8
 ds_read_b128 v[180:183], v23 offset:7168
 s_waitcnt lgkmcnt(8)
 v_smfmac_f32_16x16x64_bf16 v[80:83], v[64:67], a[96:103], v8
 ds_read_b128 v[164:167], v15 offset:53248
 v_smfmac_f32_16x16x64_bf16 v[84:87], v[64:67], a[104:111], v8
 ds_read_b128 v[184:187], v23 offset:7200
 s_waitcnt lgkmcnt(8)
 v_smfmac_f32_16x16x64_bf16 v[80:83], v[68:71], a[112:119], v8
 ds_read_b128 v[168:171], v15 offset:54272
 v_smfmac_f32_16x16x64_bf16 v[84:87], v[68:71], a[120:127], v8
 ds_read_b128 v[56:59], v23 offset:8192
 s_waitcnt lgkmcnt(8)
 v_smfmac_f32_16x16x64_bf16 v[80:83], v[72:75], a[128:135], v8
 ds_read_b128 v[172:175], v15 offset:55296
 v_smfmac_f32_16x16x64_bf16 v[84:87], v[72:75], a[136:143], v8
 ds_read_b128 v[60:63], v23 offset:8224
 s_waitcnt lgkmcnt(8)
 v_smfmac_f32_16x16x64_bf16 v[80:83], v[76:79], a[144:151], v8
 ds_read_b128 v[176:179], v15 offset:56320
 v_smfmac_f32_16x16x64_bf16 v[84:87], v[76:79], a[152:159], v8
 ds_read_b128 v[64:67], v23 offset:9216
 s_waitcnt lgkmcnt(8)
 v_smfmac_f32_16x16x64_bf16 v[80:83], v[180:183], a[160:167], v8
 ds_read_b128 v[140:143], v17 offset:14336
 v_smfmac_f32_16x16x64_bf16 v[84:87], v[180:183], a[168:175], v8
 ds_read_b128 v[68:71], v23 offset:9248
 s_waitcnt lgkmcnt(8)
 v_smfmac_f32_16x16x64_bf16 v[80:83], v[184:187], a[176:183], v8
 ds_read_b128 v[144:147], v17 offset:15360
 v_smfmac_f32_16x16x64_bf16 v[84:87], v[184:187], a[184:191], v8
 s_waitcnt lgkmcnt(7)
 v_smfmac_f32_16x16x64_bf16 v[80:83], v[56:59], a[192:199], v8
 v_smfmac_f32_16x16x64_bf16 v[84:87], v[56:59], a[200:207], v8
 s_waitcnt lgkmcnt(5)
 v_smfmac_f32_16x16x64_bf16 v[80:83], v[60:63], a[208:215], v8
 v_smfmac_f32_16x16x64_bf16 v[84:87], v[60:63], a[216:223], v8
 s_waitcnt lgkmcnt(3)
 v_smfmac_f32_16x16x64_bf16 v[80:83], v[64:67], a[224:231], v8
 v_smfmac_f32_16x16x64_bf16 v[84:87], v[64:67], a[232:239], v8
 s_waitcnt lgkmcnt(1)
 v_smfmac_f32_16x16x64_bf16 v[80:83], v[68:71], a[240:247], v8
 v_smfmac_f32_16x16x64_bf16 v[84:87], v[68:71], a[248:255], v8
 s_lshl_b32 s16, s53, 19
 s_add_u32 s16, s16, s54
 s_xor_b32 s72, s16, 8192
 s_add_u32 s72, s72, s71
 s_add_u32 s16, s16, s70
 v_cvt_pk_bf16_f32 v36, v80, v81
 v_cvt_pk_bf16_f32 v37, v82, v83
 s_nop 2
 v_cvt_pk_bf16_f32 v38, v84, v85
 v_cvt_pk_bf16_f32 v39, v86, v87
 buffer_store_dwordx4 v[36:39], v18, s[4:7], s62 offen sc1
 ds_write_b128 v16, v[36:39] offset:10240
 s_waitcnt vmcnt(1) lgkmcnt(1)
L_wf_355:
 v_cmp_ge_u32 vcc, s53, v13
 s_cbranch_vccnz L_rt_356
 v_mfma_f32_16x16x32_bf16 v[100:103], v[148:151], v[40:43], v[108:111]
 s_add_u32 m0, s68, 0
 s_nop 0
 buffer_load_dwordx4 v1, s[4:7], s72 offen offset:0 sc1 nt lds
 ds_read_b128 v[56:59], v19 offset:49152
 v_mfma_f32_16x16x32_bf16 v[104:107], v[164:167], v[40:43], v[112:115]
 ds_read_b128 v[60:63], v19 offset:50176
 v_mfma_f32_16x16x32_bf16 v[96:99], v[124:127], v[40:43], 0
 ds_read_b128 v[64:67], v19 offset:51200
 v_mfma_f32_16x16x32_bf16 v[100:103], v[152:155], v[44:47], v[100:103]
 ds_read_b128 v[68:71], v19 offset:52224
 buffer_load_dwordx4 v1, s[4:7], s72 offen offset:1024 sc1 nt lds
 v_mfma_f32_16x16x32_bf16 v[104:107], v[168:171], v[44:47], v[104:107]
 ds_read_b128 v[72:75], v19 offset:53248
 v_mfma_f32_16x16x32_bf16 v[96:99], v[128:131], v[44:47], v[96:99]
 ds_read_b128 v[76:79], v19 offset:54272
 v_mfma_f32_16x16x32_bf16 v[100:103], v[156:159], v[48:51], v[100:103]
 ds_read_b128 v[180:183], v19 offset:55296
 v_mfma_f32_16x16x32_bf16 v[104:107], v[172:175], v[48:51], v[104:107]
 buffer_load_dwordx4 v1, s[4:7], s72 offen offset:2048 sc1 nt lds
 ds_read_b128 v[184:187], v19 offset:56320
 v_mfma_f32_16x16x32_bf16 v[96:99], v[132:135], v[48:51], v[96:99]
 v_mfma_f32_16x16x32_bf16 v[100:103], v[160:163], v[52:55], v[100:103]
 v_mfma_f32_16x16x32_bf16 v[104:107], v[176:179], v[52:55], v[104:107]
 v_mfma_f32_16x16x32_bf16 v[96:99], v[136:139], v[52:55], v[96:99]
 v_mov_b32 v80, 0
 v_mov_b32 v81, 0
 buffer_load_dwordx4 v1, s[4:7], s72 offen offset:3072 sc1 nt lds
 v_mov_b32 v82, 0
 v_mov_b32 v83, 0
 v_mov_b32 v84, 0
 v_mov_b32 v85, 0
 v_mov_b32 v86, 0
 v_mov_b32 v87, 0
 v_cvt_pk_bf16_f32 v7, v100, v101
 s_add_u32 m0, s69, 0
 s_nop 0
 buffer_load_dwordx4 v1, s[4:7], s16 offen offset:0 sc1 lds
 v_lshlrev_b32 v100, 16, v7
 v_and_b32 v101, 0xffff0000, v7
 v_cvt_pk_bf16_f32 v7, v102, v103
 v_lshlrev_b32 v102, 16, v7
 v_and_b32 v103, 0xffff0000, v7
 v_cvt_pk_bf16_f32 v7, v104, v105
 v_lshlrev_b32 v104, 16, v7
 buffer_load_dwordx4 v1, s[4:7], s16 offen offset:1024 sc1 lds
 v_and_b32 v105, 0xffff0000, v7
 v_cvt_pk_bf16_f32 v7, v106, v107
 v_lshlrev_b32 v106, 16, v7
 v_and_b32 v107, 0xffff0000, v7
 v_cvt_pk_bf16_f32 v7, v98, v99
 v_lshlrev_b32 v98, 16, v7
 v_and_b32 v99, 0xffff0000, v7
 buffer_load_dwordx4 v1, s[4:7], s16 offen offset:2048 sc1 lds
 v_pk_mul_f32 v[100:101], v[100:101], s[64:65] op_sel:[0,1] op_sel_hi:[1,1]
 v_pk_mul_f32 v[102:103], v[102:103], s[64:65] op_sel:[0,1] op_sel_hi:[1,1]
 v_pk_mul_f32 v[104:105], v[104:105], s[64:65] op_sel:[0,1] op_sel_hi:[1,1]
 v_pk_mul_f32 v[106:107], v[106:107], s[64:65] op_sel:[0,1] op_sel_hi:[1,1]
 v_pk_mul_f32 v[98:99], v[98:99], s[64:65] op_sel:[0,1] op_sel_hi:[1,1]
 v_cvt_pk_bf16_f32 v7, v100, v101
 v_lshlrev_b32 v100, 16, v7
 buffer_load_dwordx4 v1, s[4:7], s16 offen offset:3072 sc1 lds
 v_and_b32 v101, 0xffff0000, v7
 v_cvt_pk_bf16_f32 v7, v102, v103
 v_lshlrev_b32 v102, 16, v7
 v_and_b32 v103, 0xffff0000, v7
 v_cvt_pk_bf16_f32 v7, v104, v105
 v_lshlrev_b32 v104, 16, v7
 v_and_b32 v105, 0xffff0000, v7
 s_add_u32 m0, s69, 4096
 s_nop 0
 buffer_load_dwordx4 v6, s[4:7], s16 offen offset:0 sc1 lds
 v_cvt_pk_bf16_f32 v7, v106, v107
 v_lshlrev_b32 v106, 16, v7
 v_and_b32 v107, 0xffff0000, v7
 v_cvt_pk_bf16_f32 v7, v98, v99
 v_lshlrev_b32 v98, 16, v7
 v_and_b32 v99, 0xffff0000, v7
 v_max_f32 v20, v100, v101
 buffer_load_dwordx4 v6, s[4:7], s16 offen offset:1024 sc1 lds
 v_max3_f32 v20, v20, v102, v103
 v_max3_f32 v20, v20, v104, v105
 v_max3_f32 v20, v20, v106, v107
 v_max3_f32 v20, v20, v98, v99
 v_mov_b32 v22, v20
 s_nop 1
 v_permlane16_swap_b32 v20, v22
 buffer_load_dwordx4 v6, s[4:7], s16 offen offset:2048 sc1 lds
 v_max_f32 v20, v20, v22
 v_mov_b32 v22, v20
 s_nop 1
 v_permlane32_swap_b32 v20, v22
 v_max_f32 v20, v20, v22
 v_mul_f32 v22, s66, v20
 v_fma_f32 v100, v100, s66, -v22
 buffer_load_dwordx4 v6, s[4:7], s16 offen offset:3072 sc1 lds
 v_fma_f32 v101, v101, s66, -v22
 v_fma_f32 v102, v102, s66, -v22
 v_fma_f32 v103, v103, s66, -v22
 v_fma_f32 v104, v104, s66, -v22
 v_fma_f32 v105, v105, s66, -v22
 v_fma_f32 v106, v106, s66, -v22
 v_fma_f32 v107, v107, s66, -v22
 buffer_store_dwordx4 v[32:35], v18, s[4:7], s61 offen sc1
 v_fma_f32 v98, v98, s66, -v22
 v_fma_f32 v99, v99, s66, -v22
 v_exp_f32 v100, v100
 v_exp_f32 v101, v101
 v_exp_f32 v102, v102
 v_exp_f32 v103, v103
 v_exp_f32 v104, v104
 buffer_load_dwordx4 v[124:127], v1, s[4:7], s62 offen offset:0 sc1
 v_exp_f32 v105, v105
 v_exp_f32 v106, v106
 v_exp_f32 v107, v107
 v_exp_f32 v98, v98
 v_exp_f32 v99, v99
 v_add_f32 v28, v100, v101
 v_add_f32 v28, v28, v102
 buffer_load_dwordx4 v[128:131], v1, s[4:7], s62 offen offset:1024 sc1
 v_add_f32 v28, v28, v103
 v_add_f32 v28, v28, v104
 v_add_f32 v28, v28, v105
 v_add_f32 v28, v28, v106
 v_add_f32 v28, v28, v107
 v_add_f32 v28, v28, v98
 v_add_f32 v28, v28, v99
 buffer_load_dwordx4 v[132:135], v1, s[4:7], s62 offen offset:2048 sc1
 v_mov_b32 v22, v28
 s_nop 1
 v_permlane16_swap_b32 v28, v22
 v_add_f32 v28, v28, v22
 v_mov_b32 v22, v28
 s_nop 1
 v_permlane32_swap_b32 v28, v22
 buffer_load_dwordx4 v[136:139], v1, s[4:7], s62 offen offset:3072 sc1
 v_add_f32 v28, v28, v22
 v_rcp_f32 v28, v28
 s_nop 0
 v_pk_mul_f32 v[100:101], v[100:101], v[28:29] op_sel_hi:[1,0]
 v_pk_mul_f32 v[102:103], v[102:103], v[28:29] op_sel_hi:[1,0]
 v_pk_mul_f32 v[104:105], v[104:105], v[28:29] op_sel_hi:[1,0]
 v_pk_mul_f32 v[106:107], v[106:107], v[28:29] op_sel_hi:[1,0]
 v_pk_mul_f32 v[98:99], v[98:99], v[28:29] op_sel_hi:[1,0]
 v_cvt_pk_bf16_f32 v116, v100, v101
 v_cvt_pk_bf16_f32 v117, v102, v103
 v_cvt_pk_bf16_f32 v118, v104, v105
 v_cvt_pk_bf16_f32 v119, v106, v107
 v_cvt_pk_bf16_f32 v120, v98, v99
 v_cvt_pk_bf16_f32 v123, v98, v99
 s_waitcnt lgkmcnt(0)
 v_mfma_f32_16x16x32_bf16 v[148:151], v[56:59], v[116:119], 0
 v_mfma_f32_16x16x32_bf16 v[152:155], v[60:63], v[116:119], 0
 v_mfma_f32_16x16x16_bf16 v[148:151], v[140:141], v[120:121], v[148:151]
 v_mfma_f32_16x16x32_bf16 v[156:159], v[64:67], v[116:119], 0
 v_mfma_f32_16x16x16_bf16 v[152:155], v[140:141], v[122:123], v[152:155]
 v_mfma_f32_16x16x32_bf16 v[160:163], v[68:71], v[116:119], 0
 v_mfma_f32_16x16x16_bf16 v[156:159], v[142:143], v[120:121], v[156:159]
 v_mfma_f32_16x16x32_bf16 v[164:167], v[72:75], v[116:119], 0
 v_mfma_f32_16x16x16_bf16 v[160:163], v[142:143], v[122:123], v[160:163]
 v_cvt_pk_bf16_f32 v40, v148, v149
 v_cvt_pk_bf16_f32 v41, v150, v151
 v_cvt_pk_bf16_f32 v42, v152, v153
 v_cvt_pk_bf16_f32 v43, v154, v155
 buffer_store_dwordx4 v[40:43], v11, s[4:7], s33 offen offset:0 sc1
 v_mfma_f32_16x16x32_bf16 v[168:171], v[76:79], v[116:119], 0
 v_mfma_f32_16x16x16_bf16 v[164:167], v[144:145], v[120:121], v[164:167]
 v_mfma_f32_16x16x32_bf16 v[172:175], v[180:183], v[116:119], 0
 v_mfma_f32_16x16x16_bf16 v[168:171], v[144:145], v[122:123], v[168:171]
 v_cvt_pk_bf16_f32 v44, v156, v157
 v_cvt_pk_bf16_f32 v45, v158, v159
 v_cvt_pk_bf16_f32 v46, v160, v161
 v_cvt_pk_bf16_f32 v47, v162, v163
 buffer_store_dwordx4 v[44:47], v11, s[4:7], s33 offen offset:2048 sc1
 s_add_u32 s33, s33, 4096
 v_mfma_f32_16x16x32_bf16 v[176:179], v[184:187], v[116:119], 0
 v_mfma_f32_16x16x16_bf16 v[172:175], v[146:147], v[120:121], v[172:175]
 v_mfma_f32_16x16x16_bf16 v[176:179], v[146:147], v[122:123], v[176:179]
 v_cvt_pk_bf16_f32 v48, v164, v165
 v_cvt_pk_bf16_f32 v49, v166, v167
 v_cvt_pk_bf16_f32 v50, v168, v169
 v_cvt_pk_bf16_f32 v51, v170, v171
 buffer_store_dwordx4 v[48:51], v11, s[4:7], s33 offen offset:0 sc1
 s_nop 3
 v_cvt_pk_bf16_f32 v52, v172, v173
 v_cvt_pk_bf16_f32 v53, v174, v175
 v_cvt_pk_bf16_f32 v54, v176, v177
 v_cvt_pk_bf16_f32 v55, v178, v179
 buffer_store_dwordx4 v[52:55], v11, s[4:7], s33 offen offset:2048 sc1
 s_cmp_ge_u32 s33, 268435456
 s_cselect_b32 s34, 268435456, s67
 s_add_u32 s67, s67, 4
 s_lshl_b32 s33, s53, 19
 s_add_u32 s33, s33, s54
 s_xor_b32 s33, s33, 8192
 s_add_u32 s33, s33, 67108864
 s_add_u32 s53, s53, 1
 v_mov_b32 v10, s53
 s_mov_b64 exec, 1
 buffer_store_dword v10, off, s[4:7], s35 sc1
 s_mov_b64 exec, -1
 s_waitcnt vmcnt(5)
L_pk_357:
 v_max3_u32 v7, v124, v128, v132
 v_max_u32 v7, v7, v136
 v_cmp_eq_u32 vcc, -1, v7
 s_cbranch_vccnz L_rt_358
 s_mov_b32 s51, 0
 buffer_load_dword v7, off, s[4:7], s17 sc1
 s_waitcnt vmcnt(0)
L_go_359:
 v_cmp_gt_u32 vcc, s53, v7
 s_cbranch_vccnz L_rt_360
 s_mov_b32 s51, 0
 s_nop 15
 s_nop 15
 s_nop 15
 s_nop 15
 buffer_load_dwordx4 v[40:43], v2, s[4:7], s59 offen offset:0 sc1
 buffer_load_dwordx4 v[44:47], v2, s[4:7], s59 offen offset:128 sc1
 buffer_load_dwordx4 v[48:51], v2, s[4:7], s59 offen offset:1024 sc1
 buffer_load_dwordx4 v[52:55], v2, s[4:7], s59 offen offset:1152 sc1
 buffer_load_dwordx4 v[56:59], v3, s[4:7], s59 offen offset:0 sc1
L_xm_361:
 s_waitcnt vmcnt(4)
 v_mfma_f32_16x16x32_bf16 v[60:63], v[24:27], v[40:43], 0
 s_waitcnt vmcnt(3)
 v_mfma_f32_16x16x32_bf16 v[64:67], v[24:27], v[44:47], 0
 s_waitcnt vmcnt(2)
 v_mfma_f32_16x16x32_bf16 v[68:71], v[24:27], v[48:51], 0
 v_max3_u32 v7, v40, v44, v48
 v_cvt_pk_bf16_f32 v60, v60, v61
 v_cvt_pk_bf16_f32 v61, v62, v63
 ds_write_b64 v4, v[60:61] offset:0
 s_waitcnt vmcnt(1)
 v_mfma_f32_16x16x32_bf16 v[72:75], v[24:27], v[52:55], 0
 v_cvt_pk_bf16_f32 v64, v64, v65
 v_cvt_pk_bf16_f32 v65, v66, v67
 ds_write_b64 v4, v[64:65] offset:8
 s_waitcnt vmcnt(0)
 v_mfma_f32_16x16x32_bf16 v[76:79], v[24:27], v[56:59], 0
 v_max3_u32 v7, v7, v52, v56
 v_cmp_eq_u32 vcc, -1, v7
 v_cvt_pk_bf16_f32 v68, v68, v69
 v_cvt_pk_bf16_f32 v69, v70, v71
 ds_write_b64 v4, v[68:69] offset:1024
 s_cbranch_vccnz L_rt_362
 v_cvt_pk_bf16_f32 v72, v72, v73
 v_cvt_pk_bf16_f32 v73, v74, v75
 ds_write_b64 v4, v[72:73] offset:1032
 s_nop 0
 v_cvt_pk_bf16_f32 v76, v76, v77
 v_cvt_pk_bf16_f32 v77, v78, v79
 ds_write_b64 v5, v[76:77] offset:0
 s_waitcnt lgkmcnt(0)
 s_barrier
 ds_read_b128 v[56:59], v23 offset:0
 ds_read_b128 v[60:63], v23 offset:32
 ds_read_b128 v[64:67], v23 offset:1024
 s_cmp_ge_u32 s34, 268435456
 s_cbranch_scc1 L_ns_363
 v_mov_b32 v10, 1
 s_mov_b64 exec, 31
 buffer_atomic_add v10, v12, s[4:7], s34 offen
 s_mov_b64 exec, -1
 L_ns_363:
 buffer_load_dword v13, off, s[4:7], s32 sc1
 s_waitcnt lgkmcnt(2)
 v_smfmac_f32_16x16x64_bf16 v[80:83], v[56:59], v[192:199], v8
 ds_read_b128 v[68:71], v23 offset:1056
 v_smfmac_f32_16x16x64_bf16 v[84:87], v[56:59], v[200:207], v8
 ds_read_b128 v[72:75], v23 offset:2048
 s_waitcnt lgkmcnt(3)
 v_smfmac_f32_16x16x64_bf16 v[80:83], v[60:63], v[208:215], v8
 ds_read_b128 v[76:79], v23 offset:2080
 v_smfmac_f32_16x16x64_bf16 v[84:87], v[60:63], v[216:223], v8
 ds_read_b128 v[180:183], v23 offset:3072
 s_waitcnt lgkmcnt(4)
 v_smfmac_f32_16x16x64_bf16 v[80:83], v[64:67], v[224:231], v8
 ds_read_b128 v[40:43], v14 offset:0
 v_smfmac_f32_16x16x64_bf16 v[84:87], v[64:67], v[232:239], v8
 ds_read_b128 v[184:187], v23 offset:3104
 s_waitcnt lgkmcnt(5)
 v_smfmac_f32_16x16x64_bf16 v[80:83], v[68:71], v[240:247], v8
 ds_read_b128 v[44:47], v14 offset:1024
 v_smfmac_f32_16x16x64_bf16 v[84:87], v[68:71], v[248:255], v8
 ds_read_b128 v[56:59], v23 offset:4096
 s_waitcnt lgkmcnt(6)
 v_smfmac_f32_16x16x64_bf16 v[80:83], v[72:75], a[0:7], v8
 ds_read_b128 v[48:51], v14 offset:2048
 v_smfmac_f32_16x16x64_bf16 v[84:87], v[72:75], a[8:15], v8
 ds_read_b128 v[60:63], v23 offset:4128
 s_waitcnt lgkmcnt(7)
 v_smfmac_f32_16x16x64_bf16 v[80:83], v[76:79], a[16:23], v8
 ds_read_b128 v[52:55], v14 offset:3072
 v_smfmac_f32_16x16x64_bf16 v[84:87], v[76:79], a[24:31], v8
 ds_read_b128 v[64:67], v23 offset:5120
 s_waitcnt lgkmcnt(8)
 v_smfmac_f32_16x16x64_bf16 v[80:83], v[180:183], a[32:39], v8
 ds_read_b128 v[148:151], v15 offset:0
 v_smfmac_f32_16x16x64_bf16 v[84:87], v[180:183], a[40:47], v8
 ds_read_b128 v[68:71], v23 offset:5152
 s_waitcnt lgkmcnt(8)
 v_smfmac_f32_16x16x64_bf16 v[80:83], v[184:187], a[48:55], v8
 ds_read_b128 v[152:155], v15 offset:1024
 v_smfmac_f32_16x16x64_bf16 v[84:87], v[184:187], a[56:63], v8
 ds_read_b128 v[72:75], v23 offset:6144
 s_waitcnt lgkmcnt(8)
 v_smfmac_f32_16x16x64_bf16 v[80:83], v[56:59], a[64:71], v8
 ds_read_b128 v[156:159], v15 offset:2048
 v_smfmac_f32_16x16x64_bf16 v[84:87], v[56:59], a[72:79], v8
 ds_read_b128 v[76:79], v23 offset:6176
 s_waitcnt lgkmcnt(8)
 v_smfmac_f32_16x16x64_bf16 v[80:83], v[60:63], a[80:87], v8
 ds_read_b128 v[160:163], v15 offset:3072
 v_smfmac_f32_16x16x64_bf16 v[84:87], v[60:63], a[88:95], v8
 ds_read_b128 v[180:183], v23 offset:7168
 s_waitcnt lgkmcnt(8)
 v_smfmac_f32_16x16x64_bf16 v[80:83], v[64:67], a[96:103], v8
 ds_read_b128 v[164:167], v15 offset:4096
 v_smfmac_f32_16x16x64_bf16 v[84:87], v[64:67], a[104:111], v8
 ds_read_b128 v[184:187], v23 offset:7200
 s_waitcnt lgkmcnt(8)
 v_smfmac_f32_16x16x64_bf16 v[80:83], v[68:71], a[112:119], v8
 ds_read_b128 v[168:171], v15 offset:5120
 v_smfmac_f32_16x16x64_bf16 v[84:87], v[68:71], a[120:127], v8
 ds_read_b128 v[56:59], v23 offset:8192
 s_waitcnt lgkmcnt(8)
 v_smfmac_f32_16x16x64_bf16 v[80:83], v[72:75], a[128:135], v8
 ds_read_b128 v[172:175], v15 offset:6144
 v_smfmac_f32_16x16x64_bf16 v[84:87], v[72:75], a[136:143], v8
 ds_read_b128 v[60:63], v23 offset:8224
 s_waitcnt lgkmcnt(8)
 v_smfmac_f32_16x16x64_bf16 v[80:83], v[76:79], a[144:151], v8
 ds_read_b128 v[176:179], v15 offset:7168
 v_smfmac_f32_16x16x64_bf16 v[84:87], v[76:79], a[152:159], v8
 ds_read_b128 v[64:67], v23 offset:9216
 s_waitcnt lgkmcnt(8)
 v_smfmac_f32_16x16x64_bf16 v[80:83], v[180:183], a[160:167], v8
 ds_read_b128 v[140:143], v17 offset:10240
 v_smfmac_f32_16x16x64_bf16 v[84:87], v[180:183], a[168:175], v8
 ds_read_b128 v[68:71], v23 offset:9248
 s_waitcnt lgkmcnt(8)
 v_smfmac_f32_16x16x64_bf16 v[80:83], v[184:187], a[176:183], v8
 ds_read_b128 v[144:147], v17 offset:11264
 v_smfmac_f32_16x16x64_bf16 v[84:87], v[184:187], a[184:191], v8
 s_waitcnt lgkmcnt(7)
 v_smfmac_f32_16x16x64_bf16 v[80:83], v[56:59], a[192:199], v8
 v_smfmac_f32_16x16x64_bf16 v[84:87], v[56:59], a[200:207], v8
 s_waitcnt lgkmcnt(5)
 v_smfmac_f32_16x16x64_bf16 v[80:83], v[60:63], a[208:215], v8
 v_smfmac_f32_16x16x64_bf16 v[84:87], v[60:63], a[216:223], v8
 s_waitcnt lgkmcnt(3)
 v_smfmac_f32_16x16x64_bf16 v[80:83], v[64:67], a[224:231], v8
 v_smfmac_f32_16x16x64_bf16 v[84:87], v[64:67], a[232:239], v8
 s_waitcnt lgkmcnt(1)
 v_smfmac_f32_16x16x64_bf16 v[80:83], v[68:71], a[240:247], v8
 v_smfmac_f32_16x16x64_bf16 v[84:87], v[68:71], a[248:255], v8
 s_lshl_b32 s16, s53, 19
 s_add_u32 s16, s16, s54
 s_xor_b32 s72, s16, 8192
 s_add_u32 s72, s72, s71
 s_add_u32 s16, s16, s70
 v_cvt_pk_bf16_f32 v36, v80, v81
 v_cvt_pk_bf16_f32 v37, v82, v83
 s_nop 2
 v_cvt_pk_bf16_f32 v38, v84, v85
 v_cvt_pk_bf16_f32 v39, v86, v87
 buffer_store_dwordx4 v[36:39], v18, s[4:7], s63 offen sc1
 ds_write_b128 v16, v[36:39] offset:14336
 s_waitcnt vmcnt(1) lgkmcnt(1)
L_wf_364:
 v_cmp_ge_u32 vcc, s53, v13
 s_cbranch_vccnz L_rt_365
 v_mfma_f32_16x16x32_bf16 v[100:103], v[148:151], v[40:43], v[108:111]
 s_add_u32 m0, s68, 49152
 s_nop 0
 buffer_load_dwordx4 v1, s[4:7], s72 offen offset:0 sc1 nt lds
 ds_read_b128 v[56:59], v19 offset:0
 v_mfma_f32_16x16x32_bf16 v[104:107], v[164:167], v[40:43], v[112:115]
 ds_read_b128 v[60:63], v19 offset:1024
 v_mfma_f32_16x16x32_bf16 v[96:99], v[124:127], v[40:43], 0
 ds_read_b128 v[64:67], v19 offset:2048
 v_mfma_f32_16x16x32_bf16 v[100:103], v[152:155], v[44:47], v[100:103]
 ds_read_b128 v[68:71], v19 offset:3072
 buffer_load_dwordx4 v1, s[4:7], s72 offen offset:1024 sc1 nt lds
 v_mfma_f32_16x16x32_bf16 v[104:107], v[168:171], v[44:47], v[104:107]
 ds_read_b128 v[72:75], v19 offset:4096
 v_mfma_f32_16x16x32_bf16 v[96:99], v[128:131], v[44:47], v[96:99]
 ds_read_b128 v[76:79], v19 offset:5120
 v_mfma_f32_16x16x32_bf16 v[100:103], v[156:159], v[48:51], v[100:103]
 ds_read_b128 v[180:183], v19 offset:6144
 v_mfma_f32_16x16x32_bf16 v[104:107], v[172:175], v[48:51], v[104:107]
 buffer_load_dwordx4 v1, s[4:7], s72 offen offset:2048 sc1 nt lds
 ds_read_b128 v[184:187], v19 offset:7168
 v_mfma_f32_16x16x32_bf16 v[96:99], v[132:135], v[48:51], v[96:99]
 v_mfma_f32_16x16x32_bf16 v[100:103], v[160:163], v[52:55], v[100:103]
 v_mfma_f32_16x16x32_bf16 v[104:107], v[176:179], v[52:55], v[104:107]
 v_mfma_f32_16x16x32_bf16 v[96:99], v[136:139], v[52:55], v[96:99]
 v_mov_b32 v80, 0
 v_mov_b32 v81, 0
 buffer_load_dwordx4 v1, s[4:7], s72 offen offset:3072 sc1 nt lds
 v_mov_b32 v82, 0
 v_mov_b32 v83, 0
 v_mov_b32 v84, 0
 v_mov_b32 v85, 0
 v_mov_b32 v86, 0
 v_mov_b32 v87, 0
 v_cvt_pk_bf16_f32 v7, v100, v101
 s_add_u32 m0, s69, 49152
 s_nop 0
 buffer_load_dwordx4 v1, s[4:7], s16 offen offset:0 sc1 lds
 v_lshlrev_b32 v100, 16, v7
 v_and_b32 v101, 0xffff0000, v7
 v_cvt_pk_bf16_f32 v7, v102, v103
 v_lshlrev_b32 v102, 16, v7
 v_and_b32 v103, 0xffff0000, v7
 v_cvt_pk_bf16_f32 v7, v104, v105
 v_lshlrev_b32 v104, 16, v7
 buffer_load_dwordx4 v1, s[4:7], s16 offen offset:1024 sc1 lds
 v_and_b32 v105, 0xffff0000, v7
 v_cvt_pk_bf16_f32 v7, v106, v107
 v_lshlrev_b32 v106, 16, v7
 v_and_b32 v107, 0xffff0000, v7
 v_cvt_pk_bf16_f32 v7, v98, v99
 v_lshlrev_b32 v98, 16, v7
 v_and_b32 v99, 0xffff0000, v7
 buffer_load_dwordx4 v1, s[4:7], s16 offen offset:2048 sc1 lds
 v_pk_mul_f32 v[100:101], v[100:101], s[64:65] op_sel:[0,1] op_sel_hi:[1,1]
 v_pk_mul_f32 v[102:103], v[102:103], s[64:65] op_sel:[0,1] op_sel_hi:[1,1]
 v_pk_mul_f32 v[104:105], v[104:105], s[64:65] op_sel:[0,1] op_sel_hi:[1,1]
 v_pk_mul_f32 v[106:107], v[106:107], s[64:65] op_sel:[0,1] op_sel_hi:[1,1]
 v_pk_mul_f32 v[98:99], v[98:99], s[64:65] op_sel:[0,1] op_sel_hi:[1,1]
 v_cvt_pk_bf16_f32 v7, v100, v101
 v_lshlrev_b32 v100, 16, v7
 buffer_load_dwordx4 v1, s[4:7], s16 offen offset:3072 sc1 lds
 v_and_b32 v101, 0xffff0000, v7
 v_cvt_pk_bf16_f32 v7, v102, v103
 v_lshlrev_b32 v102, 16, v7
 v_and_b32 v103, 0xffff0000, v7
 v_cvt_pk_bf16_f32 v7, v104, v105
 v_lshlrev_b32 v104, 16, v7
 v_and_b32 v105, 0xffff0000, v7
 s_add_u32 m0, s69, 53248
 s_nop 0
 buffer_load_dwordx4 v6, s[4:7], s16 offen offset:0 sc1 lds
 v_cvt_pk_bf16_f32 v7, v106, v107
 v_lshlrev_b32 v106, 16, v7
 v_and_b32 v107, 0xffff0000, v7
 v_cvt_pk_bf16_f32 v7, v98, v99
 v_lshlrev_b32 v98, 16, v7
 v_and_b32 v99, 0xffff0000, v7
 v_max_f32 v20, v100, v101
 buffer_load_dwordx4 v6, s[4:7], s16 offen offset:1024 sc1 lds
 v_max3_f32 v20, v20, v102, v103
 v_max3_f32 v20, v20, v104, v105
 v_max3_f32 v20, v20, v106, v107
 v_max3_f32 v20, v20, v98, v99
 v_mov_b32 v22, v20
 s_nop 1
 v_permlane16_swap_b32 v20, v22
 buffer_load_dwordx4 v6, s[4:7], s16 offen offset:2048 sc1 lds
 v_max_f32 v20, v20, v22
 v_mov_b32 v22, v20
 s_nop 1
 v_permlane32_swap_b32 v20, v22
 v_max_f32 v20, v20, v22
 v_mul_f32 v22, s66, v20
 v_fma_f32 v100, v100, s66, -v22
 buffer_load_dwordx4 v6, s[4:7], s16 offen offset:3072 sc1 lds
 v_fma_f32 v101, v101, s66, -v22
 v_fma_f32 v102, v102, s66, -v22
 v_fma_f32 v103, v103, s66, -v22
 v_fma_f32 v104, v104, s66, -v22
 v_fma_f32 v105, v105, s66, -v22
 v_fma_f32 v106, v106, s66, -v22
 v_fma_f32 v107, v107, s66, -v22
 buffer_store_dwordx4 v[32:35], v18, s[4:7], s62 offen sc1
 v_fma_f32 v98, v98, s66, -v22
 v_fma_f32 v99, v99, s66, -v22
 v_exp_f32 v100, v100
 v_exp_f32 v101, v101
 v_exp_f32 v102, v102
 v_exp_f32 v103, v103
 v_exp_f32 v104, v104
 buffer_load_dwordx4 v[124:127], v1, s[4:7], s63 offen offset:0 sc1
 v_exp_f32 v105, v105
 v_exp_f32 v106, v106
 v_exp_f32 v107, v107
 v_exp_f32 v98, v98
 v_exp_f32 v99, v99
 v_add_f32 v28, v100, v101
 v_add_f32 v28, v28, v102
 buffer_load_dwordx4 v[128:131], v1, s[4:7], s63 offen offset:1024 sc1
 v_add_f32 v28, v28, v103
 v_add_f32 v28, v28, v104
 v_add_f32 v28, v28, v105
 v_add_f32 v28, v28, v106
 v_add_f32 v28, v28, v107
 v_add_f32 v28, v28, v98
 v_add_f32 v28, v28, v99
 buffer_load_dwordx4 v[132:135], v1, s[4:7], s63 offen offset:2048 sc1
 v_mov_b32 v22, v28
 s_nop 1
 v_permlane16_swap_b32 v28, v22
 v_add_f32 v28, v28, v22
 v_mov_b32 v22, v28
 s_nop 1
 v_permlane32_swap_b32 v28, v22
 buffer_load_dwordx4 v[136:139], v1, s[4:7], s63 offen offset:3072 sc1
 v_add_f32 v28, v28, v22
 v_rcp_f32 v28, v28
 s_nop 0
 v_pk_mul_f32 v[100:101], v[100:101], v[28:29] op_sel_hi:[1,0]
 v_pk_mul_f32 v[102:103], v[102:103], v[28:29] op_sel_hi:[1,0]
 v_pk_mul_f32 v[104:105], v[104:105], v[28:29] op_sel_hi:[1,0]
 v_pk_mul_f32 v[106:107], v[106:107], v[28:29] op_sel_hi:[1,0]
 v_pk_mul_f32 v[98:99], v[98:99], v[28:29] op_sel_hi:[1,0]
 v_cvt_pk_bf16_f32 v116, v100, v101
 v_cvt_pk_bf16_f32 v117, v102, v103
 v_cvt_pk_bf16_f32 v118, v104, v105
 v_cvt_pk_bf16_f32 v119, v106, v107
 v_cvt_pk_bf16_f32 v120, v98, v99
 v_cvt_pk_bf16_f32 v123, v98, v99
 s_waitcnt lgkmcnt(0)
 v_mfma_f32_16x16x32_bf16 v[148:151], v[56:59], v[116:119], 0
 v_mfma_f32_16x16x32_bf16 v[152:155], v[60:63], v[116:119], 0
 v_mfma_f32_16x16x16_bf16 v[148:151], v[140:141], v[120:121], v[148:151]
 v_mfma_f32_16x16x32_bf16 v[156:159], v[64:67], v[116:119], 0
 v_mfma_f32_16x16x16_bf16 v[152:155], v[140:141], v[122:123], v[152:155]
 v_mfma_f32_16x16x32_bf16 v[160:163], v[68:71], v[116:119], 0
 v_mfma_f32_16x16x16_bf16 v[156:159], v[142:143], v[120:121], v[156:159]
 v_mfma_f32_16x16x32_bf16 v[164:167], v[72:75], v[116:119], 0
 v_mfma_f32_16x16x16_bf16 v[160:163], v[142:143], v[122:123], v[160:163]
 v_cvt_pk_bf16_f32 v40, v148, v149
 v_cvt_pk_bf16_f32 v41, v150, v151
 v_cvt_pk_bf16_f32 v42, v152, v153
 v_cvt_pk_bf16_f32 v43, v154, v155
 buffer_store_dwordx4 v[40:43], v11, s[4:7], s33 offen offset:0 sc1
 v_mfma_f32_16x16x32_bf16 v[168:171], v[76:79], v[116:119], 0
 v_mfma_f32_16x16x16_bf16 v[164:167], v[144:145], v[120:121], v[164:167]
 v_mfma_f32_16x16x32_bf16 v[172:175], v[180:183], v[116:119], 0
 v_mfma_f32_16x16x16_bf16 v[168:171], v[144:145], v[122:123], v[168:171]
 v_cvt_pk_bf16_f32 v44, v156, v157
 v_cvt_pk_bf16_f32 v45, v158, v159
 v_cvt_pk_bf16_f32 v46, v160, v161
 v_cvt_pk_bf16_f32 v47, v162, v163
 buffer_store_dwordx4 v[44:47], v11, s[4:7], s33 offen offset:2048 sc1
 s_add_u32 s33, s33, 4096
 v_mfma_f32_16x16x32_bf16 v[176:179], v[184:187], v[116:119], 0
 v_mfma_f32_16x16x16_bf16 v[172:175], v[146:147], v[120:121], v[172:175]
 v_mfma_f32_16x16x16_bf16 v[176:179], v[146:147], v[122:123], v[176:179]
 v_cvt_pk_bf16_f32 v48, v164, v165
 v_cvt_pk_bf16_f32 v49, v166, v167
 v_cvt_pk_bf16_f32 v50, v168, v169
 v_cvt_pk_bf16_f32 v51, v170, v171
 buffer_store_dwordx4 v[48:51], v11, s[4:7], s33 offen offset:0 sc1
 s_nop 3
 v_cvt_pk_bf16_f32 v52, v172, v173
 v_cvt_pk_bf16_f32 v53, v174, v175
 v_cvt_pk_bf16_f32 v54, v176, v177
 v_cvt_pk_bf16_f32 v55, v178, v179
 buffer_store_dwordx4 v[52:55], v11, s[4:7], s33 offen offset:2048 sc1
 s_cmp_ge_u32 s33, 268435456
 s_cselect_b32 s34, 268435456, s67
 s_add_u32 s67, s67, 4
 s_lshl_b32 s33, s53, 19
 s_add_u32 s33, s33, s54
 s_xor_b32 s33, s33, 8192
 s_add_u32 s33, s33, 67108864
 s_add_u32 s53, s53, 1
 v_mov_b32 v10, s53
 s_mov_b64 exec, 1
 buffer_store_dword v10, off, s[4:7], s35 sc1
 s_mov_b64 exec, -1
 s_waitcnt vmcnt(5)
L_pk_366:
 v_max3_u32 v7, v124, v128, v132
 v_max_u32 v7, v7, v136
 v_cmp_eq_u32 vcc, -1, v7
 s_cbranch_vccnz L_rt_367
 s_cmp_eq_u32 s53, 64
 s_cbranch_scc1 L_vr_last
 s_branch L_vr_loops
L_rt_333:
 s_nop 7
 buffer_load_dword v7, off, s[4:7], s17 sc1
 s_waitcnt vmcnt(0)
 s_add_u32 s51, s51, 1
 s_cmp_lt_u32 s51, 131072
 s_cbranch_scc1 L_go_332
 s_branch L_bail
L_rt_335:
 s_nop 7
 buffer_load_dwordx4 v[40:43], v2, s[4:7], s56 offen offset:0 sc1
 buffer_load_dwordx4 v[44:47], v2, s[4:7], s56 offen offset:128 sc1
 buffer_load_dwordx4 v[48:51], v2, s[4:7], s56 offen offset:1024 sc1
 buffer_load_dwordx4 v[52:55], v2, s[4:7], s56 offen offset:1152 sc1
 buffer_load_dwordx4 v[56:59], v3, s[4:7], s56 offen offset:0 sc1
 s_add_u32 s51, s51, 1
 s_cmp_lt_u32 s51, 131072
 s_cbranch_scc1 L_xm_334
 s_branch L_bail
L_rt_338:
 s_sleep 1
 buffer_load_dword v13, off, s[4:7], s32 sc1
 s_waitcnt vmcnt(0)
 s_add_u32 s51, s51, 1
 s_cmp_lt_u32 s51, 131072
 s_cbranch_scc1 L_wf_337
 s_branch L_bail
L_rt_340:
 s_nop 7
 buffer_load_dwordx4 v[124:127], v1, s[4:7], s60 offen offset:0 sc1
 buffer_load_dwordx4 v[128:131], v1, s[4:7], s60 offen offset:1024 sc1
 buffer_load_dwordx4 v[132:135], v1, s[4:7], s60 offen offset:2048 sc1
 buffer_load_dwordx4 v[136:139], v1, s[4:7], s60 offen offset:3072 sc1
 s_waitcnt vmcnt(0)
 s_add_u32 s51, s51, 1
 s_cmp_lt_u32 s51, 131072
 s_cbranch_scc1 L_pk_339
 s_branch L_bail
L_rt_342:
 s_nop 7
 buffer_load_dword v7, off, s[4:7], s17 sc1
 s_waitcnt vmcnt(0)
 s_add_u32 s51, s51, 1
 s_cmp_lt_u32 s51, 131072
 s_cbranch_scc1 L_go_341
 s_branch L_bail
L_rt_344:
 s_nop 7
 buffer_load_dwordx4 v[40:43], v2, s[4:7], s57 offen offset:0 sc1
 buffer_load_dwordx4 v[44:47], v2, s[4:7], s57 offen offset:128 sc1
 buffer_load_dwordx4 v[48:51], v2, s[4:7], s57 offen offset:1024 sc1
 buffer_load_dwordx4 v[52:55], v2, s[4:7], s57 offen offset:1152 sc1
 buffer_load_dwordx4 v[56:59], v3, s[4:7], s57 offen offset:0 sc1
 s_add_u32 s51, s51, 1
 s_cmp_lt_u32 s51, 131072
 s_cbranch_scc1 L_xm_343
 s_branch L_bail
L_rt_347:
 s_sleep 1
 buffer_load_dword v13, off, s[4:7], s32 sc1
 s_waitcnt vmcnt(0)
 s_add_u32 s51, s51, 1
 s_cmp_lt_u32 s51, 131072
 s_cbranch_scc1 L_wf_346
 s_branch L_bail
L_rt_349:
 s_nop 7
 buffer_load_dwordx4 v[124:127], v1, s[4:7], s61 offen offset:0 sc1
 buffer_load_dwordx4 v[128:131], v1, s[4:7], s61 offen offset:1024 sc1
 buffer_load_dwordx4 v[132:135], v1, s[4:7], s61 offen offset:2048 sc1
 buffer_load_dwordx4 v[136:139], v1, s[4:7], s61 offen offset:3072 sc1
 s_waitcnt vmcnt(0)
 s_add_u32 s51, s51, 1
 s_cmp_lt_u32 s51, 131072
 s_cbranch_scc1 L_pk_348
 s_branch L_bail
L_rt_351:
 s_nop 7
 buffer_load_dword v7, off, s[4:7], s17 sc1
 s_waitcnt vmcnt(0)
 s_add_u32 s51, s51, 1
 s_cmp_lt_u32 s51, 131072
 s_cbranch_scc1 L_go_350
 s_branch L_bail
L_rt_353:
 s_nop 7
 buffer_load_dwordx4 v[40:43], v2, s[4:7], s58 offen offset:0 sc1
 buffer_load_dwordx4 v[44:47], v2, s[4:7], s58 offen offset:128 sc1
 buffer_load_dwordx4 v[48:51], v2, s[4:7], s58 offen offset:1024 sc1
 buffer_load_dwordx4 v[52:55], v2, s[4:7], s58 offen offset:1152 sc1
 buffer_load_dwordx4 v[56:59], v3, s[4:7], s58 offen offset:0 sc1
 s_add_u32 s51, s51, 1
 s_cmp_lt_u32 s51, 131072
 s_cbranch_scc1 L_xm_352
 s_branch L_bail
L_rt_356:
 s_sleep 1
 buffer_load_dword v13, off, s[4:7], s32 sc1
 s_waitcnt vmcnt(0)
 s_add_u32 s51, s51, 1
 s_cmp_lt_u32 s51, 131072
 s_cbranch_scc1 L_wf_355
 s_branch L_bail
L_rt_358:
 s_nop 7
 buffer_load_dwordx4 v[124:127], v1, s[4:7], s62 offen offset:0 sc1
 buffer_load_dwordx4 v[128:131], v1, s[4:7], s62 offen offset:1024 sc1
 buffer_load_dwordx4 v[132:135], v1, s[4:7], s62 offen offset:2048 sc1
 buffer_load_dwordx4 v[136:139], v1, s[4:7], s62 offen offset:3072 sc1
 s_waitcnt vmcnt(0)
 s_add_u32 s51, s51, 1
 s_cmp_lt_u32 s51, 131072
 s_cbranch_scc1 L_pk_357
 s_branch L_bail
L_rt_360:
 s_nop 7
 buffer_load_dword v7, off, s[4:7], s17 sc1
 s_waitcnt vmcnt(0)
 s_add_u32 s51, s51, 1
 s_cmp_lt_u32 s51, 131072
 s_cbranch_scc1 L_go_359
 s_branch L_bail
L_rt_362:
 s_nop 7
 buffer_load_dwordx4 v[40:43], v2, s[4:7], s59 offen offset:0 sc1
 buffer_load_dwordx4 v[44:47], v2, s[4:7], s59 offen offset:128 sc1
 buffer_load_dwordx4 v[48:51], v2, s[4:7], s59 offen offset:1024 sc1
 buffer_load_dwordx4 v[52:55], v2, s[4:7], s59 offen offset:1152 sc1
 buffer_load_dwordx4 v[56:59], v3, s[4:7], s59 offen offset:0 sc1
 s_add_u32 s51, s51, 1
 s_cmp_lt_u32 s51, 131072
 s_cbranch_scc1 L_xm_361
 s_branch L_bail
L_rt_365:
 s_sleep 1
 buffer_load_dword v13, off, s[4:7], s32 sc1
 s_waitcnt vmcnt(0)
 s_add_u32 s51, s51, 1
 s_cmp_lt_u32 s51, 131072
 s_cbranch_scc1 L_wf_364
 s_branch L_bail
L_rt_367:
 s_nop 7
 buffer_load_dwordx4 v[124:127], v1, s[4:7], s63 offen offset:0 sc1
 buffer_load_dwordx4 v[128:131], v1, s[4:7], s63 offen offset:1024 sc1
 buffer_load_dwordx4 v[132:135], v1, s[4:7], s63 offen offset:2048 sc1
 buffer_load_dwordx4 v[136:139], v1, s[4:7], s63 offen offset:3072 sc1
 s_waitcnt vmcnt(0)
 s_add_u32 s51, s51, 1
 s_cmp_lt_u32 s51, 131072
 s_cbranch_scc1 L_pk_366
 s_branch L_bail
L_vr_last:
 s_barrier
 ds_read_b128 v[148:151], v15 offset:49152
 ds_read_b128 v[152:155], v15 offset:50176
 ds_read_b128 v[156:159], v15 offset:51200
 ds_read_b128 v[160:163], v15 offset:52224
 ds_read_b128 v[164:167], v15 offset:53248
 ds_read_b128 v[168:171], v15 offset:54272
 ds_read_b128 v[172:175], v15 offset:55296
 ds_read_b128 v[176:179], v15 offset:56320
 ds_read_b128 v[140:143], v17 offset:14336
 ds_read_b128 v[144:147], v17 offset:15360
 s_waitcnt vmcnt(0)
 ds_read_b128 v[40:43], v14 offset:49152
 ds_read_b128 v[44:47], v14 offset:50176
 ds_read_b128 v[48:51], v14 offset:51200
 ds_read_b128 v[52:55], v14 offset:52224
 v_mov_b32 v10, 1
 s_mov_b64 exec, 31
 buffer_atomic_add v10, v12, s[4:7], s34 offen
 s_mov_b64 exec, -1
 s_waitcnt lgkmcnt(0)
 v_mfma_f32_16x16x32_bf16 v[100:103], v[148:151], v[40:43], v[108:111]
 ds_read_b128 v[56:59], v19 offset:49152
 v_mfma_f32_16x16x32_bf16 v[104:107], v[164:167], v[40:43], v[112:115]
 ds_read_b128 v[60:63], v19 offset:50176
 v_mfma_f32_16x16x32_bf16 v[96:99], v[124:127], v[40:43], 0
 ds_read_b128 v[64:67], v19 offset:51200
 v_mfma_f32_16x16x32_bf16 v[100:103], v[152:155], v[44:47], v[100:103]
 ds_read_b128 v[68:71], v19 offset:52224
 v_mfma_f32_16x16x32_bf16 v[104:107], v[168:171], v[44:47], v[104:107]
 ds_read_b128 v[72:75], v19 offset:53248
 v_mfma_f32_16x16x32_bf16 v[96:99], v[128:131], v[44:47], v[96:99]
 ds_read_b128 v[76:79], v19 offset:54272
 v_mfma_f32_16x16x32_bf16 v[100:103], v[156:159], v[48:51], v[100:103]
 ds_read_b128 v[180:183], v19 offset:55296
 v_mfma_f32_16x16x32_bf16 v[104:107], v[172:175], v[48:51], v[104:107]
 ds_read_b128 v[184:187], v19 offset:56320
 v_mfma_f32_16x16x32_bf16 v[96:99], v[132:135], v[48:51], v[96:99]
 v_mfma_f32_16x16x32_bf16 v[100:103], v[160:163], v[52:55], v[100:103]
 v_mfma_f32_16x16x32_bf16 v[104:107], v[176:179], v[52:55], v[104:107]
 v_mfma_f32_16x16x32_bf16 v[96:99], v[136:139], v[52:55], v[96:99]
 v_mov_b32 v80, 0
 v_mov_b32 v81, 0
 v_mov_b32 v82, 0
 v_mov_b32 v83, 0
 v_mov_b32 v84, 0
 v_mov_b32 v85, 0
 v_mov_b32 v86, 0
 v_mov_b32 v87, 0
 v_cvt_pk_bf16_f32 v7, v100, v101
 v_lshlrev_b32 v100, 16, v7
 v_and_b32 v101, 0xffff0000, v7
 v_cvt_pk_bf16_f32 v7, v102, v103
 v_lshlrev_b32 v102, 16, v7
 v_and_b32 v103, 0xffff0000, v7
 v_cvt_pk_bf16_f32 v7, v104, v105
 v_lshlrev_b32 v104, 16, v7
 v_and_b32 v105, 0xffff0000, v7
 v_cvt_pk_bf16_f32 v7, v106, v107
 v_lshlrev_b32 v106, 16, v7
 v_and_b32 v107, 0xffff0000, v7
 v_cvt_pk_bf16_f32 v7, v98, v99
 v_lshlrev_b32 v98, 16, v7
 v_and_b32 v99, 0xffff0000, v7
 v_pk_mul_f32 v[100:101], v[100:101], s[64:65] op_sel:[0,1] op_sel_hi:[1,1]
 v_pk_mul_f32 v[102:103], v[102:103], s[64:65] op_sel:[0,1] op_sel_hi:[1,1]
 v_pk_mul_f32 v[104:105], v[104:105], s[64:65] op_sel:[0,1] op_sel_hi:[1,1]
 v_pk_mul_f32 v[106:107], v[106:107], s[64:65] op_sel:[0,1] op_sel_hi:[1,1]
 v_pk_mul_f32 v[98:99], v[98:99], s[64:65] op_sel:[0,1] op_sel_hi:[1,1]
 v_cvt_pk_bf16_f32 v7, v100, v101
 v_lshlrev_b32 v100, 16, v7
 v_and_b32 v101, 0xffff0000, v7
 v_cvt_pk_bf16_f32 v7, v102, v103
 v_lshlrev_b32 v102, 16, v7
 v_and_b32 v103, 0xffff0000, v7
 v_cvt_pk_bf16_f32 v7, v104, v105
 v_lshlrev_b32 v104, 16, v7
 v_and_b32 v105, 0xffff0000, v7
 v_cvt_pk_bf16_f32 v7, v106, v107
 v_lshlrev_b32 v106, 16, v7
 v_and_b32 v107, 0xffff0000, v7
 v_cvt_pk_bf16_f32 v7, v98, v99
 v_lshlrev_b32 v98, 16, v7
 v_and_b32 v99, 0xffff0000, v7
 v_max_f32 v20, v100, v101
 v_max3_f32 v20, v20, v102, v103
 v_max3_f32 v20, v20, v104, v105
 v_max3_f32 v20, v20, v106, v107
 v_max3_f32 v20, v20, v98, v99
 v_mov_b32 v22, v20
 s_nop 1
 v_permlane16_swap_b32 v20, v22
 v_max_f32 v20, v20, v22
 v_mov_b32 v22, v20
 s_nop 1
 v_permlane32_swap_b32 v20, v22
 v_max_f32 v20, v20, v22
 v_mul_f32 v22, s66, v20
 v_fma_f32 v100, v100, s66, -v22
 v_fma_f32 v101, v101, s66, -v22
 v_fma_f32 v102, v102, s66, -v22
 v_fma_f32 v103, v103, s66, -v22
 v_fma_f32 v104, v104, s66, -v22
 v_fma_f32 v105, v105, s66, -v22
 v_fma_f32 v106, v106, s66, -v22
 v_fma_f32 v107, v107, s66, -v22
 v_fma_f32 v98, v98, s66, -v22
 v_fma_f32 v99, v99, s66, -v22
 v_exp_f32 v100, v100
 v_exp_f32 v101, v101
 v_exp_f32 v102, v102
 v_exp_f32 v103, v103
 v_exp_f32 v104, v104
 v_exp_f32 v105, v105
 v_exp_f32 v106, v106
 v_exp_f32 v107, v107
 v_exp_f32 v98, v98
 v_exp_f32 v99, v99
 v_add_f32 v28, v100, v101
 v_add_f32 v28, v28, v102
 v_add_f32 v28, v28, v103
 v_add_f32 v28, v28, v104
 v_add_f32 v28, v28, v105
 v_add_f32 v28, v28, v106
 v_add_f32 v28, v28, v107
 v_add_f32 v28, v28, v98
 v_add_f32 v28, v28, v99
 v_mov_b32 v22, v28
 s_nop 1
 v_permlane16_swap_b32 v28, v22
 v_add_f32 v28, v28, v22
 v_mov_b32 v22, v28
 s_nop 1
 v_permlane32_swap_b32 v28, v22
 v_add_f32 v28, v28, v22
 v_rcp_f32 v28, v28
 s_nop 0
 v_pk_mul_f32 v[100:101], v[100:101], v[28:29] op_sel_hi:[1,0]
 v_pk_mul_f32 v[102:103], v[102:103], v[28:29] op_sel_hi:[1,0]
 v_pk_mul_f32 v[104:105], v[104:105], v[28:29] op_sel_hi:[1,0]
 v_pk_mul_f32 v[106:107], v[106:107], v[28:29] op_sel_hi:[1,0]
 v_pk_mul_f32 v[98:99], v[98:99], v[28:29] op_sel_hi:[1,0]
 v_cvt_pk_bf16_f32 v116, v100, v101
 v_cvt_pk_bf16_f32 v117, v102, v103
 v_cvt_pk_bf16_f32 v118, v104, v105
 v_cvt_pk_bf16_f32 v119, v106, v107
 v_cvt_pk_bf16_f32 v120, v98, v99
 v_cvt_pk_bf16_f32 v123, v98, v99
 s_waitcnt lgkmcnt(0)
 v_mfma_f32_16x16x32_bf16 v[148:151], v[56:59], v[116:119], 0
 v_mfma_f32_16x16x32_bf16 v[152:155], v[60:63], v[116:119], 0
 v_mfma_f32_16x16x16_bf16 v[148:151], v[140:141], v[120:121], v[148:151]
 v_mfma_f32_16x16x32_bf16 v[156:159], v[64:67], v[116:119], 0
 v_mfma_f32_16x16x16_bf16 v[152:155], v[140:141], v[122:123], v[152:155]
 v_mfma_f32_16x16x32_bf16 v[160:163], v[68:71], v[116:119], 0
 v_mfma_f32_16x16x16_bf16 v[156:159], v[142:143], v[120:121], v[156:159]
 v_mfma_f32_16x16x32_bf16 v[164:167], v[72:75], v[116:119], 0
 v_mfma_f32_16x16x16_bf16 v[160:163], v[142:143], v[122:123], v[160:163]
 v_cvt_pk_bf16_f32 v40, v148, v149
 v_cvt_pk_bf16_f32 v41, v150, v151
 v_cvt_pk_bf16_f32 v42, v152, v153
 v_cvt_pk_bf16_f32 v43, v154, v155
 buffer_store_dwordx4 v[40:43], v11, s[4:7], s33 offen offset:0 sc1
 v_mfma_f32_16x16x32_bf16 v[168:171], v[76:79], v[116:119], 0
 v_mfma_f32_16x16x16_bf16 v[164:167], v[144:145], v[120:121], v[164:167]
 v_mfma_f32_16x16x32_bf16 v[172:175], v[180:183], v[116:119], 0
 v_mfma_f32_16x16x16_bf16 v[168:171], v[144:145], v[122:123], v[168:171]
 v_cvt_pk_bf16_f32 v44, v156, v157
 v_cvt_pk_bf16_f32 v45, v158, v159
 v_cvt_pk_bf16_f32 v46, v160, v161
 v_cvt_pk_bf16_f32 v47, v162, v163
 buffer_store_dwordx4 v[44:47], v11, s[4:7], s33 offen offset:2048 sc1
 s_add_u32 s33, s33, 4096
 v_mfma_f32_16x16x32_bf16 v[176:179], v[184:187], v[116:119], 0
 v_mfma_f32_16x16x16_bf16 v[172:175], v[146:147], v[120:121], v[172:175]
 v_mfma_f32_16x16x16_bf16 v[176:179], v[146:147], v[122:123], v[176:179]
 v_cvt_pk_bf16_f32 v48, v164, v165
 v_cvt_pk_bf16_f32 v49, v166, v167
 v_cvt_pk_bf16_f32 v50, v168, v169
 v_cvt_pk_bf16_f32 v51, v170, v171
 buffer_store_dwordx4 v[48:51], v11, s[4:7], s33 offen offset:0 sc1
 s_nop 3
 v_cvt_pk_bf16_f32 v52, v172, v173
 v_cvt_pk_bf16_f32 v53, v174, v175
 v_cvt_pk_bf16_f32 v54, v176, v177
 v_cvt_pk_bf16_f32 v55, v178, v179
 buffer_store_dwordx4 v[52:55], v11, s[4:7], s33 offen offset:2048 sc1
 s_waitcnt vmcnt(0)
 v_mov_b32 v10, 1
 s_mov_b64 exec, 31
 buffer_atomic_add v10, v12, s[4:7], s67 offen
 s_mov_b64 exec, -1
 s_endpgm
L_code_end:
 s_endpgm
.section .rodata,"a"
.p2align 6
.amdhsa_kernel interleave_layers__memory_aug_recurrent_mem_tr__ssm_conv_h3__prompt_kernel
  .amdhsa_next_free_vgpr 512
  .amdhsa_next_free_sgpr 102
  .amdhsa_accum_offset 256
  .amdhsa_group_segment_fixed_size 0
  .amdhsa_kernarg_size 128
  .amdhsa_user_sgpr_count 2
  .amdhsa_user_sgpr_kernarg_segment_ptr 1
  .amdhsa_system_sgpr_workgroup_id_x 1
  .amdhsa_float_denorm_mode_32 3
.end_amdhsa_kernel
.text
```

```asm
; @launch grid=(256,1,1) block=(256,1,1) lds=163840
.amdgcn_target "amdgcn-amd-amdhsa--gfx950"
.text
.globl interleave_layers__memory_aug_recurrent_mem_tr__ssm_conv_h3__prompt_kernel
.p2align 8
.type interleave_layers__memory_aug_recurrent_mem_tr__ssm_conv_h3__prompt_kernel,@function
interleave_layers__memory_aug_recurrent_mem_tr__ssm_conv_h3__prompt_kernel:
 s_cmp_ge_u32 s2, 256
 s_cbranch_scc1 L_bail
 s_load_dwordx16 s[16:31], s[0:1], 0
 s_load_dwordx16 s[32:47], s[0:1], 64
 s_getreg_b32 s48, hwreg(HW_REG_XCC_ID, 0, 3)
 v_lshrrev_b32 v1, 6, v0
 v_and_b32 v0, 63, v0
 s_nop 0
 v_readfirstlane_b32 s50, v1
 s_waitcnt lgkmcnt(0)
 s_mov_b32 s4, s46
 s_and_b32 s5, s47, 0xffff
 s_mov_b32 s6, 268435456
 s_mov_b32 s7, 0x00020000
 s_mov_b32 s8, s46
 s_and_b32 s9, s47, 0xffff
 s_mov_b32 s10, 268435456
 s_mov_b32 s11, 0x00020000
 s_mov_b32 s12, s46
 s_and_b32 s13, s47, 0xffff
 s_mov_b32 s14, 268435456
 s_mov_b32 s15, 0x00020000
 s_mov_b32 s96, s44
 s_and_b32 s97, s45, 0xffff
 s_mov_b32 s98, 256
 s_mov_b32 s99, 0x00020000
 s_cmp_lg_u32 s50, 0
 s_cbranch_scc1 L_tk_wait
 s_mov_b32 s96, s44
 s_and_b32 s97, s45, 0xffff
 s_mov_b32 s98, 256
 s_mov_b32 s99, 0x00020000
 s_lshl_b32 s3, s48, 5
 v_mov_b32 v1, 1
 v_mov_b32 v2, 0
 s_mov_b64 exec, 1
 buffer_atomic_add v1, off, s[96:99], s3 sc0
 s_waitcnt vmcnt(0)
 s_mov_b64 exec, -1
 v_readfirstlane_b32 s60, v1
 s_nop 3
 s_cmp_lt_u32 s60, 32
 s_cbranch_scc1 L_tk_ok
 v_lshlrev_b32 v3, 5, v0
 s_mov_b32 s51, 0
L_tk_lp:
 buffer_load_dword v4, v3, s[96:99], 0 offen sc1
 s_waitcnt vmcnt(0)
 s_mov_b32 s61, 0
 v_readlane_b32 s64, v4, 0
 s_nop 3
 s_add_u32 s61, s61, s64
 v_readlane_b32 s65, v4, 1
 s_nop 3
 s_add_u32 s61, s61, s65
 v_readlane_b32 s66, v4, 2
 s_nop 3
 s_add_u32 s61, s61, s66
 v_readlane_b32 s67, v4, 3
 s_nop 3
 s_add_u32 s61, s61, s67
 v_readlane_b32 s68, v4, 4
 s_nop 3
 s_add_u32 s61, s61, s68
 v_readlane_b32 s69, v4, 5
 s_nop 3
 s_add_u32 s61, s61, s69
 v_readlane_b32 s70, v4, 6
 s_nop 3
 s_add_u32 s61, s61, s70
 v_readlane_b32 s71, v4, 7
 s_nop 3
 s_add_u32 s61, s61, s71
 s_cmp_ge_u32 s61, 256
 s_cbranch_scc1 L_tk_all
 s_sleep 4
 s_add_u32 s51, s51, 1
 s_cmp_lt_u32 s51, 131072
 s_cbranch_scc1 L_tk_lp
 s_branch L_bail
L_tk_all:
 v_mov_b32 v1, 1
 s_mov_b64 exec, 1
 buffer_atomic_add v1, off, s[96:99], 0 offset:20 sc0
 s_waitcnt vmcnt(0)
 s_mov_b64 exec, -1
 v_readfirstlane_b32 s61, v1
 s_nop 3
 s_min_u32 s62, s64, 32
 s_add_u32 s60, s62, s61
 s_mov_b32 s48, 0
 s_cmp_lt_u32 s60, 32
 s_cbranch_scc1 L_tk_ok
 s_sub_u32 s61, s60, 32
 s_min_u32 s62, s65, 32
 s_add_u32 s60, s62, s61
 s_mov_b32 s48, 1
 s_cmp_lt_u32 s60, 32
 s_cbranch_scc1 L_tk_ok
 s_sub_u32 s61, s60, 32
 s_min_u32 s62, s66, 32
 s_add_u32 s60, s62, s61
 s_mov_b32 s48, 2
 s_cmp_lt_u32 s60, 32
 s_cbranch_scc1 L_tk_ok
 s_sub_u32 s61, s60, 32
 s_min_u32 s62, s67, 32
 s_add_u32 s60, s62, s61
 s_mov_b32 s48, 3
 s_cmp_lt_u32 s60, 32
 s_cbranch_scc1 L_tk_ok
 s_sub_u32 s61, s60, 32
 s_min_u32 s62, s68, 32
 s_add_u32 s60, s62, s61
 s_mov_b32 s48, 4
 s_cmp_lt_u32 s60, 32
 s_cbranch_scc1 L_tk_ok
 s_sub_u32 s61, s60, 32
 s_min_u32 s62, s69, 32
 s_add_u32 s60, s62, s61
 s_mov_b32 s48, 5
 s_cmp_lt_u32 s60, 32
 s_cbranch_scc1 L_tk_ok
 s_sub_u32 s61, s60, 32
 s_min_u32 s62, s70, 32
 s_add_u32 s60, s62, s61
 s_mov_b32 s48, 6
 s_cmp_lt_u32 s60, 32
 s_cbranch_scc1 L_tk_ok
 s_sub_u32 s61, s60, 32
 s_min_u32 s62, s71, 32
 s_add_u32 s60, s62, s61
 s_mov_b32 s48, 7
 s_cmp_lt_u32 s60, 32
 s_cbranch_scc1 L_tk_ok
 s_sub_u32 s61, s60, 32
 s_mov_b32 s48, 8
 s_mov_b32 s60, 0
L_tk_ok:
 s_lshl_b32 s3, s48, 5
 s_add_u32 s3, s3, s60
 v_mov_b32 v1, s3
 ds_write_b32 v2, v1
 s_waitcnt lgkmcnt(0)
L_tk_wait:
 s_barrier
 v_mov_b32 v2, 0
 ds_read_b32 v1, v2
 s_waitcnt lgkmcnt(0)
 v_readfirstlane_b32 s101, v1
 s_barrier
 s_mov_b32 s51, 0
 s_cmp_ge_u32 s101, 256
 s_cbranch_scc1 L_bail
 s_lshr_b32 s48, s101, 5
 s_and_b32 s48, s48, 7
 s_and_b32 s49, s101, 31
 s_cmp_ge_u32 s48, 4
 s_cbranch_scc1 L_hi
 s_cmp_ge_u32 s49, 24
 s_cbranch_scc1 L_lo2
 s_cmp_ge_u32 s48, 2
 s_cbranch_scc1 L_lo1
 s_cmp_lt_u32 s49, 16
 s_cbranch_scc1 L_ch_far
 s_branch L_vr_far
L_lo1:
 s_lshl_b32 s3, s48, 3
 s_add_u32 s3, s3, s49
 s_add_u32 s82, s3, 56
 s_mov_b32 s83, 4
 s_cmp_lt_u32 s49, 8
 s_cbranch_scc1 L_helper
 s_sub_u32 s82, s3, 24
 s_cmp_lt_u32 s49, 16
 s_cbranch_scc1 L_late
 s_sub_u32 s82, s3, 16
 s_mov_b32 s83, 2
 s_branch L_helper
L_lo2:
 s_lshl_b32 s82, s48, 1
 s_add_u32 s82, s82, s49
 s_add_u32 s82, s82, 58
 s_mov_b32 s83, 3
 s_cmp_ge_u32 s49, 30
 s_cbranch_scc1 L_helper
 s_lshl_b32 s52, s48, 2
 s_add_u32 s52, s52, s49
 s_sub_u32 s52, s52, 24
 s_mov_b32 s82, s52
 s_mov_b32 s83, 0
 s_cmp_lt_u32 s49, 28
 s_cbranch_scc1 L_helper
 s_lshl_b32 s3, s48, 1
 s_add_u32 s3, s3, s49
 s_add_u32 s3, s3, 4
 s_branch L_wo_idx
L_hi:
 s_mul_i32 s3, s48, 24
 s_add_u32 s3, s3, s49
 s_sub_u32 s3, s3, 96
 s_cmp_lt_u32 s49, 24
 s_cbranch_scc1 L_qkv_idx
 s_lshl_b32 s3, s48, 3
 s_add_u32 s3, s3, s49
 s_sub_u32 s3, s3, 56
L_wo_idx:
 s_mul_i32 s52, s3, 13108
 s_lshr_b32 s52, s52, 16
 s_mul_i32 s53, s52, 5
 s_sub_u32 s53, s3, s53
 s_add_u32 s82, s3, 32
 s_mov_b32 s83, 1
 s_cmp_ge_u32 s3, 32
 s_cbranch_scc1 L_wo_pair
 s_lshr_b32 s52, s3, 3
 s_lshl_b32 s52, s52, 1
 s_and_b32 s53, s3, 7
 s_cmp_lt_u32 s53, 5
 s_cbranch_scc1 L_helper
 s_add_u32 s52, s52, 1
 s_sub_u32 s53, s53, 5
 s_cmp_eq_u32 s53, 2
 s_cselect_b32 s53, 3, s53
 s_branch L_helper
L_wo_pair:
 s_and_b32 s53, s3, 1
 s_lshl_b32 s53, s53, 1
 s_add_u32 s53, s53, 2
 s_and_b32 s52, s3, 2
 s_lshl_b32 s52, s52, 1
 s_bfe_u32 s3, s3, 0x10002
 s_lshl_b32 s3, s3, 1
 s_add_u32 s52, s52, s3
 s_add_u32 s52, s52, 1
 s_branch L_helper
L_qkv_idx:
 s_mul_i32 s52, s3, 21846
 s_lshr_b32 s52, s52, 16
 s_mul_i32 s53, s52, 3
 s_sub_u32 s53, s3, s53
 s_mov_b32 s8, s24
 s_and_b32 s9, s25, 0xffff
 s_mov_b32 s10, 5242880
 s_mov_b32 s11, 0x00020000
 s_cmp_eq_u32 s53, 2
 s_cbranch_scc1 L_qkvv
 s_cmp_eq_u32 s53, 0
 s_cselect_b32 s8, s20, s22
 s_cselect_b32 s9, s21, s23
 s_and_b32 s9, s9, 0xffff
 s_branch L_qkvq
L_ch_far:
 s_branch L_ch
L_vr_far:
 s_branch L_vr
L_conv0:
 s_mov_b32 s8, s38
 s_and_b32 s9, s39, 0xffff
 s_mov_b32 s10, 2621440
 s_mov_b32 s11, 0x00020000
 s_mov_b32 s12, s40
 s_and_b32 s13, s41, 0xffff
 s_mov_b32 s14, 1280
 s_mov_b32 s15, 0x00020000
 v_lshlrev_b32 v130, 4, v0
 v_add_u32 v7, s71, v130
 v_mov_b32 v8, 0
 v_mov_b32 v9, 0
 v_mov_b32 v10, 0
 v_mov_b32 v11, 0
 s_mov_b32 exec_hi, 0
 ds_write_b128 v7, v[8:11] offset:0
 s_mov_b32 exec_lo, 3
 ds_write_b128 v7, v[8:11] offset:4608
 ds_write_b128 v7, v[8:11] offset:8768
 s_mov_b64 exec, -1
 v_and_b32 v8, 15, v0
 v_lshrrev_b32 v9, 5, v0
 v_sub_u32 v10, v8, v9
 v_lshlrev_b32 v10, 5, v10
 v_and_b32 v11, 16, v0
 v_add_u32 v10, v10, v11
 s_add_u32 s3, s71, 64
 v_add_u32 v14, s3, v10
 v_lshlrev_b32 v10, 5, v9
 v_lshl_add_u32 v10, v8, 1, v10
 v_sub_u32 v10, v10, v11
 v_and_b32 v11, 1, v0
 v_cmp_eq_u32 vcc, 1, v11
 v_mov_b32 v12, 8784
 v_mov_b32 v11, 4626
 s_nop 0
 v_cndmask_b32 v11, v12, v11, vcc
 v_add3_u32 v16, v10, v11, s71
 v_add_u32 v17, 512, v16
 v_add_u32 v18, 1024, v16
 v_add_u32 v19, 1536, v16
 v_lshlrev_b32 v10, 5, v8
 v_lshl_add_u32 v10, v9, 4, v10
 v_and_b32 v11, 16, v0
 v_lshrrev_b32 v11, 1, v11
 v_xor_b32 v11, 8, v11
 s_add_u32 s3, s71, 512
 v_add3_u32 v15, v10, v11, s3
 v_and_b32 v10, 1, v0
 v_lshlrev_b32 v10, 4, v10
 v_lshrrev_b32 v11, 4, v0
 v_lshl_add_u32 v10, v11, 2, v10
 s_mov_b32 s3, 40960
 v_mul_lo_u32 v13, v10, s3
 v_lshrrev_b32 v11, 1, v8
 v_lshl_add_u32 v13, v11, 3, v13
 s_cmp_lg_u32 s50, 0
 s_cbranch_scc1 L_ww_1
 s_mov_b32 s96, s44
 s_and_b32 s97, s45, 0xffff
 s_mov_b32 s98, 256
 s_mov_b32 s99, 0x00020000
 v_mov_b32 v24, 196
 s_mov_b32 s51, 0
 s_mov_b64 exec, 1
L_wb_2:
 buffer_load_dword v25, v24, s[96:99], 0 offen sc1
 s_waitcnt vmcnt(0)
 v_cmp_eq_u32 vcc, 0, v25
 s_cbranch_vccz L_wbd_3
 s_sleep 2
 s_add_u32 s51, s51, 1
 s_cmp_lt_u32 s51, 131072
 s_cbranch_scc1 L_wb_2
 s_branch L_bail
L_wbd_3:
 s_mov_b64 exec, -1
L_ww_1:
 s_barrier
 s_lshl_b32 s3, s70, 12
 s_add_u32 s3, s3, 198180864
 buffer_load_dwordx4 v[104:107], v130, s[4:7], s3 offen offset:0 sc1
 buffer_load_dwordx4 v[108:111], v130, s[4:7], s3 offen offset:1024 sc1
 s_waitcnt vmcnt(0)
L_cv_4:
 s_waitcnt vmcnt(4)
 ds_write_b128 v7, v[104:107] offset:512
 ds_write_b128 v7, v[96:99] offset:4640
 ds_write_b128 v7, v[112:115] offset:8800
 ds_write_b128 v7, v[108:111] offset:1536
 ds_write_b128 v7, v[100:103] offset:5664
 ds_write_b128 v7, v[116:119] offset:9824
 v_lshlrev_b32 v8, 16, v96
 v_lshlrev_b32 v12, 16, v128
 s_mov_b64 exec, 1
 ds_write_b32 v7, v8 offset:8796
 s_mov_b64 exec, -1
 s_lshl_b32 s72, s70, 6
 s_add_u32 s72, s72, 200802304
 s_add_u32 s70, s70, s69
 s_waitcnt lgkmcnt(0)
 s_lshl_b32 s73, s70, 12
 s_add_u32 s74, s73, 2
 buffer_load_dwordx4 v[96:99], v130, s[8:11], s73 offen offset:0
 buffer_load_dwordx4 v[100:103], v130, s[8:11], s73 offen offset:1024
 buffer_load_dwordx4 v[112:115], v130, s[8:11], s74 offen offset:0
 buffer_load_dwordx4 v[116:119], v130, s[8:11], s74 offen offset:1024
 s_lshl_b32 s3, s70, 1
 buffer_load_ushort v128, off, s[12:15], s3
 s_lshl_b32 s3, s70, 12
 s_add_u32 s3, s3, 198180864
 buffer_load_dwordx4 v[104:107], v130, s[4:7], s3 offen offset:0 sc1
 buffer_load_dwordx4 v[108:111], v130, s[4:7], s3 offen offset:1024 sc1
 ds_read_b128 v[32:35], v14 offset:448
 ds_read2_b32 v[64:65], v16 offset0:0 offset1:1
 ds_read2_b32 v[66:67], v16 offset0:2 offset1:3
 ds_read_b128 v[36:39], v14 offset:960
 ds_read2_b32 v[68:69], v17 offset0:0 offset1:1
 ds_read2_b32 v[70:71], v17 offset0:2 offset1:3
 ds_read_b128 v[40:43], v14 offset:1472
 ds_read2_b32 v[72:73], v18 offset0:0 offset1:1
 ds_read2_b32 v[74:75], v18 offset0:2 offset1:3
 ds_read_b128 v[44:47], v14 offset:1984
 ds_read2_b32 v[76:77], v19 offset0:0 offset1:1
 ds_read2_b32 v[78:79], v19 offset0:2 offset1:3
 s_waitcnt lgkmcnt(0)
 v_mfma_f32_16x16x32_bf16 v[144:147], v[64:67], v[32:35], 0
 ds_read_b128 v[176:179], v14 offset:384
 ds_read2_b32 v[208:209], v16 offset0:16 offset1:17
 v_mfma_f32_16x16x32_bf16 v[148:151], v[64:67], v[36:39], 0
 ds_read2_b32 v[210:211], v16 offset0:18 offset1:19
 ds_read_b128 v[180:183], v14 offset:896
 v_mfma_f32_16x16x32_bf16 v[152:155], v[64:67], v[40:43], 0
 ds_read2_b32 v[212:213], v17 offset0:16 offset1:17
 ds_read2_b32 v[214:215], v17 offset0:18 offset1:19
 v_mfma_f32_16x16x32_bf16 v[156:159], v[64:67], v[44:47], 0
 ds_read_b128 v[184:187], v14 offset:1408
 ds_read2_b32 v[216:217], v18 offset0:16 offset1:17
 v_mfma_f32_16x16x32_bf16 v[148:151], v[68:71], v[32:35], v[148:151]
 ds_read2_b32 v[218:219], v18 offset0:18 offset1:19
 ds_read_b128 v[188:191], v14 offset:1920
 v_mfma_f32_16x16x32_bf16 v[152:155], v[68:71], v[36:39], v[152:155]
 ds_read2_b32 v[220:221], v19 offset0:16 offset1:17
 ds_read2_b32 v[222:223], v19 offset0:18 offset1:19
 v_mfma_f32_16x16x32_bf16 v[156:159], v[68:71], v[40:43], v[156:159]
 v_mfma_f32_16x16x32_bf16 v[152:155], v[72:75], v[32:35], v[152:155]
 v_mfma_f32_16x16x32_bf16 v[156:159], v[72:75], v[36:39], v[156:159]
 v_mfma_f32_16x16x32_bf16 v[156:159], v[76:79], v[32:35], v[156:159]
 s_waitcnt lgkmcnt(0)
 v_mfma_f32_16x16x32_bf16 v[144:147], v[208:211], v[176:179], v[144:147]
 ds_read_b128 v[32:35], v14 offset:320
 ds_read2_b32 v[64:65], v16 offset0:32 offset1:33
 v_mfma_f32_16x16x32_bf16 v[148:151], v[208:211], v[180:183], v[148:151]
 ds_read2_b32 v[66:67], v16 offset0:34 offset1:35
 ds_read_b128 v[36:39], v14 offset:832
 v_mfma_f32_16x16x32_bf16 v[152:155], v[208:211], v[184:187], v[152:155]
 ds_read2_b32 v[68:69], v17 offset0:32 offset1:33
 ds_read2_b32 v[70:71], v17 offset0:34 offset1:35
 v_mfma_f32_16x16x32_bf16 v[156:159], v[208:211], v[188:191], v[156:159]
 ds_read_b128 v[40:43], v14 offset:1344
 ds_read2_b32 v[72:73], v18 offset0:32 offset1:33
 v_mfma_f32_16x16x32_bf16 v[148:151], v[212:215], v[176:179], v[148:151]
 ds_read2_b32 v[74:75], v18 offset0:34 offset1:35
 ds_read_b128 v[44:47], v14 offset:1856
 v_mfma_f32_16x16x32_bf16 v[152:155], v[212:215], v[180:183], v[152:155]
 ds_read2_b32 v[76:77], v19 offset0:32 offset1:33
 ds_read2_b32 v[78:79], v19 offset0:34 offset1:35
 v_mfma_f32_16x16x32_bf16 v[156:159], v[212:215], v[184:187], v[156:159]
 v_mfma_f32_16x16x32_bf16 v[152:155], v[216:219], v[176:179], v[152:155]
 v_mfma_f32_16x16x32_bf16 v[156:159], v[216:219], v[180:183], v[156:159]
 v_mfma_f32_16x16x32_bf16 v[156:159], v[220:223], v[176:179], v[156:159]
 s_waitcnt lgkmcnt(0)
 v_mfma_f32_16x16x32_bf16 v[144:147], v[64:67], v[32:35], v[144:147]
 ds_read_b128 v[176:179], v14 offset:256
 ds_read2_b32 v[208:209], v16 offset0:48 offset1:49
 v_mfma_f32_16x16x32_bf16 v[148:151], v[64:67], v[36:39], v[148:151]
 ds_read2_b32 v[210:211], v16 offset0:50 offset1:51
 ds_read_b128 v[180:183], v14 offset:768
 v_mfma_f32_16x16x32_bf16 v[152:155], v[64:67], v[40:43], v[152:155]
 ds_read2_b32 v[212:213], v17 offset0:48 offset1:49
 ds_read2_b32 v[214:215], v17 offset0:50 offset1:51
 v_mfma_f32_16x16x32_bf16 v[156:159], v[64:67], v[44:47], v[156:159]
 ds_read_b128 v[184:187], v14 offset:1280
 ds_read2_b32 v[216:217], v18 offset0:48 offset1:49
 v_mfma_f32_16x16x32_bf16 v[148:151], v[68:71], v[32:35], v[148:151]
 ds_read2_b32 v[218:219], v18 offset0:50 offset1:51
 ds_read_b128 v[188:191], v14 offset:1792
 v_mfma_f32_16x16x32_bf16 v[152:155], v[68:71], v[36:39], v[152:155]
 ds_read2_b32 v[220:221], v19 offset0:48 offset1:49
 ds_read2_b32 v[222:223], v19 offset0:50 offset1:51
 v_mfma_f32_16x16x32_bf16 v[156:159], v[68:71], v[40:43], v[156:159]
 v_mfma_f32_16x16x32_bf16 v[152:155], v[72:75], v[32:35], v[152:155]
 v_mfma_f32_16x16x32_bf16 v[156:159], v[72:75], v[36:39], v[156:159]
 v_mfma_f32_16x16x32_bf16 v[156:159], v[76:79], v[32:35], v[156:159]
 s_waitcnt lgkmcnt(0)
 v_mfma_f32_16x16x32_bf16 v[144:147], v[208:211], v[176:179], v[144:147]
 ds_read_b128 v[32:35], v14 offset:192
 ds_read2_b32 v[64:65], v16 offset0:64 offset1:65
 v_mfma_f32_16x16x32_bf16 v[148:151], v[208:211], v[180:183], v[148:151]
 ds_read2_b32 v[66:67], v16 offset0:66 offset1:67
 ds_read_b128 v[36:39], v14 offset:704
 v_mfma_f32_16x16x32_bf16 v[152:155], v[208:211], v[184:187], v[152:155]
 ds_read2_b32 v[68:69], v17 offset0:64 offset1:65
 ds_read2_b32 v[70:71], v17 offset0:66 offset1:67
 v_mfma_f32_16x16x32_bf16 v[156:159], v[208:211], v[188:191], v[156:159]
 ds_read_b128 v[40:43], v14 offset:1216
 ds_read2_b32 v[72:73], v18 offset0:64 offset1:65
 v_mfma_f32_16x16x32_bf16 v[148:151], v[212:215], v[176:179], v[148:151]
 ds_read2_b32 v[74:75], v18 offset0:66 offset1:67
 ds_read_b128 v[44:47], v14 offset:1728
 v_mfma_f32_16x16x32_bf16 v[152:155], v[212:215], v[180:183], v[152:155]
 ds_read2_b32 v[76:77], v19 offset0:64 offset1:65
 ds_read2_b32 v[78:79], v19 offset0:66 offset1:67
 v_mfma_f32_16x16x32_bf16 v[156:159], v[212:215], v[184:187], v[156:159]
 v_mfma_f32_16x16x32_bf16 v[152:155], v[216:219], v[176:179], v[152:155]
 v_mfma_f32_16x16x32_bf16 v[156:159], v[216:219], v[180:183], v[156:159]
 v_mfma_f32_16x16x32_bf16 v[156:159], v[220:223], v[176:179], v[156:159]
 s_waitcnt lgkmcnt(0)
 v_mfma_f32_16x16x32_bf16 v[144:147], v[64:67], v[32:35], v[144:147]
 ds_read_b128 v[176:179], v14 offset:128
 ds_read2_b32 v[208:209], v16 offset0:80 offset1:81
 v_mfma_f32_16x16x32_bf16 v[148:151], v[64:67], v[36:39], v[148:151]
 ds_read2_b32 v[210:211], v16 offset0:82 offset1:83
 ds_read_b128 v[180:183], v14 offset:640
 v_mfma_f32_16x16x32_bf16 v[152:155], v[64:67], v[40:43], v[152:155]
 ds_read2_b32 v[212:213], v17 offset0:80 offset1:81
 ds_read2_b32 v[214:215], v17 offset0:82 offset1:83
 v_mfma_f32_16x16x32_bf16 v[156:159], v[64:67], v[44:47], v[156:159]
 ds_read_b128 v[184:187], v14 offset:1152
 ds_read2_b32 v[216:217], v18 offset0:80 offset1:81
 v_mfma_f32_16x16x32_bf16 v[148:151], v[68:71], v[32:35], v[148:151]
 ds_read2_b32 v[218:219], v18 offset0:82 offset1:83
 ds_read_b128 v[188:191], v14 offset:1664
 v_mfma_f32_16x16x32_bf16 v[152:155], v[68:71], v[36:39], v[152:155]
 ds_read2_b32 v[220:221], v19 offset0:80 offset1:81
 ds_read2_b32 v[222:223], v19 offset0:82 offset1:83
 v_mfma_f32_16x16x32_bf16 v[156:159], v[68:71], v[40:43], v[156:159]
 v_mfma_f32_16x16x32_bf16 v[152:155], v[72:75], v[32:35], v[152:155]
 v_mfma_f32_16x16x32_bf16 v[156:159], v[72:75], v[36:39], v[156:159]
 v_mfma_f32_16x16x32_bf16 v[156:159], v[76:79], v[32:35], v[156:159]
 s_waitcnt lgkmcnt(0)
 v_mfma_f32_16x16x32_bf16 v[144:147], v[208:211], v[176:179], v[144:147]
 ds_read_b128 v[32:35], v14 offset:64
 ds_read2_b32 v[64:65], v16 offset0:96 offset1:97
 v_mfma_f32_16x16x32_bf16 v[148:151], v[208:211], v[180:183], v[148:151]
 ds_read2_b32 v[66:67], v16 offset0:98 offset1:99
 ds_read_b128 v[36:39], v14 offset:576
 v_mfma_f32_16x16x32_bf16 v[152:155], v[208:211], v[184:187], v[152:155]
 ds_read2_b32 v[68:69], v17 offset0:96 offset1:97
 ds_read2_b32 v[70:71], v17 offset0:98 offset1:99
 v_mfma_f32_16x16x32_bf16 v[156:159], v[208:211], v[188:191], v[156:159]
 ds_read_b128 v[40:43], v14 offset:1088
 ds_read2_b32 v[72:73], v18 offset0:96 offset1:97
 v_mfma_f32_16x16x32_bf16 v[148:151], v[212:215], v[176:179], v[148:151]
 ds_read2_b32 v[74:75], v18 offset0:98 offset1:99
 ds_read_b128 v[44:47], v14 offset:1600
 v_mfma_f32_16x16x32_bf16 v[152:155], v[212:215], v[180:183], v[152:155]
 ds_read2_b32 v[76:77], v19 offset0:96 offset1:97
 ds_read2_b32 v[78:79], v19 offset0:98 offset1:99
 v_mfma_f32_16x16x32_bf16 v[156:159], v[212:215], v[184:187], v[156:159]
 v_mfma_f32_16x16x32_bf16 v[152:155], v[216:219], v[176:179], v[152:155]
 v_mfma_f32_16x16x32_bf16 v[156:159], v[216:219], v[180:183], v[156:159]
 v_mfma_f32_16x16x32_bf16 v[156:159], v[220:223], v[176:179], v[156:159]
 s_waitcnt lgkmcnt(0)
 v_mfma_f32_16x16x32_bf16 v[144:147], v[64:67], v[32:35], v[144:147]
 ds_read_b128 v[176:179], v14 offset:0
 ds_read2_b32 v[208:209], v16 offset0:112 offset1:113
 v_mfma_f32_16x16x32_bf16 v[148:151], v[64:67], v[36:39], v[148:151]
 ds_read2_b32 v[210:211], v16 offset0:114 offset1:115
 ds_read_b128 v[180:183], v14 offset:512
 v_mfma_f32_16x16x32_bf16 v[152:155], v[64:67], v[40:43], v[152:155]
 ds_read2_b32 v[212:213], v17 offset0:112 offset1:113
 ds_read2_b32 v[214:215], v17 offset0:114 offset1:115
 v_mfma_f32_16x16x32_bf16 v[156:159], v[64:67], v[44:47], v[156:159]
 ds_read_b128 v[184:187], v14 offset:1024
 ds_read2_b32 v[216:217], v18 offset0:112 offset1:113
 v_mfma_f32_16x16x32_bf16 v[148:151], v[68:71], v[32:35], v[148:151]
 ds_read2_b32 v[218:219], v18 offset0:114 offset1:115
 ds_read_b128 v[188:191], v14 offset:1536
 v_mfma_f32_16x16x32_bf16 v[152:155], v[68:71], v[36:39], v[152:155]
 ds_read2_b32 v[220:221], v19 offset0:112 offset1:113
 ds_read2_b32 v[222:223], v19 offset0:114 offset1:115
 v_mfma_f32_16x16x32_bf16 v[156:159], v[68:71], v[40:43], v[156:159]
 v_mfma_f32_16x16x32_bf16 v[152:155], v[72:75], v[32:35], v[152:155]
 v_mfma_f32_16x16x32_bf16 v[156:159], v[72:75], v[36:39], v[156:159]
 v_mfma_f32_16x16x32_bf16 v[156:159], v[76:79], v[32:35], v[156:159]
 s_waitcnt lgkmcnt(0)
 v_mfma_f32_16x16x32_bf16 v[144:147], v[208:211], v[176:179], v[144:147]
 ds_read_b64 v[32:33], v15 offset:0
 ds_read_b64 v[34:35], v15 offset:512
 v_mfma_f32_16x16x32_bf16 v[148:151], v[208:211], v[180:183], v[148:151]
 ds_read_b64 v[36:37], v15 offset:1024
 ds_read_b64 v[38:39], v15 offset:1536
 v_mfma_f32_16x16x32_bf16 v[152:155], v[208:211], v[184:187], v[152:155]
 v_mfma_f32_16x16x32_bf16 v[156:159], v[208:211], v[188:191], v[156:159]
 v_mfma_f32_16x16x32_bf16 v[148:151], v[212:215], v[176:179], v[148:151]
 v_mfma_f32_16x16x32_bf16 v[152:155], v[212:215], v[180:183], v[152:155]
 v_mfma_f32_16x16x32_bf16 v[156:159], v[212:215], v[184:187], v[156:159]
 v_mfma_f32_16x16x32_bf16 v[152:155], v[216:219], v[176:179], v[152:155]
 v_mfma_f32_16x16x32_bf16 v[156:159], v[216:219], v[180:183], v[156:159]
 v_mfma_f32_16x16x32_bf16 v[156:159], v[220:223], v[176:179], v[156:159]
 s_waitcnt lgkmcnt(0)
 v_and_b32 v64, 0xffff0000, v33
 v_lshlrev_b32 v65, 16, v33
 v_and_b32 v66, 0xffff0000, v32
 v_lshlrev_b32 v67, 16, v32
 v_mul_f32 v64, v64, v12
 v_mul_f32 v65, v65, v12
 v_mul_f32 v66, v66, v12
 v_mul_f32 v67, v67, v12
 v_and_b32 v68, 0xffff0000, v35
 v_lshlrev_b32 v69, 16, v35
 v_and_b32 v70, 0xffff0000, v34
 v_lshlrev_b32 v71, 16, v34
 v_mul_f32 v68, v68, v12
 v_mul_f32 v69, v69, v12
 v_mul_f32 v70, v70, v12
 v_mul_f32 v71, v71, v12
 v_and_b32 v72, 0xffff0000, v37
 v_lshlrev_b32 v73, 16, v37
 v_and_b32 v74, 0xffff0000, v36
 v_lshlrev_b32 v75, 16, v36
 v_mul_f32 v72, v72, v12
 v_mul_f32 v73, v73, v12
 v_mul_f32 v74, v74, v12
 v_mul_f32 v75, v75, v12
 v_and_b32 v76, 0xffff0000, v39
 v_lshlrev_b32 v77, 16, v39
 v_and_b32 v78, 0xffff0000, v38
 v_lshlrev_b32 v79, 16, v38
 v_mul_f32 v76, v76, v12
 v_mul_f32 v77, v77, v12
 v_mul_f32 v78, v78, v12
 v_mul_f32 v79, v79, v12
 v_cvt_pk_bf16_f32 v8, v64, v65
 v_lshlrev_b32 v64, 16, v8
 v_and_b32 v65, 0xffff0000, v8
 v_cvt_pk_bf16_f32 v8, v66, v67
 v_lshlrev_b32 v66, 16, v8
 v_and_b32 v67, 0xffff0000, v8
 v_cvt_pk_bf16_f32 v8, v68, v69
 v_lshlrev_b32 v68, 16, v8
 v_and_b32 v69, 0xffff0000, v8
 v_cvt_pk_bf16_f32 v8, v70, v71
 v_lshlrev_b32 v70, 16, v8
 v_and_b32 v71, 0xffff0000, v8
 v_cvt_pk_bf16_f32 v8, v72, v73
 v_lshlrev_b32 v72, 16, v8
 v_and_b32 v73, 0xffff0000, v8
 v_cvt_pk_bf16_f32 v8, v74, v75
 v_lshlrev_b32 v74, 16, v8
 v_and_b32 v75, 0xffff0000, v8
 v_cvt_pk_bf16_f32 v8, v76, v77
 v_lshlrev_b32 v76, 16, v8
 v_and_b32 v77, 0xffff0000, v8
 v_cvt_pk_bf16_f32 v8, v78, v79
 v_lshlrev_b32 v78, 16, v8
 v_and_b32 v79, 0xffff0000, v8
 v_cvt_pk_bf16_f32 v8, v144, v145
 v_lshlrev_b32 v144, 16, v8
 v_and_b32 v145, 0xffff0000, v8
 v_cvt_pk_bf16_f32 v8, v146, v147
 v_lshlrev_b32 v146, 16, v8
 v_and_b32 v147, 0xffff0000, v8
 v_cvt_pk_bf16_f32 v8, v148, v149
 v_lshlrev_b32 v148, 16, v8
 v_and_b32 v149, 0xffff0000, v8
 v_cvt_pk_bf16_f32 v8, v150, v151
 v_lshlrev_b32 v150, 16, v8
 v_and_b32 v151, 0xffff0000, v8
 v_cvt_pk_bf16_f32 v8, v152, v153
 v_lshlrev_b32 v152, 16, v8
 v_and_b32 v153, 0xffff0000, v8
 v_cvt_pk_bf16_f32 v8, v154, v155
 v_lshlrev_b32 v154, 16, v8
 v_and_b32 v155, 0xffff0000, v8
 v_cvt_pk_bf16_f32 v8, v156, v157
 v_lshlrev_b32 v156, 16, v8
 v_and_b32 v157, 0xffff0000, v8
 v_cvt_pk_bf16_f32 v8, v158, v159
 v_lshlrev_b32 v158, 16, v8
 v_and_b32 v159, 0xffff0000, v8
 v_pk_add_f32 v[144:145], v[144:145], v[64:65]
 v_pk_add_f32 v[146:147], v[146:147], v[66:67]
 v_pk_add_f32 v[148:149], v[148:149], v[68:69]
 v_pk_add_f32 v[150:151], v[150:151], v[70:71]
 v_pk_add_f32 v[152:153], v[152:153], v[72:73]
 v_pk_add_f32 v[154:155], v[154:155], v[74:75]
 v_pk_add_f32 v[156:157], v[156:157], v[76:77]
 v_pk_add_f32 v[158:159], v[158:159], v[78:79]
 v_cvt_pk_bf16_f32 v160, v144, v148
 v_cvt_pk_bf16_f32 v161, v152, v156
 buffer_store_dwordx2 v[160:161], v13, s[4:7], s72 offen sc1
 s_add_u32 s72, s72, 40960
 v_cvt_pk_bf16_f32 v162, v145, v149
 v_cvt_pk_bf16_f32 v163, v153, v157
 buffer_store_dwordx2 v[162:163], v13, s[4:7], s72 offen sc1
 s_add_u32 s72, s72, 40960
 v_cvt_pk_bf16_f32 v164, v146, v150
 v_cvt_pk_bf16_f32 v165, v154, v158
 buffer_store_dwordx2 v[164:165], v13, s[4:7], s72 offen sc1
 s_add_u32 s72, s72, 40960
 v_cvt_pk_bf16_f32 v166, v147, v151
 v_cvt_pk_bf16_f32 v167, v155, v159
 buffer_store_dwordx2 v[166:167], v13, s[4:7], s72 offen sc1
 s_add_u32 s72, s72, 40960
 s_cmp_lt_u32 s70, 640
 s_cbranch_scc1 L_cv_4
 s_setpc_b64 s[76:77]
L_conv1:
 s_mov_b32 s8, s38
 s_and_b32 s9, s39, 0xffff
 s_mov_b32 s10, 2621440
 s_mov_b32 s11, 0x00020000
 s_mov_b32 s12, s40
 s_and_b32 s13, s41, 0xffff
 s_mov_b32 s14, 1280
 s_mov_b32 s15, 0x00020000
 v_lshlrev_b32 v130, 4, v0
 v_add_u32 v7, s71, v130
 v_mov_b32 v8, 0
 v_mov_b32 v9, 0
 v_mov_b32 v10, 0
 v_mov_b32 v11, 0
 s_mov_b32 exec_hi, 0
 ds_write_b128 v7, v[8:11] offset:0
 s_mov_b32 exec_lo, 3
 ds_write_b128 v7, v[8:11] offset:4608
 ds_write_b128 v7, v[8:11] offset:8768
 s_mov_b64 exec, -1
 v_and_b32 v8, 15, v0
 v_lshrrev_b32 v9, 5, v0
 v_sub_u32 v10, v8, v9
 v_lshlrev_b32 v10, 5, v10
 v_and_b32 v11, 16, v0
 v_add_u32 v10, v10, v11
 s_add_u32 s3, s71, 64
 v_add_u32 v14, s3, v10
 v_lshlrev_b32 v10, 5, v9
 v_lshl_add_u32 v10, v8, 1, v10
 v_sub_u32 v10, v10, v11
 v_and_b32 v11, 1, v0
 v_cmp_eq_u32 vcc, 1, v11
 v_mov_b32 v12, 8784
 v_mov_b32 v11, 4626
 s_nop 0
 v_cndmask_b32 v11, v12, v11, vcc
 v_add3_u32 v16, v10, v11, s71
 v_add_u32 v17, 512, v16
 v_add_u32 v18, 1024, v16
 v_add_u32 v19, 1536, v16
 v_add_u32 v20, 2048, v16
 v_add_u32 v21, 2560, v16
 v_add_u32 v22, 3072, v16
 v_add_u32 v23, 3584, v16
 v_lshlrev_b32 v10, 5, v8
 v_lshl_add_u32 v10, v9, 4, v10
 v_and_b32 v11, 16, v0
 v_lshrrev_b32 v11, 1, v11
 v_xor_b32 v11, 8, v11
 s_add_u32 s3, s71, 512
 v_add3_u32 v15, v10, v11, s3
 v_and_b32 v10, 1, v0
 v_lshlrev_b32 v10, 4, v10
 v_lshrrev_b32 v11, 4, v0
 v_lshl_add_u32 v10, v11, 2, v10
 s_mov_b32 s3, 40960
 v_mul_lo_u32 v13, v10, s3
 v_lshrrev_b32 v11, 1, v8
 v_lshl_add_u32 v13, v11, 3, v13
 s_waitcnt vmcnt(0)
L_cv_5:
 s_waitcnt vmcnt(4)
 ds_write_b128 v7, v[240:243] offset:512
 ds_write_b128 v7, v[96:99] offset:4640
 ds_write_b128 v7, v[112:115] offset:8800
 ds_write_b128 v7, v[244:247] offset:1536
 ds_write_b128 v7, v[100:103] offset:5664
 ds_write_b128 v7, v[116:119] offset:9824
 ds_write_b128 v7, v[248:251] offset:2560
 ds_write_b128 v7, v[104:107] offset:6688
 ds_write_b128 v7, v[120:123] offset:10848
 ds_write_b128 v7, v[252:255] offset:3584
 ds_write_b128 v7, v[108:111] offset:7712
 ds_write_b128 v7, v[124:127] offset:11872
 v_lshlrev_b32 v8, 16, v96
 v_lshlrev_b32 v12, 16, v128
 s_mov_b64 exec, 1
 ds_write_b32 v7, v8 offset:8796
 s_mov_b64 exec, -1
 s_lshl_b32 s72, s70, 6
 s_add_u32 s72, s72, 202113024
 s_add_u32 s70, s70, s69
 s_waitcnt lgkmcnt(0)
 s_lshl_b32 s73, s70, 12
 s_add_u32 s74, s73, 2
 buffer_load_dwordx4 v[96:99], v130, s[8:11], s73 offen offset:0
 buffer_load_dwordx4 v[100:103], v130, s[8:11], s73 offen offset:1024
 buffer_load_dwordx4 v[104:107], v130, s[8:11], s73 offen offset:2048
 buffer_load_dwordx4 v[108:111], v130, s[8:11], s73 offen offset:3072
 buffer_load_dwordx4 v[112:115], v130, s[8:11], s74 offen offset:0
 buffer_load_dwordx4 v[116:119], v130, s[8:11], s74 offen offset:1024
 buffer_load_dwordx4 v[120:123], v130, s[8:11], s74 offen offset:2048
 buffer_load_dwordx4 v[124:127], v130, s[8:11], s74 offen offset:3072
 s_lshl_b32 s3, s70, 1
 buffer_load_ushort v128, off, s[12:15], s3
 s_lshl_b32 s3, s70, 12
 s_add_u32 s3, s3, 198180864
 buffer_load_dwordx4 v[240:243], v130, s[4:7], s3 offen offset:0 sc1
 buffer_load_dwordx4 v[244:247], v130, s[4:7], s3 offen offset:1024 sc1
 buffer_load_dwordx4 v[248:251], v130, s[4:7], s3 offen offset:2048 sc1
 buffer_load_dwordx4 v[252:255], v130, s[4:7], s3 offen offset:3072 sc1
 ds_read_b128 v[32:35], v14 offset:448
 ds_read2_b32 v[64:65], v16 offset0:0 offset1:1
 ds_read2_b32 v[66:67], v16 offset0:2 offset1:3
 ds_read_b128 v[36:39], v14 offset:960
 ds_read2_b32 v[68:69], v17 offset0:0 offset1:1
 ds_read2_b32 v[70:71], v17 offset0:2 offset1:3
 ds_read_b128 v[40:43], v14 offset:1472
 ds_read2_b32 v[72:73], v18 offset0:0 offset1:1
 ds_read2_b32 v[74:75], v18 offset0:2 offset1:3
 ds_read_b128 v[44:47], v14 offset:1984
 ds_read2_b32 v[76:77], v19 offset0:0 offset1:1
 ds_read2_b32 v[78:79], v19 offset0:2 offset1:3
 ds_read_b128 v[48:51], v14 offset:2496
 ds_read2_b32 v[80:81], v20 offset0:0 offset1:1
 ds_read2_b32 v[82:83], v20 offset0:2 offset1:3
 ds_read_b128 v[52:55], v14 offset:3008
 ds_read2_b32 v[84:85], v21 offset0:0 offset1:1
 ds_read2_b32 v[86:87], v21 offset0:2 offset1:3
 ds_read_b128 v[56:59], v14 offset:3520
 ds_read2_b32 v[88:89], v22 offset0:0 offset1:1
 ds_read2_b32 v[90:91], v22 offset0:2 offset1:3
 ds_read_b128 v[60:63], v14 offset:4032
 ds_read2_b32 v[92:93], v23 offset0:0 offset1:1
 ds_read2_b32 v[94:95], v23 offset0:2 offset1:3
 s_waitcnt lgkmcnt(0)
 v_mfma_f32_16x16x32_bf16 v[144:147], v[64:67], v[48:51], 0
 ds_read_b128 v[176:179], v14 offset:384
 v_mfma_f32_16x16x32_bf16 v[148:151], v[64:67], v[52:55], 0
 ds_read2_b32 v[208:209], v16 offset0:16 offset1:17
 v_mfma_f32_16x16x32_bf16 v[152:155], v[64:67], v[56:59], 0
 ds_read2_b32 v[210:211], v16 offset0:18 offset1:19
 v_mfma_f32_16x16x32_bf16 v[156:159], v[64:67], v[60:63], 0
 ds_read_b128 v[180:183], v14 offset:896
 v_mfma_f32_16x16x32_bf16 v[144:147], v[68:71], v[44:47], v[144:147]
 ds_read2_b32 v[212:213], v17 offset0:16 offset1:17
 v_mfma_f32_16x16x32_bf16 v[148:151], v[68:71], v[48:51], v[148:151]
 ds_read2_b32 v[214:215], v17 offset0:18 offset1:19
 v_mfma_f32_16x16x32_bf16 v[152:155], v[68:71], v[52:55], v[152:155]
 ds_read_b128 v[184:187], v14 offset:1408
 v_mfma_f32_16x16x32_bf16 v[156:159], v[68:71], v[56:59], v[156:159]
 ds_read2_b32 v[216:217], v18 offset0:16 offset1:17
 v_mfma_f32_16x16x32_bf16 v[144:147], v[72:75], v[40:43], v[144:147]
 ds_read2_b32 v[218:219], v18 offset0:18 offset1:19
 v_mfma_f32_16x16x32_bf16 v[148:151], v[72:75], v[44:47], v[148:151]
 ds_read_b128 v[188:191], v14 offset:1920
 v_mfma_f32_16x16x32_bf16 v[152:155], v[72:75], v[48:51], v[152:155]
 ds_read2_b32 v[220:221], v19 offset0:16 offset1:17
 v_mfma_f32_16x16x32_bf16 v[156:159], v[72:75], v[52:55], v[156:159]
 ds_read2_b32 v[222:223], v19 offset0:18 offset1:19
 v_mfma_f32_16x16x32_bf16 v[144:147], v[76:79], v[36:39], v[144:147]
 ds_read_b128 v[192:195], v14 offset:2432
 v_mfma_f32_16x16x32_bf16 v[148:151], v[76:79], v[40:43], v[148:151]
 ds_read2_b32 v[224:225], v20 offset0:16 offset1:17
 v_mfma_f32_16x16x32_bf16 v[152:155], v[76:79], v[44:47], v[152:155]
 ds_read2_b32 v[226:227], v20 offset0:18 offset1:19
 v_mfma_f32_16x16x32_bf16 v[156:159], v[76:79], v[48:51], v[156:159]
 ds_read_b128 v[196:199], v14 offset:2944
 v_mfma_f32_16x16x32_bf16 v[144:147], v[80:83], v[32:35], v[144:147]
 ds_read2_b32 v[228:229], v21 offset0:16 offset1:17
 v_mfma_f32_16x16x32_bf16 v[148:151], v[80:83], v[36:39], v[148:151]
 ds_read2_b32 v[230:231], v21 offset0:18 offset1:19
 v_mfma_f32_16x16x32_bf16 v[152:155], v[80:83], v[40:43], v[152:155]
 ds_read_b128 v[200:203], v14 offset:3456
 v_mfma_f32_16x16x32_bf16 v[156:159], v[80:83], v[44:47], v[156:159]
 ds_read2_b32 v[232:233], v22 offset0:16 offset1:17
 v_mfma_f32_16x16x32_bf16 v[148:151], v[84:87], v[32:35], v[148:151]
 ds_read2_b32 v[234:235], v22 offset0:18 offset1:19
 v_mfma_f32_16x16x32_bf16 v[152:155], v[84:87], v[36:39], v[152:155]
 ds_read_b128 v[204:207], v14 offset:3968
 v_mfma_f32_16x16x32_bf16 v[156:159], v[84:87], v[40:43], v[156:159]
 ds_read2_b32 v[236:237], v23 offset0:16 offset1:17
 v_mfma_f32_16x16x32_bf16 v[152:155], v[88:91], v[32:35], v[152:155]
 ds_read2_b32 v[238:239], v23 offset0:18 offset1:19
 v_mfma_f32_16x16x32_bf16 v[156:159], v[88:91], v[36:39], v[156:159]
 v_mfma_f32_16x16x32_bf16 v[156:159], v[92:95], v[32:35], v[156:159]
 s_waitcnt lgkmcnt(0)
 v_mfma_f32_16x16x32_bf16 v[144:147], v[208:211], v[192:195], v[144:147]
 ds_read_b128 v[32:35], v14 offset:320
 v_mfma_f32_16x16x32_bf16 v[148:151], v[208:211], v[196:199], v[148:151]
 ds_read2_b32 v[64:65], v16 offset0:32 offset1:33
 v_mfma_f32_16x16x32_bf16 v[152:155], v[208:211], v[200:203], v[152:155]
 ds_read2_b32 v[66:67], v16 offset0:34 offset1:35
 v_mfma_f32_16x16x32_bf16 v[156:159], v[208:211], v[204:207], v[156:159]
 ds_read_b128 v[36:39], v14 offset:832
 v_mfma_f32_16x16x32_bf16 v[144:147], v[212:215], v[188:191], v[144:147]
 ds_read2_b32 v[68:69], v17 offset0:32 offset1:33
 v_mfma_f32_16x16x32_bf16 v[148:151], v[212:215], v[192:195], v[148:151]
 ds_read2_b32 v[70:71], v17 offset0:34 offset1:35
 v_mfma_f32_16x16x32_bf16 v[152:155], v[212:215], v[196:199], v[152:155]
 ds_read_b128 v[40:43], v14 offset:1344
 v_mfma_f32_16x16x32_bf16 v[156:159], v[212:215], v[200:203], v[156:159]
 ds_read2_b32 v[72:73], v18 offset0:32 offset1:33
 v_mfma_f32_16x16x32_bf16 v[144:147], v[216:219], v[184:187], v[144:147]
 ds_read2_b32 v[74:75], v18 offset0:34 offset1:35
 v_mfma_f32_16x16x32_bf16 v[148:151], v[216:219], v[188:191], v[148:151]
 ds_read_b128 v[44:47], v14 offset:1856
 v_mfma_f32_16x16x32_bf16 v[152:155], v[216:219], v[192:195], v[152:155]
 ds_read2_b32 v[76:77], v19 offset0:32 offset1:33
 v_mfma_f32_16x16x32_bf16 v[156:159], v[216:219], v[196:199], v[156:159]
 ds_read2_b32 v[78:79], v19 offset0:34 offset1:35
 v_mfma_f32_16x16x32_bf16 v[144:147], v[220:223], v[180:183], v[144:147]
 ds_read_b128 v[48:51], v14 offset:2368
 v_mfma_f32_16x16x32_bf16 v[148:151], v[220:223], v[184:187], v[148:151]
 ds_read2_b32 v[80:81], v20 offset0:32 offset1:33
 v_mfma_f32_16x16x32_bf16 v[152:155], v[220:223], v[188:191], v[152:155]
 ds_read2_b32 v[82:83], v20 offset0:34 offset1:35
 v_mfma_f32_16x16x32_bf16 v[156:159], v[220:223], v[192:195], v[156:159]
 ds_read_b128 v[52:55], v14 offset:2880
 v_mfma_f32_16x16x32_bf16 v[144:147], v[224:227], v[176:179], v[144:147]
 ds_read2_b32 v[84:85], v21 offset0:32 offset1:33
 v_mfma_f32_16x16x32_bf16 v[148:151], v[224:227], v[180:183], v[148:151]
 ds_read2_b32 v[86:87], v21 offset0:34 offset1:35
 v_mfma_f32_16x16x32_bf16 v[152:155], v[224:227], v[184:187], v[152:155]
 ds_read_b128 v[56:59], v14 offset:3392
 v_mfma_f32_16x16x32_bf16 v[156:159], v[224:227], v[188:191], v[156:159]
 ds_read2_b32 v[88:89], v22 offset0:32 offset1:33
 v_mfma_f32_16x16x32_bf16 v[148:151], v[228:231], v[176:179], v[148:151]
 ds_read2_b32 v[90:91], v22 offset0:34 offset1:35
 v_mfma_f32_16x16x32_bf16 v[152:155], v[228:231], v[180:183], v[152:155]
 ds_read_b128 v[60:63], v14 offset:3904
 v_mfma_f32_16x16x32_bf16 v[156:159], v[228:231], v[184:187], v[156:159]
 ds_read2_b32 v[92:93], v23 offset0:32 offset1:33
 v_mfma_f32_16x16x32_bf16 v[152:155], v[232:235], v[176:179], v[152:155]
 ds_read2_b32 v[94:95], v23 offset0:34 offset1:35
 v_mfma_f32_16x16x32_bf16 v[156:159], v[232:235], v[180:183], v[156:159]
 v_mfma_f32_16x16x32_bf16 v[156:159], v[236:239], v[176:179], v[156:159]
 s_waitcnt lgkmcnt(0)
 v_mfma_f32_16x16x32_bf16 v[144:147], v[64:67], v[48:51], v[144:147]
 ds_read_b128 v[176:179], v14 offset:256
 v_mfma_f32_16x16x32_bf16 v[148:151], v[64:67], v[52:55], v[148:151]
 ds_read2_b32 v[208:209], v16 offset0:48 offset1:49
 v_mfma_f32_16x16x32_bf16 v[152:155], v[64:67], v[56:59], v[152:155]
 ds_read2_b32 v[210:211], v16 offset0:50 offset1:51
 v_mfma_f32_16x16x32_bf16 v[156:159], v[64:67], v[60:63], v[156:159]
 ds_read_b128 v[180:183], v14 offset:768
 v_mfma_f32_16x16x32_bf16 v[144:147], v[68:71], v[44:47], v[144:147]
 ds_read2_b32 v[212:213], v17 offset0:48 offset1:49
 v_mfma_f32_16x16x32_bf16 v[148:151], v[68:71], v[48:51], v[148:151]
 ds_read2_b32 v[214:215], v17 offset0:50 offset1:51
 v_mfma_f32_16x16x32_bf16 v[152:155], v[68:71], v[52:55], v[152:155]
 ds_read_b128 v[184:187], v14 offset:1280
 v_mfma_f32_16x16x32_bf16 v[156:159], v[68:71], v[56:59], v[156:159]
 ds_read2_b32 v[216:217], v18 offset0:48 offset1:49
 v_mfma_f32_16x16x32_bf16 v[144:147], v[72:75], v[40:43], v[144:147]
 ds_read2_b32 v[218:219], v18 offset0:50 offset1:51
 v_mfma_f32_16x16x32_bf16 v[148:151], v[72:75], v[44:47], v[148:151]
 ds_read_b128 v[188:191], v14 offset:1792
 v_mfma_f32_16x16x32_bf16 v[152:155], v[72:75], v[48:51], v[152:155]
 ds_read2_b32 v[220:221], v19 offset0:48 offset1:49
 v_mfma_f32_16x16x32_bf16 v[156:159], v[72:75], v[52:55], v[156:159]
 ds_read2_b32 v[222:223], v19 offset0:50 offset1:51
 v_mfma_f32_16x16x32_bf16 v[144:147], v[76:79], v[36:39], v[144:147]
 ds_read_b128 v[192:195], v14 offset:2304
 v_mfma_f32_16x16x32_bf16 v[148:151], v[76:79], v[40:43], v[148:151]
 ds_read2_b32 v[224:225], v20 offset0:48 offset1:49
 v_mfma_f32_16x16x32_bf16 v[152:155], v[76:79], v[44:47], v[152:155]
 ds_read2_b32 v[226:227], v20 offset0:50 offset1:51
 v_mfma_f32_16x16x32_bf16 v[156:159], v[76:79], v[48:51], v[156:159]
 ds_read_b128 v[196:199], v14 offset:2816
 v_mfma_f32_16x16x32_bf16 v[144:147], v[80:83], v[32:35], v[144:147]
 ds_read2_b32 v[228:229], v21 offset0:48 offset1:49
 v_mfma_f32_16x16x32_bf16 v[148:151], v[80:83], v[36:39], v[148:151]
 ds_read2_b32 v[230:231], v21 offset0:50 offset1:51
 v_mfma_f32_16x16x32_bf16 v[152:155], v[80:83], v[40:43], v[152:155]
 ds_read_b128 v[200:203], v14 offset:3328
 v_mfma_f32_16x16x32_bf16 v[156:159], v[80:83], v[44:47], v[156:159]
 ds_read2_b32 v[232:233], v22 offset0:48 offset1:49
 v_mfma_f32_16x16x32_bf16 v[148:151], v[84:87], v[32:35], v[148:151]
 ds_read2_b32 v[234:235], v22 offset0:50 offset1:51
 v_mfma_f32_16x16x32_bf16 v[152:155], v[84:87], v[36:39], v[152:155]
 ds_read_b128 v[204:207], v14 offset:3840
 v_mfma_f32_16x16x32_bf16 v[156:159], v[84:87], v[40:43], v[156:159]
 ds_read2_b32 v[236:237], v23 offset0:48 offset1:49
 v_mfma_f32_16x16x32_bf16 v[152:155], v[88:91], v[32:35], v[152:155]
 ds_read2_b32 v[238:239], v23 offset0:50 offset1:51
 v_mfma_f32_16x16x32_bf16 v[156:159], v[88:91], v[36:39], v[156:159]
 v_mfma_f32_16x16x32_bf16 v[156:159], v[92:95], v[32:35], v[156:159]
 s_waitcnt lgkmcnt(0)
 v_mfma_f32_16x16x32_bf16 v[144:147], v[208:211], v[192:195], v[144:147]
 ds_read_b128 v[32:35], v14 offset:192
 v_mfma_f32_16x16x32_bf16 v[148:151], v[208:211], v[196:199], v[148:151]
 ds_read2_b32 v[64:65], v16 offset0:64 offset1:65
 v_mfma_f32_16x16x32_bf16 v[152:155], v[208:211], v[200:203], v[152:155]
 ds_read2_b32 v[66:67], v16 offset0:66 offset1:67
 v_mfma_f32_16x16x32_bf16 v[156:159], v[208:211], v[204:207], v[156:159]
 ds_read_b128 v[36:39], v14 offset:704
 v_mfma_f32_16x16x32_bf16 v[144:147], v[212:215], v[188:191], v[144:147]
 ds_read2_b32 v[68:69], v17 offset0:64 offset1:65
 v_mfma_f32_16x16x32_bf16 v[148:151], v[212:215], v[192:195], v[148:151]
 ds_read2_b32 v[70:71], v17 offset0:66 offset1:67
 v_mfma_f32_16x16x32_bf16 v[152:155], v[212:215], v[196:199], v[152:155]
 ds_read_b128 v[40:43], v14 offset:1216
 v_mfma_f32_16x16x32_bf16 v[156:159], v[212:215], v[200:203], v[156:159]
 ds_read2_b32 v[72:73], v18 offset0:64 offset1:65
 v_mfma_f32_16x16x32_bf16 v[144:147], v[216:219], v[184:187], v[144:147]
 ds_read2_b32 v[74:75], v18 offset0:66 offset1:67
 v_mfma_f32_16x16x32_bf16 v[148:151], v[216:219], v[188:191], v[148:151]
 ds_read_b128 v[44:47], v14 offset:1728
 v_mfma_f32_16x16x32_bf16 v[152:155], v[216:219], v[192:195], v[152:155]
 ds_read2_b32 v[76:77], v19 offset0:64 offset1:65
 v_mfma_f32_16x16x32_bf16 v[156:159], v[216:219], v[196:199], v[156:159]
 ds_read2_b32 v[78:79], v19 offset0:66 offset1:67
 v_mfma_f32_16x16x32_bf16 v[144:147], v[220:223], v[180:183], v[144:147]
 ds_read_b128 v[48:51], v14 offset:2240
 v_mfma_f32_16x16x32_bf16 v[148:151], v[220:223], v[184:187], v[148:151]
 ds_read2_b32 v[80:81], v20 offset0:64 offset1:65
 v_mfma_f32_16x16x32_bf16 v[152:155], v[220:223], v[188:191], v[152:155]
 ds_read2_b32 v[82:83], v20 offset0:66 offset1:67
 v_mfma_f32_16x16x32_bf16 v[156:159], v[220:223], v[192:195], v[156:159]
 ds_read_b128 v[52:55], v14 offset:2752
 v_mfma_f32_16x16x32_bf16 v[144:147], v[224:227], v[176:179], v[144:147]
 ds_read2_b32 v[84:85], v21 offset0:64 offset1:65
 v_mfma_f32_16x16x32_bf16 v[148:151], v[224:227], v[180:183], v[148:151]
 ds_read2_b32 v[86:87], v21 offset0:66 offset1:67
 v_mfma_f32_16x16x32_bf16 v[152:155], v[224:227], v[184:187], v[152:155]
 ds_read_b128 v[56:59], v14 offset:3264
 v_mfma_f32_16x16x32_bf16 v[156:159], v[224:227], v[188:191], v[156:159]
 ds_read2_b32 v[88:89], v22 offset0:64 offset1:65
 v_mfma_f32_16x16x32_bf16 v[148:151], v[228:231], v[176:179], v[148:151]
 ds_read2_b32 v[90:91], v22 offset0:66 offset1:67
 v_mfma_f32_16x16x32_bf16 v[152:155], v[228:231], v[180:183], v[152:155]
 ds_read_b128 v[60:63], v14 offset:3776
 v_mfma_f32_16x16x32_bf16 v[156:159], v[228:231], v[184:187], v[156:159]
 ds_read2_b32 v[92:93], v23 offset0:64 offset1:65
 v_mfma_f32_16x16x32_bf16 v[152:155], v[232:235], v[176:179], v[152:155]
 ds_read2_b32 v[94:95], v23 offset0:66 offset1:67
 v_mfma_f32_16x16x32_bf16 v[156:159], v[232:235], v[180:183], v[156:159]
 v_mfma_f32_16x16x32_bf16 v[156:159], v[236:239], v[176:179], v[156:159]
 s_waitcnt lgkmcnt(0)
 v_mfma_f32_16x16x32_bf16 v[144:147], v[64:67], v[48:51], v[144:147]
 ds_read_b128 v[176:179], v14 offset:128
 v_mfma_f32_16x16x32_bf16 v[148:151], v[64:67], v[52:55], v[148:151]
 ds_read2_b32 v[208:209], v16 offset0:80 offset1:81
 v_mfma_f32_16x16x32_bf16 v[152:155], v[64:67], v[56:59], v[152:155]
 ds_read2_b32 v[210:211], v16 offset0:82 offset1:83
 v_mfma_f32_16x16x32_bf16 v[156:159], v[64:67], v[60:63], v[156:159]
 ds_read_b128 v[180:183], v14 offset:640
 v_mfma_f32_16x16x32_bf16 v[144:147], v[68:71], v[44:47], v[144:147]
 ds_read2_b32 v[212:213], v17 offset0:80 offset1:81
 v_mfma_f32_16x16x32_bf16 v[148:151], v[68:71], v[48:51], v[148:151]
 ds_read2_b32 v[214:215], v17 offset0:82 offset1:83
 v_mfma_f32_16x16x32_bf16 v[152:155], v[68:71], v[52:55], v[152:155]
 ds_read_b128 v[184:187], v14 offset:1152
 v_mfma_f32_16x16x32_bf16 v[156:159], v[68:71], v[56:59], v[156:159]
 ds_read2_b32 v[216:217], v18 offset0:80 offset1:81
 v_mfma_f32_16x16x32_bf16 v[144:147], v[72:75], v[40:43], v[144:147]
 ds_read2_b32 v[218:219], v18 offset0:82 offset1:83
 v_mfma_f32_16x16x32_bf16 v[148:151], v[72:75], v[44:47], v[148:151]
 ds_read_b128 v[188:191], v14 offset:1664
 v_mfma_f32_16x16x32_bf16 v[152:155], v[72:75], v[48:51], v[152:155]
 ds_read2_b32 v[220:221], v19 offset0:80 offset1:81
 v_mfma_f32_16x16x32_bf16 v[156:159], v[72:75], v[52:55], v[156:159]
 ds_read2_b32 v[222:223], v19 offset0:82 offset1:83
 v_mfma_f32_16x16x32_bf16 v[144:147], v[76:79], v[36:39], v[144:147]
 ds_read_b128 v[192:195], v14 offset:2176
 v_mfma_f32_16x16x32_bf16 v[148:151], v[76:79], v[40:43], v[148:151]
 ds_read2_b32 v[224:225], v20 offset0:80 offset1:81
 v_mfma_f32_16x16x32_bf16 v[152:155], v[76:79], v[44:47], v[152:155]
 ds_read2_b32 v[226:227], v20 offset0:82 offset1:83
 v_mfma_f32_16x16x32_bf16 v[156:159], v[76:79], v[48:51], v[156:159]
 ds_read_b128 v[196:199], v14 offset:2688
 v_mfma_f32_16x16x32_bf16 v[144:147], v[80:83], v[32:35], v[144:147]
 ds_read2_b32 v[228:229], v21 offset0:80 offset1:81
 v_mfma_f32_16x16x32_bf16 v[148:151], v[80:83], v[36:39], v[148:151]
 ds_read2_b32 v[230:231], v21 offset0:82 offset1:83
 v_mfma_f32_16x16x32_bf16 v[152:155], v[80:83], v[40:43], v[152:155]
 ds_read_b128 v[200:203], v14 offset:3200
 v_mfma_f32_16x16x32_bf16 v[156:159], v[80:83], v[44:47], v[156:159]
 ds_read2_b32 v[232:233], v22 offset0:80 offset1:81
 v_mfma_f32_16x16x32_bf16 v[148:151], v[84:87], v[32:35], v[148:151]
 ds_read2_b32 v[234:235], v22 offset0:82 offset1:83
 v_mfma_f32_16x16x32_bf16 v[152:155], v[84:87], v[36:39], v[152:155]
 ds_read_b128 v[204:207], v14 offset:3712
 v_mfma_f32_16x16x32_bf16 v[156:159], v[84:87], v[40:43], v[156:159]
 ds_read2_b32 v[236:237], v23 offset0:80 offset1:81
 v_mfma_f32_16x16x32_bf16 v[152:155], v[88:91], v[32:35], v[152:155]
 ds_read2_b32 v[238:239], v23 offset0:82 offset1:83
 v_mfma_f32_16x16x32_bf16 v[156:159], v[88:91], v[36:39], v[156:159]
 v_mfma_f32_16x16x32_bf16 v[156:159], v[92:95], v[32:35], v[156:159]
 s_waitcnt lgkmcnt(0)
 v_mfma_f32_16x16x32_bf16 v[144:147], v[208:211], v[192:195], v[144:147]
 ds_read_b128 v[32:35], v14 offset:64
 v_mfma_f32_16x16x32_bf16 v[148:151], v[208:211], v[196:199], v[148:151]
 ds_read2_b32 v[64:65], v16 offset0:96 offset1:97
 v_mfma_f32_16x16x32_bf16 v[152:155], v[208:211], v[200:203], v[152:155]
 ds_read2_b32 v[66:67], v16 offset0:98 offset1:99
 v_mfma_f32_16x16x32_bf16 v[156:159], v[208:211], v[204:207], v[156:159]
 ds_read_b128 v[36:39], v14 offset:576
 v_mfma_f32_16x16x32_bf16 v[144:147], v[212:215], v[188:191], v[144:147]
 ds_read2_b32 v[68:69], v17 offset0:96 offset1:97
 v_mfma_f32_16x16x32_bf16 v[148:151], v[212:215], v[192:195], v[148:151]
 ds_read2_b32 v[70:71], v17 offset0:98 offset1:99
 v_mfma_f32_16x16x32_bf16 v[152:155], v[212:215], v[196:199], v[152:155]
 ds_read_b128 v[40:43], v14 offset:1088
 v_mfma_f32_16x16x32_bf16 v[156:159], v[212:215], v[200:203], v[156:159]
 ds_read2_b32 v[72:73], v18 offset0:96 offset1:97
 v_mfma_f32_16x16x32_bf16 v[144:147], v[216:219], v[184:187], v[144:147]
 ds_read2_b32 v[74:75], v18 offset0:98 offset1:99
 v_mfma_f32_16x16x32_bf16 v[148:151], v[216:219], v[188:191], v[148:151]
 ds_read_b128 v[44:47], v14 offset:1600
 v_mfma_f32_16x16x32_bf16 v[152:155], v[216:219], v[192:195], v[152:155]
 ds_read2_b32 v[76:77], v19 offset0:96 offset1:97
 v_mfma_f32_16x16x32_bf16 v[156:159], v[216:219], v[196:199], v[156:159]
 ds_read2_b32 v[78:79], v19 offset0:98 offset1:99
 v_mfma_f32_16x16x32_bf16 v[144:147], v[220:223], v[180:183], v[144:147]
 ds_read_b128 v[48:51], v14 offset:2112
 v_mfma_f32_16x16x32_bf16 v[148:151], v[220:223], v[184:187], v[148:151]
 ds_read2_b32 v[80:81], v20 offset0:96 offset1:97
 v_mfma_f32_16x16x32_bf16 v[152:155], v[220:223], v[188:191], v[152:155]
 ds_read2_b32 v[82:83], v20 offset0:98 offset1:99
 v_mfma_f32_16x16x32_bf16 v[156:159], v[220:223], v[192:195], v[156:159]
 ds_read_b128 v[52:55], v14 offset:2624
 v_mfma_f32_16x16x32_bf16 v[144:147], v[224:227], v[176:179], v[144:147]
 ds_read2_b32 v[84:85], v21 offset0:96 offset1:97
 v_mfma_f32_16x16x32_bf16 v[148:151], v[224:227], v[180:183], v[148:151]
 ds_read2_b32 v[86:87], v21 offset0:98 offset1:99
 v_mfma_f32_16x16x32_bf16 v[152:155], v[224:227], v[184:187], v[152:155]
 ds_read_b128 v[56:59], v14 offset:3136
 v_mfma_f32_16x16x32_bf16 v[156:159], v[224:227], v[188:191], v[156:159]
 ds_read2_b32 v[88:89], v22 offset0:96 offset1:97
 v_mfma_f32_16x16x32_bf16 v[148:151], v[228:231], v[176:179], v[148:151]
 ds_read2_b32 v[90:91], v22 offset0:98 offset1:99
 v_mfma_f32_16x16x32_bf16 v[152:155], v[228:231], v[180:183], v[152:155]
 ds_read_b128 v[60:63], v14 offset:3648
 v_mfma_f32_16x16x32_bf16 v[156:159], v[228:231], v[184:187], v[156:159]
 ds_read2_b32 v[92:93], v23 offset0:96 offset1:97
 v_mfma_f32_16x16x32_bf16 v[152:155], v[232:235], v[176:179], v[152:155]
 ds_read2_b32 v[94:95], v23 offset0:98 offset1:99
 v_mfma_f32_16x16x32_bf16 v[156:159], v[232:235], v[180:183], v[156:159]
 v_mfma_f32_16x16x32_bf16 v[156:159], v[236:239], v[176:179], v[156:159]
 s_waitcnt lgkmcnt(0)
 v_mfma_f32_16x16x32_bf16 v[144:147], v[64:67], v[48:51], v[144:147]
 ds_read_b128 v[176:179], v14 offset:0
 v_mfma_f32_16x16x32_bf16 v[148:151], v[64:67], v[52:55], v[148:151]
 ds_read2_b32 v[208:209], v16 offset0:112 offset1:113
 v_mfma_f32_16x16x32_bf16 v[152:155], v[64:67], v[56:59], v[152:155]
 ds_read2_b32 v[210:211], v16 offset0:114 offset1:115
 v_mfma_f32_16x16x32_bf16 v[156:159], v[64:67], v[60:63], v[156:159]
 ds_read_b128 v[180:183], v14 offset:512
 v_mfma_f32_16x16x32_bf16 v[144:147], v[68:71], v[44:47], v[144:147]
 ds_read2_b32 v[212:213], v17 offset0:112 offset1:113
 v_mfma_f32_16x16x32_bf16 v[148:151], v[68:71], v[48:51], v[148:151]
 ds_read2_b32 v[214:215], v17 offset0:114 offset1:115
 v_mfma_f32_16x16x32_bf16 v[152:155], v[68:71], v[52:55], v[152:155]
 ds_read_b128 v[184:187], v14 offset:1024
 v_mfma_f32_16x16x32_bf16 v[156:159], v[68:71], v[56:59], v[156:159]
 ds_read2_b32 v[216:217], v18 offset0:112 offset1:113
 v_mfma_f32_16x16x32_bf16 v[144:147], v[72:75], v[40:43], v[144:147]
 ds_read2_b32 v[218:219], v18 offset0:114 offset1:115
 v_mfma_f32_16x16x32_bf16 v[148:151], v[72:75], v[44:47], v[148:151]
 ds_read_b128 v[188:191], v14 offset:1536
 v_mfma_f32_16x16x32_bf16 v[152:155], v[72:75], v[48:51], v[152:155]
 ds_read2_b32 v[220:221], v19 offset0:112 offset1:113
 v_mfma_f32_16x16x32_bf16 v[156:159], v[72:75], v[52:55], v[156:159]
 ds_read2_b32 v[222:223], v19 offset0:114 offset1:115
 v_mfma_f32_16x16x32_bf16 v[144:147], v[76:79], v[36:39], v[144:147]
 ds_read_b128 v[192:195], v14 offset:2048
 v_mfma_f32_16x16x32_bf16 v[148:151], v[76:79], v[40:43], v[148:151]
 ds_read2_b32 v[224:225], v20 offset0:112 offset1:113
 v_mfma_f32_16x16x32_bf16 v[152:155], v[76:79], v[44:47], v[152:155]
 ds_read2_b32 v[226:227], v20 offset0:114 offset1:115
 v_mfma_f32_16x16x32_bf16 v[156:159], v[76:79], v[48:51], v[156:159]
 ds_read_b128 v[196:199], v14 offset:2560
 v_mfma_f32_16x16x32_bf16 v[144:147], v[80:83], v[32:35], v[144:147]
 ds_read2_b32 v[228:229], v21 offset0:112 offset1:113
 v_mfma_f32_16x16x32_bf16 v[148:151], v[80:83], v[36:39], v[148:151]
 ds_read2_b32 v[230:231], v21 offset0:114 offset1:115
 v_mfma_f32_16x16x32_bf16 v[152:155], v[80:83], v[40:43], v[152:155]
 ds_read_b128 v[200:203], v14 offset:3072
 v_mfma_f32_16x16x32_bf16 v[156:159], v[80:83], v[44:47], v[156:159]
 ds_read2_b32 v[232:233], v22 offset0:112 offset1:113
 v_mfma_f32_16x16x32_bf16 v[148:151], v[84:87], v[32:35], v[148:151]
 ds_read2_b32 v[234:235], v22 offset0:114 offset1:115
 v_mfma_f32_16x16x32_bf16 v[152:155], v[84:87], v[36:39], v[152:155]
 ds_read_b128 v[204:207], v14 offset:3584
 v_mfma_f32_16x16x32_bf16 v[156:159], v[84:87], v[40:43], v[156:159]
 ds_read2_b32 v[236:237], v23 offset0:112 offset1:113
 v_mfma_f32_16x16x32_bf16 v[152:155], v[88:91], v[32:35], v[152:155]
 ds_read2_b32 v[238:239], v23 offset0:114 offset1:115
 v_mfma_f32_16x16x32_bf16 v[156:159], v[88:91], v[36:39], v[156:159]
 v_mfma_f32_16x16x32_bf16 v[156:159], v[92:95], v[32:35], v[156:159]
 s_waitcnt lgkmcnt(0)
 v_mfma_f32_16x16x32_bf16 v[144:147], v[208:211], v[192:195], v[144:147]
 ds_read_b64 v[32:33], v15 offset:2048
 v_mfma_f32_16x16x32_bf16 v[148:151], v[208:211], v[196:199], v[148:151]
 ds_read_b64 v[34:35], v15 offset:2560
 v_mfma_f32_16x16x32_bf16 v[152:155], v[208:211], v[200:203], v[152:155]
 ds_read_b64 v[36:37], v15 offset:3072
 v_mfma_f32_16x16x32_bf16 v[156:159], v[208:211], v[204:207], v[156:159]
 ds_read_b64 v[38:39], v15 offset:3584
 v_mfma_f32_16x16x32_bf16 v[144:147], v[212:215], v[188:191], v[144:147]
 v_mfma_f32_16x16x32_bf16 v[148:151], v[212:215], v[192:195], v[148:151]
 v_mfma_f32_16x16x32_bf16 v[152:155], v[212:215], v[196:199], v[152:155]
 v_mfma_f32_16x16x32_bf16 v[156:159], v[212:215], v[200:203], v[156:159]
 v_mfma_f32_16x16x32_bf16 v[144:147], v[216:219], v[184:187], v[144:147]
 v_mfma_f32_16x16x32_bf16 v[148:151], v[216:219], v[188:191], v[148:151]
 v_mfma_f32_16x16x32_bf16 v[152:155], v[216:219], v[192:195], v[152:155]
 v_mfma_f32_16x16x32_bf16 v[156:159], v[216:219], v[196:199], v[156:159]
 v_mfma_f32_16x16x32_bf16 v[144:147], v[220:223], v[180:183], v[144:147]
 v_mfma_f32_16x16x32_bf16 v[148:151], v[220:223], v[184:187], v[148:151]
 v_mfma_f32_16x16x32_bf16 v[152:155], v[220:223], v[188:191], v[152:155]
 v_mfma_f32_16x16x32_bf16 v[156:159], v[220:223], v[192:195], v[156:159]
 v_mfma_f32_16x16x32_bf16 v[144:147], v[224:227], v[176:179], v[144:147]
 v_mfma_f32_16x16x32_bf16 v[148:151], v[224:227], v[180:183], v[148:151]
 v_mfma_f32_16x16x32_bf16 v[152:155], v[224:227], v[184:187], v[152:155]
 v_mfma_f32_16x16x32_bf16 v[156:159], v[224:227], v[188:191], v[156:159]
 v_mfma_f32_16x16x32_bf16 v[148:151], v[228:231], v[176:179], v[148:151]
 v_mfma_f32_16x16x32_bf16 v[152:155], v[228:231], v[180:183], v[152:155]
 v_mfma_f32_16x16x32_bf16 v[156:159], v[228:231], v[184:187], v[156:159]
 v_mfma_f32_16x16x32_bf16 v[152:155], v[232:235], v[176:179], v[152:155]
 v_mfma_f32_16x16x32_bf16 v[156:159], v[232:235], v[180:183], v[156:159]
 v_mfma_f32_16x16x32_bf16 v[156:159], v[236:239], v[176:179], v[156:159]
 s_waitcnt lgkmcnt(0)
 v_and_b32 v64, 0xffff0000, v33
 v_lshlrev_b32 v65, 16, v33
 v_and_b32 v66, 0xffff0000, v32
 v_lshlrev_b32 v67, 16, v32
 v_mul_f32 v64, v64, v12
 v_mul_f32 v65, v65, v12
 v_mul_f32 v66, v66, v12
 v_mul_f32 v67, v67, v12
 v_and_b32 v68, 0xffff0000, v35
 v_lshlrev_b32 v69, 16, v35
 v_and_b32 v70, 0xffff0000, v34
 v_lshlrev_b32 v71, 16, v34
 v_mul_f32 v68, v68, v12
 v_mul_f32 v69, v69, v12
 v_mul_f32 v70, v70, v12
 v_mul_f32 v71, v71, v12
 v_and_b32 v72, 0xffff0000, v37
 v_lshlrev_b32 v73, 16, v37
 v_and_b32 v74, 0xffff0000, v36
 v_lshlrev_b32 v75, 16, v36
 v_mul_f32 v72, v72, v12
 v_mul_f32 v73, v73, v12
 v_mul_f32 v74, v74, v12
 v_mul_f32 v75, v75, v12
 v_and_b32 v76, 0xffff0000, v39
 v_lshlrev_b32 v77, 16, v39
 v_and_b32 v78, 0xffff0000, v38
 v_lshlrev_b32 v79, 16, v38
 v_mul_f32 v76, v76, v12
 v_mul_f32 v77, v77, v12
 v_mul_f32 v78, v78, v12
 v_mul_f32 v79, v79, v12
 v_cvt_pk_bf16_f32 v8, v64, v65
 v_lshlrev_b32 v64, 16, v8
 v_and_b32 v65, 0xffff0000, v8
 v_cvt_pk_bf16_f32 v8, v66, v67
 v_lshlrev_b32 v66, 16, v8
 v_and_b32 v67, 0xffff0000, v8
 v_cvt_pk_bf16_f32 v8, v68, v69
 v_lshlrev_b32 v68, 16, v8
 v_and_b32 v69, 0xffff0000, v8
 v_cvt_pk_bf16_f32 v8, v70, v71
 v_lshlrev_b32 v70, 16, v8
 v_and_b32 v71, 0xffff0000, v8
 v_cvt_pk_bf16_f32 v8, v72, v73
 v_lshlrev_b32 v72, 16, v8
 v_and_b32 v73, 0xffff0000, v8
 v_cvt_pk_bf16_f32 v8, v74, v75
 v_lshlrev_b32 v74, 16, v8
 v_and_b32 v75, 0xffff0000, v8
 v_cvt_pk_bf16_f32 v8, v76, v77
 v_lshlrev_b32 v76, 16, v8
 v_and_b32 v77, 0xffff0000, v8
 v_cvt_pk_bf16_f32 v8, v78, v79
 v_lshlrev_b32 v78, 16, v8
 v_and_b32 v79, 0xffff0000, v8
 v_cvt_pk_bf16_f32 v8, v144, v145
 v_lshlrev_b32 v144, 16, v8
 v_and_b32 v145, 0xffff0000, v8
 v_cvt_pk_bf16_f32 v8, v146, v147
 v_lshlrev_b32 v146, 16, v8
 v_and_b32 v147, 0xffff0000, v8
 v_cvt_pk_bf16_f32 v8, v148, v149
 v_lshlrev_b32 v148, 16, v8
 v_and_b32 v149, 0xffff0000, v8
 v_cvt_pk_bf16_f32 v8, v150, v151
 v_lshlrev_b32 v150, 16, v8
 v_and_b32 v151, 0xffff0000, v8
 v_cvt_pk_bf16_f32 v8, v152, v153
 v_lshlrev_b32 v152, 16, v8
 v_and_b32 v153, 0xffff0000, v8
 v_cvt_pk_bf16_f32 v8, v154, v155
 v_lshlrev_b32 v154, 16, v8
 v_and_b32 v155, 0xffff0000, v8
 v_cvt_pk_bf16_f32 v8, v156, v157
 v_lshlrev_b32 v156, 16, v8
 v_and_b32 v157, 0xffff0000, v8
 v_cvt_pk_bf16_f32 v8, v158, v159
 v_lshlrev_b32 v158, 16, v8
 v_and_b32 v159, 0xffff0000, v8
 v_pk_add_f32 v[144:145], v[144:145], v[64:65]
 v_pk_add_f32 v[146:147], v[146:147], v[66:67]
 v_pk_add_f32 v[148:149], v[148:149], v[68:69]
 v_pk_add_f32 v[150:151], v[150:151], v[70:71]
 v_pk_add_f32 v[152:153], v[152:153], v[72:73]
 v_pk_add_f32 v[154:155], v[154:155], v[74:75]
 v_pk_add_f32 v[156:157], v[156:157], v[76:77]
 v_pk_add_f32 v[158:159], v[158:159], v[78:79]
 v_cvt_pk_bf16_f32 v160, v144, v148
 v_cvt_pk_bf16_f32 v161, v152, v156
 buffer_store_dwordx2 v[160:161], v13, s[4:7], s72 offen sc1
 s_add_u32 s72, s72, 40960
 v_cvt_pk_bf16_f32 v162, v145, v149
 v_cvt_pk_bf16_f32 v163, v153, v157
 buffer_store_dwordx2 v[162:163], v13, s[4:7], s72 offen sc1
 s_add_u32 s72, s72, 40960
 v_cvt_pk_bf16_f32 v164, v146, v150
 v_cvt_pk_bf16_f32 v165, v154, v158
 buffer_store_dwordx2 v[164:165], v13, s[4:7], s72 offen sc1
 s_add_u32 s72, s72, 40960
 v_cvt_pk_bf16_f32 v166, v147, v151
 v_cvt_pk_bf16_f32 v167, v155, v159
 buffer_store_dwordx2 v[166:167], v13, s[4:7], s72 offen sc1
 s_add_u32 s72, s72, 40960
 s_cmp_lt_u32 s70, 640
 s_cbranch_scc1 L_cv_5
 s_setpc_b64 s[76:77]
L_helper:
 s_and_b32 s3, s82, 0x78
 s_cmp_lg_u32 s3, 80
 s_cbranch_scc1 L_np_7
 s_cmp_lg_u32 s50, 0
 s_cbranch_scc1 L_np_6
 s_mov_b32 s64, 0xffff
 s_mov_b32 s65, 0xffff
 s_mov_b32 s62, 0
 s_getreg_b32 s70, hwreg(HW_REG_XCC_ID, 2, 1)
 s_lshl_b32 s70, s70, 13
 v_lshlrev_b32 v1, 8, v0
 v_mov_b32 v2, 0
 s_mov_b32 s96, s44
 s_and_b32 s97, s45, 0xffff
 s_mov_b32 s98, 256
 s_mov_b32 s99, 0x00020000
L_probe0:
 s_sub_u32 s61, s82, 80
 s_lshl_b32 s61, s61, 14
 s_add_u32 s61, s61, 12582912
 s_add_u32 s63, s61, 8192
 s_mov_b64 exec, -1
 buffer_store_dword v2, v1, s[4:7], s61 offen sc1
 s_waitcnt vmcnt(0)
 s_mov_b64 exec, 1
L_probe:
 s_add_u32 s60, s61, 0
 s_xor_b32 s60, s60, s70
 s_memtime s[66:67]
 s_waitcnt lgkmcnt(0)
 buffer_load_dword v3, off, s[4:7], s60 sc1
 s_waitcnt vmcnt(0)
 s_memtime s[68:69]
 s_waitcnt lgkmcnt(0)
 s_sub_u32 s68, s68, s66
 s_min_u32 s64, s64, s68
 s_add_u32 s60, s61, 8192
 s_xor_b32 s60, s60, s70
 s_memtime s[66:67]
 s_waitcnt lgkmcnt(0)
 buffer_load_dword v3, off, s[4:7], s60 sc1
 s_waitcnt vmcnt(0)
 s_memtime s[68:69]
 s_waitcnt lgkmcnt(0)
 s_sub_u32 s68, s68, s66
 s_min_u32 s65, s65, s68
 s_add_u32 s61, s61, 2048
 s_cmp_lt_u32 s61, s63
 s_cbranch_scc1 L_probe
 s_cmp_lg_u32 s62, 0
 s_cbranch_scc1 L_probe_dec
 s_sub_u32 s66, 0x10000, s64
 s_sub_u32 s67, 0x10000, s65
 v_mov_b32 v4, s66
 v_mov_b32 v5, s67
 v_mov_b32 v3, 1
 buffer_atomic_umax v4, off, s[96:99], 0 offset:24
 buffer_atomic_umax v5, off, s[96:99], 0 offset:28
 s_waitcnt vmcnt(0)
 buffer_atomic_add v3, off, s[96:99], 0 offset:16 sc0
 s_waitcnt vmcnt(0)
 v_cmp_eq_u32 vcc, 7, v3
 s_cbranch_vccz L_probe_done
 buffer_atomic_umax v4, off, s[96:99], 0 offset:24 sc0
 buffer_atomic_umax v5, off, s[96:99], 0 offset:28 sc0
 s_waitcnt vmcnt(0)
 v_readfirstlane_b32 s66, v4
 v_readfirstlane_b32 s67, v5
 s_nop 3
 s_sub_u32 s64, 0x10000, s66
 s_sub_u32 s65, 0x10000, s67
L_probe_dec:
 s_add_u32 s62, s62, 1
 s_absdiff_i32 s60, s64, s65
 s_cmp_ge_u32 s62, 5
 s_cselect_b32 s60, 0xffff, s60
 s_cmp_lt_u32 s60, 112
 s_cbranch_scc1 L_probe0
 s_cmp_gt_u32 s64, s65
 s_cselect_b32 s60, 2, 1
 v_mov_b32 v3, s60
 buffer_store_dword v3, off, s[96:99], 0 offset:144 sc1
 v_mov_b32 v4, s62
 buffer_store_dword v4, off, s[96:99], 0 offset:60 sc1
L_probe_done:
 s_mov_b64 exec, -1
L_np_6:
 s_barrier
 s_lshl_b32 s72, s82, 2
 s_add_u32 s72, s72, s50
 s_add_u32 s72, s72, 32
 s_mov_b32 s8, s16
 s_and_b32 s9, s17, 0xffff
 s_mov_b32 s10, 2621440
 s_mov_b32 s11, 0x00020000
 v_lshlrev_b32 v1, 4, v0
 v_lshlrev_b32 v2, 3, v0
 v_cmp_lt_u32 vcc, 31, v0
 v_mov_b32 v3, 268435456
 s_nop 1
 v_cndmask_b32 v7, v2, v3, vcc
 s_mov_b32 s63, 0x3acccccd
 s_mov_b32 s68, 0x3727c5ac
 s_add_u32 s3, s72, 0
 s_mul_i32 s3, s3, 1280
 buffer_load_dwordx2 v[48:49], v2, s[8:11], s3 offen offset:0
 buffer_load_dwordx2 v[50:51], v2, s[8:11], s3 offen offset:512
 buffer_load_dwordx2 v[52:53], v7, s[8:11], s3 offen offset:1024
 s_waitcnt vmcnt(0)
L_ln_8:
 v_lshlrev_b32 v12, 16, v48
 v_and_b32 v13, 0xffff0000, v48
 v_lshlrev_b32 v14, 16, v49
 v_and_b32 v15, 0xffff0000, v49
 v_lshlrev_b32 v16, 16, v50
 v_and_b32 v17, 0xffff0000, v50
 v_lshlrev_b32 v18, 16, v51
 v_and_b32 v19, 0xffff0000, v51
 v_lshlrev_b32 v20, 16, v52
 v_and_b32 v21, 0xffff0000, v52
 v_lshlrev_b32 v22, 16, v53
 v_and_b32 v23, 0xffff0000, v53
 s_add_u32 s3, s72, 32
 s_mul_i32 s3, s3, 1280
 buffer_load_dwordx2 v[48:49], v2, s[8:11], s3 offen offset:0
 buffer_load_dwordx2 v[50:51], v2, s[8:11], s3 offen offset:512
 buffer_load_dwordx2 v[52:53], v7, s[8:11], s3 offen offset:1024
 s_and_b32 s3, s72, 15
 v_lshrrev_b32 v4, 3, v0
 v_lshlrev_b32 v4, 2, v4
 v_and_b32 v9, 3, v0
 v_add_u32 v4, v4, v9
 v_xor_b32 v4, s3, v4
 v_lshlrev_b32 v4, 4, v4
 v_and_b32 v9, 4, v0
 v_lshl_add_u32 v4, v9, 1, v4
 v_cndmask_b32 v8, v4, v3, vcc
 v_readfirstlane_b32 s3, v12
 s_nop 1
 v_subrev_f32 v36, s3, v12
 v_subrev_f32 v37, s3, v13
 v_subrev_f32 v38, s3, v14
 v_subrev_f32 v39, s3, v15
 v_subrev_f32 v40, s3, v16
 v_subrev_f32 v41, s3, v17
 v_subrev_f32 v42, s3, v18
 v_subrev_f32 v43, s3, v19
 v_mov_b32 v44, 0
 v_mov_b32 v45, 0
 v_mov_b32 v46, 0
 v_mov_b32 v47, 0
 s_mov_b32 exec_hi, 0
 v_subrev_f32 v44, s3, v20
 v_subrev_f32 v45, s3, v21
 v_subrev_f32 v46, s3, v22
 v_subrev_f32 v47, s3, v23
 s_mov_b32 exec_hi, -1
 v_pk_mul_f32 v[10:11], v[36:37], v[36:37]
 v_pk_fma_f32 v[10:11], v[38:39], v[38:39], v[10:11]
 v_pk_fma_f32 v[10:11], v[40:41], v[40:41], v[10:11]
 v_pk_fma_f32 v[10:11], v[42:43], v[42:43], v[10:11]
 v_pk_fma_f32 v[10:11], v[44:45], v[44:45], v[10:11]
 v_pk_fma_f32 v[10:11], v[46:47], v[46:47], v[10:11]
 v_pk_add_f32 v[36:37], v[36:37], v[38:39]
 v_pk_add_f32 v[36:37], v[36:37], v[40:41]
 v_pk_add_f32 v[36:37], v[36:37], v[42:43]
 v_pk_add_f32 v[36:37], v[36:37], v[44:45]
 v_pk_add_f32 v[36:37], v[36:37], v[46:47]
 v_add_f32 v11, v10, v11
 v_add_f32 v10, v36, v37
 s_nop 0
 v_add_f32_dpp v11, v11, v11 quad_perm:[1,0,3,2] row_mask:0xf bank_mask:0xf
 v_add_f32_dpp v10, v10, v10 quad_perm:[1,0,3,2] row_mask:0xf bank_mask:0xf
 s_nop 0
 v_add_f32_dpp v11, v11, v11 quad_perm:[2,3,0,1] row_mask:0xf bank_mask:0xf
 v_add_f32_dpp v10, v10, v10 quad_perm:[2,3,0,1] row_mask:0xf bank_mask:0xf
 s_nop 0
 v_add_f32_dpp v11, v11, v11 row_half_mirror row_mask:0xf bank_mask:0xf
 v_add_f32_dpp v10, v10, v10 row_half_mirror row_mask:0xf bank_mask:0xf
 s_nop 0
 v_add_f32_dpp v11, v11, v11 row_mirror row_mask:0xf bank_mask:0xf
 v_add_f32_dpp v10, v10, v10 row_mirror row_mask:0xf bank_mask:0xf
 v_mov_b32 v37, v11
 v_mov_b32 v36, v10
 s_nop 0
 v_permlane16_swap_b32 v11, v37
 v_permlane16_swap_b32 v10, v36
 v_pk_add_f32 v[10:11], v[10:11], v[36:37]
 v_mov_b32 v37, v11
 v_mov_b32 v36, v10
 s_nop 0
 v_permlane32_swap_b32 v11, v37
 v_permlane32_swap_b32 v10, v36
 v_pk_add_f32 v[10:11], v[10:11], v[36:37]
 v_mul_f32 v10, s63, v10
 v_mul_f32 v11, s63, v11
 v_fma_f32 v11, -v10, v10, v11
 v_max_f32 v11, 0, v11
 v_add_f32 v10, s3, v10
 v_cvt_pk_bf16_f32 v9, v10, v11
 v_lshlrev_b32 v10, 16, v9
 v_and_b32 v11, 0xffff0000, v9
 v_add_f32 v11, s68, v11
 v_cvt_pk_bf16_f32 v11, v11, v11
 v_and_b32 v11, 0xffff0000, v11
 v_sqrt_f32 v11, v11
 s_nop 0
 v_pk_add_f32 v[36:37], v[12:13], v[10:11] op_sel_hi:[1,0] neg_lo:[0,1] neg_hi:[0,1]
 v_pk_add_f32 v[38:39], v[14:15], v[10:11] op_sel_hi:[1,0] neg_lo:[0,1] neg_hi:[0,1]
 v_pk_add_f32 v[40:41], v[16:17], v[10:11] op_sel_hi:[1,0] neg_lo:[0,1] neg_hi:[0,1]
 v_pk_add_f32 v[42:43], v[18:19], v[10:11] op_sel_hi:[1,0] neg_lo:[0,1] neg_hi:[0,1]
 v_pk_add_f32 v[44:45], v[20:21], v[10:11] op_sel_hi:[1,0] neg_lo:[0,1] neg_hi:[0,1]
 v_pk_add_f32 v[46:47], v[22:23], v[10:11] op_sel_hi:[1,0] neg_lo:[0,1] neg_hi:[0,1]
 v_cvt_pk_bf16_f32 v11, v11, v11
 v_and_b32 v11, 0xffff0000, v11
 v_rcp_f32 v11, v11
 v_cvt_pk_bf16_f32 v9, v36, v37
 v_lshlrev_b32 v36, 16, v9
 v_and_b32 v37, 0xffff0000, v9
 v_cvt_pk_bf16_f32 v9, v38, v39
 v_lshlrev_b32 v38, 16, v9
 v_and_b32 v39, 0xffff0000, v9
 v_cvt_pk_bf16_f32 v9, v40, v41
 v_lshlrev_b32 v40, 16, v9
 v_and_b32 v41, 0xffff0000, v9
 v_cvt_pk_bf16_f32 v9, v42, v43
 v_lshlrev_b32 v42, 16, v9
 v_and_b32 v43, 0xffff0000, v9
 v_cvt_pk_bf16_f32 v9, v44, v45
 v_lshlrev_b32 v44, 16, v9
 v_and_b32 v45, 0xffff0000, v9
 v_cvt_pk_bf16_f32 v9, v46, v47
 v_lshlrev_b32 v46, 16, v9
 v_and_b32 v47, 0xffff0000, v9
 v_pk_mul_f32 v[36:37], v[36:37], v[10:11] op_sel:[0,1] op_sel_hi:[1,1]
 v_pk_mul_f32 v[38:39], v[38:39], v[10:11] op_sel:[0,1] op_sel_hi:[1,1]
 v_pk_mul_f32 v[40:41], v[40:41], v[10:11] op_sel:[0,1] op_sel_hi:[1,1]
 v_pk_mul_f32 v[42:43], v[42:43], v[10:11] op_sel:[0,1] op_sel_hi:[1,1]
 v_pk_mul_f32 v[44:45], v[44:45], v[10:11] op_sel:[0,1] op_sel_hi:[1,1]
 v_pk_mul_f32 v[46:47], v[46:47], v[10:11] op_sel:[0,1] op_sel_hi:[1,1]
 v_cvt_pk_bf16_f32 v24, v36, v37
 v_cvt_pk_bf16_f32 v25, v38, v39
 v_cvt_pk_bf16_f32 v26, v40, v41
 v_cvt_pk_bf16_f32 v27, v42, v43
 v_cvt_pk_bf16_f32 v28, v44, v45
 v_cvt_pk_bf16_f32 v29, v46, v47
 s_mul_i32 s3, s72, 1280
 s_add_u32 s3, s3, 192937984
 buffer_store_dwordx2 v[24:25], v4, s[4:7], s3 offen offset:0 sc1
 buffer_store_dwordx2 v[26:27], v4, s[4:7], s3 offen offset:512 sc1
 buffer_store_dwordx2 v[28:29], v8, s[4:7], s3 offen offset:1024 sc1
 s_add_u32 s72, s72, 32
 s_waitcnt vmcnt(3)
 s_cmp_lt_u32 s72, 544
 s_cbranch_scc1 L_ln_8
 s_waitcnt vmcnt(0)
 s_barrier
 s_cmp_lg_u32 s50, 3
 s_cbranch_scc1 L_ar_9
 s_mov_b32 s96, s44
 s_and_b32 s97, s45, 0xffff
 s_mov_b32 s98, 256
 s_mov_b32 s99, 0x00020000
 v_mov_b32 v1, 1
 s_mov_b64 exec, 1
 buffer_atomic_add v1, off, s[96:99], 0 offset:72 sc0
 s_waitcnt vmcnt(0)
 v_cmp_eq_u32 vcc, 7, v1
 s_cbranch_vccz L_aw_10
 buffer_store_dword v1, off, s[96:99], 0 offset:200 sc1
L_aw_10:
 s_mov_b64 exec, -1
L_ar_9:
 s_branch L_help_done
L_np_7:
 s_lshl_b32 s60, s82, 2
 s_add_u32 s60, s60, s50
 s_sub_u32 s3, s60, 32
 s_cmp_ge_u32 s60, 320
 s_cselect_b32 s60, s3, s60
 s_mov_b32 s72, s60
 s_mov_b32 s8, s16
 s_and_b32 s9, s17, 0xffff
 s_mov_b32 s10, 2621440
 s_mov_b32 s11, 0x00020000
 v_lshlrev_b32 v1, 4, v0
 v_lshlrev_b32 v2, 3, v0
 v_cmp_lt_u32 vcc, 31, v0
 v_mov_b32 v3, 268435456
 s_nop 1
 v_cndmask_b32 v7, v2, v3, vcc
 s_mov_b32 s63, 0x3acccccd
 s_mov_b32 s68, 0x3727c5ac
 s_add_u32 s3, s72, 0
 s_mul_i32 s3, s3, 1280
 buffer_load_dwordx2 v[48:49], v2, s[8:11], s3 offen offset:0
 buffer_load_dwordx2 v[50:51], v2, s[8:11], s3 offen offset:512
 buffer_load_dwordx2 v[52:53], v7, s[8:11], s3 offen offset:1024
 v_mov_b32 v12, 0
 v_mov_b32 v13, 0
 v_mov_b32 v14, 0
 v_mov_b32 v15, 0
 s_lshl_b32 s73, s60, 10
 s_add_u32 s73, s73, 0
L_cl_11:
 s_cmp_ge_u32 s73, 1736704
 s_cbranch_scc1 L_cle_12
 buffer_store_dwordx4 v[12:15], v1, s[4:7], s73 offen sc1
 s_add_u32 s73, s73, 360448
 s_branch L_cl_11
L_cle_12:
 s_nop 1
 v_mov_b32 v12, -1
 v_mov_b32 v13, -1
 v_mov_b32 v14, -1
 v_mov_b32 v15, -1
 s_lshl_b32 s73, s60, 10
 s_add_u32 s73, s73, 1736704
L_cl_13:
 s_cmp_ge_u32 s73, 3309568
 s_cbranch_scc1 L_cle_14
 buffer_store_dwordx4 v[12:15], v1, s[4:7], s73 offen sc1
 s_add_u32 s73, s73, 360448
 s_branch L_cl_13
L_cle_14:
 s_nop 1
 v_mov_b32 v12, -1
 v_mov_b32 v13, -1
 v_mov_b32 v14, -1
 v_mov_b32 v15, -1
 s_lshl_b32 s73, s60, 10
 s_add_u32 s73, s73, 4194304
L_cl_15:
 s_cmp_ge_u32 s73, 4325376
 s_cbranch_scc1 L_cle_16
 buffer_store_dwordx4 v[12:15], v1, s[4:7], s73 offen sc1
 s_add_u32 s73, s73, 360448
 s_branch L_cl_15
L_cle_16:
 s_nop 1
 v_mov_b32 v12, -1
 v_mov_b32 v13, -1
 v_mov_b32 v14, -1
 v_mov_b32 v15, -1
 s_lshl_b32 s73, s60, 10
 s_add_u32 s73, s73, 6291456
L_cl_17:
 s_cmp_ge_u32 s73, 6422528
 s_cbranch_scc1 L_cle_18
 buffer_store_dwordx4 v[12:15], v1, s[4:7], s73 offen sc1
 s_add_u32 s73, s73, 360448
 s_branch L_cl_17
L_cle_18:
 s_nop 1
 v_mov_b32 v12, -1
 v_mov_b32 v13, -1
 v_mov_b32 v14, -1
 v_mov_b32 v15, -1
 s_lshl_b32 s73, s60, 10
 s_add_u32 s73, s73, 8388608
L_cl_19:
 s_cmp_ge_u32 s73, 8519680
 s_cbranch_scc1 L_cle_20
 buffer_store_dwordx4 v[12:15], v1, s[4:7], s73 offen sc1
 s_add_u32 s73, s73, 360448
 s_branch L_cl_19
L_cle_20:
 s_nop 1
 v_mov_b32 v12, -1
 v_mov_b32 v13, -1
 v_mov_b32 v14, -1
 v_mov_b32 v15, -1
 s_lshl_b32 s73, s60, 10
 s_add_u32 s73, s73, 10485760
L_cl_21:
 s_cmp_ge_u32 s73, 10616832
 s_cbranch_scc1 L_cle_22
 buffer_store_dwordx4 v[12:15], v1, s[4:7], s73 offen sc1
 s_add_u32 s73, s73, 360448
 s_branch L_cl_21
L_cle_22:
 s_nop 1
 s_waitcnt vmcnt(8)
L_ln_23:
 v_lshlrev_b32 v12, 16, v48
 v_and_b32 v13, 0xffff0000, v48
 v_lshlrev_b32 v14, 16, v49
 v_and_b32 v15, 0xffff0000, v49
 v_lshlrev_b32 v16, 16, v50
 v_and_b32 v17, 0xffff0000, v50
 v_lshlrev_b32 v18, 16, v51
 v_and_b32 v19, 0xffff0000, v51
 v_lshlrev_b32 v20, 16, v52
 v_and_b32 v21, 0xffff0000, v52
 v_lshlrev_b32 v22, 16, v53
 v_and_b32 v23, 0xffff0000, v53
 s_and_b32 s3, s72, 15
 v_lshrrev_b32 v4, 3, v0
 v_lshlrev_b32 v4, 2, v4
 v_and_b32 v9, 3, v0
 v_add_u32 v4, v4, v9
 v_xor_b32 v4, s3, v4
 v_lshlrev_b32 v4, 4, v4
 v_and_b32 v9, 4, v0
 v_lshl_add_u32 v4, v9, 1, v4
 v_cndmask_b32 v8, v4, v3, vcc
 v_readfirstlane_b32 s3, v12
 s_nop 1
 v_subrev_f32 v36, s3, v12
 v_subrev_f32 v37, s3, v13
 v_subrev_f32 v38, s3, v14
 v_subrev_f32 v39, s3, v15
 v_subrev_f32 v40, s3, v16
 v_subrev_f32 v41, s3, v17
 v_subrev_f32 v42, s3, v18
 v_subrev_f32 v43, s3, v19
 v_mov_b32 v44, 0
 v_mov_b32 v45, 0
 v_mov_b32 v46, 0
 v_mov_b32 v47, 0
 s_mov_b32 exec_hi, 0
 v_subrev_f32 v44, s3, v20
 v_subrev_f32 v45, s3, v21
 v_subrev_f32 v46, s3, v22
 v_subrev_f32 v47, s3, v23
 s_mov_b32 exec_hi, -1
 v_pk_mul_f32 v[10:11], v[36:37], v[36:37]
 v_pk_fma_f32 v[10:11], v[38:39], v[38:39], v[10:11]
 v_pk_fma_f32 v[10:11], v[40:41], v[40:41], v[10:11]
 v_pk_fma_f32 v[10:11], v[42:43], v[42:43], v[10:11]
 v_pk_fma_f32 v[10:11], v[44:45], v[44:45], v[10:11]
 v_pk_fma_f32 v[10:11], v[46:47], v[46:47], v[10:11]
 v_pk_add_f32 v[36:37], v[36:37], v[38:39]
 v_pk_add_f32 v[36:37], v[36:37], v[40:41]
 v_pk_add_f32 v[36:37], v[36:37], v[42:43]
 v_pk_add_f32 v[36:37], v[36:37], v[44:45]
 v_pk_add_f32 v[36:37], v[36:37], v[46:47]
 v_add_f32 v11, v10, v11
 v_add_f32 v10, v36, v37
 s_nop 0
 v_add_f32_dpp v11, v11, v11 quad_perm:[1,0,3,2] row_mask:0xf bank_mask:0xf
 v_add_f32_dpp v10, v10, v10 quad_perm:[1,0,3,2] row_mask:0xf bank_mask:0xf
 s_nop 0
 v_add_f32_dpp v11, v11, v11 quad_perm:[2,3,0,1] row_mask:0xf bank_mask:0xf
 v_add_f32_dpp v10, v10, v10 quad_perm:[2,3,0,1] row_mask:0xf bank_mask:0xf
 s_nop 0
 v_add_f32_dpp v11, v11, v11 row_half_mirror row_mask:0xf bank_mask:0xf
 v_add_f32_dpp v10, v10, v10 row_half_mirror row_mask:0xf bank_mask:0xf
 s_nop 0
 v_add_f32_dpp v11, v11, v11 row_mirror row_mask:0xf bank_mask:0xf
 v_add_f32_dpp v10, v10, v10 row_mirror row_mask:0xf bank_mask:0xf
 v_mov_b32 v37, v11
 v_mov_b32 v36, v10
 s_nop 0
 v_permlane16_swap_b32 v11, v37
 v_permlane16_swap_b32 v10, v36
 v_pk_add_f32 v[10:11], v[10:11], v[36:37]
 v_mov_b32 v37, v11
 v_mov_b32 v36, v10
 s_nop 0
 v_permlane32_swap_b32 v11, v37
 v_permlane32_swap_b32 v10, v36
 v_pk_add_f32 v[10:11], v[10:11], v[36:37]
 v_mul_f32 v10, s63, v10
 v_mul_f32 v11, s63, v11
 v_fma_f32 v11, -v10, v10, v11
 v_max_f32 v11, 0, v11
 v_add_f32 v10, s3, v10
 v_cvt_pk_bf16_f32 v9, v10, v11
 v_lshlrev_b32 v10, 16, v9
 v_and_b32 v11, 0xffff0000, v9
 v_add_f32 v11, s68, v11
 v_cvt_pk_bf16_f32 v11, v11, v11
 v_and_b32 v11, 0xffff0000, v11
 v_sqrt_f32 v11, v11
 s_nop 0
 v_pk_add_f32 v[36:37], v[12:13], v[10:11] op_sel_hi:[1,0] neg_lo:[0,1] neg_hi:[0,1]
 v_pk_add_f32 v[38:39], v[14:15], v[10:11] op_sel_hi:[1,0] neg_lo:[0,1] neg_hi:[0,1]
 v_pk_add_f32 v[40:41], v[16:17], v[10:11] op_sel_hi:[1,0] neg_lo:[0,1] neg_hi:[0,1]
 v_pk_add_f32 v[42:43], v[18:19], v[10:11] op_sel_hi:[1,0] neg_lo:[0,1] neg_hi:[0,1]
 v_pk_add_f32 v[44:45], v[20:21], v[10:11] op_sel_hi:[1,0] neg_lo:[0,1] neg_hi:[0,1]
 v_pk_add_f32 v[46:47], v[22:23], v[10:11] op_sel_hi:[1,0] neg_lo:[0,1] neg_hi:[0,1]
 v_cvt_pk_bf16_f32 v11, v11, v11
 v_and_b32 v11, 0xffff0000, v11
 v_rcp_f32 v11, v11
 v_cvt_pk_bf16_f32 v9, v36, v37
 v_lshlrev_b32 v36, 16, v9
 v_and_b32 v37, 0xffff0000, v9
 v_cvt_pk_bf16_f32 v9, v38, v39
 v_lshlrev_b32 v38, 16, v9
 v_and_b32 v39, 0xffff0000, v9
 v_cvt_pk_bf16_f32 v9, v40, v41
 v_lshlrev_b32 v40, 16, v9
 v_and_b32 v41, 0xffff0000, v9
 v_cvt_pk_bf16_f32 v9, v42, v43
 v_lshlrev_b32 v42, 16, v9
 v_and_b32 v43, 0xffff0000, v9
 v_cvt_pk_bf16_f32 v9, v44, v45
 v_lshlrev_b32 v44, 16, v9
 v_and_b32 v45, 0xffff0000, v9
 v_cvt_pk_bf16_f32 v9, v46, v47
 v_lshlrev_b32 v46, 16, v9
 v_and_b32 v47, 0xffff0000, v9
 v_pk_mul_f32 v[36:37], v[36:37], v[10:11] op_sel:[0,1] op_sel_hi:[1,1]
 v_pk_mul_f32 v[38:39], v[38:39], v[10:11] op_sel:[0,1] op_sel_hi:[1,1]
 v_pk_mul_f32 v[40:41], v[40:41], v[10:11] op_sel:[0,1] op_sel_hi:[1,1]
 v_pk_mul_f32 v[42:43], v[42:43], v[10:11] op_sel:[0,1] op_sel_hi:[1,1]
 v_pk_mul_f32 v[44:45], v[44:45], v[10:11] op_sel:[0,1] op_sel_hi:[1,1]
 v_pk_mul_f32 v[46:47], v[46:47], v[10:11] op_sel:[0,1] op_sel_hi:[1,1]
 v_cvt_pk_bf16_f32 v24, v36, v37
 v_cvt_pk_bf16_f32 v25, v38, v39
 v_cvt_pk_bf16_f32 v26, v40, v41
 v_cvt_pk_bf16_f32 v27, v42, v43
 v_cvt_pk_bf16_f32 v28, v44, v45
 v_cvt_pk_bf16_f32 v29, v46, v47
 s_mul_i32 s3, s72, 1280
 s_add_u32 s3, s3, 192937984
 buffer_store_dwordx2 v[24:25], v4, s[4:7], s3 offen offset:0 sc1
 buffer_store_dwordx2 v[26:27], v4, s[4:7], s3 offen offset:512 sc1
 buffer_store_dwordx2 v[28:29], v8, s[4:7], s3 offen offset:1024 sc1
 s_waitcnt vmcnt(0)
 s_barrier
 s_cmp_lg_u32 s50, 3
 s_cbranch_scc1 L_ar_24
 s_mov_b32 s96, s44
 s_and_b32 s97, s45, 0xffff
 s_mov_b32 s98, 256
 s_mov_b32 s99, 0x00020000
 v_mov_b32 v1, 1
 s_mov_b64 exec, 1
 buffer_atomic_add v1, off, s[96:99], 0 offset:4 sc0
 s_waitcnt vmcnt(0)
 v_cmp_eq_u32 vcc, 87, v1
 s_cbranch_vccz L_aw_25
 buffer_store_dword v1, off, s[96:99], 0 offset:132 sc1
L_aw_25:
 s_mov_b64 exec, -1
L_ar_24:
 s_cmp_eq_u32 s83, 3
 s_cbranch_scc1 L_help_done
 s_sub_u32 s60, s60, 128
 s_cmp_eq_u32 s83, 1
 s_cbranch_scc1 L_k2_26
 s_add_u32 s3, s60, 288
 s_add_u32 s60, s60, 128
 s_cmp_lt_u32 s82, 32
 s_cselect_b32 s60, s3, s60
L_k2_26:
 s_mov_b32 s8, s32
 s_and_b32 s9, s33, 0xffff
 s_mov_b32 s10, 2621440
 s_mov_b32 s11, 0x00020000
 s_mov_b32 s12, s34
 s_and_b32 s13, s35, 0xffff
 s_mov_b32 s14, 2621440
 s_mov_b32 s15, 0x00020000
 s_mul_i32 s73, s60, 6554
 s_lshr_b32 s73, s73, 16
 s_mul_i32 s3, s73, 10
 s_sub_u32 s74, s60, s3
 s_mul_i32 s69, s73, 81920
 s_lshl_b32 s3, s74, 7
 s_add_u32 s69, s69, s3
 v_lshrrev_b32 v90, 3, v0
 s_mov_b32 s3, 10240
 v_mul_lo_u32 v91, v90, s3
 v_and_b32 v92, 7, v0
 v_lshl_add_u32 v91, v92, 4, v91
 v_add_u32 v91, s69, v91
 v_subrev_u32 v93, 3840, v91
 v_cmp_gt_i32 vcc, 0, v93
 s_nop 1
 v_cndmask_b32 v93, v93, v3, vcc
 buffer_load_dwordx4 v[100:103], v93, s[8:11], 0 offen offset:0
 buffer_load_dwordx4 v[104:107], v93, s[8:11], 0 offen offset:1280
 buffer_load_dwordx4 v[108:111], v93, s[8:11], 0 offen offset:2560
 s_mov_b32 s3, 0
 buffer_load_dwordx4 v[112:115], v91, s[8:11], s3 offen
 buffer_load_dwordx4 v[144:147], v91, s[12:15], s3 offen
 s_mov_b32 s3, 1280
 buffer_load_dwordx4 v[116:119], v91, s[8:11], s3 offen
 buffer_load_dwordx4 v[148:151], v91, s[12:15], s3 offen
 s_mov_b32 s3, 2560
 buffer_load_dwordx4 v[120:123], v91, s[8:11], s3 offen
 buffer_load_dwordx4 v[152:155], v91, s[12:15], s3 offen
 s_mov_b32 s3, 3840
 buffer_load_dwordx4 v[124:127], v91, s[8:11], s3 offen
 buffer_load_dwordx4 v[156:159], v91, s[12:15], s3 offen
 s_mov_b32 s3, 5120
 buffer_load_dwordx4 v[128:131], v91, s[8:11], s3 offen
 buffer_load_dwordx4 v[160:163], v91, s[12:15], s3 offen
 s_mov_b32 s3, 6400
 buffer_load_dwordx4 v[132:135], v91, s[8:11], s3 offen
 buffer_load_dwordx4 v[164:167], v91, s[12:15], s3 offen
 s_mov_b32 s3, 7680
 buffer_load_dwordx4 v[136:139], v91, s[8:11], s3 offen
 buffer_load_dwordx4 v[168:171], v91, s[12:15], s3 offen
 s_mov_b32 s3, 8960
 buffer_load_dwordx4 v[140:143], v91, s[8:11], s3 offen
 buffer_load_dwordx4 v[172:175], v91, s[12:15], s3 offen
 s_mov_b32 s8, s36
 s_and_b32 s9, s37, 0xffff
 s_mov_b32 s10, 5120
 s_mov_b32 s11, 0x00020000
 v_lshlrev_b32 v93, 6, v92
 s_lshl_b32 s3, s74, 9
 buffer_load_dwordx4 v[176:179], v93, s[8:11], s3 offen offset:0
 buffer_load_dwordx4 v[180:183], v93, s[8:11], s3 offen offset:16
 buffer_load_dwordx4 v[184:187], v93, s[8:11], s3 offen offset:32
 buffer_load_dwordx4 v[188:191], v93, s[8:11], s3 offen offset:48
 v_lshlrev_b32 v94, 15, v92
 v_lshl_add_u32 v94, v90, 4, v94
 s_lshl_b32 s70, s74, 18
 s_lshl_b32 s3, s73, 7
 s_add_u32 s70, s70, s3
 s_add_u32 s70, s70, 198180864
 s_waitcnt vmcnt(0)
 v_lshlrev_b32 v12, 16, v100
 v_and_b32 v13, 0xffff0000, v100
 v_lshlrev_b32 v14, 16, v104
 v_and_b32 v15, 0xffff0000, v104
 v_lshlrev_b32 v16, 16, v108
 v_and_b32 v17, 0xffff0000, v108
 v_lshlrev_b32 v18, 16, v112
 v_and_b32 v19, 0xffff0000, v112
 v_lshlrev_b32 v20, 16, v116
 v_and_b32 v21, 0xffff0000, v116
 v_lshlrev_b32 v22, 16, v120
 v_and_b32 v23, 0xffff0000, v120
 v_lshlrev_b32 v24, 16, v124
 v_and_b32 v25, 0xffff0000, v124
 v_lshlrev_b32 v26, 16, v128
 v_and_b32 v27, 0xffff0000, v128
 v_lshlrev_b32 v28, 16, v132
 v_and_b32 v29, 0xffff0000, v132
 v_lshlrev_b32 v30, 16, v136
 v_and_b32 v31, 0xffff0000, v136
 v_lshlrev_b32 v32, 16, v140
 v_and_b32 v33, 0xffff0000, v140
 v_lshlrev_b32 v68, 16, v176
 v_lshlrev_b32 v69, 16, v178
 v_and_b32 v70, 0xffff0000, v176
 v_and_b32 v71, 0xffff0000, v178
 v_lshlrev_b32 v72, 16, v177
 v_lshlrev_b32 v73, 16, v179
 v_and_b32 v74, 0xffff0000, v177
 v_and_b32 v75, 0xffff0000, v179
 v_pk_mul_f32 v[36:37], v[12:13], v[74:75]
 v_pk_mul_f32 v[38:39], v[14:15], v[74:75]
 v_pk_mul_f32 v[40:41], v[16:17], v[74:75]
 v_pk_mul_f32 v[42:43], v[18:19], v[74:75]
 v_pk_mul_f32 v[44:45], v[20:21], v[74:75]
 v_pk_mul_f32 v[46:47], v[22:23], v[74:75]
 v_pk_mul_f32 v[48:49], v[24:25], v[74:75]
 v_pk_mul_f32 v[50:51], v[26:27], v[74:75]
 v_cvt_pk_bf16_f32 v84, v36, v37
 v_lshlrev_b32 v36, 16, v84
 v_and_b32 v37, 0xffff0000, v84
 v_cvt_pk_bf16_f32 v84, v38, v39
 v_lshlrev_b32 v38, 16, v84
 v_and_b32 v39, 0xffff0000, v84
 v_cvt_pk_bf16_f32 v84, v40, v41
 v_lshlrev_b32 v40, 16, v84
 v_and_b32 v41, 0xffff0000, v84
 v_cvt_pk_bf16_f32 v84, v42, v43
 v_lshlrev_b32 v42, 16, v84
 v_and_b32 v43, 0xffff0000, v84
 v_cvt_pk_bf16_f32 v84, v44, v45
 v_lshlrev_b32 v44, 16, v84
 v_and_b32 v45, 0xffff0000, v84
 v_cvt_pk_bf16_f32 v84, v46, v47
 v_lshlrev_b32 v46, 16, v84
 v_and_b32 v47, 0xffff0000, v84
 v_cvt_pk_bf16_f32 v84, v48, v49
 v_lshlrev_b32 v48, 16, v84
 v_and_b32 v49, 0xffff0000, v84
 v_cvt_pk_bf16_f32 v84, v50, v51
 v_lshlrev_b32 v50, 16, v84
 v_and_b32 v51, 0xffff0000, v84
 v_pk_mul_f32 v[52:53], v[14:15], v[72:73]
 v_pk_mul_f32 v[54:55], v[16:17], v[72:73]
 v_pk_mul_f32 v[56:57], v[18:19], v[72:73]
 v_pk_mul_f32 v[58:59], v[20:21], v[72:73]
 v_pk_mul_f32 v[60:61], v[22:23], v[72:73]
 v_pk_mul_f32 v[62:63], v[24:25], v[72:73]
 v_pk_mul_f32 v[64:65], v[26:27], v[72:73]
 v_pk_mul_f32 v[66:67], v[28:29], v[72:73]
 v_cvt_pk_bf16_f32 v84, v52, v53
 v_lshlrev_b32 v52, 16, v84
 v_and_b32 v53, 0xffff0000, v84
 v_cvt_pk_bf16_f32 v84, v54, v55
 v_lshlrev_b32 v54, 16, v84
 v_and_b32 v55, 0xffff0000, v84
 v_cvt_pk_bf16_f32 v84, v56, v57
 v_lshlrev_b32 v56, 16, v84
 v_and_b32 v57, 0xffff0000, v84
 v_cvt_pk_bf16_f32 v84, v58, v59
 v_lshlrev_b32 v58, 16, v84
 v_and_b32 v59, 0xffff0000, v84
 v_cvt_pk_bf16_f32 v84, v60, v61
 v_lshlrev_b32 v60, 16, v84
 v_and_b32 v61, 0xffff0000, v84
 v_cvt_pk_bf16_f32 v84, v62, v63
 v_lshlrev_b32 v62, 16, v84
 v_and_b32 v63, 0xffff0000, v84
 v_cvt_pk_bf16_f32 v84, v64, v65
 v_lshlrev_b32 v64, 16, v84
 v_and_b32 v65, 0xffff0000, v84
 v_cvt_pk_bf16_f32 v84, v66, v67
 v_lshlrev_b32 v66, 16, v84
 v_and_b32 v67, 0xffff0000, v84
 v_pk_add_f32 v[36:37], v[36:37], v[52:53]
 v_pk_add_f32 v[38:39], v[38:39], v[54:55]
 v_pk_add_f32 v[40:41], v[40:41], v[56:57]
 v_pk_add_f32 v[42:43], v[42:43], v[58:59]
 v_pk_add_f32 v[44:45], v[44:45], v[60:61]
 v_pk_add_f32 v[46:47], v[46:47], v[62:63]
 v_pk_add_f32 v[48:49], v[48:49], v[64:65]
 v_pk_add_f32 v[50:51], v[50:51], v[66:67]
 v_cvt_pk_bf16_f32 v84, v36, v37
 v_lshlrev_b32 v36, 16, v84
 v_and_b32 v37, 0xffff0000, v84
 v_cvt_pk_bf16_f32 v84, v38, v39
 v_lshlrev_b32 v38, 16, v84
 v_and_b32 v39, 0xffff0000, v84
 v_cvt_pk_bf16_f32 v84, v40, v41
 v_lshlrev_b32 v40, 16, v84
 v_and_b32 v41, 0xffff0000, v84
 v_cvt_pk_bf16_f32 v84, v42, v43
 v_lshlrev_b32 v42, 16, v84
 v_and_b32 v43, 0xffff0000, v84
 v_cvt_pk_bf16_f32 v84, v44, v45
 v_lshlrev_b32 v44, 16, v84
 v_and_b32 v45, 0xffff0000, v84
 v_cvt_pk_bf16_f32 v84, v46, v47
 v_lshlrev_b32 v46, 16, v84
 v_and_b32 v47, 0xffff0000, v84
 v_cvt_pk_bf16_f32 v84, v48, v49
 v_lshlrev_b32 v48, 16, v84
 v_and_b32 v49, 0xffff0000, v84
 v_cvt_pk_bf16_f32 v84, v50, v51
 v_lshlrev_b32 v50, 16, v84
 v_and_b32 v51, 0xffff0000, v84
 v_pk_mul_f32 v[52:53], v[16:17], v[70:71]
 v_pk_mul_f32 v[54:55], v[18:19], v[70:71]
 v_pk_mul_f32 v[56:57], v[20:21], v[70:71]
 v_pk_mul_f32 v[58:59], v[22:23], v[70:71]
 v_pk_mul_f32 v[60:61], v[24:25], v[70:71]
 v_pk_mul_f32 v[62:63], v[26:27], v[70:71]
 v_pk_mul_f32 v[64:65], v[28:29], v[70:71]
 v_pk_mul_f32 v[66:67], v[30:31], v[70:71]
 v_cvt_pk_bf16_f32 v84, v52, v53
 v_lshlrev_b32 v52, 16, v84
 v_and_b32 v53, 0xffff0000, v84
 v_cvt_pk_bf16_f32 v84, v54, v55
 v_lshlrev_b32 v54, 16, v84
 v_and_b32 v55, 0xffff0000, v84
 v_cvt_pk_bf16_f32 v84, v56, v57
 v_lshlrev_b32 v56, 16, v84
 v_and_b32 v57, 0xffff0000, v84
 v_cvt_pk_bf16_f32 v84, v58, v59
 v_lshlrev_b32 v58, 16, v84
 v_and_b32 v59, 0xffff0000, v84
 v_cvt_pk_bf16_f32 v84, v60, v61
 v_lshlrev_b32 v60, 16, v84
 v_and_b32 v61, 0xffff0000, v84
 v_cvt_pk_bf16_f32 v84, v62, v63
 v_lshlrev_b32 v62, 16, v84
 v_and_b32 v63, 0xffff0000, v84
 v_cvt_pk_bf16_f32 v84, v64, v65
 v_lshlrev_b32 v64, 16, v84
 v_and_b32 v65, 0xffff0000, v84
 v_cvt_pk_bf16_f32 v84, v66, v67
 v_lshlrev_b32 v66, 16, v84
 v_and_b32 v67, 0xffff0000, v84
 v_pk_add_f32 v[36:37], v[36:37], v[52:53]
 v_pk_add_f32 v[38:39], v[38:39], v[54:55]
 v_pk_add_f32 v[40:41], v[40:41], v[56:57]
 v_pk_add_f32 v[42:43], v[42:43], v[58:59]
 v_pk_add_f32 v[44:45], v[44:45], v[60:61]
 v_pk_add_f32 v[46:47], v[46:47], v[62:63]
 v_pk_add_f32 v[48:49], v[48:49], v[64:65]
 v_pk_add_f32 v[50:51], v[50:51], v[66:67]
 v_cvt_pk_bf16_f32 v84, v36, v37
 v_lshlrev_b32 v36, 16, v84
 v_and_b32 v37, 0xffff0000, v84
 v_cvt_pk_bf16_f32 v84, v38, v39
 v_lshlrev_b32 v38, 16, v84
 v_and_b32 v39, 0xffff0000, v84
 v_cvt_pk_bf16_f32 v84, v40, v41
 v_lshlrev_b32 v40, 16, v84
 v_and_b32 v41, 0xffff0000, v84
 v_cvt_pk_bf16_f32 v84, v42, v43
 v_lshlrev_b32 v42, 16, v84
 v_and_b32 v43, 0xffff0000, v84
 v_cvt_pk_bf16_f32 v84, v44, v45
 v_lshlrev_b32 v44, 16, v84
 v_and_b32 v45, 0xffff0000, v84
 v_cvt_pk_bf16_f32 v84, v46, v47
 v_lshlrev_b32 v46, 16, v84
 v_and_b32 v47, 0xffff0000, v84
 v_cvt_pk_bf16_f32 v84, v48, v49
 v_lshlrev_b32 v48, 16, v84
 v_and_b32 v49, 0xffff0000, v84
 v_cvt_pk_bf16_f32 v84, v50, v51
 v_lshlrev_b32 v50, 16, v84
 v_and_b32 v51, 0xffff0000, v84
 v_pk_mul_f32 v[52:53], v[18:19], v[68:69]
 v_pk_mul_f32 v[54:55], v[20:21], v[68:69]
 v_pk_mul_f32 v[56:57], v[22:23], v[68:69]
 v_pk_mul_f32 v[58:59], v[24:25], v[68:69]
 v_pk_mul_f32 v[60:61], v[26:27], v[68:69]
 v_pk_mul_f32 v[62:63], v[28:29], v[68:69]
 v_pk_mul_f32 v[64:65], v[30:31], v[68:69]
 v_pk_mul_f32 v[66:67], v[32:33], v[68:69]
 v_cvt_pk_bf16_f32 v84, v52, v53
 v_lshlrev_b32 v52, 16, v84
 v_and_b32 v53, 0xffff0000, v84
 v_cvt_pk_bf16_f32 v84, v54, v55
 v_lshlrev_b32 v54, 16, v84
 v_and_b32 v55, 0xffff0000, v84
 v_cvt_pk_bf16_f32 v84, v56, v57
 v_lshlrev_b32 v56, 16, v84
 v_and_b32 v57, 0xffff0000, v84
 v_cvt_pk_bf16_f32 v84, v58, v59
 v_lshlrev_b32 v58, 16, v84
 v_and_b32 v59, 0xffff0000, v84
 v_cvt_pk_bf16_f32 v84, v60, v61
 v_lshlrev_b32 v60, 16, v84
 v_and_b32 v61, 0xffff0000, v84
 v_cvt_pk_bf16_f32 v84, v62, v63
 v_lshlrev_b32 v62, 16, v84
 v_and_b32 v63, 0xffff0000, v84
 v_cvt_pk_bf16_f32 v84, v64, v65
 v_lshlrev_b32 v64, 16, v84
 v_and_b32 v65, 0xffff0000, v84
 v_cvt_pk_bf16_f32 v84, v66, v67
 v_lshlrev_b32 v66, 16, v84
 v_and_b32 v67, 0xffff0000, v84
 v_pk_add_f32 v[36:37], v[36:37], v[52:53]
 v_pk_add_f32 v[38:39], v[38:39], v[54:55]
 v_pk_add_f32 v[40:41], v[40:41], v[56:57]
 v_pk_add_f32 v[42:43], v[42:43], v[58:59]
 v_pk_add_f32 v[44:45], v[44:45], v[60:61]
 v_pk_add_f32 v[46:47], v[46:47], v[62:63]
 v_pk_add_f32 v[48:49], v[48:49], v[64:65]
 v_pk_add_f32 v[50:51], v[50:51], v[66:67]
 v_cvt_pk_bf16_f32 v84, v36, v37
 v_lshlrev_b32 v36, 16, v84
 v_and_b32 v37, 0xffff0000, v84
 v_cvt_pk_bf16_f32 v84, v38, v39
 v_lshlrev_b32 v38, 16, v84
 v_and_b32 v39, 0xffff0000, v84
 v_cvt_pk_bf16_f32 v84, v40, v41
 v_lshlrev_b32 v40, 16, v84
 v_and_b32 v41, 0xffff0000, v84
 v_cvt_pk_bf16_f32 v84, v42, v43
 v_lshlrev_b32 v42, 16, v84
 v_and_b32 v43, 0xffff0000, v84
 v_cvt_pk_bf16_f32 v84, v44, v45
 v_lshlrev_b32 v44, 16, v84
 v_and_b32 v45, 0xffff0000, v84
 v_cvt_pk_bf16_f32 v84, v46, v47
 v_lshlrev_b32 v46, 16, v84
 v_and_b32 v47, 0xffff0000, v84
 v_cvt_pk_bf16_f32 v84, v48, v49
 v_lshlrev_b32 v48, 16, v84
 v_and_b32 v49, 0xffff0000, v84
 v_cvt_pk_bf16_f32 v84, v50, v51
 v_lshlrev_b32 v50, 16, v84
 v_and_b32 v51, 0xffff0000, v84
 v_lshlrev_b32 v12, 16, v144
 v_and_b32 v13, 0xffff0000, v144
 v_lshlrev_b32 v14, 16, v148
 v_and_b32 v15, 0xffff0000, v148
 v_lshlrev_b32 v16, 16, v152
 v_and_b32 v17, 0xffff0000, v152
 v_lshlrev_b32 v18, 16, v156
 v_and_b32 v19, 0xffff0000, v156
 v_lshlrev_b32 v20, 16, v160
 v_and_b32 v21, 0xffff0000, v160
 v_lshlrev_b32 v22, 16, v164
 v_and_b32 v23, 0xffff0000, v164
 v_lshlrev_b32 v24, 16, v168
 v_and_b32 v25, 0xffff0000, v168
 v_lshlrev_b32 v26, 16, v172
 v_and_b32 v27, 0xffff0000, v172
 v_pk_mul_f32 v[36:37], v[36:37], v[12:13]
 v_pk_mul_f32 v[38:39], v[38:39], v[14:15]
 v_pk_mul_f32 v[40:41], v[40:41], v[16:17]
 v_pk_mul_f32 v[42:43], v[42:43], v[18:19]
 v_pk_mul_f32 v[44:45], v[44:45], v[20:21]
 v_pk_mul_f32 v[46:47], v[46:47], v[22:23]
 v_pk_mul_f32 v[48:49], v[48:49], v[24:25]
 v_pk_mul_f32 v[50:51], v[50:51], v[26:27]
 v_cvt_pk_bf16_f32 v76, v50, v48
 v_cvt_pk_bf16_f32 v77, v46, v44
 v_cvt_pk_bf16_f32 v78, v42, v40
 v_cvt_pk_bf16_f32 v79, v38, v36
 s_add_u32 s3, s70, 0
 buffer_store_dwordx4 v[76:79], v94, s[4:7], s3 offen sc1
 v_cvt_pk_bf16_f32 v80, v51, v49
 v_cvt_pk_bf16_f32 v81, v47, v45
 v_cvt_pk_bf16_f32 v82, v43, v41
 v_cvt_pk_bf16_f32 v83, v39, v37
 s_add_u32 s3, s70, 4096
 buffer_store_dwordx4 v[80:83], v94, s[4:7], s3 offen sc1
 v_lshlrev_b32 v12, 16, v101
 v_and_b32 v13, 0xffff0000, v101
 v_lshlrev_b32 v14, 16, v105
 v_and_b32 v15, 0xffff0000, v105
 v_lshlrev_b32 v16, 16, v109
 v_and_b32 v17, 0xffff0000, v109
 v_lshlrev_b32 v18, 16, v113
 v_and_b32 v19, 0xffff0000, v113
 v_lshlrev_b32 v20, 16, v117
 v_and_b32 v21, 0xffff0000, v117
 v_lshlrev_b32 v22, 16, v121
 v_and_b32 v23, 0xffff0000, v121
 v_lshlrev_b32 v24, 16, v125
 v_and_b32 v25, 0xffff0000, v125
 v_lshlrev_b32 v26, 16, v129
 v_and_b32 v27, 0xffff0000, v129
 v_lshlrev_b32 v28, 16, v133
 v_and_b32 v29, 0xffff0000, v133
 v_lshlrev_b32 v30, 16, v137
 v_and_b32 v31, 0xffff0000, v137
 v_lshlrev_b32 v32, 16, v141
 v_and_b32 v33, 0xffff0000, v141
 v_lshlrev_b32 v68, 16, v180
 v_lshlrev_b32 v69, 16, v182
 v_and_b32 v70, 0xffff0000, v180
 v_and_b32 v71, 0xffff0000, v182
 v_lshlrev_b32 v72, 16, v181
 v_lshlrev_b32 v73, 16, v183
 v_and_b32 v74, 0xffff0000, v181
 v_and_b32 v75, 0xffff0000, v183
 v_pk_mul_f32 v[36:37], v[12:13], v[74:75]
 v_pk_mul_f32 v[38:39], v[14:15], v[74:75]
 v_pk_mul_f32 v[40:41], v[16:17], v[74:75]
 v_pk_mul_f32 v[42:43], v[18:19], v[74:75]
 v_pk_mul_f32 v[44:45], v[20:21], v[74:75]
 v_pk_mul_f32 v[46:47], v[22:23], v[74:75]
 v_pk_mul_f32 v[48:49], v[24:25], v[74:75]
 v_pk_mul_f32 v[50:51], v[26:27], v[74:75]
 v_cvt_pk_bf16_f32 v84, v36, v37
 v_lshlrev_b32 v36, 16, v84
 v_and_b32 v37, 0xffff0000, v84
 v_cvt_pk_bf16_f32 v84, v38, v39
 v_lshlrev_b32 v38, 16, v84
 v_and_b32 v39, 0xffff0000, v84
 v_cvt_pk_bf16_f32 v84, v40, v41
 v_lshlrev_b32 v40, 16, v84
 v_and_b32 v41, 0xffff0000, v84
 v_cvt_pk_bf16_f32 v84, v42, v43
 v_lshlrev_b32 v42, 16, v84
 v_and_b32 v43, 0xffff0000, v84
 v_cvt_pk_bf16_f32 v84, v44, v45
 v_lshlrev_b32 v44, 16, v84
 v_and_b32 v45, 0xffff0000, v84
 v_cvt_pk_bf16_f32 v84, v46, v47
 v_lshlrev_b32 v46, 16, v84
 v_and_b32 v47, 0xffff0000, v84
 v_cvt_pk_bf16_f32 v84, v48, v49
 v_lshlrev_b32 v48, 16, v84
 v_and_b32 v49, 0xffff0000, v84
 v_cvt_pk_bf16_f32 v84, v50, v51
 v_lshlrev_b32 v50, 16, v84
 v_and_b32 v51, 0xffff0000, v84
 v_pk_mul_f32 v[52:53], v[14:15], v[72:73]
 v_pk_mul_f32 v[54:55], v[16:17], v[72:73]
 v_pk_mul_f32 v[56:57], v[18:19], v[72:73]
 v_pk_mul_f32 v[58:59], v[20:21], v[72:73]
 v_pk_mul_f32 v[60:61], v[22:23], v[72:73]
 v_pk_mul_f32 v[62:63], v[24:25], v[72:73]
 v_pk_mul_f32 v[64:65], v[26:27], v[72:73]
 v_pk_mul_f32 v[66:67], v[28:29], v[72:73]
 v_cvt_pk_bf16_f32 v84, v52, v53
 v_lshlrev_b32 v52, 16, v84
 v_and_b32 v53, 0xffff0000, v84
 v_cvt_pk_bf16_f32 v84, v54, v55
 v_lshlrev_b32 v54, 16, v84
 v_and_b32 v55, 0xffff0000, v84
 v_cvt_pk_bf16_f32 v84, v56, v57
 v_lshlrev_b32 v56, 16, v84
 v_and_b32 v57, 0xffff0000, v84
 v_cvt_pk_bf16_f32 v84, v58, v59
 v_lshlrev_b32 v58, 16, v84
 v_and_b32 v59, 0xffff0000, v84
 v_cvt_pk_bf16_f32 v84, v60, v61
 v_lshlrev_b32 v60, 16, v84
 v_and_b32 v61, 0xffff0000, v84
 v_cvt_pk_bf16_f32 v84, v62, v63
 v_lshlrev_b32 v62, 16, v84
 v_and_b32 v63, 0xffff0000, v84
 v_cvt_pk_bf16_f32 v84, v64, v65
 v_lshlrev_b32 v64, 16, v84
 v_and_b32 v65, 0xffff0000, v84
 v_cvt_pk_bf16_f32 v84, v66, v67
 v_lshlrev_b32 v66, 16, v84
 v_and_b32 v67, 0xffff0000, v84
 v_pk_add_f32 v[36:37], v[36:37], v[52:53]
 v_pk_add_f32 v[38:39], v[38:39], v[54:55]
 v_pk_add_f32 v[40:41], v[40:41], v[56:57]
 v_pk_add_f32 v[42:43], v[42:43], v[58:59]
 v_pk_add_f32 v[44:45], v[44:45], v[60:61]
 v_pk_add_f32 v[46:47], v[46:47], v[62:63]
 v_pk_add_f32 v[48:49], v[48:49], v[64:65]
 v_pk_add_f32 v[50:51], v[50:51], v[66:67]
 v_cvt_pk_bf16_f32 v84, v36, v37
 v_lshlrev_b32 v36, 16, v84
 v_and_b32 v37, 0xffff0000, v84
 v_cvt_pk_bf16_f32 v84, v38, v39
 v_lshlrev_b32 v38, 16, v84
 v_and_b32 v39, 0xffff0000, v84
 v_cvt_pk_bf16_f32 v84, v40, v41
 v_lshlrev_b32 v40, 16, v84
 v_and_b32 v41, 0xffff0000, v84
 v_cvt_pk_bf16_f32 v84, v42, v43
 v_lshlrev_b32 v42, 16, v84
 v_and_b32 v43, 0xffff0000, v84
 v_cvt_pk_bf16_f32 v84, v44, v45
 v_lshlrev_b32 v44, 16, v84
 v_and_b32 v45, 0xffff0000, v84
 v_cvt_pk_bf16_f32 v84, v46, v47
 v_lshlrev_b32 v46, 16, v84
 v_and_b32 v47, 0xffff0000, v84
 v_cvt_pk_bf16_f32 v84, v48, v49
 v_lshlrev_b32 v48, 16, v84
 v_and_b32 v49, 0xffff0000, v84
 v_cvt_pk_bf16_f32 v84, v50, v51
 v_lshlrev_b32 v50, 16, v84
 v_and_b32 v51, 0xffff0000, v84
 v_pk_mul_f32 v[52:53], v[16:17], v[70:71]
 v_pk_mul_f32 v[54:55], v[18:19], v[70:71]
 v_pk_mul_f32 v[56:57], v[20:21], v[70:71]
 v_pk_mul_f32 v[58:59], v[22:23], v[70:71]
 v_pk_mul_f32 v[60:61], v[24:25], v[70:71]
 v_pk_mul_f32 v[62:63], v[26:27], v[70:71]
 v_pk_mul_f32 v[64:65], v[28:29], v[70:71]
 v_pk_mul_f32 v[66:67], v[30:31], v[70:71]
 v_cvt_pk_bf16_f32 v84, v52, v53
 v_lshlrev_b32 v52, 16, v84
 v_and_b32 v53, 0xffff0000, v84
 v_cvt_pk_bf16_f32 v84, v54, v55
 v_lshlrev_b32 v54, 16, v84
 v_and_b32 v55, 0xffff0000, v84
 v_cvt_pk_bf16_f32 v84, v56, v57
 v_lshlrev_b32 v56, 16, v84
 v_and_b32 v57, 0xffff0000, v84
 v_cvt_pk_bf16_f32 v84, v58, v59
 v_lshlrev_b32 v58, 16, v84
 v_and_b32 v59, 0xffff0000, v84
 v_cvt_pk_bf16_f32 v84, v60, v61
 v_lshlrev_b32 v60, 16, v84
 v_and_b32 v61, 0xffff0000, v84
 v_cvt_pk_bf16_f32 v84, v62, v63
 v_lshlrev_b32 v62, 16, v84
 v_and_b32 v63, 0xffff0000, v84
 v_cvt_pk_bf16_f32 v84, v64, v65
 v_lshlrev_b32 v64, 16, v84
 v_and_b32 v65, 0xffff0000, v84
 v_cvt_pk_bf16_f32 v84, v66, v67
 v_lshlrev_b32 v66, 16, v84
 v_and_b32 v67, 0xffff0000, v84
 v_pk_add_f32 v[36:37], v[36:37], v[52:53]
 v_pk_add_f32 v[38:39], v[38:39], v[54:55]
 v_pk_add_f32 v[40:41], v[40:41], v[56:57]
 v_pk_add_f32 v[42:43], v[42:43], v[58:59]
 v_pk_add_f32 v[44:45], v[44:45], v[60:61]
 v_pk_add_f32 v[46:47], v[46:47], v[62:63]
 v_pk_add_f32 v[48:49], v[48:49], v[64:65]
 v_pk_add_f32 v[50:51], v[50:51], v[66:67]
 v_cvt_pk_bf16_f32 v84, v36, v37
 v_lshlrev_b32 v36, 16, v84
 v_and_b32 v37, 0xffff0000, v84
 v_cvt_pk_bf16_f32 v84, v38, v39
 v_lshlrev_b32 v38, 16, v84
 v_and_b32 v39, 0xffff0000, v84
 v_cvt_pk_bf16_f32 v84, v40, v41
 v_lshlrev_b32 v40, 16, v84
 v_and_b32 v41, 0xffff0000, v84
 v_cvt_pk_bf16_f32 v84, v42, v43
 v_lshlrev_b32 v42, 16, v84
 v_and_b32 v43, 0xffff0000, v84
 v_cvt_pk_bf16_f32 v84, v44, v45
 v_lshlrev_b32 v44, 16, v84
 v_and_b32 v45, 0xffff0000, v84
 v_cvt_pk_bf16_f32 v84, v46, v47
 v_lshlrev_b32 v46, 16, v84
 v_and_b32 v47, 0xffff0000, v84
 v_cvt_pk_bf16_f32 v84, v48, v49
 v_lshlrev_b32 v48, 16, v84
 v_and_b32 v49, 0xffff0000, v84
 v_cvt_pk_bf16_f32 v84, v50, v51
 v_lshlrev_b32 v50, 16, v84
 v_and_b32 v51, 0xffff0000, v84
 v_pk_mul_f32 v[52:53], v[18:19], v[68:69]
 v_pk_mul_f32 v[54:55], v[20:21], v[68:69]
 v_pk_mul_f32 v[56:57], v[22:23], v[68:69]
 v_pk_mul_f32 v[58:59], v[24:25], v[68:69]
 v_pk_mul_f32 v[60:61], v[26:27], v[68:69]
 v_pk_mul_f32 v[62:63], v[28:29], v[68:69]
 v_pk_mul_f32 v[64:65], v[30:31], v[68:69]
 v_pk_mul_f32 v[66:67], v[32:33], v[68:69]
 v_cvt_pk_bf16_f32 v84, v52, v53
 v_lshlrev_b32 v52, 16, v84
 v_and_b32 v53, 0xffff0000, v84
 v_cvt_pk_bf16_f32 v84, v54, v55
 v_lshlrev_b32 v54, 16, v84
 v_and_b32 v55, 0xffff0000, v84
 v_cvt_pk_bf16_f32 v84, v56, v57
 v_lshlrev_b32 v56, 16, v84
 v_and_b32 v57, 0xffff0000, v84
 v_cvt_pk_bf16_f32 v84, v58, v59
 v_lshlrev_b32 v58, 16, v84
 v_and_b32 v59, 0xffff0000, v84
 v_cvt_pk_bf16_f32 v84, v60, v61
 v_lshlrev_b32 v60, 16, v84
 v_and_b32 v61, 0xffff0000, v84
 v_cvt_pk_bf16_f32 v84, v62, v63
 v_lshlrev_b32 v62, 16, v84
 v_and_b32 v63, 0xffff0000, v84
 v_cvt_pk_bf16_f32 v84, v64, v65
 v_lshlrev_b32 v64, 16, v84
 v_and_b32 v65, 0xffff0000, v84
 v_cvt_pk_bf16_f32 v84, v66, v67
 v_lshlrev_b32 v66, 16, v84
 v_and_b32 v67, 0xffff0000, v84
 v_pk_add_f32 v[36:37], v[36:37], v[52:53]
 v_pk_add_f32 v[38:39], v[38:39], v[54:55]
 v_pk_add_f32 v[40:41], v[40:41], v[56:57]
 v_pk_add_f32 v[42:43], v[42:43], v[58:59]
 v_pk_add_f32 v[44:45], v[44:45], v[60:61]
 v_pk_add_f32 v[46:47], v[46:47], v[62:63]
 v_pk_add_f32 v[48:49], v[48:49], v[64:65]
 v_pk_add_f32 v[50:51], v[50:51], v[66:67]
 v_cvt_pk_bf16_f32 v84, v36, v37
 v_lshlrev_b32 v36, 16, v84
 v_and_b32 v37, 0xffff0000, v84
 v_cvt_pk_bf16_f32 v84, v38, v39
 v_lshlrev_b32 v38, 16, v84
 v_and_b32 v39, 0xffff0000, v84
 v_cvt_pk_bf16_f32 v84, v40, v41
 v_lshlrev_b32 v40, 16, v84
 v_and_b32 v41, 0xffff0000, v84
 v_cvt_pk_bf16_f32 v84, v42, v43
 v_lshlrev_b32 v42, 16, v84
 v_and_b32 v43, 0xffff0000, v84
 v_cvt_pk_bf16_f32 v84, v44, v45
 v_lshlrev_b32 v44, 16, v84
 v_and_b32 v45, 0xffff0000, v84
 v_cvt_pk_bf16_f32 v84, v46, v47
 v_lshlrev_b32 v46, 16, v84
 v_and_b32 v47, 0xffff0000, v84
 v_cvt_pk_bf16_f32 v84, v48, v49
 v_lshlrev_b32 v48, 16, v84
 v_and_b32 v49, 0xffff0000, v84
 v_cvt_pk_bf16_f32 v84, v50, v51
 v_lshlrev_b32 v50, 16, v84
 v_and_b32 v51, 0xffff0000, v84
 v_lshlrev_b32 v12, 16, v145
 v_and_b32 v13, 0xffff0000, v145
 v_lshlrev_b32 v14, 16, v149
 v_and_b32 v15, 0xffff0000, v149
 v_lshlrev_b32 v16, 16, v153
 v_and_b32 v17, 0xffff0000, v153
 v_lshlrev_b32 v18, 16, v157
 v_and_b32 v19, 0xffff0000, v157
 v_lshlrev_b32 v20, 16, v161
 v_and_b32 v21, 0xffff0000, v161
 v_lshlrev_b32 v22, 16, v165
 v_and_b32 v23, 0xffff0000, v165
 v_lshlrev_b32 v24, 16, v169
 v_and_b32 v25, 0xffff0000, v169
 v_lshlrev_b32 v26, 16, v173
 v_and_b32 v27, 0xffff0000, v173
 v_pk_mul_f32 v[36:37], v[36:37], v[12:13]
 v_pk_mul_f32 v[38:39], v[38:39], v[14:15]
 v_pk_mul_f32 v[40:41], v[40:41], v[16:17]
 v_pk_mul_f32 v[42:43], v[42:43], v[18:19]
 v_pk_mul_f32 v[44:45], v[44:45], v[20:21]
 v_pk_mul_f32 v[46:47], v[46:47], v[22:23]
 v_pk_mul_f32 v[48:49], v[48:49], v[24:25]
 v_pk_mul_f32 v[50:51], v[50:51], v[26:27]
 v_cvt_pk_bf16_f32 v76, v50, v48
 v_cvt_pk_bf16_f32 v77, v46, v44
 v_cvt_pk_bf16_f32 v78, v42, v40
 v_cvt_pk_bf16_f32 v79, v38, v36
 s_add_u32 s3, s70, 8192
 buffer_store_dwordx4 v[76:79], v94, s[4:7], s3 offen sc1
 v_cvt_pk_bf16_f32 v80, v51, v49
 v_cvt_pk_bf16_f32 v81, v47, v45
 v_cvt_pk_bf16_f32 v82, v43, v41
 v_cvt_pk_bf16_f32 v83, v39, v37
 s_add_u32 s3, s70, 12288
 buffer_store_dwordx4 v[80:83], v94, s[4:7], s3 offen sc1
 v_lshlrev_b32 v12, 16, v102
 v_and_b32 v13, 0xffff0000, v102
 v_lshlrev_b32 v14, 16, v106
 v_and_b32 v15, 0xffff0000, v106
 v_lshlrev_b32 v16, 16, v110
 v_and_b32 v17, 0xffff0000, v110
 v_lshlrev_b32 v18, 16, v114
 v_and_b32 v19, 0xffff0000, v114
 v_lshlrev_b32 v20, 16, v118
 v_and_b32 v21, 0xffff0000, v118
 v_lshlrev_b32 v22, 16, v122
 v_and_b32 v23, 0xffff0000, v122
 v_lshlrev_b32 v24, 16, v126
 v_and_b32 v25, 0xffff0000, v126
 v_lshlrev_b32 v26, 16, v130
 v_and_b32 v27, 0xffff0000, v130
 v_lshlrev_b32 v28, 16, v134
 v_and_b32 v29, 0xffff0000, v134
 v_lshlrev_b32 v30, 16, v138
 v_and_b32 v31, 0xffff0000, v138
 v_lshlrev_b32 v32, 16, v142
 v_and_b32 v33, 0xffff0000, v142
 v_lshlrev_b32 v68, 16, v184
 v_lshlrev_b32 v69, 16, v186
 v_and_b32 v70, 0xffff0000, v184
 v_and_b32 v71, 0xffff0000, v186
 v_lshlrev_b32 v72, 16, v185
 v_lshlrev_b32 v73, 16, v187
 v_and_b32 v74, 0xffff0000, v185
 v_and_b32 v75, 0xffff0000, v187
 v_pk_mul_f32 v[36:37], v[12:13], v[74:75]
 v_pk_mul_f32 v[38:39], v[14:15], v[74:75]
 v_pk_mul_f32 v[40:41], v[16:17], v[74:75]
 v_pk_mul_f32 v[42:43], v[18:19], v[74:75]
 v_pk_mul_f32 v[44:45], v[20:21], v[74:75]
 v_pk_mul_f32 v[46:47], v[22:23], v[74:75]
 v_pk_mul_f32 v[48:49], v[24:25], v[74:75]
 v_pk_mul_f32 v[50:51], v[26:27], v[74:75]
 v_cvt_pk_bf16_f32 v84, v36, v37
 v_lshlrev_b32 v36, 16, v84
 v_and_b32 v37, 0xffff0000, v84
 v_cvt_pk_bf16_f32 v84, v38, v39
 v_lshlrev_b32 v38, 16, v84
 v_and_b32 v39, 0xffff0000, v84
 v_cvt_pk_bf16_f32 v84, v40, v41
 v_lshlrev_b32 v40, 16, v84
 v_and_b32 v41, 0xffff0000, v84
 v_cvt_pk_bf16_f32 v84, v42, v43
 v_lshlrev_b32 v42, 16, v84
 v_and_b32 v43, 0xffff0000, v84
 v_cvt_pk_bf16_f32 v84, v44, v45
 v_lshlrev_b32 v44, 16, v84
 v_and_b32 v45, 0xffff0000, v84
 v_cvt_pk_bf16_f32 v84, v46, v47
 v_lshlrev_b32 v46, 16, v84
 v_and_b32 v47, 0xffff0000, v84
 v_cvt_pk_bf16_f32 v84, v48, v49
 v_lshlrev_b32 v48, 16, v84
 v_and_b32 v49, 0xffff0000, v84
 v_cvt_pk_bf16_f32 v84, v50, v51
 v_lshlrev_b32 v50, 16, v84
 v_and_b32 v51, 0xffff0000, v84
 v_pk_mul_f32 v[52:53], v[14:15], v[72:73]
 v_pk_mul_f32 v[54:55], v[16:17], v[72:73]
 v_pk_mul_f32 v[56:57], v[18:19], v[72:73]
 v_pk_mul_f32 v[58:59], v[20:21], v[72:73]
 v_pk_mul_f32 v[60:61], v[22:23], v[72:73]
 v_pk_mul_f32 v[62:63], v[24:25], v[72:73]
 v_pk_mul_f32 v[64:65], v[26:27], v[72:73]
 v_pk_mul_f32 v[66:67], v[28:29], v[72:73]
 v_cvt_pk_bf16_f32 v84, v52, v53
 v_lshlrev_b32 v52, 16, v84
 v_and_b32 v53, 0xffff0000, v84
 v_cvt_pk_bf16_f32 v84, v54, v55
 v_lshlrev_b32 v54, 16, v84
 v_and_b32 v55, 0xffff0000, v84
 v_cvt_pk_bf16_f32 v84, v56, v57
 v_lshlrev_b32 v56, 16, v84
 v_and_b32 v57, 0xffff0000, v84
 v_cvt_pk_bf16_f32 v84, v58, v59
 v_lshlrev_b32 v58, 16, v84
 v_and_b32 v59, 0xffff0000, v84
 v_cvt_pk_bf16_f32 v84, v60, v61
 v_lshlrev_b32 v60, 16, v84
 v_and_b32 v61, 0xffff0000, v84
 v_cvt_pk_bf16_f32 v84, v62, v63
 v_lshlrev_b32 v62, 16, v84
 v_and_b32 v63, 0xffff0000, v84
 v_cvt_pk_bf16_f32 v84, v64, v65
 v_lshlrev_b32 v64, 16, v84
 v_and_b32 v65, 0xffff0000, v84
 v_cvt_pk_bf16_f32 v84, v66, v67
 v_lshlrev_b32 v66, 16, v84
 v_and_b32 v67, 0xffff0000, v84
 v_pk_add_f32 v[36:37], v[36:37], v[52:53]
 v_pk_add_f32 v[38:39], v[38:39], v[54:55]
 v_pk_add_f32 v[40:41], v[40:41], v[56:57]
 v_pk_add_f32 v[42:43], v[42:43], v[58:59]
 v_pk_add_f32 v[44:45], v[44:45], v[60:61]
 v_pk_add_f32 v[46:47], v[46:47], v[62:63]
 v_pk_add_f32 v[48:49], v[48:49], v[64:65]
 v_pk_add_f32 v[50:51], v[50:51], v[66:67]
 v_cvt_pk_bf16_f32 v84, v36, v37
 v_lshlrev_b32 v36, 16, v84
 v_and_b32 v37, 0xffff0000, v84
 v_cvt_pk_bf16_f32 v84, v38, v39
 v_lshlrev_b32 v38, 16, v84
 v_and_b32 v39, 0xffff0000, v84
 v_cvt_pk_bf16_f32 v84, v40, v41
 v_lshlrev_b32 v40, 16, v84
 v_and_b32 v41, 0xffff0000, v84
 v_cvt_pk_bf16_f32 v84, v42, v43
 v_lshlrev_b32 v42, 16, v84
 v_and_b32 v43, 0xffff0000, v84
 v_cvt_pk_bf16_f32 v84, v44, v45
 v_lshlrev_b32 v44, 16, v84
 v_and_b32 v45, 0xffff0000, v84
 v_cvt_pk_bf16_f32 v84, v46, v47
 v_lshlrev_b32 v46, 16, v84
 v_and_b32 v47, 0xffff0000, v84
 v_cvt_pk_bf16_f32 v84, v48, v49
 v_lshlrev_b32 v48, 16, v84
 v_and_b32 v49, 0xffff0000, v84
 v_cvt_pk_bf16_f32 v84, v50, v51
 v_lshlrev_b32 v50, 16, v84
 v_and_b32 v51, 0xffff0000, v84
 v_pk_mul_f32 v[52:53], v[16:17], v[70:71]
 v_pk_mul_f32 v[54:55], v[18:19], v[70:71]
 v_pk_mul_f32 v[56:57], v[20:21], v[70:71]
 v_pk_mul_f32 v[58:59], v[22:23], v[70:71]
 v_pk_mul_f32 v[60:61], v[24:25], v[70:71]
 v_pk_mul_f32 v[62:63], v[26:27], v[70:71]
 v_pk_mul_f32 v[64:65], v[28:29], v[70:71]
 v_pk_mul_f32 v[66:67], v[30:31], v[70:71]
 v_cvt_pk_bf16_f32 v84, v52, v53
 v_lshlrev_b32 v52, 16, v84
 v_and_b32 v53, 0xffff0000, v84
 v_cvt_pk_bf16_f32 v84, v54, v55
 v_lshlrev_b32 v54, 16, v84
 v_and_b32 v55, 0xffff0000, v84
 v_cvt_pk_bf16_f32 v84, v56, v57
 v_lshlrev_b32 v56, 16, v84
 v_and_b32 v57, 0xffff0000, v84
 v_cvt_pk_bf16_f32 v84, v58, v59
 v_lshlrev_b32 v58, 16, v84
 v_and_b32 v59, 0xffff0000, v84
 v_cvt_pk_bf16_f32 v84, v60, v61
 v_lshlrev_b32 v60, 16, v84
 v_and_b32 v61, 0xffff0000, v84
 v_cvt_pk_bf16_f32 v84, v62, v63
 v_lshlrev_b32 v62, 16, v84
 v_and_b32 v63, 0xffff0000, v84
 v_cvt_pk_bf16_f32 v84, v64, v65
 v_lshlrev_b32 v64, 16, v84
 v_and_b32 v65, 0xffff0000, v84
 v_cvt_pk_bf16_f32 v84, v66, v67
 v_lshlrev_b32 v66, 16, v84
 v_and_b32 v67, 0xffff0000, v84
 v_pk_add_f32 v[36:37], v[36:37], v[52:53]
 v_pk_add_f32 v[38:39], v[38:39], v[54:55]
 v_pk_add_f32 v[40:41], v[40:41], v[56:57]
 v_pk_add_f32 v[42:43], v[42:43], v[58:59]
 v_pk_add_f32 v[44:45], v[44:45], v[60:61]
 v_pk_add_f32 v[46:47], v[46:47], v[62:63]
 v_pk_add_f32 v[48:49], v[48:49], v[64:65]
 v_pk_add_f32 v[50:51], v[50:51], v[66:67]
 v_cvt_pk_bf16_f32 v84, v36, v37
 v_lshlrev_b32 v36, 16, v84
 v_and_b32 v37, 0xffff0000, v84
 v_cvt_pk_bf16_f32 v84, v38, v39
 v_lshlrev_b32 v38, 16, v84
 v_and_b32 v39, 0xffff0000, v84
 v_cvt_pk_bf16_f32 v84, v40, v41
 v_lshlrev_b32 v40, 16, v84
 v_and_b32 v41, 0xffff0000, v84
 v_cvt_pk_bf16_f32 v84, v42, v43
 v_lshlrev_b32 v42, 16, v84
 v_and_b32 v43, 0xffff0000, v84
 v_cvt_pk_bf16_f32 v84, v44, v45
 v_lshlrev_b32 v44, 16, v84
 v_and_b32 v45, 0xffff0000, v84
 v_cvt_pk_bf16_f32 v84, v46, v47
 v_lshlrev_b32 v46, 16, v84
 v_and_b32 v47, 0xffff0000, v84
 v_cvt_pk_bf16_f32 v84, v48, v49
 v_lshlrev_b32 v48, 16, v84
 v_and_b32 v49, 0xffff0000, v84
 v_cvt_pk_bf16_f32 v84, v50, v51
 v_lshlrev_b32 v50, 16, v84
 v_and_b32 v51, 0xffff0000, v84
 v_pk_mul_f32 v[52:53], v[18:19], v[68:69]
 v_pk_mul_f32 v[54:55], v[20:21], v[68:69]
 v_pk_mul_f32 v[56:57], v[22:23], v[68:69]
 v_pk_mul_f32 v[58:59], v[24:25], v[68:69]
 v_pk_mul_f32 v[60:61], v[26:27], v[68:69]
 v_pk_mul_f32 v[62:63], v[28:29], v[68:69]
 v_pk_mul_f32 v[64:65], v[30:31], v[68:69]
 v_pk_mul_f32 v[66:67], v[32:33], v[68:69]
 v_cvt_pk_bf16_f32 v84, v52, v53
 v_lshlrev_b32 v52, 16, v84
 v_and_b32 v53, 0xffff0000, v84
 v_cvt_pk_bf16_f32 v84, v54, v55
 v_lshlrev_b32 v54, 16, v84
 v_and_b32 v55, 0xffff0000, v84
 v_cvt_pk_bf16_f32 v84, v56, v57
 v_lshlrev_b32 v56, 16, v84
 v_and_b32 v57, 0xffff0000, v84
 v_cvt_pk_bf16_f32 v84, v58, v59
 v_lshlrev_b32 v58, 16, v84
 v_and_b32 v59, 0xffff0000, v84
 v_cvt_pk_bf16_f32 v84, v60, v61
 v_lshlrev_b32 v60, 16, v84
 v_and_b32 v61, 0xffff0000, v84
 v_cvt_pk_bf16_f32 v84, v62, v63
 v_lshlrev_b32 v62, 16, v84
 v_and_b32 v63, 0xffff0000, v84
 v_cvt_pk_bf16_f32 v84, v64, v65
 v_lshlrev_b32 v64, 16, v84
 v_and_b32 v65, 0xffff0000, v84
 v_cvt_pk_bf16_f32 v84, v66, v67
 v_lshlrev_b32 v66, 16, v84
 v_and_b32 v67, 0xffff0000, v84
 v_pk_add_f32 v[36:37], v[36:37], v[52:53]
 v_pk_add_f32 v[38:39], v[38:39], v[54:55]
 v_pk_add_f32 v[40:41], v[40:41], v[56:57]
 v_pk_add_f32 v[42:43], v[42:43], v[58:59]
 v_pk_add_f32 v[44:45], v[44:45], v[60:61]
 v_pk_add_f32 v[46:47], v[46:47], v[62:63]
 v_pk_add_f32 v[48:49], v[48:49], v[64:65]
 v_pk_add_f32 v[50:51], v[50:51], v[66:67]
 v_cvt_pk_bf16_f32 v84, v36, v37
 v_lshlrev_b32 v36, 16, v84
 v_and_b32 v37, 0xffff0000, v84
 v_cvt_pk_bf16_f32 v84, v38, v39
 v_lshlrev_b32 v38, 16, v84
 v_and_b32 v39, 0xffff0000, v84
 v_cvt_pk_bf16_f32 v84, v40, v41
 v_lshlrev_b32 v40, 16, v84
 v_and_b32 v41, 0xffff0000, v84
 v_cvt_pk_bf16_f32 v84, v42, v43
 v_lshlrev_b32 v42, 16, v84
 v_and_b32 v43, 0xffff0000, v84
 v_cvt_pk_bf16_f32 v84, v44, v45
 v_lshlrev_b32 v44, 16, v84
 v_and_b32 v45, 0xffff0000, v84
 v_cvt_pk_bf16_f32 v84, v46, v47
 v_lshlrev_b32 v46, 16, v84
 v_and_b32 v47, 0xffff0000, v84
 v_cvt_pk_bf16_f32 v84, v48, v49
 v_lshlrev_b32 v48, 16, v84
 v_and_b32 v49, 0xffff0000, v84
 v_cvt_pk_bf16_f32 v84, v50, v51
 v_lshlrev_b32 v50, 16, v84
 v_and_b32 v51, 0xffff0000, v84
 v_lshlrev_b32 v12, 16, v146
 v_and_b32 v13, 0xffff0000, v146
 v_lshlrev_b32 v14, 16, v150
 v_and_b32 v15, 0xffff0000, v150
 v_lshlrev_b32 v16, 16, v154
 v_and_b32 v17, 0xffff0000, v154
 v_lshlrev_b32 v18, 16, v158
 v_and_b32 v19, 0xffff0000, v158
 v_lshlrev_b32 v20, 16, v162
 v_and_b32 v21, 0xffff0000, v162
 v_lshlrev_b32 v22, 16, v166
 v_and_b32 v23, 0xffff0000, v166
 v_lshlrev_b32 v24, 16, v170
 v_and_b32 v25, 0xffff0000, v170
 v_lshlrev_b32 v26, 16, v174
 v_and_b32 v27, 0xffff0000, v174
 v_pk_mul_f32 v[36:37], v[36:37], v[12:13]
 v_pk_mul_f32 v[38:39], v[38:39], v[14:15]
 v_pk_mul_f32 v[40:41], v[40:41], v[16:17]
 v_pk_mul_f32 v[42:43], v[42:43], v[18:19]
 v_pk_mul_f32 v[44:45], v[44:45], v[20:21]
 v_pk_mul_f32 v[46:47], v[46:47], v[22:23]
 v_pk_mul_f32 v[48:49], v[48:49], v[24:25]
 v_pk_mul_f32 v[50:51], v[50:51], v[26:27]
 v_cvt_pk_bf16_f32 v76, v50, v48
 v_cvt_pk_bf16_f32 v77, v46, v44
 v_cvt_pk_bf16_f32 v78, v42, v40
 v_cvt_pk_bf16_f32 v79, v38, v36
 s_add_u32 s3, s70, 16384
 buffer_store_dwordx4 v[76:79], v94, s[4:7], s3 offen sc1
 v_cvt_pk_bf16_f32 v80, v51, v49
 v_cvt_pk_bf16_f32 v81, v47, v45
 v_cvt_pk_bf16_f32 v82, v43, v41
 v_cvt_pk_bf16_f32 v83, v39, v37
 s_add_u32 s3, s70, 20480
 buffer_store_dwordx4 v[80:83], v94, s[4:7], s3 offen sc1
 v_lshlrev_b32 v12, 16, v103
 v_and_b32 v13, 0xffff0000, v103
 v_lshlrev_b32 v14, 16, v107
 v_and_b32 v15, 0xffff0000, v107
 v_lshlrev_b32 v16, 16, v111
 v_and_b32 v17, 0xffff0000, v111
 v_lshlrev_b32 v18, 16, v115
 v_and_b32 v19, 0xffff0000, v115
 v_lshlrev_b32 v20, 16, v119
 v_and_b32 v21, 0xffff0000, v119
 v_lshlrev_b32 v22, 16, v123
 v_and_b32 v23, 0xffff0000, v123
 v_lshlrev_b32 v24, 16, v127
 v_and_b32 v25, 0xffff0000, v127
 v_lshlrev_b32 v26, 16, v131
 v_and_b32 v27, 0xffff0000, v131
 v_lshlrev_b32 v28, 16, v135
 v_and_b32 v29, 0xffff0000, v135
 v_lshlrev_b32 v30, 16, v139
 v_and_b32 v31, 0xffff0000, v139
 v_lshlrev_b32 v32, 16, v143
 v_and_b32 v33, 0xffff0000, v143
 v_lshlrev_b32 v68, 16, v188
 v_lshlrev_b32 v69, 16, v190
 v_and_b32 v70, 0xffff0000, v188
 v_and_b32 v71, 0xffff0000, v190
 v_lshlrev_b32 v72, 16, v189
 v_lshlrev_b32 v73, 16, v191
 v_and_b32 v74, 0xffff0000, v189
 v_and_b32 v75, 0xffff0000, v191
 v_pk_mul_f32 v[36:37], v[12:13], v[74:75]
 v_pk_mul_f32 v[38:39], v[14:15], v[74:75]
 v_pk_mul_f32 v[40:41], v[16:17], v[74:75]
 v_pk_mul_f32 v[42:43], v[18:19], v[74:75]
 v_pk_mul_f32 v[44:45], v[20:21], v[74:75]
 v_pk_mul_f32 v[46:47], v[22:23], v[74:75]
 v_pk_mul_f32 v[48:49], v[24:25], v[74:75]
 v_pk_mul_f32 v[50:51], v[26:27], v[74:75]
 v_cvt_pk_bf16_f32 v84, v36, v37
 v_lshlrev_b32 v36, 16, v84
 v_and_b32 v37, 0xffff0000, v84
 v_cvt_pk_bf16_f32 v84, v38, v39
 v_lshlrev_b32 v38, 16, v84
 v_and_b32 v39, 0xffff0000, v84
 v_cvt_pk_bf16_f32 v84, v40, v41
 v_lshlrev_b32 v40, 16, v84
 v_and_b32 v41, 0xffff0000, v84
 v_cvt_pk_bf16_f32 v84, v42, v43
 v_lshlrev_b32 v42, 16, v84
 v_and_b32 v43, 0xffff0000, v84
 v_cvt_pk_bf16_f32 v84, v44, v45
 v_lshlrev_b32 v44, 16, v84
 v_and_b32 v45, 0xffff0000, v84
 v_cvt_pk_bf16_f32 v84, v46, v47
 v_lshlrev_b32 v46, 16, v84
 v_and_b32 v47, 0xffff0000, v84
 v_cvt_pk_bf16_f32 v84, v48, v49
 v_lshlrev_b32 v48, 16, v84
 v_and_b32 v49, 0xffff0000, v84
 v_cvt_pk_bf16_f32 v84, v50, v51
 v_lshlrev_b32 v50, 16, v84
 v_and_b32 v51, 0xffff0000, v84
 v_pk_mul_f32 v[52:53], v[14:15], v[72:73]
 v_pk_mul_f32 v[54:55], v[16:17], v[72:73]
 v_pk_mul_f32 v[56:57], v[18:19], v[72:73]
 v_pk_mul_f32 v[58:59], v[20:21], v[72:73]
 v_pk_mul_f32 v[60:61], v[22:23], v[72:73]
 v_pk_mul_f32 v[62:63], v[24:25], v[72:73]
 v_pk_mul_f32 v[64:65], v[26:27], v[72:73]
 v_pk_mul_f32 v[66:67], v[28:29], v[72:73]
 v_cvt_pk_bf16_f32 v84, v52, v53
 v_lshlrev_b32 v52, 16, v84
 v_and_b32 v53, 0xffff0000, v84
 v_cvt_pk_bf16_f32 v84, v54, v55
 v_lshlrev_b32 v54, 16, v84
 v_and_b32 v55, 0xffff0000, v84
 v_cvt_pk_bf16_f32 v84, v56, v57
 v_lshlrev_b32 v56, 16, v84
 v_and_b32 v57, 0xffff0000, v84
 v_cvt_pk_bf16_f32 v84, v58, v59
 v_lshlrev_b32 v58, 16, v84
 v_and_b32 v59, 0xffff0000, v84
 v_cvt_pk_bf16_f32 v84, v60, v61
 v_lshlrev_b32 v60, 16, v84
 v_and_b32 v61, 0xffff0000, v84
 v_cvt_pk_bf16_f32 v84, v62, v63
 v_lshlrev_b32 v62, 16, v84
 v_and_b32 v63, 0xffff0000, v84
 v_cvt_pk_bf16_f32 v84, v64, v65
 v_lshlrev_b32 v64, 16, v84
 v_and_b32 v65, 0xffff0000, v84
 v_cvt_pk_bf16_f32 v84, v66, v67
 v_lshlrev_b32 v66, 16, v84
 v_and_b32 v67, 0xffff0000, v84
 v_pk_add_f32 v[36:37], v[36:37], v[52:53]
 v_pk_add_f32 v[38:39], v[38:39], v[54:55]
 v_pk_add_f32 v[40:41], v[40:41], v[56:57]
 v_pk_add_f32 v[42:43], v[42:43], v[58:59]
 v_pk_add_f32 v[44:45], v[44:45], v[60:61]
 v_pk_add_f32 v[46:47], v[46:47], v[62:63]
 v_pk_add_f32 v[48:49], v[48:49], v[64:65]
 v_pk_add_f32 v[50:51], v[50:51], v[66:67]
 v_cvt_pk_bf16_f32 v84, v36, v37
 v_lshlrev_b32 v36, 16, v84
 v_and_b32 v37, 0xffff0000, v84
 v_cvt_pk_bf16_f32 v84, v38, v39
 v_lshlrev_b32 v38, 16, v84
 v_and_b32 v39, 0xffff0000, v84
 v_cvt_pk_bf16_f32 v84, v40, v41
 v_lshlrev_b32 v40, 16, v84
 v_and_b32 v41, 0xffff0000, v84
 v_cvt_pk_bf16_f32 v84, v42, v43
 v_lshlrev_b32 v42, 16, v84
 v_and_b32 v43, 0xffff0000, v84
 v_cvt_pk_bf16_f32 v84, v44, v45
 v_lshlrev_b32 v44, 16, v84
 v_and_b32 v45, 0xffff0000, v84
 v_cvt_pk_bf16_f32 v84, v46, v47
 v_lshlrev_b32 v46, 16, v84
 v_and_b32 v47, 0xffff0000, v84
 v_cvt_pk_bf16_f32 v84, v48, v49
 v_lshlrev_b32 v48, 16, v84
 v_and_b32 v49, 0xffff0000, v84
 v_cvt_pk_bf16_f32 v84, v50, v51
 v_lshlrev_b32 v50, 16, v84
 v_and_b32 v51, 0xffff0000, v84
 v_pk_mul_f32 v[52:53], v[16:17], v[70:71]
 v_pk_mul_f32 v[54:55], v[18:19], v[70:71]
 v_pk_mul_f32 v[56:57], v[20:21], v[70:71]
 v_pk_mul_f32 v[58:59], v[22:23], v[70:71]
 v_pk_mul_f32 v[60:61], v[24:25], v[70:71]
 v_pk_mul_f32 v[62:63], v[26:27], v[70:71]
 v_pk_mul_f32 v[64:65], v[28:29], v[70:71]
 v_pk_mul_f32 v[66:67], v[30:31], v[70:71]
 v_cvt_pk_bf16_f32 v84, v52, v53
 v_lshlrev_b32 v52, 16, v84
 v_and_b32 v53, 0xffff0000, v84
 v_cvt_pk_bf16_f32 v84, v54, v55
 v_lshlrev_b32 v54, 16, v84
 v_and_b32 v55, 0xffff0000, v84
 v_cvt_pk_bf16_f32 v84, v56, v57
 v_lshlrev_b32 v56, 16, v84
 v_and_b32 v57, 0xffff0000, v84
 v_cvt_pk_bf16_f32 v84, v58, v59
 v_lshlrev_b32 v58, 16, v84
 v_and_b32 v59, 0xffff0000, v84
 v_cvt_pk_bf16_f32 v84, v60, v61
 v_lshlrev_b32 v60, 16, v84
 v_and_b32 v61, 0xffff0000, v84
 v_cvt_pk_bf16_f32 v84, v62, v63
 v_lshlrev_b32 v62, 16, v84
 v_and_b32 v63, 0xffff0000, v84
 v_cvt_pk_bf16_f32 v84, v64, v65
 v_lshlrev_b32 v64, 16, v84
 v_and_b32 v65, 0xffff0000, v84
 v_cvt_pk_bf16_f32 v84, v66, v67
 v_lshlrev_b32 v66, 16, v84
 v_and_b32 v67, 0xffff0000, v84
 v_pk_add_f32 v[36:37], v[36:37], v[52:53]
 v_pk_add_f32 v[38:39], v[38:39], v[54:55]
 v_pk_add_f32 v[40:41], v[40:41], v[56:57]
 v_pk_add_f32 v[42:43], v[42:43], v[58:59]
 v_pk_add_f32 v[44:45], v[44:45], v[60:61]
 v_pk_add_f32 v[46:47], v[46:47], v[62:63]
 v_pk_add_f32 v[48:49], v[48:49], v[64:65]
 v_pk_add_f32 v[50:51], v[50:51], v[66:67]
 v_cvt_pk_bf16_f32 v84, v36, v37
 v_lshlrev_b32 v36, 16, v84
 v_and_b32 v37, 0xffff0000, v84
 v_cvt_pk_bf16_f32 v84, v38, v39
 v_lshlrev_b32 v38, 16, v84
 v_and_b32 v39, 0xffff0000, v84
 v_cvt_pk_bf16_f32 v84, v40, v41
 v_lshlrev_b32 v40, 16, v84
 v_and_b32 v41, 0xffff0000, v84
 v_cvt_pk_bf16_f32 v84, v42, v43
 v_lshlrev_b32 v42, 16, v84
 v_and_b32 v43, 0xffff0000, v84
 v_cvt_pk_bf16_f32 v84, v44, v45
 v_lshlrev_b32 v44, 16, v84
 v_and_b32 v45, 0xffff0000, v84
 v_cvt_pk_bf16_f32 v84, v46, v47
 v_lshlrev_b32 v46, 16, v84
 v_and_b32 v47, 0xffff0000, v84
 v_cvt_pk_bf16_f32 v84, v48, v49
 v_lshlrev_b32 v48, 16, v84
 v_and_b32 v49, 0xffff0000, v84
 v_cvt_pk_bf16_f32 v84, v50, v51
 v_lshlrev_b32 v50, 16, v84
 v_and_b32 v51, 0xffff0000, v84
 v_pk_mul_f32 v[52:53], v[18:19], v[68:69]
 v_pk_mul_f32 v[54:55], v[20:21], v[68:69]
 v_pk_mul_f32 v[56:57], v[22:23], v[68:69]
 v_pk_mul_f32 v[58:59], v[24:25], v[68:69]
 v_pk_mul_f32 v[60:61], v[26:27], v[68:69]
 v_pk_mul_f32 v[62:63], v[28:29], v[68:69]
 v_pk_mul_f32 v[64:65], v[30:31], v[68:69]
 v_pk_mul_f32 v[66:67], v[32:33], v[68:69]
 v_cvt_pk_bf16_f32 v84, v52, v53
 v_lshlrev_b32 v52, 16, v84
 v_and_b32 v53, 0xffff0000, v84
 v_cvt_pk_bf16_f32 v84, v54, v55
 v_lshlrev_b32 v54, 16, v84
 v_and_b32 v55, 0xffff0000, v84
 v_cvt_pk_bf16_f32 v84, v56, v57
 v_lshlrev_b32 v56, 16, v84
 v_and_b32 v57, 0xffff0000, v84
 v_cvt_pk_bf16_f32 v84, v58, v59
 v_lshlrev_b32 v58, 16, v84
 v_and_b32 v59, 0xffff0000, v84
 v_cvt_pk_bf16_f32 v84, v60, v61
 v_lshlrev_b32 v60, 16, v84
 v_and_b32 v61, 0xffff0000, v84
 v_cvt_pk_bf16_f32 v84, v62, v63
 v_lshlrev_b32 v62, 16, v84
 v_and_b32 v63, 0xffff0000, v84
 v_cvt_pk_bf16_f32 v84, v64, v65
 v_lshlrev_b32 v64, 16, v84
 v_and_b32 v65, 0xffff0000, v84
 v_cvt_pk_bf16_f32 v84, v66, v67
 v_lshlrev_b32 v66, 16, v84
 v_and_b32 v67, 0xffff0000, v84
 v_pk_add_f32 v[36:37], v[36:37], v[52:53]
 v_pk_add_f32 v[38:39], v[38:39], v[54:55]
 v_pk_add_f32 v[40:41], v[40:41], v[56:57]
 v_pk_add_f32 v[42:43], v[42:43], v[58:59]
 v_pk_add_f32 v[44:45], v[44:45], v[60:61]
 v_pk_add_f32 v[46:47], v[46:47], v[62:63]
 v_pk_add_f32 v[48:49], v[48:49], v[64:65]
 v_pk_add_f32 v[50:51], v[50:51], v[66:67]
 v_cvt_pk_bf16_f32 v84, v36, v37
 v_lshlrev_b32 v36, 16, v84
 v_and_b32 v37, 0xffff0000, v84
 v_cvt_pk_bf16_f32 v84, v38, v39
 v_lshlrev_b32 v38, 16, v84
 v_and_b32 v39, 0xffff0000, v84
 v_cvt_pk_bf16_f32 v84, v40, v41
 v_lshlrev_b32 v40, 16, v84
 v_and_b32 v41, 0xffff0000, v84
 v_cvt_pk_bf16_f32 v84, v42, v43
 v_lshlrev_b32 v42, 16, v84
 v_and_b32 v43, 0xffff0000, v84
 v_cvt_pk_bf16_f32 v84, v44, v45
 v_lshlrev_b32 v44, 16, v84
 v_and_b32 v45, 0xffff0000, v84
 v_cvt_pk_bf16_f32 v84, v46, v47
 v_lshlrev_b32 v46, 16, v84
 v_and_b32 v47, 0xffff0000, v84
 v_cvt_pk_bf16_f32 v84, v48, v49
 v_lshlrev_b32 v48, 16, v84
 v_and_b32 v49, 0xffff0000, v84
 v_cvt_pk_bf16_f32 v84, v50, v51
 v_lshlrev_b32 v50, 16, v84
 v_and_b32 v51, 0xffff0000, v84
 v_lshlrev_b32 v12, 16, v147
 v_and_b32 v13, 0xffff0000, v147
 v_lshlrev_b32 v14, 16, v151
 v_and_b32 v15, 0xffff0000, v151
 v_lshlrev_b32 v16, 16, v155
 v_and_b32 v17, 0xffff0000, v155
 v_lshlrev_b32 v18, 16, v159
 v_and_b32 v19, 0xffff0000, v159
 v_lshlrev_b32 v20, 16, v163
 v_and_b32 v21, 0xffff0000, v163
 v_lshlrev_b32 v22, 16, v167
 v_and_b32 v23, 0xffff0000, v167
 v_lshlrev_b32 v24, 16, v171
 v_and_b32 v25, 0xffff0000, v171
 v_lshlrev_b32 v26, 16, v175
 v_and_b32 v27, 0xffff0000, v175
 v_pk_mul_f32 v[36:37], v[36:37], v[12:13]
 v_pk_mul_f32 v[38:39], v[38:39], v[14:15]
 v_pk_mul_f32 v[40:41], v[40:41], v[16:17]
 v_pk_mul_f32 v[42:43], v[42:43], v[18:19]
 v_pk_mul_f32 v[44:45], v[44:45], v[20:21]
 v_pk_mul_f32 v[46:47], v[46:47], v[22:23]
 v_pk_mul_f32 v[48:49], v[48:49], v[24:25]
 v_pk_mul_f32 v[50:51], v[50:51], v[26:27]
 v_cvt_pk_bf16_f32 v76, v50, v48
 v_cvt_pk_bf16_f32 v77, v46, v44
 v_cvt_pk_bf16_f32 v78, v42, v40
 v_cvt_pk_bf16_f32 v79, v38, v36
 s_add_u32 s3, s70, 24576
 buffer_store_dwordx4 v[76:79], v94, s[4:7], s3 offen sc1
 v_cvt_pk_bf16_f32 v80, v51, v49
 v_cvt_pk_bf16_f32 v81, v47, v45
 v_cvt_pk_bf16_f32 v82, v43, v41
 v_cvt_pk_bf16_f32 v83, v39, v37
 s_add_u32 s3, s70, 28672
 buffer_store_dwordx4 v[80:83], v94, s[4:7], s3 offen sc1
 s_cmp_eq_u32 s83, 1
 s_cbranch_scc1 L_k3_27
 s_waitcnt vmcnt(0)
 s_barrier
 s_cmp_lg_u32 s50, 3
 s_cbranch_scc1 L_ar_28
 s_mov_b32 s96, s44
 s_and_b32 s97, s45, 0xffff
 s_mov_b32 s98, 256
 s_mov_b32 s99, 0x00020000
 v_mov_b32 v1, 1
 s_mov_b64 exec, 1
 buffer_atomic_add v1, off, s[96:99], 0 offset:80 sc0
 s_waitcnt vmcnt(0)
 v_cmp_eq_u32 vcc, 39, v1
 s_cbranch_vccz L_aw_29
 buffer_store_dword v1, off, s[96:99], 0 offset:208 sc1
L_aw_29:
 s_mov_b64 exec, -1
L_ar_28:
 s_branch L_help_conv
L_k3_27:
 s_waitcnt vmcnt(0)
 s_barrier
 s_cmp_lg_u32 s50, 3
 s_cbranch_scc1 L_ar_30
 s_mov_b32 s96, s44
 s_and_b32 s97, s45, 0xffff
 s_mov_b32 s98, 256
 s_mov_b32 s99, 0x00020000
 v_mov_b32 v1, 1
 s_mov_b64 exec, 1
 buffer_atomic_add v1, off, s[96:99], 0 offset:68 sc0
 s_waitcnt vmcnt(0)
 v_cmp_eq_u32 vcc, 39, v1
 s_cbranch_vccz L_aw_31
 buffer_store_dword v1, off, s[96:99], 0 offset:196 sc1
L_aw_31:
 s_mov_b64 exec, -1
L_ar_30:
 s_mov_b32 s8, s26
 s_and_b32 s9, s27, 0xffff
 s_mov_b32 s10, 5242880
 s_mov_b32 s11, 0x00020000
 s_mul_i32 s57, s50, 40960
 s_and_b32 s55, s53, 3
 s_add_u32 s64, s55, 0
 s_sub_u32 s3, s64, 4
 s_cmp_ge_u32 s64, 4
 s_cselect_b32 s64, s3, s64
 s_add_u32 s65, s55, 1
 s_sub_u32 s3, s65, 4
 s_cmp_ge_u32 s65, 4
 s_cselect_b32 s65, s3, s65
 s_add_u32 s66, s55, 2
 s_sub_u32 s3, s66, 4
 s_cmp_ge_u32 s66, 4
 s_cselect_b32 s66, s3, s66
 s_add_u32 s67, s55, 3
 s_sub_u32 s3, s67, 4
 s_cmp_ge_u32 s67, 4
 s_cselect_b32 s67, s3, s67
 s_mul_i32 s55, s52, 655360
 s_lshl_b32 s3, s53, 8
 s_add_u32 s55, s55, s3
 v_lshrrev_b32 v4, 4, v0
 s_mov_b32 s3, 1280
 v_mul_lo_u32 v4, v4, s3
 v_lshrrev_b32 v3, 3, v0
 v_and_b32 v3, 6, v3
 v_xor_b32 v3, v3, v0
 v_and_b32 v3, 15, v3
 v_lshl_add_u32 v4, v3, 4, v4
 v_xor_b32 v5, 128, v4
 s_lshl_b32 s57, s50, 13
 s_mul_i32 s3, s50, 40960
 s_add_u32 s55, s55, s3
 s_mul_i32 s51, s64, 163840
 s_add_u32 s51, s51, s55
 s_add_u32 m0, s57, 0
 s_nop 0
 buffer_load_dwordx4 v4, s[8:11], s51 offen lds
 s_add_u32 s51, s51, 5120
 s_add_u32 m0, s57, 1024
 s_nop 0
 buffer_load_dwordx4 v5, s[8:11], s51 offen lds
 s_add_u32 s51, s51, 5120
 s_add_u32 m0, s57, 2048
 s_nop 0
 buffer_load_dwordx4 v4, s[8:11], s51 offen lds
 s_add_u32 s51, s51, 5120
 s_add_u32 m0, s57, 3072
 s_nop 0
 buffer_load_dwordx4 v5, s[8:11], s51 offen lds
 s_add_u32 s51, s51, 5120
 s_add_u32 m0, s57, 4096
 s_nop 0
 buffer_load_dwordx4 v4, s[8:11], s51 offen lds
 s_add_u32 s51, s51, 5120
 s_add_u32 m0, s57, 5120
 s_nop 0
 buffer_load_dwordx4 v5, s[8:11], s51 offen lds
 s_add_u32 s51, s51, 5120
 s_add_u32 m0, s57, 6144
 s_nop 0
 buffer_load_dwordx4 v4, s[8:11], s51 offen lds
 s_add_u32 s51, s51, 5120
 s_add_u32 m0, s57, 7168
 s_nop 0
 buffer_load_dwordx4 v5, s[8:11], s51 offen lds
 s_add_u32 s51, s51, 5120
 s_mul_i32 s51, s65, 163840
 s_add_u32 s51, s51, s55
 s_add_u32 m0, s57, 32768
 s_nop 0
 buffer_load_dwordx4 v4, s[8:11], s51 offen lds
 s_add_u32 s51, s51, 5120
 s_add_u32 m0, s57, 33792
 s_nop 0
 buffer_load_dwordx4 v5, s[8:11], s51 offen lds
 s_add_u32 s51, s51, 5120
 s_add_u32 m0, s57, 34816
 s_nop 0
 buffer_load_dwordx4 v4, s[8:11], s51 offen lds
 s_add_u32 s51, s51, 5120
 s_add_u32 m0, s57, 35840
 s_nop 0
 buffer_load_dwordx4 v5, s[8:11], s51 offen lds
 s_add_u32 s51, s51, 5120
 s_add_u32 m0, s57, 36864
 s_nop 0
 buffer_load_dwordx4 v4, s[8:11], s51 offen lds
 s_add_u32 s51, s51, 5120
 s_add_u32 m0, s57, 37888
 s_nop 0
 buffer_load_dwordx4 v5, s[8:11], s51 offen lds
 s_add_u32 s51, s51, 5120
 s_add_u32 m0, s57, 38912
 s_nop 0
 buffer_load_dwordx4 v4, s[8:11], s51 offen lds
 s_add_u32 s51, s51, 5120
 s_add_u32 m0, s57, 39936
 s_nop 0
 buffer_load_dwordx4 v5, s[8:11], s51 offen lds
 s_add_u32 s51, s51, 5120
 s_mul_i32 s51, s66, 163840
 s_add_u32 s51, s51, s55
 s_add_u32 m0, s57, 65536
 s_nop 0
 buffer_load_dwordx4 v4, s[8:11], s51 offen lds
 s_add_u32 s51, s51, 5120
 s_add_u32 m0, s57, 66560
 s_nop 0
 buffer_load_dwordx4 v5, s[8:11], s51 offen lds
 s_add_u32 s51, s51, 5120
 s_add_u32 m0, s57, 67584
 s_nop 0
 buffer_load_dwordx4 v4, s[8:11], s51 offen lds
 s_add_u32 s51, s51, 5120
 s_add_u32 m0, s57, 68608
 s_nop 0
 buffer_load_dwordx4 v5, s[8:11], s51 offen lds
 s_add_u32 s51, s51, 5120
 s_add_u32 m0, s57, 69632
 s_nop 0
 buffer_load_dwordx4 v4, s[8:11], s51 offen lds
 s_add_u32 s51, s51, 5120
 s_add_u32 m0, s57, 70656
 s_nop 0
 buffer_load_dwordx4 v5, s[8:11], s51 offen lds
 s_add_u32 s51, s51, 5120
 s_add_u32 m0, s57, 71680
 s_nop 0
 buffer_load_dwordx4 v4, s[8:11], s51 offen lds
 s_add_u32 s51, s51, 5120
 s_add_u32 m0, s57, 72704
 s_nop 0
 buffer_load_dwordx4 v5, s[8:11], s51 offen lds
 s_add_u32 s51, s51, 5120
 s_mul_i32 s51, s67, 163840
 s_add_u32 s51, s51, s55
 s_add_u32 m0, s57, 98304
 s_nop 0
 buffer_load_dwordx4 v4, s[8:11], s51 offen lds
 s_add_u32 s51, s51, 5120
 s_add_u32 m0, s57, 99328
 s_nop 0
 buffer_load_dwordx4 v5, s[8:11], s51 offen lds
 s_add_u32 s51, s51, 5120
 s_add_u32 m0, s57, 100352
 s_nop 0
 buffer_load_dwordx4 v4, s[8:11], s51 offen lds
 s_add_u32 s51, s51, 5120
 s_add_u32 m0, s57, 101376
 s_nop 0
 buffer_load_dwordx4 v5, s[8:11], s51 offen lds
 s_add_u32 s51, s51, 5120
 s_add_u32 m0, s57, 102400
 s_nop 0
 buffer_load_dwordx4 v4, s[8:11], s51 offen lds
 s_add_u32 s51, s51, 5120
 s_add_u32 m0, s57, 103424
 s_nop 0
 buffer_load_dwordx4 v5, s[8:11], s51 offen lds
 s_add_u32 s51, s51, 5120
 s_add_u32 m0, s57, 104448
 s_nop 0
 buffer_load_dwordx4 v4, s[8:11], s51 offen lds
 s_add_u32 s51, s51, 5120
 s_add_u32 m0, s57, 105472
 s_nop 0
 buffer_load_dwordx4 v5, s[8:11], s51 offen lds
 s_add_u32 s51, s51, 5120
 v_lshrrev_b32 v2, 3, v0
 v_and_b32 v2, 4, v2
 v_bfe_u32 v3, v0, 2, 2
 v_or_b32 v2, v2, v3
 v_bfe_u32 v3, v0, 4, 1
 v_xor_b32 v3, v3, v2
 s_lshl_b32 s3, s50, 1
 v_xor_b32 v3, s3, v3
 v_lshlrev_b32 v2, 8, v2
 v_lshl_add_u32 v2, v3, 5, v2
 v_and_b32 v3, 3, v0
 v_lshl_add_u32 v2, v3, 3, v2
 s_waitcnt vmcnt(24)
 s_barrier
 ds_read_b64_tr_b16 a[0:1], v2 offset:0
 ds_read_b64_tr_b16 a[2:3], v2 offset:4096
 ds_read_b64_tr_b16 a[4:5], v2 offset:2048
 ds_read_b64_tr_b16 a[6:7], v2 offset:6144
 ds_read_b64_tr_b16 a[8:9], v2 offset:8192
 ds_read_b64_tr_b16 a[10:11], v2 offset:12288
 ds_read_b64_tr_b16 a[12:13], v2 offset:10240
 ds_read_b64_tr_b16 a[14:15], v2 offset:14336
 ds_read_b64_tr_b16 a[16:17], v2 offset:16384
 ds_read_b64_tr_b16 a[18:19], v2 offset:20480
 ds_read_b64_tr_b16 a[20:21], v2 offset:18432
 ds_read_b64_tr_b16 a[22:23], v2 offset:22528
 ds_read_b64_tr_b16 a[24:25], v2 offset:24576
 ds_read_b64_tr_b16 a[26:27], v2 offset:28672
 ds_read_b64_tr_b16 a[28:29], v2 offset:26624
 ds_read_b64_tr_b16 a[30:31], v2 offset:30720
 v_add_u32 v2, 0x8000, v2
 s_waitcnt vmcnt(16)
 s_barrier
 ds_read_b64_tr_b16 a[32:33], v2 offset:0
 ds_read_b64_tr_b16 a[34:35], v2 offset:4096
 ds_read_b64_tr_b16 a[36:37], v2 offset:2048
 ds_read_b64_tr_b16 a[38:39], v2 offset:6144
 ds_read_b64_tr_b16 a[40:41], v2 offset:8192
 ds_read_b64_tr_b16 a[42:43], v2 offset:12288
 ds_read_b64_tr_b16 a[44:45], v2 offset:10240
 ds_read_b64_tr_b16 a[46:47], v2 offset:14336
 ds_read_b64_tr_b16 a[48:49], v2 offset:16384
 ds_read_b64_tr_b16 a[50:51], v2 offset:20480
 ds_read_b64_tr_b16 a[52:53], v2 offset:18432
 ds_read_b64_tr_b16 a[54:55], v2 offset:22528
 ds_read_b64_tr_b16 a[56:57], v2 offset:24576
 ds_read_b64_tr_b16 a[58:59], v2 offset:28672
 ds_read_b64_tr_b16 a[60:61], v2 offset:26624
 ds_read_b64_tr_b16 a[62:63], v2 offset:30720
 v_add_u32 v2, 0x8000, v2
 s_waitcnt vmcnt(8)
 s_barrier
 ds_read_b64_tr_b16 a[64:65], v2 offset:0
 ds_read_b64_tr_b16 a[66:67], v2 offset:4096
 ds_read_b64_tr_b16 a[68:69], v2 offset:2048
 ds_read_b64_tr_b16 a[70:71], v2 offset:6144
 ds_read_b64_tr_b16 a[72:73], v2 offset:8192
 ds_read_b64_tr_b16 a[74:75], v2 offset:12288
 ds_read_b64_tr_b16 a[76:77], v2 offset:10240
 ds_read_b64_tr_b16 a[78:79], v2 offset:14336
 ds_read_b64_tr_b16 a[80:81], v2 offset:16384
 ds_read_b64_tr_b16 a[82:83], v2 offset:20480
 ds_read_b64_tr_b16 a[84:85], v2 offset:18432
 ds_read_b64_tr_b16 a[86:87], v2 offset:22528
 ds_read_b64_tr_b16 a[88:89], v2 offset:24576
 ds_read_b64_tr_b16 a[90:91], v2 offset:28672
 ds_read_b64_tr_b16 a[92:93], v2 offset:26624
 ds_read_b64_tr_b16 a[94:95], v2 offset:30720
 v_add_u32 v2, 0x8000, v2
 s_waitcnt vmcnt(0)
 s_barrier
 ds_read_b64_tr_b16 a[96:97], v2 offset:0
 ds_read_b64_tr_b16 a[98:99], v2 offset:4096
 ds_read_b64_tr_b16 a[100:101], v2 offset:2048
 ds_read_b64_tr_b16 a[102:103], v2 offset:6144
 ds_read_b64_tr_b16 a[104:105], v2 offset:8192
 ds_read_b64_tr_b16 a[106:107], v2 offset:12288
 ds_read_b64_tr_b16 a[108:109], v2 offset:10240
 ds_read_b64_tr_b16 a[110:111], v2 offset:14336
 ds_read_b64_tr_b16 a[112:113], v2 offset:16384
 ds_read_b64_tr_b16 a[114:115], v2 offset:20480
 ds_read_b64_tr_b16 a[116:117], v2 offset:18432
 ds_read_b64_tr_b16 a[118:119], v2 offset:22528
 ds_read_b64_tr_b16 a[120:121], v2 offset:24576
 ds_read_b64_tr_b16 a[122:123], v2 offset:28672
 ds_read_b64_tr_b16 a[124:125], v2 offset:26624
 ds_read_b64_tr_b16 a[126:127], v2 offset:30720
 v_add_u32 v2, 0x8000, v2
 s_waitcnt lgkmcnt(0)
 s_barrier
L_help_conv:
 s_cmp_ge_u32 s82, 64
 s_cbranch_scc1 L_help_done
 s_lshl_b32 s70, s82, 2
 s_add_u32 s70, s70, s50
 s_add_u32 s70, s70, 384
 s_mul_i32 s71, s50, 13312
 s_mov_b32 s69, 640
 s_mov_b32 s8, s38
 s_and_b32 s9, s39, 0xffff
 s_mov_b32 s10, 2621440
 s_mov_b32 s11, 0x00020000
 s_mov_b32 s12, s40
 s_and_b32 s13, s41, 0xffff
 s_mov_b32 s14, 1280
 s_mov_b32 s15, 0x00020000
 v_lshlrev_b32 v130, 4, v0
 s_lshl_b32 s73, s70, 12
 s_add_u32 s74, s73, 2
 buffer_load_dwordx4 v[96:99], v130, s[8:11], s73 offen offset:0
 buffer_load_dwordx4 v[100:103], v130, s[8:11], s73 offen offset:1024
 buffer_load_dwordx4 v[112:115], v130, s[8:11], s74 offen offset:0
 buffer_load_dwordx4 v[116:119], v130, s[8:11], s74 offen offset:1024
 s_lshl_b32 s3, s70, 1
 buffer_load_ushort v128, off, s[12:15], s3
 s_getpc_b64 s[76:77]
L_ca_32:
 s_add_u32 s76, s76, L_conv0-L_ca_32
 s_addc_u32 s77, s77, -1
 s_swappc_b64 s[76:77], s[76:77]
 s_waitcnt vmcnt(0)
 s_barrier
 s_cmp_lg_u32 s50, 3
 s_cbranch_scc1 L_ar_33
 s_mov_b32 s96, s44
 s_and_b32 s97, s45, 0xffff
 s_mov_b32 s98, 256
 s_mov_b32 s99, 0x00020000
 v_mov_b32 v1, 1
 s_mov_b64 exec, 1
 buffer_atomic_add v1, off, s[96:99], 0 offset:8 sc0
 s_waitcnt vmcnt(0)
 v_cmp_eq_u32 vcc, 159, v1
 s_cbranch_vccz L_aw_34
 buffer_store_dword v1, off, s[96:99], 0 offset:136 sc1
L_aw_34:
 s_mov_b64 exec, -1
L_ar_33:
L_help_done:
 s_cmp_lg_u32 s50, 0
 s_cbranch_scc1 L_ww_35
 s_mov_b32 s96, s44
 s_and_b32 s97, s45, 0xffff
 s_mov_b32 s98, 256
 s_mov_b32 s99, 0x00020000
 v_mov_b32 v1, 132
 s_mov_b32 s51, 0
 s_mov_b64 exec, 1
L_wb_36:
 buffer_load_dword v2, v1, s[96:99], 0 offen sc1
 s_waitcnt vmcnt(0)
 v_cmp_eq_u32 vcc, 0, v2
 s_cbranch_vccz L_wbd_37
 s_sleep 2
 s_add_u32 s51, s51, 1
 s_cmp_lt_u32 s51, 131072
 s_cbranch_scc1 L_wb_36
 s_branch L_bail
L_wbd_37:
 s_mov_b64 exec, -1
L_ww_35:
 s_barrier
 s_cmp_eq_u32 s83, 0
 s_cbranch_scc1 L_t4
 s_cmp_eq_u32 s83, 1
 s_cbranch_scc1 L_wo
 s_cmp_eq_u32 s83, 2
 s_cbranch_scc1 L_vr_far
 s_cmp_eq_u32 s83, 4
 s_cbranch_scc1 L_ch_far
 s_branch L_wm
L_late:
 s_lshl_b32 s60, s82, 2
 s_add_u32 s60, s60, s50
 s_mul_i32 s71, s50, 13312
 s_add_u32 s72, s60, 544
 s_mov_b32 s8, s16
 s_and_b32 s9, s17, 0xffff
 s_mov_b32 s10, 2621440
 s_mov_b32 s11, 0x00020000
 v_lshlrev_b32 v1, 4, v0
 v_lshlrev_b32 v2, 3, v0
 v_cmp_lt_u32 vcc, 31, v0
 v_mov_b32 v3, 268435456
 s_nop 1
 v_cndmask_b32 v7, v2, v3, vcc
 s_mov_b32 s63, 0x3acccccd
 s_mov_b32 s68, 0x3727c5ac
 s_add_u32 s3, s72, 0
 s_mul_i32 s3, s3, 1280
 buffer_load_dwordx2 v[48:49], v2, s[8:11], s3 offen offset:0
 buffer_load_dwordx2 v[50:51], v2, s[8:11], s3 offen offset:512
 buffer_load_dwordx2 v[52:53], v7, s[8:11], s3 offen offset:1024
 s_waitcnt vmcnt(0)
L_ln_38:
 v_lshlrev_b32 v12, 16, v48
 v_and_b32 v13, 0xffff0000, v48
 v_lshlrev_b32 v14, 16, v49
 v_and_b32 v15, 0xffff0000, v49
 v_lshlrev_b32 v16, 16, v50
 v_and_b32 v17, 0xffff0000, v50
 v_lshlrev_b32 v18, 16, v51
 v_and_b32 v19, 0xffff0000, v51
 v_lshlrev_b32 v20, 16, v52
 v_and_b32 v21, 0xffff0000, v52
 v_lshlrev_b32 v22, 16, v53
 v_and_b32 v23, 0xffff0000, v53
 s_add_u32 s3, s72, 64
 s_mul_i32 s3, s3, 1280
 buffer_load_dwordx2 v[48:49], v2, s[8:11], s3 offen offset:0
 buffer_load_dwordx2 v[50:51], v2, s[8:11], s3 offen offset:512
 buffer_load_dwordx2 v[52:53], v7, s[8:11], s3 offen offset:1024
 s_and_b32 s3, s72, 15
 v_lshrrev_b32 v4, 3, v0
 v_lshlrev_b32 v4, 2, v4
 v_and_b32 v9, 3, v0
 v_add_u32 v4, v4, v9
 v_xor_b32 v4, s3, v4
 v_lshlrev_b32 v4, 4, v4
 v_and_b32 v9, 4, v0
 v_lshl_add_u32 v4, v9, 1, v4
 v_cndmask_b32 v8, v4, v3, vcc
 v_readfirstlane_b32 s3, v12
 s_nop 1
 v_subrev_f32 v36, s3, v12
 v_subrev_f32 v37, s3, v13
 v_subrev_f32 v38, s3, v14
 v_subrev_f32 v39, s3, v15
 v_subrev_f32 v40, s3, v16
 v_subrev_f32 v41, s3, v17
 v_subrev_f32 v42, s3, v18
 v_subrev_f32 v43, s3, v19
 v_mov_b32 v44, 0
 v_mov_b32 v45, 0
 v_mov_b32 v46, 0
 v_mov_b32 v47, 0
 s_mov_b32 exec_hi, 0
 v_subrev_f32 v44, s3, v20
 v_subrev_f32 v45, s3, v21
 v_subrev_f32 v46, s3, v22
 v_subrev_f32 v47, s3, v23
 s_mov_b32 exec_hi, -1
 v_pk_mul_f32 v[10:11], v[36:37], v[36:37]
 v_pk_fma_f32 v[10:11], v[38:39], v[38:39], v[10:11]
 v_pk_fma_f32 v[10:11], v[40:41], v[40:41], v[10:11]
 v_pk_fma_f32 v[10:11], v[42:43], v[42:43], v[10:11]
 v_pk_fma_f32 v[10:11], v[44:45], v[44:45], v[10:11]
 v_pk_fma_f32 v[10:11], v[46:47], v[46:47], v[10:11]
 v_pk_add_f32 v[36:37], v[36:37], v[38:39]
 v_pk_add_f32 v[36:37], v[36:37], v[40:41]
 v_pk_add_f32 v[36:37], v[36:37], v[42:43]
 v_pk_add_f32 v[36:37], v[36:37], v[44:45]
 v_pk_add_f32 v[36:37], v[36:37], v[46:47]
 v_add_f32 v11, v10, v11
 v_add_f32 v10, v36, v37
 s_nop 0
 v_add_f32_dpp v11, v11, v11 quad_perm:[1,0,3,2] row_mask:0xf bank_mask:0xf
 v_add_f32_dpp v10, v10, v10 quad_perm:[1,0,3,2] row_mask:0xf bank_mask:0xf
 s_nop 0
 v_add_f32_dpp v11, v11, v11 quad_perm:[2,3,0,1] row_mask:0xf bank_mask:0xf
 v_add_f32_dpp v10, v10, v10 quad_perm:[2,3,0,1] row_mask:0xf bank_mask:0xf
 s_nop 0
 v_add_f32_dpp v11, v11, v11 row_half_mirror row_mask:0xf bank_mask:0xf
 v_add_f32_dpp v10, v10, v10 row_half_mirror row_mask:0xf bank_mask:0xf
 s_nop 0
 v_add_f32_dpp v11, v11, v11 row_mirror row_mask:0xf bank_mask:0xf
 v_add_f32_dpp v10, v10, v10 row_mirror row_mask:0xf bank_mask:0xf
 v_mov_b32 v37, v11
 v_mov_b32 v36, v10
 s_nop 0
 v_permlane16_swap_b32 v11, v37
 v_permlane16_swap_b32 v10, v36
 v_pk_add_f32 v[10:11], v[10:11], v[36:37]
 v_mov_b32 v37, v11
 v_mov_b32 v36, v10
 s_nop 0
 v_permlane32_swap_b32 v11, v37
 v_permlane32_swap_b32 v10, v36
 v_pk_add_f32 v[10:11], v[10:11], v[36:37]
 v_mul_f32 v10, s63, v10
 v_mul_f32 v11, s63, v11
 v_fma_f32 v11, -v10, v10, v11
 v_max_f32 v11, 0, v11
 v_add_f32 v10, s3, v10
 v_cvt_pk_bf16_f32 v9, v10, v11
 v_lshlrev_b32 v10, 16, v9
 v_and_b32 v11, 0xffff0000, v9
 v_add_f32 v11, s68, v11
 v_cvt_pk_bf16_f32 v11, v11, v11
 v_and_b32 v11, 0xffff0000, v11
 v_sqrt_f32 v11, v11
 s_nop 0
 v_pk_add_f32 v[36:37], v[12:13], v[10:11] op_sel_hi:[1,0] neg_lo:[0,1] neg_hi:[0,1]
 v_pk_add_f32 v[38:39], v[14:15], v[10:11] op_sel_hi:[1,0] neg_lo:[0,1] neg_hi:[0,1]
 v_pk_add_f32 v[40:41], v[16:17], v[10:11] op_sel_hi:[1,0] neg_lo:[0,1] neg_hi:[0,1]
 v_pk_add_f32 v[42:43], v[18:19], v[10:11] op_sel_hi:[1,0] neg_lo:[0,1] neg_hi:[0,1]
 v_pk_add_f32 v[44:45], v[20:21], v[10:11] op_sel_hi:[1,0] neg_lo:[0,1] neg_hi:[0,1]
 v_pk_add_f32 v[46:47], v[22:23], v[10:11] op_sel_hi:[1,0] neg_lo:[0,1] neg_hi:[0,1]
 v_cvt_pk_bf16_f32 v11, v11, v11
 v_and_b32 v11, 0xffff0000, v11
 v_rcp_f32 v11, v11
 v_cvt_pk_bf16_f32 v9, v36, v37
 v_lshlrev_b32 v36, 16, v9
 v_and_b32 v37, 0xffff0000, v9
 v_cvt_pk_bf16_f32 v9, v38, v39
 v_lshlrev_b32 v38, 16, v9
 v_and_b32 v39, 0xffff0000, v9
 v_cvt_pk_bf16_f32 v9, v40, v41
 v_lshlrev_b32 v40, 16, v9
 v_and_b32 v41, 0xffff0000, v9
 v_cvt_pk_bf16_f32 v9, v42, v43
 v_lshlrev_b32 v42, 16, v9
 v_and_b32 v43, 0xffff0000, v9
 v_cvt_pk_bf16_f32 v9, v44, v45
 v_lshlrev_b32 v44, 16, v9
 v_and_b32 v45, 0xffff0000, v9
 v_cvt_pk_bf16_f32 v9, v46, v47
 v_lshlrev_b32 v46, 16, v9
 v_and_b32 v47, 0xffff0000, v9
 v_pk_mul_f32 v[36:37], v[36:37], v[10:11] op_sel:[0,1] op_sel_hi:[1,1]
 v_pk_mul_f32 v[38:39], v[38:39], v[10:11] op_sel:[0,1] op_sel_hi:[1,1]
 v_pk_mul_f32 v[40:41], v[40:41], v[10:11] op_sel:[0,1] op_sel_hi:[1,1]
 v_pk_mul_f32 v[42:43], v[42:43], v[10:11] op_sel:[0,1] op_sel_hi:[1,1]
 v_pk_mul_f32 v[44:45], v[44:45], v[10:11] op_sel:[0,1] op_sel_hi:[1,1]
 v_pk_mul_f32 v[46:47], v[46:47], v[10:11] op_sel:[0,1] op_sel_hi:[1,1]
 v_cvt_pk_bf16_f32 v24, v36, v37
 v_cvt_pk_bf16_f32 v25, v38, v39
 v_cvt_pk_bf16_f32 v26, v40, v41
 v_cvt_pk_bf16_f32 v27, v42, v43
 v_cvt_pk_bf16_f32 v28, v44, v45
 v_cvt_pk_bf16_f32 v29, v46, v47
 s_mul_i32 s3, s72, 1280
 s_add_u32 s3, s3, 192937984
 buffer_store_dwordx2 v[24:25], v4, s[4:7], s3 offen offset:0 sc1
 buffer_store_dwordx2 v[26:27], v4, s[4:7], s3 offen offset:512 sc1
 buffer_store_dwordx2 v[28:29], v8, s[4:7], s3 offen offset:1024 sc1
 s_add_u32 s72, s72, 64
 s_waitcnt vmcnt(3)
 s_cmp_lt_u32 s72, 2048
 s_cbranch_scc1 L_ln_38
 s_waitcnt vmcnt(0)
 s_mov_b32 s96, s44
 s_and_b32 s97, s45, 0xffff
 s_mov_b32 s98, 256
 s_mov_b32 s99, 0x00020000
 v_mov_b32 v1, 1
 s_mov_b64 exec, 1
 buffer_atomic_add v1, off, s[96:99], 0 offset:12 sc0
 s_waitcnt vmcnt(0)
 v_cmp_eq_u32 vcc, 63, v1
 s_cbranch_vccz L_aw_39
 buffer_store_dword v1, off, s[96:99], 0 offset:140 sc1
L_aw_39:
 s_mov_b64 exec, -1
 s_branch L_ch_far
L_qkvq:
 s_mul_i32 s57, s50, 40960
 s_mul_i32 s62, s52, 3
 s_add_u32 s62, s62, s53
 s_mul_i32 s3, s62, 13108
 s_lshr_b32 s3, s3, 16
 s_mul_i32 s3, s3, 5
 s_sub_u32 s55, s62, s3
 s_add_u32 s64, s55, 0
 s_sub_u32 s3, s64, 5
 s_cmp_ge_u32 s64, 5
 s_cselect_b32 s64, s3, s64
 s_add_u32 s65, s55, 1
 s_sub_u32 s3, s65, 5
 s_cmp_ge_u32 s65, 5
 s_cselect_b32 s65, s3, s65
 s_add_u32 s66, s55, 2
 s_sub_u32 s3, s66, 5
 s_cmp_ge_u32 s66, 5
 s_cselect_b32 s66, s3, s66
 s_add_u32 s67, s55, 3
 s_sub_u32 s3, s67, 5
 s_cmp_ge_u32 s67, 5
 s_cselect_b32 s67, s3, s67
 s_add_u32 s68, s55, 4
 s_sub_u32 s3, s68, 5
 s_cmp_ge_u32 s68, 5
 s_cselect_b32 s68, s3, s68
 s_lshl_b32 s55, s52, 8
 v_lshrrev_b32 v4, 4, v0
 s_mov_b32 s3, 8192
 v_mul_lo_u32 v4, v4, s3
 v_lshrrev_b32 v3, 3, v0
 v_and_b32 v3, 6, v3
 v_xor_b32 v3, v3, v0
 v_and_b32 v3, 15, v3
 v_lshl_add_u32 v4, v3, 4, v4
 v_xor_b32 v5, 128, v4
 s_lshl_b32 s57, s50, 13
 s_mul_i32 s3, s50, 262144
 s_add_u32 s55, s55, s3
 s_mul_i32 s51, s64, 1048576
 s_add_u32 s51, s51, s55
 s_add_u32 m0, s57, 0
 s_nop 0
 buffer_load_dwordx4 v4, s[8:11], s51 offen lds
 s_add_u32 s51, s51, 32768
 s_add_u32 m0, s57, 1024
 s_nop 0
 buffer_load_dwordx4 v5, s[8:11], s51 offen lds
 s_add_u32 s51, s51, 32768
 s_add_u32 m0, s57, 2048
 s_nop 0
 buffer_load_dwordx4 v4, s[8:11], s51 offen lds
 s_add_u32 s51, s51, 32768
 s_add_u32 m0, s57, 3072
 s_nop 0
 buffer_load_dwordx4 v5, s[8:11], s51 offen lds
 s_add_u32 s51, s51, 32768
 s_add_u32 m0, s57, 4096
 s_nop 0
 buffer_load_dwordx4 v4, s[8:11], s51 offen lds
 s_add_u32 s51, s51, 32768
 s_add_u32 m0, s57, 5120
 s_nop 0
 buffer_load_dwordx4 v5, s[8:11], s51 offen lds
 s_add_u32 s51, s51, 32768
 s_add_u32 m0, s57, 6144
 s_nop 0
 buffer_load_dwordx4 v4, s[8:11], s51 offen lds
 s_add_u32 s51, s51, 32768
 s_add_u32 m0, s57, 7168
 s_nop 0
 buffer_load_dwordx4 v5, s[8:11], s51 offen lds
 s_add_u32 s51, s51, 32768
 s_mul_i32 s51, s65, 1048576
 s_add_u32 s51, s51, s55
 s_add_u32 m0, s57, 32768
 s_nop 0
 buffer_load_dwordx4 v4, s[8:11], s51 offen lds
 s_add_u32 s51, s51, 32768
 s_add_u32 m0, s57, 33792
 s_nop 0
 buffer_load_dwordx4 v5, s[8:11], s51 offen lds
 s_add_u32 s51, s51, 32768
 s_add_u32 m0, s57, 34816
 s_nop 0
 buffer_load_dwordx4 v4, s[8:11], s51 offen lds
 s_add_u32 s51, s51, 32768
 s_add_u32 m0, s57, 35840
 s_nop 0
 buffer_load_dwordx4 v5, s[8:11], s51 offen lds
 s_add_u32 s51, s51, 32768
 s_add_u32 m0, s57, 36864
 s_nop 0
 buffer_load_dwordx4 v4, s[8:11], s51 offen lds
 s_add_u32 s51, s51, 32768
 s_add_u32 m0, s57, 37888
 s_nop 0
 buffer_load_dwordx4 v5, s[8:11], s51 offen lds
 s_add_u32 s51, s51, 32768
 s_add_u32 m0, s57, 38912
 s_nop 0
 buffer_load_dwordx4 v4, s[8:11], s51 offen lds
 s_add_u32 s51, s51, 32768
 s_add_u32 m0, s57, 39936
 s_nop 0
 buffer_load_dwordx4 v5, s[8:11], s51 offen lds
 s_add_u32 s51, s51, 32768
 s_mul_i32 s51, s66, 1048576
 s_add_u32 s51, s51, s55
 s_add_u32 m0, s57, 65536
 s_nop 0
 buffer_load_dwordx4 v4, s[8:11], s51 offen lds
 s_add_u32 s51, s51, 32768
 s_add_u32 m0, s57, 66560
 s_nop 0
 buffer_load_dwordx4 v5, s[8:11], s51 offen lds
 s_add_u32 s51, s51, 32768
 s_add_u32 m0, s57, 67584
 s_nop 0
 buffer_load_dwordx4 v4, s[8:11], s51 offen lds
 s_add_u32 s51, s51, 32768
 s_add_u32 m0, s57, 68608
 s_nop 0
 buffer_load_dwordx4 v5, s[8:11], s51 offen lds
 s_add_u32 s51, s51, 32768
 s_add_u32 m0, s57, 69632
 s_nop 0
 buffer_load_dwordx4 v4, s[8:11], s51 offen lds
 s_add_u32 s51, s51, 32768
 s_add_u32 m0, s57, 70656
 s_nop 0
 buffer_load_dwordx4 v5, s[8:11], s51 offen lds
 s_add_u32 s51, s51, 32768
 s_add_u32 m0, s57, 71680
 s_nop 0
 buffer_load_dwordx4 v4, s[8:11], s51 offen lds
 s_add_u32 s51, s51, 32768
 s_add_u32 m0, s57, 72704
 s_nop 0
 buffer_load_dwordx4 v5, s[8:11], s51 offen lds
 s_add_u32 s51, s51, 32768
 s_mul_i32 s51, s67, 1048576
 s_add_u32 s51, s51, s55
 s_add_u32 m0, s57, 98304
 s_nop 0
 buffer_load_dwordx4 v4, s[8:11], s51 offen lds
 s_add_u32 s51, s51, 32768
 s_add_u32 m0, s57, 99328
 s_nop 0
 buffer_load_dwordx4 v5, s[8:11], s51 offen lds
 s_add_u32 s51, s51, 32768
 s_add_u32 m0, s57, 100352
 s_nop 0
 buffer_load_dwordx4 v4, s[8:11], s51 offen lds
 s_add_u32 s51, s51, 32768
 s_add_u32 m0, s57, 101376
 s_nop 0
 buffer_load_dwordx4 v5, s[8:11], s51 offen lds
 s_add_u32 s51, s51, 32768
 s_add_u32 m0, s57, 102400
 s_nop 0
 buffer_load_dwordx4 v4, s[8:11], s51 offen lds
 s_add_u32 s51, s51, 32768
 s_add_u32 m0, s57, 103424
 s_nop 0
 buffer_load_dwordx4 v5, s[8:11], s51 offen lds
 s_add_u32 s51, s51, 32768
 s_add_u32 m0, s57, 104448
 s_nop 0
 buffer_load_dwordx4 v4, s[8:11], s51 offen lds
 s_add_u32 s51, s51, 32768
 s_add_u32 m0, s57, 105472
 s_nop 0
 buffer_load_dwordx4 v5, s[8:11], s51 offen lds
 s_add_u32 s51, s51, 32768
 s_mul_i32 s51, s68, 1048576
 s_add_u32 s51, s51, s55
 s_add_u32 m0, s57, 131072
 s_nop 0
 buffer_load_dwordx4 v4, s[8:11], s51 offen lds
 s_add_u32 s51, s51, 32768
 s_add_u32 m0, s57, 132096
 s_nop 0
 buffer_load_dwordx4 v5, s[8:11], s51 offen lds
 s_add_u32 s51, s51, 32768
 s_add_u32 m0, s57, 133120
 s_nop 0
 buffer_load_dwordx4 v4, s[8:11], s51 offen lds
 s_add_u32 s51, s51, 32768
 s_add_u32 m0, s57, 134144
 s_nop 0
 buffer_load_dwordx4 v5, s[8:11], s51 offen lds
 s_add_u32 s51, s51, 32768
 s_add_u32 m0, s57, 135168
 s_nop 0
 buffer_load_dwordx4 v4, s[8:11], s51 offen lds
 s_add_u32 s51, s51, 32768
 s_add_u32 m0, s57, 136192
 s_nop 0
 buffer_load_dwordx4 v5, s[8:11], s51 offen lds
 s_add_u32 s51, s51, 32768
 s_add_u32 m0, s57, 137216
 s_nop 0
 buffer_load_dwordx4 v4, s[8:11], s51 offen lds
 s_add_u32 s51, s51, 32768
 s_add_u32 m0, s57, 138240
 s_nop 0
 buffer_load_dwordx4 v5, s[8:11], s51 offen lds
 s_add_u32 s51, s51, 32768
 s_mov_b32 s96, s44
 s_and_b32 s97, s45, 0xffff
 s_mov_b32 s98, 256
 s_mov_b32 s99, 0x00020000
 buffer_load_dword v30, off, s[96:99], 0 offset:132 sc1
 v_lshrrev_b32 v2, 3, v0
 v_and_b32 v2, 4, v2
 v_bfe_u32 v3, v0, 2, 2
 v_or_b32 v2, v2, v3
 v_bfe_u32 v3, v0, 4, 1
 v_xor_b32 v3, v3, v2
 s_lshl_b32 s3, s50, 1
 v_xor_b32 v3, s3, v3
 v_lshlrev_b32 v2, 8, v2
 v_lshl_add_u32 v2, v3, 5, v2
 v_and_b32 v3, 3, v0
 v_lshl_add_u32 v2, v3, 3, v2
 s_waitcnt vmcnt(32)
 s_barrier
 ds_read_b64_tr_b16 a[0:1], v2 offset:0
 ds_read_b64_tr_b16 a[2:3], v2 offset:4096
 ds_read_b64_tr_b16 a[4:5], v2 offset:2048
 ds_read_b64_tr_b16 a[6:7], v2 offset:6144
 ds_read_b64_tr_b16 a[8:9], v2 offset:8192
 ds_read_b64_tr_b16 a[10:11], v2 offset:12288
 ds_read_b64_tr_b16 a[12:13], v2 offset:10240
 ds_read_b64_tr_b16 a[14:15], v2 offset:14336
 ds_read_b64_tr_b16 a[16:17], v2 offset:16384
 ds_read_b64_tr_b16 a[18:19], v2 offset:20480
 ds_read_b64_tr_b16 a[20:21], v2 offset:18432
 ds_read_b64_tr_b16 a[22:23], v2 offset:22528
 ds_read_b64_tr_b16 a[24:25], v2 offset:24576
 ds_read_b64_tr_b16 a[26:27], v2 offset:28672
 ds_read_b64_tr_b16 a[28:29], v2 offset:26624
 ds_read_b64_tr_b16 a[30:31], v2 offset:30720
 v_add_u32 v2, 0x8000, v2
 s_waitcnt vmcnt(24)
 s_barrier
 ds_read_b64_tr_b16 a[32:33], v2 offset:0
 ds_read_b64_tr_b16 a[34:35], v2 offset:4096
 ds_read_b64_tr_b16 a[36:37], v2 offset:2048
 ds_read_b64_tr_b16 a[38:39], v2 offset:6144
 ds_read_b64_tr_b16 a[40:41], v2 offset:8192
 ds_read_b64_tr_b16 a[42:43], v2 offset:12288
 ds_read_b64_tr_b16 a[44:45], v2 offset:10240
 ds_read_b64_tr_b16 a[46:47], v2 offset:14336
 ds_read_b64_tr_b16 a[48:49], v2 offset:16384
 ds_read_b64_tr_b16 a[50:51], v2 offset:20480
 ds_read_b64_tr_b16 a[52:53], v2 offset:18432
 ds_read_b64_tr_b16 a[54:55], v2 offset:22528
 ds_read_b64_tr_b16 a[56:57], v2 offset:24576
 ds_read_b64_tr_b16 a[58:59], v2 offset:28672
 ds_read_b64_tr_b16 a[60:61], v2 offset:26624
 ds_read_b64_tr_b16 a[62:63], v2 offset:30720
 v_add_u32 v2, 0x8000, v2
 s_waitcnt vmcnt(16)
 s_barrier
 ds_read_b64_tr_b16 a[64:65], v2 offset:0
 ds_read_b64_tr_b16 a[66:67], v2 offset:4096
 ds_read_b64_tr_b16 a[68:69], v2 offset:2048
 ds_read_b64_tr_b16 a[70:71], v2 offset:6144
 ds_read_b64_tr_b16 a[72:73], v2 offset:8192
 ds_read_b64_tr_b16 a[74:75], v2 offset:12288
 ds_read_b64_tr_b16 a[76:77], v2 offset:10240
 ds_read_b64_tr_b16 a[78:79], v2 offset:14336
 ds_read_b64_tr_b16 a[80:81], v2 offset:16384
 ds_read_b64_tr_b16 a[82:83], v2 offset:20480
 ds_read_b64_tr_b16 a[84:85], v2 offset:18432
 ds_read_b64_tr_b16 a[86:87], v2 offset:22528
 ds_read_b64_tr_b16 a[88:89], v2 offset:24576
 ds_read_b64_tr_b16 a[90:91], v2 offset:28672
 ds_read_b64_tr_b16 a[92:93], v2 offset:26624
 ds_read_b64_tr_b16 a[94:95], v2 offset:30720
 v_add_u32 v2, 0x8000, v2
 s_waitcnt vmcnt(8)
 s_barrier
 ds_read_b64_tr_b16 a[96:97], v2 offset:0
 ds_read_b64_tr_b16 a[98:99], v2 offset:4096
 ds_read_b64_tr_b16 a[100:101], v2 offset:2048
 ds_read_b64_tr_b16 a[102:103], v2 offset:6144
 ds_read_b64_tr_b16 a[104:105], v2 offset:8192
 ds_read_b64_tr_b16 a[106:107], v2 offset:12288
 ds_read_b64_tr_b16 a[108:109], v2 offset:10240
 ds_read_b64_tr_b16 a[110:111], v2 offset:14336
 ds_read_b64_tr_b16 a[112:113], v2 offset:16384
 ds_read_b64_tr_b16 a[114:115], v2 offset:20480
 ds_read_b64_tr_b16 a[116:117], v2 offset:18432
 ds_read_b64_tr_b16 a[118:119], v2 offset:22528
 ds_read_b64_tr_b16 a[120:121], v2 offset:24576
 ds_read_b64_tr_b16 a[122:123], v2 offset:28672
 ds_read_b64_tr_b16 a[124:125], v2 offset:26624
 ds_read_b64_tr_b16 a[126:127], v2 offset:30720
 v_add_u32 v2, 0x8000, v2
 s_waitcnt vmcnt(0)
 s_barrier
 ds_read_b64_tr_b16 a[128:129], v2 offset:0
 ds_read_b64_tr_b16 a[130:131], v2 offset:4096
 ds_read_b64_tr_b16 a[132:133], v2 offset:2048
 ds_read_b64_tr_b16 a[134:135], v2 offset:6144
 ds_read_b64_tr_b16 a[136:137], v2 offset:8192
 ds_read_b64_tr_b16 a[138:139], v2 offset:12288
 ds_read_b64_tr_b16 a[140:141], v2 offset:10240
 ds_read_b64_tr_b16 a[142:143], v2 offset:14336
 ds_read_b64_tr_b16 a[144:145], v2 offset:16384
 ds_read_b64_tr_b16 a[146:147], v2 offset:20480
 ds_read_b64_tr_b16 a[148:149], v2 offset:18432
 ds_read_b64_tr_b16 a[150:151], v2 offset:22528
 ds_read_b64_tr_b16 a[152:153], v2 offset:24576
 ds_read_b64_tr_b16 a[154:155], v2 offset:28672
 ds_read_b64_tr_b16 a[156:157], v2 offset:26624
 ds_read_b64_tr_b16 a[158:159], v2 offset:30720
 v_add_u32 v2, 0x8000, v2
 s_waitcnt lgkmcnt(0)
 s_barrier
 v_cmp_eq_u32 vcc, 0, v30
 s_cbranch_vccz L_qa_40
 s_mov_b32 s96, s44
 s_and_b32 s97, s45, 0xffff
 s_mov_b32 s98, 256
 s_mov_b32 s99, 0x00020000
 v_mov_b32 v1, 132
 s_mov_b32 s51, 0
 s_mov_b64 exec, 1
L_wb_41:
 buffer_load_dword v2, v1, s[96:99], 0 offen sc1
 s_waitcnt vmcnt(0)
 v_cmp_eq_u32 vcc, 0, v2
 s_cbranch_vccz L_wbd_42
 s_sleep 2
 s_add_u32 s51, s51, 1
 s_cmp_lt_u32 s51, 131072
 s_cbranch_scc1 L_wb_41
 s_branch L_bail
L_wbd_42:
 s_mov_b64 exec, -1
L_qa_40:
 s_lshl_b32 s64, s64, 8
 s_lshl_b32 s65, s65, 8
 s_lshl_b32 s66, s66, 8
 s_lshl_b32 s67, s67, 8
 s_lshl_b32 s68, s68, 8
 v_lshrrev_b32 v1, 4, v0
 s_mov_b32 s3, 1280
 v_mul_lo_u32 v1, v1, s3
 v_and_b32 v3, 15, v0
 v_lshl_add_u32 v1, v3, 4, v1
 v_add_u32 v6, 5120, v1
 v_mov_b32 v24, v6
 v_and_b32 v2, 31, v0
 v_lshlrev_b32 v2, 8, v2
 v_lshrrev_b32 v4, 5, v0
 v_xor_b32 v4, v4, v3
 v_xor_b32 v8, 0, v4
 v_lshl_add_u32 v8, v8, 4, v2
 v_add_u32 v16, 40960, v8
 v_xor_b32 v9, 2, v4
 v_lshl_add_u32 v9, v9, 4, v2
 v_add_u32 v17, 40960, v9
 v_xor_b32 v10, 4, v4
 v_lshl_add_u32 v10, v10, 4, v2
 v_add_u32 v18, 40960, v10
 v_xor_b32 v11, 6, v4
 v_lshl_add_u32 v11, v11, 4, v2
 v_add_u32 v19, 40960, v11
 v_xor_b32 v12, 8, v4
 v_lshl_add_u32 v12, v12, 4, v2
 v_add_u32 v20, 40960, v12
 v_xor_b32 v13, 10, v4
 v_lshl_add_u32 v13, v13, 4, v2
 v_add_u32 v21, 40960, v13
 v_xor_b32 v14, 12, v4
 v_lshl_add_u32 v14, v14, 4, v2
 v_add_u32 v22, 40960, v14
 v_xor_b32 v15, 14, v4
 v_lshl_add_u32 v15, v15, 4, v2
 v_add_u32 v23, 40960, v15
 v_lshrrev_b32 v4, 5, v0
 v_lshlrev_b32 v4, 8, v4
 v_lshl_add_u32 v4, v3, 4, v4
 v_and_b32 v2, 16, v0
 v_lshl_add_u32 v4, v2, 8, v4
 s_lshl_b32 s3, s50, 10
 v_add_u32 v4, s3, v4
 v_mul_u32_u24 v5, 49152, v0
 v_mov_b32 v7, 163776
 s_lshl_b32 s75, s62, 2
 s_add_u32 s75, s75, s50
 s_and_b32 s100, s52, 1
 s_lshl_b32 s100, s100, 13
 s_lshl_b32 s58, s52, 14
 s_add_u32 s58, s58, s100
 s_add_u32 s58, s58, 16777216
 s_cmp_eq_u32 s53, 0
 s_cselect_b32 s82, 8192, 0
 s_lshl_b32 s59, s52, 8
 s_add_u32 s59, s59, 16384
 s_lshl_b32 s56, s50, 11
 s_mov_b32 s54, 0
 s_mov_b32 s61, 0
 s_mov_b32 s70, s75
 s_mul_i32 s55, s54, 40960
 s_mul_i32 s3, s50, 10240
 s_add_u32 s55, s55, s3
 s_add_u32 s55, s55, 192937984
 s_add_u32 m0, s56, 0
 s_add_u32 s3, s55, s64
 buffer_load_dwordx4 v1, s[4:7], s3 offen sc1 lds
 s_add_u32 m0, s56, 1024
 s_add_u32 s3, s55, s64
 buffer_load_dwordx4 v24, s[4:7], s3 offen sc1 lds
 s_add_u32 m0, s56, 8192
 s_add_u32 s3, s55, s65
 buffer_load_dwordx4 v1, s[4:7], s3 offen sc1 lds
 s_add_u32 m0, s56, 9216
 s_add_u32 s3, s55, s65
 buffer_load_dwordx4 v24, s[4:7], s3 offen sc1 lds
 s_add_u32 m0, s56, 16384
 s_add_u32 s3, s55, s66
 buffer_load_dwordx4 v1, s[4:7], s3 offen sc1 lds
 s_add_u32 m0, s56, 17408
 s_add_u32 s3, s55, s66
 buffer_load_dwordx4 v24, s[4:7], s3 offen sc1 lds
 s_add_u32 m0, s56, 24576
 s_add_u32 s3, s55, s67
 buffer_load_dwordx4 v1, s[4:7], s3 offen sc1 lds
 s_add_u32 m0, s56, 25600
 s_add_u32 s3, s55, s67
 buffer_load_dwordx4 v24, s[4:7], s3 offen sc1 lds
 s_add_u32 m0, s56, 32768
 s_add_u32 s3, s55, s68
 buffer_load_dwordx4 v1, s[4:7], s3 offen sc1 lds
 s_add_u32 m0, s56, 33792
 s_add_u32 s3, s55, s68
 buffer_load_dwordx4 v24, s[4:7], s3 offen sc1 lds
 s_waitcnt vmcnt(0)
L_qkvq_pre:
 s_barrier
 s_mov_b32 s60, s54
 s_add_u32 s54, s54, 1
 s_mul_i32 s55, s54, 40960
 s_mul_i32 s3, s50, 10240
 s_add_u32 s55, s55, s3
 s_add_u32 s55, s55, 192937984
 ds_read_b128 v[32:35], v8 offset:0
 ds_read_b128 v[36:39], v9 offset:0
 ds_read_b128 v[40:43], v10 offset:0
 ds_read_b128 v[44:47], v11 offset:0
 s_waitcnt lgkmcnt(3)
 v_mfma_f32_32x32x16_bf16 v[64:79], a[0:3], v[32:35], 0
 ds_read_b128 v[48:51], v12 offset:0
 s_add_u32 m0, s56, 40960
 s_add_u32 s3, s55, s64
 buffer_load_dwordx4 v1, s[4:7], s3 offen sc1 lds
 s_waitcnt lgkmcnt(3)
 v_mfma_f32_32x32x16_bf16 v[64:79], a[4:7], v[36:39], v[64:79]
 ds_read_b128 v[52:55], v13 offset:0
 s_waitcnt lgkmcnt(3)
 v_mfma_f32_32x32x16_bf16 v[64:79], a[8:11], v[40:43], v[64:79]
 ds_read_b128 v[56:59], v14 offset:0
 s_waitcnt lgkmcnt(3)
 v_mfma_f32_32x32x16_bf16 v[64:79], a[12:15], v[44:47], v[64:79]
 ds_read_b128 v[60:63], v15 offset:0
 s_add_u32 m0, s56, 41984
 s_add_u32 s3, s55, s64
 buffer_load_dwordx4 v24, s[4:7], s3 offen sc1 lds
 s_waitcnt lgkmcnt(3)
 v_mfma_f32_32x32x16_bf16 v[64:79], a[16:19], v[48:51], v[64:79]
 ds_read_b128 v[32:35], v8 offset:8192
 s_waitcnt lgkmcnt(3)
 v_mfma_f32_32x32x16_bf16 v[64:79], a[20:23], v[52:55], v[64:79]
 ds_read_b128 v[36:39], v9 offset:8192
 s_waitcnt lgkmcnt(3)
 v_mfma_f32_32x32x16_bf16 v[64:79], a[24:27], v[56:59], v[64:79]
 ds_read_b128 v[40:43], v10 offset:8192
 s_add_u32 m0, s56, 49152
 s_add_u32 s3, s55, s65
 buffer_load_dwordx4 v1, s[4:7], s3 offen sc1 lds
 s_waitcnt lgkmcnt(3)
 v_mfma_f32_32x32x16_bf16 v[64:79], a[28:31], v[60:63], v[64:79]
 ds_read_b128 v[44:47], v11 offset:8192
 s_waitcnt lgkmcnt(3)
 v_mfma_f32_32x32x16_bf16 v[64:79], a[32:35], v[32:35], v[64:79]
 ds_read_b128 v[48:51], v12 offset:8192
 s_waitcnt lgkmcnt(3)
 v_mfma_f32_32x32x16_bf16 v[64:79], a[36:39], v[36:39], v[64:79]
 ds_read_b128 v[52:55], v13 offset:8192
 s_add_u32 m0, s56, 50176
 s_add_u32 s3, s55, s65
 buffer_load_dwordx4 v24, s[4:7], s3 offen sc1 lds
 s_waitcnt lgkmcnt(3)
 v_mfma_f32_32x32x16_bf16 v[64:79], a[40:43], v[40:43], v[64:79]
 ds_read_b128 v[56:59], v14 offset:8192
 s_waitcnt lgkmcnt(3)
 v_mfma_f32_32x32x16_bf16 v[64:79], a[44:47], v[44:47], v[64:79]
 ds_read_b128 v[60:63], v15 offset:8192
 s_waitcnt lgkmcnt(3)
 v_mfma_f32_32x32x16_bf16 v[64:79], a[48:51], v[48:51], v[64:79]
 ds_read_b128 v[32:35], v8 offset:16384
 s_add_u32 m0, s56, 57344
 s_add_u32 s3, s55, s66
 buffer_load_dwordx4 v1, s[4:7], s3 offen sc1 lds
 s_waitcnt lgkmcnt(3)
 v_mfma_f32_32x32x16_bf16 v[64:79], a[52:55], v[52:55], v[64:79]
 ds_read_b128 v[36:39], v9 offset:16384
 s_waitcnt lgkmcnt(3)
 v_mfma_f32_32x32x16_bf16 v[64:79], a[56:59], v[56:59], v[64:79]
 ds_read_b128 v[40:43], v10 offset:16384
 s_waitcnt lgkmcnt(3)
 v_mfma_f32_32x32x16_bf16 v[64:79], a[60:63], v[60:63], v[64:79]
 ds_read_b128 v[44:47], v11 offset:16384
 s_add_u32 m0, s56, 58368
 s_add_u32 s3, s55, s66
 buffer_load_dwordx4 v24, s[4:7], s3 offen sc1 lds
 s_waitcnt lgkmcnt(3)
 v_mfma_f32_32x32x16_bf16 v[64:79], a[64:67], v[32:35], v[64:79]
 ds_read_b128 v[48:51], v12 offset:16384
 s_waitcnt lgkmcnt(3)
 v_mfma_f32_32x32x16_bf16 v[64:79], a[68:71], v[36:39], v[64:79]
 ds_read_b128 v[52:55], v13 offset:16384
 s_waitcnt lgkmcnt(3)
 v_mfma_f32_32x32x16_bf16 v[64:79], a[72:75], v[40:43], v[64:79]
 ds_read_b128 v[56:59], v14 offset:16384
 s_add_u32 m0, s56, 65536
 s_add_u32 s3, s55, s67
 buffer_load_dwordx4 v1, s[4:7], s3 offen sc1 lds
 s_waitcnt lgkmcnt(3)
 v_mfma_f32_32x32x16_bf16 v[64:79], a[76:79], v[44:47], v[64:79]
 ds_read_b128 v[60:63], v15 offset:16384
 s_waitcnt vmcnt(7)
 s_cmp_eq_u32 s61, 0
 s_cbranch_scc1 L_pf_43
 s_lshl_b32 s3, s61, 2
 s_add_u32 s3, s3, s59
 s_sub_u32 s3, s3, 4
 v_mov_b32 v3, 1
 s_mov_b64 exec, 1
 buffer_atomic_add v3, v5, s[4:7], s3 offen
 s_mov_b64 exec, -1
 s_mov_b32 s61, 0
L_pf_43:
 s_waitcnt lgkmcnt(3)
 v_mfma_f32_32x32x16_bf16 v[64:79], a[80:83], v[48:51], v[64:79]
 ds_read_b128 v[32:35], v8 offset:24576
 s_waitcnt lgkmcnt(3)
 v_mfma_f32_32x32x16_bf16 v[64:79], a[84:87], v[52:55], v[64:79]
 ds_read_b128 v[36:39], v9 offset:24576
 s_add_u32 m0, s56, 66560
 s_add_u32 s3, s55, s67
 buffer_load_dwordx4 v24, s[4:7], s3 offen sc1 lds
 s_waitcnt lgkmcnt(3)
 v_mfma_f32_32x32x16_bf16 v[64:79], a[88:91], v[56:59], v[64:79]
 ds_read_b128 v[40:43], v10 offset:24576
 s_waitcnt lgkmcnt(3)
 v_mfma_f32_32x32x16_bf16 v[64:79], a[92:95], v[60:63], v[64:79]
 ds_read_b128 v[44:47], v11 offset:24576
 s_waitcnt lgkmcnt(3)
 v_mfma_f32_32x32x16_bf16 v[64:79], a[96:99], v[32:35], v[64:79]
 ds_read_b128 v[48:51], v12 offset:24576
 s_add_u32 m0, s56, 73728
 s_add_u32 s3, s55, s68
 buffer_load_dwordx4 v1, s[4:7], s3 offen sc1 lds
 s_waitcnt lgkmcnt(3)
 v_mfma_f32_32x32x16_bf16 v[64:79], a[100:103], v[36:39], v[64:79]
 ds_read_b128 v[52:55], v13 offset:24576
 s_waitcnt lgkmcnt(3)
 v_mfma_f32_32x32x16_bf16 v[64:79], a[104:107], v[40:43], v[64:79]
 ds_read_b128 v[56:59], v14 offset:24576
 s_waitcnt lgkmcnt(3)
 v_mfma_f32_32x32x16_bf16 v[64:79], a[108:111], v[44:47], v[64:79]
 ds_read_b128 v[60:63], v15 offset:24576
 s_add_u32 m0, s56, 74752
 s_add_u32 s3, s55, s68
 buffer_load_dwordx4 v24, s[4:7], s3 offen sc1 lds
 s_waitcnt lgkmcnt(3)
 v_mfma_f32_32x32x16_bf16 v[64:79], a[112:115], v[48:51], v[64:79]
 ds_read_b128 v[32:35], v8 offset:32768
 s_waitcnt lgkmcnt(3)
 v_mfma_f32_32x32x16_bf16 v[64:79], a[116:119], v[52:55], v[64:79]
 ds_read_b128 v[36:39], v9 offset:32768
 s_waitcnt lgkmcnt(3)
 v_mfma_f32_32x32x16_bf16 v[64:79], a[120:123], v[56:59], v[64:79]
 ds_read_b128 v[40:43], v10 offset:32768
 s_waitcnt lgkmcnt(3)
 v_mfma_f32_32x32x16_bf16 v[64:79], a[124:127], v[60:63], v[64:79]
 ds_read_b128 v[44:47], v11 offset:32768
 s_waitcnt lgkmcnt(3)
 v_mfma_f32_32x32x16_bf16 v[64:79], a[128:131], v[32:35], v[64:79]
 ds_read_b128 v[48:51], v12 offset:32768
 s_waitcnt lgkmcnt(3)
 v_mfma_f32_32x32x16_bf16 v[64:79], a[132:135], v[36:39], v[64:79]
 ds_read_b128 v[52:55], v13 offset:32768
 s_waitcnt lgkmcnt(3)
 v_mfma_f32_32x32x16_bf16 v[64:79], a[136:139], v[40:43], v[64:79]
 ds_read_b128 v[56:59], v14 offset:32768
 s_waitcnt lgkmcnt(3)
 v_mfma_f32_32x32x16_bf16 v[64:79], a[140:143], v[44:47], v[64:79]
 ds_read_b128 v[60:63], v15 offset:32768
 s_waitcnt lgkmcnt(3)
 v_mfma_f32_32x32x16_bf16 v[64:79], a[144:147], v[48:51], v[64:79]
 s_waitcnt lgkmcnt(2)
 v_mfma_f32_32x32x16_bf16 v[64:79], a[148:151], v[52:55], v[64:79]
 s_waitcnt lgkmcnt(1)
 v_mfma_f32_32x32x16_bf16 v[64:79], a[152:155], v[56:59], v[64:79]
 s_waitcnt lgkmcnt(0)
 v_mfma_f32_32x32x16_bf16 v[64:79], a[156:159], v[60:63], v[64:79]
 s_lshl_b32 s3, s60, 19
 s_add_u32 s3, s3, s58
 s_xor_b32 s3, s3, s82
 s_nop 8
 v_cvt_pk_bf16_f32 v80, v64, v65
 v_cvt_pk_bf16_f32 v81, v66, v67
 v_cvt_pk_bf16_f32 v82, v72, v73
 v_cvt_pk_bf16_f32 v83, v74, v75
 buffer_store_dwordx4 v[80:83], v4, s[4:7], s3 offen offset:0 sc1
 v_cvt_pk_bf16_f32 v84, v68, v69
 v_cvt_pk_bf16_f32 v85, v70, v71
 v_cvt_pk_bf16_f32 v86, v76, v77
 v_cvt_pk_bf16_f32 v87, v78, v79
 buffer_store_dwordx4 v[84:87], v4, s[4:7], s3 offen offset:512 sc1
 s_mov_b32 s61, s54
 s_cmp_lg_u32 s54, 1
 s_cbranch_scc1 L_f1_44
 s_waitcnt vmcnt(0)
 s_cmp_eq_u32 s61, 0
 s_cbranch_scc1 L_pf_45
 s_lshl_b32 s3, s61, 2
 s_add_u32 s3, s3, s59
 s_sub_u32 s3, s3, 4
 v_mov_b32 v3, 1
 s_mov_b64 exec, 1
 buffer_atomic_add v3, v5, s[4:7], s3 offen
 s_mov_b64 exec, -1
 s_mov_b32 s61, 0
L_pf_45:
 s_mov_b32 s8, s38
 s_and_b32 s9, s39, 0xffff
 s_mov_b32 s10, 2621440
 s_mov_b32 s11, 0x00020000
 s_mov_b32 s12, s40
 s_and_b32 s13, s41, 0xffff
 s_mov_b32 s14, 1280
 s_mov_b32 s15, 0x00020000
 v_lshlrev_b32 v130, 4, v0
 s_lshl_b32 s73, s70, 12
 s_add_u32 s74, s73, 2
 buffer_load_dwordx4 v[96:99], v130, s[8:11], s73 offen offset:0
 buffer_load_dwordx4 v[100:103], v130, s[8:11], s73 offen offset:1024
 buffer_load_dwordx4 v[112:115], v130, s[8:11], s74 offen offset:0
 buffer_load_dwordx4 v[116:119], v130, s[8:11], s74 offen offset:1024
 s_lshl_b32 s3, s70, 1
 buffer_load_ushort v128, off, s[12:15], s3
 s_branch L_f2_46
L_f1_44:
 s_waitcnt vmcnt(2)
L_f2_46:
 s_barrier
 s_mov_b32 s60, s54
 s_add_u32 s54, s54, 1
 s_mul_i32 s55, s54, 40960
 s_mul_i32 s3, s50, 10240
 s_add_u32 s55, s55, s3
 s_add_u32 s55, s55, 192937984
 ds_read_b128 v[32:35], v16 offset:0
 ds_read_b128 v[36:39], v17 offset:0
 ds_read_b128 v[40:43], v18 offset:0
 ds_read_b128 v[44:47], v19 offset:0
 s_waitcnt lgkmcnt(3)
 v_mfma_f32_32x32x16_bf16 v[64:79], a[0:3], v[32:35], 0
 ds_read_b128 v[48:51], v20 offset:0
 s_add_u32 m0, s56, 0
 s_add_u32 s3, s55, s64
 buffer_load_dwordx4 v1, s[4:7], s3 offen sc1 lds
 s_waitcnt lgkmcnt(3)
 v_mfma_f32_32x32x16_bf16 v[64:79], a[4:7], v[36:39], v[64:79]
 ds_read_b128 v[52:55], v21 offset:0
 s_waitcnt lgkmcnt(3)
 v_mfma_f32_32x32x16_bf16 v[64:79], a[8:11], v[40:43], v[64:79]
 ds_read_b128 v[56:59], v22 offset:0
 s_waitcnt lgkmcnt(3)
 v_mfma_f32_32x32x16_bf16 v[64:79], a[12:15], v[44:47], v[64:79]
 ds_read_b128 v[60:63], v23 offset:0
 s_add_u32 m0, s56, 1024
 s_add_u32 s3, s55, s64
 buffer_load_dwordx4 v24, s[4:7], s3 offen sc1 lds
 s_waitcnt lgkmcnt(3)
 v_mfma_f32_32x32x16_bf16 v[64:79], a[16:19], v[48:51], v[64:79]
 ds_read_b128 v[32:35], v16 offset:8192
 s_waitcnt lgkmcnt(3)
 v_mfma_f32_32x32x16_bf16 v[64:79], a[20:23], v[52:55], v[64:79]
 ds_read_b128 v[36:39], v17 offset:8192
 s_waitcnt lgkmcnt(3)
 v_mfma_f32_32x32x16_bf16 v[64:79], a[24:27], v[56:59], v[64:79]
 ds_read_b128 v[40:43], v18 offset:8192
 s_add_u32 m0, s56, 8192
 s_add_u32 s3, s55, s65
 buffer_load_dwordx4 v1, s[4:7], s3 offen sc1 lds
 s_waitcnt lgkmcnt(3)
 v_mfma_f32_32x32x16_bf16 v[64:79], a[28:31], v[60:63], v[64:79]
 ds_read_b128 v[44:47], v19 offset:8192
 s_waitcnt lgkmcnt(3)
 v_mfma_f32_32x32x16_bf16 v[64:79], a[32:35], v[32:35], v[64:79]
 ds_read_b128 v[48:51], v20 offset:8192
 s_waitcnt lgkmcnt(3)
 v_mfma_f32_32x32x16_bf16 v[64:79], a[36:39], v[36:39], v[64:79]
 ds_read_b128 v[52:55], v21 offset:8192
 s_add_u32 m0, s56, 9216
 s_add_u32 s3, s55, s65
 buffer_load_dwordx4 v24, s[4:7], s3 offen sc1 lds
 s_waitcnt lgkmcnt(3)
 v_mfma_f32_32x32x16_bf16 v[64:79], a[40:43], v[40:43], v[64:79]
 ds_read_b128 v[56:59], v22 offset:8192
 s_waitcnt lgkmcnt(3)
 v_mfma_f32_32x32x16_bf16 v[64:79], a[44:47], v[44:47], v[64:79]
 ds_read_b128 v[60:63], v23 offset:8192
 s_waitcnt lgkmcnt(3)
 v_mfma_f32_32x32x16_bf16 v[64:79], a[48:51], v[48:51], v[64:79]
 ds_read_b128 v[32:35], v16 offset:16384
 s_add_u32 m0, s56, 16384
 s_add_u32 s3, s55, s66
 buffer_load_dwordx4 v1, s[4:7], s3 offen sc1 lds
 s_waitcnt lgkmcnt(3)
 v_mfma_f32_32x32x16_bf16 v[64:79], a[52:55], v[52:55], v[64:79]
 ds_read_b128 v[36:39], v17 offset:16384
 s_waitcnt lgkmcnt(3)
 v_mfma_f32_32x32x16_bf16 v[64:79], a[56:59], v[56:59], v[64:79]
 ds_read_b128 v[40:43], v18 offset:16384
 s_waitcnt lgkmcnt(3)
 v_mfma_f32_32x32x16_bf16 v[64:79], a[60:63], v[60:63], v[64:79]
 ds_read_b128 v[44:47], v19 offset:16384
 s_add_u32 m0, s56, 17408
 s_add_u32 s3, s55, s66
 buffer_load_dwordx4 v24, s[4:7], s3 offen sc1 lds
 s_waitcnt lgkmcnt(3)
 v_mfma_f32_32x32x16_bf16 v[64:79], a[64:67], v[32:35], v[64:79]
 ds_read_b128 v[48:51], v20 offset:16384
 s_waitcnt lgkmcnt(3)
 v_mfma_f32_32x32x16_bf16 v[64:79], a[68:71], v[36:39], v[64:79]
 ds_read_b128 v[52:55], v21 offset:16384
 s_waitcnt lgkmcnt(3)
 v_mfma_f32_32x32x16_bf16 v[64:79], a[72:75], v[40:43], v[64:79]
 ds_read_b128 v[56:59], v22 offset:16384
 s_add_u32 m0, s56, 24576
 s_add_u32 s3, s55, s67
 buffer_load_dwordx4 v1, s[4:7], s3 offen sc1 lds
 s_waitcnt lgkmcnt(3)
 v_mfma_f32_32x32x16_bf16 v[64:79], a[76:79], v[44:47], v[64:79]
 ds_read_b128 v[60:63], v23 offset:16384
 s_waitcnt vmcnt(7)
 s_cmp_eq_u32 s61, 0
 s_cbranch_scc1 L_pf_47
 s_lshl_b32 s3, s61, 2
 s_add_u32 s3, s3, s59
 s_sub_u32 s3, s3, 4
 v_mov_b32 v3, 1
 s_mov_b64 exec, 1
 buffer_atomic_add v3, v5, s[4:7], s3 offen
 s_mov_b64 exec, -1
 s_mov_b32 s61, 0
L_pf_47:
 s_waitcnt lgkmcnt(3)
 v_mfma_f32_32x32x16_bf16 v[64:79], a[80:83], v[48:51], v[64:79]
 ds_read_b128 v[32:35], v16 offset:24576
 s_waitcnt lgkmcnt(3)
 v_mfma_f32_32x32x16_bf16 v[64:79], a[84:87], v[52:55], v[64:79]
 ds_read_b128 v[36:39], v17 offset:24576
 s_add_u32 m0, s56, 25600
 s_add_u32 s3, s55, s67
 buffer_load_dwordx4 v24, s[4:7], s3 offen sc1 lds
 s_waitcnt lgkmcnt(3)
 v_mfma_f32_32x32x16_bf16 v[64:79], a[88:91], v[56:59], v[64:79]
 ds_read_b128 v[40:43], v18 offset:24576
 s_waitcnt lgkmcnt(3)
 v_mfma_f32_32x32x16_bf16 v[64:79], a[92:95], v[60:63], v[64:79]
 ds_read_b128 v[44:47], v19 offset:24576
 s_waitcnt lgkmcnt(3)
 v_mfma_f32_32x32x16_bf16 v[64:79], a[96:99], v[32:35], v[64:79]
 ds_read_b128 v[48:51], v20 offset:24576
 s_add_u32 m0, s56, 32768
 s_add_u32 s3, s55, s68
 buffer_load_dwordx4 v1, s[4:7], s3 offen sc1 lds
 s_waitcnt lgkmcnt(3)
 v_mfma_f32_32x32x16_bf16 v[64:79], a[100:103], v[36:39], v[64:79]
 ds_read_b128 v[52:55], v21 offset:24576
 s_waitcnt lgkmcnt(3)
 v_mfma_f32_32x32x16_bf16 v[64:79], a[104:107], v[40:43], v[64:79]
 ds_read_b128 v[56:59], v22 offset:24576
 s_waitcnt lgkmcnt(3)
 v_mfma_f32_32x32x16_bf16 v[64:79], a[108:111], v[44:47], v[64:79]
 ds_read_b128 v[60:63], v23 offset:24576
 s_add_u32 m0, s56, 33792
 s_add_u32 s3, s55, s68
 buffer_load_dwordx4 v24, s[4:7], s3 offen sc1 lds
 s_waitcnt lgkmcnt(3)
 v_mfma_f32_32x32x16_bf16 v[64:79], a[112:115], v[48:51], v[64:79]
 ds_read_b128 v[32:35], v16 offset:32768
 s_waitcnt lgkmcnt(3)
 v_mfma_f32_32x32x16_bf16 v[64:79], a[116:119], v[52:55], v[64:79]
 ds_read_b128 v[36:39], v17 offset:32768
 s_waitcnt lgkmcnt(3)
 v_mfma_f32_32x32x16_bf16 v[64:79], a[120:123], v[56:59], v[64:79]
 ds_read_b128 v[40:43], v18 offset:32768
 s_waitcnt lgkmcnt(3)
 v_mfma_f32_32x32x16_bf16 v[64:79], a[124:127], v[60:63], v[64:79]
 ds_read_b128 v[44:47], v19 offset:32768
 s_waitcnt lgkmcnt(3)
 v_mfma_f32_32x32x16_bf16 v[64:79], a[128:131], v[32:35], v[64:79]
 ds_read_b128 v[48:51], v20 offset:32768
 s_waitcnt lgkmcnt(3)
 v_mfma_f32_32x32x16_bf16 v[64:79], a[132:135], v[36:39], v[64:79]
 ds_read_b128 v[52:55], v21 offset:32768
 s_waitcnt lgkmcnt(3)
 v_mfma_f32_32x32x16_bf16 v[64:79], a[136:139], v[40:43], v[64:79]
 ds_read_b128 v[56:59], v22 offset:32768
 s_waitcnt lgkmcnt(3)
 v_mfma_f32_32x32x16_bf16 v[64:79], a[140:143], v[44:47], v[64:79]
 ds_read_b128 v[60:63], v23 offset:32768
 s_waitcnt lgkmcnt(3)
 v_mfma_f32_32x32x16_bf16 v[64:79], a[144:147], v[48:51], v[64:79]
 s_waitcnt lgkmcnt(2)
 v_mfma_f32_32x32x16_bf16 v[64:79], a[148:151], v[52:55], v[64:79]
 s_waitcnt lgkmcnt(1)
 v_mfma_f32_32x32x16_bf16 v[64:79], a[152:155], v[56:59], v[64:79]
 s_waitcnt lgkmcnt(0)
 v_mfma_f32_32x32x16_bf16 v[64:79], a[156:159], v[60:63], v[64:79]
 s_lshl_b32 s3, s60, 19
 s_add_u32 s3, s3, s58
 s_xor_b32 s3, s3, s82
 s_nop 8
 v_cvt_pk_bf16_f32 v88, v64, v65
 v_cvt_pk_bf16_f32 v89, v66, v67
 v_cvt_pk_bf16_f32 v90, v72, v73
 v_cvt_pk_bf16_f32 v91, v74, v75
 buffer_store_dwordx4 v[88:91], v4, s[4:7], s3 offen offset:0 sc1
 v_cvt_pk_bf16_f32 v92, v68, v69
 v_cvt_pk_bf16_f32 v93, v70, v71
 v_cvt_pk_bf16_f32 v94, v76, v77
 v_cvt_pk_bf16_f32 v95, v78, v79
 buffer_store_dwordx4 v[92:95], v4, s[4:7], s3 offen offset:512 sc1
 s_mov_b32 s61, s54
 s_waitcnt vmcnt(2)
 s_cmp_lg_u32 s54, 4
 s_cbranch_scc1 L_cv_48
 s_waitcnt vmcnt(0)
 s_cmp_eq_u32 s61, 0
 s_cbranch_scc1 L_pf_49
 s_lshl_b32 s3, s61, 2
 s_add_u32 s3, s3, s59
 s_sub_u32 s3, s3, 4
 v_mov_b32 v3, 1
 s_mov_b64 exec, 1
 buffer_atomic_add v3, v5, s[4:7], s3 offen
 s_mov_b64 exec, -1
 s_mov_b32 s61, 0
L_pf_49:
 s_mul_i32 s71, s50, 13312
 s_add_u32 s71, s71, 81920
 s_mov_b32 s70, s75
 s_mov_b32 s69, 640
 s_getpc_b64 s[76:77]
L_ca_50:
 s_add_u32 s76, s76, L_conv0-L_ca_50
 s_addc_u32 s77, s77, -1
 s_swappc_b64 s[76:77], s[76:77]
 s_waitcnt vmcnt(0)
 s_barrier
 s_cmp_lg_u32 s50, 3
 s_cbranch_scc1 L_ar_51
 s_mov_b32 s96, s44
 s_and_b32 s97, s45, 0xffff
 s_mov_b32 s98, 256
 s_mov_b32 s99, 0x00020000
 v_mov_b32 v1, 1
 s_mov_b64 exec, 1
 buffer_atomic_add v1, off, s[96:99], 0 offset:8 sc0
 s_waitcnt vmcnt(0)
 v_cmp_eq_u32 vcc, 159, v1
 s_cbranch_vccz L_aw_52
 buffer_store_dword v1, off, s[96:99], 0 offset:136 sc1
L_aw_52:
 s_mov_b64 exec, -1
L_ar_51:
 s_cmp_lg_u32 s50, 0
 s_cbranch_scc1 L_ww_53
 s_mov_b32 s96, s44
 s_and_b32 s97, s45, 0xffff
 s_mov_b32 s98, 256
 s_mov_b32 s99, 0x00020000
 v_mov_b32 v24, 208
 s_mov_b32 s51, 0
 s_mov_b64 exec, 1
L_wb_54:
 buffer_load_dword v25, v24, s[96:99], 0 offen sc1
 s_waitcnt vmcnt(0)
 v_cmp_eq_u32 vcc, 0, v25
 s_cbranch_vccz L_wbd_55
 s_sleep 2
 s_add_u32 s51, s51, 1
 s_cmp_lt_u32 s51, 131072
 s_cbranch_scc1 L_wb_54
 s_branch L_bail
L_wbd_55:
 s_mov_b64 exec, -1
L_ww_53:
 s_barrier
 s_mov_b32 s70, s75
 s_mov_b32 s8, s38
 s_and_b32 s9, s39, 0xffff
 s_mov_b32 s10, 2621440
 s_mov_b32 s11, 0x00020000
 s_mov_b32 s12, s40
 s_and_b32 s13, s41, 0xffff
 s_mov_b32 s14, 1280
 s_mov_b32 s15, 0x00020000
 v_lshlrev_b32 v130, 4, v0
 s_lshl_b32 s73, s70, 12
 s_add_u32 s74, s73, 2
 buffer_load_dwordx4 v[96:99], v130, s[8:11], s73 offen offset:0
 buffer_load_dwordx4 v[100:103], v130, s[8:11], s73 offen offset:1024
 buffer_load_dwordx4 v[104:107], v130, s[8:11], s73 offen offset:2048
 buffer_load_dwordx4 v[108:111], v130, s[8:11], s73 offen offset:3072
 buffer_load_dwordx4 v[112:115], v130, s[8:11], s74 offen offset:0
 buffer_load_dwordx4 v[116:119], v130, s[8:11], s74 offen offset:1024
 buffer_load_dwordx4 v[120:123], v130, s[8:11], s74 offen offset:2048
 buffer_load_dwordx4 v[124:127], v130, s[8:11], s74 offen offset:3072
 s_lshl_b32 s3, s70, 1
 buffer_load_ushort v128, off, s[12:15], s3
 s_lshl_b32 s3, s70, 12
 s_add_u32 s3, s3, 198180864
 buffer_load_dwordx4 v[240:243], v130, s[4:7], s3 offen offset:0 sc1
 buffer_load_dwordx4 v[244:247], v130, s[4:7], s3 offen offset:1024 sc1
 buffer_load_dwordx4 v[248:251], v130, s[4:7], s3 offen offset:2048 sc1
 buffer_load_dwordx4 v[252:255], v130, s[4:7], s3 offen offset:3072 sc1
 v_lshrrev_b32 v1, 4, v0
 s_mov_b32 s3, 1280
 v_mul_lo_u32 v1, v1, s3
 v_and_b32 v3, 15, v0
 v_lshl_add_u32 v1, v3, 4, v1
 v_add_u32 v6, 5120, v1
 v_mov_b32 v24, v6
 v_and_b32 v2, 31, v0
 v_lshlrev_b32 v2, 8, v2
 v_lshrrev_b32 v4, 5, v0
 v_xor_b32 v4, v4, v3
 v_xor_b32 v8, 0, v4
 v_lshl_add_u32 v8, v8, 4, v2
 v_add_u32 v16, 40960, v8
 v_xor_b32 v9, 2, v4
 v_lshl_add_u32 v9, v9, 4, v2
 v_add_u32 v17, 40960, v9
 v_xor_b32 v10, 4, v4
 v_lshl_add_u32 v10, v10, 4, v2
 v_add_u32 v18, 40960, v10
 v_xor_b32 v11, 6, v4
 v_lshl_add_u32 v11, v11, 4, v2
 v_add_u32 v19, 40960, v11
 v_xor_b32 v12, 8, v4
 v_lshl_add_u32 v12, v12, 4, v2
 v_add_u32 v20, 40960, v12
 v_xor_b32 v13, 10, v4
 v_lshl_add_u32 v13, v13, 4, v2
 v_add_u32 v21, 40960, v13
 v_xor_b32 v14, 12, v4
 v_lshl_add_u32 v14, v14, 4, v2
 v_add_u32 v22, 40960, v14
 v_xor_b32 v15, 14, v4
 v_lshl_add_u32 v15, v15, 4, v2
 v_add_u32 v23, 40960, v15
 v_lshrrev_b32 v4, 5, v0
 v_lshlrev_b32 v4, 8, v4
 v_lshl_add_u32 v4, v3, 4, v4
 v_and_b32 v2, 16, v0
 v_lshl_add_u32 v4, v2, 8, v4
 s_lshl_b32 s3, s50, 10
 v_add_u32 v4, s3, v4
 v_mul_u32_u24 v5, 49152, v0
 v_mov_b32 v7, 163776
L_cv_48:
 s_cmp_lt_u32 s54, 10
 s_cbranch_scc1 L_qkvq_pre
 s_waitcnt vmcnt(0)
 s_cmp_eq_u32 s61, 0
 s_cbranch_scc1 L_pf_56
 s_lshl_b32 s3, s61, 2
 s_add_u32 s3, s3, s59
 s_sub_u32 s3, s3, 4
 v_mov_b32 v3, 1
 s_mov_b64 exec, 1
 buffer_atomic_add v3, v5, s[4:7], s3 offen
 s_mov_b64 exec, -1
 s_mov_b32 s61, 0
L_pf_56:
 s_mul_i32 s71, s50, 13312
 s_add_u32 s71, s71, 81920
 s_mov_b32 s70, s75
 s_mov_b32 s69, 640
 s_getpc_b64 s[76:77]
L_ca_57:
 s_add_u32 s76, s76, L_conv1-L_ca_57
 s_addc_u32 s77, s77, -1
 s_swappc_b64 s[76:77], s[76:77]
 s_waitcnt vmcnt(0)
 s_barrier
 s_cmp_lg_u32 s50, 3
 s_cbranch_scc1 L_ar_58
 s_mov_b32 s96, s44
 s_and_b32 s97, s45, 0xffff
 s_mov_b32 s98, 256
 s_mov_b32 s99, 0x00020000
 v_mov_b32 v1, 1
 s_mov_b64 exec, 1
 buffer_atomic_add v1, off, s[96:99], 0 offset:76 sc0
 s_waitcnt vmcnt(0)
 v_cmp_eq_u32 vcc, 127, v1
 s_cbranch_vccz L_aw_59
 buffer_store_dword v1, off, s[96:99], 0 offset:204 sc1
L_aw_59:
 s_mov_b64 exec, -1
L_ar_58:
 v_lshrrev_b32 v1, 4, v0
 s_mov_b32 s3, 1280
 v_mul_lo_u32 v1, v1, s3
 v_and_b32 v3, 15, v0
 v_lshl_add_u32 v1, v3, 4, v1
 v_add_u32 v6, 5120, v1
 v_mov_b32 v24, v6
 v_and_b32 v2, 31, v0
 v_lshlrev_b32 v2, 8, v2
 v_lshrrev_b32 v4, 5, v0
 v_xor_b32 v4, v4, v3
 v_xor_b32 v8, 0, v4
 v_lshl_add_u32 v8, v8, 4, v2
 v_add_u32 v16, 40960, v8
 v_xor_b32 v9, 2, v4
 v_lshl_add_u32 v9, v9, 4, v2
 v_add_u32 v17, 40960, v9
 v_xor_b32 v10, 4, v4
 v_lshl_add_u32 v10, v10, 4, v2
 v_add_u32 v18, 40960, v10
 v_xor_b32 v11, 6, v4
 v_lshl_add_u32 v11, v11, 4, v2
 v_add_u32 v19, 40960, v11
 v_xor_b32 v12, 8, v4
 v_lshl_add_u32 v12, v12, 4, v2
 v_add_u32 v20, 40960, v12
 v_xor_b32 v13, 10, v4
 v_lshl_add_u32 v13, v13, 4, v2
 v_add_u32 v21, 40960, v13
 v_xor_b32 v14, 12, v4
 v_lshl_add_u32 v14, v14, 4, v2
 v_add_u32 v22, 40960, v14
 v_xor_b32 v15, 14, v4
 v_lshl_add_u32 v15, v15, 4, v2
 v_add_u32 v23, 40960, v15
 v_lshrrev_b32 v4, 5, v0
 v_lshlrev_b32 v4, 8, v4
 v_lshl_add_u32 v4, v3, 4, v4
 v_and_b32 v2, 16, v0
 v_lshl_add_u32 v4, v2, 8, v4
 s_lshl_b32 s3, s50, 10
 v_add_u32 v4, s3, v4
 v_mul_u32_u24 v5, 49152, v0
 v_mov_b32 v7, 163776
 s_cmp_lg_u32 s50, 0
 s_cbranch_scc1 L_ww_60
 s_mov_b32 s96, s44
 s_and_b32 s97, s45, 0xffff
 s_mov_b32 s98, 256
 s_mov_b32 s99, 0x00020000
 v_mov_b32 v25, 200
 s_mov_b32 s51, 0
 s_mov_b64 exec, 1
L_wb_61:
 buffer_load_dword v26, v25, s[96:99], 0 offen sc1
 s_waitcnt vmcnt(0)
 v_cmp_eq_u32 vcc, 0, v26
 s_cbranch_vccz L_wbd_62
 s_sleep 2
 s_add_u32 s51, s51, 1
 s_cmp_lt_u32 s51, 131072
 s_cbranch_scc1 L_wb_61
 s_branch L_bail
L_wbd_62:
 s_mov_b64 exec, -1
L_ww_60:
 s_barrier
 s_mov_b32 s96, s44
 s_and_b32 s97, s45, 0xffff
 s_mov_b32 s98, 256
 s_mov_b32 s99, 0x00020000
 v_mov_b32 v25, 132
 s_mov_b32 s3, 144
 v_writelane_b32 v25, s3, 1
 s_mov_b32 s51, 0
 s_mov_b64 exec, 3
L_wb_63:
 buffer_load_dword v26, v25, s[96:99], 0 offen sc1
 s_waitcnt vmcnt(0)
 v_cmp_eq_u32 vcc, 0, v26
 s_cbranch_vccz L_wbd_64
 s_sleep 2
 s_add_u32 s51, s51, 1
 s_cmp_lt_u32 s51, 131072
 s_cbranch_scc1 L_wb_63
 s_branch L_bail
L_wbd_64:
 s_mov_b64 exec, -1
 v_readlane_b32 s81, v26, 1
 s_nop 3
 s_sub_u32 s81, s81, 1
 s_xor_b32 s78, s81, 0
 s_lshl_b32 s78, s78, 13
 s_xor_b32 s79, s78, 8192
 s_cmp_lt_u32 s62, 96
 s_cselect_b32 s3, s79, s78
 s_lshl_b32 s62, s62, 8
 s_lshr_b32 s100, s62, 13
 s_lshl_b32 s100, s100, 13
 s_add_u32 s62, s62, s100
 s_add_u32 s62, s62, s3
 s_add_u32 s62, s62, 229376
 s_add_u32 s63, s59, s78
 s_add_u32 s63, s63, 16344
 s_mov_b32 s72, 0
L_qkvq_block:
 s_lshl_b32 s55, s54, 2
 s_add_u32 s55, s55, s62
 s_sub_u32 s55, s55, 40
 s_cmp_lg_u32 s50, 0
 s_cselect_b32 s3, 268435456, s55
 v_mov_b32 v6, 8
 s_mov_b64 exec, 15
 v_mov_b32 v6, 0
 buffer_atomic_add v6, v5, s[4:7], s3 offen sc0
 s_mov_b64 exec, -1
 s_waitcnt vmcnt(0)
 s_cmp_eq_u32 s61, 0
 s_cbranch_scc1 L_pf_67
 s_lshl_b32 s3, s61, 2
 s_add_u32 s3, s3, s59
 s_sub_u32 s3, s3, 4
 v_mov_b32 v3, 1
 s_mov_b64 exec, 1
 buffer_atomic_add v3, v5, s[4:7], s3 offen
 s_mov_b64 exec, -1
 s_mov_b32 s61, 0
L_pf_67:
 s_cmp_lg_u32 s50, 0
 s_cbranch_scc1 L_w_65
 v_cmp_gt_u32 vcc, 8, v6
 s_cbranch_vccz L_w_65
 s_mov_b32 s51, 0
 s_mov_b64 exec, 15
 v_mov_b32 v28, 0
 buffer_atomic_add v28, v5, s[4:7], s55 offen sc0
 s_sleep 5
L_wc_68:
 v_mov_b32 v29, 0
 buffer_atomic_add v29, v5, s[4:7], s55 offen sc0
 s_waitcnt vmcnt(1)
 v_cmp_gt_u32 vcc, 8, v28
 s_cbranch_vccz L_wcd_69
 v_mov_b32 v28, 0
 buffer_atomic_add v28, v5, s[4:7], s55 offen sc0
 s_waitcnt vmcnt(1)
 v_cmp_gt_u32 vcc, 8, v29
 s_cbranch_vccz L_wcd_69
 s_add_u32 s51, s51, 1
 s_cmp_lt_u32 s51, 131072
 s_cbranch_scc1 L_wc_68
 s_branch L_bail
L_wcd_69:
 s_mov_b64 exec, -1
L_w_65:
 s_barrier
L_qkvq_loop:
 s_cmp_lg_u32 s54, 17
 s_cbranch_scc1 L_c2_70
 s_cmp_lg_u32 s50, 0
 s_cbranch_scc1 L_ww_71
 s_mov_b32 s96, s44
 s_and_b32 s97, s45, 0xffff
 s_mov_b32 s98, 256
 s_mov_b32 s99, 0x00020000
 v_mov_b32 v25, 140
 s_mov_b32 s51, 0
 s_mov_b64 exec, 1
L_wb_72:
 buffer_load_dword v26, v25, s[96:99], 0 offen sc1
 s_waitcnt vmcnt(0)
 v_cmp_eq_u32 vcc, 0, v26
 s_cbranch_vccz L_wbd_73
 s_sleep 2
 s_add_u32 s51, s51, 1
 s_cmp_lt_u32 s51, 131072
 s_cbranch_scc1 L_wb_72
 s_branch L_bail
L_wbd_73:
 s_mov_b64 exec, -1
L_ww_71:
 s_barrier
L_c2_70:
 s_sub_u32 s60, s54, 10
 s_cmp_lg_u32 s72, 0
 s_cbranch_scc1 L_hv_74
 s_mul_i32 s55, s60, 40960
 s_mul_i32 s3, s50, 10240
 s_add_u32 s55, s55, s3
 s_add_u32 s55, s55, 195559424
 s_add_u32 m0, s56, 40960
 s_add_u32 s3, s55, s64
 buffer_load_dwordx4 v1, s[4:7], s3 offen sc1 lds
 s_add_u32 m0, s56, 41984
 s_add_u32 s3, s55, s64
 buffer_load_dwordx4 v24, s[4:7], s3 offen sc1 lds
 s_add_u32 m0, s56, 49152
 s_add_u32 s3, s55, s65
 buffer_load_dwordx4 v1, s[4:7], s3 offen sc1 lds
 s_add_u32 m0, s56, 50176
 s_add_u32 s3, s55, s65
 buffer_load_dwordx4 v24, s[4:7], s3 offen sc1 lds
 s_add_u32 m0, s56, 57344
 s_add_u32 s3, s55, s66
 buffer_load_dwordx4 v1, s[4:7], s3 offen sc1 lds
 s_add_u32 m0, s56, 58368
 s_add_u32 s3, s55, s66
 buffer_load_dwordx4 v24, s[4:7], s3 offen sc1 lds
 s_add_u32 m0, s56, 65536
 s_add_u32 s3, s55, s67
 buffer_load_dwordx4 v1, s[4:7], s3 offen sc1 lds
 s_add_u32 m0, s56, 66560
 s_add_u32 s3, s55, s67
 buffer_load_dwordx4 v24, s[4:7], s3 offen sc1 lds
 s_add_u32 m0, s56, 73728
 s_add_u32 s3, s55, s68
 buffer_load_dwordx4 v1, s[4:7], s3 offen sc1 lds
 s_add_u32 m0, s56, 74752
 s_add_u32 s3, s55, s68
 buffer_load_dwordx4 v24, s[4:7], s3 offen sc1 lds
L_hv_74:
 s_mov_b32 s72, 0
 s_min_u32 s51, s54, 63
 s_mul_i32 s55, s51, 40960
 s_mul_i32 s3, s50, 10240
 s_add_u32 s55, s55, s3
 s_add_u32 s55, s55, 192937984
 s_waitcnt vmcnt(8)
 s_barrier
 ds_read_b128 v[32:35], v16 offset:0
 ds_read_b128 v[36:39], v17 offset:0
 ds_read_b128 v[40:43], v18 offset:0
 ds_read_b128 v[44:47], v19 offset:0
 s_waitcnt lgkmcnt(3)
 v_mfma_f32_32x32x16_bf16 v[64:79], a[0:3], v[32:35], 0
 ds_read_b128 v[48:51], v20 offset:0
 s_add_u32 m0, s56, 0
 s_add_u32 s3, s55, s64
 buffer_load_dwordx4 v1, s[4:7], s3 offen sc1 lds
 s_waitcnt lgkmcnt(3)
 v_mfma_f32_32x32x16_bf16 v[64:79], a[4:7], v[36:39], v[64:79]
 ds_read_b128 v[52:55], v21 offset:0
 s_waitcnt lgkmcnt(3)
 v_mfma_f32_32x32x16_bf16 v[64:79], a[8:11], v[40:43], v[64:79]
 ds_read_b128 v[56:59], v22 offset:0
 s_waitcnt lgkmcnt(3)
 v_mfma_f32_32x32x16_bf16 v[64:79], a[12:15], v[44:47], v[64:79]
 ds_read_b128 v[60:63], v23 offset:0
 s_add_u32 m0, s56, 1024
 s_add_u32 s3, s55, s64
 buffer_load_dwordx4 v24, s[4:7], s3 offen sc1 lds
 s_waitcnt lgkmcnt(3)
 v_mfma_f32_32x32x16_bf16 v[64:79], a[16:19], v[48:51], v[64:79]
 s_waitcnt vmcnt(8)
 s_barrier
 ds_read_b128 v[32:35], v16 offset:8192
 s_waitcnt lgkmcnt(3)
 v_mfma_f32_32x32x16_bf16 v[64:79], a[20:23], v[52:55], v[64:79]
 ds_read_b128 v[36:39], v17 offset:8192
 s_waitcnt lgkmcnt(3)
 v_mfma_f32_32x32x16_bf16 v[64:79], a[24:27], v[56:59], v[64:79]
 ds_read_b128 v[40:43], v18 offset:8192
 s_add_u32 m0, s56, 8192
 s_add_u32 s3, s55, s65
 buffer_load_dwordx4 v1, s[4:7], s3 offen sc1 lds
 s_waitcnt lgkmcnt(3)
 v_mfma_f32_32x32x16_bf16 v[64:79], a[28:31], v[60:63], v[64:79]
 ds_read_b128 v[44:47], v19 offset:8192
 s_waitcnt lgkmcnt(3)
 v_mfma_f32_32x32x16_bf16 v[64:79], a[32:35], v[32:35], v[64:79]
 ds_read_b128 v[48:51], v20 offset:8192
 s_waitcnt lgkmcnt(3)
 v_mfma_f32_32x32x16_bf16 v[64:79], a[36:39], v[36:39], v[64:79]
 ds_read_b128 v[52:55], v21 offset:8192
 s_add_u32 m0, s56, 9216
 s_add_u32 s3, s55, s65
 buffer_load_dwordx4 v24, s[4:7], s3 offen sc1 lds
 s_waitcnt lgkmcnt(3)
 v_mfma_f32_32x32x16_bf16 v[64:79], a[40:43], v[40:43], v[64:79]
 ds_read_b128 v[56:59], v22 offset:8192
 s_waitcnt lgkmcnt(3)
 v_mfma_f32_32x32x16_bf16 v[64:79], a[44:47], v[44:47], v[64:79]
 ds_read_b128 v[60:63], v23 offset:8192
 s_waitcnt lgkmcnt(3)
 v_mfma_f32_32x32x16_bf16 v[64:79], a[48:51], v[48:51], v[64:79]
 s_waitcnt vmcnt(8)
 s_barrier
 ds_read_b128 v[32:35], v16 offset:16384
 s_add_u32 m0, s56, 16384
 s_add_u32 s3, s55, s66
 buffer_load_dwordx4 v1, s[4:7], s3 offen sc1 lds
 s_waitcnt lgkmcnt(3)
 v_mfma_f32_32x32x16_bf16 v[64:79], a[52:55], v[52:55], v[64:79]
 ds_read_b128 v[36:39], v17 offset:16384
 s_waitcnt lgkmcnt(3)
 v_mfma_f32_32x32x16_bf16 v[64:79], a[56:59], v[56:59], v[64:79]
 ds_read_b128 v[40:43], v18 offset:16384
 s_waitcnt lgkmcnt(3)
 v_mfma_f32_32x32x16_bf16 v[64:79], a[60:63], v[60:63], v[64:79]
 ds_read_b128 v[44:47], v19 offset:16384
 s_add_u32 m0, s56, 17408
 s_add_u32 s3, s55, s66
 buffer_load_dwordx4 v24, s[4:7], s3 offen sc1 lds
 s_waitcnt lgkmcnt(3)
 v_mfma_f32_32x32x16_bf16 v[64:79], a[64:67], v[32:35], v[64:79]
 ds_read_b128 v[48:51], v20 offset:16384
 s_waitcnt lgkmcnt(3)
 v_mfma_f32_32x32x16_bf16 v[64:79], a[68:71], v[36:39], v[64:79]
 ds_read_b128 v[52:55], v21 offset:16384
 s_waitcnt lgkmcnt(3)
 v_mfma_f32_32x32x16_bf16 v[64:79], a[72:75], v[40:43], v[64:79]
 ds_read_b128 v[56:59], v22 offset:16384
 s_add_u32 m0, s56, 24576
 s_add_u32 s3, s55, s67
 buffer_load_dwordx4 v1, s[4:7], s3 offen sc1 lds
 s_waitcnt lgkmcnt(3)
 v_mfma_f32_32x32x16_bf16 v[64:79], a[76:79], v[44:47], v[64:79]
 ds_read_b128 v[60:63], v23 offset:16384
 s_waitcnt lgkmcnt(3)
 v_mfma_f32_32x32x16_bf16 v[64:79], a[80:83], v[48:51], v[64:79]
 s_waitcnt vmcnt(9)
 s_barrier
 ds_read_b128 v[32:35], v16 offset:24576
 s_waitcnt lgkmcnt(3)
 v_mfma_f32_32x32x16_bf16 v[64:79], a[84:87], v[52:55], v[64:79]
 ds_read_b128 v[36:39], v17 offset:24576
 s_add_u32 m0, s56, 25600
 s_add_u32 s3, s55, s67
 buffer_load_dwordx4 v24, s[4:7], s3 offen sc1 lds
 s_waitcnt lgkmcnt(3)
 v_mfma_f32_32x32x16_bf16 v[64:79], a[88:91], v[56:59], v[64:79]
 ds_read_b128 v[40:43], v18 offset:24576
 s_waitcnt lgkmcnt(3)
 v_mfma_f32_32x32x16_bf16 v[64:79], a[92:95], v[60:63], v[64:79]
 ds_read_b128 v[44:47], v19 offset:24576
 s_waitcnt lgkmcnt(3)
 v_mfma_f32_32x32x16_bf16 v[64:79], a[96:99], v[32:35], v[64:79]
 ds_read_b128 v[48:51], v20 offset:24576
 s_add_u32 m0, s56, 32768
 s_add_u32 s3, s55, s68
 buffer_load_dwordx4 v1, s[4:7], s3 offen sc1 lds
 s_waitcnt lgkmcnt(3)
 v_mfma_f32_32x32x16_bf16 v[64:79], a[100:103], v[36:39], v[64:79]
 ds_read_b128 v[52:55], v21 offset:24576
 s_waitcnt lgkmcnt(3)
 v_mfma_f32_32x32x16_bf16 v[64:79], a[104:107], v[40:43], v[64:79]
 ds_read_b128 v[56:59], v22 offset:24576
 s_waitcnt lgkmcnt(3)
 v_mfma_f32_32x32x16_bf16 v[64:79], a[108:111], v[44:47], v[64:79]
 ds_read_b128 v[60:63], v23 offset:24576
 s_add_u32 m0, s56, 33792
 s_add_u32 s3, s55, s68
 buffer_load_dwordx4 v24, s[4:7], s3 offen sc1 lds
 s_waitcnt lgkmcnt(3)
 v_mfma_f32_32x32x16_bf16 v[64:79], a[112:115], v[48:51], v[64:79]
 s_waitcnt vmcnt(10)
 s_barrier
 ds_read_b128 v[32:35], v16 offset:32768
 s_waitcnt lgkmcnt(3)
 v_mfma_f32_32x32x16_bf16 v[64:79], a[116:119], v[52:55], v[64:79]
 ds_read_b128 v[36:39], v17 offset:32768
 s_waitcnt lgkmcnt(3)
 v_mfma_f32_32x32x16_bf16 v[64:79], a[120:123], v[56:59], v[64:79]
 ds_read_b128 v[40:43], v18 offset:32768
 s_waitcnt lgkmcnt(3)
 v_mfma_f32_32x32x16_bf16 v[64:79], a[124:127], v[60:63], v[64:79]
 ds_read_b128 v[44:47], v19 offset:32768
 s_waitcnt lgkmcnt(3)
 v_mfma_f32_32x32x16_bf16 v[64:79], a[128:131], v[32:35], v[64:79]
 ds_read_b128 v[48:51], v20 offset:32768
 s_waitcnt lgkmcnt(3)
 v_mfma_f32_32x32x16_bf16 v[64:79], a[132:135], v[36:39], v[64:79]
 ds_read_b128 v[52:55], v21 offset:32768
 s_waitcnt lgkmcnt(3)
 v_mfma_f32_32x32x16_bf16 v[64:79], a[136:139], v[40:43], v[64:79]
 ds_read_b128 v[56:59], v22 offset:32768
 s_waitcnt lgkmcnt(3)
 v_mfma_f32_32x32x16_bf16 v[64:79], a[140:143], v[44:47], v[64:79]
 ds_read_b128 v[60:63], v23 offset:32768
 s_waitcnt lgkmcnt(3)
 v_mfma_f32_32x32x16_bf16 v[64:79], a[144:147], v[48:51], v[64:79]
 s_waitcnt lgkmcnt(2)
 v_mfma_f32_32x32x16_bf16 v[64:79], a[148:151], v[52:55], v[64:79]
 s_lshl_b32 s55, s54, 2
 s_add_u32 s55, s55, s62
 s_sub_u32 s55, s55, 36
 s_cmp_lg_u32 s50, 0
 s_cselect_b32 s55, 268435456, s55
 v_mov_b32 v6, 8
 s_mov_b64 exec, 15
 v_mov_b32 v6, 0
 buffer_atomic_add v6, v5, s[4:7], s55 offen sc0
 s_mov_b64 exec, -1
 s_waitcnt lgkmcnt(1)
 v_mfma_f32_32x32x16_bf16 v[64:79], a[152:155], v[56:59], v[64:79]
 s_waitcnt lgkmcnt(0)
 v_mfma_f32_32x32x16_bf16 v[64:79], a[156:159], v[60:63], v[64:79]
 s_lshl_b32 s3, s60, 19
 s_add_u32 s3, s3, s58
 s_xor_b32 s3, s3, s82
 s_add_u32 s3, s3, 33554432
 s_nop 8
 v_cvt_pk_bf16_f32 v88, v64, v65
 v_cvt_pk_bf16_f32 v89, v66, v67
 v_cvt_pk_bf16_f32 v90, v72, v73
 v_cvt_pk_bf16_f32 v91, v74, v75
 buffer_store_dwordx4 v[88:91], v4, s[4:7], s3 offen offset:0 sc1
 v_cvt_pk_bf16_f32 v92, v68, v69
 v_cvt_pk_bf16_f32 v93, v70, v71
 v_cvt_pk_bf16_f32 v94, v76, v77
 v_cvt_pk_bf16_f32 v95, v78, v79
 buffer_store_dwordx4 v[92:95], v4, s[4:7], s3 offen offset:512 sc1
 s_cmp_ge_u32 s54, 64
 s_cbranch_scc1 L_n0_75
 s_waitcnt vmcnt(3)
 s_barrier
 s_mov_b32 s60, s54
 ds_read_b128 v[32:35], v8 offset:0
 ds_read_b128 v[36:39], v9 offset:0
 ds_read_b128 v[40:43], v10 offset:0
 ds_read_b128 v[44:47], v11 offset:0
 s_waitcnt lgkmcnt(3)
 v_mfma_f32_32x32x16_bf16 v[64:79], a[0:3], v[32:35], 0
 ds_read_b128 v[48:51], v12 offset:0
 s_waitcnt lgkmcnt(3)
 v_mfma_f32_32x32x16_bf16 v[64:79], a[4:7], v[36:39], v[64:79]
 ds_read_b128 v[52:55], v13 offset:0
 s_waitcnt lgkmcnt(3)
 v_mfma_f32_32x32x16_bf16 v[64:79], a[8:11], v[40:43], v[64:79]
 ds_read_b128 v[56:59], v14 offset:0
 s_waitcnt lgkmcnt(3)
 v_mfma_f32_32x32x16_bf16 v[64:79], a[12:15], v[44:47], v[64:79]
 ds_read_b128 v[60:63], v15 offset:0
 s_waitcnt lgkmcnt(3)
 v_mfma_f32_32x32x16_bf16 v[64:79], a[16:19], v[48:51], v[64:79]
 ds_read_b128 v[32:35], v8 offset:8192
 s_waitcnt lgkmcnt(3)
 v_mfma_f32_32x32x16_bf16 v[64:79], a[20:23], v[52:55], v[64:79]
 ds_read_b128 v[36:39], v9 offset:8192
 s_waitcnt lgkmcnt(3)
 v_mfma_f32_32x32x16_bf16 v[64:79], a[24:27], v[56:59], v[64:79]
 ds_read_b128 v[40:43], v10 offset:8192
 s_waitcnt lgkmcnt(3)
 v_mfma_f32_32x32x16_bf16 v[64:79], a[28:31], v[60:63], v[64:79]
 ds_read_b128 v[44:47], v11 offset:8192
 s_waitcnt lgkmcnt(3)
 v_mfma_f32_32x32x16_bf16 v[64:79], a[32:35], v[32:35], v[64:79]
 ds_read_b128 v[48:51], v12 offset:8192
 s_waitcnt lgkmcnt(3)
 v_mfma_f32_32x32x16_bf16 v[64:79], a[36:39], v[36:39], v[64:79]
 ds_read_b128 v[52:55], v13 offset:8192
 s_waitcnt lgkmcnt(3)
 v_mfma_f32_32x32x16_bf16 v[64:79], a[40:43], v[40:43], v[64:79]
 ds_read_b128 v[56:59], v14 offset:8192
 s_waitcnt lgkmcnt(3)
 v_mfma_f32_32x32x16_bf16 v[64:79], a[44:47], v[44:47], v[64:79]
 ds_read_b128 v[60:63], v15 offset:8192
 s_waitcnt lgkmcnt(3)
 v_mfma_f32_32x32x16_bf16 v[64:79], a[48:51], v[48:51], v[64:79]
 ds_read_b128 v[32:35], v8 offset:16384
 s_waitcnt lgkmcnt(3)
 v_mfma_f32_32x32x16_bf16 v[64:79], a[52:55], v[52:55], v[64:79]
 ds_read_b128 v[36:39], v9 offset:16384
 s_waitcnt lgkmcnt(3)
 v_mfma_f32_32x32x16_bf16 v[64:79], a[56:59], v[56:59], v[64:79]
 ds_read_b128 v[40:43], v10 offset:16384
 s_waitcnt lgkmcnt(3)
 v_mfma_f32_32x32x16_bf16 v[64:79], a[60:63], v[60:63], v[64:79]
 ds_read_b128 v[44:47], v11 offset:16384
 s_waitcnt lgkmcnt(3)
 v_mfma_f32_32x32x16_bf16 v[64:79], a[64:67], v[32:35], v[64:79]
 ds_read_b128 v[48:51], v12 offset:16384
 s_waitcnt lgkmcnt(3)
 v_mfma_f32_32x32x16_bf16 v[64:79], a[68:71], v[36:39], v[64:79]
 ds_read_b128 v[52:55], v13 offset:16384
 s_waitcnt vmcnt(0)
 v_cmp_gt_u32 vcc, 8, v6
 s_cmp_lg_u32 s50, 0
 s_nop 1
 v_mov_b32 v2, vcc_lo
 s_cselect_b64 exec, 0, 1
 ds_write_b32 v7, v2 offset:16
 s_mov_b64 exec, -1
 s_lshl_b32 s3, s54, 2
 s_add_u32 s3, s3, s63
 v_mov_b32 v3, 1
 s_mov_b64 exec, 1
 buffer_atomic_add v3, v5, s[4:7], s3 offen
 s_mov_b64 exec, -1
 s_cmp_eq_u32 s61, 0
 s_cbranch_scc1 L_pf_76
 s_lshl_b32 s3, s61, 2
 s_add_u32 s3, s3, s59
 s_sub_u32 s3, s3, 4
 v_mov_b32 v3, 1
 s_mov_b64 exec, 1
 buffer_atomic_add v3, v5, s[4:7], s3 offen
 s_mov_b64 exec, -1
 s_mov_b32 s61, 0
L_pf_76:
 s_waitcnt lgkmcnt(3)
 v_mfma_f32_32x32x16_bf16 v[64:79], a[72:75], v[40:43], v[64:79]
 ds_read_b128 v[56:59], v14 offset:16384
 s_waitcnt lgkmcnt(3)
 v_mfma_f32_32x32x16_bf16 v[64:79], a[76:79], v[44:47], v[64:79]
 ds_read_b128 v[60:63], v15 offset:16384
 s_waitcnt lgkmcnt(3)
 v_mfma_f32_32x32x16_bf16 v[64:79], a[80:83], v[48:51], v[64:79]
 ds_read_b128 v[32:35], v8 offset:24576
 s_waitcnt lgkmcnt(3)
 v_mfma_f32_32x32x16_bf16 v[64:79], a[84:87], v[52:55], v[64:79]
 ds_read_b128 v[36:39], v9 offset:24576
 s_waitcnt lgkmcnt(3)
 v_mfma_f32_32x32x16_bf16 v[64:79], a[88:91], v[56:59], v[64:79]
 ds_read_b128 v[40:43], v10 offset:24576
 s_barrier
 ds_read_b32 v2, v7 offset:16
 s_waitcnt lgkmcnt(3)
 v_mfma_f32_32x32x16_bf16 v[64:79], a[92:95], v[60:63], v[64:79]
 ds_read_b128 v[44:47], v11 offset:24576
 s_waitcnt lgkmcnt(3)
 v_mfma_f32_32x32x16_bf16 v[64:79], a[96:99], v[32:35], v[64:79]
 ds_read_b128 v[48:51], v12 offset:24576
 s_waitcnt lgkmcnt(3)
 v_mfma_f32_32x32x16_bf16 v[64:79], a[100:103], v[36:39], v[64:79]
 ds_read_b128 v[52:55], v13 offset:24576
 s_waitcnt lgkmcnt(3)
 v_mfma_f32_32x32x16_bf16 v[64:79], a[104:107], v[40:43], v[64:79]
 ds_read_b128 v[56:59], v14 offset:24576
 s_waitcnt lgkmcnt(3)
 v_mfma_f32_32x32x16_bf16 v[64:79], a[108:111], v[44:47], v[64:79]
 ds_read_b128 v[60:63], v15 offset:24576
 v_readfirstlane_b32 s3, v2
 s_cmp_lg_u32 s3, 0
 s_cbranch_scc1 L_pf_77
 s_sub_u32 s72, s54, 9
 s_mul_i32 s55, s72, 40960
 s_mul_i32 s3, s50, 10240
 s_add_u32 s55, s55, s3
 s_add_u32 s55, s55, 195559424
 s_add_u32 m0, s56, 40960
 s_add_u32 s3, s55, s64
 buffer_load_dwordx4 v1, s[4:7], s3 offen sc1 lds
 s_branch L_pf_78
L_pf_77:
 s_mov_b64 exec, 15
 v_mov_b32 v6, 0
 buffer_atomic_add v6, v5, s[4:7], s55 offen sc0
 s_mov_b64 exec, -1
L_pf_78:
 s_waitcnt lgkmcnt(3)
 v_mfma_f32_32x32x16_bf16 v[64:79], a[112:115], v[48:51], v[64:79]
 ds_read_b128 v[32:35], v8 offset:32768
 s_cmp_eq_u32 s72, 0
 s_cbranch_scc1 L_pf_79
 s_add_u32 m0, s56, 41984
 s_add_u32 s3, s55, s64
 buffer_load_dwordx4 v24, s[4:7], s3 offen sc1 lds
L_pf_79:
 s_waitcnt lgkmcnt(3)
 v_mfma_f32_32x32x16_bf16 v[64:79], a[116:119], v[52:55], v[64:79]
 ds_read_b128 v[36:39], v9 offset:32768
 s_cmp_eq_u32 s72, 0
 s_cbranch_scc1 L_pf_80
 s_add_u32 m0, s56, 49152
 s_add_u32 s3, s55, s65
 buffer_load_dwordx4 v1, s[4:7], s3 offen sc1 lds
L_pf_80:
 s_waitcnt lgkmcnt(3)
 v_mfma_f32_32x32x16_bf16 v[64:79], a[120:123], v[56:59], v[64:79]
 ds_read_b128 v[40:43], v10 offset:32768
 s_cmp_eq_u32 s72, 0
 s_cbranch_scc1 L_pf_81
 s_add_u32 m0, s56, 50176
 s_add_u32 s3, s55, s65
 buffer_load_dwordx4 v24, s[4:7], s3 offen sc1 lds
L_pf_81:
 s_waitcnt lgkmcnt(3)
 v_mfma_f32_32x32x16_bf16 v[64:79], a[124:127], v[60:63], v[64:79]
 ds_read_b128 v[44:47], v11 offset:32768
 s_cmp_eq_u32 s72, 0
 s_cbranch_scc1 L_pf_82
 s_add_u32 m0, s56, 57344
 s_add_u32 s3, s55, s66
 buffer_load_dwordx4 v1, s[4:7], s3 offen sc1 lds
L_pf_82:
 s_waitcnt lgkmcnt(3)
 v_mfma_f32_32x32x16_bf16 v[64:79], a[128:131], v[32:35], v[64:79]
 ds_read_b128 v[48:51], v12 offset:32768
 s_cmp_eq_u32 s72, 0
 s_cbranch_scc1 L_pf_83
 s_add_u32 m0, s56, 58368
 s_add_u32 s3, s55, s66
 buffer_load_dwordx4 v24, s[4:7], s3 offen sc1 lds
L_pf_83:
 s_waitcnt lgkmcnt(3)
 v_mfma_f32_32x32x16_bf16 v[64:79], a[132:135], v[36:39], v[64:79]
 ds_read_b128 v[52:55], v13 offset:32768
 s_cmp_eq_u32 s72, 0
 s_cbranch_scc1 L_pf_84
 s_add_u32 m0, s56, 65536
 s_add_u32 s3, s55, s67
 buffer_load_dwordx4 v1, s[4:7], s3 offen sc1 lds
L_pf_84:
 s_waitcnt lgkmcnt(3)
 v_mfma_f32_32x32x16_bf16 v[64:79], a[136:139], v[40:43], v[64:79]
 ds_read_b128 v[56:59], v14 offset:32768
 s_cmp_eq_u32 s72, 0
 s_cbranch_scc1 L_pf_85
 s_add_u32 m0, s56, 66560
 s_add_u32 s3, s55, s67
 buffer_load_dwordx4 v24, s[4:7], s3 offen sc1 lds
L_pf_85:
 s_waitcnt lgkmcnt(3)
 v_mfma_f32_32x32x16_bf16 v[64:79], a[140:143], v[44:47], v[64:79]
 ds_read_b128 v[60:63], v15 offset:32768
 s_cmp_eq_u32 s72, 0
 s_cbranch_scc1 L_pf_86
 s_add_u32 m0, s56, 73728
 s_add_u32 s3, s55, s68
 buffer_load_dwordx4 v1, s[4:7], s3 offen sc1 lds
L_pf_86:
 s_waitcnt lgkmcnt(3)
 v_mfma_f32_32x32x16_bf16 v[64:79], a[144:147], v[48:51], v[64:79]
 s_cmp_eq_u32 s72, 0
 s_cbranch_scc1 L_pf_87
 s_add_u32 m0, s56, 74752
 s_add_u32 s3, s55, s68
 buffer_load_dwordx4 v24, s[4:7], s3 offen sc1 lds
L_pf_87:
 s_waitcnt lgkmcnt(2)
 v_mfma_f32_32x32x16_bf16 v[64:79], a[148:151], v[52:55], v[64:79]
 s_waitcnt lgkmcnt(1)
 v_mfma_f32_32x32x16_bf16 v[64:79], a[152:155], v[56:59], v[64:79]
 s_waitcnt lgkmcnt(0)
 v_mfma_f32_32x32x16_bf16 v[64:79], a[156:159], v[60:63], v[64:79]
 s_lshl_b32 s3, s60, 19
 s_add_u32 s3, s3, s58
 s_xor_b32 s3, s3, s82
 s_nop 8
 v_cvt_pk_bf16_f32 v80, v64, v65
 v_cvt_pk_bf16_f32 v81, v66, v67
 v_cvt_pk_bf16_f32 v82, v72, v73
 v_cvt_pk_bf16_f32 v83, v74, v75
 buffer_store_dwordx4 v[80:83], v4, s[4:7], s3 offen offset:0 sc1
 v_cvt_pk_bf16_f32 v84, v68, v69
 v_cvt_pk_bf16_f32 v85, v70, v71
 v_cvt_pk_bf16_f32 v86, v76, v77
 v_cvt_pk_bf16_f32 v87, v78, v79
 buffer_store_dwordx4 v[84:87], v4, s[4:7], s3 offen offset:512 sc1
 s_add_u32 s54, s54, 1
 s_mov_b32 s61, s54
 s_cmp_lg_u32 s72, 0
 s_cbranch_scc1 L_qkvq_loop
 s_cmp_lg_u32 s50, 0
 s_cbranch_scc1 L_w_88
 s_waitcnt vmcnt(2)
 v_cmp_gt_u32 vcc, 8, v6
 s_nop 1
 v_mov_b32 v3, vcc_lo
 ds_write_b32 v7, v3
 s_waitcnt lgkmcnt(0)
L_w_88:
 s_barrier
 ds_read_b32 v3, v7
 s_waitcnt lgkmcnt(0)
 v_readfirstlane_b32 s3, v3
 s_cmp_eq_u32 s3, 0
 s_cbranch_scc1 L_qkvq_loop
 s_branch L_qkvq_block
L_n0_75:
 s_waitcnt vmcnt(0)
 s_lshl_b32 s3, s54, 2
 s_add_u32 s3, s3, s63
 v_mov_b32 v3, 1
 s_mov_b64 exec, 1
 buffer_atomic_add v3, v5, s[4:7], s3 offen
 s_mov_b64 exec, -1
 s_add_u32 s54, s54, 1
 s_cmp_lt_u32 s54, 74
 s_cbranch_scc1 L_qkvq_block
 s_endpgm
L_qkvv:
 s_mul_i32 s57, s50, 40960
 s_mul_i32 s62, s52, 3
 s_add_u32 s62, s62, s53
 s_mul_i32 s3, s62, 13108
 s_lshr_b32 s3, s3, 16
 s_mul_i32 s3, s3, 5
 s_sub_u32 s55, s62, s3
 s_add_u32 s64, s55, 0
 s_sub_u32 s3, s64, 5
 s_cmp_ge_u32 s64, 5
 s_cselect_b32 s64, s3, s64
 s_add_u32 s65, s55, 1
 s_sub_u32 s3, s65, 5
 s_cmp_ge_u32 s65, 5
 s_cselect_b32 s65, s3, s65
 s_add_u32 s66, s55, 2
 s_sub_u32 s3, s66, 5
 s_cmp_ge_u32 s66, 5
 s_cselect_b32 s66, s3, s66
 s_add_u32 s67, s55, 3
 s_sub_u32 s3, s67, 5
 s_cmp_ge_u32 s67, 5
 s_cselect_b32 s67, s3, s67
 s_add_u32 s68, s55, 4
 s_sub_u32 s3, s68, 5
 s_cmp_ge_u32 s68, 5
 s_cselect_b32 s68, s3, s68
 s_lshl_b32 s55, s52, 8
 v_lshrrev_b32 v4, 4, v0
 s_mov_b32 s3, 8192
 v_mul_lo_u32 v4, v4, s3
 v_lshrrev_b32 v3, 3, v0
 v_and_b32 v3, 6, v3
 v_xor_b32 v3, v3, v0
 v_and_b32 v3, 15, v3
 v_lshl_add_u32 v4, v3, 4, v4
 v_xor_b32 v5, 128, v4
 s_lshl_b32 s57, s50, 13
 s_mul_i32 s3, s50, 262144
 s_add_u32 s55, s55, s3
 s_mul_i32 s51, s64, 1048576
 s_add_u32 s51, s51, s55
 s_add_u32 m0, s57, 0
 s_nop 0
 buffer_load_dwordx4 v4, s[8:11], s51 offen lds
 s_add_u32 s51, s51, 32768
 s_add_u32 m0, s57, 1024
 s_nop 0
 buffer_load_dwordx4 v5, s[8:11], s51 offen lds
 s_add_u32 s51, s51, 32768
 s_add_u32 m0, s57, 2048
 s_nop 0
 buffer_load_dwordx4 v4, s[8:11], s51 offen lds
 s_add_u32 s51, s51, 32768
 s_add_u32 m0, s57, 3072
 s_nop 0
 buffer_load_dwordx4 v5, s[8:11], s51 offen lds
 s_add_u32 s51, s51, 32768
 s_add_u32 m0, s57, 4096
 s_nop 0
 buffer_load_dwordx4 v4, s[8:11], s51 offen lds
 s_add_u32 s51, s51, 32768
 s_add_u32 m0, s57, 5120
 s_nop 0
 buffer_load_dwordx4 v5, s[8:11], s51 offen lds
 s_add_u32 s51, s51, 32768
 s_add_u32 m0, s57, 6144
 s_nop 0
 buffer_load_dwordx4 v4, s[8:11], s51 offen lds
 s_add_u32 s51, s51, 32768
 s_add_u32 m0, s57, 7168
 s_nop 0
 buffer_load_dwordx4 v5, s[8:11], s51 offen lds
 s_add_u32 s51, s51, 32768
 s_mul_i32 s51, s65, 1048576
 s_add_u32 s51, s51, s55
 s_add_u32 m0, s57, 32768
 s_nop 0
 buffer_load_dwordx4 v4, s[8:11], s51 offen lds
 s_add_u32 s51, s51, 32768
 s_add_u32 m0, s57, 33792
 s_nop 0
 buffer_load_dwordx4 v5, s[8:11], s51 offen lds
 s_add_u32 s51, s51, 32768
 s_add_u32 m0, s57, 34816
 s_nop 0
 buffer_load_dwordx4 v4, s[8:11], s51 offen lds
 s_add_u32 s51, s51, 32768
 s_add_u32 m0, s57, 35840
 s_nop 0
 buffer_load_dwordx4 v5, s[8:11], s51 offen lds
 s_add_u32 s51, s51, 32768
 s_add_u32 m0, s57, 36864
 s_nop 0
 buffer_load_dwordx4 v4, s[8:11], s51 offen lds
 s_add_u32 s51, s51, 32768
 s_add_u32 m0, s57, 37888
 s_nop 0
 buffer_load_dwordx4 v5, s[8:11], s51 offen lds
 s_add_u32 s51, s51, 32768
 s_add_u32 m0, s57, 38912
 s_nop 0
 buffer_load_dwordx4 v4, s[8:11], s51 offen lds
 s_add_u32 s51, s51, 32768
 s_add_u32 m0, s57, 39936
 s_nop 0
 buffer_load_dwordx4 v5, s[8:11], s51 offen lds
 s_add_u32 s51, s51, 32768
 s_mul_i32 s51, s66, 1048576
 s_add_u32 s51, s51, s55
 s_add_u32 m0, s57, 65536
 s_nop 0
 buffer_load_dwordx4 v4, s[8:11], s51 offen lds
 s_add_u32 s51, s51, 32768
 s_add_u32 m0, s57, 66560
 s_nop 0
 buffer_load_dwordx4 v5, s[8:11], s51 offen lds
 s_add_u32 s51, s51, 32768
 s_add_u32 m0, s57, 67584
 s_nop 0
 buffer_load_dwordx4 v4, s[8:11], s51 offen lds
 s_add_u32 s51, s51, 32768
 s_add_u32 m0, s57, 68608
 s_nop 0
 buffer_load_dwordx4 v5, s[8:11], s51 offen lds
 s_add_u32 s51, s51, 32768
 s_add_u32 m0, s57, 69632
 s_nop 0
 buffer_load_dwordx4 v4, s[8:11], s51 offen lds
 s_add_u32 s51, s51, 32768
 s_add_u32 m0, s57, 70656
 s_nop 0
 buffer_load_dwordx4 v5, s[8:11], s51 offen lds
 s_add_u32 s51, s51, 32768
 s_add_u32 m0, s57, 71680
 s_nop 0
 buffer_load_dwordx4 v4, s[8:11], s51 offen lds
 s_add_u32 s51, s51, 32768
 s_add_u32 m0, s57, 72704
 s_nop 0
 buffer_load_dwordx4 v5, s[8:11], s51 offen lds
 s_add_u32 s51, s51, 32768
 s_mul_i32 s51, s67, 1048576
 s_add_u32 s51, s51, s55
 s_add_u32 m0, s57, 98304
 s_nop 0
 buffer_load_dwordx4 v4, s[8:11], s51 offen lds
 s_add_u32 s51, s51, 32768
 s_add_u32 m0, s57, 99328
 s_nop 0
 buffer_load_dwordx4 v5, s[8:11], s51 offen lds
 s_add_u32 s51, s51, 32768
 s_add_u32 m0, s57, 100352
 s_nop 0
 buffer_load_dwordx4 v4, s[8:11], s51 offen lds
 s_add_u32 s51, s51, 32768
 s_add_u32 m0, s57, 101376
 s_nop 0
 buffer_load_dwordx4 v5, s[8:11], s51 offen lds
 s_add_u32 s51, s51, 32768
 s_add_u32 m0, s57, 102400
 s_nop 0
 buffer_load_dwordx4 v4, s[8:11], s51 offen lds
 s_add_u32 s51, s51, 32768
 s_add_u32 m0, s57, 103424
 s_nop 0
 buffer_load_dwordx4 v5, s[8:11], s51 offen lds
 s_add_u32 s51, s51, 32768
 s_add_u32 m0, s57, 104448
 s_nop 0
 buffer_load_dwordx4 v4, s[8:11], s51 offen lds
 s_add_u32 s51, s51, 32768
 s_add_u32 m0, s57, 105472
 s_nop 0
 buffer_load_dwordx4 v5, s[8:11], s51 offen lds
 s_add_u32 s51, s51, 32768
 s_mul_i32 s51, s68, 1048576
 s_add_u32 s51, s51, s55
 s_add_u32 m0, s57, 131072
 s_nop 0
 buffer_load_dwordx4 v4, s[8:11], s51 offen lds
 s_add_u32 s51, s51, 32768
 s_add_u32 m0, s57, 132096
 s_nop 0
 buffer_load_dwordx4 v5, s[8:11], s51 offen lds
 s_add_u32 s51, s51, 32768
 s_add_u32 m0, s57, 133120
 s_nop 0
 buffer_load_dwordx4 v4, s[8:11], s51 offen lds
 s_add_u32 s51, s51, 32768
 s_add_u32 m0, s57, 134144
 s_nop 0
 buffer_load_dwordx4 v5, s[8:11], s51 offen lds
 s_add_u32 s51, s51, 32768
 s_add_u32 m0, s57, 135168
 s_nop 0
 buffer_load_dwordx4 v4, s[8:11], s51 offen lds
 s_add_u32 s51, s51, 32768
 s_add_u32 m0, s57, 136192
 s_nop 0
 buffer_load_dwordx4 v5, s[8:11], s51 offen lds
 s_add_u32 s51, s51, 32768
 s_add_u32 m0, s57, 137216
 s_nop 0
 buffer_load_dwordx4 v4, s[8:11], s51 offen lds
 s_add_u32 s51, s51, 32768
 s_add_u32 m0, s57, 138240
 s_nop 0
 buffer_load_dwordx4 v5, s[8:11], s51 offen lds
 s_add_u32 s51, s51, 32768
 s_mov_b32 s96, s44
 s_and_b32 s97, s45, 0xffff
 s_mov_b32 s98, 256
 s_mov_b32 s99, 0x00020000
 buffer_load_dword v30, off, s[96:99], 0 offset:132 sc1
 v_lshrrev_b32 v2, 3, v0
 v_and_b32 v2, 4, v2
 v_bfe_u32 v3, v0, 2, 2
 v_or_b32 v2, v2, v3
 v_bfe_u32 v3, v0, 4, 1
 v_xor_b32 v3, v3, v2
 s_lshl_b32 s3, s50, 1
 v_xor_b32 v3, s3, v3
 v_lshlrev_b32 v2, 8, v2
 v_lshl_add_u32 v2, v3, 5, v2
 v_and_b32 v3, 3, v0
 v_lshl_add_u32 v2, v3, 3, v2
 s_waitcnt vmcnt(32)
 s_barrier
 ds_read_b64_tr_b16 a[0:1], v2 offset:0
 ds_read_b64_tr_b16 a[2:3], v2 offset:4096
 ds_read_b64_tr_b16 a[4:5], v2 offset:2048
 ds_read_b64_tr_b16 a[6:7], v2 offset:6144
 ds_read_b64_tr_b16 a[8:9], v2 offset:8192
 ds_read_b64_tr_b16 a[10:11], v2 offset:12288
 ds_read_b64_tr_b16 a[12:13], v2 offset:10240
 ds_read_b64_tr_b16 a[14:15], v2 offset:14336
 ds_read_b64_tr_b16 a[16:17], v2 offset:16384
 ds_read_b64_tr_b16 a[18:19], v2 offset:20480
 ds_read_b64_tr_b16 a[20:21], v2 offset:18432
 ds_read_b64_tr_b16 a[22:23], v2 offset:22528
 ds_read_b64_tr_b16 a[24:25], v2 offset:24576
 ds_read_b64_tr_b16 a[26:27], v2 offset:28672
 ds_read_b64_tr_b16 a[28:29], v2 offset:26624
 ds_read_b64_tr_b16 a[30:31], v2 offset:30720
 v_add_u32 v2, 0x8000, v2
 s_waitcnt vmcnt(24)
 s_barrier
 ds_read_b64_tr_b16 a[32:33], v2 offset:0
 ds_read_b64_tr_b16 a[34:35], v2 offset:4096
 ds_read_b64_tr_b16 a[36:37], v2 offset:2048
 ds_read_b64_tr_b16 a[38:39], v2 offset:6144
 ds_read_b64_tr_b16 a[40:41], v2 offset:8192
 ds_read_b64_tr_b16 a[42:43], v2 offset:12288
 ds_read_b64_tr_b16 a[44:45], v2 offset:10240
 ds_read_b64_tr_b16 a[46:47], v2 offset:14336
 ds_read_b64_tr_b16 a[48:49], v2 offset:16384
 ds_read_b64_tr_b16 a[50:51], v2 offset:20480
 ds_read_b64_tr_b16 a[52:53], v2 offset:18432
 ds_read_b64_tr_b16 a[54:55], v2 offset:22528
 ds_read_b64_tr_b16 a[56:57], v2 offset:24576
 ds_read_b64_tr_b16 a[58:59], v2 offset:28672
 ds_read_b64_tr_b16 a[60:61], v2 offset:26624
 ds_read_b64_tr_b16 a[62:63], v2 offset:30720
 v_add_u32 v2, 0x8000, v2
 s_waitcnt vmcnt(16)
 s_barrier
 ds_read_b64_tr_b16 a[64:65], v2 offset:0
 ds_read_b64_tr_b16 a[66:67], v2 offset:4096
 ds_read_b64_tr_b16 a[68:69], v2 offset:2048
 ds_read_b64_tr_b16 a[70:71], v2 offset:6144
 ds_read_b64_tr_b16 a[72:73], v2 offset:8192
 ds_read_b64_tr_b16 a[74:75], v2 offset:12288
 ds_read_b64_tr_b16 a[76:77], v2 offset:10240
 ds_read_b64_tr_b16 a[78:79], v2 offset:14336
 ds_read_b64_tr_b16 a[80:81], v2 offset:16384
 ds_read_b64_tr_b16 a[82:83], v2 offset:20480
 ds_read_b64_tr_b16 a[84:85], v2 offset:18432
 ds_read_b64_tr_b16 a[86:87], v2 offset:22528
 ds_read_b64_tr_b16 a[88:89], v2 offset:24576
 ds_read_b64_tr_b16 a[90:91], v2 offset:28672
 ds_read_b64_tr_b16 a[92:93], v2 offset:26624
 ds_read_b64_tr_b16 a[94:95], v2 offset:30720
 v_add_u32 v2, 0x8000, v2
 s_waitcnt vmcnt(8)
 s_barrier
 ds_read_b64_tr_b16 a[96:97], v2 offset:0
 ds_read_b64_tr_b16 a[98:99], v2 offset:4096
 ds_read_b64_tr_b16 a[100:101], v2 offset:2048
 ds_read_b64_tr_b16 a[102:103], v2 offset:6144
 ds_read_b64_tr_b16 a[104:105], v2 offset:8192
 ds_read_b64_tr_b16 a[106:107], v2 offset:12288
 ds_read_b64_tr_b16 a[108:109], v2 offset:10240
 ds_read_b64_tr_b16 a[110:111], v2 offset:14336
 ds_read_b64_tr_b16 a[112:113], v2 offset:16384
 ds_read_b64_tr_b16 a[114:115], v2 offset:20480
 ds_read_b64_tr_b16 a[116:117], v2 offset:18432
 ds_read_b64_tr_b16 a[118:119], v2 offset:22528
 ds_read_b64_tr_b16 a[120:121], v2 offset:24576
 ds_read_b64_tr_b16 a[122:123], v2 offset:28672
 ds_read_b64_tr_b16 a[124:125], v2 offset:26624
 ds_read_b64_tr_b16 a[126:127], v2 offset:30720
 v_add_u32 v2, 0x8000, v2
 s_waitcnt vmcnt(0)
 s_barrier
 ds_read_b64_tr_b16 a[128:129], v2 offset:0
 ds_read_b64_tr_b16 a[130:131], v2 offset:4096
 ds_read_b64_tr_b16 a[132:133], v2 offset:2048
 ds_read_b64_tr_b16 a[134:135], v2 offset:6144
 ds_read_b64_tr_b16 a[136:137], v2 offset:8192
 ds_read_b64_tr_b16 a[138:139], v2 offset:12288
 ds_read_b64_tr_b16 a[140:141], v2 offset:10240
 ds_read_b64_tr_b16 a[142:143], v2 offset:14336
 ds_read_b64_tr_b16 a[144:145], v2 offset:16384
 ds_read_b64_tr_b16 a[146:147], v2 offset:20480
 ds_read_b64_tr_b16 a[148:149], v2 offset:18432
 ds_read_b64_tr_b16 a[150:151], v2 offset:22528
 ds_read_b64_tr_b16 a[152:153], v2 offset:24576
 ds_read_b64_tr_b16 a[154:155], v2 offset:28672
 ds_read_b64_tr_b16 a[156:157], v2 offset:26624
 ds_read_b64_tr_b16 a[158:159], v2 offset:30720
 v_add_u32 v2, 0x8000, v2
 s_waitcnt lgkmcnt(0)
 s_barrier
 v_cmp_eq_u32 vcc, 0, v30
 s_cbranch_vccz L_qa_89
 s_mov_b32 s96, s44
 s_and_b32 s97, s45, 0xffff
 s_mov_b32 s98, 256
 s_mov_b32 s99, 0x00020000
 v_mov_b32 v1, 132
 s_mov_b32 s51, 0
 s_mov_b64 exec, 1
L_wb_90:
 buffer_load_dword v2, v1, s[96:99], 0 offen sc1
 s_waitcnt vmcnt(0)
 v_cmp_eq_u32 vcc, 0, v2
 s_cbranch_vccz L_wbd_91
 s_sleep 2
 s_add_u32 s51, s51, 1
 s_cmp_lt_u32 s51, 131072
 s_cbranch_scc1 L_wb_90
 s_branch L_bail
L_wbd_91:
 s_mov_b64 exec, -1
L_qa_89:
 s_lshl_b32 s64, s64, 8
 s_lshl_b32 s65, s65, 8
 s_lshl_b32 s66, s66, 8
 s_lshl_b32 s67, s67, 8
 s_lshl_b32 s68, s68, 8
 v_lshrrev_b32 v1, 4, v0
 s_mov_b32 s3, 1280
 v_mul_lo_u32 v1, v1, s3
 v_and_b32 v3, 15, v0
 v_lshl_add_u32 v1, v3, 4, v1
 v_add_u32 v6, 5120, v1
 v_mov_b32 v24, v6
 v_and_b32 v2, 31, v0
 v_lshlrev_b32 v2, 8, v2
 v_lshrrev_b32 v4, 5, v0
 v_xor_b32 v4, v4, v3
 v_xor_b32 v8, 0, v4
 v_lshl_add_u32 v8, v8, 4, v2
 v_add_u32 v16, 40960, v8
 v_xor_b32 v9, 2, v4
 v_lshl_add_u32 v9, v9, 4, v2
 v_add_u32 v17, 40960, v9
 v_xor_b32 v10, 4, v4
 v_lshl_add_u32 v10, v10, 4, v2
 v_add_u32 v18, 40960, v10
 v_xor_b32 v11, 6, v4
 v_lshl_add_u32 v11, v11, 4, v2
 v_add_u32 v19, 40960, v11
 v_xor_b32 v12, 8, v4
 v_lshl_add_u32 v12, v12, 4, v2
 v_add_u32 v20, 40960, v12
 v_xor_b32 v13, 10, v4
 v_lshl_add_u32 v13, v13, 4, v2
 v_add_u32 v21, 40960, v13
 v_xor_b32 v14, 12, v4
 v_lshl_add_u32 v14, v14, 4, v2
 v_add_u32 v22, 40960, v14
 v_xor_b32 v15, 14, v4
 v_lshl_add_u32 v15, v15, 4, v2
 v_add_u32 v23, 40960, v15
 v_lshrrev_b32 v4, 5, v0
 v_lshlrev_b32 v4, 8, v4
 v_lshl_add_u32 v4, v3, 4, v4
 v_and_b32 v2, 16, v0
 v_lshl_add_u32 v4, v2, 6, v4
 s_lshl_b32 s3, s50, 11
 v_add_u32 v4, s3, v4
 v_mul_u32_u24 v5, 49152, v0
 v_mov_b32 v7, 163776
 s_lshl_b32 s75, s62, 2
 s_add_u32 s75, s75, s50
 s_and_b32 s100, s52, 1
 s_lshl_b32 s100, s100, 13
 s_lshl_b32 s58, s52, 14
 s_add_u32 s58, s58, s100
 s_add_u32 s58, s58, 83886080
 s_cmp_eq_u32 s53, 0
 s_cselect_b32 s82, 8192, 0
 s_lshl_b32 s59, s52, 8
 s_add_u32 s59, s59, 16384
 s_lshl_b32 s56, s50, 11
 s_mov_b32 s54, 0
 s_mov_b32 s61, 0
 s_mov_b32 s70, s75
 s_mul_i32 s55, s54, 40960
 s_mul_i32 s3, s50, 10240
 s_add_u32 s55, s55, s3
 s_add_u32 s55, s55, 192937984
 s_add_u32 m0, s56, 0
 s_add_u32 s3, s55, s64
 buffer_load_dwordx4 v1, s[4:7], s3 offen sc1 lds
 s_add_u32 m0, s56, 1024
 s_add_u32 s3, s55, s64
 buffer_load_dwordx4 v24, s[4:7], s3 offen sc1 lds
 s_add_u32 m0, s56, 8192
 s_add_u32 s3, s55, s65
 buffer_load_dwordx4 v1, s[4:7], s3 offen sc1 lds
 s_add_u32 m0, s56, 9216
 s_add_u32 s3, s55, s65
 buffer_load_dwordx4 v24, s[4:7], s3 offen sc1 lds
 s_add_u32 m0, s56, 16384
 s_add_u32 s3, s55, s66
 buffer_load_dwordx4 v1, s[4:7], s3 offen sc1 lds
 s_add_u32 m0, s56, 17408
 s_add_u32 s3, s55, s66
 buffer_load_dwordx4 v24, s[4:7], s3 offen sc1 lds
 s_add_u32 m0, s56, 24576
 s_add_u32 s3, s55, s67
 buffer_load_dwordx4 v1, s[4:7], s3 offen sc1 lds
 s_add_u32 m0, s56, 25600
 s_add_u32 s3, s55, s67
 buffer_load_dwordx4 v24, s[4:7], s3 offen sc1 lds
 s_add_u32 m0, s56, 32768
 s_add_u32 s3, s55, s68
 buffer_load_dwordx4 v1, s[4:7], s3 offen sc1 lds
 s_add_u32 m0, s56, 33792
 s_add_u32 s3, s55, s68
 buffer_load_dwordx4 v24, s[4:7], s3 offen sc1 lds
 s_waitcnt vmcnt(0)
L_qkvv_pre:
 s_barrier
 s_mov_b32 s60, s54
 s_add_u32 s54, s54, 1
 s_mul_i32 s55, s54, 40960
 s_mul_i32 s3, s50, 10240
 s_add_u32 s55, s55, s3
 s_add_u32 s55, s55, 192937984
 ds_read_b128 v[32:35], v8 offset:0
 ds_read_b128 v[36:39], v9 offset:0
 ds_read_b128 v[40:43], v10 offset:0
 ds_read_b128 v[44:47], v11 offset:0
 s_waitcnt lgkmcnt(3)
 v_mfma_f32_32x32x16_bf16 v[64:79], v[32:35], a[0:3], 0
 ds_read_b128 v[48:51], v12 offset:0
 s_add_u32 m0, s56, 40960
 s_add_u32 s3, s55, s64
 buffer_load_dwordx4 v1, s[4:7], s3 offen sc1 lds
 s_waitcnt lgkmcnt(3)
 v_mfma_f32_32x32x16_bf16 v[64:79], v[36:39], a[4:7], v[64:79]
 ds_read_b128 v[52:55], v13 offset:0
 s_waitcnt lgkmcnt(3)
 v_mfma_f32_32x32x16_bf16 v[64:79], v[40:43], a[8:11], v[64:79]
 ds_read_b128 v[56:59], v14 offset:0
 s_waitcnt lgkmcnt(3)
 v_mfma_f32_32x32x16_bf16 v[64:79], v[44:47], a[12:15], v[64:79]
 ds_read_b128 v[60:63], v15 offset:0
 s_add_u32 m0, s56, 41984
 s_add_u32 s3, s55, s64
 buffer_load_dwordx4 v24, s[4:7], s3 offen sc1 lds
 s_waitcnt lgkmcnt(3)
 v_mfma_f32_32x32x16_bf16 v[64:79], v[48:51], a[16:19], v[64:79]
 ds_read_b128 v[32:35], v8 offset:8192
 s_waitcnt lgkmcnt(3)
 v_mfma_f32_32x32x16_bf16 v[64:79], v[52:55], a[20:23], v[64:79]
 ds_read_b128 v[36:39], v9 offset:8192
 s_waitcnt lgkmcnt(3)
 v_mfma_f32_32x32x16_bf16 v[64:79], v[56:59], a[24:27], v[64:79]
 ds_read_b128 v[40:43], v10 offset:8192
 s_add_u32 m0, s56, 49152
 s_add_u32 s3, s55, s65
 buffer_load_dwordx4 v1, s[4:7], s3 offen sc1 lds
 s_waitcnt lgkmcnt(3)
 v_mfma_f32_32x32x16_bf16 v[64:79], v[60:63], a[28:31], v[64:79]
 ds_read_b128 v[44:47], v11 offset:8192
 s_waitcnt lgkmcnt(3)
 v_mfma_f32_32x32x16_bf16 v[64:79], v[32:35], a[32:35], v[64:79]
 ds_read_b128 v[48:51], v12 offset:8192
 s_waitcnt lgkmcnt(3)
 v_mfma_f32_32x32x16_bf16 v[64:79], v[36:39], a[36:39], v[64:79]
 ds_read_b128 v[52:55], v13 offset:8192
 s_add_u32 m0, s56, 50176
 s_add_u32 s3, s55, s65
 buffer_load_dwordx4 v24, s[4:7], s3 offen sc1 lds
 s_waitcnt lgkmcnt(3)
 v_mfma_f32_32x32x16_bf16 v[64:79], v[40:43], a[40:43], v[64:79]
 ds_read_b128 v[56:59], v14 offset:8192
 s_waitcnt lgkmcnt(3)
 v_mfma_f32_32x32x16_bf16 v[64:79], v[44:47], a[44:47], v[64:79]
 ds_read_b128 v[60:63], v15 offset:8192
 s_waitcnt lgkmcnt(3)
 v_mfma_f32_32x32x16_bf16 v[64:79], v[48:51], a[48:51], v[64:79]
 ds_read_b128 v[32:35], v8 offset:16384
 s_add_u32 m0, s56, 57344
 s_add_u32 s3, s55, s66
 buffer_load_dwordx4 v1, s[4:7], s3 offen sc1 lds
 s_waitcnt lgkmcnt(3)
 v_mfma_f32_32x32x16_bf16 v[64:79], v[52:55], a[52:55], v[64:79]
 ds_read_b128 v[36:39], v9 offset:16384
 s_waitcnt lgkmcnt(3)
 v_mfma_f32_32x32x16_bf16 v[64:79], v[56:59], a[56:59], v[64:79]
 ds_read_b128 v[40:43], v10 offset:16384
 s_waitcnt lgkmcnt(3)
 v_mfma_f32_32x32x16_bf16 v[64:79], v[60:63], a[60:63], v[64:79]
 ds_read_b128 v[44:47], v11 offset:16384
 s_add_u32 m0, s56, 58368
 s_add_u32 s3, s55, s66
 buffer_load_dwordx4 v24, s[4:7], s3 offen sc1 lds
 s_waitcnt lgkmcnt(3)
 v_mfma_f32_32x32x16_bf16 v[64:79], v[32:35], a[64:67], v[64:79]
 ds_read_b128 v[48:51], v12 offset:16384
 s_waitcnt lgkmcnt(3)
 v_mfma_f32_32x32x16_bf16 v[64:79], v[36:39], a[68:71], v[64:79]
 ds_read_b128 v[52:55], v13 offset:16384
 s_waitcnt lgkmcnt(3)
 v_mfma_f32_32x32x16_bf16 v[64:79], v[40:43], a[72:75], v[64:79]
 ds_read_b128 v[56:59], v14 offset:16384
 s_add_u32 m0, s56, 65536
 s_add_u32 s3, s55, s67
 buffer_load_dwordx4 v1, s[4:7], s3 offen sc1 lds
 s_waitcnt lgkmcnt(3)
 v_mfma_f32_32x32x16_bf16 v[64:79], v[44:47], a[76:79], v[64:79]
 ds_read_b128 v[60:63], v15 offset:16384
 s_waitcnt vmcnt(7)
 s_cmp_eq_u32 s61, 0
 s_cbranch_scc1 L_pf_92
 s_lshl_b32 s3, s61, 2
 s_add_u32 s3, s3, s59
 s_sub_u32 s3, s3, 4
 v_mov_b32 v3, 1
 s_mov_b64 exec, 1
 buffer_atomic_add v3, v5, s[4:7], s3 offen
 s_mov_b64 exec, -1
 s_mov_b32 s61, 0
L_pf_92:
 s_waitcnt lgkmcnt(3)
 v_mfma_f32_32x32x16_bf16 v[64:79], v[48:51], a[80:83], v[64:79]
 ds_read_b128 v[32:35], v8 offset:24576
 s_waitcnt lgkmcnt(3)
 v_mfma_f32_32x32x16_bf16 v[64:79], v[52:55], a[84:87], v[64:79]
 ds_read_b128 v[36:39], v9 offset:24576
 s_add_u32 m0, s56, 66560
 s_add_u32 s3, s55, s67
 buffer_load_dwordx4 v24, s[4:7], s3 offen sc1 lds
 s_waitcnt lgkmcnt(3)
 v_mfma_f32_32x32x16_bf16 v[64:79], v[56:59], a[88:91], v[64:79]
 ds_read_b128 v[40:43], v10 offset:24576
 s_waitcnt lgkmcnt(3)
 v_mfma_f32_32x32x16_bf16 v[64:79], v[60:63], a[92:95], v[64:79]
 ds_read_b128 v[44:47], v11 offset:24576
 s_waitcnt lgkmcnt(3)
 v_mfma_f32_32x32x16_bf16 v[64:79], v[32:35], a[96:99], v[64:79]
 ds_read_b128 v[48:51], v12 offset:24576
 s_add_u32 m0, s56, 73728
 s_add_u32 s3, s55, s68
 buffer_load_dwordx4 v1, s[4:7], s3 offen sc1 lds
 s_waitcnt lgkmcnt(3)
 v_mfma_f32_32x32x16_bf16 v[64:79], v[36:39], a[100:103], v[64:79]
 ds_read_b128 v[52:55], v13 offset:24576
 s_waitcnt lgkmcnt(3)
 v_mfma_f32_32x32x16_bf16 v[64:79], v[40:43], a[104:107], v[64:79]
 ds_read_b128 v[56:59], v14 offset:24576
 s_waitcnt lgkmcnt(3)
 v_mfma_f32_32x32x16_bf16 v[64:79], v[44:47], a[108:111], v[64:79]
 ds_read_b128 v[60:63], v15 offset:24576
 s_add_u32 m0, s56, 74752
 s_add_u32 s3, s55, s68
 buffer_load_dwordx4 v24, s[4:7], s3 offen sc1 lds
 s_waitcnt lgkmcnt(3)
 v_mfma_f32_32x32x16_bf16 v[64:79], v[48:51], a[112:115], v[64:79]
 ds_read_b128 v[32:35], v8 offset:32768
 s_waitcnt lgkmcnt(3)
 v_mfma_f32_32x32x16_bf16 v[64:79], v[52:55], a[116:119], v[64:79]
 ds_read_b128 v[36:39], v9 offset:32768
 s_waitcnt lgkmcnt(3)
 v_mfma_f32_32x32x16_bf16 v[64:79], v[56:59], a[120:123], v[64:79]
 ds_read_b128 v[40:43], v10 offset:32768
 s_waitcnt lgkmcnt(3)
 v_mfma_f32_32x32x16_bf16 v[64:79], v[60:63], a[124:127], v[64:79]
 ds_read_b128 v[44:47], v11 offset:32768
 s_waitcnt lgkmcnt(3)
 v_mfma_f32_32x32x16_bf16 v[64:79], v[32:35], a[128:131], v[64:79]
 ds_read_b128 v[48:51], v12 offset:32768
 s_waitcnt lgkmcnt(3)
 v_mfma_f32_32x32x16_bf16 v[64:79], v[36:39], a[132:135], v[64:79]
 ds_read_b128 v[52:55], v13 offset:32768
 s_waitcnt lgkmcnt(3)
 v_mfma_f32_32x32x16_bf16 v[64:79], v[40:43], a[136:139], v[64:79]
 ds_read_b128 v[56:59], v14 offset:32768
 s_waitcnt lgkmcnt(3)
 v_mfma_f32_32x32x16_bf16 v[64:79], v[44:47], a[140:143], v[64:79]
 ds_read_b128 v[60:63], v15 offset:32768
 s_waitcnt lgkmcnt(3)
 v_mfma_f32_32x32x16_bf16 v[64:79], v[48:51], a[144:147], v[64:79]
 s_waitcnt lgkmcnt(2)
 v_mfma_f32_32x32x16_bf16 v[64:79], v[52:55], a[148:151], v[64:79]
 s_waitcnt lgkmcnt(1)
 v_mfma_f32_32x32x16_bf16 v[64:79], v[56:59], a[152:155], v[64:79]
 s_waitcnt lgkmcnt(0)
 v_mfma_f32_32x32x16_bf16 v[64:79], v[60:63], a[156:159], v[64:79]
 s_lshl_b32 s3, s60, 19
 s_add_u32 s3, s3, s58
 s_xor_b32 s3, s3, s82
 s_nop 8
 v_cvt_pk_bf16_f32 v80, v64, v65
 v_cvt_pk_bf16_f32 v81, v66, v67
 v_cvt_pk_bf16_f32 v82, v72, v73
 v_cvt_pk_bf16_f32 v83, v74, v75
 buffer_store_dwordx4 v[80:83], v4, s[4:7], s3 offen offset:0 sc1
 v_cvt_pk_bf16_f32 v84, v68, v69
 v_cvt_pk_bf16_f32 v85, v70, v71
 v_cvt_pk_bf16_f32 v86, v76, v77
 v_cvt_pk_bf16_f32 v87, v78, v79
 buffer_store_dwordx4 v[84:87], v4, s[4:7], s3 offen offset:512 sc1
 s_mov_b32 s61, s54
 s_cmp_lg_u32 s54, 1
 s_cbranch_scc1 L_f1_93
 s_waitcnt vmcnt(0)
 s_cmp_eq_u32 s61, 0
 s_cbranch_scc1 L_pf_94
 s_lshl_b32 s3, s61, 2
 s_add_u32 s3, s3, s59
 s_sub_u32 s3, s3, 4
 v_mov_b32 v3, 1
 s_mov_b64 exec, 1
 buffer_atomic_add v3, v5, s[4:7], s3 offen
 s_mov_b64 exec, -1
 s_mov_b32 s61, 0
L_pf_94:
 s_mov_b32 s8, s38
 s_and_b32 s9, s39, 0xffff
 s_mov_b32 s10, 2621440
 s_mov_b32 s11, 0x00020000
 s_mov_b32 s12, s40
 s_and_b32 s13, s41, 0xffff
 s_mov_b32 s14, 1280
 s_mov_b32 s15, 0x00020000
 v_lshlrev_b32 v130, 4, v0
 s_lshl_b32 s73, s70, 12
 s_add_u32 s74, s73, 2
 buffer_load_dwordx4 v[96:99], v130, s[8:11], s73 offen offset:0
 buffer_load_dwordx4 v[100:103], v130, s[8:11], s73 offen offset:1024
 buffer_load_dwordx4 v[112:115], v130, s[8:11], s74 offen offset:0
 buffer_load_dwordx4 v[116:119], v130, s[8:11], s74 offen offset:1024
 s_lshl_b32 s3, s70, 1
 buffer_load_ushort v128, off, s[12:15], s3
 s_branch L_f2_95
L_f1_93:
 s_waitcnt vmcnt(2)
L_f2_95:
 s_barrier
 s_mov_b32 s60, s54
 s_add_u32 s54, s54, 1
 s_mul_i32 s55, s54, 40960
 s_mul_i32 s3, s50, 10240
 s_add_u32 s55, s55, s3
 s_add_u32 s55, s55, 192937984
 ds_read_b128 v[32:35], v16 offset:0
 ds_read_b128 v[36:39], v17 offset:0
 ds_read_b128 v[40:43], v18 offset:0
 ds_read_b128 v[44:47], v19 offset:0
 s_waitcnt lgkmcnt(3)
 v_mfma_f32_32x32x16_bf16 v[64:79], v[32:35], a[0:3], 0
 ds_read_b128 v[48:51], v20 offset:0
 s_add_u32 m0, s56, 0
 s_add_u32 s3, s55, s64
 buffer_load_dwordx4 v1, s[4:7], s3 offen sc1 lds
 s_waitcnt lgkmcnt(3)
 v_mfma_f32_32x32x16_bf16 v[64:79], v[36:39], a[4:7], v[64:79]
 ds_read_b128 v[52:55], v21 offset:0
 s_waitcnt lgkmcnt(3)
 v_mfma_f32_32x32x16_bf16 v[64:79], v[40:43], a[8:11], v[64:79]
 ds_read_b128 v[56:59], v22 offset:0
 s_waitcnt lgkmcnt(3)
 v_mfma_f32_32x32x16_bf16 v[64:79], v[44:47], a[12:15], v[64:79]
 ds_read_b128 v[60:63], v23 offset:0
 s_add_u32 m0, s56, 1024
 s_add_u32 s3, s55, s64
 buffer_load_dwordx4 v24, s[4:7], s3 offen sc1 lds
 s_waitcnt lgkmcnt(3)
 v_mfma_f32_32x32x16_bf16 v[64:79], v[48:51], a[16:19], v[64:79]
 ds_read_b128 v[32:35], v16 offset:8192
 s_waitcnt lgkmcnt(3)
 v_mfma_f32_32x32x16_bf16 v[64:79], v[52:55], a[20:23], v[64:79]
 ds_read_b128 v[36:39], v17 offset:8192
 s_waitcnt lgkmcnt(3)
 v_mfma_f32_32x32x16_bf16 v[64:79], v[56:59], a[24:27], v[64:79]
 ds_read_b128 v[40:43], v18 offset:8192
 s_add_u32 m0, s56, 8192
 s_add_u32 s3, s55, s65
 buffer_load_dwordx4 v1, s[4:7], s3 offen sc1 lds
 s_waitcnt lgkmcnt(3)
 v_mfma_f32_32x32x16_bf16 v[64:79], v[60:63], a[28:31], v[64:79]
 ds_read_b128 v[44:47], v19 offset:8192
 s_waitcnt lgkmcnt(3)
 v_mfma_f32_32x32x16_bf16 v[64:79], v[32:35], a[32:35], v[64:79]
 ds_read_b128 v[48:51], v20 offset:8192
 s_waitcnt lgkmcnt(3)
 v_mfma_f32_32x32x16_bf16 v[64:79], v[36:39], a[36:39], v[64:79]
 ds_read_b128 v[52:55], v21 offset:8192
 s_add_u32 m0, s56, 9216
 s_add_u32 s3, s55, s65
 buffer_load_dwordx4 v24, s[4:7], s3 offen sc1 lds
 s_waitcnt lgkmcnt(3)
 v_mfma_f32_32x32x16_bf16 v[64:79], v[40:43], a[40:43], v[64:79]
 ds_read_b128 v[56:59], v22 offset:8192
 s_waitcnt lgkmcnt(3)
 v_mfma_f32_32x32x16_bf16 v[64:79], v[44:47], a[44:47], v[64:79]
 ds_read_b128 v[60:63], v23 offset:8192
 s_waitcnt lgkmcnt(3)
 v_mfma_f32_32x32x16_bf16 v[64:79], v[48:51], a[48:51], v[64:79]
 ds_read_b128 v[32:35], v16 offset:16384
 s_add_u32 m0, s56, 16384
 s_add_u32 s3, s55, s66
 buffer_load_dwordx4 v1, s[4:7], s3 offen sc1 lds
 s_waitcnt lgkmcnt(3)
 v_mfma_f32_32x32x16_bf16 v[64:79], v[52:55], a[52:55], v[64:79]
 ds_read_b128 v[36:39], v17 offset:16384
 s_waitcnt lgkmcnt(3)
 v_mfma_f32_32x32x16_bf16 v[64:79], v[56:59], a[56:59], v[64:79]
 ds_read_b128 v[40:43], v18 offset:16384
 s_waitcnt lgkmcnt(3)
 v_mfma_f32_32x32x16_bf16 v[64:79], v[60:63], a[60:63], v[64:79]
 ds_read_b128 v[44:47], v19 offset:16384
 s_add_u32 m0, s56, 17408
 s_add_u32 s3, s55, s66
 buffer_load_dwordx4 v24, s[4:7], s3 offen sc1 lds
 s_waitcnt lgkmcnt(3)
 v_mfma_f32_32x32x16_bf16 v[64:79], v[32:35], a[64:67], v[64:79]
 ds_read_b128 v[48:51], v20 offset:16384
 s_waitcnt lgkmcnt(3)
 v_mfma_f32_32x32x16_bf16 v[64:79], v[36:39], a[68:71], v[64:79]
 ds_read_b128 v[52:55], v21 offset:16384
 s_waitcnt lgkmcnt(3)
 v_mfma_f32_32x32x16_bf16 v[64:79], v[40:43], a[72:75], v[64:79]
 ds_read_b128 v[56:59], v22 offset:16384
 s_add_u32 m0, s56, 24576
 s_add_u32 s3, s55, s67
 buffer_load_dwordx4 v1, s[4:7], s3 offen sc1 lds
 s_waitcnt lgkmcnt(3)
 v_mfma_f32_32x32x16_bf16 v[64:79], v[44:47], a[76:79], v[64:79]
 ds_read_b128 v[60:63], v23 offset:16384
 s_waitcnt vmcnt(7)
 s_cmp_eq_u32 s61, 0
 s_cbranch_scc1 L_pf_96
 s_lshl_b32 s3, s61, 2
 s_add_u32 s3, s3, s59
 s_sub_u32 s3, s3, 4
 v_mov_b32 v3, 1
 s_mov_b64 exec, 1
 buffer_atomic_add v3, v5, s[4:7], s3 offen
 s_mov_b64 exec, -1
 s_mov_b32 s61, 0
L_pf_96:
 s_waitcnt lgkmcnt(3)
 v_mfma_f32_32x32x16_bf16 v[64:79], v[48:51], a[80:83], v[64:79]
 ds_read_b128 v[32:35], v16 offset:24576
 s_waitcnt lgkmcnt(3)
 v_mfma_f32_32x32x16_bf16 v[64:79], v[52:55], a[84:87], v[64:79]
 ds_read_b128 v[36:39], v17 offset:24576
 s_add_u32 m0, s56, 25600
 s_add_u32 s3, s55, s67
 buffer_load_dwordx4 v24, s[4:7], s3 offen sc1 lds
 s_waitcnt lgkmcnt(3)
 v_mfma_f32_32x32x16_bf16 v[64:79], v[56:59], a[88:91], v[64:79]
 ds_read_b128 v[40:43], v18 offset:24576
 s_waitcnt lgkmcnt(3)
 v_mfma_f32_32x32x16_bf16 v[64:79], v[60:63], a[92:95], v[64:79]
 ds_read_b128 v[44:47], v19 offset:24576
 s_waitcnt lgkmcnt(3)
 v_mfma_f32_32x32x16_bf16 v[64:79], v[32:35], a[96:99], v[64:79]
 ds_read_b128 v[48:51], v20 offset:24576
 s_add_u32 m0, s56, 32768
 s_add_u32 s3, s55, s68
 buffer_load_dwordx4 v1, s[4:7], s3 offen sc1 lds
 s_waitcnt lgkmcnt(3)
 v_mfma_f32_32x32x16_bf16 v[64:79], v[36:39], a[100:103], v[64:79]
 ds_read_b128 v[52:55], v21 offset:24576
 s_waitcnt lgkmcnt(3)
 v_mfma_f32_32x32x16_bf16 v[64:79], v[40:43], a[104:107], v[64:79]
 ds_read_b128 v[56:59], v22 offset:24576
 s_waitcnt lgkmcnt(3)
 v_mfma_f32_32x32x16_bf16 v[64:79], v[44:47], a[108:111], v[64:79]
 ds_read_b128 v[60:63], v23 offset:24576
 s_add_u32 m0, s56, 33792
 s_add_u32 s3, s55, s68
 buffer_load_dwordx4 v24, s[4:7], s3 offen sc1 lds
 s_waitcnt lgkmcnt(3)
 v_mfma_f32_32x32x16_bf16 v[64:79], v[48:51], a[112:115], v[64:79]
 ds_read_b128 v[32:35], v16 offset:32768
 s_waitcnt lgkmcnt(3)
 v_mfma_f32_32x32x16_bf16 v[64:79], v[52:55], a[116:119], v[64:79]
 ds_read_b128 v[36:39], v17 offset:32768
 s_waitcnt lgkmcnt(3)
 v_mfma_f32_32x32x16_bf16 v[64:79], v[56:59], a[120:123], v[64:79]
 ds_read_b128 v[40:43], v18 offset:32768
 s_waitcnt lgkmcnt(3)
 v_mfma_f32_32x32x16_bf16 v[64:79], v[60:63], a[124:127], v[64:79]
 ds_read_b128 v[44:47], v19 offset:32768
 s_waitcnt lgkmcnt(3)
 v_mfma_f32_32x32x16_bf16 v[64:79], v[32:35], a[128:131], v[64:79]
 ds_read_b128 v[48:51], v20 offset:32768
 s_waitcnt lgkmcnt(3)
 v_mfma_f32_32x32x16_bf16 v[64:79], v[36:39], a[132:135], v[64:79]
 ds_read_b128 v[52:55], v21 offset:32768
 s_waitcnt lgkmcnt(3)
 v_mfma_f32_32x32x16_bf16 v[64:79], v[40:43], a[136:139], v[64:79]
 ds_read_b128 v[56:59], v22 offset:32768
 s_waitcnt lgkmcnt(3)
 v_mfma_f32_32x32x16_bf16 v[64:79], v[44:47], a[140:143], v[64:79]
 ds_read_b128 v[60:63], v23 offset:32768
 s_waitcnt lgkmcnt(3)
 v_mfma_f32_32x32x16_bf16 v[64:79], v[48:51], a[144:147], v[64:79]
 s_waitcnt lgkmcnt(2)
 v_mfma_f32_32x32x16_bf16 v[64:79], v[52:55], a[148:151], v[64:79]
 s_waitcnt lgkmcnt(1)
 v_mfma_f32_32x32x16_bf16 v[64:79], v[56:59], a[152:155], v[64:79]
 s_waitcnt lgkmcnt(0)
 v_mfma_f32_32x32x16_bf16 v[64:79], v[60:63], a[156:159], v[64:79]
 s_lshl_b32 s3, s60, 19
 s_add_u32 s3, s3, s58
 s_xor_b32 s3, s3, s82
 s_nop 8
 v_cvt_pk_bf16_f32 v88, v64, v65
 v_cvt_pk_bf16_f32 v89, v66, v67
 v_cvt_pk_bf16_f32 v90, v72, v73
 v_cvt_pk_bf16_f32 v91, v74, v75
 buffer_store_dwordx4 v[88:91], v4, s[4:7], s3 offen offset:0 sc1
 v_cvt_pk_bf16_f32 v92, v68, v69
 v_cvt_pk_bf16_f32 v93, v70, v71
 v_cvt_pk_bf16_f32 v94, v76, v77
 v_cvt_pk_bf16_f32 v95, v78, v79
 buffer_store_dwordx4 v[92:95], v4, s[4:7], s3 offen offset:512 sc1
 s_mov_b32 s61, s54
 s_waitcnt vmcnt(2)
 s_cmp_lg_u32 s54, 4
 s_cbranch_scc1 L_cv_97
 s_waitcnt vmcnt(0)
 s_cmp_eq_u32 s61, 0
 s_cbranch_scc1 L_pf_98
 s_lshl_b32 s3, s61, 2
 s_add_u32 s3, s3, s59
 s_sub_u32 s3, s3, 4
 v_mov_b32 v3, 1
 s_mov_b64 exec, 1
 buffer_atomic_add v3, v5, s[4:7], s3 offen
 s_mov_b64 exec, -1
 s_mov_b32 s61, 0
L_pf_98:
 s_mul_i32 s71, s50, 13312
 s_add_u32 s71, s71, 81920
 s_mov_b32 s70, s75
 s_mov_b32 s69, 640
 s_getpc_b64 s[76:77]
L_ca_99:
 s_add_u32 s76, s76, L_conv0-L_ca_99
 s_addc_u32 s77, s77, -1
 s_swappc_b64 s[76:77], s[76:77]
 s_waitcnt vmcnt(0)
 s_barrier
 s_cmp_lg_u32 s50, 3
 s_cbranch_scc1 L_ar_100
 s_mov_b32 s96, s44
 s_and_b32 s97, s45, 0xffff
 s_mov_b32 s98, 256
 s_mov_b32 s99, 0x00020000
 v_mov_b32 v1, 1
 s_mov_b64 exec, 1
 buffer_atomic_add v1, off, s[96:99], 0 offset:8 sc0
 s_waitcnt vmcnt(0)
 v_cmp_eq_u32 vcc, 159, v1
 s_cbranch_vccz L_aw_101
 buffer_store_dword v1, off, s[96:99], 0 offset:136 sc1
L_aw_101:
 s_mov_b64 exec, -1
L_ar_100:
 s_cmp_lg_u32 s50, 0
 s_cbranch_scc1 L_ww_102
 s_mov_b32 s96, s44
 s_and_b32 s97, s45, 0xffff
 s_mov_b32 s98, 256
 s_mov_b32 s99, 0x00020000
 v_mov_b32 v24, 208
 s_mov_b32 s51, 0
 s_mov_b64 exec, 1
L_wb_103:
 buffer_load_dword v25, v24, s[96:99], 0 offen sc1
 s_waitcnt vmcnt(0)
 v_cmp_eq_u32 vcc, 0, v25
 s_cbranch_vccz L_wbd_104
 s_sleep 2
 s_add_u32 s51, s51, 1
 s_cmp_lt_u32 s51, 131072
 s_cbranch_scc1 L_wb_103
 s_branch L_bail
L_wbd_104:
 s_mov_b64 exec, -1
L_ww_102:
 s_barrier
 s_mov_b32 s70, s75
 s_mov_b32 s8, s38
 s_and_b32 s9, s39, 0xffff
 s_mov_b32 s10, 2621440
 s_mov_b32 s11, 0x00020000
 s_mov_b32 s12, s40
 s_and_b32 s13, s41, 0xffff
 s_mov_b32 s14, 1280
 s_mov_b32 s15, 0x00020000
 v_lshlrev_b32 v130, 4, v0
 s_lshl_b32 s73, s70, 12
 s_add_u32 s74, s73, 2
 buffer_load_dwordx4 v[96:99], v130, s[8:11], s73 offen offset:0
 buffer_load_dwordx4 v[100:103], v130, s[8:11], s73 offen offset:1024
 buffer_load_dwordx4 v[104:107], v130, s[8:11], s73 offen offset:2048
 buffer_load_dwordx4 v[108:111], v130, s[8:11], s73 offen offset:3072
 buffer_load_dwordx4 v[112:115], v130, s[8:11], s74 offen offset:0
 buffer_load_dwordx4 v[116:119], v130, s[8:11], s74 offen offset:1024
 buffer_load_dwordx4 v[120:123], v130, s[8:11], s74 offen offset:2048
 buffer_load_dwordx4 v[124:127], v130, s[8:11], s74 offen offset:3072
 s_lshl_b32 s3, s70, 1
 buffer_load_ushort v128, off, s[12:15], s3
 s_lshl_b32 s3, s70, 12
 s_add_u32 s3, s3, 198180864
 buffer_load_dwordx4 v[240:243], v130, s[4:7], s3 offen offset:0 sc1
 buffer_load_dwordx4 v[244:247], v130, s[4:7], s3 offen offset:1024 sc1
 buffer_load_dwordx4 v[248:251], v130, s[4:7], s3 offen offset:2048 sc1
 buffer_load_dwordx4 v[252:255], v130, s[4:7], s3 offen offset:3072 sc1
 v_lshrrev_b32 v1, 4, v0
 s_mov_b32 s3, 1280
 v_mul_lo_u32 v1, v1, s3
 v_and_b32 v3, 15, v0
 v_lshl_add_u32 v1, v3, 4, v1
 v_add_u32 v6, 5120, v1
 v_mov_b32 v24, v6
 v_and_b32 v2, 31, v0
 v_lshlrev_b32 v2, 8, v2
 v_lshrrev_b32 v4, 5, v0
 v_xor_b32 v4, v4, v3
 v_xor_b32 v8, 0, v4
 v_lshl_add_u32 v8, v8, 4, v2
 v_add_u32 v16, 40960, v8
 v_xor_b32 v9, 2, v4
 v_lshl_add_u32 v9, v9, 4, v2
 v_add_u32 v17, 40960, v9
 v_xor_b32 v10, 4, v4
 v_lshl_add_u32 v10, v10, 4, v2
 v_add_u32 v18, 40960, v10
 v_xor_b32 v11, 6, v4
 v_lshl_add_u32 v11, v11, 4, v2
 v_add_u32 v19, 40960, v11
 v_xor_b32 v12, 8, v4
 v_lshl_add_u32 v12, v12, 4, v2
 v_add_u32 v20, 40960, v12
 v_xor_b32 v13, 10, v4
 v_lshl_add_u32 v13, v13, 4, v2
 v_add_u32 v21, 40960, v13
 v_xor_b32 v14, 12, v4
 v_lshl_add_u32 v14, v14, 4, v2
 v_add_u32 v22, 40960, v14
 v_xor_b32 v15, 14, v4
 v_lshl_add_u32 v15, v15, 4, v2
 v_add_u32 v23, 40960, v15
 v_lshrrev_b32 v4, 5, v0
 v_lshlrev_b32 v4, 8, v4
 v_lshl_add_u32 v4, v3, 4, v4
 v_and_b32 v2, 16, v0
 v_lshl_add_u32 v4, v2, 6, v4
 s_lshl_b32 s3, s50, 11
 v_add_u32 v4, s3, v4
 v_mul_u32_u24 v5, 49152, v0
 v_mov_b32 v7, 163776
L_cv_97:
 s_cmp_lt_u32 s54, 10
 s_cbranch_scc1 L_qkvv_pre
 s_waitcnt vmcnt(0)
 s_cmp_eq_u32 s61, 0
 s_cbranch_scc1 L_pf_105
 s_lshl_b32 s3, s61, 2
 s_add_u32 s3, s3, s59
 s_sub_u32 s3, s3, 4
 v_mov_b32 v3, 1
 s_mov_b64 exec, 1
 buffer_atomic_add v3, v5, s[4:7], s3 offen
 s_mov_b64 exec, -1
 s_mov_b32 s61, 0
L_pf_105:
 s_mul_i32 s71, s50, 13312
 s_add_u32 s71, s71, 81920
 s_mov_b32 s70, s75
 s_mov_b32 s69, 640
 s_getpc_b64 s[76:77]
L_ca_106:
 s_add_u32 s76, s76, L_conv1-L_ca_106
 s_addc_u32 s77, s77, -1
 s_swappc_b64 s[76:77], s[76:77]
 s_waitcnt vmcnt(0)
 s_barrier
 s_cmp_lg_u32 s50, 3
 s_cbranch_scc1 L_ar_107
 s_mov_b32 s96, s44
 s_and_b32 s97, s45, 0xffff
 s_mov_b32 s98, 256
 s_mov_b32 s99, 0x00020000
 v_mov_b32 v1, 1
 s_mov_b64 exec, 1
 buffer_atomic_add v1, off, s[96:99], 0 offset:76 sc0
 s_waitcnt vmcnt(0)
 v_cmp_eq_u32 vcc, 127, v1
 s_cbranch_vccz L_aw_108
 buffer_store_dword v1, off, s[96:99], 0 offset:204 sc1
L_aw_108:
 s_mov_b64 exec, -1
L_ar_107:
 v_lshrrev_b32 v1, 4, v0
 s_mov_b32 s3, 1280
 v_mul_lo_u32 v1, v1, s3
 v_and_b32 v3, 15, v0
 v_lshl_add_u32 v1, v3, 4, v1
 v_add_u32 v6, 5120, v1
 v_mov_b32 v24, v6
 v_and_b32 v2, 31, v0
 v_lshlrev_b32 v2, 8, v2
 v_lshrrev_b32 v4, 5, v0
 v_xor_b32 v4, v4, v3
 v_xor_b32 v8, 0, v4
 v_lshl_add_u32 v8, v8, 4, v2
 v_add_u32 v16, 40960, v8
 v_xor_b32 v9, 2, v4
 v_lshl_add_u32 v9, v9, 4, v2
 v_add_u32 v17, 40960, v9
 v_xor_b32 v10, 4, v4
 v_lshl_add_u32 v10, v10, 4, v2
 v_add_u32 v18, 40960, v10
 v_xor_b32 v11, 6, v4
 v_lshl_add_u32 v11, v11, 4, v2
 v_add_u32 v19, 40960, v11
 v_xor_b32 v12, 8, v4
 v_lshl_add_u32 v12, v12, 4, v2
 v_add_u32 v20, 40960, v12
 v_xor_b32 v13, 10, v4
 v_lshl_add_u32 v13, v13, 4, v2
 v_add_u32 v21, 40960, v13
 v_xor_b32 v14, 12, v4
 v_lshl_add_u32 v14, v14, 4, v2
 v_add_u32 v22, 40960, v14
 v_xor_b32 v15, 14, v4
 v_lshl_add_u32 v15, v15, 4, v2
 v_add_u32 v23, 40960, v15
 v_lshrrev_b32 v4, 5, v0
 v_lshlrev_b32 v4, 8, v4
 v_lshl_add_u32 v4, v3, 4, v4
 v_and_b32 v2, 16, v0
 v_lshl_add_u32 v4, v2, 6, v4
 s_lshl_b32 s3, s50, 11
 v_add_u32 v4, s3, v4
 v_mul_u32_u24 v5, 49152, v0
 v_mov_b32 v7, 163776
 s_cmp_lg_u32 s50, 0
 s_cbranch_scc1 L_ww_109
 s_mov_b32 s96, s44
 s_and_b32 s97, s45, 0xffff
 s_mov_b32 s98, 256
 s_mov_b32 s99, 0x00020000
 v_mov_b32 v25, 200
 s_mov_b32 s51, 0
 s_mov_b64 exec, 1
L_wb_110:
 buffer_load_dword v26, v25, s[96:99], 0 offen sc1
 s_waitcnt vmcnt(0)
 v_cmp_eq_u32 vcc, 0, v26
 s_cbranch_vccz L_wbd_111
 s_sleep 2
 s_add_u32 s51, s51, 1
 s_cmp_lt_u32 s51, 131072
 s_cbranch_scc1 L_wb_110
 s_branch L_bail
L_wbd_111:
 s_mov_b64 exec, -1
L_ww_109:
 s_barrier
 s_mov_b32 s96, s44
 s_and_b32 s97, s45, 0xffff
 s_mov_b32 s98, 256
 s_mov_b32 s99, 0x00020000
 v_mov_b32 v25, 132
 s_mov_b32 s3, 144
 v_writelane_b32 v25, s3, 1
 s_mov_b32 s51, 0
 s_mov_b64 exec, 3
L_wb_112:
 buffer_load_dword v26, v25, s[96:99], 0 offen sc1
 s_waitcnt vmcnt(0)
 v_cmp_eq_u32 vcc, 0, v26
 s_cbranch_vccz L_wbd_113
 s_sleep 2
 s_add_u32 s51, s51, 1
 s_cmp_lt_u32 s51, 131072
 s_cbranch_scc1 L_wb_112
 s_branch L_bail
L_wbd_113:
 s_mov_b64 exec, -1
 v_readlane_b32 s81, v26, 1
 s_nop 3
 s_sub_u32 s81, s81, 1
 s_xor_b32 s78, s81, 0
 s_lshl_b32 s78, s78, 13
 s_xor_b32 s79, s78, 8192
 s_cmp_lt_u32 s62, 96
 s_cselect_b32 s3, s79, s78
 s_lshl_b32 s62, s62, 8
 s_lshr_b32 s100, s62, 13
 s_lshl_b32 s100, s100, 13
 s_add_u32 s62, s62, s100
 s_add_u32 s62, s62, s3
 s_add_u32 s62, s62, 229376
 s_add_u32 s63, s59, s78
 s_add_u32 s63, s63, 16344
 s_mov_b32 s72, 0
L_qkvv_block:
 s_lshl_b32 s55, s54, 2
 s_add_u32 s55, s55, s62
 s_sub_u32 s55, s55, 40
 s_cmp_lg_u32 s50, 0
 s_cselect_b32 s3, 268435456, s55
 v_mov_b32 v6, 8
 s_mov_b64 exec, 15
 v_mov_b32 v6, 0
 buffer_atomic_add v6, v5, s[4:7], s3 offen sc0
 s_mov_b64 exec, -1
 s_waitcnt vmcnt(0)
 s_cmp_eq_u32 s61, 0
 s_cbranch_scc1 L_pf_116
 s_lshl_b32 s3, s61, 2
 s_add_u32 s3, s3, s59
 s_sub_u32 s3, s3, 4
 v_mov_b32 v3, 1
 s_mov_b64 exec, 1
 buffer_atomic_add v3, v5, s[4:7], s3 offen
 s_mov_b64 exec, -1
 s_mov_b32 s61, 0
L_pf_116:
 s_cmp_lg_u32 s50, 0
 s_cbranch_scc1 L_w_114
 v_cmp_gt_u32 vcc, 8, v6
 s_cbranch_vccz L_w_114
 s_mov_b32 s51, 0
 s_mov_b64 exec, 15
 v_mov_b32 v28, 0
 buffer_atomic_add v28, v5, s[4:7], s55 offen sc0
 s_sleep 5
L_wc_117:
 v_mov_b32 v29, 0
 buffer_atomic_add v29, v5, s[4:7], s55 offen sc0
 s_waitcnt vmcnt(1)
 v_cmp_gt_u32 vcc, 8, v28
 s_cbranch_vccz L_wcd_118
 v_mov_b32 v28, 0
 buffer_atomic_add v28, v5, s[4:7], s55 offen sc0
 s_waitcnt vmcnt(1)
 v_cmp_gt_u32 vcc, 8, v29
 s_cbranch_vccz L_wcd_118
 s_add_u32 s51, s51, 1
 s_cmp_lt_u32 s51, 131072
 s_cbranch_scc1 L_wc_117
 s_branch L_bail
L_wcd_118:
 s_mov_b64 exec, -1
L_w_114:
 s_barrier
L_qkvv_loop:
 s_cmp_lg_u32 s54, 17
 s_cbranch_scc1 L_c2_119
 s_cmp_lg_u32 s50, 0
 s_cbranch_scc1 L_ww_120
 s_mov_b32 s96, s44
 s_and_b32 s97, s45, 0xffff
 s_mov_b32 s98, 256
 s_mov_b32 s99, 0x00020000
 v_mov_b32 v25, 140
 s_mov_b32 s51, 0
 s_mov_b64 exec, 1
L_wb_121:
 buffer_load_dword v26, v25, s[96:99], 0 offen sc1
 s_waitcnt vmcnt(0)
 v_cmp_eq_u32 vcc, 0, v26
 s_cbranch_vccz L_wbd_122
 s_sleep 2
 s_add_u32 s51, s51, 1
 s_cmp_lt_u32 s51, 131072
 s_cbranch_scc1 L_wb_121
 s_branch L_bail
L_wbd_122:
 s_mov_b64 exec, -1
L_ww_120:
 s_barrier
L_c2_119:
 s_sub_u32 s60, s54, 10
 s_cmp_lg_u32 s72, 0
 s_cbranch_scc1 L_hv_123
 s_mul_i32 s55, s60, 40960
 s_mul_i32 s3, s50, 10240
 s_add_u32 s55, s55, s3
 s_add_u32 s55, s55, 195559424
 s_add_u32 m0, s56, 40960
 s_add_u32 s3, s55, s64
 buffer_load_dwordx4 v1, s[4:7], s3 offen sc1 lds
 s_add_u32 m0, s56, 41984
 s_add_u32 s3, s55, s64
 buffer_load_dwordx4 v24, s[4:7], s3 offen sc1 lds
 s_add_u32 m0, s56, 49152
 s_add_u32 s3, s55, s65
 buffer_load_dwordx4 v1, s[4:7], s3 offen sc1 lds
 s_add_u32 m0, s56, 50176
 s_add_u32 s3, s55, s65
 buffer_load_dwordx4 v24, s[4:7], s3 offen sc1 lds
 s_add_u32 m0, s56, 57344
 s_add_u32 s3, s55, s66
 buffer_load_dwordx4 v1, s[4:7], s3 offen sc1 lds
 s_add_u32 m0, s56, 58368
 s_add_u32 s3, s55, s66
 buffer_load_dwordx4 v24, s[4:7], s3 offen sc1 lds
 s_add_u32 m0, s56, 65536
 s_add_u32 s3, s55, s67
 buffer_load_dwordx4 v1, s[4:7], s3 offen sc1 lds
 s_add_u32 m0, s56, 66560
 s_add_u32 s3, s55, s67
 buffer_load_dwordx4 v24, s[4:7], s3 offen sc1 lds
 s_add_u32 m0, s56, 73728
 s_add_u32 s3, s55, s68
 buffer_load_dwordx4 v1, s[4:7], s3 offen sc1 lds
 s_add_u32 m0, s56, 74752
 s_add_u32 s3, s55, s68
 buffer_load_dwordx4 v24, s[4:7], s3 offen sc1 lds
L_hv_123:
 s_mov_b32 s72, 0
 s_min_u32 s51, s54, 63
 s_mul_i32 s55, s51, 40960
 s_mul_i32 s3, s50, 10240
 s_add_u32 s55, s55, s3
 s_add_u32 s55, s55, 192937984
 s_waitcnt vmcnt(8)
 s_barrier
 ds_read_b128 v[32:35], v16 offset:0
 ds_read_b128 v[36:39], v17 offset:0
 ds_read_b128 v[40:43], v18 offset:0
 ds_read_b128 v[44:47], v19 offset:0
 s_waitcnt lgkmcnt(3)
 v_mfma_f32_32x32x16_bf16 v[64:79], v[32:35], a[0:3], 0
 ds_read_b128 v[48:51], v20 offset:0
 s_add_u32 m0, s56, 0
 s_add_u32 s3, s55, s64
 buffer_load_dwordx4 v1, s[4:7], s3 offen sc1 lds
 s_waitcnt lgkmcnt(3)
 v_mfma_f32_32x32x16_bf16 v[64:79], v[36:39], a[4:7], v[64:79]
 ds_read_b128 v[52:55], v21 offset:0
 s_waitcnt lgkmcnt(3)
 v_mfma_f32_32x32x16_bf16 v[64:79], v[40:43], a[8:11], v[64:79]
 ds_read_b128 v[56:59], v22 offset:0
 s_waitcnt lgkmcnt(3)
 v_mfma_f32_32x32x16_bf16 v[64:79], v[44:47], a[12:15], v[64:79]
 ds_read_b128 v[60:63], v23 offset:0
 s_add_u32 m0, s56, 1024
 s_add_u32 s3, s55, s64
 buffer_load_dwordx4 v24, s[4:7], s3 offen sc1 lds
 s_waitcnt lgkmcnt(3)
 v_mfma_f32_32x32x16_bf16 v[64:79], v[48:51], a[16:19], v[64:79]
 s_waitcnt vmcnt(8)
 s_barrier
 ds_read_b128 v[32:35], v16 offset:8192
 s_waitcnt lgkmcnt(3)
 v_mfma_f32_32x32x16_bf16 v[64:79], v[52:55], a[20:23], v[64:79]
 ds_read_b128 v[36:39], v17 offset:8192
 s_waitcnt lgkmcnt(3)
 v_mfma_f32_32x32x16_bf16 v[64:79], v[56:59], a[24:27], v[64:79]
 ds_read_b128 v[40:43], v18 offset:8192
 s_add_u32 m0, s56, 8192
 s_add_u32 s3, s55, s65
 buffer_load_dwordx4 v1, s[4:7], s3 offen sc1 lds
 s_waitcnt lgkmcnt(3)
 v_mfma_f32_32x32x16_bf16 v[64:79], v[60:63], a[28:31], v[64:79]
 ds_read_b128 v[44:47], v19 offset:8192
 s_waitcnt lgkmcnt(3)
 v_mfma_f32_32x32x16_bf16 v[64:79], v[32:35], a[32:35], v[64:79]
 ds_read_b128 v[48:51], v20 offset:8192
 s_waitcnt lgkmcnt(3)
 v_mfma_f32_32x32x16_bf16 v[64:79], v[36:39], a[36:39], v[64:79]
 ds_read_b128 v[52:55], v21 offset:8192
 s_add_u32 m0, s56, 9216
 s_add_u32 s3, s55, s65
 buffer_load_dwordx4 v24, s[4:7], s3 offen sc1 lds
 s_waitcnt lgkmcnt(3)
 v_mfma_f32_32x32x16_bf16 v[64:79], v[40:43], a[40:43], v[64:79]
 ds_read_b128 v[56:59], v22 offset:8192
 s_waitcnt lgkmcnt(3)
 v_mfma_f32_32x32x16_bf16 v[64:79], v[44:47], a[44:47], v[64:79]
 ds_read_b128 v[60:63], v23 offset:8192
 s_waitcnt lgkmcnt(3)
 v_mfma_f32_32x32x16_bf16 v[64:79], v[48:51], a[48:51], v[64:79]
 s_waitcnt vmcnt(8)
 s_barrier
 ds_read_b128 v[32:35], v16 offset:16384
 s_add_u32 m0, s56, 16384
 s_add_u32 s3, s55, s66
 buffer_load_dwordx4 v1, s[4:7], s3 offen sc1 lds
 s_waitcnt lgkmcnt(3)
 v_mfma_f32_32x32x16_bf16 v[64:79], v[52:55], a[52:55], v[64:79]
 ds_read_b128 v[36:39], v17 offset:16384
 s_waitcnt lgkmcnt(3)
 v_mfma_f32_32x32x16_bf16 v[64:79], v[56:59], a[56:59], v[64:79]
 ds_read_b128 v[40:43], v18 offset:16384
 s_waitcnt lgkmcnt(3)
 v_mfma_f32_32x32x16_bf16 v[64:79], v[60:63], a[60:63], v[64:79]
 ds_read_b128 v[44:47], v19 offset:16384
 s_add_u32 m0, s56, 17408
 s_add_u32 s3, s55, s66
 buffer_load_dwordx4 v24, s[4:7], s3 offen sc1 lds
 s_waitcnt lgkmcnt(3)
 v_mfma_f32_32x32x16_bf16 v[64:79], v[32:35], a[64:67], v[64:79]
 ds_read_b128 v[48:51], v20 offset:16384
 s_waitcnt lgkmcnt(3)
 v_mfma_f32_32x32x16_bf16 v[64:79], v[36:39], a[68:71], v[64:79]
 ds_read_b128 v[52:55], v21 offset:16384
 s_waitcnt lgkmcnt(3)
 v_mfma_f32_32x32x16_bf16 v[64:79], v[40:43], a[72:75], v[64:79]
 ds_read_b128 v[56:59], v22 offset:16384
 s_add_u32 m0, s56, 24576
 s_add_u32 s3, s55, s67
 buffer_load_dwordx4 v1, s[4:7], s3 offen sc1 lds
 s_waitcnt lgkmcnt(3)
 v_mfma_f32_32x32x16_bf16 v[64:79], v[44:47], a[76:79], v[64:79]
 ds_read_b128 v[60:63], v23 offset:16384
 s_waitcnt lgkmcnt(3)
 v_mfma_f32_32x32x16_bf16 v[64:79], v[48:51], a[80:83], v[64:79]
 s_waitcnt vmcnt(9)
 s_barrier
 ds_read_b128 v[32:35], v16 offset:24576
 s_waitcnt lgkmcnt(3)
 v_mfma_f32_32x32x16_bf16 v[64:79], v[52:55], a[84:87], v[64:79]
 ds_read_b128 v[36:39], v17 offset:24576
 s_add_u32 m0, s56, 25600
 s_add_u32 s3, s55, s67
 buffer_load_dwordx4 v24, s[4:7], s3 offen sc1 lds
 s_waitcnt lgkmcnt(3)
 v_mfma_f32_32x32x16_bf16 v[64:79], v[56:59], a[88:91], v[64:79]
 ds_read_b128 v[40:43], v18 offset:24576
 s_waitcnt lgkmcnt(3)
 v_mfma_f32_32x32x16_bf16 v[64:79], v[60:63], a[92:95], v[64:79]
 ds_read_b128 v[44:47], v19 offset:24576
 s_waitcnt lgkmcnt(3)
 v_mfma_f32_32x32x16_bf16 v[64:79], v[32:35], a[96:99], v[64:79]
 ds_read_b128 v[48:51], v20 offset:24576
 s_add_u32 m0, s56, 32768
 s_add_u32 s3, s55, s68
 buffer_load_dwordx4 v1, s[4:7], s3 offen sc1 lds
 s_waitcnt lgkmcnt(3)
 v_mfma_f32_32x32x16_bf16 v[64:79], v[36:39], a[100:103], v[64:79]
 ds_read_b128 v[52:55], v21 offset:24576
 s_waitcnt lgkmcnt(3)
 v_mfma_f32_32x32x16_bf16 v[64:79], v[40:43], a[104:107], v[64:79]
 ds_read_b128 v[56:59], v22 offset:24576
 s_waitcnt lgkmcnt(3)
 v_mfma_f32_32x32x16_bf16 v[64:79], v[44:47], a[108:111], v[64:79]
 ds_read_b128 v[60:63], v23 offset:24576
 s_add_u32 m0, s56, 33792
 s_add_u32 s3, s55, s68
 buffer_load_dwordx4 v24, s[4:7], s3 offen sc1 lds
 s_waitcnt lgkmcnt(3)
 v_mfma_f32_32x32x16_bf16 v[64:79], v[48:51], a[112:115], v[64:79]
 s_waitcnt vmcnt(10)
 s_barrier
 ds_read_b128 v[32:35], v16 offset:32768
 s_waitcnt lgkmcnt(3)
 v_mfma_f32_32x32x16_bf16 v[64:79], v[52:55], a[116:119], v[64:79]
 ds_read_b128 v[36:39], v17 offset:32768
 s_waitcnt lgkmcnt(3)
 v_mfma_f32_32x32x16_bf16 v[64:79], v[56:59], a[120:123], v[64:79]
 ds_read_b128 v[40:43], v18 offset:32768
 s_waitcnt lgkmcnt(3)
 v_mfma_f32_32x32x16_bf16 v[64:79], v[60:63], a[124:127], v[64:79]
 ds_read_b128 v[44:47], v19 offset:32768
 s_waitcnt lgkmcnt(3)
 v_mfma_f32_32x32x16_bf16 v[64:79], v[32:35], a[128:131], v[64:79]
 ds_read_b128 v[48:51], v20 offset:32768
 s_waitcnt lgkmcnt(3)
 v_mfma_f32_32x32x16_bf16 v[64:79], v[36:39], a[132:135], v[64:79]
 ds_read_b128 v[52:55], v21 offset:32768
 s_waitcnt lgkmcnt(3)
 v_mfma_f32_32x32x16_bf16 v[64:79], v[40:43], a[136:139], v[64:79]
 ds_read_b128 v[56:59], v22 offset:32768
 s_waitcnt lgkmcnt(3)
 v_mfma_f32_32x32x16_bf16 v[64:79], v[44:47], a[140:143], v[64:79]
 ds_read_b128 v[60:63], v23 offset:32768
 s_waitcnt lgkmcnt(3)
 v_mfma_f32_32x32x16_bf16 v[64:79], v[48:51], a[144:147], v[64:79]
 s_waitcnt lgkmcnt(2)
 v_mfma_f32_32x32x16_bf16 v[64:79], v[52:55], a[148:151], v[64:79]
 s_lshl_b32 s55, s54, 2
 s_add_u32 s55, s55, s62
 s_sub_u32 s55, s55, 36
 s_cmp_lg_u32 s50, 0
 s_cselect_b32 s55, 268435456, s55
 v_mov_b32 v6, 8
 s_mov_b64 exec, 15
 v_mov_b32 v6, 0
 buffer_atomic_add v6, v5, s[4:7], s55 offen sc0
 s_mov_b64 exec, -1
 s_waitcnt lgkmcnt(1)
 v_mfma_f32_32x32x16_bf16 v[64:79], v[56:59], a[152:155], v[64:79]
 s_waitcnt lgkmcnt(0)
 v_mfma_f32_32x32x16_bf16 v[64:79], v[60:63], a[156:159], v[64:79]
 s_lshl_b32 s3, s60, 19
 s_add_u32 s3, s3, s58
 s_xor_b32 s3, s3, s82
 s_add_u32 s3, s3, 33554432
 s_nop 8
 v_cvt_pk_bf16_f32 v88, v64, v65
 v_cvt_pk_bf16_f32 v89, v66, v67
 v_cvt_pk_bf16_f32 v90, v72, v73
 v_cvt_pk_bf16_f32 v91, v74, v75
 buffer_store_dwordx4 v[88:91], v4, s[4:7], s3 offen offset:0 sc1
 v_cvt_pk_bf16_f32 v92, v68, v69
 v_cvt_pk_bf16_f32 v93, v70, v71
 v_cvt_pk_bf16_f32 v94, v76, v77
 v_cvt_pk_bf16_f32 v95, v78, v79
 buffer_store_dwordx4 v[92:95], v4, s[4:7], s3 offen offset:512 sc1
 s_cmp_ge_u32 s54, 64
 s_cbranch_scc1 L_n0_124
 s_waitcnt vmcnt(3)
 s_barrier
 s_mov_b32 s60, s54
 ds_read_b128 v[32:35], v8 offset:0
 ds_read_b128 v[36:39], v9 offset:0
 ds_read_b128 v[40:43], v10 offset:0
 ds_read_b128 v[44:47], v11 offset:0
 s_waitcnt lgkmcnt(3)
 v_mfma_f32_32x32x16_bf16 v[64:79], v[32:35], a[0:3], 0
 ds_read_b128 v[48:51], v12 offset:0
 s_waitcnt lgkmcnt(3)
 v_mfma_f32_32x32x16_bf16 v[64:79], v[36:39], a[4:7], v[64:79]
 ds_read_b128 v[52:55], v13 offset:0
 s_waitcnt lgkmcnt(3)
 v_mfma_f32_32x32x16_bf16 v[64:79], v[40:43], a[8:11], v[64:79]
 ds_read_b128 v[56:59], v14 offset:0
 s_waitcnt lgkmcnt(3)
 v_mfma_f32_32x32x16_bf16 v[64:79], v[44:47], a[12:15], v[64:79]
 ds_read_b128 v[60:63], v15 offset:0
 s_waitcnt lgkmcnt(3)
 v_mfma_f32_32x32x16_bf16 v[64:79], v[48:51], a[16:19], v[64:79]
 ds_read_b128 v[32:35], v8 offset:8192
 s_waitcnt lgkmcnt(3)
 v_mfma_f32_32x32x16_bf16 v[64:79], v[52:55], a[20:23], v[64:79]
 ds_read_b128 v[36:39], v9 offset:8192
 s_waitcnt lgkmcnt(3)
 v_mfma_f32_32x32x16_bf16 v[64:79], v[56:59], a[24:27], v[64:79]
 ds_read_b128 v[40:43], v10 offset:8192
 s_waitcnt lgkmcnt(3)
 v_mfma_f32_32x32x16_bf16 v[64:79], v[60:63], a[28:31], v[64:79]
 ds_read_b128 v[44:47], v11 offset:8192
 s_waitcnt lgkmcnt(3)
 v_mfma_f32_32x32x16_bf16 v[64:79], v[32:35], a[32:35], v[64:79]
 ds_read_b128 v[48:51], v12 offset:8192
 s_waitcnt lgkmcnt(3)
 v_mfma_f32_32x32x16_bf16 v[64:79], v[36:39], a[36:39], v[64:79]
 ds_read_b128 v[52:55], v13 offset:8192
 s_waitcnt lgkmcnt(3)
 v_mfma_f32_32x32x16_bf16 v[64:79], v[40:43], a[40:43], v[64:79]
 ds_read_b128 v[56:59], v14 offset:8192
 s_waitcnt lgkmcnt(3)
 v_mfma_f32_32x32x16_bf16 v[64:79], v[44:47], a[44:47], v[64:79]
 ds_read_b128 v[60:63], v15 offset:8192
 s_waitcnt lgkmcnt(3)
 v_mfma_f32_32x32x16_bf16 v[64:79], v[48:51], a[48:51], v[64:79]
 ds_read_b128 v[32:35], v8 offset:16384
 s_waitcnt lgkmcnt(3)
 v_mfma_f32_32x32x16_bf16 v[64:79], v[52:55], a[52:55], v[64:79]
 ds_read_b128 v[36:39], v9 offset:16384
 s_waitcnt lgkmcnt(3)
 v_mfma_f32_32x32x16_bf16 v[64:79], v[56:59], a[56:59], v[64:79]
 ds_read_b128 v[40:43], v10 offset:16384
 s_waitcnt lgkmcnt(3)
 v_mfma_f32_32x32x16_bf16 v[64:79], v[60:63], a[60:63], v[64:79]
 ds_read_b128 v[44:47], v11 offset:16384
 s_waitcnt lgkmcnt(3)
 v_mfma_f32_32x32x16_bf16 v[64:79], v[32:35], a[64:67], v[64:79]
 ds_read_b128 v[48:51], v12 offset:16384
 s_waitcnt lgkmcnt(3)
 v_mfma_f32_32x32x16_bf16 v[64:79], v[36:39], a[68:71], v[64:79]
 ds_read_b128 v[52:55], v13 offset:16384
 s_waitcnt vmcnt(0)
 v_cmp_gt_u32 vcc, 8, v6
 s_cmp_lg_u32 s50, 0
 s_nop 1
 v_mov_b32 v2, vcc_lo
 s_cselect_b64 exec, 0, 1
 ds_write_b32 v7, v2 offset:16
 s_mov_b64 exec, -1
 s_lshl_b32 s3, s54, 2
 s_add_u32 s3, s3, s63
 v_mov_b32 v3, 1
 s_mov_b64 exec, 1
 buffer_atomic_add v3, v5, s[4:7], s3 offen
 s_mov_b64 exec, -1
 s_cmp_eq_u32 s61, 0
 s_cbranch_scc1 L_pf_125
 s_lshl_b32 s3, s61, 2
 s_add_u32 s3, s3, s59
 s_sub_u32 s3, s3, 4
 v_mov_b32 v3, 1
 s_mov_b64 exec, 1
 buffer_atomic_add v3, v5, s[4:7], s3 offen
 s_mov_b64 exec, -1
 s_mov_b32 s61, 0
L_pf_125:
 s_waitcnt lgkmcnt(3)
 v_mfma_f32_32x32x16_bf16 v[64:79], v[40:43], a[72:75], v[64:79]
 ds_read_b128 v[56:59], v14 offset:16384
 s_waitcnt lgkmcnt(3)
 v_mfma_f32_32x32x16_bf16 v[64:79], v[44:47], a[76:79], v[64:79]
 ds_read_b128 v[60:63], v15 offset:16384
 s_waitcnt lgkmcnt(3)
 v_mfma_f32_32x32x16_bf16 v[64:79], v[48:51], a[80:83], v[64:79]
 ds_read_b128 v[32:35], v8 offset:24576
 s_waitcnt lgkmcnt(3)
 v_mfma_f32_32x32x16_bf16 v[64:79], v[52:55], a[84:87], v[64:79]
 ds_read_b128 v[36:39], v9 offset:24576
 s_waitcnt lgkmcnt(3)
 v_mfma_f32_32x32x16_bf16 v[64:79], v[56:59], a[88:91], v[64:79]
 ds_read_b128 v[40:43], v10 offset:24576
 s_barrier
 ds_read_b32 v2, v7 offset:16
 s_waitcnt lgkmcnt(3)
 v_mfma_f32_32x32x16_bf16 v[64:79], v[60:63], a[92:95], v[64:79]
 ds_read_b128 v[44:47], v11 offset:24576
 s_waitcnt lgkmcnt(3)
 v_mfma_f32_32x32x16_bf16 v[64:79], v[32:35], a[96:99], v[64:79]
 ds_read_b128 v[48:51], v12 offset:24576
 s_waitcnt lgkmcnt(3)
 v_mfma_f32_32x32x16_bf16 v[64:79], v[36:39], a[100:103], v[64:79]
 ds_read_b128 v[52:55], v13 offset:24576
 s_waitcnt lgkmcnt(3)
 v_mfma_f32_32x32x16_bf16 v[64:79], v[40:43], a[104:107], v[64:79]
 ds_read_b128 v[56:59], v14 offset:24576
 s_waitcnt lgkmcnt(3)
 v_mfma_f32_32x32x16_bf16 v[64:79], v[44:47], a[108:111], v[64:79]
 ds_read_b128 v[60:63], v15 offset:24576
 v_readfirstlane_b32 s3, v2
 s_cmp_lg_u32 s3, 0
 s_cbranch_scc1 L_pf_126
 s_sub_u32 s72, s54, 9
 s_mul_i32 s55, s72, 40960
 s_mul_i32 s3, s50, 10240
 s_add_u32 s55, s55, s3
 s_add_u32 s55, s55, 195559424
 s_add_u32 m0, s56, 40960
 s_add_u32 s3, s55, s64
 buffer_load_dwordx4 v1, s[4:7], s3 offen sc1 lds
 s_branch L_pf_127
L_pf_126:
 s_mov_b64 exec, 15
 v_mov_b32 v6, 0
 buffer_atomic_add v6, v5, s[4:7], s55 offen sc0
 s_mov_b64 exec, -1
L_pf_127:
 s_waitcnt lgkmcnt(3)
 v_mfma_f32_32x32x16_bf16 v[64:79], v[48:51], a[112:115], v[64:79]
 ds_read_b128 v[32:35], v8 offset:32768
 s_cmp_eq_u32 s72, 0
 s_cbranch_scc1 L_pf_128
 s_add_u32 m0, s56, 41984
 s_add_u32 s3, s55, s64
 buffer_load_dwordx4 v24, s[4:7], s3 offen sc1 lds
L_pf_128:
 s_waitcnt lgkmcnt(3)
 v_mfma_f32_32x32x16_bf16 v[64:79], v[52:55], a[116:119], v[64:79]
 ds_read_b128 v[36:39], v9 offset:32768
 s_cmp_eq_u32 s72, 0
 s_cbranch_scc1 L_pf_129
 s_add_u32 m0, s56, 49152
 s_add_u32 s3, s55, s65
 buffer_load_dwordx4 v1, s[4:7], s3 offen sc1 lds
L_pf_129:
 s_waitcnt lgkmcnt(3)
 v_mfma_f32_32x32x16_bf16 v[64:79], v[56:59], a[120:123], v[64:79]
 ds_read_b128 v[40:43], v10 offset:32768
 s_cmp_eq_u32 s72, 0
 s_cbranch_scc1 L_pf_130
 s_add_u32 m0, s56, 50176
 s_add_u32 s3, s55, s65
 buffer_load_dwordx4 v24, s[4:7], s3 offen sc1 lds
L_pf_130:
 s_waitcnt lgkmcnt(3)
 v_mfma_f32_32x32x16_bf16 v[64:79], v[60:63], a[124:127], v[64:79]
 ds_read_b128 v[44:47], v11 offset:32768
 s_cmp_eq_u32 s72, 0
 s_cbranch_scc1 L_pf_131
 s_add_u32 m0, s56, 57344
 s_add_u32 s3, s55, s66
 buffer_load_dwordx4 v1, s[4:7], s3 offen sc1 lds
L_pf_131:
 s_waitcnt lgkmcnt(3)
 v_mfma_f32_32x32x16_bf16 v[64:79], v[32:35], a[128:131], v[64:79]
 ds_read_b128 v[48:51], v12 offset:32768
 s_cmp_eq_u32 s72, 0
 s_cbranch_scc1 L_pf_132
 s_add_u32 m0, s56, 58368
 s_add_u32 s3, s55, s66
 buffer_load_dwordx4 v24, s[4:7], s3 offen sc1 lds
L_pf_132:
 s_waitcnt lgkmcnt(3)
 v_mfma_f32_32x32x16_bf16 v[64:79], v[36:39], a[132:135], v[64:79]
 ds_read_b128 v[52:55], v13 offset:32768
 s_cmp_eq_u32 s72, 0
 s_cbranch_scc1 L_pf_133
 s_add_u32 m0, s56, 65536
 s_add_u32 s3, s55, s67
 buffer_load_dwordx4 v1, s[4:7], s3 offen sc1 lds
L_pf_133:
 s_waitcnt lgkmcnt(3)
 v_mfma_f32_32x32x16_bf16 v[64:79], v[40:43], a[136:139], v[64:79]
 ds_read_b128 v[56:59], v14 offset:32768
 s_cmp_eq_u32 s72, 0
 s_cbranch_scc1 L_pf_134
 s_add_u32 m0, s56, 66560
 s_add_u32 s3, s55, s67
 buffer_load_dwordx4 v24, s[4:7], s3 offen sc1 lds
L_pf_134:
 s_waitcnt lgkmcnt(3)
 v_mfma_f32_32x32x16_bf16 v[64:79], v[44:47], a[140:143], v[64:79]
 ds_read_b128 v[60:63], v15 offset:32768
 s_cmp_eq_u32 s72, 0
 s_cbranch_scc1 L_pf_135
 s_add_u32 m0, s56, 73728
 s_add_u32 s3, s55, s68
 buffer_load_dwordx4 v1, s[4:7], s3 offen sc1 lds
L_pf_135:
 s_waitcnt lgkmcnt(3)
 v_mfma_f32_32x32x16_bf16 v[64:79], v[48:51], a[144:147], v[64:79]
 s_cmp_eq_u32 s72, 0
 s_cbranch_scc1 L_pf_136
 s_add_u32 m0, s56, 74752
 s_add_u32 s3, s55, s68
 buffer_load_dwordx4 v24, s[4:7], s3 offen sc1 lds
L_pf_136:
 s_waitcnt lgkmcnt(2)
 v_mfma_f32_32x32x16_bf16 v[64:79], v[52:55], a[148:151], v[64:79]
 s_waitcnt lgkmcnt(1)
 v_mfma_f32_32x32x16_bf16 v[64:79], v[56:59], a[152:155], v[64:79]
 s_waitcnt lgkmcnt(0)
 v_mfma_f32_32x32x16_bf16 v[64:79], v[60:63], a[156:159], v[64:79]
 s_lshl_b32 s3, s60, 19
 s_add_u32 s3, s3, s58
 s_xor_b32 s3, s3, s82
 s_nop 8
 v_cvt_pk_bf16_f32 v80, v64, v65
 v_cvt_pk_bf16_f32 v81, v66, v67
 v_cvt_pk_bf16_f32 v82, v72, v73
 v_cvt_pk_bf16_f32 v83, v74, v75
 buffer_store_dwordx4 v[80:83], v4, s[4:7], s3 offen offset:0 sc1
 v_cvt_pk_bf16_f32 v84, v68, v69
 v_cvt_pk_bf16_f32 v85, v70, v71
 v_cvt_pk_bf16_f32 v86, v76, v77
 v_cvt_pk_bf16_f32 v87, v78, v79
 buffer_store_dwordx4 v[84:87], v4, s[4:7], s3 offen offset:512 sc1
 s_add_u32 s54, s54, 1
 s_mov_b32 s61, s54
 s_cmp_lg_u32 s72, 0
 s_cbranch_scc1 L_qkvv_loop
 s_cmp_lg_u32 s50, 0
 s_cbranch_scc1 L_w_137
 s_waitcnt vmcnt(2)
 v_cmp_gt_u32 vcc, 8, v6
 s_nop 1
 v_mov_b32 v3, vcc_lo
 ds_write_b32 v7, v3
 s_waitcnt lgkmcnt(0)
L_w_137:
 s_barrier
 ds_read_b32 v3, v7
 s_waitcnt lgkmcnt(0)
 v_readfirstlane_b32 s3, v3
 s_cmp_eq_u32 s3, 0
 s_cbranch_scc1 L_qkvv_loop
 s_branch L_qkvv_block
L_n0_124:
 s_waitcnt vmcnt(0)
 s_lshl_b32 s3, s54, 2
 s_add_u32 s3, s3, s63
 v_mov_b32 v3, 1
 s_mov_b64 exec, 1
 buffer_atomic_add v3, v5, s[4:7], s3 offen
 s_mov_b64 exec, -1
 s_add_u32 s54, s54, 1
 s_cmp_lt_u32 s54, 74
 s_cbranch_scc1 L_qkvv_block
 s_endpgm
L_wm:
 s_mov_b32 s96, s44
 s_and_b32 s97, s45, 0xffff
 s_mov_b32 s98, 256
 s_mov_b32 s99, 0x00020000
 v_mov_b32 v1, 132
 s_mov_b32 s3, 144
 v_writelane_b32 v1, s3, 1
 s_mov_b32 s51, 0
 s_mov_b64 exec, 3
L_wb_138:
 buffer_load_dword v2, v1, s[96:99], 0 offen sc1
 s_waitcnt vmcnt(0)
 v_cmp_eq_u32 vcc, 0, v2
 s_cbranch_vccz L_wbd_139
 s_sleep 2
 s_add_u32 s51, s51, 1
 s_cmp_lt_u32 s51, 131072
 s_cbranch_scc1 L_wb_138
 s_branch L_bail
L_wbd_139:
 s_mov_b64 exec, -1
 v_readlane_b32 s81, v2, 1
 s_nop 3
 s_sub_u32 s81, s81, 1
 s_mov_b32 s96, s44
 s_and_b32 s97, s45, 0xffff
 s_mov_b32 s98, 256
 s_mov_b32 s99, 0x00020000
 v_lshlrev_b32 v1, 5, v0
 s_mov_b32 s51, 0
L_gl_140:
 buffer_load_dword v2, v1, s[96:99], 0 offen sc1
 s_waitcnt vmcnt(0)
 v_readlane_b32 s3, v2, s48
 s_mov_b32 s80, 0
 s_nop 2
 s_cmp_ge_u32 s3, 32
 s_cbranch_scc1 L_gld_141
 s_mov_b32 s80, 0
 v_readlane_b32 s3, v2, 0
 s_nop 3
 s_add_u32 s80, s80, s3
 v_readlane_b32 s3, v2, 1
 s_nop 3
 s_add_u32 s80, s80, s3
 v_readlane_b32 s3, v2, 2
 s_nop 3
 s_add_u32 s80, s80, s3
 v_readlane_b32 s3, v2, 3
 s_nop 3
 s_add_u32 s80, s80, s3
 v_readlane_b32 s3, v2, 4
 s_nop 3
 s_add_u32 s80, s80, s3
 v_readlane_b32 s3, v2, 5
 s_nop 3
 s_add_u32 s80, s80, s3
 v_readlane_b32 s3, v2, 6
 s_nop 3
 s_add_u32 s80, s80, s3
 v_readlane_b32 s3, v2, 7
 s_nop 3
 s_add_u32 s80, s80, s3
 s_cmp_ge_u32 s80, 256
 s_cbranch_scc1 L_gld_141
 s_sleep 4
 s_add_u32 s51, s51, 1
 s_cmp_lt_u32 s51, 131072
 s_cbranch_scc1 L_gl_140
 s_branch L_bail
L_gld_141:
 s_xor_b32 s78, s81, 0
 s_lshl_b32 s78, s78, 13
 s_xor_b32 s79, s78, 8192
 s_and_b32 s52, s48, 1
 s_lshl_b32 s52, s52, 1
 s_add_u32 s52, s52, s49
 s_sub_u32 s52, s52, 30
 s_lshl_b32 s52, s52, 2
 s_add_u32 s52, s52, s50
 s_lshl_b32 s52, s52, 1
 v_lshlrev_b32 v1, 7, v0
 v_lshlrev_b32 v6, 8, v0
 s_add_u32 s54, s78, 32768
 s_cmp_lt_u32 s48, 2
 s_cselect_b32 s54, 16384, s54
 s_cselect_b32 s57, 0, 33554432
 s_cselect_b32 s56, 0, 8192
 s_lshl_b32 s3, s52, 8
 s_add_u32 s54, s54, s3
 v_add_u32 v3, s54, v6
 s_add_u32 s56, s56, s3
 s_add_u32 s56, s56, 0
 s_lshl_b32 s3, s52, 14
 s_add_u32 s57, s57, s3
 s_add_u32 s57, s57, 16777216
 s_mov_b32 s53, 0
 v_mov_b32 v4, 0
 v_mov_b32 v5, 0
 v_mov_b32 v7, 0
L_wm_loop:
 s_sub_i32 s55, s53, 2
 s_max_i32 s55, s55, 0
 v_cmp_gt_u32 vcc, s55, v7
 s_cbranch_vccz L_wg_142
 s_add_u32 s54, s56, 8
 s_mov_b32 s51, 0
 s_mov_b64 exec, 1
L_pl_144:
 buffer_load_dword v2, v4, s[4:7], s54 offen sc1
 s_waitcnt vmcnt(0)
 v_cmp_gt_u32 vcc, s55, v2
 s_cbranch_vccz L_pld_145
 s_sleep 2
 s_add_u32 s51, s51, 1
 s_cmp_lt_u32 s51, 131072
 s_cbranch_scc1 L_pl_144
 s_branch L_bail
L_pld_145:
 s_mov_b64 exec, -1
L_wg_142:
 s_lshl_b32 s54, s53, 2
 v_cmp_gt_u32 vcc, 12, v5
 s_and_b32 s3, vcc_lo, 3
 s_cbranch_scc0 L_wh_143
 s_mov_b32 s51, 0
 s_mov_b64 exec, 3
L_wc_146:
 v_mov_b32 v5, 0
 buffer_atomic_add v5, v3, s[4:7], s54 offen sc0
 s_waitcnt vmcnt(0)
 v_cmp_gt_u32 vcc, 12, v5
 s_cbranch_vccz L_wcd_147
 s_sleep 1
 s_add_u32 s51, s51, 1
 s_cmp_lt_u32 s51, 131072
 s_cbranch_scc1 L_wc_146
 s_branch L_bail
L_wcd_147:
 s_mov_b64 exec, -1
L_wh_143:
 s_lshl_b32 s58, s53, 19
 s_add_u32 s58, s58, s57
 s_add_u32 s3, s58, 0
 buffer_load_dword v8, v1, s[4:7], s3 offen sc1
 s_add_u32 s3, s58, 24576
 buffer_load_dword v9, v1, s[4:7], s3 offen sc1
 s_add_u32 s3, s58, 67108864
 buffer_load_dword v10, v1, s[4:7], s3 offen sc1
 s_add_u32 s3, s58, 67133440
 buffer_load_dword v11, v1, s[4:7], s3 offen sc1
 v_mov_b32 v5, 0
 s_mov_b64 exec, 3
 buffer_atomic_add v5, v3, s[4:7], s54 offen offset:4 sc0
 s_mov_b64 exec, -1
 buffer_load_dword v7, off, s[4:7], s56 offset:8 sc1
 s_add_u32 s55, s53, 1
 v_mov_b32 v2, s55
 s_waitcnt vmcnt(2)
 s_mov_b64 exec, 3
 s_cmp_lg_u32 s80, 0
 s_cbranch_scc1 L_lf_148
 buffer_store_dword v2, v6, s[4:7], s56 offen
 s_branch L_lf_149
L_lf_148:
 buffer_store_dword v2, v6, s[4:7], s56 offen sc1
L_lf_149:
 s_mov_b64 exec, -1
 s_waitcnt vmcnt(1)
 s_add_u32 s53, s53, 1
 s_cmp_lt_u32 s53, 64
 s_cbranch_scc1 L_wm_loop
 s_endpgm
L_wo:
 s_and_b32 s100, s64, 1
 s_lshl_b32 s100, s100, 13
 s_lshl_b32 s64, s64, 14
 s_add_u32 s64, s64, s100
 s_xor_b32 s64, s64, 8192
 s_and_b32 s100, s65, 1
 s_lshl_b32 s100, s100, 13
 s_lshl_b32 s65, s65, 14
 s_add_u32 s65, s65, s100
 s_xor_b32 s65, s65, 8192
 s_and_b32 s100, s66, 1
 s_lshl_b32 s100, s100, 13
 s_lshl_b32 s66, s66, 14
 s_add_u32 s66, s66, s100
 s_xor_b32 s66, s66, 8192
 s_and_b32 s100, s67, 1
 s_lshl_b32 s100, s100, 13
 s_lshl_b32 s67, s67, 14
 s_add_u32 s67, s67, s100
 s_xor_b32 s67, s67, 8192
 v_lshlrev_b32 v7, 4, v0
 s_lshl_b32 s3, s50, 3
 v_lshrrev_b32 v4, 4, v0
 v_add_u32 v4, s3, v4
 v_mul_u32_u24 v15, 272, v4
 v_mul_u32_u24 v4, 1280, v4
 v_and_b32 v3, 15, v0
 v_lshl_add_u32 v4, v3, 4, v4
 v_lshl_add_u32 v15, v3, 4, v15
 v_and_b32 v14, 31, v0
 v_mul_u32_u24 v14, 272, v14
 v_lshrrev_b32 v3, 5, v0
 v_lshl_add_u32 v14, v3, 3, v14
 s_lshl_b32 s3, s50, 6
 s_add_u32 s3, s3, 65536
 v_add_u32 v14, s3, v14
 v_add_u32 v15, 0x10000, v15
 s_lshl_b32 s3, s53, 8
 v_add_u32 v4, s3, v4
 s_mul_i32 s58, s52, 40960
 s_add_u32 s58, s58, 150994944
 s_mov_b32 s96, s44
 s_and_b32 s97, s45, 0xffff
 s_mov_b32 s98, 256
 s_mov_b32 s99, 0x00020000
 v_mov_b32 v12, 132
 s_mov_b32 s3, 144
 v_writelane_b32 v12, s3, 1
 s_mov_b32 s51, 0
 s_mov_b64 exec, 3
L_wb_150:
 buffer_load_dword v13, v12, s[96:99], 0 offen sc1
 s_waitcnt vmcnt(0)
 v_cmp_eq_u32 vcc, 0, v13
 s_cbranch_vccz L_wbd_151
 s_sleep 2
 s_add_u32 s51, s51, 1
 s_cmp_lt_u32 s51, 131072
 s_cbranch_scc1 L_wb_150
 s_branch L_bail
L_wbd_151:
 s_mov_b64 exec, -1
 v_readlane_b32 s81, v13, 1
 s_nop 3
 s_sub_u32 s81, s81, 1
 s_xor_b32 s78, s81, 0
 s_lshl_b32 s78, s78, 13
 s_xor_b32 s79, s78, 8192
 v_lshlrev_b32 v8, 9, v0
 v_and_b32 v3, 0xffffe000, v8
 v_add_u32 v8, v8, v3
 v_add_u32 v8, s78, v8
 s_mul_i32 s3, s52, 5
 s_add_u32 s3, s3, s53
 s_and_b32 s55, s3, 3
 s_mul_i32 s55, s55, 32768
 v_add_u32 v8, s55, v8
 s_lshl_b32 s3, s3, 9
 s_lshr_b32 s100, s3, 13
 s_lshl_b32 s100, s100, 13
 s_add_u32 s3, s3, s100
 s_add_u32 s3, s3, s79
 s_add_u32 s3, s3, 49152
 v_lshlrev_b32 v5, 8, v0
 v_add_u32 v5, s3, v5
 v_mov_b32 v6, 0
 v_and_b32 v10, 1, v0
 v_lshlrev_b32 v10, 2, v10
 v_add_u32 v10, 163776, v10
 s_lshl_b32 s56, s50, 11
 s_mov_b32 s54, 0
 s_mov_b32 s61, -1
 s_mov_b32 s63, 268435456
 s_mov_b32 s59, 0
 s_cmp_lg_u32 s50, 0
 s_cselect_b32 s68, 268435456, 0
 v_mov_b32 v2, s59
 v_writelane_b32 v2, s54, 0
 v_lshl_add_u32 v2, v2, 2, v5
 s_cmp_lt_u32 s54, 64
 s_cselect_b32 s3, 8, 0
 v_writelane_b32 v6, s3, 0
 s_cselect_b32 s3, 13, 0
 s_add_u32 s3, s3, s59
 s_cmp_ge_u32 s54, s3
 s_cselect_b32 s3, 8, 0
 v_writelane_b32 v6, s3, 1
 s_mov_b32 s72, 0
L_wo_block:
 s_cmp_lg_u32 s50, 0
 s_cbranch_scc1 L_w_152
 v_mov_b32 v13, 0
 s_mov_b32 s51, 0
 s_mov_b64 exec, 3
 v_mov_b32 v12, 0
 buffer_atomic_add v12, v2, s[4:7], 0 offen sc0
 s_sleep 5
L_wc_153:
 v_mov_b32 v13, 0
 buffer_atomic_add v13, v2, s[4:7], 0 offen sc0
 s_waitcnt vmcnt(1)
 v_cmp_gt_u32 vcc, v6, v12
 s_cbranch_vccz L_wcd_154
 v_mov_b32 v12, 0
 buffer_atomic_add v12, v2, s[4:7], 0 offen sc0
 s_waitcnt vmcnt(1)
 v_cmp_gt_u32 vcc, v6, v13
 s_cbranch_vccz L_wcd_154
 s_add_u32 s51, s51, 1
 s_cmp_lt_u32 s51, 131072
 s_cbranch_scc1 L_wc_153
 s_branch L_bail
L_wcd_154:
 s_mov_b64 exec, -1
 v_max_u32 v9, v12, v13
L_w_152:
 s_cmp_lg_u32 s50, 0
 s_cselect_b64 exec, 0, 3
 ds_write_b32 v10, v9 offset:8
 s_mov_b64 exec, -1
 s_waitcnt lgkmcnt(0)
 s_barrier
 ds_read_b32 v9, v10 offset:8
 s_waitcnt lgkmcnt(0)
L_wo_loop:
 s_cmp_lg_u32 s72, 0
 s_cbranch_scc1 L_wo_have
 s_lshl_b32 s3, s52, 16
 s_add_u32 s3, s3, s56
 s_add_u32 s3, s3, 83886080
 s_lshl_b32 s55, s54, 19
 s_add_u32 s55, s55, s3
 s_cmp_lt_u32 s54, 64
 s_cselect_b32 s55, s55, 268435456
 s_add_u32 m0, s56, 0
 s_add_u32 s3, s55, s64
 buffer_load_dwordx4 v7, s[4:7], s3 offen offset:0 sc1 lds
 s_add_u32 m0, s56, 0
 s_add_u32 s3, s55, s64
 buffer_load_dwordx4 v7, s[4:7], s3 offen offset:1024 sc1 lds
 s_add_u32 m0, s56, 8192
 s_add_u32 s3, s55, s65
 buffer_load_dwordx4 v7, s[4:7], s3 offen offset:0 sc1 lds
 s_add_u32 m0, s56, 8192
 s_add_u32 s3, s55, s65
 buffer_load_dwordx4 v7, s[4:7], s3 offen offset:1024 sc1 lds
 s_add_u32 m0, s56, 16384
 s_add_u32 s3, s55, s66
 buffer_load_dwordx4 v7, s[4:7], s3 offen offset:0 sc1 lds
 s_add_u32 m0, s56, 16384
 s_add_u32 s3, s55, s66
 buffer_load_dwordx4 v7, s[4:7], s3 offen offset:1024 sc1 lds
 s_add_u32 m0, s56, 24576
 s_add_u32 s3, s55, s67
 buffer_load_dwordx4 v7, s[4:7], s3 offen offset:0 sc1 lds
 s_add_u32 m0, s56, 24576
 s_add_u32 s3, s55, s67
 buffer_load_dwordx4 v7, s[4:7], s3 offen offset:1024 sc1 lds
L_wo_have:
 v_readlane_b32 s3, v9, 1
 s_nop 3
 s_cmp_ge_u32 s3, 8
 s_cselect_b32 s60, s59, -1
 s_addc_u32 s59, s59, 0
 s_mov_b32 s57, s54
 s_add_u32 s54, s54, 1
 s_lshl_b32 s3, s52, 16
 s_add_u32 s3, s3, s56
 s_add_u32 s3, s3, 117440512
 s_lshl_b32 s55, s60, 19
 s_add_u32 s55, s55, s3
 s_cmp_lt_u32 s60, 64
 s_cselect_b32 s55, s55, 268435456
 s_waitcnt vmcnt(6)
 s_barrier
 ds_read_b128 v[32:35], v7 offset:0
 ds_read_b128 v[36:39], v7 offset:1024
 ds_read_b128 v[40:43], v7 offset:2048
 ds_read_b128 v[44:47], v7 offset:3072
 s_waitcnt lgkmcnt(3)
 v_mfma_f32_32x32x16_bf16 v[64:79], a[0:3], v[32:35], 0
 ds_read_b128 v[48:51], v7 offset:4096
 s_add_u32 m0, s56, 32768
 s_add_u32 s3, s55, s64
 buffer_load_dwordx4 v7, s[4:7], s3 offen offset:0 sc1 lds
 s_waitcnt lgkmcnt(3)
 v_mfma_f32_32x32x16_bf16 v[64:79], a[4:7], v[36:39], v[64:79]
 ds_read_b128 v[52:55], v7 offset:5120
 s_waitcnt lgkmcnt(3)
 v_mfma_f32_32x32x16_bf16 v[64:79], a[8:11], v[40:43], v[64:79]
 ds_read_b128 v[56:59], v7 offset:6144
 s_add_u32 m0, s56, 32768
 s_add_u32 s3, s55, s64
 buffer_load_dwordx4 v7, s[4:7], s3 offen offset:1024 sc1 lds
 s_waitcnt lgkmcnt(3)
 v_mfma_f32_32x32x16_bf16 v[64:79], a[12:15], v[44:47], v[64:79]
 ds_read_b128 v[60:63], v7 offset:7168
 s_waitcnt lgkmcnt(3)
 v_mfma_f32_32x32x16_bf16 v[64:79], a[16:19], v[48:51], v[64:79]
 s_waitcnt vmcnt(6)
 s_barrier
 ds_read_b128 v[32:35], v7 offset:8192
 s_add_u32 m0, s56, 40960
 s_add_u32 s3, s55, s65
 buffer_load_dwordx4 v7, s[4:7], s3 offen offset:0 sc1 lds
 s_waitcnt lgkmcnt(3)
 v_mfma_f32_32x32x16_bf16 v[64:79], a[20:23], v[52:55], v[64:79]
 ds_read_b128 v[36:39], v7 offset:9216
 s_waitcnt lgkmcnt(3)
 v_mfma_f32_32x32x16_bf16 v[64:79], a[24:27], v[56:59], v[64:79]
 ds_read_b128 v[40:43], v7 offset:10240
 s_add_u32 m0, s56, 40960
 s_add_u32 s3, s55, s65
 buffer_load_dwordx4 v7, s[4:7], s3 offen offset:1024 sc1 lds
 s_waitcnt lgkmcnt(3)
 v_mfma_f32_32x32x16_bf16 v[64:79], a[28:31], v[60:63], v[64:79]
 ds_read_b128 v[44:47], v7 offset:11264
 s_waitcnt lgkmcnt(3)
 v_mfma_f32_32x32x16_bf16 v[64:79], a[32:35], v[32:35], v[64:79]
 ds_read_b128 v[48:51], v7 offset:12288
 s_add_u32 m0, s56, 49152
 s_add_u32 s3, s55, s66
 buffer_load_dwordx4 v7, s[4:7], s3 offen offset:0 sc1 lds
 s_waitcnt lgkmcnt(3)
 v_mfma_f32_32x32x16_bf16 v[64:79], a[36:39], v[36:39], v[64:79]
 ds_read_b128 v[52:55], v7 offset:13312
 s_waitcnt lgkmcnt(3)
 v_mfma_f32_32x32x16_bf16 v[64:79], a[40:43], v[40:43], v[64:79]
 ds_read_b128 v[56:59], v7 offset:14336
 s_add_u32 m0, s56, 49152
 s_add_u32 s3, s55, s66
 buffer_load_dwordx4 v7, s[4:7], s3 offen offset:1024 sc1 lds
 s_waitcnt lgkmcnt(3)
 v_mfma_f32_32x32x16_bf16 v[64:79], a[44:47], v[44:47], v[64:79]
 ds_read_b128 v[60:63], v7 offset:15360
 s_waitcnt lgkmcnt(3)
 v_mfma_f32_32x32x16_bf16 v[64:79], a[48:51], v[48:51], v[64:79]
 s_waitcnt vmcnt(8)
 s_barrier
 ds_read_b128 v[32:35], v7 offset:16384
 s_add_u32 m0, s56, 57344
 s_add_u32 s3, s55, s67
 buffer_load_dwordx4 v7, s[4:7], s3 offen offset:0 sc1 lds
 s_waitcnt lgkmcnt(3)
 v_mfma_f32_32x32x16_bf16 v[64:79], a[52:55], v[52:55], v[64:79]
 ds_read_b128 v[36:39], v7 offset:17408
 s_waitcnt lgkmcnt(3)
 v_mfma_f32_32x32x16_bf16 v[64:79], a[56:59], v[56:59], v[64:79]
 ds_read_b128 v[40:43], v7 offset:18432
 s_add_u32 m0, s56, 57344
 s_add_u32 s3, s55, s67
 buffer_load_dwordx4 v7, s[4:7], s3 offen offset:1024 sc1 lds
 v_mov_b32 v2, s59
 v_writelane_b32 v2, s54, 0
 v_lshl_add_u32 v2, v2, 2, v5
 s_cmp_lt_u32 s54, 64
 s_cselect_b32 s3, 8, 0
 v_writelane_b32 v6, s3, 0
 s_cselect_b32 s3, 13, 0
 s_add_u32 s3, s3, s59
 s_cmp_ge_u32 s54, s3
 s_cselect_b32 s3, 8, 0
 v_writelane_b32 v6, s3, 1
 v_mov_b32 v9, 0
 s_mov_b64 exec, 3
 buffer_atomic_add v9, v2, s[4:7], s68 offen sc0
 s_mov_b64 exec, -1
 s_waitcnt lgkmcnt(3)
 v_mfma_f32_32x32x16_bf16 v[64:79], a[60:63], v[60:63], v[64:79]
 ds_read_b128 v[44:47], v7 offset:19456
 s_waitcnt lgkmcnt(3)
 v_mfma_f32_32x32x16_bf16 v[64:79], a[64:67], v[32:35], v[64:79]
 ds_read_b128 v[48:51], v7 offset:20480
 s_add_u32 s3, s63, 0
 buffer_store_dwordx4 v[112:115], v4, s[4:7], s3 offen sc1
 s_waitcnt lgkmcnt(3)
 v_mfma_f32_32x32x16_bf16 v[64:79], a[68:71], v[36:39], v[64:79]
 ds_read_b128 v[52:55], v7 offset:21504
 s_waitcnt lgkmcnt(3)
 v_mfma_f32_32x32x16_bf16 v[64:79], a[72:75], v[40:43], v[64:79]
 ds_read_b128 v[56:59], v7 offset:22528
 s_waitcnt lgkmcnt(3)
 v_mfma_f32_32x32x16_bf16 v[64:79], a[76:79], v[44:47], v[64:79]
 ds_read_b128 v[60:63], v7 offset:23552
 s_waitcnt lgkmcnt(3)
 v_mfma_f32_32x32x16_bf16 v[64:79], a[80:83], v[48:51], v[64:79]
 s_waitcnt vmcnt(9)
 s_barrier
 ds_read_b128 v[32:35], v7 offset:24576
 s_add_u32 s3, s63, 5120
 buffer_store_dwordx4 v[116:119], v4, s[4:7], s3 offen sc1
 s_waitcnt lgkmcnt(3)
 v_mfma_f32_32x32x16_bf16 v[64:79], a[84:87], v[52:55], v[64:79]
 ds_read_b128 v[36:39], v7 offset:25600
 s_waitcnt lgkmcnt(3)
 v_mfma_f32_32x32x16_bf16 v[64:79], a[88:91], v[56:59], v[64:79]
 ds_read_b128 v[40:43], v7 offset:26624
 s_waitcnt lgkmcnt(3)
 v_mfma_f32_32x32x16_bf16 v[64:79], a[92:95], v[60:63], v[64:79]
 ds_read_b128 v[44:47], v7 offset:27648
 s_waitcnt lgkmcnt(3)
 v_mfma_f32_32x32x16_bf16 v[64:79], a[96:99], v[32:35], v[64:79]
 ds_read_b128 v[48:51], v7 offset:28672
 s_waitcnt lgkmcnt(3)
 v_mfma_f32_32x32x16_bf16 v[64:79], a[100:103], v[36:39], v[64:79]
 ds_read_b128 v[52:55], v7 offset:29696
 s_waitcnt lgkmcnt(3)
 v_mfma_f32_32x32x16_bf16 v[64:79], a[104:107], v[40:43], v[64:79]
 ds_read_b128 v[56:59], v7 offset:30720
 s_waitcnt lgkmcnt(3)
 v_mfma_f32_32x32x16_bf16 v[64:79], a[108:111], v[44:47], v[64:79]
 ds_read_b128 v[60:63], v7 offset:31744
 s_waitcnt lgkmcnt(3)
 v_mfma_f32_32x32x16_bf16 v[64:79], a[112:115], v[48:51], v[64:79]
 s_waitcnt lgkmcnt(2)
 v_mfma_f32_32x32x16_bf16 v[64:79], a[116:119], v[52:55], v[64:79]
 s_waitcnt lgkmcnt(1)
 v_mfma_f32_32x32x16_bf16 v[64:79], a[120:123], v[56:59], v[64:79]
 s_waitcnt lgkmcnt(0)
 v_mfma_f32_32x32x16_bf16 v[64:79], a[124:127], v[60:63], v[64:79]
 s_mul_i32 s62, s57, 327680
 s_add_u32 s62, s62, s58
 s_cmp_lt_u32 s57, 64
 s_cselect_b32 s62, s62, 268435456
 s_nop 8
 v_cvt_pk_bf16_f32 v64, v64, v65
 v_cvt_pk_bf16_f32 v65, v66, v67
 ds_write_b64 v14, v[64:65] offset:0
 v_cvt_pk_bf16_f32 v68, v68, v69
 v_cvt_pk_bf16_f32 v69, v70, v71
 ds_write_b64 v14, v[68:69] offset:16
 v_cvt_pk_bf16_f32 v72, v72, v73
 v_cvt_pk_bf16_f32 v73, v74, v75
 ds_write_b64 v14, v[72:73] offset:32
 v_cvt_pk_bf16_f32 v76, v76, v77
 v_cvt_pk_bf16_f32 v77, v78, v79
 ds_write_b64 v14, v[76:77] offset:48
 s_waitcnt vmcnt(2)
 s_cmp_lg_u32 s50, 0
 s_cselect_b64 exec, 0, 3
 ds_write_b32 v10, v9 offset:16
 s_mov_b64 exec, -1
 s_waitcnt lgkmcnt(0)
 s_barrier
 ds_read_b32 v9, v10 offset:16
 ds_read_b128 v[96:99], v15 offset:0
 ds_read_b128 v[100:103], v15 offset:1088
 ds_read_b128 v[32:35], v7 offset:32768
 ds_read_b128 v[36:39], v7 offset:33792
 ds_read_b128 v[40:43], v7 offset:34816
 ds_read_b128 v[44:47], v7 offset:35840
 s_waitcnt lgkmcnt(3)
 v_mfma_f32_32x32x16_bf16 v[80:95], a[0:3], v[32:35], 0
 ds_read_b128 v[48:51], v7 offset:36864
 s_add_u32 s3, s62, 0
 buffer_store_dwordx4 v[96:99], v4, s[4:7], s3 offen sc1
 s_waitcnt lgkmcnt(3)
 v_mfma_f32_32x32x16_bf16 v[80:95], a[4:7], v[36:39], v[80:95]
 ds_read_b128 v[52:55], v7 offset:37888
 v_cmp_gt_u32 vcc, v6, v9
 s_lshl_b32 s3, s52, 16
 s_add_u32 s3, s3, s56
 s_add_u32 s3, s3, 83886080
 s_lshl_b32 s55, s54, 19
 s_add_u32 s55, s55, s3
 s_cmp_lt_u32 s54, 64
 s_cselect_b32 s55, s55, 268435456
 s_cmp_eq_u64 vcc, 0
 s_cselect_b32 s72, 1, 0
 s_waitcnt lgkmcnt(3)
 v_mfma_f32_32x32x16_bf16 v[80:95], a[8:11], v[40:43], v[80:95]
 ds_read_b128 v[56:59], v7 offset:38912
 s_add_u32 s3, s62, 5120
 buffer_store_dwordx4 v[100:103], v4, s[4:7], s3 offen sc1
 s_cmp_eq_u32 s72, 0
 s_cbranch_scc1 L_pf_155
 s_add_u32 m0, s56, 0
 s_add_u32 s3, s55, s64
 buffer_load_dwordx4 v7, s[4:7], s3 offen offset:0 sc1 lds
L_pf_155:
 s_waitcnt lgkmcnt(3)
 v_mfma_f32_32x32x16_bf16 v[80:95], a[12:15], v[44:47], v[80:95]
 ds_read_b128 v[60:63], v7 offset:39936
 s_cmp_eq_u32 s72, 0
 s_cbranch_scc1 L_pf_156
 s_add_u32 m0, s56, 0
 s_add_u32 s3, s55, s64
 buffer_load_dwordx4 v7, s[4:7], s3 offen offset:1024 sc1 lds
L_pf_156:
 s_waitcnt lgkmcnt(3)
 v_mfma_f32_32x32x16_bf16 v[80:95], a[16:19], v[48:51], v[80:95]
 ds_read_b128 v[32:35], v7 offset:40960
 s_waitcnt lgkmcnt(3)
 v_mfma_f32_32x32x16_bf16 v[80:95], a[20:23], v[52:55], v[80:95]
 ds_read_b128 v[36:39], v7 offset:41984
 s_cmp_eq_u32 s72, 0
 s_cbranch_scc1 L_pf_157
 s_add_u32 m0, s56, 8192
 s_add_u32 s3, s55, s65
 buffer_load_dwordx4 v7, s[4:7], s3 offen offset:0 sc1 lds
L_pf_157:
 s_waitcnt lgkmcnt(3)
 v_mfma_f32_32x32x16_bf16 v[80:95], a[24:27], v[56:59], v[80:95]
 ds_read_b128 v[40:43], v7 offset:43008
 s_cmp_eq_u32 s72, 0
 s_cbranch_scc1 L_pf_158
 s_add_u32 m0, s56, 8192
 s_add_u32 s3, s55, s65
 buffer_load_dwordx4 v7, s[4:7], s3 offen offset:1024 sc1 lds
L_pf_158:
 s_waitcnt lgkmcnt(3)
 v_mfma_f32_32x32x16_bf16 v[80:95], a[28:31], v[60:63], v[80:95]
 ds_read_b128 v[44:47], v7 offset:44032
 s_waitcnt lgkmcnt(3)
 v_mfma_f32_32x32x16_bf16 v[80:95], a[32:35], v[32:35], v[80:95]
 ds_read_b128 v[48:51], v7 offset:45056
 s_cmp_eq_u32 s72, 0
 s_cbranch_scc1 L_pf_159
 s_add_u32 m0, s56, 16384
 s_add_u32 s3, s55, s66
 buffer_load_dwordx4 v7, s[4:7], s3 offen offset:0 sc1 lds
L_pf_159:
 s_waitcnt lgkmcnt(3)
 v_mfma_f32_32x32x16_bf16 v[80:95], a[36:39], v[36:39], v[80:95]
 ds_read_b128 v[52:55], v7 offset:46080
 s_cmp_eq_u32 s72, 0
 s_cbranch_scc1 L_pf_160
 s_add_u32 m0, s56, 16384
 s_add_u32 s3, s55, s66
 buffer_load_dwordx4 v7, s[4:7], s3 offen offset:1024 sc1 lds
L_pf_160:
 s_waitcnt lgkmcnt(3)
 v_mfma_f32_32x32x16_bf16 v[80:95], a[40:43], v[40:43], v[80:95]
 ds_read_b128 v[56:59], v7 offset:47104
 s_waitcnt lgkmcnt(3)
 v_mfma_f32_32x32x16_bf16 v[80:95], a[44:47], v[44:47], v[80:95]
 ds_read_b128 v[60:63], v7 offset:48128
 s_cmp_eq_u32 s72, 0
 s_cbranch_scc1 L_pf_161
 s_add_u32 m0, s56, 24576
 s_add_u32 s3, s55, s67
 buffer_load_dwordx4 v7, s[4:7], s3 offen offset:0 sc1 lds
L_pf_161:
 s_waitcnt lgkmcnt(3)
 v_mfma_f32_32x32x16_bf16 v[80:95], a[48:51], v[48:51], v[80:95]
 ds_read_b128 v[32:35], v7 offset:49152
 s_cmp_eq_u32 s72, 0
 s_cbranch_scc1 L_pf_162
 s_add_u32 m0, s56, 24576
 s_add_u32 s3, s55, s67
 buffer_load_dwordx4 v7, s[4:7], s3 offen offset:1024 sc1 lds
L_pf_162:
 s_waitcnt lgkmcnt(3)
 v_mfma_f32_32x32x16_bf16 v[80:95], a[52:55], v[52:55], v[80:95]
 ds_read_b128 v[36:39], v7 offset:50176
 v_mov_b32 v2, s59
 v_writelane_b32 v2, s54, 0
 v_lshl_add_u32 v2, v2, 2, v5
 s_cmp_lt_u32 s54, 64
 s_cselect_b32 s3, 8, 0
 v_writelane_b32 v6, s3, 0
 s_cselect_b32 s3, 13, 0
 s_add_u32 s3, s3, s59
 s_cmp_ge_u32 s54, s3
 s_cselect_b32 s3, 8, 0
 v_writelane_b32 v6, s3, 1
 v_mov_b32 v9, 0
 s_mov_b64 exec, 3
 buffer_atomic_add v9, v2, s[4:7], s68 offen sc0
 s_mov_b64 exec, -1
 s_waitcnt lgkmcnt(3)
 v_mfma_f32_32x32x16_bf16 v[80:95], a[56:59], v[56:59], v[80:95]
 ds_read_b128 v[40:43], v7 offset:51200
 s_waitcnt lgkmcnt(3)
 v_mfma_f32_32x32x16_bf16 v[80:95], a[60:63], v[60:63], v[80:95]
 ds_read_b128 v[44:47], v7 offset:52224
 s_waitcnt lgkmcnt(3)
 v_mfma_f32_32x32x16_bf16 v[80:95], a[64:67], v[32:35], v[80:95]
 ds_read_b128 v[48:51], v7 offset:53248
 s_waitcnt lgkmcnt(3)
 v_mfma_f32_32x32x16_bf16 v[80:95], a[68:71], v[36:39], v[80:95]
 ds_read_b128 v[52:55], v7 offset:54272
 s_waitcnt lgkmcnt(3)
 v_mfma_f32_32x32x16_bf16 v[80:95], a[72:75], v[40:43], v[80:95]
 ds_read_b128 v[56:59], v7 offset:55296
 s_waitcnt lgkmcnt(3)
 v_mfma_f32_32x32x16_bf16 v[80:95], a[76:79], v[44:47], v[80:95]
 ds_read_b128 v[60:63], v7 offset:56320
 s_waitcnt vmcnt(9)
 s_cmp_lg_u32 s72, 0
 s_cbranch_scc1 L_pf_163
 s_waitcnt vmcnt(1)
L_pf_163:
 s_barrier
 s_cmp_lg_u32 s50, 1
 s_cbranch_scc1 L_sg_164
 s_cmp_ge_u32 s57, 64
 s_cbranch_scc1 L_sg_164
 s_lshl_b32 s3, s57, 2
 s_add_u32 s3, s3, 98304
 v_mov_b32 v3, 1
 s_mov_b32 exec_hi, 0
 buffer_atomic_add v3, v8, s[4:7], s3 offen
 s_mov_b64 exec, -1
L_sg_164:
 s_waitcnt lgkmcnt(3)
 v_mfma_f32_32x32x16_bf16 v[80:95], a[80:83], v[48:51], v[80:95]
 ds_read_b128 v[32:35], v7 offset:57344
 s_waitcnt lgkmcnt(3)
 v_mfma_f32_32x32x16_bf16 v[80:95], a[84:87], v[52:55], v[80:95]
 ds_read_b128 v[36:39], v7 offset:58368
 s_waitcnt lgkmcnt(3)
 v_mfma_f32_32x32x16_bf16 v[80:95], a[88:91], v[56:59], v[80:95]
 ds_read_b128 v[40:43], v7 offset:59392
 s_waitcnt lgkmcnt(3)
 v_mfma_f32_32x32x16_bf16 v[80:95], a[92:95], v[60:63], v[80:95]
 ds_read_b128 v[44:47], v7 offset:60416
 s_waitcnt lgkmcnt(3)
 v_mfma_f32_32x32x16_bf16 v[80:95], a[96:99], v[32:35], v[80:95]
 ds_read_b128 v[48:51], v7 offset:61440
 s_waitcnt lgkmcnt(3)
 v_mfma_f32_32x32x16_bf16 v[80:95], a[100:103], v[36:39], v[80:95]
 ds_read_b128 v[52:55], v7 offset:62464
 s_waitcnt lgkmcnt(3)
 v_mfma_f32_32x32x16_bf16 v[80:95], a[104:107], v[40:43], v[80:95]
 ds_read_b128 v[56:59], v7 offset:63488
 s_waitcnt lgkmcnt(3)
 v_mfma_f32_32x32x16_bf16 v[80:95], a[108:111], v[44:47], v[80:95]
 ds_read_b128 v[60:63], v7 offset:64512
 s_waitcnt lgkmcnt(3)
 v_mfma_f32_32x32x16_bf16 v[80:95], a[112:115], v[48:51], v[80:95]
 s_waitcnt lgkmcnt(2)
 v_mfma_f32_32x32x16_bf16 v[80:95], a[116:119], v[52:55], v[80:95]
 s_waitcnt lgkmcnt(1)
 v_mfma_f32_32x32x16_bf16 v[80:95], a[120:123], v[56:59], v[80:95]
 s_waitcnt lgkmcnt(0)
 v_mfma_f32_32x32x16_bf16 v[80:95], a[124:127], v[60:63], v[80:95]
 s_mul_i32 s63, s60, 327680
 s_add_u32 s63, s63, s58
 s_add_u32 s63, s63, 20971520
 s_cmp_lt_u32 s60, 64
 s_cselect_b32 s63, s63, 268435456
 s_nop 8
 v_cvt_pk_bf16_f32 v80, v80, v81
 v_cvt_pk_bf16_f32 v81, v82, v83
 ds_write_b64 v14, v[80:81] offset:8704
 v_cvt_pk_bf16_f32 v84, v84, v85
 v_cvt_pk_bf16_f32 v85, v86, v87
 ds_write_b64 v14, v[84:85] offset:8720
 v_cvt_pk_bf16_f32 v88, v88, v89
 v_cvt_pk_bf16_f32 v89, v90, v91
 ds_write_b64 v14, v[88:89] offset:8736
 v_cvt_pk_bf16_f32 v92, v92, v93
 v_cvt_pk_bf16_f32 v93, v94, v95
 ds_write_b64 v14, v[92:93] offset:8752
 s_cmp_lg_u32 s50, 0
 s_cbranch_scc1 L_w0_165
 s_waitcnt vmcnt(0)
L_w0_165:
 s_cmp_lg_u32 s50, 0
 s_cselect_b64 exec, 0, 3
 ds_write_b32 v10, v9 offset:0
 s_mov_b64 exec, -1
 s_waitcnt lgkmcnt(0)
 s_barrier
 ds_read_b32 v9, v10 offset:0
 ds_read_b128 v[112:115], v15 offset:8704
 ds_read_b128 v[116:119], v15 offset:9792
 s_cmp_lg_u32 s50, 2
 s_cbranch_scc1 L_sg_166
 s_cmp_ge_u32 s61, 64
 s_cbranch_scc1 L_sg_166
 s_lshl_b32 s3, s61, 2
 s_add_u32 s3, s3, 98560
 v_mov_b32 v3, 1
 s_mov_b32 exec_hi, 0
 buffer_atomic_add v3, v8, s[4:7], s3 offen
 s_mov_b64 exec, -1
L_sg_166:
 s_mov_b32 s61, s60
 s_waitcnt lgkmcnt(0)
 v_cmp_gt_u32 vcc, v6, v9
 s_cmp_ge_u32 s54, 64
 s_cbranch_scc1 L_wo_tail
 s_cbranch_vccz L_wo_loop
 s_branch L_wo_block
L_wo_tail:
 s_add_u32 s3, s63, 0
 buffer_store_dwordx4 v[112:115], v4, s[4:7], s3 offen sc1
 s_add_u32 s3, s63, 5120
 buffer_store_dwordx4 v[116:119], v4, s[4:7], s3 offen sc1
 v_mov_b32 v2, s59
 v_writelane_b32 v2, s54, 0
 v_lshl_add_u32 v2, v2, 2, v5
 s_cmp_lt_u32 s54, 64
 s_cselect_b32 s3, 8, 0
 v_writelane_b32 v6, s3, 0
 s_cselect_b32 s3, 13, 0
 s_add_u32 s3, s3, s59
 s_cmp_ge_u32 s54, s3
 s_cselect_b32 s3, 8, 0
 v_writelane_b32 v6, s3, 1
 v_mov_b32 v9, 0
 s_mov_b64 exec, 3
 buffer_atomic_add v9, v2, s[4:7], s68 offen sc0
 s_mov_b64 exec, -1
 s_waitcnt vmcnt(1)
 s_barrier
 s_cmp_lg_u32 s50, 1
 s_cbranch_scc1 L_sg_167
 s_cmp_ge_u32 s61, 64
 s_cbranch_scc1 L_sg_167
 s_lshl_b32 s3, s61, 2
 s_add_u32 s3, s3, 98560
 v_mov_b32 v3, 1
 s_mov_b32 exec_hi, 0
 buffer_atomic_add v3, v8, s[4:7], s3 offen
 s_mov_b64 exec, -1
L_sg_167:
 s_cmp_ge_u32 s59, 64
 s_cbranch_scc1 L_bail
 s_cmp_lg_u32 s50, 0
 s_cbranch_scc1 L_w_168
 s_waitcnt vmcnt(0)
 v_cmp_gt_u32 vcc, v6, v9
 s_cbranch_vccz L_w_168
 v_mov_b32 v13, 0
 s_mov_b32 s51, 0
 s_mov_b64 exec, 3
 v_mov_b32 v12, 0
 buffer_atomic_add v12, v2, s[4:7], 0 offen sc0
 s_sleep 5
L_wc_169:
 v_mov_b32 v13, 0
 buffer_atomic_add v13, v2, s[4:7], 0 offen sc0
 s_waitcnt vmcnt(1)
 v_cmp_gt_u32 vcc, v6, v12
 s_cbranch_vccz L_wcd_170
 v_mov_b32 v12, 0
 buffer_atomic_add v12, v2, s[4:7], 0 offen sc0
 s_waitcnt vmcnt(1)
 v_cmp_gt_u32 vcc, v6, v13
 s_cbranch_vccz L_wcd_170
 s_add_u32 s51, s51, 1
 s_cmp_lt_u32 s51, 131072
 s_cbranch_scc1 L_wc_169
 s_branch L_bail
L_wcd_170:
 s_mov_b64 exec, -1
 v_max_u32 v9, v12, v13
L_w_168:
 s_barrier
 s_mov_b32 s61, s59
 s_add_u32 s59, s59, 1
 s_lshl_b32 s3, s52, 16
 s_add_u32 s3, s3, s56
 s_add_u32 s3, s3, 117440512
 s_lshl_b32 s55, s61, 19
 s_add_u32 s55, s55, s3
 s_cmp_lt_u32 s61, 64
 s_cselect_b32 s55, s55, 268435456
 s_add_u32 m0, s56, 32768
 s_add_u32 s3, s55, s64
 buffer_load_dwordx4 v7, s[4:7], s3 offen offset:0 sc1 lds
 s_add_u32 m0, s56, 32768
 s_add_u32 s3, s55, s64
 buffer_load_dwordx4 v7, s[4:7], s3 offen offset:1024 sc1 lds
 s_add_u32 m0, s56, 40960
 s_add_u32 s3, s55, s65
 buffer_load_dwordx4 v7, s[4:7], s3 offen offset:0 sc1 lds
 s_add_u32 m0, s56, 40960
 s_add_u32 s3, s55, s65
 buffer_load_dwordx4 v7, s[4:7], s3 offen offset:1024 sc1 lds
 s_add_u32 m0, s56, 49152
 s_add_u32 s3, s55, s66
 buffer_load_dwordx4 v7, s[4:7], s3 offen offset:0 sc1 lds
 s_add_u32 m0, s56, 49152
 s_add_u32 s3, s55, s66
 buffer_load_dwordx4 v7, s[4:7], s3 offen offset:1024 sc1 lds
 s_add_u32 m0, s56, 57344
 s_add_u32 s3, s55, s67
 buffer_load_dwordx4 v7, s[4:7], s3 offen offset:0 sc1 lds
 s_add_u32 m0, s56, 57344
 s_add_u32 s3, s55, s67
 buffer_load_dwordx4 v7, s[4:7], s3 offen offset:1024 sc1 lds
 s_waitcnt vmcnt(6)
 s_barrier
 ds_read_b128 v[32:35], v7 offset:32768
 ds_read_b128 v[36:39], v7 offset:33792
 ds_read_b128 v[40:43], v7 offset:34816
 ds_read_b128 v[44:47], v7 offset:35840
 s_waitcnt lgkmcnt(3)
 v_mfma_f32_32x32x16_bf16 v[80:95], a[0:3], v[32:35], 0
 ds_read_b128 v[48:51], v7 offset:36864
 s_waitcnt lgkmcnt(3)
 v_mfma_f32_32x32x16_bf16 v[80:95], a[4:7], v[36:39], v[80:95]
 ds_read_b128 v[52:55], v7 offset:37888
 s_waitcnt lgkmcnt(3)
 v_mfma_f32_32x32x16_bf16 v[80:95], a[8:11], v[40:43], v[80:95]
 ds_read_b128 v[56:59], v7 offset:38912
 s_waitcnt lgkmcnt(3)
 v_mfma_f32_32x32x16_bf16 v[80:95], a[12:15], v[44:47], v[80:95]
 ds_read_b128 v[60:63], v7 offset:39936
 s_waitcnt lgkmcnt(3)
 v_mfma_f32_32x32x16_bf16 v[80:95], a[16:19], v[48:51], v[80:95]
 s_waitcnt vmcnt(4)
 s_barrier
 ds_read_b128 v[32:35], v7 offset:40960
 s_waitcnt lgkmcnt(3)
 v_mfma_f32_32x32x16_bf16 v[80:95], a[20:23], v[52:55], v[80:95]
 ds_read_b128 v[36:39], v7 offset:41984
 s_waitcnt lgkmcnt(3)
 v_mfma_f32_32x32x16_bf16 v[80:95], a[24:27], v[56:59], v[80:95]
 ds_read_b128 v[40:43], v7 offset:43008
 s_waitcnt lgkmcnt(3)
 v_mfma_f32_32x32x16_bf16 v[80:95], a[28:31], v[60:63], v[80:95]
 ds_read_b128 v[44:47], v7 offset:44032
 s_waitcnt lgkmcnt(3)
 v_mfma_f32_32x32x16_bf16 v[80:95], a[32:35], v[32:35], v[80:95]
 ds_read_b128 v[48:51], v7 offset:45056
 s_waitcnt lgkmcnt(3)
 v_mfma_f32_32x32x16_bf16 v[80:95], a[36:39], v[36:39], v[80:95]
 ds_read_b128 v[52:55], v7 offset:46080
 s_waitcnt lgkmcnt(3)
 v_mfma_f32_32x32x16_bf16 v[80:95], a[40:43], v[40:43], v[80:95]
 ds_read_b128 v[56:59], v7 offset:47104
 s_waitcnt lgkmcnt(3)
 v_mfma_f32_32x32x16_bf16 v[80:95], a[44:47], v[44:47], v[80:95]
 ds_read_b128 v[60:63], v7 offset:48128
 s_waitcnt lgkmcnt(3)
 v_mfma_f32_32x32x16_bf16 v[80:95], a[48:51], v[48:51], v[80:95]
 s_waitcnt vmcnt(2)
 s_barrier
 ds_read_b128 v[32:35], v7 offset:49152
 s_waitcnt lgkmcnt(3)
 v_mfma_f32_32x32x16_bf16 v[80:95], a[52:55], v[52:55], v[80:95]
 ds_read_b128 v[36:39], v7 offset:50176
 s_waitcnt lgkmcnt(3)
 v_mfma_f32_32x32x16_bf16 v[80:95], a[56:59], v[56:59], v[80:95]
 ds_read_b128 v[40:43], v7 offset:51200
 s_waitcnt lgkmcnt(3)
 v_mfma_f32_32x32x16_bf16 v[80:95], a[60:63], v[60:63], v[80:95]
 ds_read_b128 v[44:47], v7 offset:52224
 s_waitcnt lgkmcnt(3)
 v_mfma_f32_32x32x16_bf16 v[80:95], a[64:67], v[32:35], v[80:95]
 ds_read_b128 v[48:51], v7 offset:53248
 s_waitcnt lgkmcnt(3)
 v_mfma_f32_32x32x16_bf16 v[80:95], a[68:71], v[36:39], v[80:95]
 ds_read_b128 v[52:55], v7 offset:54272
 s_waitcnt lgkmcnt(3)
 v_mfma_f32_32x32x16_bf16 v[80:95], a[72:75], v[40:43], v[80:95]
 ds_read_b128 v[56:59], v7 offset:55296
 s_waitcnt lgkmcnt(3)
 v_mfma_f32_32x32x16_bf16 v[80:95], a[76:79], v[44:47], v[80:95]
 ds_read_b128 v[60:63], v7 offset:56320
 s_waitcnt lgkmcnt(3)
 v_mfma_f32_32x32x16_bf16 v[80:95], a[80:83], v[48:51], v[80:95]
 s_waitcnt vmcnt(0)
 s_barrier
 ds_read_b128 v[32:35], v7 offset:57344
 s_waitcnt lgkmcnt(3)
 v_mfma_f32_32x32x16_bf16 v[80:95], a[84:87], v[52:55], v[80:95]
 ds_read_b128 v[36:39], v7 offset:58368
 s_waitcnt lgkmcnt(3)
 v_mfma_f32_32x32x16_bf16 v[80:95], a[88:91], v[56:59], v[80:95]
 ds_read_b128 v[40:43], v7 offset:59392
 s_waitcnt lgkmcnt(3)
 v_mfma_f32_32x32x16_bf16 v[80:95], a[92:95], v[60:63], v[80:95]
 ds_read_b128 v[44:47], v7 offset:60416
 s_waitcnt lgkmcnt(3)
 v_mfma_f32_32x32x16_bf16 v[80:95], a[96:99], v[32:35], v[80:95]
 ds_read_b128 v[48:51], v7 offset:61440
 s_waitcnt lgkmcnt(3)
 v_mfma_f32_32x32x16_bf16 v[80:95], a[100:103], v[36:39], v[80:95]
 ds_read_b128 v[52:55], v7 offset:62464
 s_waitcnt lgkmcnt(3)
 v_mfma_f32_32x32x16_bf16 v[80:95], a[104:107], v[40:43], v[80:95]
 ds_read_b128 v[56:59], v7 offset:63488
 s_waitcnt lgkmcnt(3)
 v_mfma_f32_32x32x16_bf16 v[80:95], a[108:111], v[44:47], v[80:95]
 ds_read_b128 v[60:63], v7 offset:64512
 s_waitcnt lgkmcnt(3)
 v_mfma_f32_32x32x16_bf16 v[80:95], a[112:115], v[48:51], v[80:95]
 s_waitcnt lgkmcnt(2)
 v_mfma_f32_32x32x16_bf16 v[80:95], a[116:119], v[52:55], v[80:95]
 s_waitcnt lgkmcnt(1)
 v_mfma_f32_32x32x16_bf16 v[80:95], a[120:123], v[56:59], v[80:95]
 s_waitcnt lgkmcnt(0)
 v_mfma_f32_32x32x16_bf16 v[80:95], a[124:127], v[60:63], v[80:95]
 s_mul_i32 s63, s61, 327680
 s_add_u32 s63, s63, s58
 s_add_u32 s63, s63, 20971520
 s_cmp_lt_u32 s61, 64
 s_cselect_b32 s63, s63, 268435456
 s_nop 8
 v_cvt_pk_bf16_f32 v80, v80, v81
 v_cvt_pk_bf16_f32 v81, v82, v83
 ds_write_b64 v14, v[80:81] offset:8704
 v_cvt_pk_bf16_f32 v84, v84, v85
 v_cvt_pk_bf16_f32 v85, v86, v87
 ds_write_b64 v14, v[84:85] offset:8720
 v_cvt_pk_bf16_f32 v88, v88, v89
 v_cvt_pk_bf16_f32 v89, v90, v91
 ds_write_b64 v14, v[88:89] offset:8736
 v_cvt_pk_bf16_f32 v92, v92, v93
 v_cvt_pk_bf16_f32 v93, v94, v95
 ds_write_b64 v14, v[92:93] offset:8752
 s_waitcnt lgkmcnt(0)
 s_barrier
 ds_read_b128 v[112:115], v15 offset:8704
 ds_read_b128 v[116:119], v15 offset:9792
 s_waitcnt lgkmcnt(0)
 s_branch L_wo_tail
L_t4:
 s_lshr_b32 s53, s50, 1
 s_and_b32 s61, s50, 1
 s_lshl_b32 s52, s52, 1
 s_add_u32 s52, s52, s61
 s_mov_b32 s54, 0
 v_lshlrev_b32 v1, 4, v0
 v_mov_b32 v72, 0
 s_lshl_b32 s3, s50, 2
 s_add_u32 s3, s3, 163776
 v_mov_b32 v73, s3
 ds_write_b32 v73, v72
 s_cmp_lg_u32 s50, 0
 s_cbranch_scc1 L_ww_171
 s_mov_b32 s96, s44
 s_and_b32 s97, s45, 0xffff
 s_mov_b32 s98, 256
 s_mov_b32 s99, 0x00020000
 v_mov_b32 v12, 136
 s_mov_b32 s51, 0
 s_mov_b64 exec, 1
L_wb_172:
 buffer_load_dword v13, v12, s[96:99], 0 offen sc1
 s_waitcnt vmcnt(0)
 v_cmp_eq_u32 vcc, 0, v13
 s_cbranch_vccz L_wbd_173
 s_sleep 2
 s_add_u32 s51, s51, 1
 s_cmp_lt_u32 s51, 131072
 s_cbranch_scc1 L_wb_172
 s_branch L_bail
L_wbd_173:
 s_mov_b64 exec, -1
L_ww_171:
 s_barrier
 s_mul_i32 s55, s52, 40960
 s_mul_i32 s56, s53, 20480
 s_add_u32 s55, s55, s56
 s_add_u32 s55, s55, 200802304
 s_mul_i32 s59, s61, 40960
 s_add_u32 s56, s56, s59
 v_and_b32 v36, 48, v0
 v_xor_b32 v36, v36, v1
 v_xor_b32 v37, 64, v36
 v_xor_b32 v38, 128, v36
 v_xor_b32 v39, 192, v36
 s_add_u32 m0, s56, 0
 s_add_u32 s3, s55, 0
 buffer_load_dwordx4 v36, s[4:7], s3 offen offset:0 sc1 lds
 buffer_load_dwordx4 v37, s[4:7], s3 offen offset:1024 sc1 lds
 buffer_load_dwordx4 v38, s[4:7], s3 offen offset:2048 sc1 lds
 buffer_load_dwordx4 v39, s[4:7], s3 offen offset:3072 sc1 lds
 s_add_u32 m0, s56, 4096
 s_add_u32 s3, s55, 4096
 buffer_load_dwordx4 v36, s[4:7], s3 offen offset:0 sc1 lds
 buffer_load_dwordx4 v37, s[4:7], s3 offen offset:1024 sc1 lds
 buffer_load_dwordx4 v38, s[4:7], s3 offen offset:2048 sc1 lds
 buffer_load_dwordx4 v39, s[4:7], s3 offen offset:3072 sc1 lds
 s_add_u32 m0, s56, 8192
 s_add_u32 s3, s55, 8192
 buffer_load_dwordx4 v36, s[4:7], s3 offen offset:0 sc1 lds
 buffer_load_dwordx4 v37, s[4:7], s3 offen offset:1024 sc1 lds
 buffer_load_dwordx4 v38, s[4:7], s3 offen offset:2048 sc1 lds
 buffer_load_dwordx4 v39, s[4:7], s3 offen offset:3072 sc1 lds
 s_add_u32 m0, s56, 12288
 s_add_u32 s3, s55, 12288
 buffer_load_dwordx4 v36, s[4:7], s3 offen offset:0 sc1 lds
 buffer_load_dwordx4 v37, s[4:7], s3 offen offset:1024 sc1 lds
 buffer_load_dwordx4 v38, s[4:7], s3 offen offset:2048 sc1 lds
 buffer_load_dwordx4 v39, s[4:7], s3 offen offset:3072 sc1 lds
 s_add_u32 m0, s56, 16384
 s_add_u32 s3, s55, 16384
 buffer_load_dwordx4 v36, s[4:7], s3 offen offset:0 sc1 lds
 buffer_load_dwordx4 v37, s[4:7], s3 offen offset:1024 sc1 lds
 buffer_load_dwordx4 v38, s[4:7], s3 offen offset:2048 sc1 lds
 buffer_load_dwordx4 v39, s[4:7], s3 offen offset:3072 sc1 lds
 s_waitcnt vmcnt(0) lgkmcnt(0)
 s_barrier
 s_cmp_eq_u32 s53, 0
 s_cbranch_scc1 L_e0_174
 s_mul_i32 s71, s61, 13312
 s_add_u32 s71, s71, 131072
 s_add_u32 s70, s52, 384
 s_mov_b32 s69, 32
 s_mov_b32 s96, s44
 s_and_b32 s97, s45, 0xffff
 s_mov_b32 s98, 256
 s_mov_b32 s99, 0x00020000
 v_mov_b32 v1, 208
 s_mov_b32 s51, 0
 s_mov_b64 exec, 1
L_wb_175:
 buffer_load_dword v2, v1, s[96:99], 0 offen sc1
 s_waitcnt vmcnt(0)
 v_cmp_eq_u32 vcc, 0, v2
 s_cbranch_vccz L_wbd_176
 s_sleep 2
 s_add_u32 s51, s51, 1
 s_cmp_lt_u32 s51, 131072
 s_cbranch_scc1 L_wb_175
 s_branch L_bail
L_wbd_176:
 s_mov_b64 exec, -1
 s_mov_b32 s8, s38
 s_and_b32 s9, s39, 0xffff
 s_mov_b32 s10, 2621440
 s_mov_b32 s11, 0x00020000
 s_mov_b32 s12, s40
 s_and_b32 s13, s41, 0xffff
 s_mov_b32 s14, 1280
 s_mov_b32 s15, 0x00020000
 v_lshlrev_b32 v130, 4, v0
 s_lshl_b32 s73, s70, 12
 s_add_u32 s74, s73, 2
 buffer_load_dwordx4 v[96:99], v130, s[8:11], s73 offen offset:0
 buffer_load_dwordx4 v[100:103], v130, s[8:11], s73 offen offset:1024
 buffer_load_dwordx4 v[104:107], v130, s[8:11], s73 offen offset:2048
 buffer_load_dwordx4 v[108:111], v130, s[8:11], s73 offen offset:3072
 buffer_load_dwordx4 v[112:115], v130, s[8:11], s74 offen offset:0
 buffer_load_dwordx4 v[116:119], v130, s[8:11], s74 offen offset:1024
 buffer_load_dwordx4 v[120:123], v130, s[8:11], s74 offen offset:2048
 buffer_load_dwordx4 v[124:127], v130, s[8:11], s74 offen offset:3072
 s_lshl_b32 s3, s70, 1
 buffer_load_ushort v128, off, s[12:15], s3
 s_lshl_b32 s3, s70, 12
 s_add_u32 s3, s3, 198180864
 buffer_load_dwordx4 v[240:243], v130, s[4:7], s3 offen offset:0 sc1
 buffer_load_dwordx4 v[244:247], v130, s[4:7], s3 offen offset:1024 sc1
 buffer_load_dwordx4 v[248:251], v130, s[4:7], s3 offen offset:2048 sc1
 buffer_load_dwordx4 v[252:255], v130, s[4:7], s3 offen offset:3072 sc1
 s_getpc_b64 s[76:77]
L_ca_177:
 s_add_u32 s76, s76, L_conv1-L_ca_177
 s_addc_u32 s77, s77, -1
 s_swappc_b64 s[76:77], s[76:77]
 s_waitcnt vmcnt(0)
 s_mov_b32 s96, s44
 s_and_b32 s97, s45, 0xffff
 s_mov_b32 s98, 256
 s_mov_b32 s99, 0x00020000
 v_mov_b32 v1, 1
 s_mov_b64 exec, 1
 buffer_atomic_add v1, off, s[96:99], 0 offset:76 sc0
 s_waitcnt vmcnt(0)
 v_cmp_eq_u32 vcc, 127, v1
 s_cbranch_vccz L_aw_178
 buffer_store_dword v1, off, s[96:99], 0 offset:204 sc1
L_aw_178:
 s_mov_b64 exec, -1
 s_mov_b32 s96, s44
 s_and_b32 s97, s45, 0xffff
 s_mov_b32 s98, 256
 s_mov_b32 s99, 0x00020000
 v_mov_b32 v1, 204
 s_mov_b32 s51, 0
 s_mov_b64 exec, 1
L_wb_179:
 buffer_load_dword v2, v1, s[96:99], 0 offen sc1
 s_waitcnt vmcnt(0)
 v_cmp_eq_u32 vcc, 0, v2
 s_cbranch_vccz L_wbd_180
 s_sleep 16
 s_add_u32 s51, s51, 1
 s_cmp_lt_u32 s51, 131072
 s_cbranch_scc1 L_wb_179
 s_branch L_bail
L_wbd_180:
 s_mov_b64 exec, -1
 v_lshlrev_b32 v1, 4, v0
 v_and_b32 v36, 48, v0
 v_xor_b32 v36, v36, v1
 v_xor_b32 v37, 64, v36
 v_xor_b32 v38, 128, v36
 v_xor_b32 v39, 192, v36
 s_add_u32 s3, s55, 1290240
 buffer_load_dwordx4 a[0:3], v36, s[4:7], s3 offen offset:0 sc1
 buffer_load_dwordx4 a[4:7], v37, s[4:7], s3 offen offset:1024 sc1
 buffer_load_dwordx4 a[8:11], v38, s[4:7], s3 offen offset:2048 sc1
 buffer_load_dwordx4 a[12:15], v39, s[4:7], s3 offen offset:3072 sc1
 s_add_u32 s3, s55, 1294336
 buffer_load_dwordx4 a[16:19], v36, s[4:7], s3 offen offset:0 sc1
 buffer_load_dwordx4 a[20:23], v37, s[4:7], s3 offen offset:1024 sc1
 buffer_load_dwordx4 a[24:27], v38, s[4:7], s3 offen offset:2048 sc1
 buffer_load_dwordx4 a[28:31], v39, s[4:7], s3 offen offset:3072 sc1
 s_add_u32 s3, s55, 1298432
 buffer_load_dwordx4 a[32:35], v36, s[4:7], s3 offen offset:0 sc1
 buffer_load_dwordx4 a[36:39], v37, s[4:7], s3 offen offset:1024 sc1
 buffer_load_dwordx4 a[40:43], v38, s[4:7], s3 offen offset:2048 sc1
 buffer_load_dwordx4 a[44:47], v39, s[4:7], s3 offen offset:3072 sc1
 s_add_u32 s3, s55, 1302528
 buffer_load_dwordx4 a[48:51], v36, s[4:7], s3 offen offset:0 sc1
 buffer_load_dwordx4 a[52:55], v37, s[4:7], s3 offen offset:1024 sc1
 buffer_load_dwordx4 a[56:59], v38, s[4:7], s3 offen offset:2048 sc1
 buffer_load_dwordx4 a[60:63], v39, s[4:7], s3 offen offset:3072 sc1
 s_add_u32 s3, s55, 1306624
 buffer_load_dwordx4 a[64:67], v36, s[4:7], s3 offen offset:0 sc1
 buffer_load_dwordx4 a[68:71], v37, s[4:7], s3 offen offset:1024 sc1
 buffer_load_dwordx4 a[72:75], v38, s[4:7], s3 offen offset:2048 sc1
 buffer_load_dwordx4 a[76:79], v39, s[4:7], s3 offen offset:3072 sc1
 s_add_u32 s3, s55, 1310720
 buffer_load_dwordx4 a[80:83], v36, s[4:7], s3 offen offset:0 sc1
 buffer_load_dwordx4 a[84:87], v37, s[4:7], s3 offen offset:1024 sc1
 buffer_load_dwordx4 a[88:91], v38, s[4:7], s3 offen offset:2048 sc1
 buffer_load_dwordx4 a[92:95], v39, s[4:7], s3 offen offset:3072 sc1
 s_add_u32 s3, s55, 1314816
 buffer_load_dwordx4 a[96:99], v36, s[4:7], s3 offen offset:0 sc1
 buffer_load_dwordx4 a[100:103], v37, s[4:7], s3 offen offset:1024 sc1
 buffer_load_dwordx4 a[104:107], v38, s[4:7], s3 offen offset:2048 sc1
 buffer_load_dwordx4 a[108:111], v39, s[4:7], s3 offen offset:3072 sc1
 s_add_u32 s3, s55, 1318912
 buffer_load_dwordx4 a[112:115], v36, s[4:7], s3 offen offset:0 sc1
 buffer_load_dwordx4 a[116:119], v37, s[4:7], s3 offen offset:1024 sc1
 buffer_load_dwordx4 a[120:123], v38, s[4:7], s3 offen offset:2048 sc1
 buffer_load_dwordx4 a[124:127], v39, s[4:7], s3 offen offset:3072 sc1
 s_add_u32 s3, s55, 1323008
 buffer_load_dwordx4 a[128:131], v36, s[4:7], s3 offen offset:0 sc1
 buffer_load_dwordx4 a[132:135], v37, s[4:7], s3 offen offset:1024 sc1
 buffer_load_dwordx4 a[136:139], v38, s[4:7], s3 offen offset:2048 sc1
 buffer_load_dwordx4 a[140:143], v39, s[4:7], s3 offen offset:3072 sc1
 s_add_u32 s3, s55, 1327104
 buffer_load_dwordx4 a[144:147], v36, s[4:7], s3 offen offset:0 sc1
 buffer_load_dwordx4 a[148:151], v37, s[4:7], s3 offen offset:1024 sc1
 buffer_load_dwordx4 a[152:155], v38, s[4:7], s3 offen offset:2048 sc1
 buffer_load_dwordx4 a[156:159], v39, s[4:7], s3 offen offset:3072 sc1
 s_waitcnt vmcnt(0)
L_e0_174:
 v_add_u32 v74, s59, v1
 v_and_b32 v72, 0xf0, v1
 v_lshl_add_u32 v72, v0, 8, v72
 v_add_u32 v72, s59, v72
 s_lshl_b32 s3, s61, 2
 s_add_u32 s3, s3, 163776
 v_mov_b32 v73, s3
 s_mov_b32 s8, s16
 s_and_b32 s9, s17, 0xffff
 s_mov_b32 s10, 2621440
 s_mov_b32 s11, 0x00020000
 s_mov_b32 s12, s42
 s_and_b32 s13, s43, 0xffff
 s_mov_b32 s14, 2621440
 s_mov_b32 s15, 0x00020000
 v_lshlrev_b32 v1, 4, v0
 v_lshlrev_b32 v2, 3, v0
 v_cmp_lt_u32 vcc, 31, v0
 v_mov_b32 v3, 268435456
 s_nop 1
 v_cndmask_b32 v6, v1, v3, vcc
 v_cndmask_b32 v7, v2, v3, vcc
 s_and_b32 s3, s52, 15
 v_lshrrev_b32 v4, 3, v0
 v_lshlrev_b32 v4, 2, v4
 v_and_b32 v10, 3, v0
 v_add_u32 v4, v4, v10
 v_xor_b32 v4, s3, v4
 v_lshlrev_b32 v4, 4, v4
 v_and_b32 v10, 4, v0
 v_lshl_add_u32 v4, v10, 1, v4
 v_cndmask_b32 v8, v4, v3, vcc
 s_mov_b32 s96, s44
 s_and_b32 s97, s45, 0xffff
 s_mov_b32 s98, 256
 s_mov_b32 s99, 0x00020000
 v_mov_b32 v12, 132
 s_mov_b32 s3, 144
 v_writelane_b32 v12, s3, 1
 s_mov_b32 s51, 0
 s_mov_b64 exec, 3
L_wb_181:
 buffer_load_dword v13, v12, s[96:99], 0 offen sc1
 s_waitcnt vmcnt(0)
 v_cmp_eq_u32 vcc, 0, v13
 s_cbranch_vccz L_wbd_182
 s_sleep 2
 s_add_u32 s51, s51, 1
 s_cmp_lt_u32 s51, 131072
 s_cbranch_scc1 L_wb_181
 s_branch L_bail
L_wbd_182:
 s_mov_b64 exec, -1
 v_readlane_b32 s81, v13, 1
 s_nop 3
 s_sub_u32 s81, s81, 1
 s_xor_b32 s78, s81, 0
 s_lshl_b32 s78, s78, 13
 s_xor_b32 s79, s78, 8192
 s_lshl_b32 s3, s52, 9
 s_lshr_b32 s100, s3, 13
 s_lshl_b32 s100, s100, 13
 s_add_u32 s3, s3, s100
 s_lshl_b32 s55, s53, 8
 s_add_u32 s3, s3, s55
 s_add_u32 s3, s3, s78
 s_add_u32 s3, s3, 98304
 v_mul_u32_u24 v5, 32768, v0
 v_add_u32 v5, s3, v5
 v_lshlrev_b32 v68, 8, v0
 v_and_b32 v10, 0xffffe000, v68
 v_add_u32 v68, v68, v10
 v_add_u32 v69, s79, v68
 v_add_u32 v68, s79, v68
 v_cmp_lt_u32 vcc, 55, v0
 s_nop 1
 v_cndmask_b32 v68, v68, v69, vcc
 s_mov_b32 s57, 0x3acccccd
 s_mov_b32 s58, 0x3727c5ac
 s_mov_b32 s62, 0x3f80
 s_mov_b32 s63, 0x3f800000
 v_mov_b32 v24, 0
 v_mov_b32 v25, 0
 v_mov_b32 v26, 0
 v_mov_b32 v27, 0
 v_mov_b32 v28, 0
 v_mov_b32 v29, 0
 v_mov_b32 v30, 0
 v_mov_b32 v31, 0
 v_mov_b32 v32, 0
 v_mov_b32 v33, 0
 v_mov_b32 v34, 0
 v_mov_b32 v35, 0
 s_mul_i32 s60, s52, 1280
 s_add_u32 s3, s60, 0
 s_cmp_eq_u32 s53, 0
 s_cselect_b32 s3, s3, 268435456
 buffer_load_dwordx2 v[176:177], v2, s[8:11], s3 offen offset:0
 buffer_load_dwordx2 v[178:179], v2, s[8:11], s3 offen offset:512
 buffer_load_dwordx2 v[180:181], v7, s[8:11], s3 offen offset:1024
 s_lshl_b32 s55, s54, 2
 v_mov_b32 v75, 0
 s_mov_b64 exec, 15
 buffer_atomic_add v75, v5, s[4:7], s55 offen offset:0 sc0
 s_mov_b64 exec, -1
 s_waitcnt vmcnt(0)
L_t4_loop:
 s_mov_b32 s51, 0
L_tw_183:
 v_cmp_gt_u32 vcc, 10, v75
 s_and_b32 s3, vcc_lo, 15
 s_cbranch_scc0 L_twd_184
 s_sleep 2
 s_lshl_b32 s55, s54, 2
 v_mov_b32 v75, 0
 s_mov_b64 exec, 15
 buffer_atomic_add v75, v5, s[4:7], s55 offen offset:0 sc0
 s_mov_b64 exec, -1
 s_waitcnt vmcnt(0)
 s_add_u32 s51, s51, 1
 s_cmp_lt_u32 s51, 131072
 s_cbranch_scc1 L_tw_183
 s_branch L_bail
L_twd_184:
 s_lshl_b32 s55, s53, 6
 s_add_u32 s55, s55, s54
 s_mul_i32 s55, s55, 327680
 s_mul_i32 s3, s52, 1280
 s_add_u32 s55, s55, s3
 s_add_u32 s55, s55, 150994944
 buffer_load_dwordx2 v[92:93], v2, s[4:7], s55 offen offset:0 sc1 nt
 buffer_load_dwordx2 v[94:95], v2, s[4:7], s55 offen offset:512 sc1 nt
 buffer_load_dwordx2 v[96:97], v7, s[4:7], s55 offen offset:1024 sc1 nt
 s_add_u32 s55, s55, 40960
 buffer_load_dwordx2 v[98:99], v2, s[4:7], s55 offen offset:0 sc1 nt
 buffer_load_dwordx2 v[100:101], v2, s[4:7], s55 offen offset:512 sc1 nt
 buffer_load_dwordx2 v[102:103], v7, s[4:7], s55 offen offset:1024 sc1 nt
 s_add_u32 s55, s55, 40960
 buffer_load_dwordx2 v[104:105], v2, s[4:7], s55 offen offset:0 sc1 nt
 buffer_load_dwordx2 v[106:107], v2, s[4:7], s55 offen offset:512 sc1 nt
 buffer_load_dwordx2 v[108:109], v7, s[4:7], s55 offen offset:1024 sc1 nt
 s_add_u32 s55, s55, 40960
 buffer_load_dwordx2 v[110:111], v2, s[4:7], s55 offen offset:0 sc1 nt
 buffer_load_dwordx2 v[112:113], v2, s[4:7], s55 offen offset:512 sc1 nt
 buffer_load_dwordx2 v[114:115], v7, s[4:7], s55 offen offset:1024 sc1 nt
 s_add_u32 s55, s55, 40960
 buffer_load_dwordx2 v[116:117], v2, s[4:7], s55 offen offset:0 sc1 nt
 buffer_load_dwordx2 v[118:119], v2, s[4:7], s55 offen offset:512 sc1 nt
 buffer_load_dwordx2 v[120:121], v7, s[4:7], s55 offen offset:1024 sc1 nt
 s_add_u32 s55, s55, 40960
 buffer_load_dwordx2 v[122:123], v2, s[4:7], s55 offen offset:0 sc1 nt
 buffer_load_dwordx2 v[124:125], v2, s[4:7], s55 offen offset:512 sc1 nt
 buffer_load_dwordx2 v[126:127], v7, s[4:7], s55 offen offset:1024 sc1 nt
 s_add_u32 s55, s55, 40960
 buffer_load_dwordx2 v[128:129], v2, s[4:7], s55 offen offset:0 sc1 nt
 buffer_load_dwordx2 v[130:131], v2, s[4:7], s55 offen offset:512 sc1 nt
 buffer_load_dwordx2 v[132:133], v7, s[4:7], s55 offen offset:1024 sc1 nt
 s_add_u32 s55, s55, 40960
 buffer_load_dwordx2 v[134:135], v2, s[4:7], s55 offen offset:0 sc1 nt
 buffer_load_dwordx2 v[136:137], v2, s[4:7], s55 offen offset:512 sc1 nt
 buffer_load_dwordx2 v[138:139], v7, s[4:7], s55 offen offset:1024 sc1 nt
 s_add_u32 s55, s55, 40960
 s_and_b32 s3, s54, 39
 s_cmp_lg_u32 s3, 32
 s_cbranch_scc1 L_yhd_186
 s_bfe_u32 s55, s54, 0x20003
 s_mov_b32 s51, 0
L_yh_185:
 ds_read_b32 v36, v73 offset:8
 s_waitcnt lgkmcnt(0)
 v_cmp_ge_u32 vcc, s55, v36
 s_cbranch_vccz L_yhd_186
 s_sleep 8
 s_add_u32 s51, s51, 1
 s_cmp_lt_u32 s51, 131072
 s_cbranch_scc1 L_yh_185
 s_branch L_bail
L_yhd_186:
 s_and_b32 s3, s54, 7
 s_lshl_b32 s3, s3, 3
 s_bfe_u32 s55, s54, 0x20003
 s_lshl_b32 s55, s55, 1
 s_add_u32 s3, s3, s55
 v_xor_b32 v36, s3, v72
 v_xor_b32 v37, 64, v36
 v_xor_b32 v38, 128, v36
 v_xor_b32 v39, 192, v36
 ds_read_u16_d16_hi v24, v36 offset:0
 ds_read_u16_d16_hi v25, v37 offset:0
 ds_read_u16_d16_hi v26, v38 offset:0
 ds_read_u16_d16_hi v27, v39 offset:0
 ds_read_u16_d16_hi v28, v36 offset:16384
 ds_read_u16_d16_hi v29, v37 offset:16384
 ds_read_u16_d16_hi v30, v38 offset:16384
 ds_read_u16_d16_hi v31, v39 offset:16384
 s_mov_b32 exec_hi, 0
 ds_read_u16_d16_hi v32, v36 offset:32768
 ds_read_u16_d16_hi v33, v37 offset:32768
 ds_read_u16_d16_hi v34, v38 offset:32768
 ds_read_u16_d16_hi v35, v39 offset:32768
 s_mov_b32 exec_hi, -1
 v_lshlrev_b32 v12, 16, v176
 v_and_b32 v13, 0xffff0000, v176
 v_lshlrev_b32 v14, 16, v177
 v_and_b32 v15, 0xffff0000, v177
 v_lshlrev_b32 v16, 16, v178
 v_and_b32 v17, 0xffff0000, v178
 v_lshlrev_b32 v18, 16, v179
 v_and_b32 v19, 0xffff0000, v179
 v_lshlrev_b32 v20, 16, v180
 v_and_b32 v21, 0xffff0000, v180
 v_lshlrev_b32 v22, 16, v181
 v_and_b32 v23, 0xffff0000, v181
 s_add_u32 s3, s60, 40960
 s_cmp_eq_u32 s53, 0
 s_cselect_b32 s3, s3, 268435456
 buffer_load_dwordx2 v[176:177], v2, s[8:11], s3 offen offset:0
 buffer_load_dwordx2 v[178:179], v2, s[8:11], s3 offen offset:512
 buffer_load_dwordx2 v[180:181], v7, s[8:11], s3 offen offset:1024
 s_and_b32 s56, s54, 15
 s_lshl_b32 s3, s61, 4
 s_add_u32 s56, s56, s3
 s_mul_i32 s56, s56, 1536
 s_add_u32 s56, s56, 81920
 v_add_u32 v3, s56, v2
 s_cmp_eq_u32 s53, 0
 s_cbranch_scc1 L_l0_187
 ds_read_b64 v[48:49], v3 offset:0
 ds_read_b64 v[50:51], v3 offset:512
 ds_read_b64 v[52:53], v3 offset:1024
 s_waitcnt lgkmcnt(0)
 v_lshlrev_b32 v12, 16, v48
 v_and_b32 v13, 0xffff0000, v48
 v_lshlrev_b32 v14, 16, v49
 v_and_b32 v15, 0xffff0000, v49
 v_lshlrev_b32 v16, 16, v50
 v_and_b32 v17, 0xffff0000, v50
 v_lshlrev_b32 v18, 16, v51
 v_and_b32 v19, 0xffff0000, v51
 v_lshlrev_b32 v20, 16, v52
 v_and_b32 v21, 0xffff0000, v52
 v_lshlrev_b32 v22, 16, v53
 v_and_b32 v23, 0xffff0000, v53
 s_add_u32 s3, s54, 1
 v_mov_b32 v10, s3
 ds_write_b32 v73, v10
L_l0_187:
 s_waitcnt vmcnt(24)
 v_lshlrev_b32 v80, 16, v92
 v_and_b32 v81, 0xffff0000, v92
 v_lshlrev_b32 v82, 16, v93
 v_and_b32 v83, 0xffff0000, v93
 v_lshlrev_b32 v84, 16, v94
 v_and_b32 v85, 0xffff0000, v94
 v_lshlrev_b32 v86, 16, v95
 v_and_b32 v87, 0xffff0000, v95
 v_lshlrev_b32 v88, 16, v96
 v_and_b32 v89, 0xffff0000, v96
 v_lshlrev_b32 v90, 16, v97
 v_and_b32 v91, 0xffff0000, v97
 s_waitcnt vmcnt(21)
 v_dot2c_f32_bf16 v80, s62, v98
 v_dot2c_f32_bf16 v81, s63, v98
 v_dot2c_f32_bf16 v82, s62, v99
 v_dot2c_f32_bf16 v83, s63, v99
 v_dot2c_f32_bf16 v84, s62, v100
 v_dot2c_f32_bf16 v85, s63, v100
 v_dot2c_f32_bf16 v86, s62, v101
 v_dot2c_f32_bf16 v87, s63, v101
 v_dot2c_f32_bf16 v88, s62, v102
 v_dot2c_f32_bf16 v89, s63, v102
 v_dot2c_f32_bf16 v90, s62, v103
 v_dot2c_f32_bf16 v91, s63, v103
 s_waitcnt vmcnt(18)
 v_dot2c_f32_bf16 v80, s62, v104
 v_dot2c_f32_bf16 v81, s63, v104
 v_dot2c_f32_bf16 v82, s62, v105
 v_dot2c_f32_bf16 v83, s63, v105
 v_dot2c_f32_bf16 v84, s62, v106
 v_dot2c_f32_bf16 v85, s63, v106
 v_dot2c_f32_bf16 v86, s62, v107
 v_dot2c_f32_bf16 v87, s63, v107
 v_dot2c_f32_bf16 v88, s62, v108
 v_dot2c_f32_bf16 v89, s63, v108
 v_dot2c_f32_bf16 v90, s62, v109
 v_dot2c_f32_bf16 v91, s63, v109
 s_waitcnt vmcnt(15)
 v_dot2c_f32_bf16 v80, s62, v110
 v_dot2c_f32_bf16 v81, s63, v110
 v_dot2c_f32_bf16 v82, s62, v111
 v_dot2c_f32_bf16 v83, s63, v111
 v_dot2c_f32_bf16 v84, s62, v112
 v_dot2c_f32_bf16 v85, s63, v112
 v_dot2c_f32_bf16 v86, s62, v113
 v_dot2c_f32_bf16 v87, s63, v113
 v_dot2c_f32_bf16 v88, s62, v114
 v_dot2c_f32_bf16 v89, s63, v114
 v_dot2c_f32_bf16 v90, s62, v115
 v_dot2c_f32_bf16 v91, s63, v115
 s_waitcnt vmcnt(12)
 v_dot2c_f32_bf16 v80, s62, v116
 v_dot2c_f32_bf16 v81, s63, v116
 v_dot2c_f32_bf16 v82, s62, v117
 v_dot2c_f32_bf16 v83, s63, v117
 v_dot2c_f32_bf16 v84, s62, v118
 v_dot2c_f32_bf16 v85, s63, v118
 v_dot2c_f32_bf16 v86, s62, v119
 v_dot2c_f32_bf16 v87, s63, v119
 v_dot2c_f32_bf16 v88, s62, v120
 v_dot2c_f32_bf16 v89, s63, v120
 v_dot2c_f32_bf16 v90, s62, v121
 v_dot2c_f32_bf16 v91, s63, v121
 s_waitcnt vmcnt(9)
 v_dot2c_f32_bf16 v80, s62, v122
 v_dot2c_f32_bf16 v81, s63, v122
 v_dot2c_f32_bf16 v82, s62, v123
 v_dot2c_f32_bf16 v83, s63, v123
 v_dot2c_f32_bf16 v84, s62, v124
 v_dot2c_f32_bf16 v85, s63, v124
 v_dot2c_f32_bf16 v86, s62, v125
 v_dot2c_f32_bf16 v87, s63, v125
 v_dot2c_f32_bf16 v88, s62, v126
 v_dot2c_f32_bf16 v89, s63, v126
 v_dot2c_f32_bf16 v90, s62, v127
 v_dot2c_f32_bf16 v91, s63, v127
 s_waitcnt vmcnt(6)
 v_dot2c_f32_bf16 v80, s62, v128
 v_dot2c_f32_bf16 v81, s63, v128
 v_dot2c_f32_bf16 v82, s62, v129
 v_dot2c_f32_bf16 v83, s63, v129
 v_dot2c_f32_bf16 v84, s62, v130
 v_dot2c_f32_bf16 v85, s63, v130
 v_dot2c_f32_bf16 v86, s62, v131
 v_dot2c_f32_bf16 v87, s63, v131
 v_dot2c_f32_bf16 v88, s62, v132
 v_dot2c_f32_bf16 v89, s63, v132
 v_dot2c_f32_bf16 v90, s62, v133
 v_dot2c_f32_bf16 v91, s63, v133
 s_waitcnt vmcnt(3)
 v_dot2c_f32_bf16 v80, s62, v134
 v_dot2c_f32_bf16 v81, s63, v134
 v_dot2c_f32_bf16 v82, s62, v135
 v_dot2c_f32_bf16 v83, s63, v135
 v_dot2c_f32_bf16 v84, s62, v136
 v_dot2c_f32_bf16 v85, s63, v136
 v_dot2c_f32_bf16 v86, s62, v137
 v_dot2c_f32_bf16 v87, s63, v137
 v_dot2c_f32_bf16 v88, s62, v138
 v_dot2c_f32_bf16 v89, s63, v138
 v_dot2c_f32_bf16 v90, s62, v139
 v_dot2c_f32_bf16 v91, s63, v139
 s_waitcnt lgkmcnt(0)
 s_nop 1
 v_cvt_pk_bf16_f32 v9, v80, v81
 v_lshlrev_b32 v80, 16, v9
 v_and_b32 v81, 0xffff0000, v9
 v_cvt_pk_bf16_f32 v9, v82, v83
 v_lshlrev_b32 v82, 16, v9
 v_and_b32 v83, 0xffff0000, v9
 v_cvt_pk_bf16_f32 v9, v84, v85
 v_lshlrev_b32 v84, 16, v9
 v_and_b32 v85, 0xffff0000, v9
 v_cvt_pk_bf16_f32 v9, v86, v87
 v_lshlrev_b32 v86, 16, v9
 v_and_b32 v87, 0xffff0000, v9
 v_cvt_pk_bf16_f32 v9, v88, v89
 v_lshlrev_b32 v88, 16, v9
 v_and_b32 v89, 0xffff0000, v9
 v_cvt_pk_bf16_f32 v9, v90, v91
 v_lshlrev_b32 v90, 16, v9
 v_and_b32 v91, 0xffff0000, v9
 v_pk_add_f32 v[12:13], v[12:13], v[80:81]
 v_pk_add_f32 v[14:15], v[14:15], v[82:83]
 v_pk_add_f32 v[16:17], v[16:17], v[84:85]
 v_pk_add_f32 v[18:19], v[18:19], v[86:87]
 v_pk_add_f32 v[20:21], v[20:21], v[88:89]
 v_pk_add_f32 v[22:23], v[22:23], v[90:91]
 v_cvt_pk_bf16_f32 v9, v12, v13
 v_lshlrev_b32 v12, 16, v9
 v_and_b32 v13, 0xffff0000, v9
 v_cvt_pk_bf16_f32 v9, v14, v15
 v_lshlrev_b32 v14, 16, v9
 v_and_b32 v15, 0xffff0000, v9
 v_cvt_pk_bf16_f32 v9, v16, v17
 v_lshlrev_b32 v16, 16, v9
 v_and_b32 v17, 0xffff0000, v9
 v_cvt_pk_bf16_f32 v9, v18, v19
 v_lshlrev_b32 v18, 16, v9
 v_and_b32 v19, 0xffff0000, v9
 v_cvt_pk_bf16_f32 v9, v20, v21
 v_lshlrev_b32 v20, 16, v9
 v_and_b32 v21, 0xffff0000, v9
 v_cvt_pk_bf16_f32 v9, v22, v23
 v_lshlrev_b32 v22, 16, v9
 v_and_b32 v23, 0xffff0000, v9
 v_readfirstlane_b32 s3, v12
 s_nop 1
 v_subrev_f32 v36, s3, v12
 v_subrev_f32 v37, s3, v13
 v_subrev_f32 v38, s3, v14
 v_subrev_f32 v39, s3, v15
 v_subrev_f32 v40, s3, v16
 v_subrev_f32 v41, s3, v17
 v_subrev_f32 v42, s3, v18
 v_subrev_f32 v43, s3, v19
 v_mov_b32 v44, 0
 v_mov_b32 v45, 0
 v_mov_b32 v46, 0
 v_mov_b32 v47, 0
 s_mov_b32 exec_hi, 0
 v_subrev_f32 v44, s3, v20
 v_subrev_f32 v45, s3, v21
 v_subrev_f32 v46, s3, v22
 v_subrev_f32 v47, s3, v23
 s_mov_b32 exec_hi, -1
 v_pk_mul_f32 v[10:11], v[36:37], v[36:37]
 v_pk_fma_f32 v[10:11], v[38:39], v[38:39], v[10:11]
 v_pk_fma_f32 v[10:11], v[40:41], v[40:41], v[10:11]
 v_pk_fma_f32 v[10:11], v[42:43], v[42:43], v[10:11]
 v_pk_fma_f32 v[10:11], v[44:45], v[44:45], v[10:11]
 v_pk_fma_f32 v[10:11], v[46:47], v[46:47], v[10:11]
 v_pk_add_f32 v[36:37], v[36:37], v[38:39]
 v_pk_add_f32 v[36:37], v[36:37], v[40:41]
 v_pk_add_f32 v[36:37], v[36:37], v[42:43]
 v_pk_add_f32 v[36:37], v[36:37], v[44:45]
 v_pk_add_f32 v[36:37], v[36:37], v[46:47]
 v_add_f32 v11, v10, v11
 v_add_f32 v10, v36, v37
 s_nop 0
 v_add_f32_dpp v11, v11, v11 quad_perm:[1,0,3,2] row_mask:0xf bank_mask:0xf
 v_add_f32_dpp v10, v10, v10 quad_perm:[1,0,3,2] row_mask:0xf bank_mask:0xf
 s_nop 0
 v_add_f32_dpp v11, v11, v11 quad_perm:[2,3,0,1] row_mask:0xf bank_mask:0xf
 v_add_f32_dpp v10, v10, v10 quad_perm:[2,3,0,1] row_mask:0xf bank_mask:0xf
 s_nop 0
 v_add_f32_dpp v11, v11, v11 row_half_mirror row_mask:0xf bank_mask:0xf
 v_add_f32_dpp v10, v10, v10 row_half_mirror row_mask:0xf bank_mask:0xf
 s_nop 0
 v_add_f32_dpp v11, v11, v11 row_mirror row_mask:0xf bank_mask:0xf
 v_add_f32_dpp v10, v10, v10 row_mirror row_mask:0xf bank_mask:0xf
 v_mov_b32 v37, v11
 v_mov_b32 v36, v10
 s_nop 0
 v_permlane16_swap_b32 v11, v37
 v_permlane16_swap_b32 v10, v36
 v_pk_add_f32 v[10:11], v[10:11], v[36:37]
 v_mov_b32 v37, v11
 v_mov_b32 v36, v10
 s_nop 0
 v_permlane32_swap_b32 v11, v37
 v_permlane32_swap_b32 v10, v36
 v_pk_add_f32 v[10:11], v[10:11], v[36:37]
 v_mul_f32 v10, s57, v10
 v_mul_f32 v11, s57, v11
 v_fma_f32 v11, -v10, v10, v11
 v_max_f32 v11, 0, v11
 v_add_f32 v10, s3, v10
 v_cvt_pk_bf16_f32 v9, v10, v11
 v_lshlrev_b32 v10, 16, v9
 v_and_b32 v11, 0xffff0000, v9
 v_add_f32 v11, s58, v11
 v_cvt_pk_bf16_f32 v11, v11, v11
 v_and_b32 v11, 0xffff0000, v11
 v_sqrt_f32 v11, v11
 s_nop 0
 v_pk_add_f32 v[36:37], v[12:13], v[10:11] op_sel_hi:[1,0] neg_lo:[0,1] neg_hi:[0,1]
 v_pk_add_f32 v[38:39], v[14:15], v[10:11] op_sel_hi:[1,0] neg_lo:[0,1] neg_hi:[0,1]
 v_pk_add_f32 v[40:41], v[16:17], v[10:11] op_sel_hi:[1,0] neg_lo:[0,1] neg_hi:[0,1]
 v_pk_add_f32 v[42:43], v[18:19], v[10:11] op_sel_hi:[1,0] neg_lo:[0,1] neg_hi:[0,1]
 v_pk_add_f32 v[44:45], v[20:21], v[10:11] op_sel_hi:[1,0] neg_lo:[0,1] neg_hi:[0,1]
 v_pk_add_f32 v[46:47], v[22:23], v[10:11] op_sel_hi:[1,0] neg_lo:[0,1] neg_hi:[0,1]
 v_cvt_pk_bf16_f32 v11, v11, v11
 v_and_b32 v11, 0xffff0000, v11
 v_rcp_f32 v11, v11
 v_cvt_pk_bf16_f32 v9, v36, v37
 v_lshlrev_b32 v36, 16, v9
 v_and_b32 v37, 0xffff0000, v9
 v_cvt_pk_bf16_f32 v9, v38, v39
 v_lshlrev_b32 v38, 16, v9
 v_and_b32 v39, 0xffff0000, v9
 v_cvt_pk_bf16_f32 v9, v40, v41
 v_lshlrev_b32 v40, 16, v9
 v_and_b32 v41, 0xffff0000, v9
 v_cvt_pk_bf16_f32 v9, v42, v43
 v_lshlrev_b32 v42, 16, v9
 v_and_b32 v43, 0xffff0000, v9
 v_cvt_pk_bf16_f32 v9, v44, v45
 v_lshlrev_b32 v44, 16, v9
 v_and_b32 v45, 0xffff0000, v9
 v_cvt_pk_bf16_f32 v9, v46, v47
 v_lshlrev_b32 v46, 16, v9
 v_and_b32 v47, 0xffff0000, v9
 v_pk_mul_f32 v[36:37], v[36:37], v[10:11] op_sel:[0,1] op_sel_hi:[1,1]
 v_pk_mul_f32 v[38:39], v[38:39], v[10:11] op_sel:[0,1] op_sel_hi:[1,1]
 v_pk_mul_f32 v[40:41], v[40:41], v[10:11] op_sel:[0,1] op_sel_hi:[1,1]
 v_pk_mul_f32 v[42:43], v[42:43], v[10:11] op_sel:[0,1] op_sel_hi:[1,1]
 v_pk_mul_f32 v[44:45], v[44:45], v[10:11] op_sel:[0,1] op_sel_hi:[1,1]
 v_pk_mul_f32 v[46:47], v[46:47], v[10:11] op_sel:[0,1] op_sel_hi:[1,1]
 v_cvt_pk_bf16_f32 v9, v36, v37
 v_lshlrev_b32 v36, 16, v9
 v_and_b32 v37, 0xffff0000, v9
 v_cvt_pk_bf16_f32 v9, v38, v39
 v_lshlrev_b32 v38, 16, v9
 v_and_b32 v39, 0xffff0000, v9
 v_cvt_pk_bf16_f32 v9, v40, v41
 v_lshlrev_b32 v40, 16, v9
 v_and_b32 v41, 0xffff0000, v9
 v_cvt_pk_bf16_f32 v9, v42, v43
 v_lshlrev_b32 v42, 16, v9
 v_and_b32 v43, 0xffff0000, v9
 v_cvt_pk_bf16_f32 v9, v44, v45
 v_lshlrev_b32 v44, 16, v9
 v_and_b32 v45, 0xffff0000, v9
 v_cvt_pk_bf16_f32 v9, v46, v47
 v_lshlrev_b32 v46, 16, v9
 v_and_b32 v47, 0xffff0000, v9
 v_pk_mul_f32 v[36:37], v[36:37], v[24:25]
 v_pk_mul_f32 v[38:39], v[38:39], v[26:27]
 v_pk_mul_f32 v[40:41], v[40:41], v[28:29]
 v_pk_mul_f32 v[42:43], v[42:43], v[30:31]
 v_pk_mul_f32 v[44:45], v[44:45], v[32:33]
 v_pk_mul_f32 v[46:47], v[46:47], v[34:35]
 v_cvt_pk_bf16_f32 v9, v36, v37
 v_lshlrev_b32 v36, 16, v9
 v_and_b32 v37, 0xffff0000, v9
 v_cvt_pk_bf16_f32 v9, v38, v39
 v_lshlrev_b32 v38, 16, v9
 v_and_b32 v39, 0xffff0000, v9
 v_cvt_pk_bf16_f32 v9, v40, v41
 v_lshlrev_b32 v40, 16, v9
 v_and_b32 v41, 0xffff0000, v9
 v_cvt_pk_bf16_f32 v9, v42, v43
 v_lshlrev_b32 v42, 16, v9
 v_and_b32 v43, 0xffff0000, v9
 v_cvt_pk_bf16_f32 v9, v44, v45
 v_lshlrev_b32 v44, 16, v9
 v_and_b32 v45, 0xffff0000, v9
 v_cvt_pk_bf16_f32 v9, v46, v47
 v_lshlrev_b32 v46, 16, v9
 v_and_b32 v47, 0xffff0000, v9
 v_pk_add_f32 v[12:13], v[12:13], v[36:37]
 v_pk_add_f32 v[14:15], v[14:15], v[38:39]
 v_pk_add_f32 v[16:17], v[16:17], v[40:41]
 v_pk_add_f32 v[18:19], v[18:19], v[42:43]
 v_pk_add_f32 v[20:21], v[20:21], v[44:45]
 v_pk_add_f32 v[22:23], v[22:23], v[46:47]
 v_cvt_pk_bf16_f32 v60, v12, v13
 v_cvt_pk_bf16_f32 v61, v14, v15
 v_cvt_pk_bf16_f32 v62, v16, v17
 v_cvt_pk_bf16_f32 v63, v18, v19
 v_cvt_pk_bf16_f32 v64, v20, v21
 v_cvt_pk_bf16_f32 v65, v22, v23
 s_cmp_lg_u32 s53, 0
 s_cbranch_scc1 L_l1_188
 s_cmp_lt_u32 s54, 16
 s_cbranch_scc1 L_rgd_191
 s_sub_u32 s55, s54, 15
 s_mov_b32 s51, 0
L_rg_190:
 ds_read_b32 v10, v73
 s_waitcnt lgkmcnt(0)
 v_cmp_gt_u32 vcc, s55, v10
 s_cbranch_vccz L_rgd_191
 s_sleep 8
 s_add_u32 s51, s51, 1
 s_cmp_lt_u32 s51, 131072
 s_cbranch_scc1 L_rg_190
 s_branch L_bail
L_rgd_191:
 ds_write_b64 v3, v[60:61] offset:0
 ds_write_b64 v3, v[62:63] offset:512
 ds_write_b64 v3, v[64:65] offset:1024
 v_lshlrev_b32 v12, 16, v60
 v_and_b32 v13, 0xffff0000, v60
 v_lshlrev_b32 v14, 16, v61
 v_and_b32 v15, 0xffff0000, v61
 v_lshlrev_b32 v16, 16, v62
 v_and_b32 v17, 0xffff0000, v62
 v_lshlrev_b32 v18, 16, v63
 v_and_b32 v19, 0xffff0000, v63
 v_lshlrev_b32 v20, 16, v64
 v_and_b32 v21, 0xffff0000, v64
 v_lshlrev_b32 v22, 16, v65
 v_and_b32 v23, 0xffff0000, v65
 s_nop 0
 v_readfirstlane_b32 s3, v12
 s_nop 1
 v_subrev_f32 v36, s3, v12
 v_subrev_f32 v37, s3, v13
 v_subrev_f32 v38, s3, v14
 v_subrev_f32 v39, s3, v15
 v_subrev_f32 v40, s3, v16
 v_subrev_f32 v41, s3, v17
 v_subrev_f32 v42, s3, v18
 v_subrev_f32 v43, s3, v19
 v_mov_b32 v44, 0
 v_mov_b32 v45, 0
 v_mov_b32 v46, 0
 v_mov_b32 v47, 0
 s_mov_b32 exec_hi, 0
 v_subrev_f32 v44, s3, v20
 v_subrev_f32 v45, s3, v21
 v_subrev_f32 v46, s3, v22
 v_subrev_f32 v47, s3, v23
 s_mov_b32 exec_hi, -1
 v_pk_mul_f32 v[10:11], v[36:37], v[36:37]
 v_pk_fma_f32 v[10:11], v[38:39], v[38:39], v[10:11]
 v_pk_fma_f32 v[10:11], v[40:41], v[40:41], v[10:11]
 v_pk_fma_f32 v[10:11], v[42:43], v[42:43], v[10:11]
 v_pk_fma_f32 v[10:11], v[44:45], v[44:45], v[10:11]
 v_pk_fma_f32 v[10:11], v[46:47], v[46:47], v[10:11]
 v_pk_add_f32 v[36:37], v[36:37], v[38:39]
 v_pk_add_f32 v[36:37], v[36:37], v[40:41]
 v_pk_add_f32 v[36:37], v[36:37], v[42:43]
 v_pk_add_f32 v[36:37], v[36:37], v[44:45]
 v_pk_add_f32 v[36:37], v[36:37], v[46:47]
 v_add_f32 v11, v10, v11
 v_add_f32 v10, v36, v37
 s_nop 0
 v_add_f32_dpp v11, v11, v11 quad_perm:[1,0,3,2] row_mask:0xf bank_mask:0xf
 v_add_f32_dpp v10, v10, v10 quad_perm:[1,0,3,2] row_mask:0xf bank_mask:0xf
 s_nop 0
 v_add_f32_dpp v11, v11, v11 quad_perm:[2,3,0,1] row_mask:0xf bank_mask:0xf
 v_add_f32_dpp v10, v10, v10 quad_perm:[2,3,0,1] row_mask:0xf bank_mask:0xf
 s_nop 0
 v_add_f32_dpp v11, v11, v11 row_half_mirror row_mask:0xf bank_mask:0xf
 v_add_f32_dpp v10, v10, v10 row_half_mirror row_mask:0xf bank_mask:0xf
 s_nop 0
 v_add_f32_dpp v11, v11, v11 row_mirror row_mask:0xf bank_mask:0xf
 v_add_f32_dpp v10, v10, v10 row_mirror row_mask:0xf bank_mask:0xf
 v_mov_b32 v37, v11
 v_mov_b32 v36, v10
 s_nop 0
 v_permlane16_swap_b32 v11, v37
 v_permlane16_swap_b32 v10, v36
 v_pk_add_f32 v[10:11], v[10:11], v[36:37]
 v_mov_b32 v37, v11
 v_mov_b32 v36, v10
 s_nop 0
 v_permlane32_swap_b32 v11, v37
 v_permlane32_swap_b32 v10, v36
 v_pk_add_f32 v[10:11], v[10:11], v[36:37]
 v_mul_f32 v10, s57, v10
 v_mul_f32 v11, s57, v11
 v_fma_f32 v11, -v10, v10, v11
 v_max_f32 v11, 0, v11
 v_add_f32 v10, s3, v10
 v_cvt_pk_bf16_f32 v9, v10, v11
 v_lshlrev_b32 v10, 16, v9
 v_and_b32 v11, 0xffff0000, v9
 v_add_f32 v11, s58, v11
 v_cvt_pk_bf16_f32 v11, v11, v11
 v_and_b32 v11, 0xffff0000, v11
 v_sqrt_f32 v11, v11
 s_nop 0
 v_pk_add_f32 v[36:37], v[12:13], v[10:11] op_sel_hi:[1,0] neg_lo:[0,1] neg_hi:[0,1]
 v_pk_add_f32 v[38:39], v[14:15], v[10:11] op_sel_hi:[1,0] neg_lo:[0,1] neg_hi:[0,1]
 v_pk_add_f32 v[40:41], v[16:17], v[10:11] op_sel_hi:[1,0] neg_lo:[0,1] neg_hi:[0,1]
 v_pk_add_f32 v[42:43], v[18:19], v[10:11] op_sel_hi:[1,0] neg_lo:[0,1] neg_hi:[0,1]
 v_pk_add_f32 v[44:45], v[20:21], v[10:11] op_sel_hi:[1,0] neg_lo:[0,1] neg_hi:[0,1]
 v_pk_add_f32 v[46:47], v[22:23], v[10:11] op_sel_hi:[1,0] neg_lo:[0,1] neg_hi:[0,1]
 v_cvt_pk_bf16_f32 v11, v11, v11
 v_and_b32 v11, 0xffff0000, v11
 v_rcp_f32 v11, v11
 v_cvt_pk_bf16_f32 v9, v36, v37
 v_lshlrev_b32 v36, 16, v9
 v_and_b32 v37, 0xffff0000, v9
 v_cvt_pk_bf16_f32 v9, v38, v39
 v_lshlrev_b32 v38, 16, v9
 v_and_b32 v39, 0xffff0000, v9
 v_cvt_pk_bf16_f32 v9, v40, v41
 v_lshlrev_b32 v40, 16, v9
 v_and_b32 v41, 0xffff0000, v9
 v_cvt_pk_bf16_f32 v9, v42, v43
 v_lshlrev_b32 v42, 16, v9
 v_and_b32 v43, 0xffff0000, v9
 v_cvt_pk_bf16_f32 v9, v44, v45
 v_lshlrev_b32 v44, 16, v9
 v_and_b32 v45, 0xffff0000, v9
 v_cvt_pk_bf16_f32 v9, v46, v47
 v_lshlrev_b32 v46, 16, v9
 v_and_b32 v47, 0xffff0000, v9
 v_pk_mul_f32 v[36:37], v[36:37], v[10:11] op_sel:[0,1] op_sel_hi:[1,1]
 v_pk_mul_f32 v[38:39], v[38:39], v[10:11] op_sel:[0,1] op_sel_hi:[1,1]
 v_pk_mul_f32 v[40:41], v[40:41], v[10:11] op_sel:[0,1] op_sel_hi:[1,1]
 v_pk_mul_f32 v[42:43], v[42:43], v[10:11] op_sel:[0,1] op_sel_hi:[1,1]
 v_pk_mul_f32 v[44:45], v[44:45], v[10:11] op_sel:[0,1] op_sel_hi:[1,1]
 v_pk_mul_f32 v[46:47], v[46:47], v[10:11] op_sel:[0,1] op_sel_hi:[1,1]
 v_cvt_pk_bf16_f32 v48, v36, v37
 v_cvt_pk_bf16_f32 v49, v38, v39
 v_cvt_pk_bf16_f32 v50, v40, v41
 v_cvt_pk_bf16_f32 v51, v42, v43
 v_cvt_pk_bf16_f32 v52, v44, v45
 v_cvt_pk_bf16_f32 v53, v46, v47
 s_add_u32 s3, s60, 195559424
 buffer_store_dwordx2 v[48:49], v4, s[4:7], s3 offen offset:0 sc1
 buffer_store_dwordx2 v[50:51], v4, s[4:7], s3 offen offset:512 sc1
 buffer_store_dwordx2 v[52:53], v8, s[4:7], s3 offen offset:1024 sc1
 s_lshl_b32 s55, s54, 2
 v_mov_b32 v75, 0
 s_mov_b64 exec, 15
 buffer_atomic_add v75, v5, s[4:7], s55 offen offset:4 sc0
 s_mov_b64 exec, -1
 s_waitcnt vmcnt(1) lgkmcnt(0)
 s_and_b32 s55, s52, 3
 s_mul_i32 s55, s55, 49152
 s_lshl_b32 s3, s54, 2
 s_add_u32 s3, s3, s55
 s_add_u32 s3, s3, 229376
 v_mov_b32 v3, 1
 s_mov_b64 exec, -1
 buffer_atomic_add v3, v68, s[4:7], s3 offen
 s_mov_b64 exec, -1
 s_add_u32 s3, s3, 32768
 v_mov_b32 v3, 1
 s_mov_b32 exec_hi, 0
 buffer_atomic_add v3, v69, s[4:7], s3 offen
 s_mov_b64 exec, -1
 s_waitcnt vmcnt(2)
 s_branch L_le_189
L_l1_188:
 buffer_store_dwordx2 v[60:61], v2, s[12:15], s60 offen offset:0 nt
 buffer_store_dwordx2 v[62:63], v2, s[12:15], s60 offen offset:512 nt
 buffer_store_dwordx2 v[64:65], v7, s[12:15], s60 offen offset:1024 nt
 s_lshl_b32 s55, s54, 2
 v_mov_b32 v75, 0
 s_mov_b64 exec, 15
 buffer_atomic_add v75, v5, s[4:7], s55 offen offset:4 sc0
 s_mov_b64 exec, -1
 s_cmp_lg_u32 s54, 7
 s_cbranch_scc1 L_yn_193
 ds_write_b16 v74, a0 offset:0
 ds_write_b16 v74, a2 offset:8
 ds_write_b16 v74, a4 offset:1024
 ds_write_b16 v74, a6 offset:1032
 ds_write_b16 v74, a8 offset:2048
 ds_write_b16 v74, a10 offset:2056
 ds_write_b16 v74, a12 offset:3072
 ds_write_b16 v74, a14 offset:3080
 ds_write_b16 v74, a16 offset:4096
 ds_write_b16 v74, a18 offset:4104
 ds_write_b16 v74, a20 offset:5120
 ds_write_b16 v74, a22 offset:5128
 ds_write_b16 v74, a24 offset:6144
 ds_write_b16 v74, a26 offset:6152
 ds_write_b16 v74, a28 offset:7168
 ds_write_b16 v74, a30 offset:7176
 ds_write_b16 v74, a32 offset:8192
 ds_write_b16 v74, a34 offset:8200
 ds_write_b16 v74, a36 offset:9216
 ds_write_b16 v74, a38 offset:9224
 ds_write_b16 v74, a40 offset:10240
 ds_write_b16 v74, a42 offset:10248
 ds_write_b16 v74, a44 offset:11264
 ds_write_b16 v74, a46 offset:11272
 ds_write_b16 v74, a48 offset:12288
 ds_write_b16 v74, a50 offset:12296
 ds_write_b16 v74, a52 offset:13312
 ds_write_b16 v74, a54 offset:13320
 ds_write_b16 v74, a56 offset:14336
 ds_write_b16 v74, a58 offset:14344
 ds_write_b16 v74, a60 offset:15360
 ds_write_b16 v74, a62 offset:15368
 ds_write_b16 v74, a64 offset:16384
 ds_write_b16 v74, a66 offset:16392
 ds_write_b16 v74, a68 offset:17408
 ds_write_b16 v74, a70 offset:17416
 ds_write_b16 v74, a72 offset:18432
 ds_write_b16 v74, a74 offset:18440
 ds_write_b16 v74, a76 offset:19456
 ds_write_b16 v74, a78 offset:19464
 ds_write_b16 v74, a80 offset:20480
 ds_write_b16 v74, a82 offset:20488
 ds_write_b16 v74, a84 offset:21504
 ds_write_b16 v74, a86 offset:21512
 ds_write_b16 v74, a88 offset:22528
 ds_write_b16 v74, a90 offset:22536
 ds_write_b16 v74, a92 offset:23552
 ds_write_b16 v74, a94 offset:23560
 ds_write_b16 v74, a96 offset:24576
 ds_write_b16 v74, a98 offset:24584
 ds_write_b16 v74, a100 offset:25600
 ds_write_b16 v74, a102 offset:25608
 ds_write_b16 v74, a104 offset:26624
 ds_write_b16 v74, a106 offset:26632
 ds_write_b16 v74, a108 offset:27648
 ds_write_b16 v74, a110 offset:27656
 ds_write_b16 v74, a112 offset:28672
 ds_write_b16 v74, a114 offset:28680
 ds_write_b16 v74, a116 offset:29696
 ds_write_b16 v74, a118 offset:29704
 ds_write_b16 v74, a120 offset:30720
 ds_write_b16 v74, a122 offset:30728
 ds_write_b16 v74, a124 offset:31744
 ds_write_b16 v74, a126 offset:31752
 ds_write_b16 v74, a128 offset:32768
 ds_write_b16 v74, a130 offset:32776
 ds_write_b16 v74, a132 offset:33792
 ds_write_b16 v74, a134 offset:33800
 ds_write_b16 v74, a136 offset:34816
 ds_write_b16 v74, a138 offset:34824
 ds_write_b16 v74, a140 offset:35840
 ds_write_b16 v74, a142 offset:35848
 ds_write_b16 v74, a144 offset:36864
 ds_write_b16 v74, a146 offset:36872
 ds_write_b16 v74, a148 offset:37888
 ds_write_b16 v74, a150 offset:37896
 ds_write_b16 v74, a152 offset:38912
 ds_write_b16 v74, a154 offset:38920
 ds_write_b16 v74, a156 offset:39936
 ds_write_b16 v74, a158 offset:39944
 v_mov_b32 v10, 1
 ds_write_b32 v73, v10 offset:8
 s_branch L_yc_192
L_yn_193:
 s_cmp_lg_u32 s54, 15
 s_cbranch_scc1 L_yn_194
 ds_write_b16_d16_hi v74, a0 offset:2
 ds_write_b16_d16_hi v74, a2 offset:10
 ds_write_b16_d16_hi v74, a4 offset:1026
 ds_write_b16_d16_hi v74, a6 offset:1034
 ds_write_b16_d16_hi v74, a8 offset:2050
 ds_write_b16_d16_hi v74, a10 offset:2058
 ds_write_b16_d16_hi v74, a12 offset:3074
 ds_write_b16_d16_hi v74, a14 offset:3082
 ds_write_b16_d16_hi v74, a16 offset:4098
 ds_write_b16_d16_hi v74, a18 offset:4106
 ds_write_b16_d16_hi v74, a20 offset:5122
 ds_write_b16_d16_hi v74, a22 offset:5130
 ds_write_b16_d16_hi v74, a24 offset:6146
 ds_write_b16_d16_hi v74, a26 offset:6154
 ds_write_b16_d16_hi v74, a28 offset:7170
 ds_write_b16_d16_hi v74, a30 offset:7178
 ds_write_b16_d16_hi v74, a32 offset:8194
 ds_write_b16_d16_hi v74, a34 offset:8202
 ds_write_b16_d16_hi v74, a36 offset:9218
 ds_write_b16_d16_hi v74, a38 offset:9226
 ds_write_b16_d16_hi v74, a40 offset:10242
 ds_write_b16_d16_hi v74, a42 offset:10250
 ds_write_b16_d16_hi v74, a44 offset:11266
 ds_write_b16_d16_hi v74, a46 offset:11274
 ds_write_b16_d16_hi v74, a48 offset:12290
 ds_write_b16_d16_hi v74, a50 offset:12298
 ds_write_b16_d16_hi v74, a52 offset:13314
 ds_write_b16_d16_hi v74, a54 offset:13322
 ds_write_b16_d16_hi v74, a56 offset:14338
 ds_write_b16_d16_hi v74, a58 offset:14346
 ds_write_b16_d16_hi v74, a60 offset:15362
 ds_write_b16_d16_hi v74, a62 offset:15370
 ds_write_b16_d16_hi v74, a64 offset:16386
 ds_write_b16_d16_hi v74, a66 offset:16394
 ds_write_b16_d16_hi v74, a68 offset:17410
 ds_write_b16_d16_hi v74, a70 offset:17418
 ds_write_b16_d16_hi v74, a72 offset:18434
 ds_write_b16_d16_hi v74, a74 offset:18442
 ds_write_b16_d16_hi v74, a76 offset:19458
 ds_write_b16_d16_hi v74, a78 offset:19466
 ds_write_b16_d16_hi v74, a80 offset:20482
 ds_write_b16_d16_hi v74, a82 offset:20490
 ds_write_b16_d16_hi v74, a84 offset:21506
 ds_write_b16_d16_hi v74, a86 offset:21514
 ds_write_b16_d16_hi v74, a88 offset:22530
 ds_write_b16_d16_hi v74, a90 offset:22538
 ds_write_b16_d16_hi v74, a92 offset:23554
 ds_write_b16_d16_hi v74, a94 offset:23562
 ds_write_b16_d16_hi v74, a96 offset:24578
 ds_write_b16_d16_hi v74, a98 offset:24586
 ds_write_b16_d16_hi v74, a100 offset:25602
 ds_write_b16_d16_hi v74, a102 offset:25610
 ds_write_b16_d16_hi v74, a104 offset:26626
 ds_write_b16_d16_hi v74, a106 offset:26634
 ds_write_b16_d16_hi v74, a108 offset:27650
 ds_write_b16_d16_hi v74, a110 offset:27658
 ds_write_b16_d16_hi v74, a112 offset:28674
 ds_write_b16_d16_hi v74, a114 offset:28682
 ds_write_b16_d16_hi v74, a116 offset:29698
 ds_write_b16_d16_hi v74, a118 offset:29706
 ds_write_b16_d16_hi v74, a120 offset:30722
 ds_write_b16_d16_hi v74, a122 offset:30730
 ds_write_b16_d16_hi v74, a124 offset:31746
 ds_write_b16_d16_hi v74, a126 offset:31754
 ds_write_b16_d16_hi v74, a128 offset:32770
 ds_write_b16_d16_hi v74, a130 offset:32778
 ds_write_b16_d16_hi v74, a132 offset:33794
 ds_write_b16_d16_hi v74, a134 offset:33802
 ds_write_b16_d16_hi v74, a136 offset:34818
 ds_write_b16_d16_hi v74, a138 offset:34826
 ds_write_b16_d16_hi v74, a140 offset:35842
 ds_write_b16_d16_hi v74, a142 offset:35850
 ds_write_b16_d16_hi v74, a144 offset:36866
 ds_write_b16_d16_hi v74, a146 offset:36874
 ds_write_b16_d16_hi v74, a148 offset:37890
 ds_write_b16_d16_hi v74, a150 offset:37898
 ds_write_b16_d16_hi v74, a152 offset:38914
 ds_write_b16_d16_hi v74, a154 offset:38922
 ds_write_b16_d16_hi v74, a156 offset:39938
 ds_write_b16_d16_hi v74, a158 offset:39946
 v_mov_b32 v10, 2
 ds_write_b32 v73, v10 offset:8
 s_branch L_yc_192
L_yn_194:
 s_cmp_lg_u32 s54, 23
 s_cbranch_scc1 L_yn_195
 ds_write_b16 v74, a1 offset:4
 ds_write_b16 v74, a3 offset:12
 ds_write_b16 v74, a5 offset:1028
 ds_write_b16 v74, a7 offset:1036
 ds_write_b16 v74, a9 offset:2052
 ds_write_b16 v74, a11 offset:2060
 ds_write_b16 v74, a13 offset:3076
 ds_write_b16 v74, a15 offset:3084
 ds_write_b16 v74, a17 offset:4100
 ds_write_b16 v74, a19 offset:4108
 ds_write_b16 v74, a21 offset:5124
 ds_write_b16 v74, a23 offset:5132
 ds_write_b16 v74, a25 offset:6148
 ds_write_b16 v74, a27 offset:6156
 ds_write_b16 v74, a29 offset:7172
 ds_write_b16 v74, a31 offset:7180
 ds_write_b16 v74, a33 offset:8196
 ds_write_b16 v74, a35 offset:8204
 ds_write_b16 v74, a37 offset:9220
 ds_write_b16 v74, a39 offset:9228
 ds_write_b16 v74, a41 offset:10244
 ds_write_b16 v74, a43 offset:10252
 ds_write_b16 v74, a45 offset:11268
 ds_write_b16 v74, a47 offset:11276
 ds_write_b16 v74, a49 offset:12292
 ds_write_b16 v74, a51 offset:12300
 ds_write_b16 v74, a53 offset:13316
 ds_write_b16 v74, a55 offset:13324
 ds_write_b16 v74, a57 offset:14340
 ds_write_b16 v74, a59 offset:14348
 ds_write_b16 v74, a61 offset:15364
 ds_write_b16 v74, a63 offset:15372
 ds_write_b16 v74, a65 offset:16388
 ds_write_b16 v74, a67 offset:16396
 ds_write_b16 v74, a69 offset:17412
 ds_write_b16 v74, a71 offset:17420
 ds_write_b16 v74, a73 offset:18436
 ds_write_b16 v74, a75 offset:18444
 ds_write_b16 v74, a77 offset:19460
 ds_write_b16 v74, a79 offset:19468
 ds_write_b16 v74, a81 offset:20484
 ds_write_b16 v74, a83 offset:20492
 ds_write_b16 v74, a85 offset:21508
 ds_write_b16 v74, a87 offset:21516
 ds_write_b16 v74, a89 offset:22532
 ds_write_b16 v74, a91 offset:22540
 ds_write_b16 v74, a93 offset:23556
 ds_write_b16 v74, a95 offset:23564
 ds_write_b16 v74, a97 offset:24580
 ds_write_b16 v74, a99 offset:24588
 ds_write_b16 v74, a101 offset:25604
 ds_write_b16 v74, a103 offset:25612
 ds_write_b16 v74, a105 offset:26628
 ds_write_b16 v74, a107 offset:26636
 ds_write_b16 v74, a109 offset:27652
 ds_write_b16 v74, a111 offset:27660
 ds_write_b16 v74, a113 offset:28676
 ds_write_b16 v74, a115 offset:28684
 ds_write_b16 v74, a117 offset:29700
 ds_write_b16 v74, a119 offset:29708
 ds_write_b16 v74, a121 offset:30724
 ds_write_b16 v74, a123 offset:30732
 ds_write_b16 v74, a125 offset:31748
 ds_write_b16 v74, a127 offset:31756
 ds_write_b16 v74, a129 offset:32772
 ds_write_b16 v74, a131 offset:32780
 ds_write_b16 v74, a133 offset:33796
 ds_write_b16 v74, a135 offset:33804
 ds_write_b16 v74, a137 offset:34820
 ds_write_b16 v74, a139 offset:34828
 ds_write_b16 v74, a141 offset:35844
 ds_write_b16 v74, a143 offset:35852
 ds_write_b16 v74, a145 offset:36868
 ds_write_b16 v74, a147 offset:36876
 ds_write_b16 v74, a149 offset:37892
 ds_write_b16 v74, a151 offset:37900
 ds_write_b16 v74, a153 offset:38916
 ds_write_b16 v74, a155 offset:38924
 ds_write_b16 v74, a157 offset:39940
 ds_write_b16 v74, a159 offset:39948
 v_mov_b32 v10, 3
 ds_write_b32 v73, v10 offset:8
 s_branch L_yc_192
L_yn_195:
 s_cmp_lg_u32 s54, 31
 s_cbranch_scc1 L_yc_192
 ds_write_b16_d16_hi v74, a1 offset:6
 ds_write_b16_d16_hi v74, a3 offset:14
 ds_write_b16_d16_hi v74, a5 offset:1030
 ds_write_b16_d16_hi v74, a7 offset:1038
 ds_write_b16_d16_hi v74, a9 offset:2054
 ds_write_b16_d16_hi v74, a11 offset:2062
 ds_write_b16_d16_hi v74, a13 offset:3078
 ds_write_b16_d16_hi v74, a15 offset:3086
 ds_write_b16_d16_hi v74, a17 offset:4102
 ds_write_b16_d16_hi v74, a19 offset:4110
 ds_write_b16_d16_hi v74, a21 offset:5126
 ds_write_b16_d16_hi v74, a23 offset:5134
 ds_write_b16_d16_hi v74, a25 offset:6150
 ds_write_b16_d16_hi v74, a27 offset:6158
 ds_write_b16_d16_hi v74, a29 offset:7174
 ds_write_b16_d16_hi v74, a31 offset:7182
 ds_write_b16_d16_hi v74, a33 offset:8198
 ds_write_b16_d16_hi v74, a35 offset:8206
 ds_write_b16_d16_hi v74, a37 offset:9222
 ds_write_b16_d16_hi v74, a39 offset:9230
 ds_write_b16_d16_hi v74, a41 offset:10246
 ds_write_b16_d16_hi v74, a43 offset:10254
 ds_write_b16_d16_hi v74, a45 offset:11270
 ds_write_b16_d16_hi v74, a47 offset:11278
 ds_write_b16_d16_hi v74, a49 offset:12294
 ds_write_b16_d16_hi v74, a51 offset:12302
 ds_write_b16_d16_hi v74, a53 offset:13318
 ds_write_b16_d16_hi v74, a55 offset:13326
 ds_write_b16_d16_hi v74, a57 offset:14342
 ds_write_b16_d16_hi v74, a59 offset:14350
 ds_write_b16_d16_hi v74, a61 offset:15366
 ds_write_b16_d16_hi v74, a63 offset:15374
 ds_write_b16_d16_hi v74, a65 offset:16390
 ds_write_b16_d16_hi v74, a67 offset:16398
 ds_write_b16_d16_hi v74, a69 offset:17414
 ds_write_b16_d16_hi v74, a71 offset:17422
 ds_write_b16_d16_hi v74, a73 offset:18438
 ds_write_b16_d16_hi v74, a75 offset:18446
 ds_write_b16_d16_hi v74, a77 offset:19462
 ds_write_b16_d16_hi v74, a79 offset:19470
 ds_write_b16_d16_hi v74, a81 offset:20486
 ds_write_b16_d16_hi v74, a83 offset:20494
 ds_write_b16_d16_hi v74, a85 offset:21510
 ds_write_b16_d16_hi v74, a87 offset:21518
 ds_write_b16_d16_hi v74, a89 offset:22534
 ds_write_b16_d16_hi v74, a91 offset:22542
 ds_write_b16_d16_hi v74, a93 offset:23558
 ds_write_b16_d16_hi v74, a95 offset:23566
 ds_write_b16_d16_hi v74, a97 offset:24582
 ds_write_b16_d16_hi v74, a99 offset:24590
 ds_write_b16_d16_hi v74, a101 offset:25606
 ds_write_b16_d16_hi v74, a103 offset:25614
 ds_write_b16_d16_hi v74, a105 offset:26630
 ds_write_b16_d16_hi v74, a107 offset:26638
 ds_write_b16_d16_hi v74, a109 offset:27654
 ds_write_b16_d16_hi v74, a111 offset:27662
 ds_write_b16_d16_hi v74, a113 offset:28678
 ds_write_b16_d16_hi v74, a115 offset:28686
 ds_write_b16_d16_hi v74, a117 offset:29702
 ds_write_b16_d16_hi v74, a119 offset:29710
 ds_write_b16_d16_hi v74, a121 offset:30726
 ds_write_b16_d16_hi v74, a123 offset:30734
 ds_write_b16_d16_hi v74, a125 offset:31750
 ds_write_b16_d16_hi v74, a127 offset:31758
 ds_write_b16_d16_hi v74, a129 offset:32774
 ds_write_b16_d16_hi v74, a131 offset:32782
 ds_write_b16_d16_hi v74, a133 offset:33798
 ds_write_b16_d16_hi v74, a135 offset:33806
 ds_write_b16_d16_hi v74, a137 offset:34822
 ds_write_b16_d16_hi v74, a139 offset:34830
 ds_write_b16_d16_hi v74, a141 offset:35846
 ds_write_b16_d16_hi v74, a143 offset:35854
 ds_write_b16_d16_hi v74, a145 offset:36870
 ds_write_b16_d16_hi v74, a147 offset:36878
 ds_write_b16_d16_hi v74, a149 offset:37894
 ds_write_b16_d16_hi v74, a151 offset:37902
 ds_write_b16_d16_hi v74, a153 offset:38918
 ds_write_b16_d16_hi v74, a155 offset:38926
 ds_write_b16_d16_hi v74, a157 offset:39942
 ds_write_b16_d16_hi v74, a159 offset:39950
 v_mov_b32 v10, 4
 ds_write_b32 v73, v10 offset:8
L_yc_192:
 s_waitcnt vmcnt(0)
L_le_189:
 s_add_u32 s54, s54, 1
 s_add_u32 s60, s60, 40960
 s_cmp_lt_u32 s54, 64
 s_cbranch_scc1 L_t4_loop
 s_cmp_lg_u32 s50, 3
 s_cbranch_scc1 L_bail
 s_endpgm
L_bail:
 s_endpgm
L_ch:
 s_and_b32 s3, s48, 1
 s_lshl_b32 s3, s3, 4
 s_add_u32 s52, s3, s49
 s_mov_b32 s8, s20
 s_and_b32 s9, s21, 0xffff
 s_mov_b32 s10, 5242880
 s_mov_b32 s11, 0x00020000
 s_cmp_lt_u32 s50, 2
 s_cselect_b32 s8, s20, s22
 s_cselect_b32 s9, s21, s23
 s_and_b32 s9, s9, 0xffff
 v_lshrrev_b32 v2, 4, v0
 v_and_b32 v14, 1, v2
 v_lshlrev_b32 v14, 1, v14
 v_xor_b32 v14, v14, v0
 s_lshr_b32 s3, s50, 1
 s_lshl_b32 s3, s3, 3
 v_xor_b32 v14, s3, v14
 v_and_b32 v14, 15, v14
 s_mov_b32 s3, 8192
 v_mul_lo_u32 v2, v2, s3
 v_lshl_add_u32 v2, v14, 4, v2
 v_xor_b32 v3, 64, v2
 s_and_b32 s3, s50, 1
 s_mul_i32 s76, s3, 262144
 s_lshl_b32 s3, s52, 8
 s_add_u32 s76, s76, s3
 s_lshl_b32 s78, s50, 13
 s_add_u32 m0, s78, 0
 s_nop 0
 buffer_load_dwordx4 v2, s[8:11], s76 offen lds
 s_add_u32 s76, s76, 32768
 s_add_u32 m0, s78, 1024
 s_nop 0
 buffer_load_dwordx4 v2, s[8:11], s76 offen lds
 s_add_u32 s76, s76, 32768
 s_add_u32 m0, s78, 2048
 s_nop 0
 buffer_load_dwordx4 v3, s[8:11], s76 offen lds
 s_add_u32 s76, s76, 32768
 s_add_u32 m0, s78, 3072
 s_nop 0
 buffer_load_dwordx4 v3, s[8:11], s76 offen lds
 s_add_u32 s76, s76, 32768
 s_add_u32 m0, s78, 4096
 s_nop 0
 buffer_load_dwordx4 v2, s[8:11], s76 offen lds
 s_add_u32 s76, s76, 32768
 s_add_u32 m0, s78, 5120
 s_nop 0
 buffer_load_dwordx4 v2, s[8:11], s76 offen lds
 s_add_u32 s76, s76, 32768
 s_add_u32 m0, s78, 6144
 s_nop 0
 buffer_load_dwordx4 v3, s[8:11], s76 offen lds
 s_add_u32 s76, s76, 32768
 s_add_u32 m0, s78, 7168
 s_nop 0
 buffer_load_dwordx4 v3, s[8:11], s76 offen lds
 s_add_u32 s76, s76, 294912
 s_add_u32 m0, s78, 32768
 s_nop 0
 buffer_load_dwordx4 v2, s[8:11], s76 offen lds
 s_add_u32 s76, s76, 32768
 s_add_u32 m0, s78, 33792
 s_nop 0
 buffer_load_dwordx4 v2, s[8:11], s76 offen lds
 s_add_u32 s76, s76, 32768
 s_add_u32 m0, s78, 34816
 s_nop 0
 buffer_load_dwordx4 v3, s[8:11], s76 offen lds
 s_add_u32 s76, s76, 32768
 s_add_u32 m0, s78, 35840
 s_nop 0
 buffer_load_dwordx4 v3, s[8:11], s76 offen lds
 s_add_u32 s76, s76, 32768
 s_add_u32 m0, s78, 36864
 s_nop 0
 buffer_load_dwordx4 v2, s[8:11], s76 offen lds
 s_add_u32 s76, s76, 32768
 s_add_u32 m0, s78, 37888
 s_nop 0
 buffer_load_dwordx4 v2, s[8:11], s76 offen lds
 s_add_u32 s76, s76, 32768
 s_add_u32 m0, s78, 38912
 s_nop 0
 buffer_load_dwordx4 v3, s[8:11], s76 offen lds
 s_add_u32 s76, s76, 32768
 s_add_u32 m0, s78, 39936
 s_nop 0
 buffer_load_dwordx4 v3, s[8:11], s76 offen lds
 s_add_u32 s76, s76, 294912
 s_add_u32 m0, s78, 65536
 s_nop 0
 buffer_load_dwordx4 v2, s[8:11], s76 offen lds
 s_add_u32 s76, s76, 32768
 s_add_u32 m0, s78, 66560
 s_nop 0
 buffer_load_dwordx4 v2, s[8:11], s76 offen lds
 s_add_u32 s76, s76, 32768
 s_add_u32 m0, s78, 67584
 s_nop 0
 buffer_load_dwordx4 v3, s[8:11], s76 offen lds
 s_add_u32 s76, s76, 32768
 s_add_u32 m0, s78, 68608
 s_nop 0
 buffer_load_dwordx4 v3, s[8:11], s76 offen lds
 s_add_u32 s76, s76, 32768
 s_add_u32 m0, s78, 69632
 s_nop 0
 buffer_load_dwordx4 v2, s[8:11], s76 offen lds
 s_add_u32 s76, s76, 32768
 s_add_u32 m0, s78, 70656
 s_nop 0
 buffer_load_dwordx4 v2, s[8:11], s76 offen lds
 s_add_u32 s76, s76, 32768
 s_add_u32 m0, s78, 71680
 s_nop 0
 buffer_load_dwordx4 v3, s[8:11], s76 offen lds
 s_add_u32 s76, s76, 32768
 s_add_u32 m0, s78, 72704
 s_nop 0
 buffer_load_dwordx4 v3, s[8:11], s76 offen lds
 s_add_u32 s76, s76, 294912
 s_add_u32 m0, s78, 98304
 s_nop 0
 buffer_load_dwordx4 v2, s[8:11], s76 offen lds
 s_add_u32 s76, s76, 32768
 s_add_u32 m0, s78, 99328
 s_nop 0
 buffer_load_dwordx4 v2, s[8:11], s76 offen lds
 s_add_u32 s76, s76, 32768
 s_add_u32 m0, s78, 100352
 s_nop 0
 buffer_load_dwordx4 v3, s[8:11], s76 offen lds
 s_add_u32 s76, s76, 32768
 s_add_u32 m0, s78, 101376
 s_nop 0
 buffer_load_dwordx4 v3, s[8:11], s76 offen lds
 s_add_u32 s76, s76, 32768
 s_add_u32 m0, s78, 102400
 s_nop 0
 buffer_load_dwordx4 v2, s[8:11], s76 offen lds
 s_add_u32 s76, s76, 32768
 s_add_u32 m0, s78, 103424
 s_nop 0
 buffer_load_dwordx4 v2, s[8:11], s76 offen lds
 s_add_u32 s76, s76, 32768
 s_add_u32 m0, s78, 104448
 s_nop 0
 buffer_load_dwordx4 v3, s[8:11], s76 offen lds
 s_add_u32 s76, s76, 32768
 s_add_u32 m0, s78, 105472
 s_nop 0
 buffer_load_dwordx4 v3, s[8:11], s76 offen lds
 s_add_u32 s76, s76, 294912
 s_add_u32 m0, s78, 131072
 s_nop 0
 buffer_load_dwordx4 v2, s[8:11], s76 offen lds
 s_add_u32 s76, s76, 32768
 s_add_u32 m0, s78, 132096
 s_nop 0
 buffer_load_dwordx4 v2, s[8:11], s76 offen lds
 s_add_u32 s76, s76, 32768
 s_add_u32 m0, s78, 133120
 s_nop 0
 buffer_load_dwordx4 v3, s[8:11], s76 offen lds
 s_add_u32 s76, s76, 32768
 s_add_u32 m0, s78, 134144
 s_nop 0
 buffer_load_dwordx4 v3, s[8:11], s76 offen lds
 s_add_u32 s76, s76, 32768
 s_add_u32 m0, s78, 135168
 s_nop 0
 buffer_load_dwordx4 v2, s[8:11], s76 offen lds
 s_add_u32 s76, s76, 32768
 s_add_u32 m0, s78, 136192
 s_nop 0
 buffer_load_dwordx4 v2, s[8:11], s76 offen lds
 s_add_u32 s76, s76, 32768
 s_add_u32 m0, s78, 137216
 s_nop 0
 buffer_load_dwordx4 v3, s[8:11], s76 offen lds
 s_add_u32 s76, s76, 32768
 s_add_u32 m0, s78, 138240
 s_nop 0
 buffer_load_dwordx4 v3, s[8:11], s76 offen lds
 s_add_u32 s76, s76, 294912
 v_bfe_u32 v14, v0, 2, 1
 v_lshlrev_b32 v4, 8, v14
 v_lshl_add_u32 v4, v14, 5, v4
 v_bfe_u32 v14, v0, 4, 1
 v_lshl_add_u32 v4, v14, 11, v4
 v_lshl_add_u32 v4, v14, 6, v4
 v_bfe_u32 v14, v0, 5, 1
 v_lshl_add_u32 v4, v14, 12, v4
 v_and_b32 v14, 3, v0
 v_lshl_add_u32 v4, v14, 3, v4
 v_bfe_u32 v14, v0, 3, 1
 v_mul_u32_u24 v14, 16512, v14
 v_xor_b32 v4, v4, v14
 s_lshl_b32 s3, s50, 6
 v_xor_b32 v4, s3, v4
 v_xor_b32 v5, 32, v4
 s_waitcnt vmcnt(32)
 s_barrier
 v_add_u32 v6, 0, v4
 v_add_u32 v7, 0, v5
 ds_read_b64_tr_b16 v[224:225], v6 offset:0
 ds_read_b64_tr_b16 v[226:227], v6 offset:512
 ds_read_b64_tr_b16 v[228:229], v6 offset:1024
 ds_read_b64_tr_b16 v[230:231], v6 offset:1536
 ds_read_b64_tr_b16 v[232:233], v7 offset:0
 ds_read_b64_tr_b16 v[234:235], v7 offset:512
 ds_read_b64_tr_b16 v[236:237], v7 offset:1024
 ds_read_b64_tr_b16 v[238:239], v7 offset:1536
 ds_read_b64_tr_b16 v[240:241], v6 offset:8192
 ds_read_b64_tr_b16 v[242:243], v6 offset:8704
 ds_read_b64_tr_b16 v[244:245], v6 offset:9216
 ds_read_b64_tr_b16 v[246:247], v6 offset:9728
 ds_read_b64_tr_b16 v[248:249], v7 offset:8192
 ds_read_b64_tr_b16 v[250:251], v7 offset:8704
 ds_read_b64_tr_b16 v[252:253], v7 offset:9216
 ds_read_b64_tr_b16 v[254:255], v7 offset:9728
 s_waitcnt lgkmcnt(0)
 s_barrier
 s_add_u32 m0, s78, 0
 s_nop 0
 buffer_load_dwordx4 v2, s[8:11], s76 offen lds
 s_add_u32 s76, s76, 32768
 s_add_u32 m0, s78, 1024
 s_nop 0
 buffer_load_dwordx4 v2, s[8:11], s76 offen lds
 s_add_u32 s76, s76, 32768
 s_add_u32 m0, s78, 2048
 s_nop 0
 buffer_load_dwordx4 v3, s[8:11], s76 offen lds
 s_add_u32 s76, s76, 32768
 s_add_u32 m0, s78, 3072
 s_nop 0
 buffer_load_dwordx4 v3, s[8:11], s76 offen lds
 s_add_u32 s76, s76, 32768
 s_add_u32 m0, s78, 4096
 s_nop 0
 buffer_load_dwordx4 v2, s[8:11], s76 offen lds
 s_add_u32 s76, s76, 32768
 s_add_u32 m0, s78, 5120
 s_nop 0
 buffer_load_dwordx4 v2, s[8:11], s76 offen lds
 s_add_u32 s76, s76, 32768
 s_add_u32 m0, s78, 6144
 s_nop 0
 buffer_load_dwordx4 v3, s[8:11], s76 offen lds
 s_add_u32 s76, s76, 32768
 s_add_u32 m0, s78, 7168
 s_nop 0
 buffer_load_dwordx4 v3, s[8:11], s76 offen lds
 s_add_u32 s76, s76, 294912
 s_waitcnt vmcnt(32)
 s_barrier
 v_add_u32 v6, 32768, v4
 v_add_u32 v7, 32768, v5
 ds_read_b64_tr_b16 v[192:193], v6 offset:0
 ds_read_b64_tr_b16 v[194:195], v6 offset:512
 ds_read_b64_tr_b16 v[196:197], v6 offset:1024
 ds_read_b64_tr_b16 v[198:199], v6 offset:1536
 ds_read_b64_tr_b16 v[200:201], v7 offset:0
 ds_read_b64_tr_b16 v[202:203], v7 offset:512
 ds_read_b64_tr_b16 v[204:205], v7 offset:1024
 ds_read_b64_tr_b16 v[206:207], v7 offset:1536
 ds_read_b64_tr_b16 v[208:209], v6 offset:8192
 ds_read_b64_tr_b16 v[210:211], v6 offset:8704
 ds_read_b64_tr_b16 v[212:213], v6 offset:9216
 ds_read_b64_tr_b16 v[214:215], v6 offset:9728
 ds_read_b64_tr_b16 v[216:217], v7 offset:8192
 ds_read_b64_tr_b16 v[218:219], v7 offset:8704
 ds_read_b64_tr_b16 v[220:221], v7 offset:9216
 ds_read_b64_tr_b16 v[222:223], v7 offset:9728
 s_waitcnt lgkmcnt(0)
 s_barrier
 s_add_u32 m0, s78, 32768
 s_nop 0
 buffer_load_dwordx4 v2, s[8:11], s76 offen lds
 s_add_u32 s76, s76, 32768
 s_add_u32 m0, s78, 33792
 s_nop 0
 buffer_load_dwordx4 v2, s[8:11], s76 offen lds
 s_add_u32 s76, s76, 32768
 s_add_u32 m0, s78, 34816
 s_nop 0
 buffer_load_dwordx4 v3, s[8:11], s76 offen lds
 s_add_u32 s76, s76, 32768
 s_add_u32 m0, s78, 35840
 s_nop 0
 buffer_load_dwordx4 v3, s[8:11], s76 offen lds
 s_add_u32 s76, s76, 32768
 s_add_u32 m0, s78, 36864
 s_nop 0
 buffer_load_dwordx4 v2, s[8:11], s76 offen lds
 s_add_u32 s76, s76, 32768
 s_add_u32 m0, s78, 37888
 s_nop 0
 buffer_load_dwordx4 v2, s[8:11], s76 offen lds
 s_add_u32 s76, s76, 32768
 s_add_u32 m0, s78, 38912
 s_nop 0
 buffer_load_dwordx4 v3, s[8:11], s76 offen lds
 s_add_u32 s76, s76, 32768
 s_add_u32 m0, s78, 39936
 s_nop 0
 buffer_load_dwordx4 v3, s[8:11], s76 offen lds
 s_add_u32 s76, s76, 294912
 s_waitcnt vmcnt(32)
 s_barrier
 v_add_u32 v6, 65536, v4
 v_add_u32 v7, 65536, v5
 ds_read_b64_tr_b16 a[0:1], v6 offset:0
 ds_read_b64_tr_b16 a[2:3], v6 offset:512
 ds_read_b64_tr_b16 a[4:5], v6 offset:1024
 ds_read_b64_tr_b16 a[6:7], v6 offset:1536
 ds_read_b64_tr_b16 a[8:9], v7 offset:0
 ds_read_b64_tr_b16 a[10:11], v7 offset:512
 ds_read_b64_tr_b16 a[12:13], v7 offset:1024
 ds_read_b64_tr_b16 a[14:15], v7 offset:1536
 ds_read_b64_tr_b16 a[16:17], v6 offset:8192
 ds_read_b64_tr_b16 a[18:19], v6 offset:8704
 ds_read_b64_tr_b16 a[20:21], v6 offset:9216
 ds_read_b64_tr_b16 a[22:23], v6 offset:9728
 ds_read_b64_tr_b16 a[24:25], v7 offset:8192
 ds_read_b64_tr_b16 a[26:27], v7 offset:8704
 ds_read_b64_tr_b16 a[28:29], v7 offset:9216
 ds_read_b64_tr_b16 a[30:31], v7 offset:9728
 s_waitcnt lgkmcnt(0)
 s_barrier
 s_add_u32 m0, s78, 65536
 s_nop 0
 buffer_load_dwordx4 v2, s[8:11], s76 offen lds
 s_add_u32 s76, s76, 32768
 s_add_u32 m0, s78, 66560
 s_nop 0
 buffer_load_dwordx4 v2, s[8:11], s76 offen lds
 s_add_u32 s76, s76, 32768
 s_add_u32 m0, s78, 67584
 s_nop 0
 buffer_load_dwordx4 v3, s[8:11], s76 offen lds
 s_add_u32 s76, s76, 32768
 s_add_u32 m0, s78, 68608
 s_nop 0
 buffer_load_dwordx4 v3, s[8:11], s76 offen lds
 s_add_u32 s76, s76, 32768
 s_add_u32 m0, s78, 69632
 s_nop 0
 buffer_load_dwordx4 v2, s[8:11], s76 offen lds
 s_add_u32 s76, s76, 32768
 s_add_u32 m0, s78, 70656
 s_nop 0
 buffer_load_dwordx4 v2, s[8:11], s76 offen lds
 s_add_u32 s76, s76, 32768
 s_add_u32 m0, s78, 71680
 s_nop 0
 buffer_load_dwordx4 v3, s[8:11], s76 offen lds
 s_add_u32 s76, s76, 32768
 s_add_u32 m0, s78, 72704
 s_nop 0
 buffer_load_dwordx4 v3, s[8:11], s76 offen lds
 s_add_u32 s76, s76, 294912
 s_waitcnt vmcnt(32)
 s_barrier
 v_add_u32 v6, 98304, v4
 v_add_u32 v7, 98304, v5
 ds_read_b64_tr_b16 a[32:33], v6 offset:0
 ds_read_b64_tr_b16 a[34:35], v6 offset:512
 ds_read_b64_tr_b16 a[36:37], v6 offset:1024
 ds_read_b64_tr_b16 a[38:39], v6 offset:1536
 ds_read_b64_tr_b16 a[40:41], v7 offset:0
 ds_read_b64_tr_b16 a[42:43], v7 offset:512
 ds_read_b64_tr_b16 a[44:45], v7 offset:1024
 ds_read_b64_tr_b16 a[46:47], v7 offset:1536
 ds_read_b64_tr_b16 a[48:49], v6 offset:8192
 ds_read_b64_tr_b16 a[50:51], v6 offset:8704
 ds_read_b64_tr_b16 a[52:53], v6 offset:9216
 ds_read_b64_tr_b16 a[54:55], v6 offset:9728
 ds_read_b64_tr_b16 a[56:57], v7 offset:8192
 ds_read_b64_tr_b16 a[58:59], v7 offset:8704
 ds_read_b64_tr_b16 a[60:61], v7 offset:9216
 ds_read_b64_tr_b16 a[62:63], v7 offset:9728
 s_waitcnt lgkmcnt(0)
 s_barrier
 s_add_u32 m0, s78, 98304
 s_nop 0
 buffer_load_dwordx4 v2, s[8:11], s76 offen lds
 s_add_u32 s76, s76, 32768
 s_add_u32 m0, s78, 99328
 s_nop 0
 buffer_load_dwordx4 v2, s[8:11], s76 offen lds
 s_add_u32 s76, s76, 32768
 s_add_u32 m0, s78, 100352
 s_nop 0
 buffer_load_dwordx4 v3, s[8:11], s76 offen lds
 s_add_u32 s76, s76, 32768
 s_add_u32 m0, s78, 101376
 s_nop 0
 buffer_load_dwordx4 v3, s[8:11], s76 offen lds
 s_add_u32 s76, s76, 32768
 s_add_u32 m0, s78, 102400
 s_nop 0
 buffer_load_dwordx4 v2, s[8:11], s76 offen lds
 s_add_u32 s76, s76, 32768
 s_add_u32 m0, s78, 103424
 s_nop 0
 buffer_load_dwordx4 v2, s[8:11], s76 offen lds
 s_add_u32 s76, s76, 32768
 s_add_u32 m0, s78, 104448
 s_nop 0
 buffer_load_dwordx4 v3, s[8:11], s76 offen lds
 s_add_u32 s76, s76, 32768
 s_add_u32 m0, s78, 105472
 s_nop 0
 buffer_load_dwordx4 v3, s[8:11], s76 offen lds
 s_add_u32 s76, s76, 294912
 s_waitcnt vmcnt(32)
 s_barrier
 v_add_u32 v6, 131072, v4
 v_add_u32 v7, 131072, v5
 ds_read_b64_tr_b16 a[64:65], v6 offset:0
 ds_read_b64_tr_b16 a[66:67], v6 offset:512
 ds_read_b64_tr_b16 a[68:69], v6 offset:1024
 ds_read_b64_tr_b16 a[70:71], v6 offset:1536
 ds_read_b64_tr_b16 a[72:73], v7 offset:0
 ds_read_b64_tr_b16 a[74:75], v7 offset:512
 ds_read_b64_tr_b16 a[76:77], v7 offset:1024
 ds_read_b64_tr_b16 a[78:79], v7 offset:1536
 ds_read_b64_tr_b16 a[80:81], v6 offset:8192
 ds_read_b64_tr_b16 a[82:83], v6 offset:8704
 ds_read_b64_tr_b16 a[84:85], v6 offset:9216
 ds_read_b64_tr_b16 a[86:87], v6 offset:9728
 ds_read_b64_tr_b16 a[88:89], v7 offset:8192
 ds_read_b64_tr_b16 a[90:91], v7 offset:8704
 ds_read_b64_tr_b16 a[92:93], v7 offset:9216
 ds_read_b64_tr_b16 a[94:95], v7 offset:9728
 s_waitcnt lgkmcnt(0)
 s_barrier
 s_add_u32 m0, s78, 131072
 s_nop 0
 buffer_load_dwordx4 v2, s[8:11], s76 offen lds
 s_add_u32 s76, s76, 32768
 s_add_u32 m0, s78, 132096
 s_nop 0
 buffer_load_dwordx4 v2, s[8:11], s76 offen lds
 s_add_u32 s76, s76, 32768
 s_add_u32 m0, s78, 133120
 s_nop 0
 buffer_load_dwordx4 v3, s[8:11], s76 offen lds
 s_add_u32 s76, s76, 32768
 s_add_u32 m0, s78, 134144
 s_nop 0
 buffer_load_dwordx4 v3, s[8:11], s76 offen lds
 s_add_u32 s76, s76, 32768
 s_add_u32 m0, s78, 135168
 s_nop 0
 buffer_load_dwordx4 v2, s[8:11], s76 offen lds
 s_add_u32 s76, s76, 32768
 s_add_u32 m0, s78, 136192
 s_nop 0
 buffer_load_dwordx4 v2, s[8:11], s76 offen lds
 s_add_u32 s76, s76, 32768
 s_add_u32 m0, s78, 137216
 s_nop 0
 buffer_load_dwordx4 v3, s[8:11], s76 offen lds
 s_add_u32 s76, s76, 32768
 s_add_u32 m0, s78, 138240
 s_nop 0
 buffer_load_dwordx4 v3, s[8:11], s76 offen lds
 s_add_u32 s76, s76, 294912
 s_waitcnt vmcnt(32)
 s_barrier
 v_add_u32 v6, 0, v4
 v_add_u32 v7, 0, v5
 ds_read_b64_tr_b16 a[96:97], v6 offset:0
 ds_read_b64_tr_b16 a[98:99], v6 offset:512
 ds_read_b64_tr_b16 a[100:101], v6 offset:1024
 ds_read_b64_tr_b16 a[102:103], v6 offset:1536
 ds_read_b64_tr_b16 a[104:105], v7 offset:0
 ds_read_b64_tr_b16 a[106:107], v7 offset:512
 ds_read_b64_tr_b16 a[108:109], v7 offset:1024
 ds_read_b64_tr_b16 a[110:111], v7 offset:1536
 ds_read_b64_tr_b16 a[112:113], v6 offset:8192
 ds_read_b64_tr_b16 a[114:115], v6 offset:8704
 ds_read_b64_tr_b16 a[116:117], v6 offset:9216
 ds_read_b64_tr_b16 a[118:119], v6 offset:9728
 ds_read_b64_tr_b16 a[120:121], v7 offset:8192
 ds_read_b64_tr_b16 a[122:123], v7 offset:8704
 ds_read_b64_tr_b16 a[124:125], v7 offset:9216
 ds_read_b64_tr_b16 a[126:127], v7 offset:9728
 s_waitcnt lgkmcnt(0)
 s_barrier
 s_mov_b32 s8, s26
 s_and_b32 s9, s27, 0xffff
 s_mov_b32 s10, 5242880
 s_mov_b32 s11, 0x00020000
 v_lshrrev_b32 v2, 4, v0
 v_and_b32 v14, 1, v2
 v_lshlrev_b32 v14, 1, v14
 v_xor_b32 v14, v14, v0
 s_and_b32 s3, s50, 1
 s_lshl_b32 s3, s3, 3
 v_xor_b32 v14, s3, v14
 v_and_b32 v14, 15, v14
 s_mov_b32 s3, 1280
 v_mul_lo_u32 v2, v2, s3
 v_lshl_add_u32 v2, v14, 4, v2
 v_xor_b32 v3, 64, v2
 s_lshl_b32 s3, s52, 2
 s_add_u32 s3, s3, s50
 s_mul_i32 s76, s3, 40960
 s_add_u32 m0, s78, 0
 s_nop 0
 buffer_load_dwordx4 v2, s[8:11], s76 offen lds
 s_add_u32 s76, s76, 5120
 s_add_u32 m0, s78, 1024
 s_nop 0
 buffer_load_dwordx4 v2, s[8:11], s76 offen lds
 s_add_u32 s76, s76, 5120
 s_add_u32 m0, s78, 2048
 s_nop 0
 buffer_load_dwordx4 v2, s[8:11], s76 offen lds
 s_add_u32 s76, s76, 5120
 s_add_u32 m0, s78, 3072
 s_nop 0
 buffer_load_dwordx4 v2, s[8:11], s76 offen lds
 s_add_u32 s76, s76, 5120
 s_add_u32 m0, s78, 4096
 s_nop 0
 buffer_load_dwordx4 v3, s[8:11], s76 offen lds
 s_add_u32 s76, s76, 5120
 s_add_u32 m0, s78, 5120
 s_nop 0
 buffer_load_dwordx4 v3, s[8:11], s76 offen lds
 s_add_u32 s76, s76, 5120
 s_add_u32 m0, s78, 6144
 s_nop 0
 buffer_load_dwordx4 v3, s[8:11], s76 offen lds
 s_add_u32 s76, s76, 5120
 s_add_u32 m0, s78, 7168
 s_nop 0
 buffer_load_dwordx4 v3, s[8:11], s76 offen lds
 s_add_u32 s76, s76, 4294931712
 s_waitcnt vmcnt(32)
 s_barrier
 v_add_u32 v6, 32768, v4
 v_add_u32 v7, 32768, v5
 ds_read_b64_tr_b16 a[128:129], v6 offset:0
 ds_read_b64_tr_b16 a[130:131], v6 offset:512
 ds_read_b64_tr_b16 a[132:133], v6 offset:1024
 ds_read_b64_tr_b16 a[134:135], v6 offset:1536
 ds_read_b64_tr_b16 a[136:137], v7 offset:0
 ds_read_b64_tr_b16 a[138:139], v7 offset:512
 ds_read_b64_tr_b16 a[140:141], v7 offset:1024
 ds_read_b64_tr_b16 a[142:143], v7 offset:1536
 ds_read_b64_tr_b16 a[144:145], v6 offset:8192
 ds_read_b64_tr_b16 a[146:147], v6 offset:8704
 ds_read_b64_tr_b16 a[148:149], v6 offset:9216
 ds_read_b64_tr_b16 a[150:151], v6 offset:9728
 ds_read_b64_tr_b16 a[152:153], v7 offset:8192
 ds_read_b64_tr_b16 a[154:155], v7 offset:8704
 ds_read_b64_tr_b16 a[156:157], v7 offset:9216
 ds_read_b64_tr_b16 a[158:159], v7 offset:9728
 s_waitcnt lgkmcnt(0)
 s_barrier
 s_add_u32 m0, s78, 32768
 s_nop 0
 buffer_load_dwordx4 v2, s[8:11], s76 offen lds
 s_add_u32 s76, s76, 5120
 s_add_u32 m0, s78, 33792
 s_nop 0
 buffer_load_dwordx4 v2, s[8:11], s76 offen lds
 s_add_u32 s76, s76, 5120
 s_add_u32 m0, s78, 34816
 s_nop 0
 buffer_load_dwordx4 v2, s[8:11], s76 offen lds
 s_add_u32 s76, s76, 5120
 s_add_u32 m0, s78, 35840
 s_nop 0
 buffer_load_dwordx4 v2, s[8:11], s76 offen lds
 s_add_u32 s76, s76, 5120
 s_add_u32 m0, s78, 36864
 s_nop 0
 buffer_load_dwordx4 v3, s[8:11], s76 offen lds
 s_add_u32 s76, s76, 5120
 s_add_u32 m0, s78, 37888
 s_nop 0
 buffer_load_dwordx4 v3, s[8:11], s76 offen lds
 s_add_u32 s76, s76, 5120
 s_add_u32 m0, s78, 38912
 s_nop 0
 buffer_load_dwordx4 v3, s[8:11], s76 offen lds
 s_add_u32 s76, s76, 5120
 s_add_u32 m0, s78, 39936
 s_nop 0
 buffer_load_dwordx4 v3, s[8:11], s76 offen lds
 s_add_u32 s76, s76, 4294931712
 s_waitcnt vmcnt(32)
 s_barrier
 v_add_u32 v6, 65536, v4
 v_add_u32 v7, 65536, v5
 ds_read_b64_tr_b16 a[160:161], v6 offset:0
 ds_read_b64_tr_b16 a[162:163], v6 offset:512
 ds_read_b64_tr_b16 a[164:165], v6 offset:1024
 ds_read_b64_tr_b16 a[166:167], v6 offset:1536
 ds_read_b64_tr_b16 a[168:169], v7 offset:0
 ds_read_b64_tr_b16 a[170:171], v7 offset:512
 ds_read_b64_tr_b16 a[172:173], v7 offset:1024
 ds_read_b64_tr_b16 a[174:175], v7 offset:1536
 ds_read_b64_tr_b16 a[176:177], v6 offset:8192
 ds_read_b64_tr_b16 a[178:179], v6 offset:8704
 ds_read_b64_tr_b16 a[180:181], v6 offset:9216
 ds_read_b64_tr_b16 a[182:183], v6 offset:9728
 ds_read_b64_tr_b16 a[184:185], v7 offset:8192
 ds_read_b64_tr_b16 a[186:187], v7 offset:8704
 ds_read_b64_tr_b16 a[188:189], v7 offset:9216
 ds_read_b64_tr_b16 a[190:191], v7 offset:9728
 s_waitcnt lgkmcnt(0)
 s_barrier
 s_add_u32 m0, s78, 65536
 s_nop 0
 buffer_load_dwordx4 v2, s[8:11], s76 offen lds
 s_add_u32 s76, s76, 5120
 s_add_u32 m0, s78, 66560
 s_nop 0
 buffer_load_dwordx4 v2, s[8:11], s76 offen lds
 s_add_u32 s76, s76, 5120
 s_add_u32 m0, s78, 67584
 s_nop 0
 buffer_load_dwordx4 v2, s[8:11], s76 offen lds
 s_add_u32 s76, s76, 5120
 s_add_u32 m0, s78, 68608
 s_nop 0
 buffer_load_dwordx4 v2, s[8:11], s76 offen lds
 s_add_u32 s76, s76, 5120
 s_add_u32 m0, s78, 69632
 s_nop 0
 buffer_load_dwordx4 v3, s[8:11], s76 offen lds
 s_add_u32 s76, s76, 5120
 s_add_u32 m0, s78, 70656
 s_nop 0
 buffer_load_dwordx4 v3, s[8:11], s76 offen lds
 s_add_u32 s76, s76, 5120
 s_add_u32 m0, s78, 71680
 s_nop 0
 buffer_load_dwordx4 v3, s[8:11], s76 offen lds
 s_add_u32 s76, s76, 5120
 s_add_u32 m0, s78, 72704
 s_nop 0
 buffer_load_dwordx4 v3, s[8:11], s76 offen lds
 s_add_u32 s76, s76, 4294931712
 s_waitcnt vmcnt(32)
 s_barrier
 v_add_u32 v6, 98304, v4
 v_add_u32 v7, 98304, v5
 ds_read_b64_tr_b16 a[192:193], v6 offset:0
 ds_read_b64_tr_b16 a[194:195], v6 offset:512
 ds_read_b64_tr_b16 a[196:197], v6 offset:1024
 ds_read_b64_tr_b16 a[198:199], v6 offset:1536
 ds_read_b64_tr_b16 a[200:201], v7 offset:0
 ds_read_b64_tr_b16 a[202:203], v7 offset:512
 ds_read_b64_tr_b16 a[204:205], v7 offset:1024
 ds_read_b64_tr_b16 a[206:207], v7 offset:1536
 ds_read_b64_tr_b16 a[208:209], v6 offset:8192
 ds_read_b64_tr_b16 a[210:211], v6 offset:8704
 ds_read_b64_tr_b16 a[212:213], v6 offset:9216
 ds_read_b64_tr_b16 a[214:215], v6 offset:9728
 ds_read_b64_tr_b16 a[216:217], v7 offset:8192
 ds_read_b64_tr_b16 a[218:219], v7 offset:8704
 ds_read_b64_tr_b16 a[220:221], v7 offset:9216
 ds_read_b64_tr_b16 a[222:223], v7 offset:9728
 s_waitcnt lgkmcnt(0)
 s_barrier
 s_add_u32 m0, s78, 98304
 s_nop 0
 buffer_load_dwordx4 v2, s[8:11], s76 offen lds
 s_add_u32 s76, s76, 5120
 s_add_u32 m0, s78, 99328
 s_nop 0
 buffer_load_dwordx4 v2, s[8:11], s76 offen lds
 s_add_u32 s76, s76, 5120
 s_add_u32 m0, s78, 100352
 s_nop 0
 buffer_load_dwordx4 v2, s[8:11], s76 offen lds
 s_add_u32 s76, s76, 5120
 s_add_u32 m0, s78, 101376
 s_nop 0
 buffer_load_dwordx4 v2, s[8:11], s76 offen lds
 s_add_u32 s76, s76, 5120
 s_add_u32 m0, s78, 102400
 s_nop 0
 buffer_load_dwordx4 v3, s[8:11], s76 offen lds
 s_add_u32 s76, s76, 5120
 s_add_u32 m0, s78, 103424
 s_nop 0
 buffer_load_dwordx4 v3, s[8:11], s76 offen lds
 s_add_u32 s76, s76, 5120
 s_add_u32 m0, s78, 104448
 s_nop 0
 buffer_load_dwordx4 v3, s[8:11], s76 offen lds
 s_add_u32 s76, s76, 5120
 s_add_u32 m0, s78, 105472
 s_nop 0
 buffer_load_dwordx4 v3, s[8:11], s76 offen lds
 s_add_u32 s76, s76, 4294931712
 s_waitcnt vmcnt(32)
 s_barrier
 v_add_u32 v6, 131072, v4
 v_add_u32 v7, 131072, v5
 ds_read_b64_tr_b16 a[224:225], v6 offset:0
 ds_read_b64_tr_b16 a[226:227], v6 offset:512
 ds_read_b64_tr_b16 a[228:229], v6 offset:1024
 ds_read_b64_tr_b16 a[230:231], v6 offset:1536
 ds_read_b64_tr_b16 a[232:233], v7 offset:0
 ds_read_b64_tr_b16 a[234:235], v7 offset:512
 ds_read_b64_tr_b16 a[236:237], v7 offset:1024
 ds_read_b64_tr_b16 a[238:239], v7 offset:1536
 ds_read_b64_tr_b16 a[240:241], v6 offset:8192
 ds_read_b64_tr_b16 a[242:243], v6 offset:8704
 ds_read_b64_tr_b16 a[244:245], v6 offset:9216
 ds_read_b64_tr_b16 a[246:247], v6 offset:9728
 ds_read_b64_tr_b16 a[248:249], v7 offset:8192
 ds_read_b64_tr_b16 a[250:251], v7 offset:8704
 ds_read_b64_tr_b16 a[252:253], v7 offset:9216
 ds_read_b64_tr_b16 a[254:255], v7 offset:9728
 s_waitcnt lgkmcnt(0)
 s_barrier
 s_add_u32 m0, s78, 131072
 s_nop 0
 buffer_load_dwordx4 v2, s[8:11], s76 offen lds
 s_add_u32 s76, s76, 5120
 s_add_u32 m0, s78, 132096
 s_nop 0
 buffer_load_dwordx4 v2, s[8:11], s76 offen lds
 s_add_u32 s76, s76, 5120
 s_add_u32 m0, s78, 133120
 s_nop 0
 buffer_load_dwordx4 v2, s[8:11], s76 offen lds
 s_add_u32 s76, s76, 5120
 s_add_u32 m0, s78, 134144
 s_nop 0
 buffer_load_dwordx4 v2, s[8:11], s76 offen lds
 s_add_u32 s76, s76, 5120
 s_add_u32 m0, s78, 135168
 s_nop 0
 buffer_load_dwordx4 v3, s[8:11], s76 offen lds
 s_add_u32 s76, s76, 5120
 s_add_u32 m0, s78, 136192
 s_nop 0
 buffer_load_dwordx4 v3, s[8:11], s76 offen lds
 s_add_u32 s76, s76, 5120
 s_add_u32 m0, s78, 137216
 s_nop 0
 buffer_load_dwordx4 v3, s[8:11], s76 offen lds
 s_add_u32 s76, s76, 5120
 s_add_u32 m0, s78, 138240
 s_nop 0
 buffer_load_dwordx4 v3, s[8:11], s76 offen lds
 s_add_u32 s76, s76, 4294931712
 v_bfe_u32 v14, v0, 2, 1
 v_lshlrev_b32 v4, 8, v14
 v_lshl_add_u32 v4, v14, 5, v4
 v_bfe_u32 v14, v0, 4, 1
 v_lshl_add_u32 v4, v14, 12, v4
 v_lshl_add_u32 v4, v14, 6, v4
 v_bfe_u32 v14, v0, 5, 1
 v_lshl_add_u32 v4, v14, 10, v4
 v_and_b32 v14, 3, v0
 v_lshl_add_u32 v4, v14, 3, v4
 v_bfe_u32 v14, v0, 3, 1
 v_mul_u32_u24 v14, 32, v14
 v_xor_b32 v4, v4, v14
 s_mov_b32 s96, s44
 s_and_b32 s97, s45, 0xffff
 s_mov_b32 s98, 256
 s_mov_b32 s99, 0x00020000
 v_mov_b32 v8, 132
 s_mov_b32 s3, 144
 v_writelane_b32 v8, s3, 1
 s_mov_b32 s51, 0
 s_mov_b64 exec, 3
L_wb_197:
 buffer_load_dword v9, v8, s[96:99], 0 offen sc1
 s_waitcnt vmcnt(0)
 v_cmp_eq_u32 vcc, 0, v9
 s_cbranch_vccz L_wbd_198
 s_sleep 2
 s_add_u32 s51, s51, 1
 s_cmp_lt_u32 s51, 131072
 s_cbranch_scc1 L_wb_197
 s_branch L_bail
L_wbd_198:
 s_mov_b64 exec, -1
 v_readlane_b32 s81, v9, 1
 s_nop 3
 s_sub_u32 s81, s81, 1
 s_mov_b32 s96, s44
 s_and_b32 s97, s45, 0xffff
 s_mov_b32 s98, 256
 s_mov_b32 s99, 0x00020000
 v_lshlrev_b32 v8, 5, v0
 s_mov_b32 s51, 0
L_gl_199:
 buffer_load_dword v9, v8, s[96:99], 0 offen sc1
 s_waitcnt vmcnt(0)
 v_readlane_b32 s3, v9, s48
 s_mov_b32 s80, 0
 s_nop 2
 s_cmp_ge_u32 s3, 32
 s_cbranch_scc1 L_gld_200
 s_mov_b32 s80, 0
 v_readlane_b32 s3, v9, 0
 s_nop 3
 s_add_u32 s80, s80, s3
 v_readlane_b32 s3, v9, 1
 s_nop 3
 s_add_u32 s80, s80, s3
 v_readlane_b32 s3, v9, 2
 s_nop 3
 s_add_u32 s80, s80, s3
 v_readlane_b32 s3, v9, 3
 s_nop 3
 s_add_u32 s80, s80, s3
 v_readlane_b32 s3, v9, 4
 s_nop 3
 s_add_u32 s80, s80, s3
 v_readlane_b32 s3, v9, 5
 s_nop 3
 s_add_u32 s80, s80, s3
 v_readlane_b32 s3, v9, 6
 s_nop 3
 s_add_u32 s80, s80, s3
 v_readlane_b32 s3, v9, 7
 s_nop 3
 s_add_u32 s80, s80, s3
 s_cmp_ge_u32 s80, 256
 s_cbranch_scc1 L_gld_200
 s_sleep 4
 s_add_u32 s51, s51, 1
 s_cmp_lt_u32 s51, 131072
 s_cbranch_scc1 L_gl_199
 s_branch L_bail
L_gld_200:
 s_waitcnt vmcnt(0)
 s_barrier
 s_mul_i32 s76, s50, 10
 s_and_b32 s3, s50, 1
 s_mul_i32 s3, s3, 2
 s_add_u32 s76, s76, s3
 s_add_u32 s76, s76, 0
 s_and_b32 s3, s76, 7
 s_lshl_b32 s3, s3, 5
 v_xor_b32 v6, s3, v4
 s_lshr_b32 s3, s76, 3
 s_lshl_b32 s3, s3, 15
 v_add_u32 v6, s3, v6
 v_xor_b32 v7, 128, v6
 ds_read_b64_tr_b16 v[32:33], v6 offset:0
 ds_read_b64_tr_b16 v[34:35], v6 offset:512
 ds_read_b64_tr_b16 v[36:37], v6 offset:2048
 ds_read_b64_tr_b16 v[38:39], v6 offset:2560
 ds_read_b64_tr_b16 v[48:49], v7 offset:8192
 ds_read_b64_tr_b16 v[50:51], v7 offset:8704
 ds_read_b64_tr_b16 v[52:53], v7 offset:10240
 ds_read_b64_tr_b16 v[54:55], v7 offset:10752
 ds_read_b64_tr_b16 v[64:65], v6 offset:16384
 ds_read_b64_tr_b16 v[66:67], v6 offset:16896
 ds_read_b64_tr_b16 v[68:69], v6 offset:18432
 ds_read_b64_tr_b16 v[70:71], v6 offset:18944
 ds_read_b64_tr_b16 v[136:137], v7 offset:24576
 ds_read_b64_tr_b16 v[138:139], v7 offset:25088
 ds_read_b64_tr_b16 v[140:141], v7 offset:26624
 ds_read_b64_tr_b16 v[142:143], v7 offset:27136
 s_mul_i32 s76, s50, 10
 s_and_b32 s3, s50, 1
 s_mul_i32 s3, s3, 2
 s_add_u32 s76, s76, s3
 s_add_u32 s76, s76, 2
 s_and_b32 s3, s76, 7
 s_lshl_b32 s3, s3, 5
 v_xor_b32 v6, s3, v4
 s_lshr_b32 s3, s76, 3
 s_lshl_b32 s3, s3, 15
 v_add_u32 v6, s3, v6
 v_xor_b32 v7, 128, v6
 ds_read_b64_tr_b16 v[40:41], v6 offset:0
 ds_read_b64_tr_b16 v[42:43], v6 offset:512
 ds_read_b64_tr_b16 v[44:45], v6 offset:2048
 ds_read_b64_tr_b16 v[46:47], v6 offset:2560
 ds_read_b64_tr_b16 v[56:57], v7 offset:8192
 ds_read_b64_tr_b16 v[58:59], v7 offset:8704
 ds_read_b64_tr_b16 v[60:61], v7 offset:10240
 ds_read_b64_tr_b16 v[62:63], v7 offset:10752
 ds_read_b64_tr_b16 v[128:129], v6 offset:16384
 ds_read_b64_tr_b16 v[130:131], v6 offset:16896
 ds_read_b64_tr_b16 v[132:133], v6 offset:18432
 ds_read_b64_tr_b16 v[134:135], v6 offset:18944
 ds_read_b64_tr_b16 v[144:145], v7 offset:24576
 ds_read_b64_tr_b16 v[146:147], v7 offset:25088
 ds_read_b64_tr_b16 v[148:149], v7 offset:26624
 ds_read_b64_tr_b16 v[150:151], v7 offset:27136
 s_mul_i32 s76, s50, 10
 s_and_b32 s3, s50, 1
 s_mul_i32 s3, s3, 2
 s_add_u32 s76, s76, s3
 s_add_u32 s76, s76, 4
 s_and_b32 s3, s76, 7
 s_lshl_b32 s3, s3, 5
 v_xor_b32 v6, s3, v4
 s_lshr_b32 s3, s76, 3
 s_lshl_b32 s3, s3, 15
 v_add_u32 v6, s3, v6
 v_xor_b32 v7, 128, v6
 ds_read_b64_tr_b16 v[152:153], v6 offset:0
 ds_read_b64_tr_b16 v[154:155], v6 offset:512
 ds_read_b64_tr_b16 v[156:157], v6 offset:2048
 ds_read_b64_tr_b16 v[158:159], v6 offset:2560
 ds_read_b64_tr_b16 v[168:169], v7 offset:8192
 ds_read_b64_tr_b16 v[170:171], v7 offset:8704
 ds_read_b64_tr_b16 v[172:173], v7 offset:10240
 ds_read_b64_tr_b16 v[174:175], v7 offset:10752
 ds_read_b64_tr_b16 v[184:185], v6 offset:16384
 ds_read_b64_tr_b16 v[186:187], v6 offset:16896
 ds_read_b64_tr_b16 v[188:189], v6 offset:18432
 ds_read_b64_tr_b16 v[190:191], v6 offset:18944
 ds_read_b64_tr_b16 v[80:81], v7 offset:24576
 ds_read_b64_tr_b16 v[82:83], v7 offset:25088
 ds_read_b64_tr_b16 v[84:85], v7 offset:26624
 ds_read_b64_tr_b16 v[86:87], v7 offset:27136
 s_mul_i32 s76, s50, 10
 s_and_b32 s3, s50, 1
 s_mul_i32 s3, s3, 2
 s_add_u32 s76, s76, s3
 s_add_u32 s76, s76, 6
 s_and_b32 s3, s76, 7
 s_lshl_b32 s3, s3, 5
 v_xor_b32 v6, s3, v4
 s_lshr_b32 s3, s76, 3
 s_lshl_b32 s3, s3, 15
 v_add_u32 v6, s3, v6
 v_xor_b32 v7, 128, v6
 ds_read_b64_tr_b16 v[160:161], v6 offset:0
 ds_read_b64_tr_b16 v[162:163], v6 offset:512
 ds_read_b64_tr_b16 v[164:165], v6 offset:2048
 ds_read_b64_tr_b16 v[166:167], v6 offset:2560
 ds_read_b64_tr_b16 v[176:177], v7 offset:8192
 ds_read_b64_tr_b16 v[178:179], v7 offset:8704
 ds_read_b64_tr_b16 v[180:181], v7 offset:10240
 ds_read_b64_tr_b16 v[182:183], v7 offset:10752
 ds_read_b64_tr_b16 v[72:73], v6 offset:16384
 ds_read_b64_tr_b16 v[74:75], v6 offset:16896
 ds_read_b64_tr_b16 v[76:77], v6 offset:18432
 ds_read_b64_tr_b16 v[78:79], v6 offset:18944
 ds_read_b64_tr_b16 v[88:89], v7 offset:24576
 ds_read_b64_tr_b16 v[90:91], v7 offset:25088
 ds_read_b64_tr_b16 v[92:93], v7 offset:26624
 ds_read_b64_tr_b16 v[94:95], v7 offset:27136
 s_mul_i32 s76, s50, 10
 s_and_b32 s3, s50, 1
 s_mul_i32 s3, s3, -8
 s_add_u32 s76, s76, s3
 s_add_u32 s76, s76, 8
 s_and_b32 s3, s76, 7
 s_lshl_b32 s3, s3, 5
 v_xor_b32 v6, s3, v4
 s_lshr_b32 s3, s76, 3
 s_lshl_b32 s3, s3, 15
 v_add_u32 v6, s3, v6
 v_xor_b32 v7, 128, v6
 ds_read_b64_tr_b16 v[96:97], v6 offset:0
 ds_read_b64_tr_b16 v[98:99], v6 offset:512
 ds_read_b64_tr_b16 v[100:101], v6 offset:2048
 ds_read_b64_tr_b16 v[102:103], v6 offset:2560
 ds_read_b64_tr_b16 v[104:105], v7 offset:8192
 ds_read_b64_tr_b16 v[106:107], v7 offset:8704
 ds_read_b64_tr_b16 v[108:109], v7 offset:10240
 ds_read_b64_tr_b16 v[110:111], v7 offset:10752
 ds_read_b64_tr_b16 v[112:113], v6 offset:16384
 ds_read_b64_tr_b16 v[114:115], v6 offset:16896
 ds_read_b64_tr_b16 v[116:117], v6 offset:18432
 ds_read_b64_tr_b16 v[118:119], v6 offset:18944
 ds_read_b64_tr_b16 v[120:121], v7 offset:24576
 ds_read_b64_tr_b16 v[122:123], v7 offset:25088
 ds_read_b64_tr_b16 v[124:125], v7 offset:26624
 ds_read_b64_tr_b16 v[126:127], v7 offset:27136
 v_lshlrev_b32 v1, 4, v0
 s_lshl_b32 s3, s50, 15
 s_add_u32 s3, s3, 32768
 v_add_u32 v15, s3, v1
 s_waitcnt lgkmcnt(0)
 s_barrier
 ds_write_b128 v15, v[224:227] offset:0
 ds_write_b128 v15, v[228:231] offset:1024
 ds_write_b128 v15, v[232:235] offset:2048
 ds_write_b128 v15, v[236:239] offset:3072
 ds_write_b128 v15, v[240:243] offset:4096
 ds_write_b128 v15, v[244:247] offset:5120
 ds_write_b128 v15, v[248:251] offset:6144
 ds_write_b128 v15, v[252:255] offset:7168
 ds_write_b128 v15, v[32:35] offset:8192
 ds_write_b128 v15, v[36:39] offset:9216
 ds_write_b128 v15, v[40:43] offset:10240
 ds_write_b128 v15, v[44:47] offset:11264
 ds_write_b128 v15, v[48:51] offset:12288
 ds_write_b128 v15, v[52:55] offset:13312
 ds_write_b128 v15, v[56:59] offset:14336
 ds_write_b128 v15, v[60:63] offset:15360
 ds_write_b128 v15, v[64:67] offset:16384
 ds_write_b128 v15, v[68:71] offset:17408
 ds_write_b128 v15, v[72:75] offset:18432
 ds_write_b128 v15, v[76:79] offset:19456
 ds_write_b128 v15, v[80:83] offset:20480
 ds_write_b128 v15, v[84:87] offset:21504
 ds_write_b128 v15, v[88:91] offset:22528
 ds_write_b128 v15, v[92:95] offset:23552
 ds_write_b128 v15, v[96:99] offset:24576
 ds_write_b128 v15, v[100:103] offset:25600
 ds_write_b128 v15, v[104:107] offset:26624
 ds_write_b128 v15, v[108:111] offset:27648
 ds_write_b128 v15, v[112:115] offset:28672
 ds_write_b128 v15, v[116:119] offset:29696
 ds_write_b128 v15, v[120:123] offset:30720
 ds_write_b128 v15, v[124:127] offset:31744
 s_xor_b32 s3, s81, 0
 s_and_b32 s3, s3, 1
 s_lshl_b32 s3, s3, 13
 s_add_u32 s56, s3, 4194304
 s_and_b32 s3, s48, 2
 s_lshl_b32 s3, s3, 15
 s_add_u32 s56, s56, s3
 s_xor_b32 s3, s81, 1
 s_and_b32 s3, s3, 1
 s_lshl_b32 s3, s3, 13
 s_add_u32 s57, s3, 6291456
 s_and_b32 s3, s48, 2
 s_lshl_b32 s3, s3, 15
 s_add_u32 s57, s57, s3
 s_xor_b32 s3, s81, 0
 s_and_b32 s3, s3, 1
 s_lshl_b32 s3, s3, 13
 s_add_u32 s58, s3, 8388608
 s_and_b32 s3, s48, 2
 s_lshl_b32 s3, s3, 15
 s_add_u32 s58, s58, s3
 s_xor_b32 s3, s81, 1
 s_and_b32 s3, s3, 1
 s_lshl_b32 s3, s3, 13
 s_add_u32 s59, s3, 10485760
 s_and_b32 s3, s48, 2
 s_lshl_b32 s3, s3, 15
 s_add_u32 s59, s59, s3
 v_lshrrev_b32 v2, 5, v0
 v_lshlrev_b32 v2, 15, v2
 v_bfe_u32 v14, v0, 2, 2
 v_lshl_add_u32 v2, v14, 8, v2
 v_bfe_u32 v14, v0, 4, 1
 v_lshl_add_u32 v2, v14, 6, v2
 v_and_b32 v14, 3, v0
 v_lshl_add_u32 v2, v14, 4, v2
 s_lshr_b32 s76, s50, 1
 s_and_b32 s77, s50, 1
 s_lshl_b32 s3, s76, 14
 v_add_u32 v2, s3, v2
 s_lshl_b32 s3, s77, 7
 s_add_u32 s3, s3, 2048
 v_add_u32 v3, s3, v2
 s_mul_i32 s3, s77, 3072
 v_add_u32 v2, s3, v2
 s_mul_i32 s76, s76, 5120
 s_add_u32 s3, s3, s76
 v_add_u32 v4, s3, v1
 s_lshl_b32 s3, s77, 3
 s_add_u32 s3, s3, s76
 s_add_u32 s3, s3, 2048
 v_add_u32 v5, s3, v1
 v_and_b32 v14, 2, v0
 v_cmp_eq_u32 vcc, 0, v14
 v_mov_b32 v17, 0xeeee
 v_mov_b32 v14, 0x4444
 s_nop 0
 v_cndmask_b32 v17, v17, v14, vcc
 s_lshl_b32 s78, s48, 4
 s_add_u32 s78, s78, s49
 s_lshl_b32 s32, s78, 8
 s_add_u32 s32, s32, 0
 s_mul_i32 s76, s78, 24576
 s_lshl_b32 s3, s50, 10
 s_add_u32 s77, s76, s3
 s_add_u32 s60, s77, 1736704
 s_add_u32 s61, s77, 1742848
 s_add_u32 s62, s77, 1748992
 s_add_u32 s63, s77, 1755136
 s_lshr_b32 s3, s50, 1
 s_lshl_b32 s3, s3, 10
 s_add_u32 s76, s76, s3
 s_and_b32 s3, s50, 1
 s_lshl_b32 s3, s3, 3
 s_add_u32 s76, s76, s3
 s_add_u32 s64, s76, 1740800
 s_add_u32 s65, s76, 1746944
 s_add_u32 s66, s76, 1753088
 s_add_u32 s67, s76, 1759232
 s_mul_i32 s76, s48, 327680
 s_lshl_b32 s3, s49, 8
 s_add_u32 s77, s76, s3
 s_lshr_b32 s3, s50, 1
 s_mul_i32 s3, s3, 81920
 s_add_u32 s77, s77, s3
 s_and_b32 s3, s50, 1
 s_mul_i32 s3, s3, 49152
 s_add_u32 s3, s3, s77
 s_add_u32 s68, s3, 425984
 s_add_u32 s69, s3, 442368
 s_and_b32 s3, s50, 1
 s_lshl_b32 s3, s3, 3
 s_add_u32 s3, s3, s77
 s_add_u32 s70, s3, 458752
 s_and_b32 s3, s50, 1
 s_mul_i32 s3, s3, 49152
 s_add_u32 s3, s3, s77
 s_add_u32 s71, s3, 589824
 s_add_u32 s72, s3, 606208
 s_and_b32 s3, s50, 1
 s_lshl_b32 s3, s3, 3
 s_add_u32 s3, s3, s77
 s_add_u32 s73, s3, 622592
 s_lshl_b32 s78, s49, 1
 s_and_b32 s3, s50, 1
 s_add_u32 s78, s78, s3
 s_lshr_b32 s55, s50, 1
 s_and_b32 s77, s49, 1
 s_lshl_b32 s77, s77, 2
 s_add_u32 s77, s77, s50
 s_add_u32 s3, s32, 128
 s_cmp_eq_u32 s77, 2
 s_cselect_b32 s17, s3, 268435456
 s_lshr_b32 s3, s49, 1
 s_add_u32 s3, s3, 32
 s_cmp_eq_u32 s77, 1
 s_cselect_b32 s78, s3, s78
 s_cselect_b32 s55, 1, s55
 s_lshl_b32 s3, s78, 12
 s_add_u32 s3, s3, s76
 s_add_u32 s74, s3, 425984
 s_add_u32 s75, s3, 589824
 v_add_u32 v12, 4096, v1
 v_lshrrev_b32 v14, 4, v0
 v_and_b32 v10, 15, v0
 v_lshlrev_b32 v6, 5, v10
 v_lshl_add_u32 v6, v14, 3, v6
 s_lshl_b32 s3, s50, 10
 v_add_u32 v6, s3, v6
 v_lshlrev_b32 v10, 4, v10
 v_lshl_add_u32 v10, v14, 12, v10
 v_lshlrev_b32 v7, 3, v0
 v_add_u32 v8, s3, v7
 s_lshl_b32 s3, s50, 11
 v_add_u32 v16, s3, v1
 s_lshr_b32 s3, s50, 1
 s_lshl_b32 s3, s3, 10
 s_and_b32 s77, s50, 1
 s_lshl_b32 s77, s77, 5
 s_add_u32 s3, s3, s77
 v_add_u32 v9, s3, v1
 v_lshlrev_b32 v11, 6, v14
 v_bfe_u32 v13, v0, 2, 1
 v_lshl_add_u32 v11, v13, 5, v11
 v_and_b32 v18, 1, v0
 v_lshl_add_u32 v11, v18, 4, v11
 s_lshl_b32 s3, s78, 8
 s_cmp_ge_u32 s78, 20
 s_cselect_b32 s77, 11264, 0
 s_add_u32 s3, s3, s77
 s_and_b32 s77, s48, 1
 s_lshl_b32 s77, s77, 15
 s_add_u32 s3, s3, s77
 s_cmp_eq_u32 s55, 0
 s_cselect_b32 s3, 268435456, s3
 v_add_u32 v11, s3, v11
 s_mov_b32 s8, s18
 s_and_b32 s9, s19, 0xffff
 s_mov_b32 s10, 10240
 s_mov_b32 s11, 0x00020000
 v_mul_u32_u24 v18, 1280, v18
 v_lshl_add_u32 v18, v13, 6, v18
 v_lshl_add_u32 v18, v14, 3, v18
 s_and_b32 s3, s78, 3
 s_mul_i32 s3, s3, 2560
 s_lshr_b32 s76, s78, 2
 s_lshl_b32 s76, s76, 7
 s_add_u32 s3, s3, s76
 s_add_u32 s3, s3, s77
 v_add_u32 v18, s3, v18
 buffer_load_dwordx2 v[20:21], v18, s[8:11], 0 offen
 buffer_load_dwordx2 v[22:23], v18, s[8:11], 0 offen offset:32
 buffer_load_dword v14, off, s[4:7], s32 sc1
 s_mov_b32 s28, 0x33333333
 s_mov_b32 s29, 0x33333333
 s_mov_b32 s30, 0x00330033
 s_mov_b32 s31, 0x00330033
 s_mov_b32 s79, 0x3e0293ee
 s_and_b32 s100, s52, 1
 s_lshl_b32 s100, s100, 13
 s_lshl_b32 s54, s52, 14
 s_add_u32 s54, s54, s100
 s_lshr_b32 s3, s48, 1
 s_mul_i32 s3, s3, 33554432
 s_add_u32 s54, s54, s3
 s_add_u32 s54, s54, 16777216
 s_waitcnt vmcnt(0) lgkmcnt(0)
 s_mov_b64 exec, s[30:31]
 buffer_store_dwordx4 v[20:23], v11, s[4:7], s56 offen sc1
 s_mov_b64 exec, -1
 v_mov_b32 v32, -1
 v_mov_b32 v28, 0x3f803f80
 v_mov_b32 v36, 0
 v_mov_b32 v33, -1
 v_mov_b32 v29, 0x3f803f80
 v_mov_b32 v37, 0
 v_mov_b32 v34, -1
 v_mov_b32 v30, 0x3f803f80
 v_mov_b32 v38, 0
 v_mov_b32 v35, -1
 v_mov_b32 v31, 0x3f803f80
 v_mov_b32 v39, 0
 v_mov_b32 v88, 0
 v_mov_b32 v89, 0
 v_mov_b32 v90, 0
 v_mov_b32 v91, 0
 v_mov_b32 v92, 0
 v_mov_b32 v93, 0
 v_mov_b32 v94, 0
 v_mov_b32 v95, 0
 v_mov_b32 v96, 0
 v_mov_b32 v97, 0
 v_mov_b32 v98, 0
 v_mov_b32 v99, 0
 v_mov_b32 v100, 0
 v_mov_b32 v101, 0
 v_mov_b32 v102, 0
 v_mov_b32 v103, 0
 v_and_b32 v18, 7, v0
 v_lshrrev_b32 v13, 1, v0
 v_xor_b32 v13, v13, v0
 v_and_b32 v13, 8, v13
 v_or_b32 v18, v18, v13
 v_mov_b32 v24, 0
 v_cmp_eq_u32 vcc, 0, v18
 v_mov_b32 v13, 0x3f80
 s_nop 1
 v_cndmask_b32 v24, v24, v13, vcc
 v_cmp_eq_u32 vcc, 1, v18
 v_mov_b32 v13, 0x3f800000
 s_nop 1
 v_cndmask_b32 v24, v24, v13, vcc
 v_mov_b32 v25, 0
 v_cmp_eq_u32 vcc, 2, v18
 v_mov_b32 v13, 0x3f80
 s_nop 1
 v_cndmask_b32 v25, v25, v13, vcc
 v_cmp_eq_u32 vcc, 3, v18
 v_mov_b32 v13, 0x3f800000
 s_nop 1
 v_cndmask_b32 v25, v25, v13, vcc
 v_mov_b32 v26, 0
 v_cmp_eq_u32 vcc, 4, v18
 v_mov_b32 v13, 0x3f80
 s_nop 1
 v_cndmask_b32 v26, v26, v13, vcc
 v_cmp_eq_u32 vcc, 5, v18
 v_mov_b32 v13, 0x3f800000
 s_nop 1
 v_cndmask_b32 v26, v26, v13, vcc
 v_mov_b32 v27, 0
 v_cmp_eq_u32 vcc, 6, v18
 v_mov_b32 v13, 0x3f80
 s_nop 1
 v_cndmask_b32 v27, v27, v13, vcc
 v_cmp_eq_u32 vcc, 7, v18
 v_mov_b32 v13, 0x3f800000
 s_nop 1
 v_cndmask_b32 v27, v27, v13, vcc
 s_waitcnt vmcnt(0)
 v_and_b32 v18, 7, v0
 v_mov_b32 v20, 0
 v_cmp_eq_u32 vcc, 0, v18
 v_mov_b32 v13, 0x3f80
 s_nop 1
 v_cndmask_b32 v20, v20, v13, vcc
 v_cmp_eq_u32 vcc, 1, v18
 v_mov_b32 v13, 0x3f800000
 s_nop 1
 v_cndmask_b32 v20, v20, v13, vcc
 v_mov_b32 v21, 0
 v_cmp_eq_u32 vcc, 2, v18
 v_mov_b32 v13, 0x3f80
 s_nop 1
 v_cndmask_b32 v21, v21, v13, vcc
 v_cmp_eq_u32 vcc, 3, v18
 v_mov_b32 v13, 0x3f800000
 s_nop 1
 v_cndmask_b32 v21, v21, v13, vcc
 v_mov_b32 v22, 0
 v_cmp_eq_u32 vcc, 4, v18
 v_mov_b32 v13, 0x3f80
 s_nop 1
 v_cndmask_b32 v22, v22, v13, vcc
 v_cmp_eq_u32 vcc, 5, v18
 v_mov_b32 v13, 0x3f800000
 s_nop 1
 v_cndmask_b32 v22, v22, v13, vcc
 v_mov_b32 v23, 0
 v_cmp_eq_u32 vcc, 6, v18
 v_mov_b32 v13, 0x3f80
 s_nop 1
 v_cndmask_b32 v23, v23, v13, vcc
 v_cmp_eq_u32 vcc, 7, v18
 v_mov_b32 v13, 0x3f800000
 s_nop 1
 v_cndmask_b32 v23, v23, v13, vcc
 v_mov_b32 v18, 0
 v_mov_b32 v19, 0
 v_and_b32 v0, -33, v1
 v_mov_b32 v13, 1
 s_mov_b32 s53, -1
 s_mov_b32 s51, 0
 s_cmp_lg_u32 s50, 0
 s_cbranch_scc1 L_k0_201
 s_add_u32 s76, s53, 1
L_fl_202:
 v_cmp_ge_u32 vcc, s76, v14
 s_cbranch_vccz L_fld_203
 buffer_load_dword v14, off, s[4:7], s32 sc1
 s_waitcnt vmcnt(0)
 s_add_u32 s51, s51, 1
 s_cmp_lt_u32 s51, 131072
 s_cbranch_scc1 L_fl_202
 s_branch L_bail
L_fld_203:
 s_lshl_b32 s16, s76, 19
 s_add_u32 s16, s16, s54
 s_mov_b32 m0, 10240
 s_nop 0
 buffer_load_dwordx4 v1, s[4:7], s16 offen offset:0 sc1 lds
 buffer_load_dwordx4 v1, s[4:7], s16 offen offset:1024 sc1 lds
 buffer_load_dwordx4 v1, s[4:7], s16 offen offset:2048 sc1 lds
 buffer_load_dwordx4 v1, s[4:7], s16 offen offset:3072 sc1 lds
 s_mov_b32 m0, 14336
 s_nop 0
 buffer_load_dwordx4 v12, s[4:7], s16 offen offset:0 sc1 lds
 buffer_load_dwordx4 v12, s[4:7], s16 offen offset:1024 sc1 lds
 buffer_load_dwordx4 v12, s[4:7], s16 offen offset:2048 sc1 lds
 buffer_load_dwordx4 v12, s[4:7], s16 offen offset:3072 sc1 lds
 s_add_u32 s16, s16, 67108864
 s_mov_b32 m0, 18432
 s_nop 0
 buffer_load_dwordx4 v1, s[4:7], s16 offen offset:0 sc1 lds
 buffer_load_dwordx4 v1, s[4:7], s16 offen offset:1024 sc1 lds
 buffer_load_dwordx4 v1, s[4:7], s16 offen offset:2048 sc1 lds
 buffer_load_dwordx4 v1, s[4:7], s16 offen offset:3072 sc1 lds
 s_mov_b32 m0, 22528
 s_nop 0
 buffer_load_dwordx4 v12, s[4:7], s16 offen offset:0 sc1 lds
 buffer_load_dwordx4 v12, s[4:7], s16 offen offset:1024 sc1 lds
 buffer_load_dwordx4 v12, s[4:7], s16 offen offset:2048 sc1 lds
 buffer_load_dwordx4 v12, s[4:7], s16 offen offset:3072 sc1 lds
L_k0_201:
 s_mov_b32 s53, 0
 s_cmp_lg_u32 s80, 0
 s_cbranch_scc1 L_ch_loops
.p2align 8
L_ch_loopf:
 s_mov_b32 s51, 0
 buffer_load_dwordx4 v[40:43], v2, s[4:7], s56 offen offset:0 sc1
 buffer_load_dwordx4 v[44:47], v2, s[4:7], s56 offen offset:128 sc1
 buffer_load_dwordx4 v[48:51], v2, s[4:7], s56 offen offset:1024 sc1
 buffer_load_dwordx4 v[52:55], v2, s[4:7], s56 offen offset:1152 sc1
 buffer_load_dwordx4 v[56:59], v3, s[4:7], s56 offen offset:0 sc1
L_xm_204:
 s_waitcnt vmcnt(4)
 v_mfma_f32_16x16x32_bf16 v[60:63], v[24:27], v[40:43], 0
 s_waitcnt vmcnt(3)
 v_mfma_f32_16x16x32_bf16 v[64:67], v[24:27], v[44:47], 0
 s_waitcnt vmcnt(2)
 v_mfma_f32_16x16x32_bf16 v[68:71], v[24:27], v[48:51], 0
 v_max3_u32 v14, v40, v44, v48
 v_cvt_pk_bf16_f32 v60, v60, v61
 v_cvt_pk_bf16_f32 v61, v62, v63
 ds_write_b64 v4, v[60:61] offset:0
 s_waitcnt vmcnt(1)
 v_mfma_f32_16x16x32_bf16 v[72:75], v[24:27], v[52:55], 0
 v_cvt_pk_bf16_f32 v64, v64, v65
 v_cvt_pk_bf16_f32 v65, v66, v67
 ds_write_b64 v4, v[64:65] offset:8
 s_waitcnt vmcnt(0)
 v_mfma_f32_16x16x32_bf16 v[76:79], v[24:27], v[56:59], 0
 v_max3_u32 v14, v14, v52, v56
 v_cmp_eq_u32 vcc, -1, v14
 v_cvt_pk_bf16_f32 v68, v68, v69
 v_cvt_pk_bf16_f32 v69, v70, v71
 ds_write_b64 v4, v[68:69] offset:1024
 s_cbranch_vccnz L_rt_205
 v_cvt_pk_bf16_f32 v72, v72, v73
 v_cvt_pk_bf16_f32 v73, v74, v75
 ds_write_b64 v4, v[72:73] offset:1032
 s_nop 0
 v_cvt_pk_bf16_f32 v76, v76, v77
 v_cvt_pk_bf16_f32 v77, v78, v79
 ds_write_b64 v5, v[76:77] offset:0
 s_waitcnt lgkmcnt(0)
 s_barrier
L_ch_b1f0:
 ds_read_b128 v[72:75], v0 offset:0
 ds_read_b128 v[76:79], v0 offset:32
 ds_read_b128 v[80:83], v0 offset:1024
 s_waitcnt lgkmcnt(2)
 v_smfmac_f32_16x16x64_bf16 v[88:91], v[72:75], v[224:231], v17
 ds_read_b128 v[84:87], v0 offset:1056
 v_smfmac_f32_16x16x64_bf16 v[92:95], v[72:75], v[232:239], v17
 ds_read_b128 v[96:99], v0 offset:2048
 s_waitcnt lgkmcnt(3)
 v_smfmac_f32_16x16x64_bf16 v[88:91], v[76:79], v[240:247], v17
 ds_read_b128 v[100:103], v0 offset:2080
 v_smfmac_f32_16x16x64_bf16 v[92:95], v[76:79], v[248:255], v17
 ds_read_b128 v[112:115], v0 offset:3072
 s_waitcnt lgkmcnt(4)
 v_smfmac_f32_16x16x64_bf16 v[88:91], v[80:83], v[192:199], v17
 ds_read_b128 v[40:43], v1 offset:10240
 v_smfmac_f32_16x16x64_bf16 v[92:95], v[80:83], v[200:207], v17
 ds_read_b128 v[116:119], v0 offset:3104
 s_waitcnt lgkmcnt(5)
 v_smfmac_f32_16x16x64_bf16 v[88:91], v[84:87], v[208:215], v17
 ds_read_b128 v[44:47], v1 offset:11264
 v_smfmac_f32_16x16x64_bf16 v[92:95], v[84:87], v[216:223], v17
 ds_read_b128 v[72:75], v0 offset:4096
 s_waitcnt lgkmcnt(6)
 v_smfmac_f32_16x16x64_bf16 v[88:91], v[96:99], a[0:7], v17
 ds_read_b128 v[48:51], v1 offset:12288
 v_smfmac_f32_16x16x64_bf16 v[92:95], v[96:99], a[8:15], v17
 ds_read_b128 v[76:79], v0 offset:4128
 s_waitcnt lgkmcnt(7)
 v_smfmac_f32_16x16x64_bf16 v[88:91], v[100:103], a[16:23], v17
 ds_read_b128 v[52:55], v1 offset:13312
 v_smfmac_f32_16x16x64_bf16 v[92:95], v[100:103], a[24:31], v17
 ds_read_b128 v[80:83], v0 offset:5120
 s_waitcnt lgkmcnt(8)
 v_smfmac_f32_16x16x64_bf16 v[88:91], v[112:115], a[32:39], v17
 ds_read_b128 v[56:59], v1 offset:14336
 v_smfmac_f32_16x16x64_bf16 v[92:95], v[112:115], a[40:47], v17
 ds_read_b128 v[84:87], v0 offset:5152
 s_waitcnt lgkmcnt(8)
 v_smfmac_f32_16x16x64_bf16 v[88:91], v[116:119], a[48:55], v17
 ds_read_b128 v[60:63], v1 offset:15360
 v_smfmac_f32_16x16x64_bf16 v[92:95], v[116:119], a[56:63], v17
 ds_read_b128 v[96:99], v0 offset:6144
 s_waitcnt lgkmcnt(8)
 v_smfmac_f32_16x16x64_bf16 v[88:91], v[72:75], a[64:71], v17
 ds_read_b128 v[64:67], v1 offset:16384
 v_smfmac_f32_16x16x64_bf16 v[92:95], v[72:75], a[72:79], v17
 ds_read_b128 v[100:103], v0 offset:6176
 s_waitcnt lgkmcnt(8)
 v_smfmac_f32_16x16x64_bf16 v[88:91], v[76:79], a[80:87], v17
 ds_read_b128 v[68:71], v1 offset:17408
 v_smfmac_f32_16x16x64_bf16 v[92:95], v[76:79], a[88:95], v17
 ds_read_b128 v[112:115], v0 offset:7168
 s_waitcnt lgkmcnt(8)
 v_smfmac_f32_16x16x64_bf16 v[88:91], v[80:83], a[96:103], v17
 ds_read_b128 v[104:107], v16 offset:18432
 v_smfmac_f32_16x16x64_bf16 v[92:95], v[80:83], a[104:111], v17
 ds_read_b128 v[116:119], v0 offset:7200
 s_waitcnt lgkmcnt(8)
 v_smfmac_f32_16x16x64_bf16 v[88:91], v[84:87], a[112:119], v17
 ds_read_b128 v[108:111], v16 offset:19456
 v_smfmac_f32_16x16x64_bf16 v[92:95], v[84:87], a[120:127], v17
 ds_read_b128 v[72:75], v0 offset:8192
 s_waitcnt lgkmcnt(8)
 v_smfmac_f32_16x16x64_bf16 v[88:91], v[96:99], a[128:135], v17
 ds_read_b128 v[224:227], v15 offset:8192
 v_smfmac_f32_16x16x64_bf16 v[92:95], v[96:99], a[136:143], v17
 ds_read_b128 v[76:79], v0 offset:8224
 s_waitcnt lgkmcnt(8)
 v_smfmac_f32_16x16x64_bf16 v[88:91], v[100:103], a[144:151], v17
 ds_read_b128 v[228:231], v15 offset:9216
 v_smfmac_f32_16x16x64_bf16 v[92:95], v[100:103], a[152:159], v17
 ds_read_b128 v[80:83], v0 offset:9216
 s_waitcnt lgkmcnt(8)
 v_smfmac_f32_16x16x64_bf16 v[88:91], v[112:115], a[160:167], v17
 ds_read_b128 v[232:235], v15 offset:10240
 v_smfmac_f32_16x16x64_bf16 v[92:95], v[112:115], a[168:175], v17
 ds_read_b128 v[84:87], v0 offset:9248
 s_waitcnt lgkmcnt(8)
 v_smfmac_f32_16x16x64_bf16 v[88:91], v[116:119], a[176:183], v17
 ds_read_b128 v[236:239], v15 offset:11264
 v_smfmac_f32_16x16x64_bf16 v[92:95], v[116:119], a[184:191], v17
 ds_read_b128 v[240:243], v15 offset:12288
 s_waitcnt lgkmcnt(8)
 v_smfmac_f32_16x16x64_bf16 v[88:91], v[72:75], a[192:199], v17
 ds_read_b128 v[244:247], v15 offset:13312
 v_smfmac_f32_16x16x64_bf16 v[92:95], v[72:75], a[200:207], v17
 ds_read_b128 v[248:251], v15 offset:14336
 s_waitcnt lgkmcnt(8)
 v_smfmac_f32_16x16x64_bf16 v[88:91], v[76:79], a[208:215], v17
 ds_read_b128 v[252:255], v15 offset:15360
 v_smfmac_f32_16x16x64_bf16 v[92:95], v[76:79], a[216:223], v17
 s_waitcnt lgkmcnt(7)
 v_smfmac_f32_16x16x64_bf16 v[88:91], v[80:83], a[224:231], v17
 v_smfmac_f32_16x16x64_bf16 v[92:95], v[80:83], a[232:239], v17
 s_waitcnt lgkmcnt(5)
 v_smfmac_f32_16x16x64_bf16 v[88:91], v[84:87], a[240:247], v17
 v_smfmac_f32_16x16x64_bf16 v[92:95], v[84:87], a[248:255], v17
 s_nop 2
 v_cvt_pk_bf16_f32 v120, v88, v89
 v_cvt_pk_bf16_f32 v121, v90, v91
 ds_write_b64 v6, v[120:121] offset:26624
 s_nop 1
 v_cvt_pk_bf16_f32 v122, v92, v93
 v_cvt_pk_bf16_f32 v123, v94, v95
 ds_write_b64 v6, v[122:123] offset:27136
 s_waitcnt lgkmcnt(0)
 s_barrier
 ds_read_b64_tr_b16 v[72:73], v7 offset:26624
 ds_read_b64_tr_b16 v[74:75], v7 offset:27136
 ds_read_b64_tr_b16 v[76:77], v7 offset:27648
 ds_read_b64_tr_b16 v[78:79], v7 offset:28160
 ds_read_b64_tr_b16 v[80:81], v7 offset:28672
 ds_read_b64_tr_b16 v[82:83], v7 offset:29184
 ds_read_b64_tr_b16 v[84:85], v7 offset:29696
 ds_read_b64_tr_b16 v[86:87], v7 offset:30208
 ds_read_b64_tr_b16 v[112:113], v8 offset:26624
 ds_read_b64_tr_b16 v[114:115], v8 offset:27136
 s_waitcnt lgkmcnt(8)
 v_mfma_f32_16x16x32_bf16 v[92:95], v[40:43], v[72:75], 0
 v_mfma_f32_16x16x32_bf16 v[96:99], v[56:59], v[72:75], 0
 v_mfma_f32_16x16x32_bf16 v[88:91], v[72:75], v[72:75], 0
 s_waitcnt lgkmcnt(6)
 v_mfma_f32_16x16x32_bf16 v[92:95], v[44:47], v[76:79], v[92:95]
 v_mfma_f32_16x16x32_bf16 v[96:99], v[60:63], v[76:79], v[96:99]
 v_mfma_f32_16x16x32_bf16 v[88:91], v[76:79], v[76:79], v[88:91]
 s_waitcnt lgkmcnt(4)
 v_mfma_f32_16x16x32_bf16 v[92:95], v[48:51], v[80:83], v[92:95]
 v_mfma_f32_16x16x32_bf16 v[96:99], v[64:67], v[80:83], v[96:99]
 v_mfma_f32_16x16x32_bf16 v[88:91], v[80:83], v[80:83], v[88:91]
 s_waitcnt lgkmcnt(0)
 buffer_store_dwordx4 v[112:115], v1, s[4:7], s60 offen
 s_waitcnt lgkmcnt(2)
 v_mfma_f32_16x16x32_bf16 v[92:95], v[52:55], v[84:87], v[92:95]
 v_mfma_f32_16x16x32_bf16 v[96:99], v[68:71], v[84:87], v[96:99]
 v_mfma_f32_16x16x32_bf16 v[88:91], v[84:87], v[84:87], v[88:91]
 v_mfma_f32_32x32x8_bf16 v[40:55], v[18:19], v[18:19], 0
 v_max3_f32 v126, v92, v93, v94
 buffer_load_dwordx2 v[124:125], v1, s[4:7], s64 offen sc1
 ds_read_b128 v[80:83], v15 offset:16384
 ds_read_b128 v[84:87], v15 offset:17408
 v_max3_f32 v126, v126, v95, v96
 v_max3_f32 v126, v126, v97, v98
 v_max3_f32 v126, v126, v99, v90
 v_max_f32 v126, v126, v91
 v_mov_b32 v127, v126
 v_mov_b64 v[56:57], 0
 v_mov_b64 v[58:59], 0
 v_permlane16_swap_b32 v126, v127
 v_max_f32 v126, v126, v127
 v_mov_b32 v127, v126
 s_nop 1
 v_permlane32_swap_b32 v126, v127
 v_max_f32 v126, v126, v127
 v_mul_f32 v126, s79, v126
 v_fma_f32 v92, v92, s79, -v126
 v_fma_f32 v93, v93, s79, -v126
 v_fma_f32 v94, v94, s79, -v126
 v_fma_f32 v95, v95, s79, -v126
 v_fma_f32 v96, v96, s79, -v126
 v_fma_f32 v97, v97, s79, -v126
 v_fma_f32 v98, v98, s79, -v126
 v_fma_f32 v99, v99, s79, -v126
 v_exp_f32 v92, v92
 v_exp_f32 v93, v93
 v_exp_f32 v94, v94
 v_exp_f32 v95, v95
 v_exp_f32 v96, v96
 v_exp_f32 v97, v97
 v_exp_f32 v98, v98
 v_exp_f32 v99, v99
 v_fma_f32 v90, v90, s79, -v126
 v_cvt_pk_bf16_f32 v100, v92, v93
 v_cvt_pk_bf16_f32 v101, v94, v95
 v_cvt_pk_bf16_f32 v102, v96, v97
 v_cvt_pk_bf16_f32 v103, v98, v99
 v_fma_f32 v91, v91, s79, -v126
 v_exp_f32 v90, v90
 v_mfma_f32_16x16x32_bf16 v[120:123], v[28:31], v[100:103], 0
 v_exp_f32 v91, v91
 v_mfma_f32_16x16x32_bf16 v[112:115], v[104:107], v[100:103], 0
 v_cvt_pk_bf16_f32 v36, v90, v91
 v_cvt_pk_bf16_f32 v39, v90, v91
 v_mfma_f32_16x16x32_bf16 v[116:119], v[108:111], v[100:103], 0
 s_waitcnt vmcnt(0)
 v_mfma_f32_16x16x16_bf16 v[120:123], v[28:29], v[36:37], v[120:123]
L_pv_206:
 v_cmp_eq_u32 vcc, -1, v124
 s_cbranch_vccnz L_rt_207
 v_mfma_f32_16x16x16_bf16 v[112:115], v[124:125], v[36:37], v[112:115]
 v_mfma_f32_16x16x16_bf16 v[116:119], v[124:125], v[38:39], v[116:119]
 v_rcp_f32 v120, v120
 ds_read_b128 v[88:91], v15 offset:18432
 ds_read_b128 v[92:95], v15 offset:19456
 ds_read_b128 v[96:99], v15 offset:20480
 ds_read_b128 v[100:103], v15 offset:21504
 s_mov_b64 exec, s[28:29]
 v_pk_mul_f32 v[112:113], v[112:113], v[120:121] op_sel_hi:[1,0]
 v_pk_mul_f32 v[114:115], v[114:115], v[120:121] op_sel_hi:[1,0]
 v_cvt_pk_bf16_f32 v112, v112, v113
 v_cvt_pk_bf16_f32 v113, v114, v115
 v_pk_mul_f32 v[116:117], v[116:117], v[120:121] op_sel_hi:[1,0]
 v_pk_mul_f32 v[118:119], v[118:119], v[120:121] op_sel_hi:[1,0]
 v_cvt_pk_bf16_f32 v114, v116, v117
 v_cvt_pk_bf16_f32 v115, v118, v119
 ds_write_b128 v9, v[112:115] offset:30720
 s_mov_b64 exec, -1
 s_waitcnt lgkmcnt(0)
 s_barrier
 ds_read_b128 v[60:63], v0 offset:30720
 ds_read_b128 v[64:67], v0 offset:30752
 ds_read_b128 v[68:71], v0 offset:31744
 ds_read_b128 v[72:75], v0 offset:31776
 s_waitcnt lgkmcnt(3)
 v_smfmac_f32_16x16x64_bf16 v[40:43], v[60:63], v[224:231], v17
 ds_read_b128 v[224:227], v15 offset:22528
 v_smfmac_f32_16x16x64_bf16 v[44:47], v[60:63], v[232:239], v17
 ds_read_b128 v[228:231], v15 offset:23552
 s_waitcnt lgkmcnt(4)
 v_smfmac_f32_16x16x64_bf16 v[40:43], v[64:67], v[240:247], v17
 ds_read_b128 v[232:235], v15 offset:24576
 v_smfmac_f32_16x16x64_bf16 v[44:47], v[64:67], v[248:255], v17
 ds_read_b128 v[236:239], v15 offset:25600
 s_waitcnt lgkmcnt(5)
 v_smfmac_f32_16x16x64_bf16 v[40:43], v[68:71], v[80:87], v17
 ds_read_b128 v[240:243], v15 offset:26624
 v_smfmac_f32_16x16x64_bf16 v[44:47], v[68:71], v[128:135], v17
 ds_read_b128 v[244:247], v15 offset:27648
 s_waitcnt lgkmcnt(6)
 v_smfmac_f32_16x16x64_bf16 v[40:43], v[72:75], v[136:143], v17
 ds_read_b128 v[248:251], v15 offset:28672
 v_smfmac_f32_16x16x64_bf16 v[44:47], v[72:75], v[144:151], v17
 ds_read_b128 v[252:255], v15 offset:29696
 v_smfmac_f32_16x16x64_bf16 v[48:51], v[60:63], v[152:159], v17
 ds_read_b128 v[80:83], v15 offset:30720
 v_cvt_pk_bf16_f32 v116, v40, v41
 v_cvt_pk_bf16_f32 v117, v42, v43
 v_or_b32 v116, 1, v116
 v_smfmac_f32_16x16x64_bf16 v[52:55], v[60:63], v[160:167], v17
 ds_read_b128 v[84:87], v15 offset:31744
 v_cvt_pk_bf16_f32 v118, v44, v45
 v_cvt_pk_bf16_f32 v119, v46, v47
 v_or_b32 v118, 1, v118
 buffer_store_dwordx4 v[116:119], v10, s[4:7], s68 offen
 v_smfmac_f32_16x16x64_bf16 v[48:51], v[64:67], v[168:175], v17
 v_smfmac_f32_16x16x64_bf16 v[52:55], v[64:67], v[176:183], v17
 v_smfmac_f32_16x16x64_bf16 v[48:51], v[68:71], v[184:191], v17
 v_smfmac_f32_16x16x64_bf16 v[52:55], v[68:71], v[88:95], v17
 v_smfmac_f32_16x16x64_bf16 v[48:51], v[72:75], v[96:103], v17
 s_waitcnt lgkmcnt(8)
 v_smfmac_f32_16x16x64_bf16 v[52:55], v[72:75], v[224:231], v17
 s_waitcnt lgkmcnt(6)
 v_smfmac_f32_16x16x64_bf16 v[56:59], v[60:63], v[232:239], v17
 v_cvt_pk_bf16_f32 v120, v48, v49
 v_cvt_pk_bf16_f32 v121, v50, v51
 v_or_b32 v120, 1, v120
 s_waitcnt lgkmcnt(4)
 v_smfmac_f32_16x16x64_bf16 v[56:59], v[64:67], v[240:247], v17
 v_cvt_pk_bf16_f32 v122, v52, v53
 v_cvt_pk_bf16_f32 v123, v54, v55
 v_or_b32 v122, 1, v122
 buffer_store_dwordx4 v[120:123], v10, s[4:7], s69 offen
 s_waitcnt lgkmcnt(2)
 v_smfmac_f32_16x16x64_bf16 v[56:59], v[68:71], v[248:255], v17
 s_waitcnt lgkmcnt(0)
 v_smfmac_f32_16x16x64_bf16 v[56:59], v[72:75], v[80:87], v17
 s_nop 7
 v_cvt_pk_bf16_f32 v124, v56, v57
 v_cvt_pk_bf16_f32 v125, v58, v59
 v_or_b32 v124, 1, v124
 buffer_store_dwordx2 v[124:125], v10, s[4:7], s70 offen
 ds_read_b128 v[224:227], v15 offset:0
 ds_read_b128 v[228:231], v15 offset:1024
 ds_read_b128 v[232:235], v15 offset:2048
 ds_read_b128 v[236:239], v15 offset:3072
 ds_read_b128 v[240:243], v15 offset:4096
 ds_read_b128 v[244:247], v15 offset:5120
 ds_read_b128 v[248:251], v15 offset:6144
 ds_read_b128 v[252:255], v15 offset:7168
 v_mov_b64 v[88:89], 0
 v_mov_b64 v[90:91], 0
 v_mov_b64 v[92:93], 0
 v_mov_b64 v[94:95], 0
 s_cmp_eq_u32 s55, 0
 s_cbranch_scc1 L_nr_208
 s_nop 15
 s_nop 15
 s_nop 15
 s_nop 15
 s_nop 15
L_pp_210:
 buffer_load_dwordx4 v[40:43], v1, s[4:7], s74 offen offset:0 sc1
 buffer_load_dwordx4 v[44:47], v1, s[4:7], s74 offen offset:1024 sc1
 buffer_load_dwordx4 v[48:51], v1, s[4:7], s74 offen offset:2048 sc1
 buffer_load_dwordx4 v[52:55], v1, s[4:7], s74 offen offset:3072 sc1
 s_waitcnt vmcnt(3)
 v_mfma_f32_16x16x32_bf16 v[56:59], v[40:43], v[20:23], 0
 v_and_b32 v14, v40, v42
 s_waitcnt vmcnt(2)
 v_mfma_f32_16x16x32_bf16 v[56:59], v[44:47], v[20:23], v[56:59]
 v_bitop3_b32 v14, v14, v44, v46 bitop3:0x80
 s_waitcnt vmcnt(1)
 v_mfma_f32_16x16x32_bf16 v[56:59], v[48:51], v[20:23], v[56:59]
 v_bitop3_b32 v14, v14, v48, v50 bitop3:0x80
 s_waitcnt vmcnt(0)
 v_mfma_f32_16x16x32_bf16 v[56:59], v[52:55], v[20:23], v[56:59]
 v_bitop3_b32 v14, v14, v52, v54 bitop3:0x80
 v_and_b32 v14, 1, v14
 v_cmp_ne_u32 vcc, 1, v14
 s_cbranch_vccnz L_rt_211
 s_nop 2
 v_cvt_pk_bf16_f32 v60, v56, v57
 v_cvt_pk_bf16_f32 v61, v58, v59
 s_nop 0
 v_mov_b32_dpp v62, v60 quad_perm:[2,3,2,3] row_mask:0xf bank_mask:0xf
 v_mov_b32_dpp v63, v61 quad_perm:[2,3,2,3] row_mask:0xf bank_mask:0xf
 s_mov_b64 exec, s[30:31]
 buffer_store_dwordx4 v[60:63], v11, s[4:7], s57 offen sc1
 s_mov_b64 exec, 1
 buffer_store_dword v13, off, s[4:7], s17
 s_mov_b64 exec, s[30:31]
 buffer_store_dwordx4 v[32:35], v11, s[4:7], s59 offen sc1
 s_mov_b64 exec, -1
 s_barrier
 s_nop 15
 s_nop 15
 s_nop 15
 s_nop 15
 s_nop 15
 s_nop 15
 s_nop 15
 s_nop 7
L_rj_209:
 v_add_u32 v13, 1, v13
 s_add_u32 s53, s53, 1
.p2align 3
 s_mov_b32 s51, 0
 buffer_load_dwordx4 v[40:43], v2, s[4:7], s57 offen offset:0 sc1
 buffer_load_dwordx4 v[44:47], v2, s[4:7], s57 offen offset:128 sc1
 buffer_load_dwordx4 v[48:51], v2, s[4:7], s57 offen offset:1024 sc1
 buffer_load_dwordx4 v[52:55], v2, s[4:7], s57 offen offset:1152 sc1
 buffer_load_dwordx4 v[56:59], v3, s[4:7], s57 offen offset:0 sc1
L_xm_212:
 s_waitcnt vmcnt(4)
 v_mfma_f32_16x16x32_bf16 v[60:63], v[24:27], v[40:43], 0
 s_waitcnt vmcnt(3)
 v_mfma_f32_16x16x32_bf16 v[64:67], v[24:27], v[44:47], 0
 s_waitcnt vmcnt(2)
 v_mfma_f32_16x16x32_bf16 v[68:71], v[24:27], v[48:51], 0
 v_max3_u32 v14, v40, v44, v48
 v_cvt_pk_bf16_f32 v60, v60, v61
 v_cvt_pk_bf16_f32 v61, v62, v63
 ds_write_b64 v4, v[60:61] offset:0
 s_waitcnt vmcnt(1)
 v_mfma_f32_16x16x32_bf16 v[72:75], v[24:27], v[52:55], 0
 v_cvt_pk_bf16_f32 v64, v64, v65
 v_cvt_pk_bf16_f32 v65, v66, v67
 ds_write_b64 v4, v[64:65] offset:8
 s_waitcnt vmcnt(0)
 v_mfma_f32_16x16x32_bf16 v[76:79], v[24:27], v[56:59], 0
 v_max3_u32 v14, v14, v52, v56
 v_cmp_eq_u32 vcc, -1, v14
 v_cvt_pk_bf16_f32 v68, v68, v69
 v_cvt_pk_bf16_f32 v69, v70, v71
 ds_write_b64 v4, v[68:69] offset:1024
 s_cbranch_vccnz L_rt_213
 v_cvt_pk_bf16_f32 v72, v72, v73
 v_cvt_pk_bf16_f32 v73, v74, v75
 ds_write_b64 v4, v[72:73] offset:1032
 s_nop 0
 v_cvt_pk_bf16_f32 v76, v76, v77
 v_cvt_pk_bf16_f32 v77, v78, v79
 ds_write_b64 v5, v[76:77] offset:0
 s_waitcnt lgkmcnt(0)
 s_barrier
L_ch_b1f1:
 ds_read_b128 v[72:75], v0 offset:0
 ds_read_b128 v[76:79], v0 offset:32
 ds_read_b128 v[80:83], v0 offset:1024
 s_waitcnt lgkmcnt(2)
 v_smfmac_f32_16x16x64_bf16 v[88:91], v[72:75], v[224:231], v17
 ds_read_b128 v[84:87], v0 offset:1056
 v_smfmac_f32_16x16x64_bf16 v[92:95], v[72:75], v[232:239], v17
 ds_read_b128 v[96:99], v0 offset:2048
 s_waitcnt lgkmcnt(3)
 v_smfmac_f32_16x16x64_bf16 v[88:91], v[76:79], v[240:247], v17
 ds_read_b128 v[100:103], v0 offset:2080
 v_smfmac_f32_16x16x64_bf16 v[92:95], v[76:79], v[248:255], v17
 ds_read_b128 v[112:115], v0 offset:3072
 s_waitcnt lgkmcnt(4)
 v_smfmac_f32_16x16x64_bf16 v[88:91], v[80:83], v[192:199], v17
 ds_read_b128 v[40:43], v1 offset:10240
 v_smfmac_f32_16x16x64_bf16 v[92:95], v[80:83], v[200:207], v17
 ds_read_b128 v[116:119], v0 offset:3104
 s_waitcnt lgkmcnt(5)
 v_smfmac_f32_16x16x64_bf16 v[88:91], v[84:87], v[208:215], v17
 ds_read_b128 v[44:47], v1 offset:11264
 v_smfmac_f32_16x16x64_bf16 v[92:95], v[84:87], v[216:223], v17
 ds_read_b128 v[72:75], v0 offset:4096
 s_waitcnt lgkmcnt(6)
 v_smfmac_f32_16x16x64_bf16 v[88:91], v[96:99], a[0:7], v17
 ds_read_b128 v[48:51], v1 offset:12288
 v_smfmac_f32_16x16x64_bf16 v[92:95], v[96:99], a[8:15], v17
 ds_read_b128 v[76:79], v0 offset:4128
 s_waitcnt lgkmcnt(7)
 v_smfmac_f32_16x16x64_bf16 v[88:91], v[100:103], a[16:23], v17
 ds_read_b128 v[52:55], v1 offset:13312
 v_smfmac_f32_16x16x64_bf16 v[92:95], v[100:103], a[24:31], v17
 ds_read_b128 v[80:83], v0 offset:5120
 s_waitcnt lgkmcnt(8)
 v_smfmac_f32_16x16x64_bf16 v[88:91], v[112:115], a[32:39], v17
 ds_read_b128 v[56:59], v1 offset:14336
 v_smfmac_f32_16x16x64_bf16 v[92:95], v[112:115], a[40:47], v17
 ds_read_b128 v[84:87], v0 offset:5152
 s_waitcnt lgkmcnt(8)
 v_smfmac_f32_16x16x64_bf16 v[88:91], v[116:119], a[48:55], v17
 ds_read_b128 v[60:63], v1 offset:15360
 v_smfmac_f32_16x16x64_bf16 v[92:95], v[116:119], a[56:63], v17
 ds_read_b128 v[96:99], v0 offset:6144
 s_waitcnt lgkmcnt(8)
 v_smfmac_f32_16x16x64_bf16 v[88:91], v[72:75], a[64:71], v17
 ds_read_b128 v[64:67], v1 offset:16384
 v_smfmac_f32_16x16x64_bf16 v[92:95], v[72:75], a[72:79], v17
 ds_read_b128 v[100:103], v0 offset:6176
 s_waitcnt lgkmcnt(8)
 v_smfmac_f32_16x16x64_bf16 v[88:91], v[76:79], a[80:87], v17
 ds_read_b128 v[68:71], v1 offset:17408
 v_smfmac_f32_16x16x64_bf16 v[92:95], v[76:79], a[88:95], v17
 ds_read_b128 v[112:115], v0 offset:7168
 s_waitcnt lgkmcnt(8)
 v_smfmac_f32_16x16x64_bf16 v[88:91], v[80:83], a[96:103], v17
 ds_read_b128 v[104:107], v16 offset:18432
 v_smfmac_f32_16x16x64_bf16 v[92:95], v[80:83], a[104:111], v17
 ds_read_b128 v[116:119], v0 offset:7200
 s_waitcnt lgkmcnt(8)
 v_smfmac_f32_16x16x64_bf16 v[88:91], v[84:87], a[112:119], v17
 ds_read_b128 v[108:111], v16 offset:19456
 v_smfmac_f32_16x16x64_bf16 v[92:95], v[84:87], a[120:127], v17
 ds_read_b128 v[72:75], v0 offset:8192
 s_waitcnt lgkmcnt(8)
 v_smfmac_f32_16x16x64_bf16 v[88:91], v[96:99], a[128:135], v17
 ds_read_b128 v[224:227], v15 offset:8192
 v_smfmac_f32_16x16x64_bf16 v[92:95], v[96:99], a[136:143], v17
 ds_read_b128 v[76:79], v0 offset:8224
 s_waitcnt lgkmcnt(8)
 v_smfmac_f32_16x16x64_bf16 v[88:91], v[100:103], a[144:151], v17
 ds_read_b128 v[228:231], v15 offset:9216
 v_smfmac_f32_16x16x64_bf16 v[92:95], v[100:103], a[152:159], v17
 ds_read_b128 v[80:83], v0 offset:9216
 s_waitcnt lgkmcnt(8)
 v_smfmac_f32_16x16x64_bf16 v[88:91], v[112:115], a[160:167], v17
 ds_read_b128 v[232:235], v15 offset:10240
 v_smfmac_f32_16x16x64_bf16 v[92:95], v[112:115], a[168:175], v17
 ds_read_b128 v[84:87], v0 offset:9248
 s_waitcnt lgkmcnt(8)
 v_smfmac_f32_16x16x64_bf16 v[88:91], v[116:119], a[176:183], v17
 ds_read_b128 v[236:239], v15 offset:11264
 v_smfmac_f32_16x16x64_bf16 v[92:95], v[116:119], a[184:191], v17
 ds_read_b128 v[240:243], v15 offset:12288
 s_waitcnt lgkmcnt(8)
 v_smfmac_f32_16x16x64_bf16 v[88:91], v[72:75], a[192:199], v17
 ds_read_b128 v[244:247], v15 offset:13312
 v_smfmac_f32_16x16x64_bf16 v[92:95], v[72:75], a[200:207], v17
 ds_read_b128 v[248:251], v15 offset:14336
 s_waitcnt lgkmcnt(8)
 v_smfmac_f32_16x16x64_bf16 v[88:91], v[76:79], a[208:215], v17
 ds_read_b128 v[252:255], v15 offset:15360
 v_smfmac_f32_16x16x64_bf16 v[92:95], v[76:79], a[216:223], v17
 s_waitcnt lgkmcnt(7)
 v_smfmac_f32_16x16x64_bf16 v[88:91], v[80:83], a[224:231], v17
 v_smfmac_f32_16x16x64_bf16 v[92:95], v[80:83], a[232:239], v17
 s_waitcnt lgkmcnt(5)
 v_smfmac_f32_16x16x64_bf16 v[88:91], v[84:87], a[240:247], v17
 v_smfmac_f32_16x16x64_bf16 v[92:95], v[84:87], a[248:255], v17
 s_nop 2
 v_cvt_pk_bf16_f32 v120, v88, v89
 v_cvt_pk_bf16_f32 v121, v90, v91
 ds_write_b64 v6, v[120:121] offset:26624
 s_nop 1
 v_cvt_pk_bf16_f32 v122, v92, v93
 v_cvt_pk_bf16_f32 v123, v94, v95
 ds_write_b64 v6, v[122:123] offset:27136
 s_waitcnt lgkmcnt(0)
 s_barrier
 ds_read_b64_tr_b16 v[72:73], v7 offset:26624
 ds_read_b64_tr_b16 v[74:75], v7 offset:27136
 ds_read_b64_tr_b16 v[76:77], v7 offset:27648
 ds_read_b64_tr_b16 v[78:79], v7 offset:28160
 ds_read_b64_tr_b16 v[80:81], v7 offset:28672
 ds_read_b64_tr_b16 v[82:83], v7 offset:29184
 ds_read_b64_tr_b16 v[84:85], v7 offset:29696
 ds_read_b64_tr_b16 v[86:87], v7 offset:30208
 ds_read_b64_tr_b16 v[112:113], v8 offset:26624
 ds_read_b64_tr_b16 v[114:115], v8 offset:27136
 s_waitcnt lgkmcnt(8)
 v_mfma_f32_16x16x32_bf16 v[92:95], v[40:43], v[72:75], 0
 v_mfma_f32_16x16x32_bf16 v[96:99], v[56:59], v[72:75], 0
 v_mfma_f32_16x16x32_bf16 v[88:91], v[72:75], v[72:75], 0
 s_waitcnt lgkmcnt(6)
 v_mfma_f32_16x16x32_bf16 v[92:95], v[44:47], v[76:79], v[92:95]
 v_mfma_f32_16x16x32_bf16 v[96:99], v[60:63], v[76:79], v[96:99]
 v_mfma_f32_16x16x32_bf16 v[88:91], v[76:79], v[76:79], v[88:91]
 s_waitcnt lgkmcnt(4)
 v_mfma_f32_16x16x32_bf16 v[92:95], v[48:51], v[80:83], v[92:95]
 v_mfma_f32_16x16x32_bf16 v[96:99], v[64:67], v[80:83], v[96:99]
 v_mfma_f32_16x16x32_bf16 v[88:91], v[80:83], v[80:83], v[88:91]
 s_waitcnt lgkmcnt(0)
 buffer_store_dwordx4 v[112:115], v1, s[4:7], s61 offen
 s_waitcnt lgkmcnt(2)
 v_mfma_f32_16x16x32_bf16 v[92:95], v[52:55], v[84:87], v[92:95]
 v_mfma_f32_16x16x32_bf16 v[96:99], v[68:71], v[84:87], v[96:99]
 v_mfma_f32_16x16x32_bf16 v[88:91], v[84:87], v[84:87], v[88:91]
 v_mfma_f32_32x32x8_bf16 v[40:55], v[18:19], v[18:19], 0
 v_max3_f32 v126, v92, v93, v94
 buffer_load_dwordx2 v[124:125], v1, s[4:7], s65 offen sc1
 ds_read_b128 v[80:83], v15 offset:16384
 ds_read_b128 v[84:87], v15 offset:17408
 v_max3_f32 v126, v126, v95, v96
 v_max3_f32 v126, v126, v97, v98
 v_max3_f32 v126, v126, v99, v90
 v_max_f32 v126, v126, v91
 v_mov_b32 v127, v126
 v_mov_b64 v[56:57], 0
 v_mov_b64 v[58:59], 0
 v_permlane16_swap_b32 v126, v127
 v_max_f32 v126, v126, v127
 v_mov_b32 v127, v126
 s_nop 1
 v_permlane32_swap_b32 v126, v127
 v_max_f32 v126, v126, v127
 v_mul_f32 v126, s79, v126
 v_fma_f32 v92, v92, s79, -v126
 v_fma_f32 v93, v93, s79, -v126
 v_fma_f32 v94, v94, s79, -v126
 v_fma_f32 v95, v95, s79, -v126
 v_fma_f32 v96, v96, s79, -v126
 v_fma_f32 v97, v97, s79, -v126
 v_fma_f32 v98, v98, s79, -v126
 v_fma_f32 v99, v99, s79, -v126
 v_exp_f32 v92, v92
 v_exp_f32 v93, v93
 v_exp_f32 v94, v94
 v_exp_f32 v95, v95
 v_exp_f32 v96, v96
 v_exp_f32 v97, v97
 v_exp_f32 v98, v98
 v_exp_f32 v99, v99
 v_fma_f32 v90, v90, s79, -v126
 v_cvt_pk_bf16_f32 v100, v92, v93
 v_cvt_pk_bf16_f32 v101, v94, v95
 v_cvt_pk_bf16_f32 v102, v96, v97
 v_cvt_pk_bf16_f32 v103, v98, v99
 v_fma_f32 v91, v91, s79, -v126
 v_exp_f32 v90, v90
 v_mfma_f32_16x16x32_bf16 v[120:123], v[28:31], v[100:103], 0
 v_exp_f32 v91, v91
 v_mfma_f32_16x16x32_bf16 v[112:115], v[104:107], v[100:103], 0
 v_cvt_pk_bf16_f32 v36, v90, v91
 v_cvt_pk_bf16_f32 v39, v90, v91
 v_mfma_f32_16x16x32_bf16 v[116:119], v[108:111], v[100:103], 0
 s_waitcnt vmcnt(0)
 v_mfma_f32_16x16x16_bf16 v[120:123], v[28:29], v[36:37], v[120:123]
L_pv_214:
 v_cmp_eq_u32 vcc, -1, v124
 s_cbranch_vccnz L_rt_215
 v_mfma_f32_16x16x16_bf16 v[112:115], v[124:125], v[36:37], v[112:115]
 v_mfma_f32_16x16x16_bf16 v[116:119], v[124:125], v[38:39], v[116:119]
 v_rcp_f32 v120, v120
 ds_read_b128 v[88:91], v15 offset:18432
 ds_read_b128 v[92:95], v15 offset:19456
 ds_read_b128 v[96:99], v15 offset:20480
 ds_read_b128 v[100:103], v15 offset:21504
 s_mov_b64 exec, s[28:29]
 v_pk_mul_f32 v[112:113], v[112:113], v[120:121] op_sel_hi:[1,0]
 v_pk_mul_f32 v[114:115], v[114:115], v[120:121] op_sel_hi:[1,0]
 v_cvt_pk_bf16_f32 v112, v112, v113
 v_cvt_pk_bf16_f32 v113, v114, v115
 v_pk_mul_f32 v[116:117], v[116:117], v[120:121] op_sel_hi:[1,0]
 v_pk_mul_f32 v[118:119], v[118:119], v[120:121] op_sel_hi:[1,0]
 v_cvt_pk_bf16_f32 v114, v116, v117
 v_cvt_pk_bf16_f32 v115, v118, v119
 ds_write_b128 v9, v[112:115] offset:30720
 s_mov_b64 exec, -1
 s_waitcnt lgkmcnt(0)
 s_barrier
 ds_read_b128 v[60:63], v0 offset:30720
 ds_read_b128 v[64:67], v0 offset:30752
 ds_read_b128 v[68:71], v0 offset:31744
 ds_read_b128 v[72:75], v0 offset:31776
 s_waitcnt lgkmcnt(3)
 v_smfmac_f32_16x16x64_bf16 v[40:43], v[60:63], v[224:231], v17
 ds_read_b128 v[224:227], v15 offset:22528
 v_smfmac_f32_16x16x64_bf16 v[44:47], v[60:63], v[232:239], v17
 ds_read_b128 v[228:231], v15 offset:23552
 s_waitcnt lgkmcnt(4)
 v_smfmac_f32_16x16x64_bf16 v[40:43], v[64:67], v[240:247], v17
 ds_read_b128 v[232:235], v15 offset:24576
 v_smfmac_f32_16x16x64_bf16 v[44:47], v[64:67], v[248:255], v17
 ds_read_b128 v[236:239], v15 offset:25600
 s_waitcnt lgkmcnt(5)
 v_smfmac_f32_16x16x64_bf16 v[40:43], v[68:71], v[80:87], v17
 ds_read_b128 v[240:243], v15 offset:26624
 v_smfmac_f32_16x16x64_bf16 v[44:47], v[68:71], v[128:135], v17
 ds_read_b128 v[244:247], v15 offset:27648
 s_waitcnt lgkmcnt(6)
 v_smfmac_f32_16x16x64_bf16 v[40:43], v[72:75], v[136:143], v17
 ds_read_b128 v[248:251], v15 offset:28672
 v_smfmac_f32_16x16x64_bf16 v[44:47], v[72:75], v[144:151], v17
 ds_read_b128 v[252:255], v15 offset:29696
 v_smfmac_f32_16x16x64_bf16 v[48:51], v[60:63], v[152:159], v17
 ds_read_b128 v[80:83], v15 offset:30720
 v_cvt_pk_bf16_f32 v116, v40, v41
 v_cvt_pk_bf16_f32 v117, v42, v43
 v_or_b32 v116, 1, v116
 v_smfmac_f32_16x16x64_bf16 v[52:55], v[60:63], v[160:167], v17
 ds_read_b128 v[84:87], v15 offset:31744
 v_cvt_pk_bf16_f32 v118, v44, v45
 v_cvt_pk_bf16_f32 v119, v46, v47
 v_or_b32 v118, 1, v118
 buffer_store_dwordx4 v[116:119], v10, s[4:7], s71 offen
 v_smfmac_f32_16x16x64_bf16 v[48:51], v[64:67], v[168:175], v17
 v_smfmac_f32_16x16x64_bf16 v[52:55], v[64:67], v[176:183], v17
 v_smfmac_f32_16x16x64_bf16 v[48:51], v[68:71], v[184:191], v17
 v_smfmac_f32_16x16x64_bf16 v[52:55], v[68:71], v[88:95], v17
 v_smfmac_f32_16x16x64_bf16 v[48:51], v[72:75], v[96:103], v17
 s_waitcnt lgkmcnt(8)
 v_smfmac_f32_16x16x64_bf16 v[52:55], v[72:75], v[224:231], v17
 s_waitcnt lgkmcnt(6)
 v_smfmac_f32_16x16x64_bf16 v[56:59], v[60:63], v[232:239], v17
 v_cvt_pk_bf16_f32 v120, v48, v49
 v_cvt_pk_bf16_f32 v121, v50, v51
 v_or_b32 v120, 1, v120
 s_waitcnt lgkmcnt(4)
 v_smfmac_f32_16x16x64_bf16 v[56:59], v[64:67], v[240:247], v17
 v_cvt_pk_bf16_f32 v122, v52, v53
 v_cvt_pk_bf16_f32 v123, v54, v55
 v_or_b32 v122, 1, v122
 buffer_store_dwordx4 v[120:123], v10, s[4:7], s72 offen
 s_waitcnt lgkmcnt(2)
 v_smfmac_f32_16x16x64_bf16 v[56:59], v[68:71], v[248:255], v17
 s_waitcnt lgkmcnt(0)
 v_smfmac_f32_16x16x64_bf16 v[56:59], v[72:75], v[80:87], v17
 s_nop 7
 v_cvt_pk_bf16_f32 v124, v56, v57
 v_cvt_pk_bf16_f32 v125, v58, v59
 v_or_b32 v124, 1, v124
 buffer_store_dwordx2 v[124:125], v10, s[4:7], s73 offen
 ds_read_b128 v[224:227], v15 offset:0
 ds_read_b128 v[228:231], v15 offset:1024
 ds_read_b128 v[232:235], v15 offset:2048
 ds_read_b128 v[236:239], v15 offset:3072
 ds_read_b128 v[240:243], v15 offset:4096
 ds_read_b128 v[244:247], v15 offset:5120
 ds_read_b128 v[248:251], v15 offset:6144
 ds_read_b128 v[252:255], v15 offset:7168
 v_mov_b64 v[88:89], 0
 v_mov_b64 v[90:91], 0
 v_mov_b64 v[92:93], 0
 v_mov_b64 v[94:95], 0
 s_cmp_eq_u32 s55, 0
 s_cbranch_scc1 L_nr_216
 s_nop 15
 s_nop 15
 s_nop 15
 s_nop 15
 s_nop 15
L_pp_218:
 buffer_load_dwordx4 v[40:43], v1, s[4:7], s75 offen offset:0 sc1
 buffer_load_dwordx4 v[44:47], v1, s[4:7], s75 offen offset:1024 sc1
 buffer_load_dwordx4 v[48:51], v1, s[4:7], s75 offen offset:2048 sc1
 buffer_load_dwordx4 v[52:55], v1, s[4:7], s75 offen offset:3072 sc1
 s_waitcnt vmcnt(3)
 v_mfma_f32_16x16x32_bf16 v[56:59], v[40:43], v[20:23], 0
 v_and_b32 v14, v40, v42
 s_waitcnt vmcnt(2)
 v_mfma_f32_16x16x32_bf16 v[56:59], v[44:47], v[20:23], v[56:59]
 v_bitop3_b32 v14, v14, v44, v46 bitop3:0x80
 s_waitcnt vmcnt(1)
 v_mfma_f32_16x16x32_bf16 v[56:59], v[48:51], v[20:23], v[56:59]
 v_bitop3_b32 v14, v14, v48, v50 bitop3:0x80
 s_waitcnt vmcnt(0)
 v_mfma_f32_16x16x32_bf16 v[56:59], v[52:55], v[20:23], v[56:59]
 v_bitop3_b32 v14, v14, v52, v54 bitop3:0x80
 v_and_b32 v14, 1, v14
 v_cmp_ne_u32 vcc, 1, v14
 s_cbranch_vccnz L_rt_219
 s_nop 2
 v_cvt_pk_bf16_f32 v60, v56, v57
 v_cvt_pk_bf16_f32 v61, v58, v59
 s_nop 0
 v_mov_b32_dpp v62, v60 quad_perm:[2,3,2,3] row_mask:0xf bank_mask:0xf
 v_mov_b32_dpp v63, v61 quad_perm:[2,3,2,3] row_mask:0xf bank_mask:0xf
 s_mov_b64 exec, s[30:31]
 buffer_store_dwordx4 v[60:63], v11, s[4:7], s58 offen sc1
 s_mov_b64 exec, 1
 buffer_store_dword v13, off, s[4:7], s17
 s_mov_b64 exec, s[30:31]
 buffer_store_dwordx4 v[32:35], v11, s[4:7], s56 offen sc1
 s_mov_b64 exec, -1
 s_barrier
 s_nop 15
 s_nop 15
 s_nop 15
 s_nop 15
 s_nop 15
 s_nop 15
 s_nop 15
 s_nop 7
L_rj_217:
 v_add_u32 v13, 1, v13
 s_add_u32 s53, s53, 1
.p2align 3
 s_mov_b32 s51, 0
 buffer_load_dwordx4 v[40:43], v2, s[4:7], s58 offen offset:0 sc1
 buffer_load_dwordx4 v[44:47], v2, s[4:7], s58 offen offset:128 sc1
 buffer_load_dwordx4 v[48:51], v2, s[4:7], s58 offen offset:1024 sc1
 buffer_load_dwordx4 v[52:55], v2, s[4:7], s58 offen offset:1152 sc1
 buffer_load_dwordx4 v[56:59], v3, s[4:7], s58 offen offset:0 sc1
L_xm_220:
 s_waitcnt vmcnt(4)
 v_mfma_f32_16x16x32_bf16 v[60:63], v[24:27], v[40:43], 0
 s_waitcnt vmcnt(3)
 v_mfma_f32_16x16x32_bf16 v[64:67], v[24:27], v[44:47], 0
 s_waitcnt vmcnt(2)
 v_mfma_f32_16x16x32_bf16 v[68:71], v[24:27], v[48:51], 0
 v_max3_u32 v14, v40, v44, v48
 v_cvt_pk_bf16_f32 v60, v60, v61
 v_cvt_pk_bf16_f32 v61, v62, v63
 ds_write_b64 v4, v[60:61] offset:0
 s_waitcnt vmcnt(1)
 v_mfma_f32_16x16x32_bf16 v[72:75], v[24:27], v[52:55], 0
 v_cvt_pk_bf16_f32 v64, v64, v65
 v_cvt_pk_bf16_f32 v65, v66, v67
 ds_write_b64 v4, v[64:65] offset:8
 s_waitcnt vmcnt(0)
 v_mfma_f32_16x16x32_bf16 v[76:79], v[24:27], v[56:59], 0
 v_max3_u32 v14, v14, v52, v56
 v_cmp_eq_u32 vcc, -1, v14
 v_cvt_pk_bf16_f32 v68, v68, v69
 v_cvt_pk_bf16_f32 v69, v70, v71
 ds_write_b64 v4, v[68:69] offset:1024
 s_cbranch_vccnz L_rt_221
 v_cvt_pk_bf16_f32 v72, v72, v73
 v_cvt_pk_bf16_f32 v73, v74, v75
 ds_write_b64 v4, v[72:73] offset:1032
 s_nop 0
 v_cvt_pk_bf16_f32 v76, v76, v77
 v_cvt_pk_bf16_f32 v77, v78, v79
 ds_write_b64 v5, v[76:77] offset:0
 s_waitcnt lgkmcnt(0)
 s_barrier
L_ch_b1f2:
 ds_read_b128 v[72:75], v0 offset:0
 ds_read_b128 v[76:79], v0 offset:32
 ds_read_b128 v[80:83], v0 offset:1024
 s_waitcnt lgkmcnt(2)
 v_smfmac_f32_16x16x64_bf16 v[88:91], v[72:75], v[224:231], v17
 ds_read_b128 v[84:87], v0 offset:1056
 v_smfmac_f32_16x16x64_bf16 v[92:95], v[72:75], v[232:239], v17
 ds_read_b128 v[96:99], v0 offset:2048
 s_waitcnt lgkmcnt(3)
 v_smfmac_f32_16x16x64_bf16 v[88:91], v[76:79], v[240:247], v17
 ds_read_b128 v[100:103], v0 offset:2080
 v_smfmac_f32_16x16x64_bf16 v[92:95], v[76:79], v[248:255], v17
 ds_read_b128 v[112:115], v0 offset:3072
 s_waitcnt lgkmcnt(4)
 v_smfmac_f32_16x16x64_bf16 v[88:91], v[80:83], v[192:199], v17
 ds_read_b128 v[40:43], v1 offset:10240
 v_smfmac_f32_16x16x64_bf16 v[92:95], v[80:83], v[200:207], v17
 ds_read_b128 v[116:119], v0 offset:3104
 s_waitcnt lgkmcnt(5)
 v_smfmac_f32_16x16x64_bf16 v[88:91], v[84:87], v[208:215], v17
 ds_read_b128 v[44:47], v1 offset:11264
 v_smfmac_f32_16x16x64_bf16 v[92:95], v[84:87], v[216:223], v17
 ds_read_b128 v[72:75], v0 offset:4096
 s_waitcnt lgkmcnt(6)
 v_smfmac_f32_16x16x64_bf16 v[88:91], v[96:99], a[0:7], v17
 ds_read_b128 v[48:51], v1 offset:12288
 v_smfmac_f32_16x16x64_bf16 v[92:95], v[96:99], a[8:15], v17
 ds_read_b128 v[76:79], v0 offset:4128
 s_waitcnt lgkmcnt(7)
 v_smfmac_f32_16x16x64_bf16 v[88:91], v[100:103], a[16:23], v17
 ds_read_b128 v[52:55], v1 offset:13312
 v_smfmac_f32_16x16x64_bf16 v[92:95], v[100:103], a[24:31], v17
 ds_read_b128 v[80:83], v0 offset:5120
 s_waitcnt lgkmcnt(8)
 v_smfmac_f32_16x16x64_bf16 v[88:91], v[112:115], a[32:39], v17
 ds_read_b128 v[56:59], v1 offset:14336
 v_smfmac_f32_16x16x64_bf16 v[92:95], v[112:115], a[40:47], v17
 ds_read_b128 v[84:87], v0 offset:5152
 s_waitcnt lgkmcnt(8)
 v_smfmac_f32_16x16x64_bf16 v[88:91], v[116:119], a[48:55], v17
 ds_read_b128 v[60:63], v1 offset:15360
 v_smfmac_f32_16x16x64_bf16 v[92:95], v[116:119], a[56:63], v17
 ds_read_b128 v[96:99], v0 offset:6144
 s_waitcnt lgkmcnt(8)
 v_smfmac_f32_16x16x64_bf16 v[88:91], v[72:75], a[64:71], v17
 ds_read_b128 v[64:67], v1 offset:16384
 v_smfmac_f32_16x16x64_bf16 v[92:95], v[72:75], a[72:79], v17
 ds_read_b128 v[100:103], v0 offset:6176
 s_waitcnt lgkmcnt(8)
 v_smfmac_f32_16x16x64_bf16 v[88:91], v[76:79], a[80:87], v17
 ds_read_b128 v[68:71], v1 offset:17408
 v_smfmac_f32_16x16x64_bf16 v[92:95], v[76:79], a[88:95], v17
 ds_read_b128 v[112:115], v0 offset:7168
 s_waitcnt lgkmcnt(8)
 v_smfmac_f32_16x16x64_bf16 v[88:91], v[80:83], a[96:103], v17
 ds_read_b128 v[104:107], v16 offset:18432
 v_smfmac_f32_16x16x64_bf16 v[92:95], v[80:83], a[104:111], v17
 ds_read_b128 v[116:119], v0 offset:7200
 s_waitcnt lgkmcnt(8)
 v_smfmac_f32_16x16x64_bf16 v[88:91], v[84:87], a[112:119], v17
 ds_read_b128 v[108:111], v16 offset:19456
 v_smfmac_f32_16x16x64_bf16 v[92:95], v[84:87], a[120:127], v17
 ds_read_b128 v[72:75], v0 offset:8192
 s_waitcnt lgkmcnt(8)
 v_smfmac_f32_16x16x64_bf16 v[88:91], v[96:99], a[128:135], v17
 ds_read_b128 v[224:227], v15 offset:8192
 v_smfmac_f32_16x16x64_bf16 v[92:95], v[96:99], a[136:143], v17
 ds_read_b128 v[76:79], v0 offset:8224
 s_waitcnt lgkmcnt(8)
 v_smfmac_f32_16x16x64_bf16 v[88:91], v[100:103], a[144:151], v17
 ds_read_b128 v[228:231], v15 offset:9216
 v_smfmac_f32_16x16x64_bf16 v[92:95], v[100:103], a[152:159], v17
 ds_read_b128 v[80:83], v0 offset:9216
 s_waitcnt lgkmcnt(8)
 v_smfmac_f32_16x16x64_bf16 v[88:91], v[112:115], a[160:167], v17
 ds_read_b128 v[232:235], v15 offset:10240
 v_smfmac_f32_16x16x64_bf16 v[92:95], v[112:115], a[168:175], v17
 ds_read_b128 v[84:87], v0 offset:9248
 s_waitcnt lgkmcnt(8)
 v_smfmac_f32_16x16x64_bf16 v[88:91], v[116:119], a[176:183], v17
 ds_read_b128 v[236:239], v15 offset:11264
 v_smfmac_f32_16x16x64_bf16 v[92:95], v[116:119], a[184:191], v17
 ds_read_b128 v[240:243], v15 offset:12288
 s_waitcnt lgkmcnt(8)
 v_smfmac_f32_16x16x64_bf16 v[88:91], v[72:75], a[192:199], v17
 ds_read_b128 v[244:247], v15 offset:13312
 v_smfmac_f32_16x16x64_bf16 v[92:95], v[72:75], a[200:207], v17
 ds_read_b128 v[248:251], v15 offset:14336
 s_waitcnt lgkmcnt(8)
 v_smfmac_f32_16x16x64_bf16 v[88:91], v[76:79], a[208:215], v17
 ds_read_b128 v[252:255], v15 offset:15360
 v_smfmac_f32_16x16x64_bf16 v[92:95], v[76:79], a[216:223], v17
 s_waitcnt lgkmcnt(7)
 v_smfmac_f32_16x16x64_bf16 v[88:91], v[80:83], a[224:231], v17
 v_smfmac_f32_16x16x64_bf16 v[92:95], v[80:83], a[232:239], v17
 s_waitcnt lgkmcnt(5)
 v_smfmac_f32_16x16x64_bf16 v[88:91], v[84:87], a[240:247], v17
 v_smfmac_f32_16x16x64_bf16 v[92:95], v[84:87], a[248:255], v17
 s_nop 2
 v_cvt_pk_bf16_f32 v120, v88, v89
 v_cvt_pk_bf16_f32 v121, v90, v91
 ds_write_b64 v6, v[120:121] offset:26624
 s_nop 1
 v_cvt_pk_bf16_f32 v122, v92, v93
 v_cvt_pk_bf16_f32 v123, v94, v95
 ds_write_b64 v6, v[122:123] offset:27136
 s_waitcnt lgkmcnt(0)
 s_barrier
 ds_read_b64_tr_b16 v[72:73], v7 offset:26624
 ds_read_b64_tr_b16 v[74:75], v7 offset:27136
 ds_read_b64_tr_b16 v[76:77], v7 offset:27648
 ds_read_b64_tr_b16 v[78:79], v7 offset:28160
 ds_read_b64_tr_b16 v[80:81], v7 offset:28672
 ds_read_b64_tr_b16 v[82:83], v7 offset:29184
 ds_read_b64_tr_b16 v[84:85], v7 offset:29696
 ds_read_b64_tr_b16 v[86:87], v7 offset:30208
 ds_read_b64_tr_b16 v[112:113], v8 offset:26624
 ds_read_b64_tr_b16 v[114:115], v8 offset:27136
 s_waitcnt lgkmcnt(8)
 v_mfma_f32_16x16x32_bf16 v[92:95], v[40:43], v[72:75], 0
 v_mfma_f32_16x16x32_bf16 v[96:99], v[56:59], v[72:75], 0
 v_mfma_f32_16x16x32_bf16 v[88:91], v[72:75], v[72:75], 0
 s_waitcnt lgkmcnt(6)
 v_mfma_f32_16x16x32_bf16 v[92:95], v[44:47], v[76:79], v[92:95]
 v_mfma_f32_16x16x32_bf16 v[96:99], v[60:63], v[76:79], v[96:99]
 v_mfma_f32_16x16x32_bf16 v[88:91], v[76:79], v[76:79], v[88:91]
 s_waitcnt lgkmcnt(4)
 v_mfma_f32_16x16x32_bf16 v[92:95], v[48:51], v[80:83], v[92:95]
 v_mfma_f32_16x16x32_bf16 v[96:99], v[64:67], v[80:83], v[96:99]
 v_mfma_f32_16x16x32_bf16 v[88:91], v[80:83], v[80:83], v[88:91]
 s_waitcnt lgkmcnt(0)
 buffer_store_dwordx4 v[112:115], v1, s[4:7], s62 offen
 s_waitcnt lgkmcnt(2)
 v_mfma_f32_16x16x32_bf16 v[92:95], v[52:55], v[84:87], v[92:95]
 v_mfma_f32_16x16x32_bf16 v[96:99], v[68:71], v[84:87], v[96:99]
 v_mfma_f32_16x16x32_bf16 v[88:91], v[84:87], v[84:87], v[88:91]
 v_mfma_f32_32x32x8_bf16 v[40:55], v[18:19], v[18:19], 0
 v_max3_f32 v126, v92, v93, v94
 buffer_load_dwordx2 v[124:125], v1, s[4:7], s66 offen sc1
 ds_read_b128 v[80:83], v15 offset:16384
 ds_read_b128 v[84:87], v15 offset:17408
 v_max3_f32 v126, v126, v95, v96
 v_max3_f32 v126, v126, v97, v98
 v_max3_f32 v126, v126, v99, v90
 v_max_f32 v126, v126, v91
 v_mov_b32 v127, v126
 v_mov_b64 v[56:57], 0
 v_mov_b64 v[58:59], 0
 v_permlane16_swap_b32 v126, v127
 v_max_f32 v126, v126, v127
 v_mov_b32 v127, v126
 s_nop 1
 v_permlane32_swap_b32 v126, v127
 v_max_f32 v126, v126, v127
 v_mul_f32 v126, s79, v126
 v_fma_f32 v92, v92, s79, -v126
 v_fma_f32 v93, v93, s79, -v126
 v_fma_f32 v94, v94, s79, -v126
 v_fma_f32 v95, v95, s79, -v126
 v_fma_f32 v96, v96, s79, -v126
 v_fma_f32 v97, v97, s79, -v126
 v_fma_f32 v98, v98, s79, -v126
 v_fma_f32 v99, v99, s79, -v126
 v_exp_f32 v92, v92
 v_exp_f32 v93, v93
 v_exp_f32 v94, v94
 v_exp_f32 v95, v95
 v_exp_f32 v96, v96
 v_exp_f32 v97, v97
 v_exp_f32 v98, v98
 v_exp_f32 v99, v99
 v_fma_f32 v90, v90, s79, -v126
 v_cvt_pk_bf16_f32 v100, v92, v93
 v_cvt_pk_bf16_f32 v101, v94, v95
 v_cvt_pk_bf16_f32 v102, v96, v97
 v_cvt_pk_bf16_f32 v103, v98, v99
 v_fma_f32 v91, v91, s79, -v126
 v_exp_f32 v90, v90
 v_mfma_f32_16x16x32_bf16 v[120:123], v[28:31], v[100:103], 0
 v_exp_f32 v91, v91
 v_mfma_f32_16x16x32_bf16 v[112:115], v[104:107], v[100:103], 0
 v_cvt_pk_bf16_f32 v36, v90, v91
 v_cvt_pk_bf16_f32 v39, v90, v91
 v_mfma_f32_16x16x32_bf16 v[116:119], v[108:111], v[100:103], 0
 s_waitcnt vmcnt(0)
 v_mfma_f32_16x16x16_bf16 v[120:123], v[28:29], v[36:37], v[120:123]
L_pv_222:
 v_cmp_eq_u32 vcc, -1, v124
 s_cbranch_vccnz L_rt_223
 v_mfma_f32_16x16x16_bf16 v[112:115], v[124:125], v[36:37], v[112:115]
 v_mfma_f32_16x16x16_bf16 v[116:119], v[124:125], v[38:39], v[116:119]
 v_rcp_f32 v120, v120
 ds_read_b128 v[88:91], v15 offset:18432
 ds_read_b128 v[92:95], v15 offset:19456
 ds_read_b128 v[96:99], v15 offset:20480
 ds_read_b128 v[100:103], v15 offset:21504
 s_mov_b64 exec, s[28:29]
 v_pk_mul_f32 v[112:113], v[112:113], v[120:121] op_sel_hi:[1,0]
 v_pk_mul_f32 v[114:115], v[114:115], v[120:121] op_sel_hi:[1,0]
 v_cvt_pk_bf16_f32 v112, v112, v113
 v_cvt_pk_bf16_f32 v113, v114, v115
 v_pk_mul_f32 v[116:117], v[116:117], v[120:121] op_sel_hi:[1,0]
 v_pk_mul_f32 v[118:119], v[118:119], v[120:121] op_sel_hi:[1,0]
 v_cvt_pk_bf16_f32 v114, v116, v117
 v_cvt_pk_bf16_f32 v115, v118, v119
 ds_write_b128 v9, v[112:115] offset:30720
 s_mov_b64 exec, -1
 s_waitcnt lgkmcnt(0)
 s_barrier
 ds_read_b128 v[60:63], v0 offset:30720
 ds_read_b128 v[64:67], v0 offset:30752
 ds_read_b128 v[68:71], v0 offset:31744
 ds_read_b128 v[72:75], v0 offset:31776
 s_waitcnt lgkmcnt(3)
 v_smfmac_f32_16x16x64_bf16 v[40:43], v[60:63], v[224:231], v17
 ds_read_b128 v[224:227], v15 offset:22528
 v_smfmac_f32_16x16x64_bf16 v[44:47], v[60:63], v[232:239], v17
 ds_read_b128 v[228:231], v15 offset:23552
 s_waitcnt lgkmcnt(4)
 v_smfmac_f32_16x16x64_bf16 v[40:43], v[64:67], v[240:247], v17
 ds_read_b128 v[232:235], v15 offset:24576
 v_smfmac_f32_16x16x64_bf16 v[44:47], v[64:67], v[248:255], v17
 ds_read_b128 v[236:239], v15 offset:25600
 s_waitcnt lgkmcnt(5)
 v_smfmac_f32_16x16x64_bf16 v[40:43], v[68:71], v[80:87], v17
 ds_read_b128 v[240:243], v15 offset:26624
 v_smfmac_f32_16x16x64_bf16 v[44:47], v[68:71], v[128:135], v17
 ds_read_b128 v[244:247], v15 offset:27648
 s_waitcnt lgkmcnt(6)
 v_smfmac_f32_16x16x64_bf16 v[40:43], v[72:75], v[136:143], v17
 ds_read_b128 v[248:251], v15 offset:28672
 v_smfmac_f32_16x16x64_bf16 v[44:47], v[72:75], v[144:151], v17
 ds_read_b128 v[252:255], v15 offset:29696
 v_smfmac_f32_16x16x64_bf16 v[48:51], v[60:63], v[152:159], v17
 ds_read_b128 v[80:83], v15 offset:30720
 v_cvt_pk_bf16_f32 v116, v40, v41
 v_cvt_pk_bf16_f32 v117, v42, v43
 v_and_b32 v116, -2, v116
 v_smfmac_f32_16x16x64_bf16 v[52:55], v[60:63], v[160:167], v17
 ds_read_b128 v[84:87], v15 offset:31744
 v_cvt_pk_bf16_f32 v118, v44, v45
 v_cvt_pk_bf16_f32 v119, v46, v47
 v_and_b32 v118, -2, v118
 buffer_store_dwordx4 v[116:119], v10, s[4:7], s68 offen
 v_smfmac_f32_16x16x64_bf16 v[48:51], v[64:67], v[168:175], v17
 v_smfmac_f32_16x16x64_bf16 v[52:55], v[64:67], v[176:183], v17
 v_smfmac_f32_16x16x64_bf16 v[48:51], v[68:71], v[184:191], v17
 v_smfmac_f32_16x16x64_bf16 v[52:55], v[68:71], v[88:95], v17
 v_smfmac_f32_16x16x64_bf16 v[48:51], v[72:75], v[96:103], v17
 s_waitcnt lgkmcnt(8)
 v_smfmac_f32_16x16x64_bf16 v[52:55], v[72:75], v[224:231], v17
 s_waitcnt lgkmcnt(6)
 v_smfmac_f32_16x16x64_bf16 v[56:59], v[60:63], v[232:239], v17
 v_cvt_pk_bf16_f32 v120, v48, v49
 v_cvt_pk_bf16_f32 v121, v50, v51
 v_and_b32 v120, -2, v120
 s_waitcnt lgkmcnt(4)
 v_smfmac_f32_16x16x64_bf16 v[56:59], v[64:67], v[240:247], v17
 v_cvt_pk_bf16_f32 v122, v52, v53
 v_cvt_pk_bf16_f32 v123, v54, v55
 v_and_b32 v122, -2, v122
 buffer_store_dwordx4 v[120:123], v10, s[4:7], s69 offen
 s_waitcnt lgkmcnt(2)
 v_smfmac_f32_16x16x64_bf16 v[56:59], v[68:71], v[248:255], v17
 s_waitcnt lgkmcnt(0)
 v_smfmac_f32_16x16x64_bf16 v[56:59], v[72:75], v[80:87], v17
 s_nop 7
 v_cvt_pk_bf16_f32 v124, v56, v57
 v_cvt_pk_bf16_f32 v125, v58, v59
 v_and_b32 v124, -2, v124
 buffer_store_dwordx2 v[124:125], v10, s[4:7], s70 offen
 ds_read_b128 v[224:227], v15 offset:0
 ds_read_b128 v[228:231], v15 offset:1024
 ds_read_b128 v[232:235], v15 offset:2048
 ds_read_b128 v[236:239], v15 offset:3072
 ds_read_b128 v[240:243], v15 offset:4096
 ds_read_b128 v[244:247], v15 offset:5120
 ds_read_b128 v[248:251], v15 offset:6144
 ds_read_b128 v[252:255], v15 offset:7168
 v_mov_b64 v[88:89], 0
 v_mov_b64 v[90:91], 0
 v_mov_b64 v[92:93], 0
 v_mov_b64 v[94:95], 0
 s_cmp_eq_u32 s55, 0
 s_cbranch_scc1 L_nr_224
 s_nop 15
 s_nop 15
 s_nop 15
 s_nop 15
 s_nop 15
L_pp_226:
 buffer_load_dwordx4 v[40:43], v1, s[4:7], s74 offen offset:0 sc1
 buffer_load_dwordx4 v[44:47], v1, s[4:7], s74 offen offset:1024 sc1
 buffer_load_dwordx4 v[48:51], v1, s[4:7], s74 offen offset:2048 sc1
 buffer_load_dwordx4 v[52:55], v1, s[4:7], s74 offen offset:3072 sc1
 s_waitcnt vmcnt(3)
 v_mfma_f32_16x16x32_bf16 v[56:59], v[40:43], v[20:23], 0
 v_or_b32 v14, v40, v42
 s_waitcnt vmcnt(2)
 v_mfma_f32_16x16x32_bf16 v[56:59], v[44:47], v[20:23], v[56:59]
 v_or3_b32 v14, v14, v44, v46
 s_waitcnt vmcnt(1)
 v_mfma_f32_16x16x32_bf16 v[56:59], v[48:51], v[20:23], v[56:59]
 v_or3_b32 v14, v14, v48, v50
 s_waitcnt vmcnt(0)
 v_mfma_f32_16x16x32_bf16 v[56:59], v[52:55], v[20:23], v[56:59]
 v_or3_b32 v14, v14, v52, v54
 v_and_b32 v14, 1, v14
 v_cmp_ne_u32 vcc, 0, v14
 s_cbranch_vccnz L_rt_227
 s_nop 2
 v_cvt_pk_bf16_f32 v60, v56, v57
 v_cvt_pk_bf16_f32 v61, v58, v59
 s_nop 0
 v_mov_b32_dpp v62, v60 quad_perm:[2,3,2,3] row_mask:0xf bank_mask:0xf
 v_mov_b32_dpp v63, v61 quad_perm:[2,3,2,3] row_mask:0xf bank_mask:0xf
 s_mov_b64 exec, s[30:31]
 buffer_store_dwordx4 v[60:63], v11, s[4:7], s59 offen sc1
 s_mov_b64 exec, 1
 buffer_store_dword v13, off, s[4:7], s17
 s_mov_b64 exec, s[30:31]
 buffer_store_dwordx4 v[32:35], v11, s[4:7], s57 offen sc1
 s_mov_b64 exec, -1
 s_barrier
 s_nop 15
 s_nop 15
 s_nop 15
 s_nop 15
 s_nop 15
 s_nop 15
 s_nop 15
 s_nop 7
L_rj_225:
 v_add_u32 v13, 1, v13
 s_add_u32 s53, s53, 1
.p2align 3
 s_mov_b32 s51, 0
 buffer_load_dwordx4 v[40:43], v2, s[4:7], s59 offen offset:0 sc1
 buffer_load_dwordx4 v[44:47], v2, s[4:7], s59 offen offset:128 sc1
 buffer_load_dwordx4 v[48:51], v2, s[4:7], s59 offen offset:1024 sc1
 buffer_load_dwordx4 v[52:55], v2, s[4:7], s59 offen offset:1152 sc1
 buffer_load_dwordx4 v[56:59], v3, s[4:7], s59 offen offset:0 sc1
L_xm_228:
 s_waitcnt vmcnt(4)
 v_mfma_f32_16x16x32_bf16 v[60:63], v[24:27], v[40:43], 0
 s_waitcnt vmcnt(3)
 v_mfma_f32_16x16x32_bf16 v[64:67], v[24:27], v[44:47], 0
 s_waitcnt vmcnt(2)
 v_mfma_f32_16x16x32_bf16 v[68:71], v[24:27], v[48:51], 0
 v_max3_u32 v14, v40, v44, v48
 v_cvt_pk_bf16_f32 v60, v60, v61
 v_cvt_pk_bf16_f32 v61, v62, v63
 ds_write_b64 v4, v[60:61] offset:0
 s_waitcnt vmcnt(1)
 v_mfma_f32_16x16x32_bf16 v[72:75], v[24:27], v[52:55], 0
 v_cvt_pk_bf16_f32 v64, v64, v65
 v_cvt_pk_bf16_f32 v65, v66, v67
 ds_write_b64 v4, v[64:65] offset:8
 s_waitcnt vmcnt(0)
 v_mfma_f32_16x16x32_bf16 v[76:79], v[24:27], v[56:59], 0
 v_max3_u32 v14, v14, v52, v56
 v_cmp_eq_u32 vcc, -1, v14
 v_cvt_pk_bf16_f32 v68, v68, v69
 v_cvt_pk_bf16_f32 v69, v70, v71
 ds_write_b64 v4, v[68:69] offset:1024
 s_cbranch_vccnz L_rt_229
 v_cvt_pk_bf16_f32 v72, v72, v73
 v_cvt_pk_bf16_f32 v73, v74, v75
 ds_write_b64 v4, v[72:73] offset:1032
 s_nop 0
 v_cvt_pk_bf16_f32 v76, v76, v77
 v_cvt_pk_bf16_f32 v77, v78, v79
 ds_write_b64 v5, v[76:77] offset:0
 s_waitcnt lgkmcnt(0)
 s_barrier
L_ch_b1f3:
 ds_read_b128 v[72:75], v0 offset:0
 ds_read_b128 v[76:79], v0 offset:32
 ds_read_b128 v[80:83], v0 offset:1024
 s_waitcnt lgkmcnt(2)
 v_smfmac_f32_16x16x64_bf16 v[88:91], v[72:75], v[224:231], v17
 ds_read_b128 v[84:87], v0 offset:1056
 v_smfmac_f32_16x16x64_bf16 v[92:95], v[72:75], v[232:239], v17
 ds_read_b128 v[96:99], v0 offset:2048
 s_waitcnt lgkmcnt(3)
 v_smfmac_f32_16x16x64_bf16 v[88:91], v[76:79], v[240:247], v17
 ds_read_b128 v[100:103], v0 offset:2080
 v_smfmac_f32_16x16x64_bf16 v[92:95], v[76:79], v[248:255], v17
 ds_read_b128 v[112:115], v0 offset:3072
 s_waitcnt lgkmcnt(4)
 v_smfmac_f32_16x16x64_bf16 v[88:91], v[80:83], v[192:199], v17
 ds_read_b128 v[40:43], v1 offset:10240
 v_smfmac_f32_16x16x64_bf16 v[92:95], v[80:83], v[200:207], v17
 ds_read_b128 v[116:119], v0 offset:3104
 s_waitcnt lgkmcnt(5)
 v_smfmac_f32_16x16x64_bf16 v[88:91], v[84:87], v[208:215], v17
 ds_read_b128 v[44:47], v1 offset:11264
 v_smfmac_f32_16x16x64_bf16 v[92:95], v[84:87], v[216:223], v17
 ds_read_b128 v[72:75], v0 offset:4096
 s_waitcnt lgkmcnt(6)
 v_smfmac_f32_16x16x64_bf16 v[88:91], v[96:99], a[0:7], v17
 ds_read_b128 v[48:51], v1 offset:12288
 v_smfmac_f32_16x16x64_bf16 v[92:95], v[96:99], a[8:15], v17
 ds_read_b128 v[76:79], v0 offset:4128
 s_waitcnt lgkmcnt(7)
 v_smfmac_f32_16x16x64_bf16 v[88:91], v[100:103], a[16:23], v17
 ds_read_b128 v[52:55], v1 offset:13312
 v_smfmac_f32_16x16x64_bf16 v[92:95], v[100:103], a[24:31], v17
 ds_read_b128 v[80:83], v0 offset:5120
 s_waitcnt lgkmcnt(8)
 v_smfmac_f32_16x16x64_bf16 v[88:91], v[112:115], a[32:39], v17
 ds_read_b128 v[56:59], v1 offset:14336
 v_smfmac_f32_16x16x64_bf16 v[92:95], v[112:115], a[40:47], v17
 ds_read_b128 v[84:87], v0 offset:5152
 s_waitcnt lgkmcnt(8)
 v_smfmac_f32_16x16x64_bf16 v[88:91], v[116:119], a[48:55], v17
 ds_read_b128 v[60:63], v1 offset:15360
 v_smfmac_f32_16x16x64_bf16 v[92:95], v[116:119], a[56:63], v17
 ds_read_b128 v[96:99], v0 offset:6144
 s_waitcnt lgkmcnt(8)
 v_smfmac_f32_16x16x64_bf16 v[88:91], v[72:75], a[64:71], v17
 ds_read_b128 v[64:67], v1 offset:16384
 v_smfmac_f32_16x16x64_bf16 v[92:95], v[72:75], a[72:79], v17
 ds_read_b128 v[100:103], v0 offset:6176
 s_waitcnt lgkmcnt(8)
 v_smfmac_f32_16x16x64_bf16 v[88:91], v[76:79], a[80:87], v17
 ds_read_b128 v[68:71], v1 offset:17408
 v_smfmac_f32_16x16x64_bf16 v[92:95], v[76:79], a[88:95], v17
 ds_read_b128 v[112:115], v0 offset:7168
 s_waitcnt lgkmcnt(8)
 v_smfmac_f32_16x16x64_bf16 v[88:91], v[80:83], a[96:103], v17
 ds_read_b128 v[104:107], v16 offset:18432
 v_smfmac_f32_16x16x64_bf16 v[92:95], v[80:83], a[104:111], v17
 ds_read_b128 v[116:119], v0 offset:7200
 s_waitcnt lgkmcnt(8)
 v_smfmac_f32_16x16x64_bf16 v[88:91], v[84:87], a[112:119], v17
 ds_read_b128 v[108:111], v16 offset:19456
 v_smfmac_f32_16x16x64_bf16 v[92:95], v[84:87], a[120:127], v17
 ds_read_b128 v[72:75], v0 offset:8192
 s_waitcnt lgkmcnt(8)
 v_smfmac_f32_16x16x64_bf16 v[88:91], v[96:99], a[128:135], v17
 ds_read_b128 v[224:227], v15 offset:8192
 v_smfmac_f32_16x16x64_bf16 v[92:95], v[96:99], a[136:143], v17
 ds_read_b128 v[76:79], v0 offset:8224
 s_waitcnt lgkmcnt(8)
 v_smfmac_f32_16x16x64_bf16 v[88:91], v[100:103], a[144:151], v17
 ds_read_b128 v[228:231], v15 offset:9216
 v_smfmac_f32_16x16x64_bf16 v[92:95], v[100:103], a[152:159], v17
 ds_read_b128 v[80:83], v0 offset:9216
 s_waitcnt lgkmcnt(8)
 v_smfmac_f32_16x16x64_bf16 v[88:91], v[112:115], a[160:167], v17
 ds_read_b128 v[232:235], v15 offset:10240
 v_smfmac_f32_16x16x64_bf16 v[92:95], v[112:115], a[168:175], v17
 ds_read_b128 v[84:87], v0 offset:9248
 s_waitcnt lgkmcnt(8)
 v_smfmac_f32_16x16x64_bf16 v[88:91], v[116:119], a[176:183], v17
 ds_read_b128 v[236:239], v15 offset:11264
 v_smfmac_f32_16x16x64_bf16 v[92:95], v[116:119], a[184:191], v17
 ds_read_b128 v[240:243], v15 offset:12288
 s_waitcnt lgkmcnt(8)
 v_smfmac_f32_16x16x64_bf16 v[88:91], v[72:75], a[192:199], v17
 ds_read_b128 v[244:247], v15 offset:13312
 v_smfmac_f32_16x16x64_bf16 v[92:95], v[72:75], a[200:207], v17
 ds_read_b128 v[248:251], v15 offset:14336
 s_waitcnt lgkmcnt(8)
 v_smfmac_f32_16x16x64_bf16 v[88:91], v[76:79], a[208:215], v17
 ds_read_b128 v[252:255], v15 offset:15360
 v_smfmac_f32_16x16x64_bf16 v[92:95], v[76:79], a[216:223], v17
 s_waitcnt lgkmcnt(7)
 v_smfmac_f32_16x16x64_bf16 v[88:91], v[80:83], a[224:231], v17
 v_smfmac_f32_16x16x64_bf16 v[92:95], v[80:83], a[232:239], v17
 s_waitcnt lgkmcnt(5)
 v_smfmac_f32_16x16x64_bf16 v[88:91], v[84:87], a[240:247], v17
 v_smfmac_f32_16x16x64_bf16 v[92:95], v[84:87], a[248:255], v17
 s_nop 2
 v_cvt_pk_bf16_f32 v120, v88, v89
 v_cvt_pk_bf16_f32 v121, v90, v91
 ds_write_b64 v6, v[120:121] offset:26624
 s_nop 1
 v_cvt_pk_bf16_f32 v122, v92, v93
 v_cvt_pk_bf16_f32 v123, v94, v95
 ds_write_b64 v6, v[122:123] offset:27136
 s_waitcnt lgkmcnt(0)
 s_barrier
 ds_read_b64_tr_b16 v[72:73], v7 offset:26624
 ds_read_b64_tr_b16 v[74:75], v7 offset:27136
 ds_read_b64_tr_b16 v[76:77], v7 offset:27648
 ds_read_b64_tr_b16 v[78:79], v7 offset:28160
 ds_read_b64_tr_b16 v[80:81], v7 offset:28672
 ds_read_b64_tr_b16 v[82:83], v7 offset:29184
 ds_read_b64_tr_b16 v[84:85], v7 offset:29696
 ds_read_b64_tr_b16 v[86:87], v7 offset:30208
 ds_read_b64_tr_b16 v[112:113], v8 offset:26624
 ds_read_b64_tr_b16 v[114:115], v8 offset:27136
 s_waitcnt lgkmcnt(8)
 v_mfma_f32_16x16x32_bf16 v[92:95], v[40:43], v[72:75], 0
 v_mfma_f32_16x16x32_bf16 v[96:99], v[56:59], v[72:75], 0
 v_mfma_f32_16x16x32_bf16 v[88:91], v[72:75], v[72:75], 0
 s_waitcnt lgkmcnt(6)
 v_mfma_f32_16x16x32_bf16 v[92:95], v[44:47], v[76:79], v[92:95]
 v_mfma_f32_16x16x32_bf16 v[96:99], v[60:63], v[76:79], v[96:99]
 v_mfma_f32_16x16x32_bf16 v[88:91], v[76:79], v[76:79], v[88:91]
 s_waitcnt lgkmcnt(4)
 v_mfma_f32_16x16x32_bf16 v[92:95], v[48:51], v[80:83], v[92:95]
 v_mfma_f32_16x16x32_bf16 v[96:99], v[64:67], v[80:83], v[96:99]
 v_mfma_f32_16x16x32_bf16 v[88:91], v[80:83], v[80:83], v[88:91]
 s_waitcnt lgkmcnt(0)
 buffer_store_dwordx4 v[112:115], v1, s[4:7], s63 offen
 s_waitcnt lgkmcnt(2)
 v_mfma_f32_16x16x32_bf16 v[92:95], v[52:55], v[84:87], v[92:95]
 v_mfma_f32_16x16x32_bf16 v[96:99], v[68:71], v[84:87], v[96:99]
 v_mfma_f32_16x16x32_bf16 v[88:91], v[84:87], v[84:87], v[88:91]
 s_cmp_eq_u32 s53, 63
 s_cbranch_scc1 L_ch_last
 v_mfma_f32_32x32x8_bf16 v[40:55], v[18:19], v[18:19], 0
 v_max3_f32 v126, v92, v93, v94
 buffer_load_dwordx2 v[124:125], v1, s[4:7], s67 offen sc1
 ds_read_b128 v[80:83], v15 offset:16384
 ds_read_b128 v[84:87], v15 offset:17408
 v_max3_f32 v126, v126, v95, v96
 v_max3_f32 v126, v126, v97, v98
 v_max3_f32 v126, v126, v99, v90
 v_max_f32 v126, v126, v91
 v_mov_b32 v127, v126
 v_mov_b64 v[56:57], 0
 v_mov_b64 v[58:59], 0
 v_permlane16_swap_b32 v126, v127
 v_max_f32 v126, v126, v127
 v_mov_b32 v127, v126
 s_nop 1
 v_permlane32_swap_b32 v126, v127
 v_max_f32 v126, v126, v127
 v_mul_f32 v126, s79, v126
 v_fma_f32 v92, v92, s79, -v126
 v_fma_f32 v93, v93, s79, -v126
 v_fma_f32 v94, v94, s79, -v126
 v_fma_f32 v95, v95, s79, -v126
 v_fma_f32 v96, v96, s79, -v126
 v_fma_f32 v97, v97, s79, -v126
 v_fma_f32 v98, v98, s79, -v126
 v_fma_f32 v99, v99, s79, -v126
 v_exp_f32 v92, v92
 v_exp_f32 v93, v93
 v_exp_f32 v94, v94
 v_exp_f32 v95, v95
 v_exp_f32 v96, v96
 v_exp_f32 v97, v97
 v_exp_f32 v98, v98
 v_exp_f32 v99, v99
 v_fma_f32 v90, v90, s79, -v126
 v_cvt_pk_bf16_f32 v100, v92, v93
 v_cvt_pk_bf16_f32 v101, v94, v95
 v_cvt_pk_bf16_f32 v102, v96, v97
 v_cvt_pk_bf16_f32 v103, v98, v99
 v_fma_f32 v91, v91, s79, -v126
 v_exp_f32 v90, v90
 v_mfma_f32_16x16x32_bf16 v[120:123], v[28:31], v[100:103], 0
 v_exp_f32 v91, v91
 v_mfma_f32_16x16x32_bf16 v[112:115], v[104:107], v[100:103], 0
 v_cvt_pk_bf16_f32 v36, v90, v91
 v_cvt_pk_bf16_f32 v39, v90, v91
 v_mfma_f32_16x16x32_bf16 v[116:119], v[108:111], v[100:103], 0
 s_waitcnt vmcnt(0)
 v_mfma_f32_16x16x16_bf16 v[120:123], v[28:29], v[36:37], v[120:123]
L_pv_230:
 v_cmp_eq_u32 vcc, -1, v124
 s_cbranch_vccnz L_rt_231
 v_mfma_f32_16x16x16_bf16 v[112:115], v[124:125], v[36:37], v[112:115]
 v_mfma_f32_16x16x16_bf16 v[116:119], v[124:125], v[38:39], v[116:119]
 v_rcp_f32 v120, v120
 ds_read_b128 v[88:91], v15 offset:18432
 ds_read_b128 v[92:95], v15 offset:19456
 ds_read_b128 v[96:99], v15 offset:20480
 ds_read_b128 v[100:103], v15 offset:21504
 s_mov_b64 exec, s[28:29]
 v_pk_mul_f32 v[112:113], v[112:113], v[120:121] op_sel_hi:[1,0]
 v_pk_mul_f32 v[114:115], v[114:115], v[120:121] op_sel_hi:[1,0]
 v_cvt_pk_bf16_f32 v112, v112, v113
 v_cvt_pk_bf16_f32 v113, v114, v115
 v_pk_mul_f32 v[116:117], v[116:117], v[120:121] op_sel_hi:[1,0]
 v_pk_mul_f32 v[118:119], v[118:119], v[120:121] op_sel_hi:[1,0]
 v_cvt_pk_bf16_f32 v114, v116, v117
 v_cvt_pk_bf16_f32 v115, v118, v119
 ds_write_b128 v9, v[112:115] offset:30720
 s_mov_b64 exec, -1
 s_waitcnt lgkmcnt(0)
 s_barrier
 ds_read_b128 v[60:63], v0 offset:30720
 ds_read_b128 v[64:67], v0 offset:30752
 ds_read_b128 v[68:71], v0 offset:31744
 ds_read_b128 v[72:75], v0 offset:31776
 s_waitcnt lgkmcnt(3)
 v_smfmac_f32_16x16x64_bf16 v[40:43], v[60:63], v[224:231], v17
 ds_read_b128 v[224:227], v15 offset:22528
 v_smfmac_f32_16x16x64_bf16 v[44:47], v[60:63], v[232:239], v17
 ds_read_b128 v[228:231], v15 offset:23552
 s_waitcnt lgkmcnt(4)
 v_smfmac_f32_16x16x64_bf16 v[40:43], v[64:67], v[240:247], v17
 ds_read_b128 v[232:235], v15 offset:24576
 v_smfmac_f32_16x16x64_bf16 v[44:47], v[64:67], v[248:255], v17
 ds_read_b128 v[236:239], v15 offset:25600
 s_waitcnt lgkmcnt(5)
 v_smfmac_f32_16x16x64_bf16 v[40:43], v[68:71], v[80:87], v17
 ds_read_b128 v[240:243], v15 offset:26624
 v_smfmac_f32_16x16x64_bf16 v[44:47], v[68:71], v[128:135], v17
 ds_read_b128 v[244:247], v15 offset:27648
 s_waitcnt lgkmcnt(6)
 v_smfmac_f32_16x16x64_bf16 v[40:43], v[72:75], v[136:143], v17
 ds_read_b128 v[248:251], v15 offset:28672
 v_smfmac_f32_16x16x64_bf16 v[44:47], v[72:75], v[144:151], v17
 ds_read_b128 v[252:255], v15 offset:29696
 v_smfmac_f32_16x16x64_bf16 v[48:51], v[60:63], v[152:159], v17
 ds_read_b128 v[80:83], v15 offset:30720
 v_cvt_pk_bf16_f32 v116, v40, v41
 v_cvt_pk_bf16_f32 v117, v42, v43
 v_and_b32 v116, -2, v116
 v_smfmac_f32_16x16x64_bf16 v[52:55], v[60:63], v[160:167], v17
 ds_read_b128 v[84:87], v15 offset:31744
 v_cvt_pk_bf16_f32 v118, v44, v45
 v_cvt_pk_bf16_f32 v119, v46, v47
 v_and_b32 v118, -2, v118
 buffer_store_dwordx4 v[116:119], v10, s[4:7], s71 offen
 v_smfmac_f32_16x16x64_bf16 v[48:51], v[64:67], v[168:175], v17
 v_smfmac_f32_16x16x64_bf16 v[52:55], v[64:67], v[176:183], v17
 v_smfmac_f32_16x16x64_bf16 v[48:51], v[68:71], v[184:191], v17
 v_smfmac_f32_16x16x64_bf16 v[52:55], v[68:71], v[88:95], v17
 v_smfmac_f32_16x16x64_bf16 v[48:51], v[72:75], v[96:103], v17
 s_waitcnt lgkmcnt(8)
 v_smfmac_f32_16x16x64_bf16 v[52:55], v[72:75], v[224:231], v17
 s_waitcnt lgkmcnt(6)
 v_smfmac_f32_16x16x64_bf16 v[56:59], v[60:63], v[232:239], v17
 v_cvt_pk_bf16_f32 v120, v48, v49
 v_cvt_pk_bf16_f32 v121, v50, v51
 v_and_b32 v120, -2, v120
 s_waitcnt lgkmcnt(4)
 v_smfmac_f32_16x16x64_bf16 v[56:59], v[64:67], v[240:247], v17
 v_cvt_pk_bf16_f32 v122, v52, v53
 v_cvt_pk_bf16_f32 v123, v54, v55
 v_and_b32 v122, -2, v122
 buffer_store_dwordx4 v[120:123], v10, s[4:7], s72 offen
 s_waitcnt lgkmcnt(2)
 v_smfmac_f32_16x16x64_bf16 v[56:59], v[68:71], v[248:255], v17
 s_waitcnt lgkmcnt(0)
 v_smfmac_f32_16x16x64_bf16 v[56:59], v[72:75], v[80:87], v17
 s_nop 7
 v_cvt_pk_bf16_f32 v124, v56, v57
 v_cvt_pk_bf16_f32 v125, v58, v59
 v_and_b32 v124, -2, v124
 buffer_store_dwordx2 v[124:125], v10, s[4:7], s73 offen
 ds_read_b128 v[224:227], v15 offset:0
 ds_read_b128 v[228:231], v15 offset:1024
 ds_read_b128 v[232:235], v15 offset:2048
 ds_read_b128 v[236:239], v15 offset:3072
 ds_read_b128 v[240:243], v15 offset:4096
 ds_read_b128 v[244:247], v15 offset:5120
 ds_read_b128 v[248:251], v15 offset:6144
 ds_read_b128 v[252:255], v15 offset:7168
 v_mov_b64 v[88:89], 0
 v_mov_b64 v[90:91], 0
 v_mov_b64 v[92:93], 0
 v_mov_b64 v[94:95], 0
 s_cmp_eq_u32 s55, 0
 s_cbranch_scc1 L_nr_232
 s_nop 15
 s_nop 15
 s_nop 15
 s_nop 15
 s_nop 15
L_pp_234:
 buffer_load_dwordx4 v[40:43], v1, s[4:7], s75 offen offset:0 sc1
 buffer_load_dwordx4 v[44:47], v1, s[4:7], s75 offen offset:1024 sc1
 buffer_load_dwordx4 v[48:51], v1, s[4:7], s75 offen offset:2048 sc1
 buffer_load_dwordx4 v[52:55], v1, s[4:7], s75 offen offset:3072 sc1
 s_waitcnt vmcnt(3)
 v_mfma_f32_16x16x32_bf16 v[56:59], v[40:43], v[20:23], 0
 v_or_b32 v14, v40, v42
 s_waitcnt vmcnt(2)
 v_mfma_f32_16x16x32_bf16 v[56:59], v[44:47], v[20:23], v[56:59]
 v_or3_b32 v14, v14, v44, v46
 s_waitcnt vmcnt(1)
 v_mfma_f32_16x16x32_bf16 v[56:59], v[48:51], v[20:23], v[56:59]
 v_or3_b32 v14, v14, v48, v50
 s_waitcnt vmcnt(0)
 v_mfma_f32_16x16x32_bf16 v[56:59], v[52:55], v[20:23], v[56:59]
 v_or3_b32 v14, v14, v52, v54
 v_and_b32 v14, 1, v14
 v_cmp_ne_u32 vcc, 0, v14
 s_cbranch_vccnz L_rt_235
 s_nop 2
 v_cvt_pk_bf16_f32 v60, v56, v57
 v_cvt_pk_bf16_f32 v61, v58, v59
 s_nop 0
 v_mov_b32_dpp v62, v60 quad_perm:[2,3,2,3] row_mask:0xf bank_mask:0xf
 v_mov_b32_dpp v63, v61 quad_perm:[2,3,2,3] row_mask:0xf bank_mask:0xf
 s_mov_b64 exec, s[30:31]
 buffer_store_dwordx4 v[60:63], v11, s[4:7], s56 offen sc1
 s_mov_b64 exec, 1
 buffer_store_dword v13, off, s[4:7], s17
 s_mov_b64 exec, s[30:31]
 buffer_store_dwordx4 v[32:35], v11, s[4:7], s58 offen sc1
 s_mov_b64 exec, -1
 s_barrier
 s_nop 15
 s_nop 15
 s_nop 15
 s_nop 15
 s_nop 15
 s_nop 15
 s_nop 15
 s_nop 7
L_rj_233:
 v_add_u32 v13, 1, v13
 s_add_u32 s53, s53, 1
 s_branch L_ch_loopf
L_rt_205:
 s_nop 7
 buffer_load_dwordx4 v[40:43], v2, s[4:7], s56 offen offset:0 sc1
 buffer_load_dwordx4 v[44:47], v2, s[4:7], s56 offen offset:128 sc1
 buffer_load_dwordx4 v[48:51], v2, s[4:7], s56 offen offset:1024 sc1
 buffer_load_dwordx4 v[52:55], v2, s[4:7], s56 offen offset:1152 sc1
 buffer_load_dwordx4 v[56:59], v3, s[4:7], s56 offen offset:0 sc1
 s_add_u32 s51, s51, 1
 s_cmp_lt_u32 s51, 131072
 s_cbranch_scc1 L_xm_204
 s_branch L_bail
L_rt_207:
 buffer_load_dwordx2 v[124:125], v1, s[4:7], s64 offen sc1
 s_waitcnt vmcnt(0)
 s_add_u32 s51, s51, 1
 s_cmp_lt_u32 s51, 131072
 s_cbranch_scc1 L_pv_206
 s_branch L_bail
L_rt_211:
 s_add_u32 s51, s51, 1
 s_cmp_lt_u32 s51, 131072
 s_cbranch_scc1 L_pp_210
 s_branch L_bail
L_nr_208:
 s_cmp_lg_u32 s50, 0
 s_cbranch_scc1 L_id_236
 buffer_store_dwordx4 v[32:35], v1, s[4:7], s62 offen offset:0
 buffer_store_dwordx4 v[32:35], v1, s[4:7], s62 offen offset:1024
 buffer_store_dwordx4 v[32:35], v1, s[4:7], s62 offen offset:2048
 buffer_store_dwordx4 v[32:35], v1, s[4:7], s62 offen offset:3072
 buffer_load_dword v14, off, s[4:7], s32 sc1
 s_waitcnt vmcnt(0)
 s_barrier
 s_add_u32 s76, s53, 1
L_fl_237:
 v_cmp_ge_u32 vcc, s76, v14
 s_cbranch_vccz L_fld_238
 buffer_load_dword v14, off, s[4:7], s32 sc1
 s_waitcnt vmcnt(0)
 s_add_u32 s51, s51, 1
 s_cmp_lt_u32 s51, 131072
 s_cbranch_scc1 L_fl_237
 s_branch L_bail
L_fld_238:
 s_lshl_b32 s16, s76, 19
 s_add_u32 s16, s16, s54
 s_mov_b32 m0, 10240
 s_nop 0
 buffer_load_dwordx4 v1, s[4:7], s16 offen offset:0 sc1 lds
 buffer_load_dwordx4 v1, s[4:7], s16 offen offset:1024 sc1 lds
 buffer_load_dwordx4 v1, s[4:7], s16 offen offset:2048 sc1 lds
 buffer_load_dwordx4 v1, s[4:7], s16 offen offset:3072 sc1 lds
 s_mov_b32 m0, 14336
 s_nop 0
 buffer_load_dwordx4 v12, s[4:7], s16 offen offset:0 sc1 lds
 buffer_load_dwordx4 v12, s[4:7], s16 offen offset:1024 sc1 lds
 buffer_load_dwordx4 v12, s[4:7], s16 offen offset:2048 sc1 lds
 buffer_load_dwordx4 v12, s[4:7], s16 offen offset:3072 sc1 lds
 s_add_u32 s16, s16, 67108864
 s_mov_b32 m0, 18432
 s_nop 0
 buffer_load_dwordx4 v1, s[4:7], s16 offen offset:0 sc1 lds
 buffer_load_dwordx4 v1, s[4:7], s16 offen offset:1024 sc1 lds
 buffer_load_dwordx4 v1, s[4:7], s16 offen offset:2048 sc1 lds
 buffer_load_dwordx4 v1, s[4:7], s16 offen offset:3072 sc1 lds
 s_mov_b32 m0, 22528
 s_nop 0
 buffer_load_dwordx4 v12, s[4:7], s16 offen offset:0 sc1 lds
 buffer_load_dwordx4 v12, s[4:7], s16 offen offset:1024 sc1 lds
 buffer_load_dwordx4 v12, s[4:7], s16 offen offset:2048 sc1 lds
 buffer_load_dwordx4 v12, s[4:7], s16 offen offset:3072 sc1 lds
 s_nop 15
 s_nop 15
 s_nop 15
 s_branch L_rj_209
L_id_236:
 s_barrier
 s_nop 15
 s_nop 15
 s_nop 15
 s_nop 15
 s_nop 15
 s_nop 15
 s_nop 15
 s_nop 7
 s_branch L_rj_209
L_rt_213:
 s_nop 7
 buffer_load_dwordx4 v[40:43], v2, s[4:7], s57 offen offset:0 sc1
 buffer_load_dwordx4 v[44:47], v2, s[4:7], s57 offen offset:128 sc1
 buffer_load_dwordx4 v[48:51], v2, s[4:7], s57 offen offset:1024 sc1
 buffer_load_dwordx4 v[52:55], v2, s[4:7], s57 offen offset:1152 sc1
 buffer_load_dwordx4 v[56:59], v3, s[4:7], s57 offen offset:0 sc1
 s_add_u32 s51, s51, 1
 s_cmp_lt_u32 s51, 131072
 s_cbranch_scc1 L_xm_212
 s_branch L_bail
L_rt_215:
 buffer_load_dwordx2 v[124:125], v1, s[4:7], s65 offen sc1
 s_waitcnt vmcnt(0)
 s_add_u32 s51, s51, 1
 s_cmp_lt_u32 s51, 131072
 s_cbranch_scc1 L_pv_214
 s_branch L_bail
L_rt_219:
 s_add_u32 s51, s51, 1
 s_cmp_lt_u32 s51, 131072
 s_cbranch_scc1 L_pp_218
 s_branch L_bail
L_nr_216:
 s_cmp_lg_u32 s50, 0
 s_cbranch_scc1 L_id_239
 buffer_store_dwordx4 v[32:35], v1, s[4:7], s63 offen offset:0
 buffer_store_dwordx4 v[32:35], v1, s[4:7], s63 offen offset:1024
 buffer_store_dwordx4 v[32:35], v1, s[4:7], s63 offen offset:2048
 buffer_store_dwordx4 v[32:35], v1, s[4:7], s63 offen offset:3072
 buffer_load_dword v14, off, s[4:7], s32 sc1
 s_waitcnt vmcnt(0)
 s_barrier
 s_add_u32 s76, s53, 1
L_fl_240:
 v_cmp_ge_u32 vcc, s76, v14
 s_cbranch_vccz L_fld_241
 buffer_load_dword v14, off, s[4:7], s32 sc1
 s_waitcnt vmcnt(0)
 s_add_u32 s51, s51, 1
 s_cmp_lt_u32 s51, 131072
 s_cbranch_scc1 L_fl_240
 s_branch L_bail
L_fld_241:
 s_lshl_b32 s16, s76, 19
 s_add_u32 s16, s16, s54
 s_mov_b32 m0, 10240
 s_nop 0
 buffer_load_dwordx4 v1, s[4:7], s16 offen offset:0 sc1 lds
 buffer_load_dwordx4 v1, s[4:7], s16 offen offset:1024 sc1 lds
 buffer_load_dwordx4 v1, s[4:7], s16 offen offset:2048 sc1 lds
 buffer_load_dwordx4 v1, s[4:7], s16 offen offset:3072 sc1 lds
 s_mov_b32 m0, 14336
 s_nop 0
 buffer_load_dwordx4 v12, s[4:7], s16 offen offset:0 sc1 lds
 buffer_load_dwordx4 v12, s[4:7], s16 offen offset:1024 sc1 lds
 buffer_load_dwordx4 v12, s[4:7], s16 offen offset:2048 sc1 lds
 buffer_load_dwordx4 v12, s[4:7], s16 offen offset:3072 sc1 lds
 s_add_u32 s16, s16, 67108864
 s_mov_b32 m0, 18432
 s_nop 0
 buffer_load_dwordx4 v1, s[4:7], s16 offen offset:0 sc1 lds
 buffer_load_dwordx4 v1, s[4:7], s16 offen offset:1024 sc1 lds
 buffer_load_dwordx4 v1, s[4:7], s16 offen offset:2048 sc1 lds
 buffer_load_dwordx4 v1, s[4:7], s16 offen offset:3072 sc1 lds
 s_mov_b32 m0, 22528
 s_nop 0
 buffer_load_dwordx4 v12, s[4:7], s16 offen offset:0 sc1 lds
 buffer_load_dwordx4 v12, s[4:7], s16 offen offset:1024 sc1 lds
 buffer_load_dwordx4 v12, s[4:7], s16 offen offset:2048 sc1 lds
 buffer_load_dwordx4 v12, s[4:7], s16 offen offset:3072 sc1 lds
 s_nop 15
 s_nop 15
 s_nop 15
 s_branch L_rj_217
L_id_239:
 s_barrier
 s_nop 15
 s_nop 15
 s_nop 15
 s_nop 15
 s_nop 15
 s_nop 15
 s_nop 15
 s_nop 7
 s_branch L_rj_217
L_rt_221:
 s_nop 7
 buffer_load_dwordx4 v[40:43], v2, s[4:7], s58 offen offset:0 sc1
 buffer_load_dwordx4 v[44:47], v2, s[4:7], s58 offen offset:128 sc1
 buffer_load_dwordx4 v[48:51], v2, s[4:7], s58 offen offset:1024 sc1
 buffer_load_dwordx4 v[52:55], v2, s[4:7], s58 offen offset:1152 sc1
 buffer_load_dwordx4 v[56:59], v3, s[4:7], s58 offen offset:0 sc1
 s_add_u32 s51, s51, 1
 s_cmp_lt_u32 s51, 131072
 s_cbranch_scc1 L_xm_220
 s_branch L_bail
L_rt_223:
 buffer_load_dwordx2 v[124:125], v1, s[4:7], s66 offen sc1
 s_waitcnt vmcnt(0)
 s_add_u32 s51, s51, 1
 s_cmp_lt_u32 s51, 131072
 s_cbranch_scc1 L_pv_222
 s_branch L_bail
L_rt_227:
 s_add_u32 s51, s51, 1
 s_cmp_lt_u32 s51, 131072
 s_cbranch_scc1 L_pp_226
 s_branch L_bail
L_nr_224:
 s_cmp_lg_u32 s50, 0
 s_cbranch_scc1 L_id_242
 buffer_store_dwordx4 v[32:35], v1, s[4:7], s60 offen offset:0
 buffer_store_dwordx4 v[32:35], v1, s[4:7], s60 offen offset:1024
 buffer_store_dwordx4 v[32:35], v1, s[4:7], s60 offen offset:2048
 buffer_store_dwordx4 v[32:35], v1, s[4:7], s60 offen offset:3072
 buffer_load_dword v14, off, s[4:7], s32 sc1
 s_waitcnt vmcnt(0)
 s_barrier
 s_add_u32 s76, s53, 1
L_fl_243:
 v_cmp_ge_u32 vcc, s76, v14
 s_cbranch_vccz L_fld_244
 buffer_load_dword v14, off, s[4:7], s32 sc1
 s_waitcnt vmcnt(0)
 s_add_u32 s51, s51, 1
 s_cmp_lt_u32 s51, 131072
 s_cbranch_scc1 L_fl_243
 s_branch L_bail
L_fld_244:
 s_lshl_b32 s16, s76, 19
 s_add_u32 s16, s16, s54
 s_mov_b32 m0, 10240
 s_nop 0
 buffer_load_dwordx4 v1, s[4:7], s16 offen offset:0 sc1 lds
 buffer_load_dwordx4 v1, s[4:7], s16 offen offset:1024 sc1 lds
 buffer_load_dwordx4 v1, s[4:7], s16 offen offset:2048 sc1 lds
 buffer_load_dwordx4 v1, s[4:7], s16 offen offset:3072 sc1 lds
 s_mov_b32 m0, 14336
 s_nop 0
 buffer_load_dwordx4 v12, s[4:7], s16 offen offset:0 sc1 lds
 buffer_load_dwordx4 v12, s[4:7], s16 offen offset:1024 sc1 lds
 buffer_load_dwordx4 v12, s[4:7], s16 offen offset:2048 sc1 lds
 buffer_load_dwordx4 v12, s[4:7], s16 offen offset:3072 sc1 lds
 s_add_u32 s16, s16, 67108864
 s_mov_b32 m0, 18432
 s_nop 0
 buffer_load_dwordx4 v1, s[4:7], s16 offen offset:0 sc1 lds
 buffer_load_dwordx4 v1, s[4:7], s16 offen offset:1024 sc1 lds
 buffer_load_dwordx4 v1, s[4:7], s16 offen offset:2048 sc1 lds
 buffer_load_dwordx4 v1, s[4:7], s16 offen offset:3072 sc1 lds
 s_mov_b32 m0, 22528
 s_nop 0
 buffer_load_dwordx4 v12, s[4:7], s16 offen offset:0 sc1 lds
 buffer_load_dwordx4 v12, s[4:7], s16 offen offset:1024 sc1 lds
 buffer_load_dwordx4 v12, s[4:7], s16 offen offset:2048 sc1 lds
 buffer_load_dwordx4 v12, s[4:7], s16 offen offset:3072 sc1 lds
 s_nop 15
 s_nop 15
 s_nop 15
 s_branch L_rj_225
L_id_242:
 s_barrier
 s_nop 15
 s_nop 15
 s_nop 15
 s_nop 15
 s_nop 15
 s_nop 15
 s_nop 15
 s_nop 7
 s_branch L_rj_225
L_rt_229:
 s_nop 7
 buffer_load_dwordx4 v[40:43], v2, s[4:7], s59 offen offset:0 sc1
 buffer_load_dwordx4 v[44:47], v2, s[4:7], s59 offen offset:128 sc1
 buffer_load_dwordx4 v[48:51], v2, s[4:7], s59 offen offset:1024 sc1
 buffer_load_dwordx4 v[52:55], v2, s[4:7], s59 offen offset:1152 sc1
 buffer_load_dwordx4 v[56:59], v3, s[4:7], s59 offen offset:0 sc1
 s_add_u32 s51, s51, 1
 s_cmp_lt_u32 s51, 131072
 s_cbranch_scc1 L_xm_228
 s_branch L_bail
L_rt_231:
 buffer_load_dwordx2 v[124:125], v1, s[4:7], s67 offen sc1
 s_waitcnt vmcnt(0)
 s_add_u32 s51, s51, 1
 s_cmp_lt_u32 s51, 131072
 s_cbranch_scc1 L_pv_230
 s_branch L_bail
L_rt_235:
 s_add_u32 s51, s51, 1
 s_cmp_lt_u32 s51, 131072
 s_cbranch_scc1 L_pp_234
 s_branch L_bail
L_nr_232:
 s_cmp_lg_u32 s50, 0
 s_cbranch_scc1 L_id_245
 buffer_store_dwordx4 v[32:35], v1, s[4:7], s61 offen offset:0
 buffer_store_dwordx4 v[32:35], v1, s[4:7], s61 offen offset:1024
 buffer_store_dwordx4 v[32:35], v1, s[4:7], s61 offen offset:2048
 buffer_store_dwordx4 v[32:35], v1, s[4:7], s61 offen offset:3072
 buffer_load_dword v14, off, s[4:7], s32 sc1
 s_waitcnt vmcnt(0)
 s_barrier
 s_add_u32 s76, s53, 1
L_fl_246:
 v_cmp_ge_u32 vcc, s76, v14
 s_cbranch_vccz L_fld_247
 buffer_load_dword v14, off, s[4:7], s32 sc1
 s_waitcnt vmcnt(0)
 s_add_u32 s51, s51, 1
 s_cmp_lt_u32 s51, 131072
 s_cbranch_scc1 L_fl_246
 s_branch L_bail
L_fld_247:
 s_lshl_b32 s16, s76, 19
 s_add_u32 s16, s16, s54
 s_mov_b32 m0, 10240
 s_nop 0
 buffer_load_dwordx4 v1, s[4:7], s16 offen offset:0 sc1 lds
 buffer_load_dwordx4 v1, s[4:7], s16 offen offset:1024 sc1 lds
 buffer_load_dwordx4 v1, s[4:7], s16 offen offset:2048 sc1 lds
 buffer_load_dwordx4 v1, s[4:7], s16 offen offset:3072 sc1 lds
 s_mov_b32 m0, 14336
 s_nop 0
 buffer_load_dwordx4 v12, s[4:7], s16 offen offset:0 sc1 lds
 buffer_load_dwordx4 v12, s[4:7], s16 offen offset:1024 sc1 lds
 buffer_load_dwordx4 v12, s[4:7], s16 offen offset:2048 sc1 lds
 buffer_load_dwordx4 v12, s[4:7], s16 offen offset:3072 sc1 lds
 s_add_u32 s16, s16, 67108864
 s_mov_b32 m0, 18432
 s_nop 0
 buffer_load_dwordx4 v1, s[4:7], s16 offen offset:0 sc1 lds
 buffer_load_dwordx4 v1, s[4:7], s16 offen offset:1024 sc1 lds
 buffer_load_dwordx4 v1, s[4:7], s16 offen offset:2048 sc1 lds
 buffer_load_dwordx4 v1, s[4:7], s16 offen offset:3072 sc1 lds
 s_mov_b32 m0, 22528
 s_nop 0
 buffer_load_dwordx4 v12, s[4:7], s16 offen offset:0 sc1 lds
 buffer_load_dwordx4 v12, s[4:7], s16 offen offset:1024 sc1 lds
 buffer_load_dwordx4 v12, s[4:7], s16 offen offset:2048 sc1 lds
 buffer_load_dwordx4 v12, s[4:7], s16 offen offset:3072 sc1 lds
 s_nop 15
 s_nop 15
 s_nop 15
 s_branch L_rj_233
L_id_245:
 s_barrier
 s_nop 15
 s_nop 15
 s_nop 15
 s_nop 15
 s_nop 15
 s_nop 15
 s_nop 15
 s_nop 7
 s_branch L_rj_233
.p2align 8
L_ch_loops:
 s_mov_b32 s51, 0
 buffer_load_dwordx4 v[40:43], v2, s[4:7], s56 offen offset:0 sc1
 buffer_load_dwordx4 v[44:47], v2, s[4:7], s56 offen offset:128 sc1
 buffer_load_dwordx4 v[48:51], v2, s[4:7], s56 offen offset:1024 sc1
 buffer_load_dwordx4 v[52:55], v2, s[4:7], s56 offen offset:1152 sc1
 buffer_load_dwordx4 v[56:59], v3, s[4:7], s56 offen offset:0 sc1
L_xm_248:
 s_waitcnt vmcnt(4)
 v_mfma_f32_16x16x32_bf16 v[60:63], v[24:27], v[40:43], 0
 s_waitcnt vmcnt(3)
 v_mfma_f32_16x16x32_bf16 v[64:67], v[24:27], v[44:47], 0
 s_waitcnt vmcnt(2)
 v_mfma_f32_16x16x32_bf16 v[68:71], v[24:27], v[48:51], 0
 v_max3_u32 v14, v40, v44, v48
 v_cvt_pk_bf16_f32 v60, v60, v61
 v_cvt_pk_bf16_f32 v61, v62, v63
 ds_write_b64 v4, v[60:61] offset:0
 s_waitcnt vmcnt(1)
 v_mfma_f32_16x16x32_bf16 v[72:75], v[24:27], v[52:55], 0
 v_cvt_pk_bf16_f32 v64, v64, v65
 v_cvt_pk_bf16_f32 v65, v66, v67
 ds_write_b64 v4, v[64:65] offset:8
 s_waitcnt vmcnt(0)
 v_mfma_f32_16x16x32_bf16 v[76:79], v[24:27], v[56:59], 0
 v_max3_u32 v14, v14, v52, v56
 v_cmp_eq_u32 vcc, -1, v14
 v_cvt_pk_bf16_f32 v68, v68, v69
 v_cvt_pk_bf16_f32 v69, v70, v71
 ds_write_b64 v4, v[68:69] offset:1024
 s_cbranch_vccnz L_rt_249
 v_cvt_pk_bf16_f32 v72, v72, v73
 v_cvt_pk_bf16_f32 v73, v74, v75
 ds_write_b64 v4, v[72:73] offset:1032
 s_nop 0
 v_cvt_pk_bf16_f32 v76, v76, v77
 v_cvt_pk_bf16_f32 v77, v78, v79
 ds_write_b64 v5, v[76:77] offset:0
 s_waitcnt lgkmcnt(0)
 s_barrier
L_ch_b1s0:
 ds_read_b128 v[72:75], v0 offset:0
 ds_read_b128 v[76:79], v0 offset:32
 ds_read_b128 v[80:83], v0 offset:1024
 s_waitcnt lgkmcnt(2)
 v_smfmac_f32_16x16x64_bf16 v[88:91], v[72:75], v[224:231], v17
 ds_read_b128 v[84:87], v0 offset:1056
 v_smfmac_f32_16x16x64_bf16 v[92:95], v[72:75], v[232:239], v17
 ds_read_b128 v[96:99], v0 offset:2048
 s_waitcnt lgkmcnt(3)
 v_smfmac_f32_16x16x64_bf16 v[88:91], v[76:79], v[240:247], v17
 ds_read_b128 v[100:103], v0 offset:2080
 v_smfmac_f32_16x16x64_bf16 v[92:95], v[76:79], v[248:255], v17
 ds_read_b128 v[112:115], v0 offset:3072
 s_waitcnt lgkmcnt(4)
 v_smfmac_f32_16x16x64_bf16 v[88:91], v[80:83], v[192:199], v17
 ds_read_b128 v[40:43], v1 offset:10240
 v_smfmac_f32_16x16x64_bf16 v[92:95], v[80:83], v[200:207], v17
 ds_read_b128 v[116:119], v0 offset:3104
 s_waitcnt lgkmcnt(5)
 v_smfmac_f32_16x16x64_bf16 v[88:91], v[84:87], v[208:215], v17
 ds_read_b128 v[44:47], v1 offset:11264
 v_smfmac_f32_16x16x64_bf16 v[92:95], v[84:87], v[216:223], v17
 ds_read_b128 v[72:75], v0 offset:4096
 s_waitcnt lgkmcnt(6)
 v_smfmac_f32_16x16x64_bf16 v[88:91], v[96:99], a[0:7], v17
 ds_read_b128 v[48:51], v1 offset:12288
 v_smfmac_f32_16x16x64_bf16 v[92:95], v[96:99], a[8:15], v17
 ds_read_b128 v[76:79], v0 offset:4128
 s_waitcnt lgkmcnt(7)
 v_smfmac_f32_16x16x64_bf16 v[88:91], v[100:103], a[16:23], v17
 ds_read_b128 v[52:55], v1 offset:13312
 v_smfmac_f32_16x16x64_bf16 v[92:95], v[100:103], a[24:31], v17
 ds_read_b128 v[80:83], v0 offset:5120
 s_waitcnt lgkmcnt(8)
 v_smfmac_f32_16x16x64_bf16 v[88:91], v[112:115], a[32:39], v17
 ds_read_b128 v[56:59], v1 offset:14336
 v_smfmac_f32_16x16x64_bf16 v[92:95], v[112:115], a[40:47], v17
 ds_read_b128 v[84:87], v0 offset:5152
 s_waitcnt lgkmcnt(8)
 v_smfmac_f32_16x16x64_bf16 v[88:91], v[116:119], a[48:55], v17
 ds_read_b128 v[60:63], v1 offset:15360
 v_smfmac_f32_16x16x64_bf16 v[92:95], v[116:119], a[56:63], v17
 ds_read_b128 v[96:99], v0 offset:6144
 s_waitcnt lgkmcnt(8)
 v_smfmac_f32_16x16x64_bf16 v[88:91], v[72:75], a[64:71], v17
 ds_read_b128 v[64:67], v1 offset:16384
 v_smfmac_f32_16x16x64_bf16 v[92:95], v[72:75], a[72:79], v17
 ds_read_b128 v[100:103], v0 offset:6176
 s_waitcnt lgkmcnt(8)
 v_smfmac_f32_16x16x64_bf16 v[88:91], v[76:79], a[80:87], v17
 ds_read_b128 v[68:71], v1 offset:17408
 v_smfmac_f32_16x16x64_bf16 v[92:95], v[76:79], a[88:95], v17
 ds_read_b128 v[112:115], v0 offset:7168
 s_waitcnt lgkmcnt(8)
 v_smfmac_f32_16x16x64_bf16 v[88:91], v[80:83], a[96:103], v17
 ds_read_b128 v[104:107], v16 offset:18432
 v_smfmac_f32_16x16x64_bf16 v[92:95], v[80:83], a[104:111], v17
 ds_read_b128 v[116:119], v0 offset:7200
 s_waitcnt lgkmcnt(8)
 v_smfmac_f32_16x16x64_bf16 v[88:91], v[84:87], a[112:119], v17
 ds_read_b128 v[108:111], v16 offset:19456
 v_smfmac_f32_16x16x64_bf16 v[92:95], v[84:87], a[120:127], v17
 ds_read_b128 v[72:75], v0 offset:8192
 s_waitcnt lgkmcnt(8)
 v_smfmac_f32_16x16x64_bf16 v[88:91], v[96:99], a[128:135], v17
 ds_read_b128 v[224:227], v15 offset:8192
 v_smfmac_f32_16x16x64_bf16 v[92:95], v[96:99], a[136:143], v17
 ds_read_b128 v[76:79], v0 offset:8224
 s_waitcnt lgkmcnt(8)
 v_smfmac_f32_16x16x64_bf16 v[88:91], v[100:103], a[144:151], v17
 ds_read_b128 v[228:231], v15 offset:9216
 v_smfmac_f32_16x16x64_bf16 v[92:95], v[100:103], a[152:159], v17
 ds_read_b128 v[80:83], v0 offset:9216
 s_waitcnt lgkmcnt(8)
 v_smfmac_f32_16x16x64_bf16 v[88:91], v[112:115], a[160:167], v17
 ds_read_b128 v[232:235], v15 offset:10240
 v_smfmac_f32_16x16x64_bf16 v[92:95], v[112:115], a[168:175], v17
 ds_read_b128 v[84:87], v0 offset:9248
 s_waitcnt lgkmcnt(8)
 v_smfmac_f32_16x16x64_bf16 v[88:91], v[116:119], a[176:183], v17
 ds_read_b128 v[236:239], v15 offset:11264
 v_smfmac_f32_16x16x64_bf16 v[92:95], v[116:119], a[184:191], v17
 ds_read_b128 v[240:243], v15 offset:12288
 s_waitcnt lgkmcnt(8)
 v_smfmac_f32_16x16x64_bf16 v[88:91], v[72:75], a[192:199], v17
 ds_read_b128 v[244:247], v15 offset:13312
 v_smfmac_f32_16x16x64_bf16 v[92:95], v[72:75], a[200:207], v17
 ds_read_b128 v[248:251], v15 offset:14336
 s_waitcnt lgkmcnt(8)
 v_smfmac_f32_16x16x64_bf16 v[88:91], v[76:79], a[208:215], v17
 ds_read_b128 v[252:255], v15 offset:15360
 v_smfmac_f32_16x16x64_bf16 v[92:95], v[76:79], a[216:223], v17
 s_waitcnt lgkmcnt(7)
 v_smfmac_f32_16x16x64_bf16 v[88:91], v[80:83], a[224:231], v17
 v_smfmac_f32_16x16x64_bf16 v[92:95], v[80:83], a[232:239], v17
 s_waitcnt lgkmcnt(5)
 v_smfmac_f32_16x16x64_bf16 v[88:91], v[84:87], a[240:247], v17
 v_smfmac_f32_16x16x64_bf16 v[92:95], v[84:87], a[248:255], v17
 s_nop 2
 v_cvt_pk_bf16_f32 v120, v88, v89
 v_cvt_pk_bf16_f32 v121, v90, v91
 ds_write_b64 v6, v[120:121] offset:26624
 s_nop 1
 v_cvt_pk_bf16_f32 v122, v92, v93
 v_cvt_pk_bf16_f32 v123, v94, v95
 ds_write_b64 v6, v[122:123] offset:27136
 s_waitcnt lgkmcnt(0)
 s_barrier
 ds_read_b64_tr_b16 v[72:73], v7 offset:26624
 ds_read_b64_tr_b16 v[74:75], v7 offset:27136
 ds_read_b64_tr_b16 v[76:77], v7 offset:27648
 ds_read_b64_tr_b16 v[78:79], v7 offset:28160
 ds_read_b64_tr_b16 v[80:81], v7 offset:28672
 ds_read_b64_tr_b16 v[82:83], v7 offset:29184
 ds_read_b64_tr_b16 v[84:85], v7 offset:29696
 ds_read_b64_tr_b16 v[86:87], v7 offset:30208
 ds_read_b64_tr_b16 v[112:113], v8 offset:26624
 ds_read_b64_tr_b16 v[114:115], v8 offset:27136
 s_waitcnt lgkmcnt(8)
 v_mfma_f32_16x16x32_bf16 v[92:95], v[40:43], v[72:75], 0
 v_mfma_f32_16x16x32_bf16 v[96:99], v[56:59], v[72:75], 0
 v_mfma_f32_16x16x32_bf16 v[88:91], v[72:75], v[72:75], 0
 s_waitcnt lgkmcnt(6)
 v_mfma_f32_16x16x32_bf16 v[92:95], v[44:47], v[76:79], v[92:95]
 v_mfma_f32_16x16x32_bf16 v[96:99], v[60:63], v[76:79], v[96:99]
 v_mfma_f32_16x16x32_bf16 v[88:91], v[76:79], v[76:79], v[88:91]
 s_waitcnt lgkmcnt(4)
 v_mfma_f32_16x16x32_bf16 v[92:95], v[48:51], v[80:83], v[92:95]
 v_mfma_f32_16x16x32_bf16 v[96:99], v[64:67], v[80:83], v[96:99]
 v_mfma_f32_16x16x32_bf16 v[88:91], v[80:83], v[80:83], v[88:91]
 s_waitcnt lgkmcnt(0)
 buffer_store_dwordx4 v[112:115], v1, s[4:7], s60 offen sc1
 s_waitcnt lgkmcnt(2)
 v_mfma_f32_16x16x32_bf16 v[92:95], v[52:55], v[84:87], v[92:95]
 v_mfma_f32_16x16x32_bf16 v[96:99], v[68:71], v[84:87], v[96:99]
 v_mfma_f32_16x16x32_bf16 v[88:91], v[84:87], v[84:87], v[88:91]
 v_mfma_f32_32x32x8_bf16 v[40:55], v[18:19], v[18:19], 0
 v_max3_f32 v126, v92, v93, v94
 buffer_load_dwordx2 v[124:125], v1, s[4:7], s64 offen sc1
 ds_read_b128 v[80:83], v15 offset:16384
 ds_read_b128 v[84:87], v15 offset:17408
 v_max3_f32 v126, v126, v95, v96
 v_max3_f32 v126, v126, v97, v98
 v_max3_f32 v126, v126, v99, v90
 v_max_f32 v126, v126, v91
 v_mov_b32 v127, v126
 v_mov_b64 v[56:57], 0
 v_mov_b64 v[58:59], 0
 v_permlane16_swap_b32 v126, v127
 v_max_f32 v126, v126, v127
 v_mov_b32 v127, v126
 s_nop 1
 v_permlane32_swap_b32 v126, v127
 v_max_f32 v126, v126, v127
 v_mul_f32 v126, s79, v126
 v_fma_f32 v92, v92, s79, -v126
 v_fma_f32 v93, v93, s79, -v126
 v_fma_f32 v94, v94, s79, -v126
 v_fma_f32 v95, v95, s79, -v126
 v_fma_f32 v96, v96, s79, -v126
 v_fma_f32 v97, v97, s79, -v126
 v_fma_f32 v98, v98, s79, -v126
 v_fma_f32 v99, v99, s79, -v126
 v_exp_f32 v92, v92
 v_exp_f32 v93, v93
 v_exp_f32 v94, v94
 v_exp_f32 v95, v95
 v_exp_f32 v96, v96
 v_exp_f32 v97, v97
 v_exp_f32 v98, v98
 v_exp_f32 v99, v99
 v_fma_f32 v90, v90, s79, -v126
 v_cvt_pk_bf16_f32 v100, v92, v93
 v_cvt_pk_bf16_f32 v101, v94, v95
 v_cvt_pk_bf16_f32 v102, v96, v97
 v_cvt_pk_bf16_f32 v103, v98, v99
 v_fma_f32 v91, v91, s79, -v126
 v_exp_f32 v90, v90
 v_mfma_f32_16x16x32_bf16 v[120:123], v[28:31], v[100:103], 0
 v_exp_f32 v91, v91
 v_mfma_f32_16x16x32_bf16 v[112:115], v[104:107], v[100:103], 0
 v_cvt_pk_bf16_f32 v36, v90, v91
 v_cvt_pk_bf16_f32 v39, v90, v91
 v_mfma_f32_16x16x32_bf16 v[116:119], v[108:111], v[100:103], 0
 s_waitcnt vmcnt(0)
 v_mfma_f32_16x16x16_bf16 v[120:123], v[28:29], v[36:37], v[120:123]
L_pv_250:
 v_cmp_eq_u32 vcc, -1, v124
 s_cbranch_vccnz L_rt_251
 v_mfma_f32_16x16x16_bf16 v[112:115], v[124:125], v[36:37], v[112:115]
 v_mfma_f32_16x16x16_bf16 v[116:119], v[124:125], v[38:39], v[116:119]
 v_rcp_f32 v120, v120
 ds_read_b128 v[88:91], v15 offset:18432
 ds_read_b128 v[92:95], v15 offset:19456
 ds_read_b128 v[96:99], v15 offset:20480
 ds_read_b128 v[100:103], v15 offset:21504
 s_mov_b64 exec, s[28:29]
 v_pk_mul_f32 v[112:113], v[112:113], v[120:121] op_sel_hi:[1,0]
 v_pk_mul_f32 v[114:115], v[114:115], v[120:121] op_sel_hi:[1,0]
 v_cvt_pk_bf16_f32 v112, v112, v113
 v_cvt_pk_bf16_f32 v113, v114, v115
 v_pk_mul_f32 v[116:117], v[116:117], v[120:121] op_sel_hi:[1,0]
 v_pk_mul_f32 v[118:119], v[118:119], v[120:121] op_sel_hi:[1,0]
 v_cvt_pk_bf16_f32 v114, v116, v117
 v_cvt_pk_bf16_f32 v115, v118, v119
 ds_write_b128 v9, v[112:115] offset:30720
 s_mov_b64 exec, -1
 s_waitcnt lgkmcnt(0)
 s_barrier
 ds_read_b128 v[60:63], v0 offset:30720
 ds_read_b128 v[64:67], v0 offset:30752
 ds_read_b128 v[68:71], v0 offset:31744
 ds_read_b128 v[72:75], v0 offset:31776
 s_waitcnt lgkmcnt(3)
 v_smfmac_f32_16x16x64_bf16 v[40:43], v[60:63], v[224:231], v17
 ds_read_b128 v[224:227], v15 offset:22528
 v_smfmac_f32_16x16x64_bf16 v[44:47], v[60:63], v[232:239], v17
 ds_read_b128 v[228:231], v15 offset:23552
 s_waitcnt lgkmcnt(4)
 v_smfmac_f32_16x16x64_bf16 v[40:43], v[64:67], v[240:247], v17
 ds_read_b128 v[232:235], v15 offset:24576
 v_smfmac_f32_16x16x64_bf16 v[44:47], v[64:67], v[248:255], v17
 ds_read_b128 v[236:239], v15 offset:25600
 s_waitcnt lgkmcnt(5)
 v_smfmac_f32_16x16x64_bf16 v[40:43], v[68:71], v[80:87], v17
 ds_read_b128 v[240:243], v15 offset:26624
 v_smfmac_f32_16x16x64_bf16 v[44:47], v[68:71], v[128:135], v17
 ds_read_b128 v[244:247], v15 offset:27648
 s_waitcnt lgkmcnt(6)
 v_smfmac_f32_16x16x64_bf16 v[40:43], v[72:75], v[136:143], v17
 ds_read_b128 v[248:251], v15 offset:28672
 v_smfmac_f32_16x16x64_bf16 v[44:47], v[72:75], v[144:151], v17
 ds_read_b128 v[252:255], v15 offset:29696
 v_smfmac_f32_16x16x64_bf16 v[48:51], v[60:63], v[152:159], v17
 ds_read_b128 v[80:83], v15 offset:30720
 v_cvt_pk_bf16_f32 v116, v40, v41
 v_cvt_pk_bf16_f32 v117, v42, v43
 v_or_b32 v116, 1, v116
 v_smfmac_f32_16x16x64_bf16 v[52:55], v[60:63], v[160:167], v17
 ds_read_b128 v[84:87], v15 offset:31744
 v_cvt_pk_bf16_f32 v118, v44, v45
 v_cvt_pk_bf16_f32 v119, v46, v47
 v_or_b32 v118, 1, v118
 buffer_store_dwordx4 v[116:119], v10, s[4:7], s68 offen sc1
 v_smfmac_f32_16x16x64_bf16 v[48:51], v[64:67], v[168:175], v17
 v_smfmac_f32_16x16x64_bf16 v[52:55], v[64:67], v[176:183], v17
 v_smfmac_f32_16x16x64_bf16 v[48:51], v[68:71], v[184:191], v17
 v_smfmac_f32_16x16x64_bf16 v[52:55], v[68:71], v[88:95], v17
 v_smfmac_f32_16x16x64_bf16 v[48:51], v[72:75], v[96:103], v17
 s_waitcnt lgkmcnt(8)
 v_smfmac_f32_16x16x64_bf16 v[52:55], v[72:75], v[224:231], v17
 s_waitcnt lgkmcnt(6)
 v_smfmac_f32_16x16x64_bf16 v[56:59], v[60:63], v[232:239], v17
 v_cvt_pk_bf16_f32 v120, v48, v49
 v_cvt_pk_bf16_f32 v121, v50, v51
 v_or_b32 v120, 1, v120
 s_waitcnt lgkmcnt(4)
 v_smfmac_f32_16x16x64_bf16 v[56:59], v[64:67], v[240:247], v17
 v_cvt_pk_bf16_f32 v122, v52, v53
 v_cvt_pk_bf16_f32 v123, v54, v55
 v_or_b32 v122, 1, v122
 buffer_store_dwordx4 v[120:123], v10, s[4:7], s69 offen sc1
 s_waitcnt lgkmcnt(2)
 v_smfmac_f32_16x16x64_bf16 v[56:59], v[68:71], v[248:255], v17
 s_waitcnt lgkmcnt(0)
 v_smfmac_f32_16x16x64_bf16 v[56:59], v[72:75], v[80:87], v17
 s_nop 7
 v_cvt_pk_bf16_f32 v124, v56, v57
 v_cvt_pk_bf16_f32 v125, v58, v59
 v_or_b32 v124, 1, v124
 buffer_store_dwordx2 v[124:125], v10, s[4:7], s70 offen sc1
 ds_read_b128 v[224:227], v15 offset:0
 ds_read_b128 v[228:231], v15 offset:1024
 ds_read_b128 v[232:235], v15 offset:2048
 ds_read_b128 v[236:239], v15 offset:3072
 ds_read_b128 v[240:243], v15 offset:4096
 ds_read_b128 v[244:247], v15 offset:5120
 ds_read_b128 v[248:251], v15 offset:6144
 ds_read_b128 v[252:255], v15 offset:7168
 v_mov_b64 v[88:89], 0
 v_mov_b64 v[90:91], 0
 v_mov_b64 v[92:93], 0
 v_mov_b64 v[94:95], 0
 s_cmp_eq_u32 s55, 0
 s_cbranch_scc1 L_nr_252
 s_nop 15
 s_nop 15
 s_nop 15
 s_nop 15
 s_nop 15
L_pp_254:
 buffer_load_dwordx4 v[40:43], v1, s[4:7], s74 offen offset:0 sc1
 buffer_load_dwordx4 v[44:47], v1, s[4:7], s74 offen offset:1024 sc1
 buffer_load_dwordx4 v[48:51], v1, s[4:7], s74 offen offset:2048 sc1
 buffer_load_dwordx4 v[52:55], v1, s[4:7], s74 offen offset:3072 sc1
 s_waitcnt vmcnt(3)
 v_mfma_f32_16x16x32_bf16 v[56:59], v[40:43], v[20:23], 0
 v_and_b32 v14, v40, v42
 s_waitcnt vmcnt(2)
 v_mfma_f32_16x16x32_bf16 v[56:59], v[44:47], v[20:23], v[56:59]
 v_bitop3_b32 v14, v14, v44, v46 bitop3:0x80
 s_waitcnt vmcnt(1)
 v_mfma_f32_16x16x32_bf16 v[56:59], v[48:51], v[20:23], v[56:59]
 v_bitop3_b32 v14, v14, v48, v50 bitop3:0x80
 s_waitcnt vmcnt(0)
 v_mfma_f32_16x16x32_bf16 v[56:59], v[52:55], v[20:23], v[56:59]
 v_bitop3_b32 v14, v14, v52, v54 bitop3:0x80
 v_and_b32 v14, 1, v14
 v_cmp_ne_u32 vcc, 1, v14
 s_cbranch_vccnz L_rt_255
 s_nop 2
 v_cvt_pk_bf16_f32 v60, v56, v57
 v_cvt_pk_bf16_f32 v61, v58, v59
 s_nop 0
 v_mov_b32_dpp v62, v60 quad_perm:[2,3,2,3] row_mask:0xf bank_mask:0xf
 v_mov_b32_dpp v63, v61 quad_perm:[2,3,2,3] row_mask:0xf bank_mask:0xf
 s_mov_b64 exec, s[30:31]
 buffer_store_dwordx4 v[60:63], v11, s[4:7], s57 offen sc1
 s_mov_b64 exec, 1
 buffer_store_dword v13, off, s[4:7], s17 sc1
 s_mov_b64 exec, s[30:31]
 buffer_store_dwordx4 v[32:35], v11, s[4:7], s59 offen sc1
 s_mov_b64 exec, -1
 s_barrier
 s_nop 15
 s_nop 15
 s_nop 15
 s_nop 15
 s_nop 15
 s_nop 15
 s_nop 15
 s_nop 7
L_rj_253:
 v_add_u32 v13, 1, v13
 s_add_u32 s53, s53, 1
.p2align 3
 s_mov_b32 s51, 0
 buffer_load_dwordx4 v[40:43], v2, s[4:7], s57 offen offset:0 sc1
 buffer_load_dwordx4 v[44:47], v2, s[4:7], s57 offen offset:128 sc1
 buffer_load_dwordx4 v[48:51], v2, s[4:7], s57 offen offset:1024 sc1
 buffer_load_dwordx4 v[52:55], v2, s[4:7], s57 offen offset:1152 sc1
 buffer_load_dwordx4 v[56:59], v3, s[4:7], s57 offen offset:0 sc1
L_xm_256:
 s_waitcnt vmcnt(4)
 v_mfma_f32_16x16x32_bf16 v[60:63], v[24:27], v[40:43], 0
 s_waitcnt vmcnt(3)
 v_mfma_f32_16x16x32_bf16 v[64:67], v[24:27], v[44:47], 0
 s_waitcnt vmcnt(2)
 v_mfma_f32_16x16x32_bf16 v[68:71], v[24:27], v[48:51], 0
 v_max3_u32 v14, v40, v44, v48
 v_cvt_pk_bf16_f32 v60, v60, v61
 v_cvt_pk_bf16_f32 v61, v62, v63
 ds_write_b64 v4, v[60:61] offset:0
 s_waitcnt vmcnt(1)
 v_mfma_f32_16x16x32_bf16 v[72:75], v[24:27], v[52:55], 0
 v_cvt_pk_bf16_f32 v64, v64, v65
 v_cvt_pk_bf16_f32 v65, v66, v67
 ds_write_b64 v4, v[64:65] offset:8
 s_waitcnt vmcnt(0)
 v_mfma_f32_16x16x32_bf16 v[76:79], v[24:27], v[56:59], 0
 v_max3_u32 v14, v14, v52, v56
 v_cmp_eq_u32 vcc, -1, v14
 v_cvt_pk_bf16_f32 v68, v68, v69
 v_cvt_pk_bf16_f32 v69, v70, v71
 ds_write_b64 v4, v[68:69] offset:1024
 s_cbranch_vccnz L_rt_257
 v_cvt_pk_bf16_f32 v72, v72, v73
 v_cvt_pk_bf16_f32 v73, v74, v75
 ds_write_b64 v4, v[72:73] offset:1032
 s_nop 0
 v_cvt_pk_bf16_f32 v76, v76, v77
 v_cvt_pk_bf16_f32 v77, v78, v79
 ds_write_b64 v5, v[76:77] offset:0
 s_waitcnt lgkmcnt(0)
 s_barrier
L_ch_b1s1:
 ds_read_b128 v[72:75], v0 offset:0
 ds_read_b128 v[76:79], v0 offset:32
 ds_read_b128 v[80:83], v0 offset:1024
 s_waitcnt lgkmcnt(2)
 v_smfmac_f32_16x16x64_bf16 v[88:91], v[72:75], v[224:231], v17
 ds_read_b128 v[84:87], v0 offset:1056
 v_smfmac_f32_16x16x64_bf16 v[92:95], v[72:75], v[232:239], v17
 ds_read_b128 v[96:99], v0 offset:2048
 s_waitcnt lgkmcnt(3)
 v_smfmac_f32_16x16x64_bf16 v[88:91], v[76:79], v[240:247], v17
 ds_read_b128 v[100:103], v0 offset:2080
 v_smfmac_f32_16x16x64_bf16 v[92:95], v[76:79], v[248:255], v17
 ds_read_b128 v[112:115], v0 offset:3072
 s_waitcnt lgkmcnt(4)
 v_smfmac_f32_16x16x64_bf16 v[88:91], v[80:83], v[192:199], v17
 ds_read_b128 v[40:43], v1 offset:10240
 v_smfmac_f32_16x16x64_bf16 v[92:95], v[80:83], v[200:207], v17
 ds_read_b128 v[116:119], v0 offset:3104
 s_waitcnt lgkmcnt(5)
 v_smfmac_f32_16x16x64_bf16 v[88:91], v[84:87], v[208:215], v17
 ds_read_b128 v[44:47], v1 offset:11264
 v_smfmac_f32_16x16x64_bf16 v[92:95], v[84:87], v[216:223], v17
 ds_read_b128 v[72:75], v0 offset:4096
 s_waitcnt lgkmcnt(6)
 v_smfmac_f32_16x16x64_bf16 v[88:91], v[96:99], a[0:7], v17
 ds_read_b128 v[48:51], v1 offset:12288
 v_smfmac_f32_16x16x64_bf16 v[92:95], v[96:99], a[8:15], v17
 ds_read_b128 v[76:79], v0 offset:4128
 s_waitcnt lgkmcnt(7)
 v_smfmac_f32_16x16x64_bf16 v[88:91], v[100:103], a[16:23], v17
 ds_read_b128 v[52:55], v1 offset:13312
 v_smfmac_f32_16x16x64_bf16 v[92:95], v[100:103], a[24:31], v17
 ds_read_b128 v[80:83], v0 offset:5120
 s_waitcnt lgkmcnt(8)
 v_smfmac_f32_16x16x64_bf16 v[88:91], v[112:115], a[32:39], v17
 ds_read_b128 v[56:59], v1 offset:14336
 v_smfmac_f32_16x16x64_bf16 v[92:95], v[112:115], a[40:47], v17
 ds_read_b128 v[84:87], v0 offset:5152
 s_waitcnt lgkmcnt(8)
 v_smfmac_f32_16x16x64_bf16 v[88:91], v[116:119], a[48:55], v17
 ds_read_b128 v[60:63], v1 offset:15360
 v_smfmac_f32_16x16x64_bf16 v[92:95], v[116:119], a[56:63], v17
 ds_read_b128 v[96:99], v0 offset:6144
 s_waitcnt lgkmcnt(8)
 v_smfmac_f32_16x16x64_bf16 v[88:91], v[72:75], a[64:71], v17
 ds_read_b128 v[64:67], v1 offset:16384
 v_smfmac_f32_16x16x64_bf16 v[92:95], v[72:75], a[72:79], v17
 ds_read_b128 v[100:103], v0 offset:6176
 s_waitcnt lgkmcnt(8)
 v_smfmac_f32_16x16x64_bf16 v[88:91], v[76:79], a[80:87], v17
 ds_read_b128 v[68:71], v1 offset:17408
 v_smfmac_f32_16x16x64_bf16 v[92:95], v[76:79], a[88:95], v17
 ds_read_b128 v[112:115], v0 offset:7168
 s_waitcnt lgkmcnt(8)
 v_smfmac_f32_16x16x64_bf16 v[88:91], v[80:83], a[96:103], v17
 ds_read_b128 v[104:107], v16 offset:18432
 v_smfmac_f32_16x16x64_bf16 v[92:95], v[80:83], a[104:111], v17
 ds_read_b128 v[116:119], v0 offset:7200
 s_waitcnt lgkmcnt(8)
 v_smfmac_f32_16x16x64_bf16 v[88:91], v[84:87], a[112:119], v17
 ds_read_b128 v[108:111], v16 offset:19456
 v_smfmac_f32_16x16x64_bf16 v[92:95], v[84:87], a[120:127], v17
 ds_read_b128 v[72:75], v0 offset:8192
 s_waitcnt lgkmcnt(8)
 v_smfmac_f32_16x16x64_bf16 v[88:91], v[96:99], a[128:135], v17
 ds_read_b128 v[224:227], v15 offset:8192
 v_smfmac_f32_16x16x64_bf16 v[92:95], v[96:99], a[136:143], v17
 ds_read_b128 v[76:79], v0 offset:8224
 s_waitcnt lgkmcnt(8)
 v_smfmac_f32_16x16x64_bf16 v[88:91], v[100:103], a[144:151], v17
 ds_read_b128 v[228:231], v15 offset:9216
 v_smfmac_f32_16x16x64_bf16 v[92:95], v[100:103], a[152:159], v17
 ds_read_b128 v[80:83], v0 offset:9216
 s_waitcnt lgkmcnt(8)
 v_smfmac_f32_16x16x64_bf16 v[88:91], v[112:115], a[160:167], v17
 ds_read_b128 v[232:235], v15 offset:10240
 v_smfmac_f32_16x16x64_bf16 v[92:95], v[112:115], a[168:175], v17
 ds_read_b128 v[84:87], v0 offset:9248
 s_waitcnt lgkmcnt(8)
 v_smfmac_f32_16x16x64_bf16 v[88:91], v[116:119], a[176:183], v17
 ds_read_b128 v[236:239], v15 offset:11264
 v_smfmac_f32_16x16x64_bf16 v[92:95], v[116:119], a[184:191], v17
 ds_read_b128 v[240:243], v15 offset:12288
 s_waitcnt lgkmcnt(8)
 v_smfmac_f32_16x16x64_bf16 v[88:91], v[72:75], a[192:199], v17
 ds_read_b128 v[244:247], v15 offset:13312
 v_smfmac_f32_16x16x64_bf16 v[92:95], v[72:75], a[200:207], v17
 ds_read_b128 v[248:251], v15 offset:14336
 s_waitcnt lgkmcnt(8)
 v_smfmac_f32_16x16x64_bf16 v[88:91], v[76:79], a[208:215], v17
 ds_read_b128 v[252:255], v15 offset:15360
 v_smfmac_f32_16x16x64_bf16 v[92:95], v[76:79], a[216:223], v17
 s_waitcnt lgkmcnt(7)
 v_smfmac_f32_16x16x64_bf16 v[88:91], v[80:83], a[224:231], v17
 v_smfmac_f32_16x16x64_bf16 v[92:95], v[80:83], a[232:239], v17
 s_waitcnt lgkmcnt(5)
 v_smfmac_f32_16x16x64_bf16 v[88:91], v[84:87], a[240:247], v17
 v_smfmac_f32_16x16x64_bf16 v[92:95], v[84:87], a[248:255], v17
 s_nop 2
 v_cvt_pk_bf16_f32 v120, v88, v89
 v_cvt_pk_bf16_f32 v121, v90, v91
 ds_write_b64 v6, v[120:121] offset:26624
 s_nop 1
 v_cvt_pk_bf16_f32 v122, v92, v93
 v_cvt_pk_bf16_f32 v123, v94, v95
 ds_write_b64 v6, v[122:123] offset:27136
 s_waitcnt lgkmcnt(0)
 s_barrier
 ds_read_b64_tr_b16 v[72:73], v7 offset:26624
 ds_read_b64_tr_b16 v[74:75], v7 offset:27136
 ds_read_b64_tr_b16 v[76:77], v7 offset:27648
 ds_read_b64_tr_b16 v[78:79], v7 offset:28160
 ds_read_b64_tr_b16 v[80:81], v7 offset:28672
 ds_read_b64_tr_b16 v[82:83], v7 offset:29184
 ds_read_b64_tr_b16 v[84:85], v7 offset:29696
 ds_read_b64_tr_b16 v[86:87], v7 offset:30208
 ds_read_b64_tr_b16 v[112:113], v8 offset:26624
 ds_read_b64_tr_b16 v[114:115], v8 offset:27136
 s_waitcnt lgkmcnt(8)
 v_mfma_f32_16x16x32_bf16 v[92:95], v[40:43], v[72:75], 0
 v_mfma_f32_16x16x32_bf16 v[96:99], v[56:59], v[72:75], 0
 v_mfma_f32_16x16x32_bf16 v[88:91], v[72:75], v[72:75], 0
 s_waitcnt lgkmcnt(6)
 v_mfma_f32_16x16x32_bf16 v[92:95], v[44:47], v[76:79], v[92:95]
 v_mfma_f32_16x16x32_bf16 v[96:99], v[60:63], v[76:79], v[96:99]
 v_mfma_f32_16x16x32_bf16 v[88:91], v[76:79], v[76:79], v[88:91]
 s_waitcnt lgkmcnt(4)
 v_mfma_f32_16x16x32_bf16 v[92:95], v[48:51], v[80:83], v[92:95]
 v_mfma_f32_16x16x32_bf16 v[96:99], v[64:67], v[80:83], v[96:99]
 v_mfma_f32_16x16x32_bf16 v[88:91], v[80:83], v[80:83], v[88:91]
 s_waitcnt lgkmcnt(0)
 buffer_store_dwordx4 v[112:115], v1, s[4:7], s61 offen sc1
 s_waitcnt lgkmcnt(2)
 v_mfma_f32_16x16x32_bf16 v[92:95], v[52:55], v[84:87], v[92:95]
 v_mfma_f32_16x16x32_bf16 v[96:99], v[68:71], v[84:87], v[96:99]
 v_mfma_f32_16x16x32_bf16 v[88:91], v[84:87], v[84:87], v[88:91]
 v_mfma_f32_32x32x8_bf16 v[40:55], v[18:19], v[18:19], 0
 v_max3_f32 v126, v92, v93, v94
 buffer_load_dwordx2 v[124:125], v1, s[4:7], s65 offen sc1
 ds_read_b128 v[80:83], v15 offset:16384
 ds_read_b128 v[84:87], v15 offset:17408
 v_max3_f32 v126, v126, v95, v96
 v_max3_f32 v126, v126, v97, v98
 v_max3_f32 v126, v126, v99, v90
 v_max_f32 v126, v126, v91
 v_mov_b32 v127, v126
 v_mov_b64 v[56:57], 0
 v_mov_b64 v[58:59], 0
 v_permlane16_swap_b32 v126, v127
 v_max_f32 v126, v126, v127
 v_mov_b32 v127, v126
 s_nop 1
 v_permlane32_swap_b32 v126, v127
 v_max_f32 v126, v126, v127
 v_mul_f32 v126, s79, v126
 v_fma_f32 v92, v92, s79, -v126
 v_fma_f32 v93, v93, s79, -v126
 v_fma_f32 v94, v94, s79, -v126
 v_fma_f32 v95, v95, s79, -v126
 v_fma_f32 v96, v96, s79, -v126
 v_fma_f32 v97, v97, s79, -v126
 v_fma_f32 v98, v98, s79, -v126
 v_fma_f32 v99, v99, s79, -v126
 v_exp_f32 v92, v92
 v_exp_f32 v93, v93
 v_exp_f32 v94, v94
 v_exp_f32 v95, v95
 v_exp_f32 v96, v96
 v_exp_f32 v97, v97
 v_exp_f32 v98, v98
 v_exp_f32 v99, v99
 v_fma_f32 v90, v90, s79, -v126
 v_cvt_pk_bf16_f32 v100, v92, v93
 v_cvt_pk_bf16_f32 v101, v94, v95
 v_cvt_pk_bf16_f32 v102, v96, v97
 v_cvt_pk_bf16_f32 v103, v98, v99
 v_fma_f32 v91, v91, s79, -v126
 v_exp_f32 v90, v90
 v_mfma_f32_16x16x32_bf16 v[120:123], v[28:31], v[100:103], 0
 v_exp_f32 v91, v91
 v_mfma_f32_16x16x32_bf16 v[112:115], v[104:107], v[100:103], 0
 v_cvt_pk_bf16_f32 v36, v90, v91
 v_cvt_pk_bf16_f32 v39, v90, v91
 v_mfma_f32_16x16x32_bf16 v[116:119], v[108:111], v[100:103], 0
 s_waitcnt vmcnt(0)
 v_mfma_f32_16x16x16_bf16 v[120:123], v[28:29], v[36:37], v[120:123]
L_pv_258:
 v_cmp_eq_u32 vcc, -1, v124
 s_cbranch_vccnz L_rt_259
 v_mfma_f32_16x16x16_bf16 v[112:115], v[124:125], v[36:37], v[112:115]
 v_mfma_f32_16x16x16_bf16 v[116:119], v[124:125], v[38:39], v[116:119]
 v_rcp_f32 v120, v120
 ds_read_b128 v[88:91], v15 offset:18432
 ds_read_b128 v[92:95], v15 offset:19456
 ds_read_b128 v[96:99], v15 offset:20480
 ds_read_b128 v[100:103], v15 offset:21504
 s_mov_b64 exec, s[28:29]
 v_pk_mul_f32 v[112:113], v[112:113], v[120:121] op_sel_hi:[1,0]
 v_pk_mul_f32 v[114:115], v[114:115], v[120:121] op_sel_hi:[1,0]
 v_cvt_pk_bf16_f32 v112, v112, v113
 v_cvt_pk_bf16_f32 v113, v114, v115
 v_pk_mul_f32 v[116:117], v[116:117], v[120:121] op_sel_hi:[1,0]
 v_pk_mul_f32 v[118:119], v[118:119], v[120:121] op_sel_hi:[1,0]
 v_cvt_pk_bf16_f32 v114, v116, v117
 v_cvt_pk_bf16_f32 v115, v118, v119
 ds_write_b128 v9, v[112:115] offset:30720
 s_mov_b64 exec, -1
 s_waitcnt lgkmcnt(0)
 s_barrier
 ds_read_b128 v[60:63], v0 offset:30720
 ds_read_b128 v[64:67], v0 offset:30752
 ds_read_b128 v[68:71], v0 offset:31744
 ds_read_b128 v[72:75], v0 offset:31776
 s_waitcnt lgkmcnt(3)
 v_smfmac_f32_16x16x64_bf16 v[40:43], v[60:63], v[224:231], v17
 ds_read_b128 v[224:227], v15 offset:22528
 v_smfmac_f32_16x16x64_bf16 v[44:47], v[60:63], v[232:239], v17
 ds_read_b128 v[228:231], v15 offset:23552
 s_waitcnt lgkmcnt(4)
 v_smfmac_f32_16x16x64_bf16 v[40:43], v[64:67], v[240:247], v17
 ds_read_b128 v[232:235], v15 offset:24576
 v_smfmac_f32_16x16x64_bf16 v[44:47], v[64:67], v[248:255], v17
 ds_read_b128 v[236:239], v15 offset:25600
 s_waitcnt lgkmcnt(5)
 v_smfmac_f32_16x16x64_bf16 v[40:43], v[68:71], v[80:87], v17
 ds_read_b128 v[240:243], v15 offset:26624
 v_smfmac_f32_16x16x64_bf16 v[44:47], v[68:71], v[128:135], v17
 ds_read_b128 v[244:247], v15 offset:27648
 s_waitcnt lgkmcnt(6)
 v_smfmac_f32_16x16x64_bf16 v[40:43], v[72:75], v[136:143], v17
 ds_read_b128 v[248:251], v15 offset:28672
 v_smfmac_f32_16x16x64_bf16 v[44:47], v[72:75], v[144:151], v17
 ds_read_b128 v[252:255], v15 offset:29696
 v_smfmac_f32_16x16x64_bf16 v[48:51], v[60:63], v[152:159], v17
 ds_read_b128 v[80:83], v15 offset:30720
 v_cvt_pk_bf16_f32 v116, v40, v41
 v_cvt_pk_bf16_f32 v117, v42, v43
 v_or_b32 v116, 1, v116
 v_smfmac_f32_16x16x64_bf16 v[52:55], v[60:63], v[160:167], v17
 ds_read_b128 v[84:87], v15 offset:31744
 v_cvt_pk_bf16_f32 v118, v44, v45
 v_cvt_pk_bf16_f32 v119, v46, v47
 v_or_b32 v118, 1, v118
 buffer_store_dwordx4 v[116:119], v10, s[4:7], s71 offen sc1
 v_smfmac_f32_16x16x64_bf16 v[48:51], v[64:67], v[168:175], v17
 v_smfmac_f32_16x16x64_bf16 v[52:55], v[64:67], v[176:183], v17
 v_smfmac_f32_16x16x64_bf16 v[48:51], v[68:71], v[184:191], v17
 v_smfmac_f32_16x16x64_bf16 v[52:55], v[68:71], v[88:95], v17
 v_smfmac_f32_16x16x64_bf16 v[48:51], v[72:75], v[96:103], v17
 s_waitcnt lgkmcnt(8)
 v_smfmac_f32_16x16x64_bf16 v[52:55], v[72:75], v[224:231], v17
 s_waitcnt lgkmcnt(6)
 v_smfmac_f32_16x16x64_bf16 v[56:59], v[60:63], v[232:239], v17
 v_cvt_pk_bf16_f32 v120, v48, v49
 v_cvt_pk_bf16_f32 v121, v50, v51
 v_or_b32 v120, 1, v120
 s_waitcnt lgkmcnt(4)
 v_smfmac_f32_16x16x64_bf16 v[56:59], v[64:67], v[240:247], v17
 v_cvt_pk_bf16_f32 v122, v52, v53
 v_cvt_pk_bf16_f32 v123, v54, v55
 v_or_b32 v122, 1, v122
 buffer_store_dwordx4 v[120:123], v10, s[4:7], s72 offen sc1
 s_waitcnt lgkmcnt(2)
 v_smfmac_f32_16x16x64_bf16 v[56:59], v[68:71], v[248:255], v17
 s_waitcnt lgkmcnt(0)
 v_smfmac_f32_16x16x64_bf16 v[56:59], v[72:75], v[80:87], v17
 s_nop 7
 v_cvt_pk_bf16_f32 v124, v56, v57
 v_cvt_pk_bf16_f32 v125, v58, v59
 v_or_b32 v124, 1, v124
 buffer_store_dwordx2 v[124:125], v10, s[4:7], s73 offen sc1
 ds_read_b128 v[224:227], v15 offset:0
 ds_read_b128 v[228:231], v15 offset:1024
 ds_read_b128 v[232:235], v15 offset:2048
 ds_read_b128 v[236:239], v15 offset:3072
 ds_read_b128 v[240:243], v15 offset:4096
 ds_read_b128 v[244:247], v15 offset:5120
 ds_read_b128 v[248:251], v15 offset:6144
 ds_read_b128 v[252:255], v15 offset:7168
 v_mov_b64 v[88:89], 0
 v_mov_b64 v[90:91], 0
 v_mov_b64 v[92:93], 0
 v_mov_b64 v[94:95], 0
 s_cmp_eq_u32 s55, 0
 s_cbranch_scc1 L_nr_260
 s_nop 15
 s_nop 15
 s_nop 15
 s_nop 15
 s_nop 15
L_pp_262:
 buffer_load_dwordx4 v[40:43], v1, s[4:7], s75 offen offset:0 sc1
 buffer_load_dwordx4 v[44:47], v1, s[4:7], s75 offen offset:1024 sc1
 buffer_load_dwordx4 v[48:51], v1, s[4:7], s75 offen offset:2048 sc1
 buffer_load_dwordx4 v[52:55], v1, s[4:7], s75 offen offset:3072 sc1
 s_waitcnt vmcnt(3)
 v_mfma_f32_16x16x32_bf16 v[56:59], v[40:43], v[20:23], 0
 v_and_b32 v14, v40, v42
 s_waitcnt vmcnt(2)
 v_mfma_f32_16x16x32_bf16 v[56:59], v[44:47], v[20:23], v[56:59]
 v_bitop3_b32 v14, v14, v44, v46 bitop3:0x80
 s_waitcnt vmcnt(1)
 v_mfma_f32_16x16x32_bf16 v[56:59], v[48:51], v[20:23], v[56:59]
 v_bitop3_b32 v14, v14, v48, v50 bitop3:0x80
 s_waitcnt vmcnt(0)
 v_mfma_f32_16x16x32_bf16 v[56:59], v[52:55], v[20:23], v[56:59]
 v_bitop3_b32 v14, v14, v52, v54 bitop3:0x80
 v_and_b32 v14, 1, v14
 v_cmp_ne_u32 vcc, 1, v14
 s_cbranch_vccnz L_rt_263
 s_nop 2
 v_cvt_pk_bf16_f32 v60, v56, v57
 v_cvt_pk_bf16_f32 v61, v58, v59
 s_nop 0
 v_mov_b32_dpp v62, v60 quad_perm:[2,3,2,3] row_mask:0xf bank_mask:0xf
 v_mov_b32_dpp v63, v61 quad_perm:[2,3,2,3] row_mask:0xf bank_mask:0xf
 s_mov_b64 exec, s[30:31]
 buffer_store_dwordx4 v[60:63], v11, s[4:7], s58 offen sc1
 s_mov_b64 exec, 1
 buffer_store_dword v13, off, s[4:7], s17 sc1
 s_mov_b64 exec, s[30:31]
 buffer_store_dwordx4 v[32:35], v11, s[4:7], s56 offen sc1
 s_mov_b64 exec, -1
 s_barrier
 s_nop 15
 s_nop 15
 s_nop 15
 s_nop 15
 s_nop 15
 s_nop 15
 s_nop 15
 s_nop 7
L_rj_261:
 v_add_u32 v13, 1, v13
 s_add_u32 s53, s53, 1
.p2align 3
 s_mov_b32 s51, 0
 buffer_load_dwordx4 v[40:43], v2, s[4:7], s58 offen offset:0 sc1
 buffer_load_dwordx4 v[44:47], v2, s[4:7], s58 offen offset:128 sc1
 buffer_load_dwordx4 v[48:51], v2, s[4:7], s58 offen offset:1024 sc1
 buffer_load_dwordx4 v[52:55], v2, s[4:7], s58 offen offset:1152 sc1
 buffer_load_dwordx4 v[56:59], v3, s[4:7], s58 offen offset:0 sc1
L_xm_264:
 s_waitcnt vmcnt(4)
 v_mfma_f32_16x16x32_bf16 v[60:63], v[24:27], v[40:43], 0
 s_waitcnt vmcnt(3)
 v_mfma_f32_16x16x32_bf16 v[64:67], v[24:27], v[44:47], 0
 s_waitcnt vmcnt(2)
 v_mfma_f32_16x16x32_bf16 v[68:71], v[24:27], v[48:51], 0
 v_max3_u32 v14, v40, v44, v48
 v_cvt_pk_bf16_f32 v60, v60, v61
 v_cvt_pk_bf16_f32 v61, v62, v63
 ds_write_b64 v4, v[60:61] offset:0
 s_waitcnt vmcnt(1)
 v_mfma_f32_16x16x32_bf16 v[72:75], v[24:27], v[52:55], 0
 v_cvt_pk_bf16_f32 v64, v64, v65
 v_cvt_pk_bf16_f32 v65, v66, v67
 ds_write_b64 v4, v[64:65] offset:8
 s_waitcnt vmcnt(0)
 v_mfma_f32_16x16x32_bf16 v[76:79], v[24:27], v[56:59], 0
 v_max3_u32 v14, v14, v52, v56
 v_cmp_eq_u32 vcc, -1, v14
 v_cvt_pk_bf16_f32 v68, v68, v69
 v_cvt_pk_bf16_f32 v69, v70, v71
 ds_write_b64 v4, v[68:69] offset:1024
 s_cbranch_vccnz L_rt_265
 v_cvt_pk_bf16_f32 v72, v72, v73
 v_cvt_pk_bf16_f32 v73, v74, v75
 ds_write_b64 v4, v[72:73] offset:1032
 s_nop 0
 v_cvt_pk_bf16_f32 v76, v76, v77
 v_cvt_pk_bf16_f32 v77, v78, v79
 ds_write_b64 v5, v[76:77] offset:0
 s_waitcnt lgkmcnt(0)
 s_barrier
L_ch_b1s2:
 ds_read_b128 v[72:75], v0 offset:0
 ds_read_b128 v[76:79], v0 offset:32
 ds_read_b128 v[80:83], v0 offset:1024
 s_waitcnt lgkmcnt(2)
 v_smfmac_f32_16x16x64_bf16 v[88:91], v[72:75], v[224:231], v17
 ds_read_b128 v[84:87], v0 offset:1056
 v_smfmac_f32_16x16x64_bf16 v[92:95], v[72:75], v[232:239], v17
 ds_read_b128 v[96:99], v0 offset:2048
 s_waitcnt lgkmcnt(3)
 v_smfmac_f32_16x16x64_bf16 v[88:91], v[76:79], v[240:247], v17
 ds_read_b128 v[100:103], v0 offset:2080
 v_smfmac_f32_16x16x64_bf16 v[92:95], v[76:79], v[248:255], v17
 ds_read_b128 v[112:115], v0 offset:3072
 s_waitcnt lgkmcnt(4)
 v_smfmac_f32_16x16x64_bf16 v[88:91], v[80:83], v[192:199], v17
 ds_read_b128 v[40:43], v1 offset:10240
 v_smfmac_f32_16x16x64_bf16 v[92:95], v[80:83], v[200:207], v17
 ds_read_b128 v[116:119], v0 offset:3104
 s_waitcnt lgkmcnt(5)
 v_smfmac_f32_16x16x64_bf16 v[88:91], v[84:87], v[208:215], v17
 ds_read_b128 v[44:47], v1 offset:11264
 v_smfmac_f32_16x16x64_bf16 v[92:95], v[84:87], v[216:223], v17
 ds_read_b128 v[72:75], v0 offset:4096
 s_waitcnt lgkmcnt(6)
 v_smfmac_f32_16x16x64_bf16 v[88:91], v[96:99], a[0:7], v17
 ds_read_b128 v[48:51], v1 offset:12288
 v_smfmac_f32_16x16x64_bf16 v[92:95], v[96:99], a[8:15], v17
 ds_read_b128 v[76:79], v0 offset:4128
 s_waitcnt lgkmcnt(7)
 v_smfmac_f32_16x16x64_bf16 v[88:91], v[100:103], a[16:23], v17
 ds_read_b128 v[52:55], v1 offset:13312
 v_smfmac_f32_16x16x64_bf16 v[92:95], v[100:103], a[24:31], v17
 ds_read_b128 v[80:83], v0 offset:5120
 s_waitcnt lgkmcnt(8)
 v_smfmac_f32_16x16x64_bf16 v[88:91], v[112:115], a[32:39], v17
 ds_read_b128 v[56:59], v1 offset:14336
 v_smfmac_f32_16x16x64_bf16 v[92:95], v[112:115], a[40:47], v17
 ds_read_b128 v[84:87], v0 offset:5152
 s_waitcnt lgkmcnt(8)
 v_smfmac_f32_16x16x64_bf16 v[88:91], v[116:119], a[48:55], v17
 ds_read_b128 v[60:63], v1 offset:15360
 v_smfmac_f32_16x16x64_bf16 v[92:95], v[116:119], a[56:63], v17
 ds_read_b128 v[96:99], v0 offset:6144
 s_waitcnt lgkmcnt(8)
 v_smfmac_f32_16x16x64_bf16 v[88:91], v[72:75], a[64:71], v17
 ds_read_b128 v[64:67], v1 offset:16384
 v_smfmac_f32_16x16x64_bf16 v[92:95], v[72:75], a[72:79], v17
 ds_read_b128 v[100:103], v0 offset:6176
 s_waitcnt lgkmcnt(8)
 v_smfmac_f32_16x16x64_bf16 v[88:91], v[76:79], a[80:87], v17
 ds_read_b128 v[68:71], v1 offset:17408
 v_smfmac_f32_16x16x64_bf16 v[92:95], v[76:79], a[88:95], v17
 ds_read_b128 v[112:115], v0 offset:7168
 s_waitcnt lgkmcnt(8)
 v_smfmac_f32_16x16x64_bf16 v[88:91], v[80:83], a[96:103], v17
 ds_read_b128 v[104:107], v16 offset:18432
 v_smfmac_f32_16x16x64_bf16 v[92:95], v[80:83], a[104:111], v17
 ds_read_b128 v[116:119], v0 offset:7200
 s_waitcnt lgkmcnt(8)
 v_smfmac_f32_16x16x64_bf16 v[88:91], v[84:87], a[112:119], v17
 ds_read_b128 v[108:111], v16 offset:19456
 v_smfmac_f32_16x16x64_bf16 v[92:95], v[84:87], a[120:127], v17
 ds_read_b128 v[72:75], v0 offset:8192
 s_waitcnt lgkmcnt(8)
 v_smfmac_f32_16x16x64_bf16 v[88:91], v[96:99], a[128:135], v17
 ds_read_b128 v[224:227], v15 offset:8192
 v_smfmac_f32_16x16x64_bf16 v[92:95], v[96:99], a[136:143], v17
 ds_read_b128 v[76:79], v0 offset:8224
 s_waitcnt lgkmcnt(8)
 v_smfmac_f32_16x16x64_bf16 v[88:91], v[100:103], a[144:151], v17
 ds_read_b128 v[228:231], v15 offset:9216
 v_smfmac_f32_16x16x64_bf16 v[92:95], v[100:103], a[152:159], v17
 ds_read_b128 v[80:83], v0 offset:9216
 s_waitcnt lgkmcnt(8)
 v_smfmac_f32_16x16x64_bf16 v[88:91], v[112:115], a[160:167], v17
 ds_read_b128 v[232:235], v15 offset:10240
 v_smfmac_f32_16x16x64_bf16 v[92:95], v[112:115], a[168:175], v17
 ds_read_b128 v[84:87], v0 offset:9248
 s_waitcnt lgkmcnt(8)
 v_smfmac_f32_16x16x64_bf16 v[88:91], v[116:119], a[176:183], v17
 ds_read_b128 v[236:239], v15 offset:11264
 v_smfmac_f32_16x16x64_bf16 v[92:95], v[116:119], a[184:191], v17
 ds_read_b128 v[240:243], v15 offset:12288
 s_waitcnt lgkmcnt(8)
 v_smfmac_f32_16x16x64_bf16 v[88:91], v[72:75], a[192:199], v17
 ds_read_b128 v[244:247], v15 offset:13312
 v_smfmac_f32_16x16x64_bf16 v[92:95], v[72:75], a[200:207], v17
 ds_read_b128 v[248:251], v15 offset:14336
 s_waitcnt lgkmcnt(8)
 v_smfmac_f32_16x16x64_bf16 v[88:91], v[76:79], a[208:215], v17
 ds_read_b128 v[252:255], v15 offset:15360
 v_smfmac_f32_16x16x64_bf16 v[92:95], v[76:79], a[216:223], v17
 s_waitcnt lgkmcnt(7)
 v_smfmac_f32_16x16x64_bf16 v[88:91], v[80:83], a[224:231], v17
 v_smfmac_f32_16x16x64_bf16 v[92:95], v[80:83], a[232:239], v17
 s_waitcnt lgkmcnt(5)
 v_smfmac_f32_16x16x64_bf16 v[88:91], v[84:87], a[240:247], v17
 v_smfmac_f32_16x16x64_bf16 v[92:95], v[84:87], a[248:255], v17
 s_nop 2
 v_cvt_pk_bf16_f32 v120, v88, v89
 v_cvt_pk_bf16_f32 v121, v90, v91
 ds_write_b64 v6, v[120:121] offset:26624
 s_nop 1
 v_cvt_pk_bf16_f32 v122, v92, v93
 v_cvt_pk_bf16_f32 v123, v94, v95
 ds_write_b64 v6, v[122:123] offset:27136
 s_waitcnt lgkmcnt(0)
 s_barrier
 ds_read_b64_tr_b16 v[72:73], v7 offset:26624
 ds_read_b64_tr_b16 v[74:75], v7 offset:27136
 ds_read_b64_tr_b16 v[76:77], v7 offset:27648
 ds_read_b64_tr_b16 v[78:79], v7 offset:28160
 ds_read_b64_tr_b16 v[80:81], v7 offset:28672
 ds_read_b64_tr_b16 v[82:83], v7 offset:29184
 ds_read_b64_tr_b16 v[84:85], v7 offset:29696
 ds_read_b64_tr_b16 v[86:87], v7 offset:30208
 ds_read_b64_tr_b16 v[112:113], v8 offset:26624
 ds_read_b64_tr_b16 v[114:115], v8 offset:27136
 s_waitcnt lgkmcnt(8)
 v_mfma_f32_16x16x32_bf16 v[92:95], v[40:43], v[72:75], 0
 v_mfma_f32_16x16x32_bf16 v[96:99], v[56:59], v[72:75], 0
 v_mfma_f32_16x16x32_bf16 v[88:91], v[72:75], v[72:75], 0
 s_waitcnt lgkmcnt(6)
 v_mfma_f32_16x16x32_bf16 v[92:95], v[44:47], v[76:79], v[92:95]
 v_mfma_f32_16x16x32_bf16 v[96:99], v[60:63], v[76:79], v[96:99]
 v_mfma_f32_16x16x32_bf16 v[88:91], v[76:79], v[76:79], v[88:91]
 s_waitcnt lgkmcnt(4)
 v_mfma_f32_16x16x32_bf16 v[92:95], v[48:51], v[80:83], v[92:95]
 v_mfma_f32_16x16x32_bf16 v[96:99], v[64:67], v[80:83], v[96:99]
 v_mfma_f32_16x16x32_bf16 v[88:91], v[80:83], v[80:83], v[88:91]
 s_waitcnt lgkmcnt(0)
 buffer_store_dwordx4 v[112:115], v1, s[4:7], s62 offen sc1
 s_waitcnt lgkmcnt(2)
 v_mfma_f32_16x16x32_bf16 v[92:95], v[52:55], v[84:87], v[92:95]
 v_mfma_f32_16x16x32_bf16 v[96:99], v[68:71], v[84:87], v[96:99]
 v_mfma_f32_16x16x32_bf16 v[88:91], v[84:87], v[84:87], v[88:91]
 v_mfma_f32_32x32x8_bf16 v[40:55], v[18:19], v[18:19], 0
 v_max3_f32 v126, v92, v93, v94
 buffer_load_dwordx2 v[124:125], v1, s[4:7], s66 offen sc1
 ds_read_b128 v[80:83], v15 offset:16384
 ds_read_b128 v[84:87], v15 offset:17408
 v_max3_f32 v126, v126, v95, v96
 v_max3_f32 v126, v126, v97, v98
 v_max3_f32 v126, v126, v99, v90
 v_max_f32 v126, v126, v91
 v_mov_b32 v127, v126
 v_mov_b64 v[56:57], 0
 v_mov_b64 v[58:59], 0
 v_permlane16_swap_b32 v126, v127
 v_max_f32 v126, v126, v127
 v_mov_b32 v127, v126
 s_nop 1
 v_permlane32_swap_b32 v126, v127
 v_max_f32 v126, v126, v127
 v_mul_f32 v126, s79, v126
 v_fma_f32 v92, v92, s79, -v126
 v_fma_f32 v93, v93, s79, -v126
 v_fma_f32 v94, v94, s79, -v126
 v_fma_f32 v95, v95, s79, -v126
 v_fma_f32 v96, v96, s79, -v126
 v_fma_f32 v97, v97, s79, -v126
 v_fma_f32 v98, v98, s79, -v126
 v_fma_f32 v99, v99, s79, -v126
 v_exp_f32 v92, v92
 v_exp_f32 v93, v93
 v_exp_f32 v94, v94
 v_exp_f32 v95, v95
 v_exp_f32 v96, v96
 v_exp_f32 v97, v97
 v_exp_f32 v98, v98
 v_exp_f32 v99, v99
 v_fma_f32 v90, v90, s79, -v126
 v_cvt_pk_bf16_f32 v100, v92, v93
 v_cvt_pk_bf16_f32 v101, v94, v95
 v_cvt_pk_bf16_f32 v102, v96, v97
 v_cvt_pk_bf16_f32 v103, v98, v99
 v_fma_f32 v91, v91, s79, -v126
 v_exp_f32 v90, v90
 v_mfma_f32_16x16x32_bf16 v[120:123], v[28:31], v[100:103], 0
 v_exp_f32 v91, v91
 v_mfma_f32_16x16x32_bf16 v[112:115], v[104:107], v[100:103], 0
 v_cvt_pk_bf16_f32 v36, v90, v91
 v_cvt_pk_bf16_f32 v39, v90, v91
 v_mfma_f32_16x16x32_bf16 v[116:119], v[108:111], v[100:103], 0
 s_waitcnt vmcnt(0)
 v_mfma_f32_16x16x16_bf16 v[120:123], v[28:29], v[36:37], v[120:123]
L_pv_266:
 v_cmp_eq_u32 vcc, -1, v124
 s_cbranch_vccnz L_rt_267
 v_mfma_f32_16x16x16_bf16 v[112:115], v[124:125], v[36:37], v[112:115]
 v_mfma_f32_16x16x16_bf16 v[116:119], v[124:125], v[38:39], v[116:119]
 v_rcp_f32 v120, v120
 ds_read_b128 v[88:91], v15 offset:18432
 ds_read_b128 v[92:95], v15 offset:19456
 ds_read_b128 v[96:99], v15 offset:20480
 ds_read_b128 v[100:103], v15 offset:21504
 s_mov_b64 exec, s[28:29]
 v_pk_mul_f32 v[112:113], v[112:113], v[120:121] op_sel_hi:[1,0]
 v_pk_mul_f32 v[114:115], v[114:115], v[120:121] op_sel_hi:[1,0]
 v_cvt_pk_bf16_f32 v112, v112, v113
 v_cvt_pk_bf16_f32 v113, v114, v115
 v_pk_mul_f32 v[116:117], v[116:117], v[120:121] op_sel_hi:[1,0]
 v_pk_mul_f32 v[118:119], v[118:119], v[120:121] op_sel_hi:[1,0]
 v_cvt_pk_bf16_f32 v114, v116, v117
 v_cvt_pk_bf16_f32 v115, v118, v119
 ds_write_b128 v9, v[112:115] offset:30720
 s_mov_b64 exec, -1
 s_waitcnt lgkmcnt(0)
 s_barrier
 ds_read_b128 v[60:63], v0 offset:30720
 ds_read_b128 v[64:67], v0 offset:30752
 ds_read_b128 v[68:71], v0 offset:31744
 ds_read_b128 v[72:75], v0 offset:31776
 s_waitcnt lgkmcnt(3)
 v_smfmac_f32_16x16x64_bf16 v[40:43], v[60:63], v[224:231], v17
 ds_read_b128 v[224:227], v15 offset:22528
 v_smfmac_f32_16x16x64_bf16 v[44:47], v[60:63], v[232:239], v17
 ds_read_b128 v[228:231], v15 offset:23552
 s_waitcnt lgkmcnt(4)
 v_smfmac_f32_16x16x64_bf16 v[40:43], v[64:67], v[240:247], v17
 ds_read_b128 v[232:235], v15 offset:24576
 v_smfmac_f32_16x16x64_bf16 v[44:47], v[64:67], v[248:255], v17
 ds_read_b128 v[236:239], v15 offset:25600
 s_waitcnt lgkmcnt(5)
 v_smfmac_f32_16x16x64_bf16 v[40:43], v[68:71], v[80:87], v17
 ds_read_b128 v[240:243], v15 offset:26624
 v_smfmac_f32_16x16x64_bf16 v[44:47], v[68:71], v[128:135], v17
 ds_read_b128 v[244:247], v15 offset:27648
 s_waitcnt lgkmcnt(6)
 v_smfmac_f32_16x16x64_bf16 v[40:43], v[72:75], v[136:143], v17
 ds_read_b128 v[248:251], v15 offset:28672
 v_smfmac_f32_16x16x64_bf16 v[44:47], v[72:75], v[144:151], v17
 ds_read_b128 v[252:255], v15 offset:29696
 v_smfmac_f32_16x16x64_bf16 v[48:51], v[60:63], v[152:159], v17
 ds_read_b128 v[80:83], v15 offset:30720
 v_cvt_pk_bf16_f32 v116, v40, v41
 v_cvt_pk_bf16_f32 v117, v42, v43
 v_and_b32 v116, -2, v116
 v_smfmac_f32_16x16x64_bf16 v[52:55], v[60:63], v[160:167], v17
 ds_read_b128 v[84:87], v15 offset:31744
 v_cvt_pk_bf16_f32 v118, v44, v45
 v_cvt_pk_bf16_f32 v119, v46, v47
 v_and_b32 v118, -2, v118
 buffer_store_dwordx4 v[116:119], v10, s[4:7], s68 offen sc1
 v_smfmac_f32_16x16x64_bf16 v[48:51], v[64:67], v[168:175], v17
 v_smfmac_f32_16x16x64_bf16 v[52:55], v[64:67], v[176:183], v17
 v_smfmac_f32_16x16x64_bf16 v[48:51], v[68:71], v[184:191], v17
 v_smfmac_f32_16x16x64_bf16 v[52:55], v[68:71], v[88:95], v17
 v_smfmac_f32_16x16x64_bf16 v[48:51], v[72:75], v[96:103], v17
 s_waitcnt lgkmcnt(8)
 v_smfmac_f32_16x16x64_bf16 v[52:55], v[72:75], v[224:231], v17
 s_waitcnt lgkmcnt(6)
 v_smfmac_f32_16x16x64_bf16 v[56:59], v[60:63], v[232:239], v17
 v_cvt_pk_bf16_f32 v120, v48, v49
 v_cvt_pk_bf16_f32 v121, v50, v51
 v_and_b32 v120, -2, v120
 s_waitcnt lgkmcnt(4)
 v_smfmac_f32_16x16x64_bf16 v[56:59], v[64:67], v[240:247], v17
 v_cvt_pk_bf16_f32 v122, v52, v53
 v_cvt_pk_bf16_f32 v123, v54, v55
 v_and_b32 v122, -2, v122
 buffer_store_dwordx4 v[120:123], v10, s[4:7], s69 offen sc1
 s_waitcnt lgkmcnt(2)
 v_smfmac_f32_16x16x64_bf16 v[56:59], v[68:71], v[248:255], v17
 s_waitcnt lgkmcnt(0)
 v_smfmac_f32_16x16x64_bf16 v[56:59], v[72:75], v[80:87], v17
 s_nop 7
 v_cvt_pk_bf16_f32 v124, v56, v57
 v_cvt_pk_bf16_f32 v125, v58, v59
 v_and_b32 v124, -2, v124
 buffer_store_dwordx2 v[124:125], v10, s[4:7], s70 offen sc1
 ds_read_b128 v[224:227], v15 offset:0
 ds_read_b128 v[228:231], v15 offset:1024
 ds_read_b128 v[232:235], v15 offset:2048
 ds_read_b128 v[236:239], v15 offset:3072
 ds_read_b128 v[240:243], v15 offset:4096
 ds_read_b128 v[244:247], v15 offset:5120
 ds_read_b128 v[248:251], v15 offset:6144
 ds_read_b128 v[252:255], v15 offset:7168
 v_mov_b64 v[88:89], 0
 v_mov_b64 v[90:91], 0
 v_mov_b64 v[92:93], 0
 v_mov_b64 v[94:95], 0
 s_cmp_eq_u32 s55, 0
 s_cbranch_scc1 L_nr_268
 s_nop 15
 s_nop 15
 s_nop 15
 s_nop 15
 s_nop 15
L_pp_270:
 buffer_load_dwordx4 v[40:43], v1, s[4:7], s74 offen offset:0 sc1
 buffer_load_dwordx4 v[44:47], v1, s[4:7], s74 offen offset:1024 sc1
 buffer_load_dwordx4 v[48:51], v1, s[4:7], s74 offen offset:2048 sc1
 buffer_load_dwordx4 v[52:55], v1, s[4:7], s74 offen offset:3072 sc1
 s_waitcnt vmcnt(3)
 v_mfma_f32_16x16x32_bf16 v[56:59], v[40:43], v[20:23], 0
 v_or_b32 v14, v40, v42
 s_waitcnt vmcnt(2)
 v_mfma_f32_16x16x32_bf16 v[56:59], v[44:47], v[20:23], v[56:59]
 v_or3_b32 v14, v14, v44, v46
 s_waitcnt vmcnt(1)
 v_mfma_f32_16x16x32_bf16 v[56:59], v[48:51], v[20:23], v[56:59]
 v_or3_b32 v14, v14, v48, v50
 s_waitcnt vmcnt(0)
 v_mfma_f32_16x16x32_bf16 v[56:59], v[52:55], v[20:23], v[56:59]
 v_or3_b32 v14, v14, v52, v54
 v_and_b32 v14, 1, v14
 v_cmp_ne_u32 vcc, 0, v14
 s_cbranch_vccnz L_rt_271
 s_nop 2
 v_cvt_pk_bf16_f32 v60, v56, v57
 v_cvt_pk_bf16_f32 v61, v58, v59
 s_nop 0
 v_mov_b32_dpp v62, v60 quad_perm:[2,3,2,3] row_mask:0xf bank_mask:0xf
 v_mov_b32_dpp v63, v61 quad_perm:[2,3,2,3] row_mask:0xf bank_mask:0xf
 s_mov_b64 exec, s[30:31]
 buffer_store_dwordx4 v[60:63], v11, s[4:7], s59 offen sc1
 s_mov_b64 exec, 1
 buffer_store_dword v13, off, s[4:7], s17 sc1
 s_mov_b64 exec, s[30:31]
 buffer_store_dwordx4 v[32:35], v11, s[4:7], s57 offen sc1
 s_mov_b64 exec, -1
 s_barrier
 s_nop 15
 s_nop 15
 s_nop 15
 s_nop 15
 s_nop 15
 s_nop 15
 s_nop 15
 s_nop 7
L_rj_269:
 v_add_u32 v13, 1, v13
 s_add_u32 s53, s53, 1
.p2align 3
 s_mov_b32 s51, 0
 buffer_load_dwordx4 v[40:43], v2, s[4:7], s59 offen offset:0 sc1
 buffer_load_dwordx4 v[44:47], v2, s[4:7], s59 offen offset:128 sc1
 buffer_load_dwordx4 v[48:51], v2, s[4:7], s59 offen offset:1024 sc1
 buffer_load_dwordx4 v[52:55], v2, s[4:7], s59 offen offset:1152 sc1
 buffer_load_dwordx4 v[56:59], v3, s[4:7], s59 offen offset:0 sc1
L_xm_272:
 s_waitcnt vmcnt(4)
 v_mfma_f32_16x16x32_bf16 v[60:63], v[24:27], v[40:43], 0
 s_waitcnt vmcnt(3)
 v_mfma_f32_16x16x32_bf16 v[64:67], v[24:27], v[44:47], 0
 s_waitcnt vmcnt(2)
 v_mfma_f32_16x16x32_bf16 v[68:71], v[24:27], v[48:51], 0
 v_max3_u32 v14, v40, v44, v48
 v_cvt_pk_bf16_f32 v60, v60, v61
 v_cvt_pk_bf16_f32 v61, v62, v63
 ds_write_b64 v4, v[60:61] offset:0
 s_waitcnt vmcnt(1)
 v_mfma_f32_16x16x32_bf16 v[72:75], v[24:27], v[52:55], 0
 v_cvt_pk_bf16_f32 v64, v64, v65
 v_cvt_pk_bf16_f32 v65, v66, v67
 ds_write_b64 v4, v[64:65] offset:8
 s_waitcnt vmcnt(0)
 v_mfma_f32_16x16x32_bf16 v[76:79], v[24:27], v[56:59], 0
 v_max3_u32 v14, v14, v52, v56
 v_cmp_eq_u32 vcc, -1, v14
 v_cvt_pk_bf16_f32 v68, v68, v69
 v_cvt_pk_bf16_f32 v69, v70, v71
 ds_write_b64 v4, v[68:69] offset:1024
 s_cbranch_vccnz L_rt_273
 v_cvt_pk_bf16_f32 v72, v72, v73
 v_cvt_pk_bf16_f32 v73, v74, v75
 ds_write_b64 v4, v[72:73] offset:1032
 s_nop 0
 v_cvt_pk_bf16_f32 v76, v76, v77
 v_cvt_pk_bf16_f32 v77, v78, v79
 ds_write_b64 v5, v[76:77] offset:0
 s_waitcnt lgkmcnt(0)
 s_barrier
L_ch_b1s3:
 ds_read_b128 v[72:75], v0 offset:0
 ds_read_b128 v[76:79], v0 offset:32
 ds_read_b128 v[80:83], v0 offset:1024
 s_waitcnt lgkmcnt(2)
 v_smfmac_f32_16x16x64_bf16 v[88:91], v[72:75], v[224:231], v17
 ds_read_b128 v[84:87], v0 offset:1056
 v_smfmac_f32_16x16x64_bf16 v[92:95], v[72:75], v[232:239], v17
 ds_read_b128 v[96:99], v0 offset:2048
 s_waitcnt lgkmcnt(3)
 v_smfmac_f32_16x16x64_bf16 v[88:91], v[76:79], v[240:247], v17
 ds_read_b128 v[100:103], v0 offset:2080
 v_smfmac_f32_16x16x64_bf16 v[92:95], v[76:79], v[248:255], v17
 ds_read_b128 v[112:115], v0 offset:3072
 s_waitcnt lgkmcnt(4)
 v_smfmac_f32_16x16x64_bf16 v[88:91], v[80:83], v[192:199], v17
 ds_read_b128 v[40:43], v1 offset:10240
 v_smfmac_f32_16x16x64_bf16 v[92:95], v[80:83], v[200:207], v17
 ds_read_b128 v[116:119], v0 offset:3104
 s_waitcnt lgkmcnt(5)
 v_smfmac_f32_16x16x64_bf16 v[88:91], v[84:87], v[208:215], v17
 ds_read_b128 v[44:47], v1 offset:11264
 v_smfmac_f32_16x16x64_bf16 v[92:95], v[84:87], v[216:223], v17
 ds_read_b128 v[72:75], v0 offset:4096
 s_waitcnt lgkmcnt(6)
 v_smfmac_f32_16x16x64_bf16 v[88:91], v[96:99], a[0:7], v17
 ds_read_b128 v[48:51], v1 offset:12288
 v_smfmac_f32_16x16x64_bf16 v[92:95], v[96:99], a[8:15], v17
 ds_read_b128 v[76:79], v0 offset:4128
 s_waitcnt lgkmcnt(7)
 v_smfmac_f32_16x16x64_bf16 v[88:91], v[100:103], a[16:23], v17
 ds_read_b128 v[52:55], v1 offset:13312
 v_smfmac_f32_16x16x64_bf16 v[92:95], v[100:103], a[24:31], v17
 ds_read_b128 v[80:83], v0 offset:5120
 s_waitcnt lgkmcnt(8)
 v_smfmac_f32_16x16x64_bf16 v[88:91], v[112:115], a[32:39], v17
 ds_read_b128 v[56:59], v1 offset:14336
 v_smfmac_f32_16x16x64_bf16 v[92:95], v[112:115], a[40:47], v17
 ds_read_b128 v[84:87], v0 offset:5152
 s_waitcnt lgkmcnt(8)
 v_smfmac_f32_16x16x64_bf16 v[88:91], v[116:119], a[48:55], v17
 ds_read_b128 v[60:63], v1 offset:15360
 v_smfmac_f32_16x16x64_bf16 v[92:95], v[116:119], a[56:63], v17
 ds_read_b128 v[96:99], v0 offset:6144
 s_waitcnt lgkmcnt(8)
 v_smfmac_f32_16x16x64_bf16 v[88:91], v[72:75], a[64:71], v17
 ds_read_b128 v[64:67], v1 offset:16384
 v_smfmac_f32_16x16x64_bf16 v[92:95], v[72:75], a[72:79], v17
 ds_read_b128 v[100:103], v0 offset:6176
 s_waitcnt lgkmcnt(8)
 v_smfmac_f32_16x16x64_bf16 v[88:91], v[76:79], a[80:87], v17
 ds_read_b128 v[68:71], v1 offset:17408
 v_smfmac_f32_16x16x64_bf16 v[92:95], v[76:79], a[88:95], v17
 ds_read_b128 v[112:115], v0 offset:7168
 s_waitcnt lgkmcnt(8)
 v_smfmac_f32_16x16x64_bf16 v[88:91], v[80:83], a[96:103], v17
 ds_read_b128 v[104:107], v16 offset:18432
 v_smfmac_f32_16x16x64_bf16 v[92:95], v[80:83], a[104:111], v17
 ds_read_b128 v[116:119], v0 offset:7200
 s_waitcnt lgkmcnt(8)
 v_smfmac_f32_16x16x64_bf16 v[88:91], v[84:87], a[112:119], v17
 ds_read_b128 v[108:111], v16 offset:19456
 v_smfmac_f32_16x16x64_bf16 v[92:95], v[84:87], a[120:127], v17
 ds_read_b128 v[72:75], v0 offset:8192
 s_waitcnt lgkmcnt(8)
 v_smfmac_f32_16x16x64_bf16 v[88:91], v[96:99], a[128:135], v17
 ds_read_b128 v[224:227], v15 offset:8192
 v_smfmac_f32_16x16x64_bf16 v[92:95], v[96:99], a[136:143], v17
 ds_read_b128 v[76:79], v0 offset:8224
 s_waitcnt lgkmcnt(8)
 v_smfmac_f32_16x16x64_bf16 v[88:91], v[100:103], a[144:151], v17
 ds_read_b128 v[228:231], v15 offset:9216
 v_smfmac_f32_16x16x64_bf16 v[92:95], v[100:103], a[152:159], v17
 ds_read_b128 v[80:83], v0 offset:9216
 s_waitcnt lgkmcnt(8)
 v_smfmac_f32_16x16x64_bf16 v[88:91], v[112:115], a[160:167], v17
 ds_read_b128 v[232:235], v15 offset:10240
 v_smfmac_f32_16x16x64_bf16 v[92:95], v[112:115], a[168:175], v17
 ds_read_b128 v[84:87], v0 offset:9248
 s_waitcnt lgkmcnt(8)
 v_smfmac_f32_16x16x64_bf16 v[88:91], v[116:119], a[176:183], v17
 ds_read_b128 v[236:239], v15 offset:11264
 v_smfmac_f32_16x16x64_bf16 v[92:95], v[116:119], a[184:191], v17
 ds_read_b128 v[240:243], v15 offset:12288
 s_waitcnt lgkmcnt(8)
 v_smfmac_f32_16x16x64_bf16 v[88:91], v[72:75], a[192:199], v17
 ds_read_b128 v[244:247], v15 offset:13312
 v_smfmac_f32_16x16x64_bf16 v[92:95], v[72:75], a[200:207], v17
 ds_read_b128 v[248:251], v15 offset:14336
 s_waitcnt lgkmcnt(8)
 v_smfmac_f32_16x16x64_bf16 v[88:91], v[76:79], a[208:215], v17
 ds_read_b128 v[252:255], v15 offset:15360
 v_smfmac_f32_16x16x64_bf16 v[92:95], v[76:79], a[216:223], v17
 s_waitcnt lgkmcnt(7)
 v_smfmac_f32_16x16x64_bf16 v[88:91], v[80:83], a[224:231], v17
 v_smfmac_f32_16x16x64_bf16 v[92:95], v[80:83], a[232:239], v17
 s_waitcnt lgkmcnt(5)
 v_smfmac_f32_16x16x64_bf16 v[88:91], v[84:87], a[240:247], v17
 v_smfmac_f32_16x16x64_bf16 v[92:95], v[84:87], a[248:255], v17
 s_nop 2
 v_cvt_pk_bf16_f32 v120, v88, v89
 v_cvt_pk_bf16_f32 v121, v90, v91
 ds_write_b64 v6, v[120:121] offset:26624
 s_nop 1
 v_cvt_pk_bf16_f32 v122, v92, v93
 v_cvt_pk_bf16_f32 v123, v94, v95
 ds_write_b64 v6, v[122:123] offset:27136
 s_waitcnt lgkmcnt(0)
 s_barrier
 ds_read_b64_tr_b16 v[72:73], v7 offset:26624
 ds_read_b64_tr_b16 v[74:75], v7 offset:27136
 ds_read_b64_tr_b16 v[76:77], v7 offset:27648
 ds_read_b64_tr_b16 v[78:79], v7 offset:28160
 ds_read_b64_tr_b16 v[80:81], v7 offset:28672
 ds_read_b64_tr_b16 v[82:83], v7 offset:29184
 ds_read_b64_tr_b16 v[84:85], v7 offset:29696
 ds_read_b64_tr_b16 v[86:87], v7 offset:30208
 ds_read_b64_tr_b16 v[112:113], v8 offset:26624
 ds_read_b64_tr_b16 v[114:115], v8 offset:27136
 s_waitcnt lgkmcnt(8)
 v_mfma_f32_16x16x32_bf16 v[92:95], v[40:43], v[72:75], 0
 v_mfma_f32_16x16x32_bf16 v[96:99], v[56:59], v[72:75], 0
 v_mfma_f32_16x16x32_bf16 v[88:91], v[72:75], v[72:75], 0
 s_waitcnt lgkmcnt(6)
 v_mfma_f32_16x16x32_bf16 v[92:95], v[44:47], v[76:79], v[92:95]
 v_mfma_f32_16x16x32_bf16 v[96:99], v[60:63], v[76:79], v[96:99]
 v_mfma_f32_16x16x32_bf16 v[88:91], v[76:79], v[76:79], v[88:91]
 s_waitcnt lgkmcnt(4)
 v_mfma_f32_16x16x32_bf16 v[92:95], v[48:51], v[80:83], v[92:95]
 v_mfma_f32_16x16x32_bf16 v[96:99], v[64:67], v[80:83], v[96:99]
 v_mfma_f32_16x16x32_bf16 v[88:91], v[80:83], v[80:83], v[88:91]
 s_waitcnt lgkmcnt(0)
 buffer_store_dwordx4 v[112:115], v1, s[4:7], s63 offen sc1
 s_waitcnt lgkmcnt(2)
 v_mfma_f32_16x16x32_bf16 v[92:95], v[52:55], v[84:87], v[92:95]
 v_mfma_f32_16x16x32_bf16 v[96:99], v[68:71], v[84:87], v[96:99]
 v_mfma_f32_16x16x32_bf16 v[88:91], v[84:87], v[84:87], v[88:91]
 s_cmp_eq_u32 s53, 63
 s_cbranch_scc1 L_ch_last
 v_mfma_f32_32x32x8_bf16 v[40:55], v[18:19], v[18:19], 0
 v_max3_f32 v126, v92, v93, v94
 buffer_load_dwordx2 v[124:125], v1, s[4:7], s67 offen sc1
 ds_read_b128 v[80:83], v15 offset:16384
 ds_read_b128 v[84:87], v15 offset:17408
 v_max3_f32 v126, v126, v95, v96
 v_max3_f32 v126, v126, v97, v98
 v_max3_f32 v126, v126, v99, v90
 v_max_f32 v126, v126, v91
 v_mov_b32 v127, v126
 v_mov_b64 v[56:57], 0
 v_mov_b64 v[58:59], 0
 v_permlane16_swap_b32 v126, v127
 v_max_f32 v126, v126, v127
 v_mov_b32 v127, v126
 s_nop 1
 v_permlane32_swap_b32 v126, v127
 v_max_f32 v126, v126, v127
 v_mul_f32 v126, s79, v126
 v_fma_f32 v92, v92, s79, -v126
 v_fma_f32 v93, v93, s79, -v126
 v_fma_f32 v94, v94, s79, -v126
 v_fma_f32 v95, v95, s79, -v126
 v_fma_f32 v96, v96, s79, -v126
 v_fma_f32 v97, v97, s79, -v126
 v_fma_f32 v98, v98, s79, -v126
 v_fma_f32 v99, v99, s79, -v126
 v_exp_f32 v92, v92
 v_exp_f32 v93, v93
 v_exp_f32 v94, v94
 v_exp_f32 v95, v95
 v_exp_f32 v96, v96
 v_exp_f32 v97, v97
 v_exp_f32 v98, v98
 v_exp_f32 v99, v99
 v_fma_f32 v90, v90, s79, -v126
 v_cvt_pk_bf16_f32 v100, v92, v93
 v_cvt_pk_bf16_f32 v101, v94, v95
 v_cvt_pk_bf16_f32 v102, v96, v97
 v_cvt_pk_bf16_f32 v103, v98, v99
 v_fma_f32 v91, v91, s79, -v126
 v_exp_f32 v90, v90
 v_mfma_f32_16x16x32_bf16 v[120:123], v[28:31], v[100:103], 0
 v_exp_f32 v91, v91
 v_mfma_f32_16x16x32_bf16 v[112:115], v[104:107], v[100:103], 0
 v_cvt_pk_bf16_f32 v36, v90, v91
 v_cvt_pk_bf16_f32 v39, v90, v91
 v_mfma_f32_16x16x32_bf16 v[116:119], v[108:111], v[100:103], 0
 s_waitcnt vmcnt(0)
 v_mfma_f32_16x16x16_bf16 v[120:123], v[28:29], v[36:37], v[120:123]
L_pv_274:
 v_cmp_eq_u32 vcc, -1, v124
 s_cbranch_vccnz L_rt_275
 v_mfma_f32_16x16x16_bf16 v[112:115], v[124:125], v[36:37], v[112:115]
 v_mfma_f32_16x16x16_bf16 v[116:119], v[124:125], v[38:39], v[116:119]
 v_rcp_f32 v120, v120
 ds_read_b128 v[88:91], v15 offset:18432
 ds_read_b128 v[92:95], v15 offset:19456
 ds_read_b128 v[96:99], v15 offset:20480
 ds_read_b128 v[100:103], v15 offset:21504
 s_mov_b64 exec, s[28:29]
 v_pk_mul_f32 v[112:113], v[112:113], v[120:121] op_sel_hi:[1,0]
 v_pk_mul_f32 v[114:115], v[114:115], v[120:121] op_sel_hi:[1,0]
 v_cvt_pk_bf16_f32 v112, v112, v113
 v_cvt_pk_bf16_f32 v113, v114, v115
 v_pk_mul_f32 v[116:117], v[116:117], v[120:121] op_sel_hi:[1,0]
 v_pk_mul_f32 v[118:119], v[118:119], v[120:121] op_sel_hi:[1,0]
 v_cvt_pk_bf16_f32 v114, v116, v117
 v_cvt_pk_bf16_f32 v115, v118, v119
 ds_write_b128 v9, v[112:115] offset:30720
 s_mov_b64 exec, -1
 s_waitcnt lgkmcnt(0)
 s_barrier
 ds_read_b128 v[60:63], v0 offset:30720
 ds_read_b128 v[64:67], v0 offset:30752
 ds_read_b128 v[68:71], v0 offset:31744
 ds_read_b128 v[72:75], v0 offset:31776
 s_waitcnt lgkmcnt(3)
 v_smfmac_f32_16x16x64_bf16 v[40:43], v[60:63], v[224:231], v17
 ds_read_b128 v[224:227], v15 offset:22528
 v_smfmac_f32_16x16x64_bf16 v[44:47], v[60:63], v[232:239], v17
 ds_read_b128 v[228:231], v15 offset:23552
 s_waitcnt lgkmcnt(4)
 v_smfmac_f32_16x16x64_bf16 v[40:43], v[64:67], v[240:247], v17
 ds_read_b128 v[232:235], v15 offset:24576
 v_smfmac_f32_16x16x64_bf16 v[44:47], v[64:67], v[248:255], v17
 ds_read_b128 v[236:239], v15 offset:25600
 s_waitcnt lgkmcnt(5)
 v_smfmac_f32_16x16x64_bf16 v[40:43], v[68:71], v[80:87], v17
 ds_read_b128 v[240:243], v15 offset:26624
 v_smfmac_f32_16x16x64_bf16 v[44:47], v[68:71], v[128:135], v17
 ds_read_b128 v[244:247], v15 offset:27648
 s_waitcnt lgkmcnt(6)
 v_smfmac_f32_16x16x64_bf16 v[40:43], v[72:75], v[136:143], v17
 ds_read_b128 v[248:251], v15 offset:28672
 v_smfmac_f32_16x16x64_bf16 v[44:47], v[72:75], v[144:151], v17
 ds_read_b128 v[252:255], v15 offset:29696
 v_smfmac_f32_16x16x64_bf16 v[48:51], v[60:63], v[152:159], v17
 ds_read_b128 v[80:83], v15 offset:30720
 v_cvt_pk_bf16_f32 v116, v40, v41
 v_cvt_pk_bf16_f32 v117, v42, v43
 v_and_b32 v116, -2, v116
 v_smfmac_f32_16x16x64_bf16 v[52:55], v[60:63], v[160:167], v17
 ds_read_b128 v[84:87], v15 offset:31744
 v_cvt_pk_bf16_f32 v118, v44, v45
 v_cvt_pk_bf16_f32 v119, v46, v47
 v_and_b32 v118, -2, v118
 buffer_store_dwordx4 v[116:119], v10, s[4:7], s71 offen sc1
 v_smfmac_f32_16x16x64_bf16 v[48:51], v[64:67], v[168:175], v17
 v_smfmac_f32_16x16x64_bf16 v[52:55], v[64:67], v[176:183], v17
 v_smfmac_f32_16x16x64_bf16 v[48:51], v[68:71], v[184:191], v17
 v_smfmac_f32_16x16x64_bf16 v[52:55], v[68:71], v[88:95], v17
 v_smfmac_f32_16x16x64_bf16 v[48:51], v[72:75], v[96:103], v17
 s_waitcnt lgkmcnt(8)
 v_smfmac_f32_16x16x64_bf16 v[52:55], v[72:75], v[224:231], v17
 s_waitcnt lgkmcnt(6)
 v_smfmac_f32_16x16x64_bf16 v[56:59], v[60:63], v[232:239], v17
 v_cvt_pk_bf16_f32 v120, v48, v49
 v_cvt_pk_bf16_f32 v121, v50, v51
 v_and_b32 v120, -2, v120
 s_waitcnt lgkmcnt(4)
 v_smfmac_f32_16x16x64_bf16 v[56:59], v[64:67], v[240:247], v17
 v_cvt_pk_bf16_f32 v122, v52, v53
 v_cvt_pk_bf16_f32 v123, v54, v55
 v_and_b32 v122, -2, v122
 buffer_store_dwordx4 v[120:123], v10, s[4:7], s72 offen sc1
 s_waitcnt lgkmcnt(2)
 v_smfmac_f32_16x16x64_bf16 v[56:59], v[68:71], v[248:255], v17
 s_waitcnt lgkmcnt(0)
 v_smfmac_f32_16x16x64_bf16 v[56:59], v[72:75], v[80:87], v17
 s_nop 7
 v_cvt_pk_bf16_f32 v124, v56, v57
 v_cvt_pk_bf16_f32 v125, v58, v59
 v_and_b32 v124, -2, v124
 buffer_store_dwordx2 v[124:125], v10, s[4:7], s73 offen sc1
 ds_read_b128 v[224:227], v15 offset:0
 ds_read_b128 v[228:231], v15 offset:1024
 ds_read_b128 v[232:235], v15 offset:2048
 ds_read_b128 v[236:239], v15 offset:3072
 ds_read_b128 v[240:243], v15 offset:4096
 ds_read_b128 v[244:247], v15 offset:5120
 ds_read_b128 v[248:251], v15 offset:6144
 ds_read_b128 v[252:255], v15 offset:7168
 v_mov_b64 v[88:89], 0
 v_mov_b64 v[90:91], 0
 v_mov_b64 v[92:93], 0
 v_mov_b64 v[94:95], 0
 s_cmp_eq_u32 s55, 0
 s_cbranch_scc1 L_nr_276
 s_nop 15
 s_nop 15
 s_nop 15
 s_nop 15
 s_nop 15
L_pp_278:
 buffer_load_dwordx4 v[40:43], v1, s[4:7], s75 offen offset:0 sc1
 buffer_load_dwordx4 v[44:47], v1, s[4:7], s75 offen offset:1024 sc1
 buffer_load_dwordx4 v[48:51], v1, s[4:7], s75 offen offset:2048 sc1
 buffer_load_dwordx4 v[52:55], v1, s[4:7], s75 offen offset:3072 sc1
 s_waitcnt vmcnt(3)
 v_mfma_f32_16x16x32_bf16 v[56:59], v[40:43], v[20:23], 0
 v_or_b32 v14, v40, v42
 s_waitcnt vmcnt(2)
 v_mfma_f32_16x16x32_bf16 v[56:59], v[44:47], v[20:23], v[56:59]
 v_or3_b32 v14, v14, v44, v46
 s_waitcnt vmcnt(1)
 v_mfma_f32_16x16x32_bf16 v[56:59], v[48:51], v[20:23], v[56:59]
 v_or3_b32 v14, v14, v48, v50
 s_waitcnt vmcnt(0)
 v_mfma_f32_16x16x32_bf16 v[56:59], v[52:55], v[20:23], v[56:59]
 v_or3_b32 v14, v14, v52, v54
 v_and_b32 v14, 1, v14
 v_cmp_ne_u32 vcc, 0, v14
 s_cbranch_vccnz L_rt_279
 s_nop 2
 v_cvt_pk_bf16_f32 v60, v56, v57
 v_cvt_pk_bf16_f32 v61, v58, v59
 s_nop 0
 v_mov_b32_dpp v62, v60 quad_perm:[2,3,2,3] row_mask:0xf bank_mask:0xf
 v_mov_b32_dpp v63, v61 quad_perm:[2,3,2,3] row_mask:0xf bank_mask:0xf
 s_mov_b64 exec, s[30:31]
 buffer_store_dwordx4 v[60:63], v11, s[4:7], s56 offen sc1
 s_mov_b64 exec, 1
 buffer_store_dword v13, off, s[4:7], s17 sc1
 s_mov_b64 exec, s[30:31]
 buffer_store_dwordx4 v[32:35], v11, s[4:7], s58 offen sc1
 s_mov_b64 exec, -1
 s_barrier
 s_nop 15
 s_nop 15
 s_nop 15
 s_nop 15
 s_nop 15
 s_nop 15
 s_nop 15
 s_nop 7
L_rj_277:
 v_add_u32 v13, 1, v13
 s_add_u32 s53, s53, 1
 s_branch L_ch_loops
L_rt_249:
 s_nop 7
 buffer_load_dwordx4 v[40:43], v2, s[4:7], s56 offen offset:0 sc1
 buffer_load_dwordx4 v[44:47], v2, s[4:7], s56 offen offset:128 sc1
 buffer_load_dwordx4 v[48:51], v2, s[4:7], s56 offen offset:1024 sc1
 buffer_load_dwordx4 v[52:55], v2, s[4:7], s56 offen offset:1152 sc1
 buffer_load_dwordx4 v[56:59], v3, s[4:7], s56 offen offset:0 sc1
 s_add_u32 s51, s51, 1
 s_cmp_lt_u32 s51, 131072
 s_cbranch_scc1 L_xm_248
 s_branch L_bail
L_rt_251:
 buffer_load_dwordx2 v[124:125], v1, s[4:7], s64 offen sc1
 s_waitcnt vmcnt(0)
 s_add_u32 s51, s51, 1
 s_cmp_lt_u32 s51, 131072
 s_cbranch_scc1 L_pv_250
 s_branch L_bail
L_rt_255:
 s_add_u32 s51, s51, 1
 s_cmp_lt_u32 s51, 131072
 s_cbranch_scc1 L_pp_254
 s_branch L_bail
L_nr_252:
 s_cmp_lg_u32 s50, 0
 s_cbranch_scc1 L_id_280
 buffer_store_dwordx4 v[32:35], v1, s[4:7], s62 offen offset:0 sc1
 buffer_store_dwordx4 v[32:35], v1, s[4:7], s62 offen offset:1024 sc1
 buffer_store_dwordx4 v[32:35], v1, s[4:7], s62 offen offset:2048 sc1
 buffer_store_dwordx4 v[32:35], v1, s[4:7], s62 offen offset:3072 sc1
 buffer_load_dword v14, off, s[4:7], s32 sc1
 s_waitcnt vmcnt(0)
 s_barrier
 s_add_u32 s76, s53, 1
L_fl_281:
 v_cmp_ge_u32 vcc, s76, v14
 s_cbranch_vccz L_fld_282
 buffer_load_dword v14, off, s[4:7], s32 sc1
 s_waitcnt vmcnt(0)
 s_add_u32 s51, s51, 1
 s_cmp_lt_u32 s51, 131072
 s_cbranch_scc1 L_fl_281
 s_branch L_bail
L_fld_282:
 s_lshl_b32 s16, s76, 19
 s_add_u32 s16, s16, s54
 s_mov_b32 m0, 10240
 s_nop 0
 buffer_load_dwordx4 v1, s[4:7], s16 offen offset:0 sc1 lds
 buffer_load_dwordx4 v1, s[4:7], s16 offen offset:1024 sc1 lds
 buffer_load_dwordx4 v1, s[4:7], s16 offen offset:2048 sc1 lds
 buffer_load_dwordx4 v1, s[4:7], s16 offen offset:3072 sc1 lds
 s_mov_b32 m0, 14336
 s_nop 0
 buffer_load_dwordx4 v12, s[4:7], s16 offen offset:0 sc1 lds
 buffer_load_dwordx4 v12, s[4:7], s16 offen offset:1024 sc1 lds
 buffer_load_dwordx4 v12, s[4:7], s16 offen offset:2048 sc1 lds
 buffer_load_dwordx4 v12, s[4:7], s16 offen offset:3072 sc1 lds
 s_add_u32 s16, s16, 67108864
 s_mov_b32 m0, 18432
 s_nop 0
 buffer_load_dwordx4 v1, s[4:7], s16 offen offset:0 sc1 lds
 buffer_load_dwordx4 v1, s[4:7], s16 offen offset:1024 sc1 lds
 buffer_load_dwordx4 v1, s[4:7], s16 offen offset:2048 sc1 lds
 buffer_load_dwordx4 v1, s[4:7], s16 offen offset:3072 sc1 lds
 s_mov_b32 m0, 22528
 s_nop 0
 buffer_load_dwordx4 v12, s[4:7], s16 offen offset:0 sc1 lds
 buffer_load_dwordx4 v12, s[4:7], s16 offen offset:1024 sc1 lds
 buffer_load_dwordx4 v12, s[4:7], s16 offen offset:2048 sc1 lds
 buffer_load_dwordx4 v12, s[4:7], s16 offen offset:3072 sc1 lds
 s_nop 15
 s_nop 15
 s_nop 15
 s_branch L_rj_253
L_id_280:
 s_barrier
 s_nop 15
 s_nop 15
 s_nop 15
 s_nop 15
 s_nop 15
 s_nop 15
 s_nop 15
 s_nop 7
 s_branch L_rj_253
L_rt_257:
 s_nop 7
 buffer_load_dwordx4 v[40:43], v2, s[4:7], s57 offen offset:0 sc1
 buffer_load_dwordx4 v[44:47], v2, s[4:7], s57 offen offset:128 sc1
 buffer_load_dwordx4 v[48:51], v2, s[4:7], s57 offen offset:1024 sc1
 buffer_load_dwordx4 v[52:55], v2, s[4:7], s57 offen offset:1152 sc1
 buffer_load_dwordx4 v[56:59], v3, s[4:7], s57 offen offset:0 sc1
 s_add_u32 s51, s51, 1
 s_cmp_lt_u32 s51, 131072
 s_cbranch_scc1 L_xm_256
 s_branch L_bail
L_rt_259:
 buffer_load_dwordx2 v[124:125], v1, s[4:7], s65 offen sc1
 s_waitcnt vmcnt(0)
 s_add_u32 s51, s51, 1
 s_cmp_lt_u32 s51, 131072
 s_cbranch_scc1 L_pv_258
 s_branch L_bail
L_rt_263:
 s_add_u32 s51, s51, 1
 s_cmp_lt_u32 s51, 131072
 s_cbranch_scc1 L_pp_262
 s_branch L_bail
L_nr_260:
 s_cmp_lg_u32 s50, 0
 s_cbranch_scc1 L_id_283
 buffer_store_dwordx4 v[32:35], v1, s[4:7], s63 offen offset:0 sc1
 buffer_store_dwordx4 v[32:35], v1, s[4:7], s63 offen offset:1024 sc1
 buffer_store_dwordx4 v[32:35], v1, s[4:7], s63 offen offset:2048 sc1
 buffer_store_dwordx4 v[32:35], v1, s[4:7], s63 offen offset:3072 sc1
 buffer_load_dword v14, off, s[4:7], s32 sc1
 s_waitcnt vmcnt(0)
 s_barrier
 s_add_u32 s76, s53, 1
L_fl_284:
 v_cmp_ge_u32 vcc, s76, v14
 s_cbranch_vccz L_fld_285
 buffer_load_dword v14, off, s[4:7], s32 sc1
 s_waitcnt vmcnt(0)
 s_add_u32 s51, s51, 1
 s_cmp_lt_u32 s51, 131072
 s_cbranch_scc1 L_fl_284
 s_branch L_bail
L_fld_285:
 s_lshl_b32 s16, s76, 19
 s_add_u32 s16, s16, s54
 s_mov_b32 m0, 10240
 s_nop 0
 buffer_load_dwordx4 v1, s[4:7], s16 offen offset:0 sc1 lds
 buffer_load_dwordx4 v1, s[4:7], s16 offen offset:1024 sc1 lds
 buffer_load_dwordx4 v1, s[4:7], s16 offen offset:2048 sc1 lds
 buffer_load_dwordx4 v1, s[4:7], s16 offen offset:3072 sc1 lds
 s_mov_b32 m0, 14336
 s_nop 0
 buffer_load_dwordx4 v12, s[4:7], s16 offen offset:0 sc1 lds
 buffer_load_dwordx4 v12, s[4:7], s16 offen offset:1024 sc1 lds
 buffer_load_dwordx4 v12, s[4:7], s16 offen offset:2048 sc1 lds
 buffer_load_dwordx4 v12, s[4:7], s16 offen offset:3072 sc1 lds
 s_add_u32 s16, s16, 67108864
 s_mov_b32 m0, 18432
 s_nop 0
 buffer_load_dwordx4 v1, s[4:7], s16 offen offset:0 sc1 lds
 buffer_load_dwordx4 v1, s[4:7], s16 offen offset:1024 sc1 lds
 buffer_load_dwordx4 v1, s[4:7], s16 offen offset:2048 sc1 lds
 buffer_load_dwordx4 v1, s[4:7], s16 offen offset:3072 sc1 lds
 s_mov_b32 m0, 22528
 s_nop 0
 buffer_load_dwordx4 v12, s[4:7], s16 offen offset:0 sc1 lds
 buffer_load_dwordx4 v12, s[4:7], s16 offen offset:1024 sc1 lds
 buffer_load_dwordx4 v12, s[4:7], s16 offen offset:2048 sc1 lds
 buffer_load_dwordx4 v12, s[4:7], s16 offen offset:3072 sc1 lds
 s_nop 15
 s_nop 15
 s_nop 15
 s_branch L_rj_261
L_id_283:
 s_barrier
 s_nop 15
 s_nop 15
 s_nop 15
 s_nop 15
 s_nop 15
 s_nop 15
 s_nop 15
 s_nop 7
 s_branch L_rj_261
L_rt_265:
 s_nop 7
 buffer_load_dwordx4 v[40:43], v2, s[4:7], s58 offen offset:0 sc1
 buffer_load_dwordx4 v[44:47], v2, s[4:7], s58 offen offset:128 sc1
 buffer_load_dwordx4 v[48:51], v2, s[4:7], s58 offen offset:1024 sc1
 buffer_load_dwordx4 v[52:55], v2, s[4:7], s58 offen offset:1152 sc1
 buffer_load_dwordx4 v[56:59], v3, s[4:7], s58 offen offset:0 sc1
 s_add_u32 s51, s51, 1
 s_cmp_lt_u32 s51, 131072
 s_cbranch_scc1 L_xm_264
 s_branch L_bail
L_rt_267:
 buffer_load_dwordx2 v[124:125], v1, s[4:7], s66 offen sc1
 s_waitcnt vmcnt(0)
 s_add_u32 s51, s51, 1
 s_cmp_lt_u32 s51, 131072
 s_cbranch_scc1 L_pv_266
 s_branch L_bail
L_rt_271:
 s_add_u32 s51, s51, 1
 s_cmp_lt_u32 s51, 131072
 s_cbranch_scc1 L_pp_270
 s_branch L_bail
L_nr_268:
 s_cmp_lg_u32 s50, 0
 s_cbranch_scc1 L_id_286
 buffer_store_dwordx4 v[32:35], v1, s[4:7], s60 offen offset:0 sc1
 buffer_store_dwordx4 v[32:35], v1, s[4:7], s60 offen offset:1024 sc1
 buffer_store_dwordx4 v[32:35], v1, s[4:7], s60 offen offset:2048 sc1
 buffer_store_dwordx4 v[32:35], v1, s[4:7], s60 offen offset:3072 sc1
 buffer_load_dword v14, off, s[4:7], s32 sc1
 s_waitcnt vmcnt(0)
 s_barrier
 s_add_u32 s76, s53, 1
L_fl_287:
 v_cmp_ge_u32 vcc, s76, v14
 s_cbranch_vccz L_fld_288
 buffer_load_dword v14, off, s[4:7], s32 sc1
 s_waitcnt vmcnt(0)
 s_add_u32 s51, s51, 1
 s_cmp_lt_u32 s51, 131072
 s_cbranch_scc1 L_fl_287
 s_branch L_bail
L_fld_288:
 s_lshl_b32 s16, s76, 19
 s_add_u32 s16, s16, s54
 s_mov_b32 m0, 10240
 s_nop 0
 buffer_load_dwordx4 v1, s[4:7], s16 offen offset:0 sc1 lds
 buffer_load_dwordx4 v1, s[4:7], s16 offen offset:1024 sc1 lds
 buffer_load_dwordx4 v1, s[4:7], s16 offen offset:2048 sc1 lds
 buffer_load_dwordx4 v1, s[4:7], s16 offen offset:3072 sc1 lds
 s_mov_b32 m0, 14336
 s_nop 0
 buffer_load_dwordx4 v12, s[4:7], s16 offen offset:0 sc1 lds
 buffer_load_dwordx4 v12, s[4:7], s16 offen offset:1024 sc1 lds
 buffer_load_dwordx4 v12, s[4:7], s16 offen offset:2048 sc1 lds
 buffer_load_dwordx4 v12, s[4:7], s16 offen offset:3072 sc1 lds
 s_add_u32 s16, s16, 67108864
 s_mov_b32 m0, 18432
 s_nop 0
 buffer_load_dwordx4 v1, s[4:7], s16 offen offset:0 sc1 lds
 buffer_load_dwordx4 v1, s[4:7], s16 offen offset:1024 sc1 lds
 buffer_load_dwordx4 v1, s[4:7], s16 offen offset:2048 sc1 lds
 buffer_load_dwordx4 v1, s[4:7], s16 offen offset:3072 sc1 lds
 s_mov_b32 m0, 22528
 s_nop 0
 buffer_load_dwordx4 v12, s[4:7], s16 offen offset:0 sc1 lds
 buffer_load_dwordx4 v12, s[4:7], s16 offen offset:1024 sc1 lds
 buffer_load_dwordx4 v12, s[4:7], s16 offen offset:2048 sc1 lds
 buffer_load_dwordx4 v12, s[4:7], s16 offen offset:3072 sc1 lds
 s_nop 15
 s_nop 15
 s_nop 15
 s_branch L_rj_269
L_id_286:
 s_barrier
 s_nop 15
 s_nop 15
 s_nop 15
 s_nop 15
 s_nop 15
 s_nop 15
 s_nop 15
 s_nop 7
 s_branch L_rj_269
L_rt_273:
 s_nop 7
 buffer_load_dwordx4 v[40:43], v2, s[4:7], s59 offen offset:0 sc1
 buffer_load_dwordx4 v[44:47], v2, s[4:7], s59 offen offset:128 sc1
 buffer_load_dwordx4 v[48:51], v2, s[4:7], s59 offen offset:1024 sc1
 buffer_load_dwordx4 v[52:55], v2, s[4:7], s59 offen offset:1152 sc1
 buffer_load_dwordx4 v[56:59], v3, s[4:7], s59 offen offset:0 sc1
 s_add_u32 s51, s51, 1
 s_cmp_lt_u32 s51, 131072
 s_cbranch_scc1 L_xm_272
 s_branch L_bail
L_rt_275:
 buffer_load_dwordx2 v[124:125], v1, s[4:7], s67 offen sc1
 s_waitcnt vmcnt(0)
 s_add_u32 s51, s51, 1
 s_cmp_lt_u32 s51, 131072
 s_cbranch_scc1 L_pv_274
 s_branch L_bail
L_rt_279:
 s_add_u32 s51, s51, 1
 s_cmp_lt_u32 s51, 131072
 s_cbranch_scc1 L_pp_278
 s_branch L_bail
L_nr_276:
 s_cmp_lg_u32 s50, 0
 s_cbranch_scc1 L_id_289
 buffer_store_dwordx4 v[32:35], v1, s[4:7], s61 offen offset:0 sc1
 buffer_store_dwordx4 v[32:35], v1, s[4:7], s61 offen offset:1024 sc1
 buffer_store_dwordx4 v[32:35], v1, s[4:7], s61 offen offset:2048 sc1
 buffer_store_dwordx4 v[32:35], v1, s[4:7], s61 offen offset:3072 sc1
 buffer_load_dword v14, off, s[4:7], s32 sc1
 s_waitcnt vmcnt(0)
 s_barrier
 s_add_u32 s76, s53, 1
L_fl_290:
 v_cmp_ge_u32 vcc, s76, v14
 s_cbranch_vccz L_fld_291
 buffer_load_dword v14, off, s[4:7], s32 sc1
 s_waitcnt vmcnt(0)
 s_add_u32 s51, s51, 1
 s_cmp_lt_u32 s51, 131072
 s_cbranch_scc1 L_fl_290
 s_branch L_bail
L_fld_291:
 s_lshl_b32 s16, s76, 19
 s_add_u32 s16, s16, s54
 s_mov_b32 m0, 10240
 s_nop 0
 buffer_load_dwordx4 v1, s[4:7], s16 offen offset:0 sc1 lds
 buffer_load_dwordx4 v1, s[4:7], s16 offen offset:1024 sc1 lds
 buffer_load_dwordx4 v1, s[4:7], s16 offen offset:2048 sc1 lds
 buffer_load_dwordx4 v1, s[4:7], s16 offen offset:3072 sc1 lds
 s_mov_b32 m0, 14336
 s_nop 0
 buffer_load_dwordx4 v12, s[4:7], s16 offen offset:0 sc1 lds
 buffer_load_dwordx4 v12, s[4:7], s16 offen offset:1024 sc1 lds
 buffer_load_dwordx4 v12, s[4:7], s16 offen offset:2048 sc1 lds
 buffer_load_dwordx4 v12, s[4:7], s16 offen offset:3072 sc1 lds
 s_add_u32 s16, s16, 67108864
 s_mov_b32 m0, 18432
 s_nop 0
 buffer_load_dwordx4 v1, s[4:7], s16 offen offset:0 sc1 lds
 buffer_load_dwordx4 v1, s[4:7], s16 offen offset:1024 sc1 lds
 buffer_load_dwordx4 v1, s[4:7], s16 offen offset:2048 sc1 lds
 buffer_load_dwordx4 v1, s[4:7], s16 offen offset:3072 sc1 lds
 s_mov_b32 m0, 22528
 s_nop 0
 buffer_load_dwordx4 v12, s[4:7], s16 offen offset:0 sc1 lds
 buffer_load_dwordx4 v12, s[4:7], s16 offen offset:1024 sc1 lds
 buffer_load_dwordx4 v12, s[4:7], s16 offen offset:2048 sc1 lds
 buffer_load_dwordx4 v12, s[4:7], s16 offen offset:3072 sc1 lds
 s_nop 15
 s_nop 15
 s_nop 15
 s_branch L_rj_277
L_id_289:
 s_barrier
 s_nop 15
 s_nop 15
 s_nop 15
 s_nop 15
 s_nop 15
 s_nop 15
 s_nop 15
 s_nop 7
 s_branch L_rj_277
L_ch_last:
 s_endpgm
L_vr:
 s_and_b32 s3, s48, 1
 s_lshl_b32 s3, s3, 3
 s_add_u32 s52, s3, s49
 s_sub_u32 s52, s52, 16
 s_lshl_b32 s52, s52, 1
 s_lshr_b32 s3, s48, 1
 s_lshl_b32 s3, s3, 5
 s_add_u32 s17, s3, s52
 s_lshl_b32 s17, s17, 8
 s_add_u32 s17, s17, 128
 s_lshr_b32 s3, s50, 1
 s_add_u32 s52, s52, s3
 s_mov_b32 s8, s24
 s_and_b32 s9, s25, 0xffff
 s_mov_b32 s10, 5242880
 s_mov_b32 s11, 0x00020000
 v_lshrrev_b32 v2, 4, v0
 v_and_b32 v7, 1, v2
 v_lshlrev_b32 v7, 1, v7
 v_xor_b32 v7, v7, v0
 s_and_b32 s3, s50, 1
 s_lshl_b32 s3, s3, 3
 v_xor_b32 v7, s3, v7
 v_and_b32 v7, 15, v7
 s_mov_b32 s3, 8192
 v_mul_lo_u32 v2, v2, s3
 v_lshl_add_u32 v2, v7, 4, v2
 v_xor_b32 v3, 64, v2
 s_and_b32 s3, s50, 1
 s_mul_i32 s76, s3, 262144
 s_lshl_b32 s3, s52, 8
 s_add_u32 s76, s76, s3
 s_lshl_b32 s64, s50, 13
 s_add_u32 m0, s64, 0
 s_nop 0
 buffer_load_dwordx4 v2, s[8:11], s76 offen lds
 s_add_u32 s76, s76, 32768
 s_add_u32 m0, s64, 1024
 s_nop 0
 buffer_load_dwordx4 v2, s[8:11], s76 offen lds
 s_add_u32 s76, s76, 32768
 s_add_u32 m0, s64, 2048
 s_nop 0
 buffer_load_dwordx4 v3, s[8:11], s76 offen lds
 s_add_u32 s76, s76, 32768
 s_add_u32 m0, s64, 3072
 s_nop 0
 buffer_load_dwordx4 v3, s[8:11], s76 offen lds
 s_add_u32 s76, s76, 32768
 s_add_u32 m0, s64, 4096
 s_nop 0
 buffer_load_dwordx4 v2, s[8:11], s76 offen lds
 s_add_u32 s76, s76, 32768
 s_add_u32 m0, s64, 5120
 s_nop 0
 buffer_load_dwordx4 v2, s[8:11], s76 offen lds
 s_add_u32 s76, s76, 32768
 s_add_u32 m0, s64, 6144
 s_nop 0
 buffer_load_dwordx4 v3, s[8:11], s76 offen lds
 s_add_u32 s76, s76, 32768
 s_add_u32 m0, s64, 7168
 s_nop 0
 buffer_load_dwordx4 v3, s[8:11], s76 offen lds
 s_add_u32 s76, s76, 294912
 s_add_u32 m0, s64, 32768
 s_nop 0
 buffer_load_dwordx4 v2, s[8:11], s76 offen lds
 s_add_u32 s76, s76, 32768
 s_add_u32 m0, s64, 33792
 s_nop 0
 buffer_load_dwordx4 v2, s[8:11], s76 offen lds
 s_add_u32 s76, s76, 32768
 s_add_u32 m0, s64, 34816
 s_nop 0
 buffer_load_dwordx4 v3, s[8:11], s76 offen lds
 s_add_u32 s76, s76, 32768
 s_add_u32 m0, s64, 35840
 s_nop 0
 buffer_load_dwordx4 v3, s[8:11], s76 offen lds
 s_add_u32 s76, s76, 32768
 s_add_u32 m0, s64, 36864
 s_nop 0
 buffer_load_dwordx4 v2, s[8:11], s76 offen lds
 s_add_u32 s76, s76, 32768
 s_add_u32 m0, s64, 37888
 s_nop 0
 buffer_load_dwordx4 v2, s[8:11], s76 offen lds
 s_add_u32 s76, s76, 32768
 s_add_u32 m0, s64, 38912
 s_nop 0
 buffer_load_dwordx4 v3, s[8:11], s76 offen lds
 s_add_u32 s76, s76, 32768
 s_add_u32 m0, s64, 39936
 s_nop 0
 buffer_load_dwordx4 v3, s[8:11], s76 offen lds
 s_add_u32 s76, s76, 294912
 s_add_u32 m0, s64, 65536
 s_nop 0
 buffer_load_dwordx4 v2, s[8:11], s76 offen lds
 s_add_u32 s76, s76, 32768
 s_add_u32 m0, s64, 66560
 s_nop 0
 buffer_load_dwordx4 v2, s[8:11], s76 offen lds
 s_add_u32 s76, s76, 32768
 s_add_u32 m0, s64, 67584
 s_nop 0
 buffer_load_dwordx4 v3, s[8:11], s76 offen lds
 s_add_u32 s76, s76, 32768
 s_add_u32 m0, s64, 68608
 s_nop 0
 buffer_load_dwordx4 v3, s[8:11], s76 offen lds
 s_add_u32 s76, s76, 32768
 s_add_u32 m0, s64, 69632
 s_nop 0
 buffer_load_dwordx4 v2, s[8:11], s76 offen lds
 s_add_u32 s76, s76, 32768
 s_add_u32 m0, s64, 70656
 s_nop 0
 buffer_load_dwordx4 v2, s[8:11], s76 offen lds
 s_add_u32 s76, s76, 32768
 s_add_u32 m0, s64, 71680
 s_nop 0
 buffer_load_dwordx4 v3, s[8:11], s76 offen lds
 s_add_u32 s76, s76, 32768
 s_add_u32 m0, s64, 72704
 s_nop 0
 buffer_load_dwordx4 v3, s[8:11], s76 offen lds
 s_add_u32 s76, s76, 294912
 s_add_u32 m0, s64, 98304
 s_nop 0
 buffer_load_dwordx4 v2, s[8:11], s76 offen lds
 s_add_u32 s76, s76, 32768
 s_add_u32 m0, s64, 99328
 s_nop 0
 buffer_load_dwordx4 v2, s[8:11], s76 offen lds
 s_add_u32 s76, s76, 32768
 s_add_u32 m0, s64, 100352
 s_nop 0
 buffer_load_dwordx4 v3, s[8:11], s76 offen lds
 s_add_u32 s76, s76, 32768
 s_add_u32 m0, s64, 101376
 s_nop 0
 buffer_load_dwordx4 v3, s[8:11], s76 offen lds
 s_add_u32 s76, s76, 32768
 s_add_u32 m0, s64, 102400
 s_nop 0
 buffer_load_dwordx4 v2, s[8:11], s76 offen lds
 s_add_u32 s76, s76, 32768
 s_add_u32 m0, s64, 103424
 s_nop 0
 buffer_load_dwordx4 v2, s[8:11], s76 offen lds
 s_add_u32 s76, s76, 32768
 s_add_u32 m0, s64, 104448
 s_nop 0
 buffer_load_dwordx4 v3, s[8:11], s76 offen lds
 s_add_u32 s76, s76, 32768
 s_add_u32 m0, s64, 105472
 s_nop 0
 buffer_load_dwordx4 v3, s[8:11], s76 offen lds
 s_add_u32 s76, s76, 294912
 s_add_u32 m0, s64, 131072
 s_nop 0
 buffer_load_dwordx4 v2, s[8:11], s76 offen lds
 s_add_u32 s76, s76, 32768
 s_add_u32 m0, s64, 132096
 s_nop 0
 buffer_load_dwordx4 v2, s[8:11], s76 offen lds
 s_add_u32 s76, s76, 32768
 s_add_u32 m0, s64, 133120
 s_nop 0
 buffer_load_dwordx4 v3, s[8:11], s76 offen lds
 s_add_u32 s76, s76, 32768
 s_add_u32 m0, s64, 134144
 s_nop 0
 buffer_load_dwordx4 v3, s[8:11], s76 offen lds
 s_add_u32 s76, s76, 32768
 s_add_u32 m0, s64, 135168
 s_nop 0
 buffer_load_dwordx4 v2, s[8:11], s76 offen lds
 s_add_u32 s76, s76, 32768
 s_add_u32 m0, s64, 136192
 s_nop 0
 buffer_load_dwordx4 v2, s[8:11], s76 offen lds
 s_add_u32 s76, s76, 32768
 s_add_u32 m0, s64, 137216
 s_nop 0
 buffer_load_dwordx4 v3, s[8:11], s76 offen lds
 s_add_u32 s76, s76, 32768
 s_add_u32 m0, s64, 138240
 s_nop 0
 buffer_load_dwordx4 v3, s[8:11], s76 offen lds
 s_add_u32 s76, s76, 294912
 v_bfe_u32 v7, v0, 2, 1
 v_lshlrev_b32 v20, 8, v7
 v_lshl_add_u32 v20, v7, 5, v20
 v_bfe_u32 v7, v0, 4, 1
 v_lshl_add_u32 v20, v7, 11, v20
 v_lshl_add_u32 v20, v7, 6, v20
 v_bfe_u32 v7, v0, 5, 1
 v_lshl_add_u32 v20, v7, 12, v20
 v_and_b32 v7, 3, v0
 v_lshl_add_u32 v20, v7, 3, v20
 v_bfe_u32 v7, v0, 3, 1
 v_mul_u32_u24 v7, 32, v7
 v_xor_b32 v20, v20, v7
 s_and_b32 s3, s50, 1
 s_lshl_b32 s3, s3, 7
 v_xor_b32 v20, s3, v20
 s_lshr_b32 s3, s50, 1
 s_lshl_b32 s3, s3, 14
 v_add_u32 v20, s3, v20
 v_xor_b32 v21, 64, v20
 v_xor_b32 v22, 8320, v20
 v_xor_b32 v23, 8384, v20
 s_waitcnt vmcnt(32)
 s_barrier
 v_add_u32 v24, 0, v20
 v_add_u32 v25, 0, v21
 v_add_u32 v26, 0, v22
 v_add_u32 v27, 0, v23
 ds_read_b64_tr_b16 v[192:193], v24 offset:0
 ds_read_b64_tr_b16 v[194:195], v24 offset:512
 ds_read_b64_tr_b16 v[196:197], v24 offset:1024
 ds_read_b64_tr_b16 v[198:199], v24 offset:1536
 ds_read_b64_tr_b16 v[200:201], v25 offset:0
 ds_read_b64_tr_b16 v[202:203], v25 offset:512
 ds_read_b64_tr_b16 v[204:205], v25 offset:1024
 ds_read_b64_tr_b16 v[206:207], v25 offset:1536
 ds_read_b64_tr_b16 v[208:209], v26 offset:0
 ds_read_b64_tr_b16 v[210:211], v26 offset:512
 ds_read_b64_tr_b16 v[212:213], v26 offset:1024
 ds_read_b64_tr_b16 v[214:215], v26 offset:1536
 ds_read_b64_tr_b16 v[216:217], v27 offset:0
 ds_read_b64_tr_b16 v[218:219], v27 offset:512
 ds_read_b64_tr_b16 v[220:221], v27 offset:1024
 ds_read_b64_tr_b16 v[222:223], v27 offset:1536
 s_waitcnt lgkmcnt(0)
 s_barrier
 s_add_u32 m0, s64, 0
 s_nop 0
 buffer_load_dwordx4 v2, s[8:11], s76 offen lds
 s_add_u32 s76, s76, 32768
 s_add_u32 m0, s64, 1024
 s_nop 0
 buffer_load_dwordx4 v2, s[8:11], s76 offen lds
 s_add_u32 s76, s76, 32768
 s_add_u32 m0, s64, 2048
 s_nop 0
 buffer_load_dwordx4 v3, s[8:11], s76 offen lds
 s_add_u32 s76, s76, 32768
 s_add_u32 m0, s64, 3072
 s_nop 0
 buffer_load_dwordx4 v3, s[8:11], s76 offen lds
 s_add_u32 s76, s76, 32768
 s_add_u32 m0, s64, 4096
 s_nop 0
 buffer_load_dwordx4 v2, s[8:11], s76 offen lds
 s_add_u32 s76, s76, 32768
 s_add_u32 m0, s64, 5120
 s_nop 0
 buffer_load_dwordx4 v2, s[8:11], s76 offen lds
 s_add_u32 s76, s76, 32768
 s_add_u32 m0, s64, 6144
 s_nop 0
 buffer_load_dwordx4 v3, s[8:11], s76 offen lds
 s_add_u32 s76, s76, 32768
 s_add_u32 m0, s64, 7168
 s_nop 0
 buffer_load_dwordx4 v3, s[8:11], s76 offen lds
 s_add_u32 s76, s76, 294912
 s_waitcnt vmcnt(32)
 s_barrier
 v_add_u32 v24, 32768, v20
 v_add_u32 v25, 32768, v21
 v_add_u32 v26, 32768, v22
 v_add_u32 v27, 32768, v23
 ds_read_b64_tr_b16 v[224:225], v24 offset:0
 ds_read_b64_tr_b16 v[226:227], v24 offset:512
 ds_read_b64_tr_b16 v[228:229], v24 offset:1024
 ds_read_b64_tr_b16 v[230:231], v24 offset:1536
 ds_read_b64_tr_b16 v[232:233], v25 offset:0
 ds_read_b64_tr_b16 v[234:235], v25 offset:512
 ds_read_b64_tr_b16 v[236:237], v25 offset:1024
 ds_read_b64_tr_b16 v[238:239], v25 offset:1536
 ds_read_b64_tr_b16 v[240:241], v26 offset:0
 ds_read_b64_tr_b16 v[242:243], v26 offset:512
 ds_read_b64_tr_b16 v[244:245], v26 offset:1024
 ds_read_b64_tr_b16 v[246:247], v26 offset:1536
 ds_read_b64_tr_b16 v[248:249], v27 offset:0
 ds_read_b64_tr_b16 v[250:251], v27 offset:512
 ds_read_b64_tr_b16 v[252:253], v27 offset:1024
 ds_read_b64_tr_b16 v[254:255], v27 offset:1536
 s_waitcnt lgkmcnt(0)
 s_barrier
 s_add_u32 m0, s64, 32768
 s_nop 0
 buffer_load_dwordx4 v2, s[8:11], s76 offen lds
 s_add_u32 s76, s76, 32768
 s_add_u32 m0, s64, 33792
 s_nop 0
 buffer_load_dwordx4 v2, s[8:11], s76 offen lds
 s_add_u32 s76, s76, 32768
 s_add_u32 m0, s64, 34816
 s_nop 0
 buffer_load_dwordx4 v3, s[8:11], s76 offen lds
 s_add_u32 s76, s76, 32768
 s_add_u32 m0, s64, 35840
 s_nop 0
 buffer_load_dwordx4 v3, s[8:11], s76 offen lds
 s_add_u32 s76, s76, 32768
 s_add_u32 m0, s64, 36864
 s_nop 0
 buffer_load_dwordx4 v2, s[8:11], s76 offen lds
 s_add_u32 s76, s76, 32768
 s_add_u32 m0, s64, 37888
 s_nop 0
 buffer_load_dwordx4 v2, s[8:11], s76 offen lds
 s_add_u32 s76, s76, 32768
 s_add_u32 m0, s64, 38912
 s_nop 0
 buffer_load_dwordx4 v3, s[8:11], s76 offen lds
 s_add_u32 s76, s76, 32768
 s_add_u32 m0, s64, 39936
 s_nop 0
 buffer_load_dwordx4 v3, s[8:11], s76 offen lds
 s_add_u32 s76, s76, 294912
 s_waitcnt vmcnt(32)
 s_barrier
 v_add_u32 v24, 65536, v20
 v_add_u32 v25, 65536, v21
 v_add_u32 v26, 65536, v22
 v_add_u32 v27, 65536, v23
 ds_read_b64_tr_b16 a[0:1], v24 offset:0
 ds_read_b64_tr_b16 a[2:3], v24 offset:512
 ds_read_b64_tr_b16 a[4:5], v24 offset:1024
 ds_read_b64_tr_b16 a[6:7], v24 offset:1536
 ds_read_b64_tr_b16 a[8:9], v25 offset:0
 ds_read_b64_tr_b16 a[10:11], v25 offset:512
 ds_read_b64_tr_b16 a[12:13], v25 offset:1024
 ds_read_b64_tr_b16 a[14:15], v25 offset:1536
 ds_read_b64_tr_b16 a[16:17], v26 offset:0
 ds_read_b64_tr_b16 a[18:19], v26 offset:512
 ds_read_b64_tr_b16 a[20:21], v26 offset:1024
 ds_read_b64_tr_b16 a[22:23], v26 offset:1536
 ds_read_b64_tr_b16 a[24:25], v27 offset:0
 ds_read_b64_tr_b16 a[26:27], v27 offset:512
 ds_read_b64_tr_b16 a[28:29], v27 offset:1024
 ds_read_b64_tr_b16 a[30:31], v27 offset:1536
 s_waitcnt lgkmcnt(0)
 s_barrier
 s_add_u32 m0, s64, 65536
 s_nop 0
 buffer_load_dwordx4 v2, s[8:11], s76 offen lds
 s_add_u32 s76, s76, 32768
 s_add_u32 m0, s64, 66560
 s_nop 0
 buffer_load_dwordx4 v2, s[8:11], s76 offen lds
 s_add_u32 s76, s76, 32768
 s_add_u32 m0, s64, 67584
 s_nop 0
 buffer_load_dwordx4 v3, s[8:11], s76 offen lds
 s_add_u32 s76, s76, 32768
 s_add_u32 m0, s64, 68608
 s_nop 0
 buffer_load_dwordx4 v3, s[8:11], s76 offen lds
 s_add_u32 s76, s76, 32768
 s_add_u32 m0, s64, 69632
 s_nop 0
 buffer_load_dwordx4 v2, s[8:11], s76 offen lds
 s_add_u32 s76, s76, 32768
 s_add_u32 m0, s64, 70656
 s_nop 0
 buffer_load_dwordx4 v2, s[8:11], s76 offen lds
 s_add_u32 s76, s76, 32768
 s_add_u32 m0, s64, 71680
 s_nop 0
 buffer_load_dwordx4 v3, s[8:11], s76 offen lds
 s_add_u32 s76, s76, 32768
 s_add_u32 m0, s64, 72704
 s_nop 0
 buffer_load_dwordx4 v3, s[8:11], s76 offen lds
 s_add_u32 s76, s76, 294912
 s_waitcnt vmcnt(32)
 s_barrier
 v_add_u32 v24, 98304, v20
 v_add_u32 v25, 98304, v21
 v_add_u32 v26, 98304, v22
 v_add_u32 v27, 98304, v23
 ds_read_b64_tr_b16 a[32:33], v24 offset:0
 ds_read_b64_tr_b16 a[34:35], v24 offset:512
 ds_read_b64_tr_b16 a[36:37], v24 offset:1024
 ds_read_b64_tr_b16 a[38:39], v24 offset:1536
 ds_read_b64_tr_b16 a[40:41], v25 offset:0
 ds_read_b64_tr_b16 a[42:43], v25 offset:512
 ds_read_b64_tr_b16 a[44:45], v25 offset:1024
 ds_read_b64_tr_b16 a[46:47], v25 offset:1536
 ds_read_b64_tr_b16 a[48:49], v26 offset:0
 ds_read_b64_tr_b16 a[50:51], v26 offset:512
 ds_read_b64_tr_b16 a[52:53], v26 offset:1024
 ds_read_b64_tr_b16 a[54:55], v26 offset:1536
 ds_read_b64_tr_b16 a[56:57], v27 offset:0
 ds_read_b64_tr_b16 a[58:59], v27 offset:512
 ds_read_b64_tr_b16 a[60:61], v27 offset:1024
 ds_read_b64_tr_b16 a[62:63], v27 offset:1536
 s_waitcnt lgkmcnt(0)
 s_barrier
 s_add_u32 m0, s64, 98304
 s_nop 0
 buffer_load_dwordx4 v2, s[8:11], s76 offen lds
 s_add_u32 s76, s76, 32768
 s_add_u32 m0, s64, 99328
 s_nop 0
 buffer_load_dwordx4 v2, s[8:11], s76 offen lds
 s_add_u32 s76, s76, 32768
 s_add_u32 m0, s64, 100352
 s_nop 0
 buffer_load_dwordx4 v3, s[8:11], s76 offen lds
 s_add_u32 s76, s76, 32768
 s_add_u32 m0, s64, 101376
 s_nop 0
 buffer_load_dwordx4 v3, s[8:11], s76 offen lds
 s_add_u32 s76, s76, 32768
 s_add_u32 m0, s64, 102400
 s_nop 0
 buffer_load_dwordx4 v2, s[8:11], s76 offen lds
 s_add_u32 s76, s76, 32768
 s_add_u32 m0, s64, 103424
 s_nop 0
 buffer_load_dwordx4 v2, s[8:11], s76 offen lds
 s_add_u32 s76, s76, 32768
 s_add_u32 m0, s64, 104448
 s_nop 0
 buffer_load_dwordx4 v3, s[8:11], s76 offen lds
 s_add_u32 s76, s76, 32768
 s_add_u32 m0, s64, 105472
 s_nop 0
 buffer_load_dwordx4 v3, s[8:11], s76 offen lds
 s_add_u32 s76, s76, 294912
 s_waitcnt vmcnt(32)
 s_barrier
 v_add_u32 v24, 131072, v20
 v_add_u32 v25, 131072, v21
 v_add_u32 v26, 131072, v22
 v_add_u32 v27, 131072, v23
 ds_read_b64_tr_b16 a[64:65], v24 offset:0
 ds_read_b64_tr_b16 a[66:67], v24 offset:512
 ds_read_b64_tr_b16 a[68:69], v24 offset:1024
 ds_read_b64_tr_b16 a[70:71], v24 offset:1536
 ds_read_b64_tr_b16 a[72:73], v25 offset:0
 ds_read_b64_tr_b16 a[74:75], v25 offset:512
 ds_read_b64_tr_b16 a[76:77], v25 offset:1024
 ds_read_b64_tr_b16 a[78:79], v25 offset:1536
 ds_read_b64_tr_b16 a[80:81], v26 offset:0
 ds_read_b64_tr_b16 a[82:83], v26 offset:512
 ds_read_b64_tr_b16 a[84:85], v26 offset:1024
 ds_read_b64_tr_b16 a[86:87], v26 offset:1536
 ds_read_b64_tr_b16 a[88:89], v27 offset:0
 ds_read_b64_tr_b16 a[90:91], v27 offset:512
 ds_read_b64_tr_b16 a[92:93], v27 offset:1024
 ds_read_b64_tr_b16 a[94:95], v27 offset:1536
 s_waitcnt lgkmcnt(0)
 s_barrier
 s_add_u32 m0, s64, 131072
 s_nop 0
 buffer_load_dwordx4 v2, s[8:11], s76 offen lds
 s_add_u32 s76, s76, 32768
 s_add_u32 m0, s64, 132096
 s_nop 0
 buffer_load_dwordx4 v2, s[8:11], s76 offen lds
 s_add_u32 s76, s76, 32768
 s_add_u32 m0, s64, 133120
 s_nop 0
 buffer_load_dwordx4 v3, s[8:11], s76 offen lds
 s_add_u32 s76, s76, 32768
 s_add_u32 m0, s64, 134144
 s_nop 0
 buffer_load_dwordx4 v3, s[8:11], s76 offen lds
 s_add_u32 s76, s76, 32768
 s_add_u32 m0, s64, 135168
 s_nop 0
 buffer_load_dwordx4 v2, s[8:11], s76 offen lds
 s_add_u32 s76, s76, 32768
 s_add_u32 m0, s64, 136192
 s_nop 0
 buffer_load_dwordx4 v2, s[8:11], s76 offen lds
 s_add_u32 s76, s76, 32768
 s_add_u32 m0, s64, 137216
 s_nop 0
 buffer_load_dwordx4 v3, s[8:11], s76 offen lds
 s_add_u32 s76, s76, 32768
 s_add_u32 m0, s64, 138240
 s_nop 0
 buffer_load_dwordx4 v3, s[8:11], s76 offen lds
 s_add_u32 s76, s76, 294912
 s_waitcnt vmcnt(32)
 s_barrier
 v_add_u32 v24, 0, v20
 v_add_u32 v25, 0, v21
 v_add_u32 v26, 0, v22
 v_add_u32 v27, 0, v23
 ds_read_b64_tr_b16 a[96:97], v24 offset:0
 ds_read_b64_tr_b16 a[98:99], v24 offset:512
 ds_read_b64_tr_b16 a[100:101], v24 offset:1024
 ds_read_b64_tr_b16 a[102:103], v24 offset:1536
 ds_read_b64_tr_b16 a[104:105], v25 offset:0
 ds_read_b64_tr_b16 a[106:107], v25 offset:512
 ds_read_b64_tr_b16 a[108:109], v25 offset:1024
 ds_read_b64_tr_b16 a[110:111], v25 offset:1536
 ds_read_b64_tr_b16 a[112:113], v26 offset:0
 ds_read_b64_tr_b16 a[114:115], v26 offset:512
 ds_read_b64_tr_b16 a[116:117], v26 offset:1024
 ds_read_b64_tr_b16 a[118:119], v26 offset:1536
 ds_read_b64_tr_b16 a[120:121], v27 offset:0
 ds_read_b64_tr_b16 a[122:123], v27 offset:512
 ds_read_b64_tr_b16 a[124:125], v27 offset:1024
 ds_read_b64_tr_b16 a[126:127], v27 offset:1536
 s_waitcnt lgkmcnt(0)
 s_waitcnt vmcnt(24)
 s_barrier
 v_add_u32 v24, 32768, v20
 v_add_u32 v25, 32768, v21
 v_add_u32 v26, 32768, v22
 v_add_u32 v27, 32768, v23
 ds_read_b64_tr_b16 a[128:129], v24 offset:0
 ds_read_b64_tr_b16 a[130:131], v24 offset:512
 ds_read_b64_tr_b16 a[132:133], v24 offset:1024
 ds_read_b64_tr_b16 a[134:135], v24 offset:1536
 ds_read_b64_tr_b16 a[136:137], v25 offset:0
 ds_read_b64_tr_b16 a[138:139], v25 offset:512
 ds_read_b64_tr_b16 a[140:141], v25 offset:1024
 ds_read_b64_tr_b16 a[142:143], v25 offset:1536
 ds_read_b64_tr_b16 a[144:145], v26 offset:0
 ds_read_b64_tr_b16 a[146:147], v26 offset:512
 ds_read_b64_tr_b16 a[148:149], v26 offset:1024
 ds_read_b64_tr_b16 a[150:151], v26 offset:1536
 ds_read_b64_tr_b16 a[152:153], v27 offset:0
 ds_read_b64_tr_b16 a[154:155], v27 offset:512
 ds_read_b64_tr_b16 a[156:157], v27 offset:1024
 ds_read_b64_tr_b16 a[158:159], v27 offset:1536
 s_waitcnt lgkmcnt(0)
 s_waitcnt vmcnt(16)
 s_barrier
 v_add_u32 v24, 65536, v20
 v_add_u32 v25, 65536, v21
 v_add_u32 v26, 65536, v22
 v_add_u32 v27, 65536, v23
 ds_read_b64_tr_b16 a[160:161], v24 offset:0
 ds_read_b64_tr_b16 a[162:163], v24 offset:512
 ds_read_b64_tr_b16 a[164:165], v24 offset:1024
 ds_read_b64_tr_b16 a[166:167], v24 offset:1536
 ds_read_b64_tr_b16 a[168:169], v25 offset:0
 ds_read_b64_tr_b16 a[170:171], v25 offset:512
 ds_read_b64_tr_b16 a[172:173], v25 offset:1024
 ds_read_b64_tr_b16 a[174:175], v25 offset:1536
 ds_read_b64_tr_b16 a[176:177], v26 offset:0
 ds_read_b64_tr_b16 a[178:179], v26 offset:512
 ds_read_b64_tr_b16 a[180:181], v26 offset:1024
 ds_read_b64_tr_b16 a[182:183], v26 offset:1536
 ds_read_b64_tr_b16 a[184:185], v27 offset:0
 ds_read_b64_tr_b16 a[186:187], v27 offset:512
 ds_read_b64_tr_b16 a[188:189], v27 offset:1024
 ds_read_b64_tr_b16 a[190:191], v27 offset:1536
 s_waitcnt lgkmcnt(0)
 s_waitcnt vmcnt(8)
 s_barrier
 v_add_u32 v24, 98304, v20
 v_add_u32 v25, 98304, v21
 v_add_u32 v26, 98304, v22
 v_add_u32 v27, 98304, v23
 ds_read_b64_tr_b16 a[192:193], v24 offset:0
 ds_read_b64_tr_b16 a[194:195], v24 offset:512
 ds_read_b64_tr_b16 a[196:197], v24 offset:1024
 ds_read_b64_tr_b16 a[198:199], v24 offset:1536
 ds_read_b64_tr_b16 a[200:201], v25 offset:0
 ds_read_b64_tr_b16 a[202:203], v25 offset:512
 ds_read_b64_tr_b16 a[204:205], v25 offset:1024
 ds_read_b64_tr_b16 a[206:207], v25 offset:1536
 ds_read_b64_tr_b16 a[208:209], v26 offset:0
 ds_read_b64_tr_b16 a[210:211], v26 offset:512
 ds_read_b64_tr_b16 a[212:213], v26 offset:1024
 ds_read_b64_tr_b16 a[214:215], v26 offset:1536
 ds_read_b64_tr_b16 a[216:217], v27 offset:0
 ds_read_b64_tr_b16 a[218:219], v27 offset:512
 ds_read_b64_tr_b16 a[220:221], v27 offset:1024
 ds_read_b64_tr_b16 a[222:223], v27 offset:1536
 s_waitcnt lgkmcnt(0)
 s_waitcnt vmcnt(0)
 s_barrier
 v_add_u32 v24, 131072, v20
 v_add_u32 v25, 131072, v21
 v_add_u32 v26, 131072, v22
 v_add_u32 v27, 131072, v23
 ds_read_b64_tr_b16 a[224:225], v24 offset:0
 ds_read_b64_tr_b16 a[226:227], v24 offset:512
 ds_read_b64_tr_b16 a[228:229], v24 offset:1024
 ds_read_b64_tr_b16 a[230:231], v24 offset:1536
 ds_read_b64_tr_b16 a[232:233], v25 offset:0
 ds_read_b64_tr_b16 a[234:235], v25 offset:512
 ds_read_b64_tr_b16 a[236:237], v25 offset:1024
 ds_read_b64_tr_b16 a[238:239], v25 offset:1536
 ds_read_b64_tr_b16 a[240:241], v26 offset:0
 ds_read_b64_tr_b16 a[242:243], v26 offset:512
 ds_read_b64_tr_b16 a[244:245], v26 offset:1024
 ds_read_b64_tr_b16 a[246:247], v26 offset:1536
 ds_read_b64_tr_b16 a[248:249], v27 offset:0
 ds_read_b64_tr_b16 a[250:251], v27 offset:512
 ds_read_b64_tr_b16 a[252:253], v27 offset:1024
 ds_read_b64_tr_b16 a[254:255], v27 offset:1536
 s_waitcnt lgkmcnt(0)
 s_mov_b32 s96, s44
 s_and_b32 s97, s45, 0xffff
 s_mov_b32 s98, 256
 s_mov_b32 s99, 0x00020000
 v_mov_b32 v8, 132
 s_mov_b32 s3, 144
 v_writelane_b32 v8, s3, 1
 s_mov_b32 s51, 0
 s_mov_b64 exec, 3
L_wb_292:
 buffer_load_dword v9, v8, s[96:99], 0 offen sc1
 s_waitcnt vmcnt(0)
 v_cmp_eq_u32 vcc, 0, v9
 s_cbranch_vccz L_wbd_293
 s_sleep 2
 s_add_u32 s51, s51, 1
 s_cmp_lt_u32 s51, 131072
 s_cbranch_scc1 L_wb_292
 s_branch L_bail
L_wbd_293:
 s_mov_b64 exec, -1
 v_readlane_b32 s81, v9, 1
 s_nop 3
 s_sub_u32 s81, s81, 1
 s_mov_b32 s96, s44
 s_and_b32 s97, s45, 0xffff
 s_mov_b32 s98, 256
 s_mov_b32 s99, 0x00020000
 v_lshlrev_b32 v8, 5, v0
 s_mov_b32 s51, 0
L_gl_294:
 buffer_load_dword v9, v8, s[96:99], 0 offen sc1
 s_waitcnt vmcnt(0)
 v_readlane_b32 s3, v9, s48
 s_mov_b32 s80, 0
 s_nop 2
 s_cmp_ge_u32 s3, 32
 s_cbranch_scc1 L_gld_295
 s_mov_b32 s80, 0
 v_readlane_b32 s3, v9, 0
 s_nop 3
 s_add_u32 s80, s80, s3
 v_readlane_b32 s3, v9, 1
 s_nop 3
 s_add_u32 s80, s80, s3
 v_readlane_b32 s3, v9, 2
 s_nop 3
 s_add_u32 s80, s80, s3
 v_readlane_b32 s3, v9, 3
 s_nop 3
 s_add_u32 s80, s80, s3
 v_readlane_b32 s3, v9, 4
 s_nop 3
 s_add_u32 s80, s80, s3
 v_readlane_b32 s3, v9, 5
 s_nop 3
 s_add_u32 s80, s80, s3
 v_readlane_b32 s3, v9, 6
 s_nop 3
 s_add_u32 s80, s80, s3
 v_readlane_b32 s3, v9, 7
 s_nop 3
 s_add_u32 s80, s80, s3
 s_cmp_ge_u32 s80, 256
 s_cbranch_scc1 L_gld_295
 s_sleep 4
 s_add_u32 s51, s51, 1
 s_cmp_lt_u32 s51, 131072
 s_cbranch_scc1 L_gl_294
 s_branch L_bail
L_gld_295:
 s_barrier
 v_lshlrev_b32 v1, 4, v0
 v_add_u32 v6, 4096, v1
 s_xor_b32 s3, s81, 0
 s_and_b32 s3, s3, 1
 s_lshl_b32 s3, s3, 13
 s_add_u32 s56, s3, 4194304
 s_and_b32 s3, s48, 2
 s_lshl_b32 s3, s3, 15
 s_add_u32 s56, s56, s3
 s_xor_b32 s3, s81, 1
 s_and_b32 s3, s3, 1
 s_lshl_b32 s3, s3, 13
 s_add_u32 s57, s3, 6291456
 s_and_b32 s3, s48, 2
 s_lshl_b32 s3, s3, 15
 s_add_u32 s57, s57, s3
 s_xor_b32 s3, s81, 0
 s_and_b32 s3, s3, 1
 s_lshl_b32 s3, s3, 13
 s_add_u32 s58, s3, 8388608
 s_and_b32 s3, s48, 2
 s_lshl_b32 s3, s3, 15
 s_add_u32 s58, s58, s3
 s_xor_b32 s3, s81, 1
 s_and_b32 s3, s3, 1
 s_lshl_b32 s3, s3, 13
 s_add_u32 s59, s3, 10485760
 s_and_b32 s3, s48, 2
 s_lshl_b32 s3, s3, 15
 s_add_u32 s59, s59, s3
 v_lshrrev_b32 v2, 5, v0
 v_lshlrev_b32 v2, 15, v2
 v_bfe_u32 v7, v0, 2, 2
 v_lshl_add_u32 v2, v7, 8, v2
 v_bfe_u32 v7, v0, 4, 1
 v_lshl_add_u32 v2, v7, 6, v2
 v_and_b32 v7, 3, v0
 v_lshl_add_u32 v2, v7, 4, v2
 s_lshr_b32 s76, s50, 1
 s_and_b32 s77, s50, 1
 s_lshl_b32 s3, s76, 14
 v_add_u32 v2, s3, v2
 s_lshl_b32 s3, s77, 7
 s_add_u32 s3, s3, 2048
 v_add_u32 v3, s3, v2
 s_mul_i32 s3, s77, 3072
 v_add_u32 v2, s3, v2
 s_mul_i32 s76, s76, 5120
 s_add_u32 s3, s3, s76
 v_add_u32 v4, s3, v1
 s_lshl_b32 s3, s77, 3
 s_add_u32 s3, s3, s76
 s_add_u32 s3, s3, 2048
 v_add_u32 v5, s3, v1
 v_and_b32 v7, 2, v0
 v_cmp_eq_u32 vcc, 0, v7
 v_mov_b32 v8, 0xeeee
 v_mov_b32 v7, 0x4444
 s_nop 0
 v_cndmask_b32 v8, v8, v7, vcc
 s_lshr_b32 s3, s48, 1
 s_lshl_b32 s3, s3, 5
 s_add_u32 s64, s3, s52
 s_lshl_b32 s32, s64, 8
 s_add_u32 s32, s32, 0
 s_mul_i32 s76, s64, 24576
 s_add_u32 s60, s76, 1736704
 s_add_u32 s61, s76, 1742848
 s_add_u32 s62, s76, 1748992
 s_add_u32 s63, s76, 1755136
 s_add_u32 s3, s32, 8
 s_cmp_eq_u32 s50, 0
 s_cselect_b32 s35, s3, 268435456
 s_and_b32 s77, s50, 1
 s_lshr_b32 s76, s50, 1
 s_lshl_b32 s3, s77, 10
 v_add_u32 v18, s3, v6
 s_lshl_b32 s3, s50, 10
 v_add_u32 v16, s3, v1
 s_lshl_b32 s3, s76, 11
 v_add_u32 v17, s3, v1
 s_mul_i32 s69, s76, 24576
 s_add_u32 s69, s69, 18432
 v_add_u32 v15, s69, v1
 v_add_u32 v19, 16384, v15
 s_lshl_b32 s71, s77, 12
 s_add_u32 s68, s69, s71
 s_add_u32 s68, s68, 8192
 v_add_u32 v14, s68, v1
 s_lshl_b32 s3, s77, 14
 s_add_u32 s69, s69, s3
 s_mul_i32 s70, s77, 67108864
 s_and_b32 s100, s52, 1
 s_lshl_b32 s100, s100, 13
 s_lshl_b32 s54, s52, 14
 s_add_u32 s54, s54, s100
 s_lshr_b32 s3, s48, 1
 s_mul_i32 s3, s3, 33554432
 s_add_u32 s54, s54, s3
 s_add_u32 s54, s54, 16777216
 s_xor_b32 s78, s81, 0
 s_lshl_b32 s78, s78, 13
 s_xor_b32 s79, s78, 8192
 s_lshr_b32 s3, s48, 1
 s_lshl_b32 s67, s3, 8
 s_add_u32 s67, s67, s79
 s_add_u32 s67, s67, 49152
 s_lshr_b32 s3, s52, 2
 s_mul_i32 s3, s3, 2560
 v_lshl_add_u32 v12, v0, 9, s3
 v_and_b32 v7, 0xffffe000, v12
 v_add_u32 v12, v12, v7
 v_lshrrev_b32 v7, 4, v0
 v_lshlrev_b32 v11, 9, v7
 v_and_b32 v10, 15, v0
 v_lshl_add_u32 v11, v10, 4, v11
 s_lshl_b32 s3, s77, 8
 v_add_u32 v11, s3, v11
 s_lshl_b32 s3, s77, 4
 v_add_u32 v10, s3, v10
 v_lshlrev_b32 v7, 2, v7
 v_mov_b32 v148, 0xff61b1e6
 v_add_u32 v149, 0, v7
 v_cmp_gt_u32 vcc, v149, v10
 s_nop 1
 v_cndmask_b32 v108, 0, v148, vcc
 v_add_u32 v149, 1, v7
 v_cmp_gt_u32 vcc, v149, v10
 s_nop 1
 v_cndmask_b32 v109, 0, v148, vcc
 v_add_u32 v149, 2, v7
 v_cmp_gt_u32 vcc, v149, v10
 s_nop 1
 v_cndmask_b32 v110, 0, v148, vcc
 v_add_u32 v149, 3, v7
 v_cmp_gt_u32 vcc, v149, v10
 s_nop 1
 v_cndmask_b32 v111, 0, v148, vcc
 v_add_u32 v149, 16, v7
 v_cmp_gt_u32 vcc, v149, v10
 s_nop 1
 v_cndmask_b32 v112, 0, v148, vcc
 v_add_u32 v149, 17, v7
 v_cmp_gt_u32 vcc, v149, v10
 s_nop 1
 v_cndmask_b32 v113, 0, v148, vcc
 v_add_u32 v149, 18, v7
 v_cmp_gt_u32 vcc, v149, v10
 s_nop 1
 v_cndmask_b32 v114, 0, v148, vcc
 v_add_u32 v149, 19, v7
 v_cmp_gt_u32 vcc, v149, v10
 s_nop 1
 v_cndmask_b32 v115, 0, v148, vcc
 v_mov_b32 v32, -1
 v_mov_b32 v120, 0
 v_mov_b32 v33, -1
 v_mov_b32 v121, 0
 v_mov_b32 v34, -1
 v_mov_b32 v122, 0
 v_mov_b32 v35, -1
 v_mov_b32 v123, 0
 v_mov_b32 v80, 0
 v_mov_b32 v81, 0
 v_mov_b32 v82, 0
 v_mov_b32 v83, 0
 v_mov_b32 v84, 0
 v_mov_b32 v85, 0
 v_mov_b32 v86, 0
 v_mov_b32 v87, 0
 v_mov_b32 v88, 0
 v_mov_b32 v89, 0
 v_mov_b32 v90, 0
 v_mov_b32 v91, 0
 v_mov_b32 v92, 0
 v_mov_b32 v93, 0
 v_mov_b32 v94, 0
 v_mov_b32 v95, 0
 v_and_b32 v9, 7, v0
 v_lshrrev_b32 v10, 1, v0
 v_xor_b32 v10, v10, v0
 v_and_b32 v10, 8, v10
 v_or_b32 v9, v9, v10
 v_mov_b32 v24, 0
 v_cmp_eq_u32 vcc, 0, v9
 v_mov_b32 v10, 0x3f80
 s_nop 1
 v_cndmask_b32 v24, v24, v10, vcc
 v_cmp_eq_u32 vcc, 1, v9
 v_mov_b32 v10, 0x3f800000
 s_nop 1
 v_cndmask_b32 v24, v24, v10, vcc
 v_mov_b32 v25, 0
 v_cmp_eq_u32 vcc, 2, v9
 v_mov_b32 v10, 0x3f80
 s_nop 1
 v_cndmask_b32 v25, v25, v10, vcc
 v_cmp_eq_u32 vcc, 3, v9
 v_mov_b32 v10, 0x3f800000
 s_nop 1
 v_cndmask_b32 v25, v25, v10, vcc
 v_mov_b32 v26, 0
 v_cmp_eq_u32 vcc, 4, v9
 v_mov_b32 v10, 0x3f80
 s_nop 1
 v_cndmask_b32 v26, v26, v10, vcc
 v_cmp_eq_u32 vcc, 5, v9
 v_mov_b32 v10, 0x3f800000
 s_nop 1
 v_cndmask_b32 v26, v26, v10, vcc
 v_mov_b32 v27, 0
 v_cmp_eq_u32 vcc, 6, v9
 v_mov_b32 v10, 0x3f80
 s_nop 1
 v_cndmask_b32 v27, v27, v10, vcc
 v_cmp_eq_u32 vcc, 7, v9
 v_mov_b32 v10, 0x3f800000
 s_nop 1
 v_cndmask_b32 v27, v27, v10, vcc
 v_mov_b32 v9, 0
 v_and_b32 v23, -33, v1
 s_mov_b32 s65, 0x3db504f3
 s_mov_b32 s66, 0x3fb8aa3b
 s_mov_b32 s53, 0
 s_mov_b32 s33, 268435456
 s_mov_b32 s34, 268435456
 s_sub_u32 s67, s67, 4
 v_mov_b32 v124, 0
 v_mov_b32 v125, 0
 v_mov_b32 v126, 0
 v_mov_b32 v127, 0
 v_mov_b32 v128, 0
 v_mov_b32 v129, 0
 v_mov_b32 v130, 0
 v_mov_b32 v131, 0
 v_mov_b32 v132, 0
 v_mov_b32 v133, 0
 v_mov_b32 v134, 0
 v_mov_b32 v135, 0
 v_mov_b32 v136, 0
 v_mov_b32 v137, 0
 v_mov_b32 v138, 0
 v_mov_b32 v139, 0
 s_cmp_lg_u32 s80, 0
 s_cbranch_scc1 L_vr_ents
 s_branch L_vr_entf
.p2align 6
L_vr_loopf:
 s_mov_b32 s51, 0
 buffer_load_dword v7, off, s[4:7], s17 sc1
 s_waitcnt vmcnt(0)
L_go_296:
 v_cmp_gt_u32 vcc, s53, v7
 s_cbranch_vccnz L_rt_297
L_vr_entf:
 s_mov_b32 s51, 0
 s_nop 15
 s_nop 7
 buffer_load_dwordx4 v[40:43], v2, s[4:7], s56 offen offset:0 sc1
 buffer_load_dwordx4 v[44:47], v2, s[4:7], s56 offen offset:128 sc1
 buffer_load_dwordx4 v[48:51], v2, s[4:7], s56 offen offset:1024 sc1
 buffer_load_dwordx4 v[52:55], v2, s[4:7], s56 offen offset:1152 sc1
 buffer_load_dwordx4 v[56:59], v3, s[4:7], s56 offen offset:0 sc1
L_xm_298:
 s_waitcnt vmcnt(4)
 v_mfma_f32_16x16x32_bf16 v[60:63], v[24:27], v[40:43], 0
 s_waitcnt vmcnt(3)
 v_mfma_f32_16x16x32_bf16 v[64:67], v[24:27], v[44:47], 0
 s_waitcnt vmcnt(2)
 v_mfma_f32_16x16x32_bf16 v[68:71], v[24:27], v[48:51], 0
 v_max3_u32 v7, v40, v44, v48
 v_cvt_pk_bf16_f32 v60, v60, v61
 v_cvt_pk_bf16_f32 v61, v62, v63
 ds_write_b64 v4, v[60:61] offset:0
 s_waitcnt vmcnt(1)
 v_mfma_f32_16x16x32_bf16 v[72:75], v[24:27], v[52:55], 0
 v_cvt_pk_bf16_f32 v64, v64, v65
 v_cvt_pk_bf16_f32 v65, v66, v67
 ds_write_b64 v4, v[64:65] offset:8
 s_waitcnt vmcnt(0)
 v_mfma_f32_16x16x32_bf16 v[76:79], v[24:27], v[56:59], 0
 v_max3_u32 v7, v7, v52, v56
 v_cmp_eq_u32 vcc, -1, v7
 v_cvt_pk_bf16_f32 v68, v68, v69
 v_cvt_pk_bf16_f32 v69, v70, v71
 ds_write_b64 v4, v[68:69] offset:1024
 s_cbranch_vccnz L_rt_299
 v_cvt_pk_bf16_f32 v72, v72, v73
 v_cvt_pk_bf16_f32 v73, v74, v75
 ds_write_b64 v4, v[72:73] offset:1032
 s_nop 0
 v_cvt_pk_bf16_f32 v76, v76, v77
 v_cvt_pk_bf16_f32 v77, v78, v79
 ds_write_b64 v5, v[76:77] offset:0
 s_waitcnt lgkmcnt(0)
 s_barrier
 ds_read_b128 v[56:59], v23 offset:0
 ds_read_b128 v[60:63], v23 offset:32
 ds_read_b128 v[64:67], v23 offset:1024
 s_cmp_ge_u32 s34, 268435456
 s_cbranch_scc1 L_ns_300
 v_mov_b32 v10, 1
 s_mov_b64 exec, 31
 buffer_atomic_add v10, v12, s[4:7], s34 offen
 s_mov_b64 exec, -1
 L_ns_300:
 buffer_load_dword v13, off, s[4:7], s32 sc1
 s_waitcnt lgkmcnt(2)
 v_smfmac_f32_16x16x64_bf16 v[80:83], v[56:59], v[192:199], v8
 ds_read_b128 v[68:71], v23 offset:1056
 v_smfmac_f32_16x16x64_bf16 v[84:87], v[56:59], v[200:207], v8
 ds_read_b128 v[72:75], v23 offset:2048
 s_waitcnt lgkmcnt(3)
 v_smfmac_f32_16x16x64_bf16 v[80:83], v[60:63], v[208:215], v8
 ds_read_b128 v[76:79], v23 offset:2080
 v_smfmac_f32_16x16x64_bf16 v[84:87], v[60:63], v[216:223], v8
 ds_read_b128 v[180:183], v23 offset:3072
 s_waitcnt lgkmcnt(4)
 v_smfmac_f32_16x16x64_bf16 v[80:83], v[64:67], v[224:231], v8
 ds_read_b128 v[40:43], v14 offset:49152
 v_smfmac_f32_16x16x64_bf16 v[84:87], v[64:67], v[232:239], v8
 ds_read_b128 v[184:187], v23 offset:3104
 s_waitcnt lgkmcnt(5)
 v_smfmac_f32_16x16x64_bf16 v[80:83], v[68:71], v[240:247], v8
 ds_read_b128 v[44:47], v14 offset:50176
 v_smfmac_f32_16x16x64_bf16 v[84:87], v[68:71], v[248:255], v8
 ds_read_b128 v[56:59], v23 offset:4096
 s_waitcnt lgkmcnt(6)
 v_smfmac_f32_16x16x64_bf16 v[80:83], v[72:75], a[0:7], v8
 ds_read_b128 v[48:51], v14 offset:51200
 v_smfmac_f32_16x16x64_bf16 v[84:87], v[72:75], a[8:15], v8
 ds_read_b128 v[60:63], v23 offset:4128
 s_waitcnt lgkmcnt(7)
 v_smfmac_f32_16x16x64_bf16 v[80:83], v[76:79], a[16:23], v8
 ds_read_b128 v[52:55], v14 offset:52224
 v_smfmac_f32_16x16x64_bf16 v[84:87], v[76:79], a[24:31], v8
 ds_read_b128 v[64:67], v23 offset:5120
 s_waitcnt lgkmcnt(8)
 v_smfmac_f32_16x16x64_bf16 v[80:83], v[180:183], a[32:39], v8
 ds_read_b128 v[148:151], v15 offset:49152
 v_smfmac_f32_16x16x64_bf16 v[84:87], v[180:183], a[40:47], v8
 ds_read_b128 v[68:71], v23 offset:5152
 s_waitcnt lgkmcnt(8)
 v_smfmac_f32_16x16x64_bf16 v[80:83], v[184:187], a[48:55], v8
 ds_read_b128 v[152:155], v15 offset:50176
 v_smfmac_f32_16x16x64_bf16 v[84:87], v[184:187], a[56:63], v8
 ds_read_b128 v[72:75], v23 offset:6144
 s_waitcnt lgkmcnt(8)
 v_smfmac_f32_16x16x64_bf16 v[80:83], v[56:59], a[64:71], v8
 ds_read_b128 v[156:159], v15 offset:51200
 v_smfmac_f32_16x16x64_bf16 v[84:87], v[56:59], a[72:79], v8
 ds_read_b128 v[76:79], v23 offset:6176
 s_waitcnt lgkmcnt(8)
 v_smfmac_f32_16x16x64_bf16 v[80:83], v[60:63], a[80:87], v8
 ds_read_b128 v[160:163], v15 offset:52224
 v_smfmac_f32_16x16x64_bf16 v[84:87], v[60:63], a[88:95], v8
 ds_read_b128 v[180:183], v23 offset:7168
 s_waitcnt lgkmcnt(8)
 v_smfmac_f32_16x16x64_bf16 v[80:83], v[64:67], a[96:103], v8
 ds_read_b128 v[164:167], v15 offset:53248
 v_smfmac_f32_16x16x64_bf16 v[84:87], v[64:67], a[104:111], v8
 ds_read_b128 v[184:187], v23 offset:7200
 s_waitcnt lgkmcnt(8)
 v_smfmac_f32_16x16x64_bf16 v[80:83], v[68:71], a[112:119], v8
 ds_read_b128 v[168:171], v15 offset:54272
 v_smfmac_f32_16x16x64_bf16 v[84:87], v[68:71], a[120:127], v8
 ds_read_b128 v[56:59], v23 offset:8192
 s_waitcnt lgkmcnt(8)
 v_smfmac_f32_16x16x64_bf16 v[80:83], v[72:75], a[128:135], v8
 ds_read_b128 v[172:175], v15 offset:55296
 v_smfmac_f32_16x16x64_bf16 v[84:87], v[72:75], a[136:143], v8
 ds_read_b128 v[60:63], v23 offset:8224
 s_waitcnt lgkmcnt(8)
 v_smfmac_f32_16x16x64_bf16 v[80:83], v[76:79], a[144:151], v8
 ds_read_b128 v[176:179], v15 offset:56320
 v_smfmac_f32_16x16x64_bf16 v[84:87], v[76:79], a[152:159], v8
 ds_read_b128 v[64:67], v23 offset:9216
 s_waitcnt lgkmcnt(8)
 v_smfmac_f32_16x16x64_bf16 v[80:83], v[180:183], a[160:167], v8
 ds_read_b128 v[140:143], v17 offset:14336
 v_smfmac_f32_16x16x64_bf16 v[84:87], v[180:183], a[168:175], v8
 ds_read_b128 v[68:71], v23 offset:9248
 s_waitcnt lgkmcnt(8)
 v_smfmac_f32_16x16x64_bf16 v[80:83], v[184:187], a[176:183], v8
 ds_read_b128 v[144:147], v17 offset:15360
 v_smfmac_f32_16x16x64_bf16 v[84:87], v[184:187], a[184:191], v8
 s_waitcnt lgkmcnt(7)
 v_smfmac_f32_16x16x64_bf16 v[80:83], v[56:59], a[192:199], v8
 v_smfmac_f32_16x16x64_bf16 v[84:87], v[56:59], a[200:207], v8
 s_waitcnt lgkmcnt(5)
 v_smfmac_f32_16x16x64_bf16 v[80:83], v[60:63], a[208:215], v8
 v_smfmac_f32_16x16x64_bf16 v[84:87], v[60:63], a[216:223], v8
 s_waitcnt lgkmcnt(3)
 v_smfmac_f32_16x16x64_bf16 v[80:83], v[64:67], a[224:231], v8
 v_smfmac_f32_16x16x64_bf16 v[84:87], v[64:67], a[232:239], v8
 s_waitcnt lgkmcnt(1)
 v_smfmac_f32_16x16x64_bf16 v[80:83], v[68:71], a[240:247], v8
 v_smfmac_f32_16x16x64_bf16 v[84:87], v[68:71], a[248:255], v8
 s_lshl_b32 s16, s53, 19
 s_add_u32 s16, s16, s54
 s_xor_b32 s72, s16, 8192
 s_add_u32 s72, s72, s71
 s_add_u32 s16, s16, s70
 v_cvt_pk_bf16_f32 v36, v80, v81
 v_cvt_pk_bf16_f32 v37, v82, v83
 s_nop 2
 v_cvt_pk_bf16_f32 v38, v84, v85
 v_cvt_pk_bf16_f32 v39, v86, v87
 buffer_store_dwordx4 v[36:39], v18, s[4:7], s60 offen
 ds_write_b128 v16, v[36:39] offset:10240
 s_waitcnt vmcnt(1) lgkmcnt(1)
L_wf_301:
 v_cmp_ge_u32 vcc, s53, v13
 s_cbranch_vccnz L_rt_302
 v_mfma_f32_16x16x32_bf16 v[100:103], v[148:151], v[40:43], v[108:111]
 s_add_u32 m0, s68, 0
 s_nop 0
 buffer_load_dwordx4 v1, s[4:7], s72 offen offset:0 sc1 nt lds
 ds_read_b128 v[56:59], v19 offset:49152
 v_mfma_f32_16x16x32_bf16 v[104:107], v[164:167], v[40:43], v[112:115]
 ds_read_b128 v[60:63], v19 offset:50176
 v_mfma_f32_16x16x32_bf16 v[96:99], v[124:127], v[40:43], 0
 ds_read_b128 v[64:67], v19 offset:51200
 v_mfma_f32_16x16x32_bf16 v[100:103], v[152:155], v[44:47], v[100:103]
 ds_read_b128 v[68:71], v19 offset:52224
 buffer_load_dwordx4 v1, s[4:7], s72 offen offset:1024 sc1 nt lds
 v_mfma_f32_16x16x32_bf16 v[104:107], v[168:171], v[44:47], v[104:107]
 ds_read_b128 v[72:75], v19 offset:53248
 v_mfma_f32_16x16x32_bf16 v[96:99], v[128:131], v[44:47], v[96:99]
 ds_read_b128 v[76:79], v19 offset:54272
 v_mfma_f32_16x16x32_bf16 v[100:103], v[156:159], v[48:51], v[100:103]
 ds_read_b128 v[180:183], v19 offset:55296
 v_mfma_f32_16x16x32_bf16 v[104:107], v[172:175], v[48:51], v[104:107]
 buffer_load_dwordx4 v1, s[4:7], s72 offen offset:2048 sc1 nt lds
 ds_read_b128 v[184:187], v19 offset:56320
 v_mfma_f32_16x16x32_bf16 v[96:99], v[132:135], v[48:51], v[96:99]
 v_mfma_f32_16x16x32_bf16 v[100:103], v[160:163], v[52:55], v[100:103]
 v_mfma_f32_16x16x32_bf16 v[104:107], v[176:179], v[52:55], v[104:107]
 v_mfma_f32_16x16x32_bf16 v[96:99], v[136:139], v[52:55], v[96:99]
 v_mov_b32 v80, 0
 v_mov_b32 v81, 0
 buffer_load_dwordx4 v1, s[4:7], s72 offen offset:3072 sc1 nt lds
 v_mov_b32 v82, 0
 v_mov_b32 v83, 0
 v_mov_b32 v84, 0
 v_mov_b32 v85, 0
 v_mov_b32 v86, 0
 v_mov_b32 v87, 0
 v_cvt_pk_bf16_f32 v7, v100, v101
 s_add_u32 m0, s69, 0
 s_nop 0
 buffer_load_dwordx4 v1, s[4:7], s16 offen offset:0 sc1 lds
 v_lshlrev_b32 v100, 16, v7
 v_and_b32 v101, 0xffff0000, v7
 v_cvt_pk_bf16_f32 v7, v102, v103
 v_lshlrev_b32 v102, 16, v7
 v_and_b32 v103, 0xffff0000, v7
 v_cvt_pk_bf16_f32 v7, v104, v105
 v_lshlrev_b32 v104, 16, v7
 buffer_load_dwordx4 v1, s[4:7], s16 offen offset:1024 sc1 lds
 v_and_b32 v105, 0xffff0000, v7
 v_cvt_pk_bf16_f32 v7, v106, v107
 v_lshlrev_b32 v106, 16, v7
 v_and_b32 v107, 0xffff0000, v7
 v_cvt_pk_bf16_f32 v7, v98, v99
 v_lshlrev_b32 v98, 16, v7
 v_and_b32 v99, 0xffff0000, v7
 buffer_load_dwordx4 v1, s[4:7], s16 offen offset:2048 sc1 lds
 v_pk_mul_f32 v[100:101], v[100:101], s[64:65] op_sel:[0,1] op_sel_hi:[1,1]
 v_pk_mul_f32 v[102:103], v[102:103], s[64:65] op_sel:[0,1] op_sel_hi:[1,1]
 v_pk_mul_f32 v[104:105], v[104:105], s[64:65] op_sel:[0,1] op_sel_hi:[1,1]
 v_pk_mul_f32 v[106:107], v[106:107], s[64:65] op_sel:[0,1] op_sel_hi:[1,1]
 v_pk_mul_f32 v[98:99], v[98:99], s[64:65] op_sel:[0,1] op_sel_hi:[1,1]
 v_cvt_pk_bf16_f32 v7, v100, v101
 v_lshlrev_b32 v100, 16, v7
 buffer_load_dwordx4 v1, s[4:7], s16 offen offset:3072 sc1 lds
 v_and_b32 v101, 0xffff0000, v7
 v_cvt_pk_bf16_f32 v7, v102, v103
 v_lshlrev_b32 v102, 16, v7
 v_and_b32 v103, 0xffff0000, v7
 v_cvt_pk_bf16_f32 v7, v104, v105
 v_lshlrev_b32 v104, 16, v7
 v_and_b32 v105, 0xffff0000, v7
 s_add_u32 m0, s69, 4096
 s_nop 0
 buffer_load_dwordx4 v6, s[4:7], s16 offen offset:0 sc1 lds
 v_cvt_pk_bf16_f32 v7, v106, v107
 v_lshlrev_b32 v106, 16, v7
 v_and_b32 v107, 0xffff0000, v7
 v_cvt_pk_bf16_f32 v7, v98, v99
 v_lshlrev_b32 v98, 16, v7
 v_and_b32 v99, 0xffff0000, v7
 v_max_f32 v20, v100, v101
 buffer_load_dwordx4 v6, s[4:7], s16 offen offset:1024 sc1 lds
 v_max3_f32 v20, v20, v102, v103
 v_max3_f32 v20, v20, v104, v105
 v_max3_f32 v20, v20, v106, v107
 v_max3_f32 v20, v20, v98, v99
 v_mov_b32 v22, v20
 s_nop 1
 v_permlane16_swap_b32 v20, v22
 buffer_load_dwordx4 v6, s[4:7], s16 offen offset:2048 sc1 lds
 v_max_f32 v20, v20, v22
 v_mov_b32 v22, v20
 s_nop 1
 v_permlane32_swap_b32 v20, v22
 v_max_f32 v20, v20, v22
 v_mul_f32 v22, s66, v20
 v_fma_f32 v100, v100, s66, -v22
 buffer_load_dwordx4 v6, s[4:7], s16 offen offset:3072 sc1 lds
 v_fma_f32 v101, v101, s66, -v22
 v_fma_f32 v102, v102, s66, -v22
 v_fma_f32 v103, v103, s66, -v22
 v_fma_f32 v104, v104, s66, -v22
 v_fma_f32 v105, v105, s66, -v22
 v_fma_f32 v106, v106, s66, -v22
 v_fma_f32 v107, v107, s66, -v22
 buffer_store_dwordx4 v[32:35], v18, s[4:7], s63 offen
 v_fma_f32 v98, v98, s66, -v22
 v_fma_f32 v99, v99, s66, -v22
 v_exp_f32 v100, v100
 v_exp_f32 v101, v101
 v_exp_f32 v102, v102
 v_exp_f32 v103, v103
 v_exp_f32 v104, v104
 buffer_load_dwordx4 v[124:127], v1, s[4:7], s60 offen offset:0 sc1
 v_exp_f32 v105, v105
 v_exp_f32 v106, v106
 v_exp_f32 v107, v107
 v_exp_f32 v98, v98
 v_exp_f32 v99, v99
 v_add_f32 v28, v100, v101
 v_add_f32 v28, v28, v102
 buffer_load_dwordx4 v[128:131], v1, s[4:7], s60 offen offset:1024 sc1
 v_add_f32 v28, v28, v103
 v_add_f32 v28, v28, v104
 v_add_f32 v28, v28, v105
 v_add_f32 v28, v28, v106
 v_add_f32 v28, v28, v107
 v_add_f32 v28, v28, v98
 v_add_f32 v28, v28, v99
 buffer_load_dwordx4 v[132:135], v1, s[4:7], s60 offen offset:2048 sc1
 v_mov_b32 v22, v28
 s_nop 1
 v_permlane16_swap_b32 v28, v22
 v_add_f32 v28, v28, v22
 v_mov_b32 v22, v28
 s_nop 1
 v_permlane32_swap_b32 v28, v22
 buffer_load_dwordx4 v[136:139], v1, s[4:7], s60 offen offset:3072 sc1
 v_add_f32 v28, v28, v22
 v_rcp_f32 v28, v28
 s_nop 0
 v_pk_mul_f32 v[100:101], v[100:101], v[28:29] op_sel_hi:[1,0]
 v_pk_mul_f32 v[102:103], v[102:103], v[28:29] op_sel_hi:[1,0]
 v_pk_mul_f32 v[104:105], v[104:105], v[28:29] op_sel_hi:[1,0]
 v_pk_mul_f32 v[106:107], v[106:107], v[28:29] op_sel_hi:[1,0]
 v_pk_mul_f32 v[98:99], v[98:99], v[28:29] op_sel_hi:[1,0]
 v_cvt_pk_bf16_f32 v116, v100, v101
 v_cvt_pk_bf16_f32 v117, v102, v103
 v_cvt_pk_bf16_f32 v118, v104, v105
 v_cvt_pk_bf16_f32 v119, v106, v107
 v_cvt_pk_bf16_f32 v120, v98, v99
 v_cvt_pk_bf16_f32 v123, v98, v99
 s_waitcnt lgkmcnt(0)
 v_mfma_f32_16x16x32_bf16 v[148:151], v[56:59], v[116:119], 0
 v_mfma_f32_16x16x32_bf16 v[152:155], v[60:63], v[116:119], 0
 v_mfma_f32_16x16x16_bf16 v[148:151], v[140:141], v[120:121], v[148:151]
 v_mfma_f32_16x16x32_bf16 v[156:159], v[64:67], v[116:119], 0
 v_mfma_f32_16x16x16_bf16 v[152:155], v[140:141], v[122:123], v[152:155]
 v_mfma_f32_16x16x32_bf16 v[160:163], v[68:71], v[116:119], 0
 v_mfma_f32_16x16x16_bf16 v[156:159], v[142:143], v[120:121], v[156:159]
 v_mfma_f32_16x16x32_bf16 v[164:167], v[72:75], v[116:119], 0
 v_mfma_f32_16x16x16_bf16 v[160:163], v[142:143], v[122:123], v[160:163]
 v_cvt_pk_bf16_f32 v40, v148, v149
 v_cvt_pk_bf16_f32 v41, v150, v151
 v_cvt_pk_bf16_f32 v42, v152, v153
 v_cvt_pk_bf16_f32 v43, v154, v155
 buffer_store_dwordx4 v[40:43], v11, s[4:7], s33 offen offset:0 sc1
 v_mfma_f32_16x16x32_bf16 v[168:171], v[76:79], v[116:119], 0
 v_mfma_f32_16x16x16_bf16 v[164:167], v[144:145], v[120:121], v[164:167]
 v_mfma_f32_16x16x32_bf16 v[172:175], v[180:183], v[116:119], 0
 v_mfma_f32_16x16x16_bf16 v[168:171], v[144:145], v[122:123], v[168:171]
 v_cvt_pk_bf16_f32 v44, v156, v157
 v_cvt_pk_bf16_f32 v45, v158, v159
 v_cvt_pk_bf16_f32 v46, v160, v161
 v_cvt_pk_bf16_f32 v47, v162, v163
 buffer_store_dwordx4 v[44:47], v11, s[4:7], s33 offen offset:2048 sc1
 s_add_u32 s33, s33, 4096
 v_mfma_f32_16x16x32_bf16 v[176:179], v[184:187], v[116:119], 0
 v_mfma_f32_16x16x16_bf16 v[172:175], v[146:147], v[120:121], v[172:175]
 v_mfma_f32_16x16x16_bf16 v[176:179], v[146:147], v[122:123], v[176:179]
 v_cvt_pk_bf16_f32 v48, v164, v165
 v_cvt_pk_bf16_f32 v49, v166, v167
 v_cvt_pk_bf16_f32 v50, v168, v169
 v_cvt_pk_bf16_f32 v51, v170, v171
 buffer_store_dwordx4 v[48:51], v11, s[4:7], s33 offen offset:0 sc1
 s_nop 3
 v_cvt_pk_bf16_f32 v52, v172, v173
 v_cvt_pk_bf16_f32 v53, v174, v175
 v_cvt_pk_bf16_f32 v54, v176, v177
 v_cvt_pk_bf16_f32 v55, v178, v179
 buffer_store_dwordx4 v[52:55], v11, s[4:7], s33 offen offset:2048 sc1
 s_cmp_ge_u32 s33, 268435456
 s_cselect_b32 s34, 268435456, s67
 s_add_u32 s67, s67, 4
 s_lshl_b32 s33, s53, 19
 s_add_u32 s33, s33, s54
 s_xor_b32 s33, s33, 8192
 s_add_u32 s33, s33, 67108864
 s_add_u32 s53, s53, 1
 v_mov_b32 v10, s53
 s_mov_b64 exec, 1
 buffer_store_dword v10, off, s[4:7], s35
 s_mov_b64 exec, -1
 s_waitcnt vmcnt(5)
L_pk_303:
 v_max3_u32 v7, v124, v128, v132
 v_max_u32 v7, v7, v136
 v_cmp_eq_u32 vcc, -1, v7
 s_cbranch_vccnz L_rt_304
 s_mov_b32 s51, 0
 buffer_load_dword v7, off, s[4:7], s17 sc1
 s_waitcnt vmcnt(0)
L_go_305:
 v_cmp_gt_u32 vcc, s53, v7
 s_cbranch_vccnz L_rt_306
 s_mov_b32 s51, 0
 s_nop 15
 s_nop 7
 buffer_load_dwordx4 v[40:43], v2, s[4:7], s57 offen offset:0 sc1
 buffer_load_dwordx4 v[44:47], v2, s[4:7], s57 offen offset:128 sc1
 buffer_load_dwordx4 v[48:51], v2, s[4:7], s57 offen offset:1024 sc1
 buffer_load_dwordx4 v[52:55], v2, s[4:7], s57 offen offset:1152 sc1
 buffer_load_dwordx4 v[56:59], v3, s[4:7], s57 offen offset:0 sc1
L_xm_307:
 s_waitcnt vmcnt(4)
 v_mfma_f32_16x16x32_bf16 v[60:63], v[24:27], v[40:43], 0
 s_waitcnt vmcnt(3)
 v_mfma_f32_16x16x32_bf16 v[64:67], v[24:27], v[44:47], 0
 s_waitcnt vmcnt(2)
 v_mfma_f32_16x16x32_bf16 v[68:71], v[24:27], v[48:51], 0
 v_max3_u32 v7, v40, v44, v48
 v_cvt_pk_bf16_f32 v60, v60, v61
 v_cvt_pk_bf16_f32 v61, v62, v63
 ds_write_b64 v4, v[60:61] offset:0
 s_waitcnt vmcnt(1)
 v_mfma_f32_16x16x32_bf16 v[72:75], v[24:27], v[52:55], 0
 v_cvt_pk_bf16_f32 v64, v64, v65
 v_cvt_pk_bf16_f32 v65, v66, v67
 ds_write_b64 v4, v[64:65] offset:8
 s_waitcnt vmcnt(0)
 v_mfma_f32_16x16x32_bf16 v[76:79], v[24:27], v[56:59], 0
 v_max3_u32 v7, v7, v52, v56
 v_cmp_eq_u32 vcc, -1, v7
 v_cvt_pk_bf16_f32 v68, v68, v69
 v_cvt_pk_bf16_f32 v69, v70, v71
 ds_write_b64 v4, v[68:69] offset:1024
 s_cbranch_vccnz L_rt_308
 v_cvt_pk_bf16_f32 v72, v72, v73
 v_cvt_pk_bf16_f32 v73, v74, v75
 ds_write_b64 v4, v[72:73] offset:1032
 s_nop 0
 v_cvt_pk_bf16_f32 v76, v76, v77
 v_cvt_pk_bf16_f32 v77, v78, v79
 ds_write_b64 v5, v[76:77] offset:0
 s_waitcnt lgkmcnt(0)
 s_barrier
 ds_read_b128 v[56:59], v23 offset:0
 ds_read_b128 v[60:63], v23 offset:32
 ds_read_b128 v[64:67], v23 offset:1024
 s_cmp_ge_u32 s34, 268435456
 s_cbranch_scc1 L_ns_309
 v_mov_b32 v10, 1
 s_mov_b64 exec, 31
 buffer_atomic_add v10, v12, s[4:7], s34 offen
 s_mov_b64 exec, -1
 L_ns_309:
 buffer_load_dword v13, off, s[4:7], s32 sc1
 s_waitcnt lgkmcnt(2)
 v_smfmac_f32_16x16x64_bf16 v[80:83], v[56:59], v[192:199], v8
 ds_read_b128 v[68:71], v23 offset:1056
 v_smfmac_f32_16x16x64_bf16 v[84:87], v[56:59], v[200:207], v8
 ds_read_b128 v[72:75], v23 offset:2048
 s_waitcnt lgkmcnt(3)
 v_smfmac_f32_16x16x64_bf16 v[80:83], v[60:63], v[208:215], v8
 ds_read_b128 v[76:79], v23 offset:2080
 v_smfmac_f32_16x16x64_bf16 v[84:87], v[60:63], v[216:223], v8
 ds_read_b128 v[180:183], v23 offset:3072
 s_waitcnt lgkmcnt(4)
 v_smfmac_f32_16x16x64_bf16 v[80:83], v[64:67], v[224:231], v8
 ds_read_b128 v[40:43], v14 offset:0
 v_smfmac_f32_16x16x64_bf16 v[84:87], v[64:67], v[232:239], v8
 ds_read_b128 v[184:187], v23 offset:3104
 s_waitcnt lgkmcnt(5)
 v_smfmac_f32_16x16x64_bf16 v[80:83], v[68:71], v[240:247], v8
 ds_read_b128 v[44:47], v14 offset:1024
 v_smfmac_f32_16x16x64_bf16 v[84:87], v[68:71], v[248:255], v8
 ds_read_b128 v[56:59], v23 offset:4096
 s_waitcnt lgkmcnt(6)
 v_smfmac_f32_16x16x64_bf16 v[80:83], v[72:75], a[0:7], v8
 ds_read_b128 v[48:51], v14 offset:2048
 v_smfmac_f32_16x16x64_bf16 v[84:87], v[72:75], a[8:15], v8
 ds_read_b128 v[60:63], v23 offset:4128
 s_waitcnt lgkmcnt(7)
 v_smfmac_f32_16x16x64_bf16 v[80:83], v[76:79], a[16:23], v8
 ds_read_b128 v[52:55], v14 offset:3072
 v_smfmac_f32_16x16x64_bf16 v[84:87], v[76:79], a[24:31], v8
 ds_read_b128 v[64:67], v23 offset:5120
 s_waitcnt lgkmcnt(8)
 v_smfmac_f32_16x16x64_bf16 v[80:83], v[180:183], a[32:39], v8
 ds_read_b128 v[148:151], v15 offset:0
 v_smfmac_f32_16x16x64_bf16 v[84:87], v[180:183], a[40:47], v8
 ds_read_b128 v[68:71], v23 offset:5152
 s_waitcnt lgkmcnt(8)
 v_smfmac_f32_16x16x64_bf16 v[80:83], v[184:187], a[48:55], v8
 ds_read_b128 v[152:155], v15 offset:1024
 v_smfmac_f32_16x16x64_bf16 v[84:87], v[184:187], a[56:63], v8
 ds_read_b128 v[72:75], v23 offset:6144
 s_waitcnt lgkmcnt(8)
 v_smfmac_f32_16x16x64_bf16 v[80:83], v[56:59], a[64:71], v8
 ds_read_b128 v[156:159], v15 offset:2048
 v_smfmac_f32_16x16x64_bf16 v[84:87], v[56:59], a[72:79], v8
 ds_read_b128 v[76:79], v23 offset:6176
 s_waitcnt lgkmcnt(8)
 v_smfmac_f32_16x16x64_bf16 v[80:83], v[60:63], a[80:87], v8
 ds_read_b128 v[160:163], v15 offset:3072
 v_smfmac_f32_16x16x64_bf16 v[84:87], v[60:63], a[88:95], v8
 ds_read_b128 v[180:183], v23 offset:7168
 s_waitcnt lgkmcnt(8)
 v_smfmac_f32_16x16x64_bf16 v[80:83], v[64:67], a[96:103], v8
 ds_read_b128 v[164:167], v15 offset:4096
 v_smfmac_f32_16x16x64_bf16 v[84:87], v[64:67], a[104:111], v8
 ds_read_b128 v[184:187], v23 offset:7200
 s_waitcnt lgkmcnt(8)
 v_smfmac_f32_16x16x64_bf16 v[80:83], v[68:71], a[112:119], v8
 ds_read_b128 v[168:171], v15 offset:5120
 v_smfmac_f32_16x16x64_bf16 v[84:87], v[68:71], a[120:127], v8
 ds_read_b128 v[56:59], v23 offset:8192
 s_waitcnt lgkmcnt(8)
 v_smfmac_f32_16x16x64_bf16 v[80:83], v[72:75], a[128:135], v8
 ds_read_b128 v[172:175], v15 offset:6144
 v_smfmac_f32_16x16x64_bf16 v[84:87], v[72:75], a[136:143], v8
 ds_read_b128 v[60:63], v23 offset:8224
 s_waitcnt lgkmcnt(8)
 v_smfmac_f32_16x16x64_bf16 v[80:83], v[76:79], a[144:151], v8
 ds_read_b128 v[176:179], v15 offset:7168
 v_smfmac_f32_16x16x64_bf16 v[84:87], v[76:79], a[152:159], v8
 ds_read_b128 v[64:67], v23 offset:9216
 s_waitcnt lgkmcnt(8)
 v_smfmac_f32_16x16x64_bf16 v[80:83], v[180:183], a[160:167], v8
 ds_read_b128 v[140:143], v17 offset:10240
 v_smfmac_f32_16x16x64_bf16 v[84:87], v[180:183], a[168:175], v8
 ds_read_b128 v[68:71], v23 offset:9248
 s_waitcnt lgkmcnt(8)
 v_smfmac_f32_16x16x64_bf16 v[80:83], v[184:187], a[176:183], v8
 ds_read_b128 v[144:147], v17 offset:11264
 v_smfmac_f32_16x16x64_bf16 v[84:87], v[184:187], a[184:191], v8
 s_waitcnt lgkmcnt(7)
 v_smfmac_f32_16x16x64_bf16 v[80:83], v[56:59], a[192:199], v8
 v_smfmac_f32_16x16x64_bf16 v[84:87], v[56:59], a[200:207], v8
 s_waitcnt lgkmcnt(5)
 v_smfmac_f32_16x16x64_bf16 v[80:83], v[60:63], a[208:215], v8
 v_smfmac_f32_16x16x64_bf16 v[84:87], v[60:63], a[216:223], v8
 s_waitcnt lgkmcnt(3)
 v_smfmac_f32_16x16x64_bf16 v[80:83], v[64:67], a[224:231], v8
 v_smfmac_f32_16x16x64_bf16 v[84:87], v[64:67], a[232:239], v8
 s_waitcnt lgkmcnt(1)
 v_smfmac_f32_16x16x64_bf16 v[80:83], v[68:71], a[240:247], v8
 v_smfmac_f32_16x16x64_bf16 v[84:87], v[68:71], a[248:255], v8
 s_lshl_b32 s16, s53, 19
 s_add_u32 s16, s16, s54
 s_xor_b32 s72, s16, 8192
 s_add_u32 s72, s72, s71
 s_add_u32 s16, s16, s70
 v_cvt_pk_bf16_f32 v36, v80, v81
 v_cvt_pk_bf16_f32 v37, v82, v83
 s_nop 2
 v_cvt_pk_bf16_f32 v38, v84, v85
 v_cvt_pk_bf16_f32 v39, v86, v87
 buffer_store_dwordx4 v[36:39], v18, s[4:7], s61 offen
 ds_write_b128 v16, v[36:39] offset:14336
 s_waitcnt vmcnt(1) lgkmcnt(1)
L_wf_310:
 v_cmp_ge_u32 vcc, s53, v13
 s_cbranch_vccnz L_rt_311
 v_mfma_f32_16x16x32_bf16 v[100:103], v[148:151], v[40:43], v[108:111]
 s_add_u32 m0, s68, 49152
 s_nop 0
 buffer_load_dwordx4 v1, s[4:7], s72 offen offset:0 sc1 nt lds
 ds_read_b128 v[56:59], v19 offset:0
 v_mfma_f32_16x16x32_bf16 v[104:107], v[164:167], v[40:43], v[112:115]
 ds_read_b128 v[60:63], v19 offset:1024
 v_mfma_f32_16x16x32_bf16 v[96:99], v[124:127], v[40:43], 0
 ds_read_b128 v[64:67], v19 offset:2048
 v_mfma_f32_16x16x32_bf16 v[100:103], v[152:155], v[44:47], v[100:103]
 ds_read_b128 v[68:71], v19 offset:3072
 buffer_load_dwordx4 v1, s[4:7], s72 offen offset:1024 sc1 nt lds
 v_mfma_f32_16x16x32_bf16 v[104:107], v[168:171], v[44:47], v[104:107]
 ds_read_b128 v[72:75], v19 offset:4096
 v_mfma_f32_16x16x32_bf16 v[96:99], v[128:131], v[44:47], v[96:99]
 ds_read_b128 v[76:79], v19 offset:5120
 v_mfma_f32_16x16x32_bf16 v[100:103], v[156:159], v[48:51], v[100:103]
 ds_read_b128 v[180:183], v19 offset:6144
 v_mfma_f32_16x16x32_bf16 v[104:107], v[172:175], v[48:51], v[104:107]
 buffer_load_dwordx4 v1, s[4:7], s72 offen offset:2048 sc1 nt lds
 ds_read_b128 v[184:187], v19 offset:7168
 v_mfma_f32_16x16x32_bf16 v[96:99], v[132:135], v[48:51], v[96:99]
 v_mfma_f32_16x16x32_bf16 v[100:103], v[160:163], v[52:55], v[100:103]
 v_mfma_f32_16x16x32_bf16 v[104:107], v[176:179], v[52:55], v[104:107]
 v_mfma_f32_16x16x32_bf16 v[96:99], v[136:139], v[52:55], v[96:99]
 v_mov_b32 v80, 0
 v_mov_b32 v81, 0
 buffer_load_dwordx4 v1, s[4:7], s72 offen offset:3072 sc1 nt lds
 v_mov_b32 v82, 0
 v_mov_b32 v83, 0
 v_mov_b32 v84, 0
 v_mov_b32 v85, 0
 v_mov_b32 v86, 0
 v_mov_b32 v87, 0
 v_cvt_pk_bf16_f32 v7, v100, v101
 s_add_u32 m0, s69, 49152
 s_nop 0
 buffer_load_dwordx4 v1, s[4:7], s16 offen offset:0 sc1 lds
 v_lshlrev_b32 v100, 16, v7
 v_and_b32 v101, 0xffff0000, v7
 v_cvt_pk_bf16_f32 v7, v102, v103
 v_lshlrev_b32 v102, 16, v7
 v_and_b32 v103, 0xffff0000, v7
 v_cvt_pk_bf16_f32 v7, v104, v105
 v_lshlrev_b32 v104, 16, v7
 buffer_load_dwordx4 v1, s[4:7], s16 offen offset:1024 sc1 lds
 v_and_b32 v105, 0xffff0000, v7
 v_cvt_pk_bf16_f32 v7, v106, v107
 v_lshlrev_b32 v106, 16, v7
 v_and_b32 v107, 0xffff0000, v7
 v_cvt_pk_bf16_f32 v7, v98, v99
 v_lshlrev_b32 v98, 16, v7
 v_and_b32 v99, 0xffff0000, v7
 buffer_load_dwordx4 v1, s[4:7], s16 offen offset:2048 sc1 lds
 v_pk_mul_f32 v[100:101], v[100:101], s[64:65] op_sel:[0,1] op_sel_hi:[1,1]
 v_pk_mul_f32 v[102:103], v[102:103], s[64:65] op_sel:[0,1] op_sel_hi:[1,1]
 v_pk_mul_f32 v[104:105], v[104:105], s[64:65] op_sel:[0,1] op_sel_hi:[1,1]
 v_pk_mul_f32 v[106:107], v[106:107], s[64:65] op_sel:[0,1] op_sel_hi:[1,1]
 v_pk_mul_f32 v[98:99], v[98:99], s[64:65] op_sel:[0,1] op_sel_hi:[1,1]
 v_cvt_pk_bf16_f32 v7, v100, v101
 v_lshlrev_b32 v100, 16, v7
 buffer_load_dwordx4 v1, s[4:7], s16 offen offset:3072 sc1 lds
 v_and_b32 v101, 0xffff0000, v7
 v_cvt_pk_bf16_f32 v7, v102, v103
 v_lshlrev_b32 v102, 16, v7
 v_and_b32 v103, 0xffff0000, v7
 v_cvt_pk_bf16_f32 v7, v104, v105
 v_lshlrev_b32 v104, 16, v7
 v_and_b32 v105, 0xffff0000, v7
 s_add_u32 m0, s69, 53248
 s_nop 0
 buffer_load_dwordx4 v6, s[4:7], s16 offen offset:0 sc1 lds
 v_cvt_pk_bf16_f32 v7, v106, v107
 v_lshlrev_b32 v106, 16, v7
 v_and_b32 v107, 0xffff0000, v7
 v_cvt_pk_bf16_f32 v7, v98, v99
 v_lshlrev_b32 v98, 16, v7
 v_and_b32 v99, 0xffff0000, v7
 v_max_f32 v20, v100, v101
 buffer_load_dwordx4 v6, s[4:7], s16 offen offset:1024 sc1 lds
 v_max3_f32 v20, v20, v102, v103
 v_max3_f32 v20, v20, v104, v105
 v_max3_f32 v20, v20, v106, v107
 v_max3_f32 v20, v20, v98, v99
 v_mov_b32 v22, v20
 s_nop 1
 v_permlane16_swap_b32 v20, v22
 buffer_load_dwordx4 v6, s[4:7], s16 offen offset:2048 sc1 lds
 v_max_f32 v20, v20, v22
 v_mov_b32 v22, v20
 s_nop 1
 v_permlane32_swap_b32 v20, v22
 v_max_f32 v20, v20, v22
 v_mul_f32 v22, s66, v20
 v_fma_f32 v100, v100, s66, -v22
 buffer_load_dwordx4 v6, s[4:7], s16 offen offset:3072 sc1 lds
 v_fma_f32 v101, v101, s66, -v22
 v_fma_f32 v102, v102, s66, -v22
 v_fma_f32 v103, v103, s66, -v22
 v_fma_f32 v104, v104, s66, -v22
 v_fma_f32 v105, v105, s66, -v22
 v_fma_f32 v106, v106, s66, -v22
 v_fma_f32 v107, v107, s66, -v22
 buffer_store_dwordx4 v[32:35], v18, s[4:7], s60 offen
 v_fma_f32 v98, v98, s66, -v22
 v_fma_f32 v99, v99, s66, -v22
 v_exp_f32 v100, v100
 v_exp_f32 v101, v101
 v_exp_f32 v102, v102
 v_exp_f32 v103, v103
 v_exp_f32 v104, v104
 buffer_load_dwordx4 v[124:127], v1, s[4:7], s61 offen offset:0 sc1
 v_exp_f32 v105, v105
 v_exp_f32 v106, v106
 v_exp_f32 v107, v107
 v_exp_f32 v98, v98
 v_exp_f32 v99, v99
 v_add_f32 v28, v100, v101
 v_add_f32 v28, v28, v102
 buffer_load_dwordx4 v[128:131], v1, s[4:7], s61 offen offset:1024 sc1
 v_add_f32 v28, v28, v103
 v_add_f32 v28, v28, v104
 v_add_f32 v28, v28, v105
 v_add_f32 v28, v28, v106
 v_add_f32 v28, v28, v107
 v_add_f32 v28, v28, v98
 v_add_f32 v28, v28, v99
 buffer_load_dwordx4 v[132:135], v1, s[4:7], s61 offen offset:2048 sc1
 v_mov_b32 v22, v28
 s_nop 1
 v_permlane16_swap_b32 v28, v22
 v_add_f32 v28, v28, v22
 v_mov_b32 v22, v28
 s_nop 1
 v_permlane32_swap_b32 v28, v22
 buffer_load_dwordx4 v[136:139], v1, s[4:7], s61 offen offset:3072 sc1
 v_add_f32 v28, v28, v22
 v_rcp_f32 v28, v28
 s_nop 0
 v_pk_mul_f32 v[100:101], v[100:101], v[28:29] op_sel_hi:[1,0]
 v_pk_mul_f32 v[102:103], v[102:103], v[28:29] op_sel_hi:[1,0]
 v_pk_mul_f32 v[104:105], v[104:105], v[28:29] op_sel_hi:[1,0]
 v_pk_mul_f32 v[106:107], v[106:107], v[28:29] op_sel_hi:[1,0]
 v_pk_mul_f32 v[98:99], v[98:99], v[28:29] op_sel_hi:[1,0]
 v_cvt_pk_bf16_f32 v116, v100, v101
 v_cvt_pk_bf16_f32 v117, v102, v103
 v_cvt_pk_bf16_f32 v118, v104, v105
 v_cvt_pk_bf16_f32 v119, v106, v107
 v_cvt_pk_bf16_f32 v120, v98, v99
 v_cvt_pk_bf16_f32 v123, v98, v99
 s_waitcnt lgkmcnt(0)
 v_mfma_f32_16x16x32_bf16 v[148:151], v[56:59], v[116:119], 0
 v_mfma_f32_16x16x32_bf16 v[152:155], v[60:63], v[116:119], 0
 v_mfma_f32_16x16x16_bf16 v[148:151], v[140:141], v[120:121], v[148:151]
 v_mfma_f32_16x16x32_bf16 v[156:159], v[64:67], v[116:119], 0
 v_mfma_f32_16x16x16_bf16 v[152:155], v[140:141], v[122:123], v[152:155]
 v_mfma_f32_16x16x32_bf16 v[160:163], v[68:71], v[116:119], 0
 v_mfma_f32_16x16x16_bf16 v[156:159], v[142:143], v[120:121], v[156:159]
 v_mfma_f32_16x16x32_bf16 v[164:167], v[72:75], v[116:119], 0
 v_mfma_f32_16x16x16_bf16 v[160:163], v[142:143], v[122:123], v[160:163]
 v_cvt_pk_bf16_f32 v40, v148, v149
 v_cvt_pk_bf16_f32 v41, v150, v151
 v_cvt_pk_bf16_f32 v42, v152, v153
 v_cvt_pk_bf16_f32 v43, v154, v155
 buffer_store_dwordx4 v[40:43], v11, s[4:7], s33 offen offset:0 sc1
 v_mfma_f32_16x16x32_bf16 v[168:171], v[76:79], v[116:119], 0
 v_mfma_f32_16x16x16_bf16 v[164:167], v[144:145], v[120:121], v[164:167]
 v_mfma_f32_16x16x32_bf16 v[172:175], v[180:183], v[116:119], 0
 v_mfma_f32_16x16x16_bf16 v[168:171], v[144:145], v[122:123], v[168:171]
 v_cvt_pk_bf16_f32 v44, v156, v157
 v_cvt_pk_bf16_f32 v45, v158, v159
 v_cvt_pk_bf16_f32 v46, v160, v161
 v_cvt_pk_bf16_f32 v47, v162, v163
 buffer_store_dwordx4 v[44:47], v11, s[4:7], s33 offen offset:2048 sc1
 s_add_u32 s33, s33, 4096
 v_mfma_f32_16x16x32_bf16 v[176:179], v[184:187], v[116:119], 0
 v_mfma_f32_16x16x16_bf16 v[172:175], v[146:147], v[120:121], v[172:175]
 v_mfma_f32_16x16x16_bf16 v[176:179], v[146:147], v[122:123], v[176:179]
 v_cvt_pk_bf16_f32 v48, v164, v165
 v_cvt_pk_bf16_f32 v49, v166, v167
 v_cvt_pk_bf16_f32 v50, v168, v169
 v_cvt_pk_bf16_f32 v51, v170, v171
 buffer_store_dwordx4 v[48:51], v11, s[4:7], s33 offen offset:0 sc1
 s_nop 3
 v_cvt_pk_bf16_f32 v52, v172, v173
 v_cvt_pk_bf16_f32 v53, v174, v175
 v_cvt_pk_bf16_f32 v54, v176, v177
 v_cvt_pk_bf16_f32 v55, v178, v179
 buffer_store_dwordx4 v[52:55], v11, s[4:7], s33 offen offset:2048 sc1
 s_cmp_ge_u32 s33, 268435456
 s_cselect_b32 s34, 268435456, s67
 s_add_u32 s67, s67, 4
 s_lshl_b32 s33, s53, 19
 s_add_u32 s33, s33, s54
 s_xor_b32 s33, s33, 8192
 s_add_u32 s33, s33, 67108864
 s_add_u32 s53, s53, 1
 v_mov_b32 v10, s53
 s_mov_b64 exec, 1
 buffer_store_dword v10, off, s[4:7], s35
 s_mov_b64 exec, -1
 s_waitcnt vmcnt(5)
L_pk_312:
 v_max3_u32 v7, v124, v128, v132
 v_max_u32 v7, v7, v136
 v_cmp_eq_u32 vcc, -1, v7
 s_cbranch_vccnz L_rt_313
 s_mov_b32 s51, 0
 buffer_load_dword v7, off, s[4:7], s17 sc1
 s_waitcnt vmcnt(0)
L_go_314:
 v_cmp_gt_u32 vcc, s53, v7
 s_cbranch_vccnz L_rt_315
 s_mov_b32 s51, 0
 s_nop 15
 s_nop 7
 buffer_load_dwordx4 v[40:43], v2, s[4:7], s58 offen offset:0 sc1
 buffer_load_dwordx4 v[44:47], v2, s[4:7], s58 offen offset:128 sc1
 buffer_load_dwordx4 v[48:51], v2, s[4:7], s58 offen offset:1024 sc1
 buffer_load_dwordx4 v[52:55], v2, s[4:7], s58 offen offset:1152 sc1
 buffer_load_dwordx4 v[56:59], v3, s[4:7], s58 offen offset:0 sc1
L_xm_316:
 s_waitcnt vmcnt(4)
 v_mfma_f32_16x16x32_bf16 v[60:63], v[24:27], v[40:43], 0
 s_waitcnt vmcnt(3)
 v_mfma_f32_16x16x32_bf16 v[64:67], v[24:27], v[44:47], 0
 s_waitcnt vmcnt(2)
 v_mfma_f32_16x16x32_bf16 v[68:71], v[24:27], v[48:51], 0
 v_max3_u32 v7, v40, v44, v48
 v_cvt_pk_bf16_f32 v60, v60, v61
 v_cvt_pk_bf16_f32 v61, v62, v63
 ds_write_b64 v4, v[60:61] offset:0
 s_waitcnt vmcnt(1)
 v_mfma_f32_16x16x32_bf16 v[72:75], v[24:27], v[52:55], 0
 v_cvt_pk_bf16_f32 v64, v64, v65
 v_cvt_pk_bf16_f32 v65, v66, v67
 ds_write_b64 v4, v[64:65] offset:8
 s_waitcnt vmcnt(0)
 v_mfma_f32_16x16x32_bf16 v[76:79], v[24:27], v[56:59], 0
 v_max3_u32 v7, v7, v52, v56
 v_cmp_eq_u32 vcc, -1, v7
 v_cvt_pk_bf16_f32 v68, v68, v69
 v_cvt_pk_bf16_f32 v69, v70, v71
 ds_write_b64 v4, v[68:69] offset:1024
 s_cbranch_vccnz L_rt_317
 v_cvt_pk_bf16_f32 v72, v72, v73
 v_cvt_pk_bf16_f32 v73, v74, v75
 ds_write_b64 v4, v[72:73] offset:1032
 s_nop 0
 v_cvt_pk_bf16_f32 v76, v76, v77
 v_cvt_pk_bf16_f32 v77, v78, v79
 ds_write_b64 v5, v[76:77] offset:0
 s_waitcnt lgkmcnt(0)
 s_barrier
 ds_read_b128 v[56:59], v23 offset:0
 ds_read_b128 v[60:63], v23 offset:32
 ds_read_b128 v[64:67], v23 offset:1024
 s_cmp_ge_u32 s34, 268435456
 s_cbranch_scc1 L_ns_318
 v_mov_b32 v10, 1
 s_mov_b64 exec, 31
 buffer_atomic_add v10, v12, s[4:7], s34 offen
 s_mov_b64 exec, -1
 L_ns_318:
 buffer_load_dword v13, off, s[4:7], s32 sc1
 s_waitcnt lgkmcnt(2)
 v_smfmac_f32_16x16x64_bf16 v[80:83], v[56:59], v[192:199], v8
 ds_read_b128 v[68:71], v23 offset:1056
 v_smfmac_f32_16x16x64_bf16 v[84:87], v[56:59], v[200:207], v8
 ds_read_b128 v[72:75], v23 offset:2048
 s_waitcnt lgkmcnt(3)
 v_smfmac_f32_16x16x64_bf16 v[80:83], v[60:63], v[208:215], v8
 ds_read_b128 v[76:79], v23 offset:2080
 v_smfmac_f32_16x16x64_bf16 v[84:87], v[60:63], v[216:223], v8
 ds_read_b128 v[180:183], v23 offset:3072
 s_waitcnt lgkmcnt(4)
 v_smfmac_f32_16x16x64_bf16 v[80:83], v[64:67], v[224:231], v8
 ds_read_b128 v[40:43], v14 offset:49152
 v_smfmac_f32_16x16x64_bf16 v[84:87], v[64:67], v[232:239], v8
 ds_read_b128 v[184:187], v23 offset:3104
 s_waitcnt lgkmcnt(5)
 v_smfmac_f32_16x16x64_bf16 v[80:83], v[68:71], v[240:247], v8
 ds_read_b128 v[44:47], v14 offset:50176
 v_smfmac_f32_16x16x64_bf16 v[84:87], v[68:71], v[248:255], v8
 ds_read_b128 v[56:59], v23 offset:4096
 s_waitcnt lgkmcnt(6)
 v_smfmac_f32_16x16x64_bf16 v[80:83], v[72:75], a[0:7], v8
 ds_read_b128 v[48:51], v14 offset:51200
 v_smfmac_f32_16x16x64_bf16 v[84:87], v[72:75], a[8:15], v8
 ds_read_b128 v[60:63], v23 offset:4128
 s_waitcnt lgkmcnt(7)
 v_smfmac_f32_16x16x64_bf16 v[80:83], v[76:79], a[16:23], v8
 ds_read_b128 v[52:55], v14 offset:52224
 v_smfmac_f32_16x16x64_bf16 v[84:87], v[76:79], a[24:31], v8
 ds_read_b128 v[64:67], v23 offset:5120
 s_waitcnt lgkmcnt(8)
 v_smfmac_f32_16x16x64_bf16 v[80:83], v[180:183], a[32:39], v8
 ds_read_b128 v[148:151], v15 offset:49152
 v_smfmac_f32_16x16x64_bf16 v[84:87], v[180:183], a[40:47], v8
 ds_read_b128 v[68:71], v23 offset:5152
 s_waitcnt lgkmcnt(8)
 v_smfmac_f32_16x16x64_bf16 v[80:83], v[184:187], a[48:55], v8
 ds_read_b128 v[152:155], v15 offset:50176
 v_smfmac_f32_16x16x64_bf16 v[84:87], v[184:187], a[56:63], v8
 ds_read_b128 v[72:75], v23 offset:6144
 s_waitcnt lgkmcnt(8)
 v_smfmac_f32_16x16x64_bf16 v[80:83], v[56:59], a[64:71], v8
 ds_read_b128 v[156:159], v15 offset:51200
 v_smfmac_f32_16x16x64_bf16 v[84:87], v[56:59], a[72:79], v8
 ds_read_b128 v[76:79], v23 offset:6176
 s_waitcnt lgkmcnt(8)
 v_smfmac_f32_16x16x64_bf16 v[80:83], v[60:63], a[80:87], v8
 ds_read_b128 v[160:163], v15 offset:52224
 v_smfmac_f32_16x16x64_bf16 v[84:87], v[60:63], a[88:95], v8
 ds_read_b128 v[180:183], v23 offset:7168
 s_waitcnt lgkmcnt(8)
 v_smfmac_f32_16x16x64_bf16 v[80:83], v[64:67], a[96:103], v8
 ds_read_b128 v[164:167], v15 offset:53248
 v_smfmac_f32_16x16x64_bf16 v[84:87], v[64:67], a[104:111], v8
 ds_read_b128 v[184:187], v23 offset:7200
 s_waitcnt lgkmcnt(8)
 v_smfmac_f32_16x16x64_bf16 v[80:83], v[68:71], a[112:119], v8
 ds_read_b128 v[168:171], v15 offset:54272
 v_smfmac_f32_16x16x64_bf16 v[84:87], v[68:71], a[120:127], v8
 ds_read_b128 v[56:59], v23 offset:8192
 s_waitcnt lgkmcnt(8)
 v_smfmac_f32_16x16x64_bf16 v[80:83], v[72:75], a[128:135], v8
 ds_read_b128 v[172:175], v15 offset:55296
 v_smfmac_f32_16x16x64_bf16 v[84:87], v[72:75], a[136:143], v8
 ds_read_b128 v[60:63], v23 offset:8224
 s_waitcnt lgkmcnt(8)
 v_smfmac_f32_16x16x64_bf16 v[80:83], v[76:79], a[144:151], v8
 ds_read_b128 v[176:179], v15 offset:56320
 v_smfmac_f32_16x16x64_bf16 v[84:87], v[76:79], a[152:159], v8
 ds_read_b128 v[64:67], v23 offset:9216
 s_waitcnt lgkmcnt(8)
 v_smfmac_f32_16x16x64_bf16 v[80:83], v[180:183], a[160:167], v8
 ds_read_b128 v[140:143], v17 offset:14336
 v_smfmac_f32_16x16x64_bf16 v[84:87], v[180:183], a[168:175], v8
 ds_read_b128 v[68:71], v23 offset:9248
 s_waitcnt lgkmcnt(8)
 v_smfmac_f32_16x16x64_bf16 v[80:83], v[184:187], a[176:183], v8
 ds_read_b128 v[144:147], v17 offset:15360
 v_smfmac_f32_16x16x64_bf16 v[84:87], v[184:187], a[184:191], v8
 s_waitcnt lgkmcnt(7)
 v_smfmac_f32_16x16x64_bf16 v[80:83], v[56:59], a[192:199], v8
 v_smfmac_f32_16x16x64_bf16 v[84:87], v[56:59], a[200:207], v8
 s_waitcnt lgkmcnt(5)
 v_smfmac_f32_16x16x64_bf16 v[80:83], v[60:63], a[208:215], v8
 v_smfmac_f32_16x16x64_bf16 v[84:87], v[60:63], a[216:223], v8
 s_waitcnt lgkmcnt(3)
 v_smfmac_f32_16x16x64_bf16 v[80:83], v[64:67], a[224:231], v8
 v_smfmac_f32_16x16x64_bf16 v[84:87], v[64:67], a[232:239], v8
 s_waitcnt lgkmcnt(1)
 v_smfmac_f32_16x16x64_bf16 v[80:83], v[68:71], a[240:247], v8
 v_smfmac_f32_16x16x64_bf16 v[84:87], v[68:71], a[248:255], v8
 s_lshl_b32 s16, s53, 19
 s_add_u32 s16, s16, s54
 s_xor_b32 s72, s16, 8192
 s_add_u32 s72, s72, s71
 s_add_u32 s16, s16, s70
 v_cvt_pk_bf16_f32 v36, v80, v81
 v_cvt_pk_bf16_f32 v37, v82, v83
 s_nop 2
 v_cvt_pk_bf16_f32 v38, v84, v85
 v_cvt_pk_bf16_f32 v39, v86, v87
 buffer_store_dwordx4 v[36:39], v18, s[4:7], s62 offen
 ds_write_b128 v16, v[36:39] offset:10240
 s_waitcnt vmcnt(1) lgkmcnt(1)
L_wf_319:
 v_cmp_ge_u32 vcc, s53, v13
 s_cbranch_vccnz L_rt_320
 v_mfma_f32_16x16x32_bf16 v[100:103], v[148:151], v[40:43], v[108:111]
 s_add_u32 m0, s68, 0
 s_nop 0
 buffer_load_dwordx4 v1, s[4:7], s72 offen offset:0 sc1 nt lds
 ds_read_b128 v[56:59], v19 offset:49152
 v_mfma_f32_16x16x32_bf16 v[104:107], v[164:167], v[40:43], v[112:115]
 ds_read_b128 v[60:63], v19 offset:50176
 v_mfma_f32_16x16x32_bf16 v[96:99], v[124:127], v[40:43], 0
 ds_read_b128 v[64:67], v19 offset:51200
 v_mfma_f32_16x16x32_bf16 v[100:103], v[152:155], v[44:47], v[100:103]
 ds_read_b128 v[68:71], v19 offset:52224
 buffer_load_dwordx4 v1, s[4:7], s72 offen offset:1024 sc1 nt lds
 v_mfma_f32_16x16x32_bf16 v[104:107], v[168:171], v[44:47], v[104:107]
 ds_read_b128 v[72:75], v19 offset:53248
 v_mfma_f32_16x16x32_bf16 v[96:99], v[128:131], v[44:47], v[96:99]
 ds_read_b128 v[76:79], v19 offset:54272
 v_mfma_f32_16x16x32_bf16 v[100:103], v[156:159], v[48:51], v[100:103]
 ds_read_b128 v[180:183], v19 offset:55296
 v_mfma_f32_16x16x32_bf16 v[104:107], v[172:175], v[48:51], v[104:107]
 buffer_load_dwordx4 v1, s[4:7], s72 offen offset:2048 sc1 nt lds
 ds_read_b128 v[184:187], v19 offset:56320
 v_mfma_f32_16x16x32_bf16 v[96:99], v[132:135], v[48:51], v[96:99]
 v_mfma_f32_16x16x32_bf16 v[100:103], v[160:163], v[52:55], v[100:103]
 v_mfma_f32_16x16x32_bf16 v[104:107], v[176:179], v[52:55], v[104:107]
 v_mfma_f32_16x16x32_bf16 v[96:99], v[136:139], v[52:55], v[96:99]
 v_mov_b32 v80, 0
 v_mov_b32 v81, 0
 buffer_load_dwordx4 v1, s[4:7], s72 offen offset:3072 sc1 nt lds
 v_mov_b32 v82, 0
 v_mov_b32 v83, 0
 v_mov_b32 v84, 0
 v_mov_b32 v85, 0
 v_mov_b32 v86, 0
 v_mov_b32 v87, 0
 v_cvt_pk_bf16_f32 v7, v100, v101
 s_add_u32 m0, s69, 0
 s_nop 0
 buffer_load_dwordx4 v1, s[4:7], s16 offen offset:0 sc1 lds
 v_lshlrev_b32 v100, 16, v7
 v_and_b32 v101, 0xffff0000, v7
 v_cvt_pk_bf16_f32 v7, v102, v103
 v_lshlrev_b32 v102, 16, v7
 v_and_b32 v103, 0xffff0000, v7
 v_cvt_pk_bf16_f32 v7, v104, v105
 v_lshlrev_b32 v104, 16, v7
 buffer_load_dwordx4 v1, s[4:7], s16 offen offset:1024 sc1 lds
 v_and_b32 v105, 0xffff0000, v7
 v_cvt_pk_bf16_f32 v7, v106, v107
 v_lshlrev_b32 v106, 16, v7
 v_and_b32 v107, 0xffff0000, v7
 v_cvt_pk_bf16_f32 v7, v98, v99
 v_lshlrev_b32 v98, 16, v7
 v_and_b32 v99, 0xffff0000, v7
 buffer_load_dwordx4 v1, s[4:7], s16 offen offset:2048 sc1 lds
 v_pk_mul_f32 v[100:101], v[100:101], s[64:65] op_sel:[0,1] op_sel_hi:[1,1]
 v_pk_mul_f32 v[102:103], v[102:103], s[64:65] op_sel:[0,1] op_sel_hi:[1,1]
 v_pk_mul_f32 v[104:105], v[104:105], s[64:65] op_sel:[0,1] op_sel_hi:[1,1]
 v_pk_mul_f32 v[106:107], v[106:107], s[64:65] op_sel:[0,1] op_sel_hi:[1,1]
 v_pk_mul_f32 v[98:99], v[98:99], s[64:65] op_sel:[0,1] op_sel_hi:[1,1]
 v_cvt_pk_bf16_f32 v7, v100, v101
 v_lshlrev_b32 v100, 16, v7
 buffer_load_dwordx4 v1, s[4:7], s16 offen offset:3072 sc1 lds
 v_and_b32 v101, 0xffff0000, v7
 v_cvt_pk_bf16_f32 v7, v102, v103
 v_lshlrev_b32 v102, 16, v7
 v_and_b32 v103, 0xffff0000, v7
 v_cvt_pk_bf16_f32 v7, v104, v105
 v_lshlrev_b32 v104, 16, v7
 v_and_b32 v105, 0xffff0000, v7
 s_add_u32 m0, s69, 4096
 s_nop 0
 buffer_load_dwordx4 v6, s[4:7], s16 offen offset:0 sc1 lds
 v_cvt_pk_bf16_f32 v7, v106, v107
 v_lshlrev_b32 v106, 16, v7
 v_and_b32 v107, 0xffff0000, v7
 v_cvt_pk_bf16_f32 v7, v98, v99
 v_lshlrev_b32 v98, 16, v7
 v_and_b32 v99, 0xffff0000, v7
 v_max_f32 v20, v100, v101
 buffer_load_dwordx4 v6, s[4:7], s16 offen offset:1024 sc1 lds
 v_max3_f32 v20, v20, v102, v103
 v_max3_f32 v20, v20, v104, v105
 v_max3_f32 v20, v20, v106, v107
 v_max3_f32 v20, v20, v98, v99
 v_mov_b32 v22, v20
 s_nop 1
 v_permlane16_swap_b32 v20, v22
 buffer_load_dwordx4 v6, s[4:7], s16 offen offset:2048 sc1 lds
 v_max_f32 v20, v20, v22
 v_mov_b32 v22, v20
 s_nop 1
 v_permlane32_swap_b32 v20, v22
 v_max_f32 v20, v20, v22
 v_mul_f32 v22, s66, v20
 v_fma_f32 v100, v100, s66, -v22
 buffer_load_dwordx4 v6, s[4:7], s16 offen offset:3072 sc1 lds
 v_fma_f32 v101, v101, s66, -v22
 v_fma_f32 v102, v102, s66, -v22
 v_fma_f32 v103, v103, s66, -v22
 v_fma_f32 v104, v104, s66, -v22
 v_fma_f32 v105, v105, s66, -v22
 v_fma_f32 v106, v106, s66, -v22
 v_fma_f32 v107, v107, s66, -v22
 buffer_store_dwordx4 v[32:35], v18, s[4:7], s61 offen
 v_fma_f32 v98, v98, s66, -v22
 v_fma_f32 v99, v99, s66, -v22
 v_exp_f32 v100, v100
 v_exp_f32 v101, v101
 v_exp_f32 v102, v102
 v_exp_f32 v103, v103
 v_exp_f32 v104, v104
 buffer_load_dwordx4 v[124:127], v1, s[4:7], s62 offen offset:0 sc1
 v_exp_f32 v105, v105
 v_exp_f32 v106, v106
 v_exp_f32 v107, v107
 v_exp_f32 v98, v98
 v_exp_f32 v99, v99
 v_add_f32 v28, v100, v101
 v_add_f32 v28, v28, v102
 buffer_load_dwordx4 v[128:131], v1, s[4:7], s62 offen offset:1024 sc1
 v_add_f32 v28, v28, v103
 v_add_f32 v28, v28, v104
 v_add_f32 v28, v28, v105
 v_add_f32 v28, v28, v106
 v_add_f32 v28, v28, v107
 v_add_f32 v28, v28, v98
 v_add_f32 v28, v28, v99
 buffer_load_dwordx4 v[132:135], v1, s[4:7], s62 offen offset:2048 sc1
 v_mov_b32 v22, v28
 s_nop 1
 v_permlane16_swap_b32 v28, v22
 v_add_f32 v28, v28, v22
 v_mov_b32 v22, v28
 s_nop 1
 v_permlane32_swap_b32 v28, v22
 buffer_load_dwordx4 v[136:139], v1, s[4:7], s62 offen offset:3072 sc1
 v_add_f32 v28, v28, v22
 v_rcp_f32 v28, v28
 s_nop 0
 v_pk_mul_f32 v[100:101], v[100:101], v[28:29] op_sel_hi:[1,0]
 v_pk_mul_f32 v[102:103], v[102:103], v[28:29] op_sel_hi:[1,0]
 v_pk_mul_f32 v[104:105], v[104:105], v[28:29] op_sel_hi:[1,0]
 v_pk_mul_f32 v[106:107], v[106:107], v[28:29] op_sel_hi:[1,0]
 v_pk_mul_f32 v[98:99], v[98:99], v[28:29] op_sel_hi:[1,0]
 v_cvt_pk_bf16_f32 v116, v100, v101
 v_cvt_pk_bf16_f32 v117, v102, v103
 v_cvt_pk_bf16_f32 v118, v104, v105
 v_cvt_pk_bf16_f32 v119, v106, v107
 v_cvt_pk_bf16_f32 v120, v98, v99
 v_cvt_pk_bf16_f32 v123, v98, v99
 s_waitcnt lgkmcnt(0)
 v_mfma_f32_16x16x32_bf16 v[148:151], v[56:59], v[116:119], 0
 v_mfma_f32_16x16x32_bf16 v[152:155], v[60:63], v[116:119], 0
 v_mfma_f32_16x16x16_bf16 v[148:151], v[140:141], v[120:121], v[148:151]
 v_mfma_f32_16x16x32_bf16 v[156:159], v[64:67], v[116:119], 0
 v_mfma_f32_16x16x16_bf16 v[152:155], v[140:141], v[122:123], v[152:155]
 v_mfma_f32_16x16x32_bf16 v[160:163], v[68:71], v[116:119], 0
 v_mfma_f32_16x16x16_bf16 v[156:159], v[142:143], v[120:121], v[156:159]
 v_mfma_f32_16x16x32_bf16 v[164:167], v[72:75], v[116:119], 0
 v_mfma_f32_16x16x16_bf16 v[160:163], v[142:143], v[122:123], v[160:163]
 v_cvt_pk_bf16_f32 v40, v148, v149
 v_cvt_pk_bf16_f32 v41, v150, v151
 v_cvt_pk_bf16_f32 v42, v152, v153
 v_cvt_pk_bf16_f32 v43, v154, v155
 buffer_store_dwordx4 v[40:43], v11, s[4:7], s33 offen offset:0 sc1
 v_mfma_f32_16x16x32_bf16 v[168:171], v[76:79], v[116:119], 0
 v_mfma_f32_16x16x16_bf16 v[164:167], v[144:145], v[120:121], v[164:167]
 v_mfma_f32_16x16x32_bf16 v[172:175], v[180:183], v[116:119], 0
 v_mfma_f32_16x16x16_bf16 v[168:171], v[144:145], v[122:123], v[168:171]
 v_cvt_pk_bf16_f32 v44, v156, v157
 v_cvt_pk_bf16_f32 v45, v158, v159
 v_cvt_pk_bf16_f32 v46, v160, v161
 v_cvt_pk_bf16_f32 v47, v162, v163
 buffer_store_dwordx4 v[44:47], v11, s[4:7], s33 offen offset:2048 sc1
 s_add_u32 s33, s33, 4096
 v_mfma_f32_16x16x32_bf16 v[176:179], v[184:187], v[116:119], 0
 v_mfma_f32_16x16x16_bf16 v[172:175], v[146:147], v[120:121], v[172:175]
 v_mfma_f32_16x16x16_bf16 v[176:179], v[146:147], v[122:123], v[176:179]
 v_cvt_pk_bf16_f32 v48, v164, v165
 v_cvt_pk_bf16_f32 v49, v166, v167
 v_cvt_pk_bf16_f32 v50, v168, v169
 v_cvt_pk_bf16_f32 v51, v170, v171
 buffer_store_dwordx4 v[48:51], v11, s[4:7], s33 offen offset:0 sc1
 s_nop 3
 v_cvt_pk_bf16_f32 v52, v172, v173
 v_cvt_pk_bf16_f32 v53, v174, v175
 v_cvt_pk_bf16_f32 v54, v176, v177
 v_cvt_pk_bf16_f32 v55, v178, v179
 buffer_store_dwordx4 v[52:55], v11, s[4:7], s33 offen offset:2048 sc1
 s_cmp_ge_u32 s33, 268435456
 s_cselect_b32 s34, 268435456, s67
 s_add_u32 s67, s67, 4
 s_lshl_b32 s33, s53, 19
 s_add_u32 s33, s33, s54
 s_xor_b32 s33, s33, 8192
 s_add_u32 s33, s33, 67108864
 s_add_u32 s53, s53, 1
 v_mov_b32 v10, s53
 s_mov_b64 exec, 1
 buffer_store_dword v10, off, s[4:7], s35
 s_mov_b64 exec, -1
 s_waitcnt vmcnt(5)
L_pk_321:
 v_max3_u32 v7, v124, v128, v132
 v_max_u32 v7, v7, v136
 v_cmp_eq_u32 vcc, -1, v7
 s_cbranch_vccnz L_rt_322
 s_mov_b32 s51, 0
 buffer_load_dword v7, off, s[4:7], s17 sc1
 s_waitcnt vmcnt(0)
L_go_323:
 v_cmp_gt_u32 vcc, s53, v7
 s_cbranch_vccnz L_rt_324
 s_mov_b32 s51, 0
 s_nop 15
 s_nop 7
 buffer_load_dwordx4 v[40:43], v2, s[4:7], s59 offen offset:0 sc1
 buffer_load_dwordx4 v[44:47], v2, s[4:7], s59 offen offset:128 sc1
 buffer_load_dwordx4 v[48:51], v2, s[4:7], s59 offen offset:1024 sc1
 buffer_load_dwordx4 v[52:55], v2, s[4:7], s59 offen offset:1152 sc1
 buffer_load_dwordx4 v[56:59], v3, s[4:7], s59 offen offset:0 sc1
L_xm_325:
 s_waitcnt vmcnt(4)
 v_mfma_f32_16x16x32_bf16 v[60:63], v[24:27], v[40:43], 0
 s_waitcnt vmcnt(3)
 v_mfma_f32_16x16x32_bf16 v[64:67], v[24:27], v[44:47], 0
 s_waitcnt vmcnt(2)
 v_mfma_f32_16x16x32_bf16 v[68:71], v[24:27], v[48:51], 0
 v_max3_u32 v7, v40, v44, v48
 v_cvt_pk_bf16_f32 v60, v60, v61
 v_cvt_pk_bf16_f32 v61, v62, v63
 ds_write_b64 v4, v[60:61] offset:0
 s_waitcnt vmcnt(1)
 v_mfma_f32_16x16x32_bf16 v[72:75], v[24:27], v[52:55], 0
 v_cvt_pk_bf16_f32 v64, v64, v65
 v_cvt_pk_bf16_f32 v65, v66, v67
 ds_write_b64 v4, v[64:65] offset:8
 s_waitcnt vmcnt(0)
 v_mfma_f32_16x16x32_bf16 v[76:79], v[24:27], v[56:59], 0
 v_max3_u32 v7, v7, v52, v56
 v_cmp_eq_u32 vcc, -1, v7
 v_cvt_pk_bf16_f32 v68, v68, v69
 v_cvt_pk_bf16_f32 v69, v70, v71
 ds_write_b64 v4, v[68:69] offset:1024
 s_cbranch_vccnz L_rt_326
 v_cvt_pk_bf16_f32 v72, v72, v73
 v_cvt_pk_bf16_f32 v73, v74, v75
 ds_write_b64 v4, v[72:73] offset:1032
 s_nop 0
 v_cvt_pk_bf16_f32 v76, v76, v77
 v_cvt_pk_bf16_f32 v77, v78, v79
 ds_write_b64 v5, v[76:77] offset:0
 s_waitcnt lgkmcnt(0)
 s_barrier
 ds_read_b128 v[56:59], v23 offset:0
 ds_read_b128 v[60:63], v23 offset:32
 ds_read_b128 v[64:67], v23 offset:1024
 s_cmp_ge_u32 s34, 268435456
 s_cbranch_scc1 L_ns_327
 v_mov_b32 v10, 1
 s_mov_b64 exec, 31
 buffer_atomic_add v10, v12, s[4:7], s34 offen
 s_mov_b64 exec, -1
 L_ns_327:
 buffer_load_dword v13, off, s[4:7], s32 sc1
 s_waitcnt lgkmcnt(2)
 v_smfmac_f32_16x16x64_bf16 v[80:83], v[56:59], v[192:199], v8
 ds_read_b128 v[68:71], v23 offset:1056
 v_smfmac_f32_16x16x64_bf16 v[84:87], v[56:59], v[200:207], v8
 ds_read_b128 v[72:75], v23 offset:2048
 s_waitcnt lgkmcnt(3)
 v_smfmac_f32_16x16x64_bf16 v[80:83], v[60:63], v[208:215], v8
 ds_read_b128 v[76:79], v23 offset:2080
 v_smfmac_f32_16x16x64_bf16 v[84:87], v[60:63], v[216:223], v8
 ds_read_b128 v[180:183], v23 offset:3072
 s_waitcnt lgkmcnt(4)
 v_smfmac_f32_16x16x64_bf16 v[80:83], v[64:67], v[224:231], v8
 ds_read_b128 v[40:43], v14 offset:0
 v_smfmac_f32_16x16x64_bf16 v[84:87], v[64:67], v[232:239], v8
 ds_read_b128 v[184:187], v23 offset:3104
 s_waitcnt lgkmcnt(5)
 v_smfmac_f32_16x16x64_bf16 v[80:83], v[68:71], v[240:247], v8
 ds_read_b128 v[44:47], v14 offset:1024
 v_smfmac_f32_16x16x64_bf16 v[84:87], v[68:71], v[248:255], v8
 ds_read_b128 v[56:59], v23 offset:4096
 s_waitcnt lgkmcnt(6)
 v_smfmac_f32_16x16x64_bf16 v[80:83], v[72:75], a[0:7], v8
 ds_read_b128 v[48:51], v14 offset:2048
 v_smfmac_f32_16x16x64_bf16 v[84:87], v[72:75], a[8:15], v8
 ds_read_b128 v[60:63], v23 offset:4128
 s_waitcnt lgkmcnt(7)
 v_smfmac_f32_16x16x64_bf16 v[80:83], v[76:79], a[16:23], v8
 ds_read_b128 v[52:55], v14 offset:3072
 v_smfmac_f32_16x16x64_bf16 v[84:87], v[76:79], a[24:31], v8
 ds_read_b128 v[64:67], v23 offset:5120
 s_waitcnt lgkmcnt(8)
 v_smfmac_f32_16x16x64_bf16 v[80:83], v[180:183], a[32:39], v8
 ds_read_b128 v[148:151], v15 offset:0
 v_smfmac_f32_16x16x64_bf16 v[84:87], v[180:183], a[40:47], v8
 ds_read_b128 v[68:71], v23 offset:5152
 s_waitcnt lgkmcnt(8)
 v_smfmac_f32_16x16x64_bf16 v[80:83], v[184:187], a[48:55], v8
 ds_read_b128 v[152:155], v15 offset:1024
 v_smfmac_f32_16x16x64_bf16 v[84:87], v[184:187], a[56:63], v8
 ds_read_b128 v[72:75], v23 offset:6144
 s_waitcnt lgkmcnt(8)
 v_smfmac_f32_16x16x64_bf16 v[80:83], v[56:59], a[64:71], v8
 ds_read_b128 v[156:159], v15 offset:2048
 v_smfmac_f32_16x16x64_bf16 v[84:87], v[56:59], a[72:79], v8
 ds_read_b128 v[76:79], v23 offset:6176
 s_waitcnt lgkmcnt(8)
 v_smfmac_f32_16x16x64_bf16 v[80:83], v[60:63], a[80:87], v8
 ds_read_b128 v[160:163], v15 offset:3072
 v_smfmac_f32_16x16x64_bf16 v[84:87], v[60:63], a[88:95], v8
 ds_read_b128 v[180:183], v23 offset:7168
 s_waitcnt lgkmcnt(8)
 v_smfmac_f32_16x16x64_bf16 v[80:83], v[64:67], a[96:103], v8
 ds_read_b128 v[164:167], v15 offset:4096
 v_smfmac_f32_16x16x64_bf16 v[84:87], v[64:67], a[104:111], v8
 ds_read_b128 v[184:187], v23 offset:7200
 s_waitcnt lgkmcnt(8)
 v_smfmac_f32_16x16x64_bf16 v[80:83], v[68:71], a[112:119], v8
 ds_read_b128 v[168:171], v15 offset:5120
 v_smfmac_f32_16x16x64_bf16 v[84:87], v[68:71], a[120:127], v8
 ds_read_b128 v[56:59], v23 offset:8192
 s_waitcnt lgkmcnt(8)
 v_smfmac_f32_16x16x64_bf16 v[80:83], v[72:75], a[128:135], v8
 ds_read_b128 v[172:175], v15 offset:6144
 v_smfmac_f32_16x16x64_bf16 v[84:87], v[72:75], a[136:143], v8
 ds_read_b128 v[60:63], v23 offset:8224
 s_waitcnt lgkmcnt(8)
 v_smfmac_f32_16x16x64_bf16 v[80:83], v[76:79], a[144:151], v8
 ds_read_b128 v[176:179], v15 offset:7168
 v_smfmac_f32_16x16x64_bf16 v[84:87], v[76:79], a[152:159], v8
 ds_read_b128 v[64:67], v23 offset:9216
 s_waitcnt lgkmcnt(8)
 v_smfmac_f32_16x16x64_bf16 v[80:83], v[180:183], a[160:167], v8
 ds_read_b128 v[140:143], v17 offset:10240
 v_smfmac_f32_16x16x64_bf16 v[84:87], v[180:183], a[168:175], v8
 ds_read_b128 v[68:71], v23 offset:9248
 s_waitcnt lgkmcnt(8)
 v_smfmac_f32_16x16x64_bf16 v[80:83], v[184:187], a[176:183], v8
 ds_read_b128 v[144:147], v17 offset:11264
 v_smfmac_f32_16x16x64_bf16 v[84:87], v[184:187], a[184:191], v8
 s_waitcnt lgkmcnt(7)
 v_smfmac_f32_16x16x64_bf16 v[80:83], v[56:59], a[192:199], v8
 v_smfmac_f32_16x16x64_bf16 v[84:87], v[56:59], a[200:207], v8
 s_waitcnt lgkmcnt(5)
 v_smfmac_f32_16x16x64_bf16 v[80:83], v[60:63], a[208:215], v8
 v_smfmac_f32_16x16x64_bf16 v[84:87], v[60:63], a[216:223], v8
 s_waitcnt lgkmcnt(3)
 v_smfmac_f32_16x16x64_bf16 v[80:83], v[64:67], a[224:231], v8
 v_smfmac_f32_16x16x64_bf16 v[84:87], v[64:67], a[232:239], v8
 s_waitcnt lgkmcnt(1)
 v_smfmac_f32_16x16x64_bf16 v[80:83], v[68:71], a[240:247], v8
 v_smfmac_f32_16x16x64_bf16 v[84:87], v[68:71], a[248:255], v8
 s_lshl_b32 s16, s53, 19
 s_add_u32 s16, s16, s54
 s_xor_b32 s72, s16, 8192
 s_add_u32 s72, s72, s71
 s_add_u32 s16, s16, s70
 v_cvt_pk_bf16_f32 v36, v80, v81
 v_cvt_pk_bf16_f32 v37, v82, v83
 s_nop 2
 v_cvt_pk_bf16_f32 v38, v84, v85
 v_cvt_pk_bf16_f32 v39, v86, v87
 buffer_store_dwordx4 v[36:39], v18, s[4:7], s63 offen
 ds_write_b128 v16, v[36:39] offset:14336
 s_waitcnt vmcnt(1) lgkmcnt(1)
L_wf_328:
 v_cmp_ge_u32 vcc, s53, v13
 s_cbranch_vccnz L_rt_329
 v_mfma_f32_16x16x32_bf16 v[100:103], v[148:151], v[40:43], v[108:111]
 s_add_u32 m0, s68, 49152
 s_nop 0
 buffer_load_dwordx4 v1, s[4:7], s72 offen offset:0 sc1 nt lds
 ds_read_b128 v[56:59], v19 offset:0
 v_mfma_f32_16x16x32_bf16 v[104:107], v[164:167], v[40:43], v[112:115]
 ds_read_b128 v[60:63], v19 offset:1024
 v_mfma_f32_16x16x32_bf16 v[96:99], v[124:127], v[40:43], 0
 ds_read_b128 v[64:67], v19 offset:2048
 v_mfma_f32_16x16x32_bf16 v[100:103], v[152:155], v[44:47], v[100:103]
 ds_read_b128 v[68:71], v19 offset:3072
 buffer_load_dwordx4 v1, s[4:7], s72 offen offset:1024 sc1 nt lds
 v_mfma_f32_16x16x32_bf16 v[104:107], v[168:171], v[44:47], v[104:107]
 ds_read_b128 v[72:75], v19 offset:4096
 v_mfma_f32_16x16x32_bf16 v[96:99], v[128:131], v[44:47], v[96:99]
 ds_read_b128 v[76:79], v19 offset:5120
 v_mfma_f32_16x16x32_bf16 v[100:103], v[156:159], v[48:51], v[100:103]
 ds_read_b128 v[180:183], v19 offset:6144
 v_mfma_f32_16x16x32_bf16 v[104:107], v[172:175], v[48:51], v[104:107]
 buffer_load_dwordx4 v1, s[4:7], s72 offen offset:2048 sc1 nt lds
 ds_read_b128 v[184:187], v19 offset:7168
 v_mfma_f32_16x16x32_bf16 v[96:99], v[132:135], v[48:51], v[96:99]
 v_mfma_f32_16x16x32_bf16 v[100:103], v[160:163], v[52:55], v[100:103]
 v_mfma_f32_16x16x32_bf16 v[104:107], v[176:179], v[52:55], v[104:107]
 v_mfma_f32_16x16x32_bf16 v[96:99], v[136:139], v[52:55], v[96:99]
 v_mov_b32 v80, 0
 v_mov_b32 v81, 0
 buffer_load_dwordx4 v1, s[4:7], s72 offen offset:3072 sc1 nt lds
 v_mov_b32 v82, 0
 v_mov_b32 v83, 0
 v_mov_b32 v84, 0
 v_mov_b32 v85, 0
 v_mov_b32 v86, 0
 v_mov_b32 v87, 0
 v_cvt_pk_bf16_f32 v7, v100, v101
 s_add_u32 m0, s69, 49152
 s_nop 0
 buffer_load_dwordx4 v1, s[4:7], s16 offen offset:0 sc1 lds
 v_lshlrev_b32 v100, 16, v7
 v_and_b32 v101, 0xffff0000, v7
 v_cvt_pk_bf16_f32 v7, v102, v103
 v_lshlrev_b32 v102, 16, v7
 v_and_b32 v103, 0xffff0000, v7
 v_cvt_pk_bf16_f32 v7, v104, v105
 v_lshlrev_b32 v104, 16, v7
 buffer_load_dwordx4 v1, s[4:7], s16 offen offset:1024 sc1 lds
 v_and_b32 v105, 0xffff0000, v7
 v_cvt_pk_bf16_f32 v7, v106, v107
 v_lshlrev_b32 v106, 16, v7
 v_and_b32 v107, 0xffff0000, v7
 v_cvt_pk_bf16_f32 v7, v98, v99
 v_lshlrev_b32 v98, 16, v7
 v_and_b32 v99, 0xffff0000, v7
 buffer_load_dwordx4 v1, s[4:7], s16 offen offset:2048 sc1 lds
 v_pk_mul_f32 v[100:101], v[100:101], s[64:65] op_sel:[0,1] op_sel_hi:[1,1]
 v_pk_mul_f32 v[102:103], v[102:103], s[64:65] op_sel:[0,1] op_sel_hi:[1,1]
 v_pk_mul_f32 v[104:105], v[104:105], s[64:65] op_sel:[0,1] op_sel_hi:[1,1]
 v_pk_mul_f32 v[106:107], v[106:107], s[64:65] op_sel:[0,1] op_sel_hi:[1,1]
 v_pk_mul_f32 v[98:99], v[98:99], s[64:65] op_sel:[0,1] op_sel_hi:[1,1]
 v_cvt_pk_bf16_f32 v7, v100, v101
 v_lshlrev_b32 v100, 16, v7
 buffer_load_dwordx4 v1, s[4:7], s16 offen offset:3072 sc1 lds
 v_and_b32 v101, 0xffff0000, v7
 v_cvt_pk_bf16_f32 v7, v102, v103
 v_lshlrev_b32 v102, 16, v7
 v_and_b32 v103, 0xffff0000, v7
 v_cvt_pk_bf16_f32 v7, v104, v105
 v_lshlrev_b32 v104, 16, v7
 v_and_b32 v105, 0xffff0000, v7
 s_add_u32 m0, s69, 53248
 s_nop 0
 buffer_load_dwordx4 v6, s[4:7], s16 offen offset:0 sc1 lds
 v_cvt_pk_bf16_f32 v7, v106, v107
 v_lshlrev_b32 v106, 16, v7
 v_and_b32 v107, 0xffff0000, v7
 v_cvt_pk_bf16_f32 v7, v98, v99
 v_lshlrev_b32 v98, 16, v7
 v_and_b32 v99, 0xffff0000, v7
 v_max_f32 v20, v100, v101
 buffer_load_dwordx4 v6, s[4:7], s16 offen offset:1024 sc1 lds
 v_max3_f32 v20, v20, v102, v103
 v_max3_f32 v20, v20, v104, v105
 v_max3_f32 v20, v20, v106, v107
 v_max3_f32 v20, v20, v98, v99
 v_mov_b32 v22, v20
 s_nop 1
 v_permlane16_swap_b32 v20, v22
 buffer_load_dwordx4 v6, s[4:7], s16 offen offset:2048 sc1 lds
 v_max_f32 v20, v20, v22
 v_mov_b32 v22, v20
 s_nop 1
 v_permlane32_swap_b32 v20, v22
 v_max_f32 v20, v20, v22
 v_mul_f32 v22, s66, v20
 v_fma_f32 v100, v100, s66, -v22
 buffer_load_dwordx4 v6, s[4:7], s16 offen offset:3072 sc1 lds
 v_fma_f32 v101, v101, s66, -v22
 v_fma_f32 v102, v102, s66, -v22
 v_fma_f32 v103, v103, s66, -v22
 v_fma_f32 v104, v104, s66, -v22
 v_fma_f32 v105, v105, s66, -v22
 v_fma_f32 v106, v106, s66, -v22
 v_fma_f32 v107, v107, s66, -v22
 buffer_store_dwordx4 v[32:35], v18, s[4:7], s62 offen
 v_fma_f32 v98, v98, s66, -v22
 v_fma_f32 v99, v99, s66, -v22
 v_exp_f32 v100, v100
 v_exp_f32 v101, v101
 v_exp_f32 v102, v102
 v_exp_f32 v103, v103
 v_exp_f32 v104, v104
 buffer_load_dwordx4 v[124:127], v1, s[4:7], s63 offen offset:0 sc1
 v_exp_f32 v105, v105
 v_exp_f32 v106, v106
 v_exp_f32 v107, v107
 v_exp_f32 v98, v98
 v_exp_f32 v99, v99
 v_add_f32 v28, v100, v101
 v_add_f32 v28, v28, v102
 buffer_load_dwordx4 v[128:131], v1, s[4:7], s63 offen offset:1024 sc1
 v_add_f32 v28, v28, v103
 v_add_f32 v28, v28, v104
 v_add_f32 v28, v28, v105
 v_add_f32 v28, v28, v106
 v_add_f32 v28, v28, v107
 v_add_f32 v28, v28, v98
 v_add_f32 v28, v28, v99
 buffer_load_dwordx4 v[132:135], v1, s[4:7], s63 offen offset:2048 sc1
 v_mov_b32 v22, v28
 s_nop 1
 v_permlane16_swap_b32 v28, v22
 v_add_f32 v28, v28, v22
 v_mov_b32 v22, v28
 s_nop 1
 v_permlane32_swap_b32 v28, v22
 buffer_load_dwordx4 v[136:139], v1, s[4:7], s63 offen offset:3072 sc1
 v_add_f32 v28, v28, v22
 v_rcp_f32 v28, v28
 s_nop 0
 v_pk_mul_f32 v[100:101], v[100:101], v[28:29] op_sel_hi:[1,0]
 v_pk_mul_f32 v[102:103], v[102:103], v[28:29] op_sel_hi:[1,0]
 v_pk_mul_f32 v[104:105], v[104:105], v[28:29] op_sel_hi:[1,0]
 v_pk_mul_f32 v[106:107], v[106:107], v[28:29] op_sel_hi:[1,0]
 v_pk_mul_f32 v[98:99], v[98:99], v[28:29] op_sel_hi:[1,0]
 v_cvt_pk_bf16_f32 v116, v100, v101
 v_cvt_pk_bf16_f32 v117, v102, v103
 v_cvt_pk_bf16_f32 v118, v104, v105
 v_cvt_pk_bf16_f32 v119, v106, v107
 v_cvt_pk_bf16_f32 v120, v98, v99
 v_cvt_pk_bf16_f32 v123, v98, v99
 s_waitcnt lgkmcnt(0)
 v_mfma_f32_16x16x32_bf16 v[148:151], v[56:59], v[116:119], 0
 v_mfma_f32_16x16x32_bf16 v[152:155], v[60:63], v[116:119], 0
 v_mfma_f32_16x16x16_bf16 v[148:151], v[140:141], v[120:121], v[148:151]
 v_mfma_f32_16x16x32_bf16 v[156:159], v[64:67], v[116:119], 0
 v_mfma_f32_16x16x16_bf16 v[152:155], v[140:141], v[122:123], v[152:155]
 v_mfma_f32_16x16x32_bf16 v[160:163], v[68:71], v[116:119], 0
 v_mfma_f32_16x16x16_bf16 v[156:159], v[142:143], v[120:121], v[156:159]
 v_mfma_f32_16x16x32_bf16 v[164:167], v[72:75], v[116:119], 0
 v_mfma_f32_16x16x16_bf16 v[160:163], v[142:143], v[122:123], v[160:163]
 v_cvt_pk_bf16_f32 v40, v148, v149
 v_cvt_pk_bf16_f32 v41, v150, v151
 v_cvt_pk_bf16_f32 v42, v152, v153
 v_cvt_pk_bf16_f32 v43, v154, v155
 buffer_store_dwordx4 v[40:43], v11, s[4:7], s33 offen offset:0 sc1
 v_mfma_f32_16x16x32_bf16 v[168:171], v[76:79], v[116:119], 0
 v_mfma_f32_16x16x16_bf16 v[164:167], v[144:145], v[120:121], v[164:167]
 v_mfma_f32_16x16x32_bf16 v[172:175], v[180:183], v[116:119], 0
 v_mfma_f32_16x16x16_bf16 v[168:171], v[144:145], v[122:123], v[168:171]
 v_cvt_pk_bf16_f32 v44, v156, v157
 v_cvt_pk_bf16_f32 v45, v158, v159
 v_cvt_pk_bf16_f32 v46, v160, v161
 v_cvt_pk_bf16_f32 v47, v162, v163
 buffer_store_dwordx4 v[44:47], v11, s[4:7], s33 offen offset:2048 sc1
 s_add_u32 s33, s33, 4096
 v_mfma_f32_16x16x32_bf16 v[176:179], v[184:187], v[116:119], 0
 v_mfma_f32_16x16x16_bf16 v[172:175], v[146:147], v[120:121], v[172:175]
 v_mfma_f32_16x16x16_bf16 v[176:179], v[146:147], v[122:123], v[176:179]
 v_cvt_pk_bf16_f32 v48, v164, v165
 v_cvt_pk_bf16_f32 v49, v166, v167
 v_cvt_pk_bf16_f32 v50, v168, v169
 v_cvt_pk_bf16_f32 v51, v170, v171
 buffer_store_dwordx4 v[48:51], v11, s[4:7], s33 offen offset:0 sc1
 s_nop 3
 v_cvt_pk_bf16_f32 v52, v172, v173
 v_cvt_pk_bf16_f32 v53, v174, v175
 v_cvt_pk_bf16_f32 v54, v176, v177
 v_cvt_pk_bf16_f32 v55, v178, v179
 buffer_store_dwordx4 v[52:55], v11, s[4:7], s33 offen offset:2048 sc1
 s_cmp_ge_u32 s33, 268435456
 s_cselect_b32 s34, 268435456, s67
 s_add_u32 s67, s67, 4
 s_lshl_b32 s33, s53, 19
 s_add_u32 s33, s33, s54
 s_xor_b32 s33, s33, 8192
 s_add_u32 s33, s33, 67108864
 s_add_u32 s53, s53, 1
 v_mov_b32 v10, s53
 s_mov_b64 exec, 1
 buffer_store_dword v10, off, s[4:7], s35
 s_mov_b64 exec, -1
 s_waitcnt vmcnt(5)
L_pk_330:
 v_max3_u32 v7, v124, v128, v132
 v_max_u32 v7, v7, v136
 v_cmp_eq_u32 vcc, -1, v7
 s_cbranch_vccnz L_rt_331
 s_cmp_eq_u32 s53, 64
 s_cbranch_scc1 L_vr_last
 s_branch L_vr_loopf
L_rt_297:
 s_nop 7
 buffer_load_dword v7, off, s[4:7], s17 sc1
 s_waitcnt vmcnt(0)
 s_add_u32 s51, s51, 1
 s_cmp_lt_u32 s51, 131072
 s_cbranch_scc1 L_go_296
 s_branch L_bail
L_rt_299:
 s_nop 7
 buffer_load_dwordx4 v[40:43], v2, s[4:7], s56 offen offset:0 sc1
 buffer_load_dwordx4 v[44:47], v2, s[4:7], s56 offen offset:128 sc1
 buffer_load_dwordx4 v[48:51], v2, s[4:7], s56 offen offset:1024 sc1
 buffer_load_dwordx4 v[52:55], v2, s[4:7], s56 offen offset:1152 sc1
 buffer_load_dwordx4 v[56:59], v3, s[4:7], s56 offen offset:0 sc1
 s_add_u32 s51, s51, 1
 s_cmp_lt_u32 s51, 131072
 s_cbranch_scc1 L_xm_298
 s_branch L_bail
L_rt_302:
 s_sleep 1
 buffer_load_dword v13, off, s[4:7], s32 sc1
 s_waitcnt vmcnt(0)
 s_add_u32 s51, s51, 1
 s_cmp_lt_u32 s51, 131072
 s_cbranch_scc1 L_wf_301
 s_branch L_bail
L_rt_304:
 s_nop 7
 buffer_load_dwordx4 v[124:127], v1, s[4:7], s60 offen offset:0 sc1
 buffer_load_dwordx4 v[128:131], v1, s[4:7], s60 offen offset:1024 sc1
 buffer_load_dwordx4 v[132:135], v1, s[4:7], s60 offen offset:2048 sc1
 buffer_load_dwordx4 v[136:139], v1, s[4:7], s60 offen offset:3072 sc1
 s_waitcnt vmcnt(0)
 s_add_u32 s51, s51, 1
 s_cmp_lt_u32 s51, 131072
 s_cbranch_scc1 L_pk_303
 s_branch L_bail
L_rt_306:
 s_nop 7
 buffer_load_dword v7, off, s[4:7], s17 sc1
 s_waitcnt vmcnt(0)
 s_add_u32 s51, s51, 1
 s_cmp_lt_u32 s51, 131072
 s_cbranch_scc1 L_go_305
 s_branch L_bail
L_rt_308:
 s_nop 7
 buffer_load_dwordx4 v[40:43], v2, s[4:7], s57 offen offset:0 sc1
 buffer_load_dwordx4 v[44:47], v2, s[4:7], s57 offen offset:128 sc1
 buffer_load_dwordx4 v[48:51], v2, s[4:7], s57 offen offset:1024 sc1
 buffer_load_dwordx4 v[52:55], v2, s[4:7], s57 offen offset:1152 sc1
 buffer_load_dwordx4 v[56:59], v3, s[4:7], s57 offen offset:0 sc1
 s_add_u32 s51, s51, 1
 s_cmp_lt_u32 s51, 131072
 s_cbranch_scc1 L_xm_307
 s_branch L_bail
L_rt_311:
 s_sleep 1
 buffer_load_dword v13, off, s[4:7], s32 sc1
 s_waitcnt vmcnt(0)
 s_add_u32 s51, s51, 1
 s_cmp_lt_u32 s51, 131072
 s_cbranch_scc1 L_wf_310
 s_branch L_bail
L_rt_313:
 s_nop 7
 buffer_load_dwordx4 v[124:127], v1, s[4:7], s61 offen offset:0 sc1
 buffer_load_dwordx4 v[128:131], v1, s[4:7], s61 offen offset:1024 sc1
 buffer_load_dwordx4 v[132:135], v1, s[4:7], s61 offen offset:2048 sc1
 buffer_load_dwordx4 v[136:139], v1, s[4:7], s61 offen offset:3072 sc1
 s_waitcnt vmcnt(0)
 s_add_u32 s51, s51, 1
 s_cmp_lt_u32 s51, 131072
 s_cbranch_scc1 L_pk_312
 s_branch L_bail
L_rt_315:
 s_nop 7
 buffer_load_dword v7, off, s[4:7], s17 sc1
 s_waitcnt vmcnt(0)
 s_add_u32 s51, s51, 1
 s_cmp_lt_u32 s51, 131072
 s_cbranch_scc1 L_go_314
 s_branch L_bail
L_rt_317:
 s_nop 7
 buffer_load_dwordx4 v[40:43], v2, s[4:7], s58 offen offset:0 sc1
 buffer_load_dwordx4 v[44:47], v2, s[4:7], s58 offen offset:128 sc1
 buffer_load_dwordx4 v[48:51], v2, s[4:7], s58 offen offset:1024 sc1
 buffer_load_dwordx4 v[52:55], v2, s[4:7], s58 offen offset:1152 sc1
 buffer_load_dwordx4 v[56:59], v3, s[4:7], s58 offen offset:0 sc1
 s_add_u32 s51, s51, 1
 s_cmp_lt_u32 s51, 131072
 s_cbranch_scc1 L_xm_316
 s_branch L_bail
L_rt_320:
 s_sleep 1
 buffer_load_dword v13, off, s[4:7], s32 sc1
 s_waitcnt vmcnt(0)
 s_add_u32 s51, s51, 1
 s_cmp_lt_u32 s51, 131072
 s_cbranch_scc1 L_wf_319
 s_branch L_bail
L_rt_322:
 s_nop 7
 buffer_load_dwordx4 v[124:127], v1, s[4:7], s62 offen offset:0 sc1
 buffer_load_dwordx4 v[128:131], v1, s[4:7], s62 offen offset:1024 sc1
 buffer_load_dwordx4 v[132:135], v1, s[4:7], s62 offen offset:2048 sc1
 buffer_load_dwordx4 v[136:139], v1, s[4:7], s62 offen offset:3072 sc1
 s_waitcnt vmcnt(0)
 s_add_u32 s51, s51, 1
 s_cmp_lt_u32 s51, 131072
 s_cbranch_scc1 L_pk_321
 s_branch L_bail
L_rt_324:
 s_nop 7
 buffer_load_dword v7, off, s[4:7], s17 sc1
 s_waitcnt vmcnt(0)
 s_add_u32 s51, s51, 1
 s_cmp_lt_u32 s51, 131072
 s_cbranch_scc1 L_go_323
 s_branch L_bail
L_rt_326:
 s_nop 7
 buffer_load_dwordx4 v[40:43], v2, s[4:7], s59 offen offset:0 sc1
 buffer_load_dwordx4 v[44:47], v2, s[4:7], s59 offen offset:128 sc1
 buffer_load_dwordx4 v[48:51], v2, s[4:7], s59 offen offset:1024 sc1
 buffer_load_dwordx4 v[52:55], v2, s[4:7], s59 offen offset:1152 sc1
 buffer_load_dwordx4 v[56:59], v3, s[4:7], s59 offen offset:0 sc1
 s_add_u32 s51, s51, 1
 s_cmp_lt_u32 s51, 131072
 s_cbranch_scc1 L_xm_325
 s_branch L_bail
L_rt_329:
 s_sleep 1
 buffer_load_dword v13, off, s[4:7], s32 sc1
 s_waitcnt vmcnt(0)
 s_add_u32 s51, s51, 1
 s_cmp_lt_u32 s51, 131072
 s_cbranch_scc1 L_wf_328
 s_branch L_bail
L_rt_331:
 s_nop 7
 buffer_load_dwordx4 v[124:127], v1, s[4:7], s63 offen offset:0 sc1
 buffer_load_dwordx4 v[128:131], v1, s[4:7], s63 offen offset:1024 sc1
 buffer_load_dwordx4 v[132:135], v1, s[4:7], s63 offen offset:2048 sc1
 buffer_load_dwordx4 v[136:139], v1, s[4:7], s63 offen offset:3072 sc1
 s_waitcnt vmcnt(0)
 s_add_u32 s51, s51, 1
 s_cmp_lt_u32 s51, 131072
 s_cbranch_scc1 L_pk_330
 s_branch L_bail
.p2align 6
L_vr_loops:
 s_mov_b32 s51, 0
 buffer_load_dword v7, off, s[4:7], s17 sc1
 s_waitcnt vmcnt(0)
L_go_332:
 v_cmp_gt_u32 vcc, s53, v7
 s_cbranch_vccnz L_rt_333
L_vr_ents:
 s_mov_b32 s51, 0
 s_nop 15
 s_nop 7
 buffer_load_dwordx4 v[40:43], v2, s[4:7], s56 offen offset:0 sc1
 buffer_load_dwordx4 v[44:47], v2, s[4:7], s56 offen offset:128 sc1
 buffer_load_dwordx4 v[48:51], v2, s[4:7], s56 offen offset:1024 sc1
 buffer_load_dwordx4 v[52:55], v2, s[4:7], s56 offen offset:1152 sc1
 buffer_load_dwordx4 v[56:59], v3, s[4:7], s56 offen offset:0 sc1
L_xm_334:
 s_waitcnt vmcnt(4)
 v_mfma_f32_16x16x32_bf16 v[60:63], v[24:27], v[40:43], 0
 s_waitcnt vmcnt(3)
 v_mfma_f32_16x16x32_bf16 v[64:67], v[24:27], v[44:47], 0
 s_waitcnt vmcnt(2)
 v_mfma_f32_16x16x32_bf16 v[68:71], v[24:27], v[48:51], 0
 v_max3_u32 v7, v40, v44, v48
 v_cvt_pk_bf16_f32 v60, v60, v61
 v_cvt_pk_bf16_f32 v61, v62, v63
 ds_write_b64 v4, v[60:61] offset:0
 s_waitcnt vmcnt(1)
 v_mfma_f32_16x16x32_bf16 v[72:75], v[24:27], v[52:55], 0
 v_cvt_pk_bf16_f32 v64, v64, v65
 v_cvt_pk_bf16_f32 v65, v66, v67
 ds_write_b64 v4, v[64:65] offset:8
 s_waitcnt vmcnt(0)
 v_mfma_f32_16x16x32_bf16 v[76:79], v[24:27], v[56:59], 0
 v_max3_u32 v7, v7, v52, v56
 v_cmp_eq_u32 vcc, -1, v7
 v_cvt_pk_bf16_f32 v68, v68, v69
 v_cvt_pk_bf16_f32 v69, v70, v71
 ds_write_b64 v4, v[68:69] offset:1024
 s_cbranch_vccnz L_rt_335
 v_cvt_pk_bf16_f32 v72, v72, v73
 v_cvt_pk_bf16_f32 v73, v74, v75
 ds_write_b64 v4, v[72:73] offset:1032
 s_nop 0
 v_cvt_pk_bf16_f32 v76, v76, v77
 v_cvt_pk_bf16_f32 v77, v78, v79
 ds_write_b64 v5, v[76:77] offset:0
 s_waitcnt lgkmcnt(0)
 s_barrier
 ds_read_b128 v[56:59], v23 offset:0
 ds_read_b128 v[60:63], v23 offset:32
 ds_read_b128 v[64:67], v23 offset:1024
 s_cmp_ge_u32 s34, 268435456
 s_cbranch_scc1 L_ns_336
 v_mov_b32 v10, 1
 s_mov_b64 exec, 31
 buffer_atomic_add v10, v12, s[4:7], s34 offen
 s_mov_b64 exec, -1
 L_ns_336:
 buffer_load_dword v13, off, s[4:7], s32 sc1
 s_waitcnt lgkmcnt(2)
 v_smfmac_f32_16x16x64_bf16 v[80:83], v[56:59], v[192:199], v8
 ds_read_b128 v[68:71], v23 offset:1056
 v_smfmac_f32_16x16x64_bf16 v[84:87], v[56:59], v[200:207], v8
 ds_read_b128 v[72:75], v23 offset:2048
 s_waitcnt lgkmcnt(3)
 v_smfmac_f32_16x16x64_bf16 v[80:83], v[60:63], v[208:215], v8
 ds_read_b128 v[76:79], v23 offset:2080
 v_smfmac_f32_16x16x64_bf16 v[84:87], v[60:63], v[216:223], v8
 ds_read_b128 v[180:183], v23 offset:3072
 s_waitcnt lgkmcnt(4)
 v_smfmac_f32_16x16x64_bf16 v[80:83], v[64:67], v[224:231], v8
 ds_read_b128 v[40:43], v14 offset:49152
 v_smfmac_f32_16x16x64_bf16 v[84:87], v[64:67], v[232:239], v8
 ds_read_b128 v[184:187], v23 offset:3104
 s_waitcnt lgkmcnt(5)
 v_smfmac_f32_16x16x64_bf16 v[80:83], v[68:71], v[240:247], v8
 ds_read_b128 v[44:47], v14 offset:50176
 v_smfmac_f32_16x16x64_bf16 v[84:87], v[68:71], v[248:255], v8
 ds_read_b128 v[56:59], v23 offset:4096
 s_waitcnt lgkmcnt(6)
 v_smfmac_f32_16x16x64_bf16 v[80:83], v[72:75], a[0:7], v8
 ds_read_b128 v[48:51], v14 offset:51200
 v_smfmac_f32_16x16x64_bf16 v[84:87], v[72:75], a[8:15], v8
 ds_read_b128 v[60:63], v23 offset:4128
 s_waitcnt lgkmcnt(7)
 v_smfmac_f32_16x16x64_bf16 v[80:83], v[76:79], a[16:23], v8
 ds_read_b128 v[52:55], v14 offset:52224
 v_smfmac_f32_16x16x64_bf16 v[84:87], v[76:79], a[24:31], v8
 ds_read_b128 v[64:67], v23 offset:5120
 s_waitcnt lgkmcnt(8)
 v_smfmac_f32_16x16x64_bf16 v[80:83], v[180:183], a[32:39], v8
 ds_read_b128 v[148:151], v15 offset:49152
 v_smfmac_f32_16x16x64_bf16 v[84:87], v[180:183], a[40:47], v8
 ds_read_b128 v[68:71], v23 offset:5152
 s_waitcnt lgkmcnt(8)
 v_smfmac_f32_16x16x64_bf16 v[80:83], v[184:187], a[48:55], v8
 ds_read_b128 v[152:155], v15 offset:50176
 v_smfmac_f32_16x16x64_bf16 v[84:87], v[184:187], a[56:63], v8
 ds_read_b128 v[72:75], v23 offset:6144
 s_waitcnt lgkmcnt(8)
 v_smfmac_f32_16x16x64_bf16 v[80:83], v[56:59], a[64:71], v8
 ds_read_b128 v[156:159], v15 offset:51200
 v_smfmac_f32_16x16x64_bf16 v[84:87], v[56:59], a[72:79], v8
 ds_read_b128 v[76:79], v23 offset:6176
 s_waitcnt lgkmcnt(8)
 v_smfmac_f32_16x16x64_bf16 v[80:83], v[60:63], a[80:87], v8
 ds_read_b128 v[160:163], v15 offset:52224
 v_smfmac_f32_16x16x64_bf16 v[84:87], v[60:63], a[88:95], v8
 ds_read_b128 v[180:183], v23 offset:7168
 s_waitcnt lgkmcnt(8)
 v_smfmac_f32_16x16x64_bf16 v[80:83], v[64:67], a[96:103], v8
 ds_read_b128 v[164:167], v15 offset:53248
 v_smfmac_f32_16x16x64_bf16 v[84:87], v[64:67], a[104:111], v8
 ds_read_b128 v[184:187], v23 offset:7200
 s_waitcnt lgkmcnt(8)
 v_smfmac_f32_16x16x64_bf16 v[80:83], v[68:71], a[112:119], v8
 ds_read_b128 v[168:171], v15 offset:54272
 v_smfmac_f32_16x16x64_bf16 v[84:87], v[68:71], a[120:127], v8
 ds_read_b128 v[56:59], v23 offset:8192
 s_waitcnt lgkmcnt(8)
 v_smfmac_f32_16x16x64_bf16 v[80:83], v[72:75], a[128:135], v8
 ds_read_b128 v[172:175], v15 offset:55296
 v_smfmac_f32_16x16x64_bf16 v[84:87], v[72:75], a[136:143], v8
 ds_read_b128 v[60:63], v23 offset:8224
 s_waitcnt lgkmcnt(8)
 v_smfmac_f32_16x16x64_bf16 v[80:83], v[76:79], a[144:151], v8
 ds_read_b128 v[176:179], v15 offset:56320
 v_smfmac_f32_16x16x64_bf16 v[84:87], v[76:79], a[152:159], v8
 ds_read_b128 v[64:67], v23 offset:9216
 s_waitcnt lgkmcnt(8)
 v_smfmac_f32_16x16x64_bf16 v[80:83], v[180:183], a[160:167], v8
 ds_read_b128 v[140:143], v17 offset:14336
 v_smfmac_f32_16x16x64_bf16 v[84:87], v[180:183], a[168:175], v8
 ds_read_b128 v[68:71], v23 offset:9248
 s_waitcnt lgkmcnt(8)
 v_smfmac_f32_16x16x64_bf16 v[80:83], v[184:187], a[176:183], v8
 ds_read_b128 v[144:147], v17 offset:15360
 v_smfmac_f32_16x16x64_bf16 v[84:87], v[184:187], a[184:191], v8
 s_waitcnt lgkmcnt(7)
 v_smfmac_f32_16x16x64_bf16 v[80:83], v[56:59], a[192:199], v8
 v_smfmac_f32_16x16x64_bf16 v[84:87], v[56:59], a[200:207], v8
 s_waitcnt lgkmcnt(5)
 v_smfmac_f32_16x16x64_bf16 v[80:83], v[60:63], a[208:215], v8
 v_smfmac_f32_16x16x64_bf16 v[84:87], v[60:63], a[216:223], v8
 s_waitcnt lgkmcnt(3)
 v_smfmac_f32_16x16x64_bf16 v[80:83], v[64:67], a[224:231], v8
 v_smfmac_f32_16x16x64_bf16 v[84:87], v[64:67], a[232:239], v8
 s_waitcnt lgkmcnt(1)
 v_smfmac_f32_16x16x64_bf16 v[80:83], v[68:71], a[240:247], v8
 v_smfmac_f32_16x16x64_bf16 v[84:87], v[68:71], a[248:255], v8
 s_lshl_b32 s16, s53, 19
 s_add_u32 s16, s16, s54
 s_xor_b32 s72, s16, 8192
 s_add_u32 s72, s72, s71
 s_add_u32 s16, s16, s70
 v_cvt_pk_bf16_f32 v36, v80, v81
 v_cvt_pk_bf16_f32 v37, v82, v83
 s_nop 2
 v_cvt_pk_bf16_f32 v38, v84, v85
 v_cvt_pk_bf16_f32 v39, v86, v87
 buffer_store_dwordx4 v[36:39], v18, s[4:7], s60 offen sc1
 ds_write_b128 v16, v[36:39] offset:10240
 s_waitcnt vmcnt(1) lgkmcnt(1)
L_wf_337:
 v_cmp_ge_u32 vcc, s53, v13
 s_cbranch_vccnz L_rt_338
 v_mfma_f32_16x16x32_bf16 v[100:103], v[148:151], v[40:43], v[108:111]
 s_add_u32 m0, s68, 0
 s_nop 0
 buffer_load_dwordx4 v1, s[4:7], s72 offen offset:0 sc1 nt lds
 ds_read_b128 v[56:59], v19 offset:49152
 v_mfma_f32_16x16x32_bf16 v[104:107], v[164:167], v[40:43], v[112:115]
 ds_read_b128 v[60:63], v19 offset:50176
 v_mfma_f32_16x16x32_bf16 v[96:99], v[124:127], v[40:43], 0
 ds_read_b128 v[64:67], v19 offset:51200
 v_mfma_f32_16x16x32_bf16 v[100:103], v[152:155], v[44:47], v[100:103]
 ds_read_b128 v[68:71], v19 offset:52224
 buffer_load_dwordx4 v1, s[4:7], s72 offen offset:1024 sc1 nt lds
 v_mfma_f32_16x16x32_bf16 v[104:107], v[168:171], v[44:47], v[104:107]
 ds_read_b128 v[72:75], v19 offset:53248
 v_mfma_f32_16x16x32_bf16 v[96:99], v[128:131], v[44:47], v[96:99]
 ds_read_b128 v[76:79], v19 offset:54272
 v_mfma_f32_16x16x32_bf16 v[100:103], v[156:159], v[48:51], v[100:103]
 ds_read_b128 v[180:183], v19 offset:55296
 v_mfma_f32_16x16x32_bf16 v[104:107], v[172:175], v[48:51], v[104:107]
 buffer_load_dwordx4 v1, s[4:7], s72 offen offset:2048 sc1 nt lds
 ds_read_b128 v[184:187], v19 offset:56320
 v_mfma_f32_16x16x32_bf16 v[96:99], v[132:135], v[48:51], v[96:99]
 v_mfma_f32_16x16x32_bf16 v[100:103], v[160:163], v[52:55], v[100:103]
 v_mfma_f32_16x16x32_bf16 v[104:107], v[176:179], v[52:55], v[104:107]
 v_mfma_f32_16x16x32_bf16 v[96:99], v[136:139], v[52:55], v[96:99]
 v_mov_b32 v80, 0
 v_mov_b32 v81, 0
 buffer_load_dwordx4 v1, s[4:7], s72 offen offset:3072 sc1 nt lds
 v_mov_b32 v82, 0
 v_mov_b32 v83, 0
 v_mov_b32 v84, 0
 v_mov_b32 v85, 0
 v_mov_b32 v86, 0
 v_mov_b32 v87, 0
 v_cvt_pk_bf16_f32 v7, v100, v101
 s_add_u32 m0, s69, 0
 s_nop 0
 buffer_load_dwordx4 v1, s[4:7], s16 offen offset:0 sc1 lds
 v_lshlrev_b32 v100, 16, v7
 v_and_b32 v101, 0xffff0000, v7
 v_cvt_pk_bf16_f32 v7, v102, v103
 v_lshlrev_b32 v102, 16, v7
 v_and_b32 v103, 0xffff0000, v7
 v_cvt_pk_bf16_f32 v7, v104, v105
 v_lshlrev_b32 v104, 16, v7
 buffer_load_dwordx4 v1, s[4:7], s16 offen offset:1024 sc1 lds
 v_and_b32 v105, 0xffff0000, v7
 v_cvt_pk_bf16_f32 v7, v106, v107
 v_lshlrev_b32 v106, 16, v7
 v_and_b32 v107, 0xffff0000, v7
 v_cvt_pk_bf16_f32 v7, v98, v99
 v_lshlrev_b32 v98, 16, v7
 v_and_b32 v99, 0xffff0000, v7
 buffer_load_dwordx4 v1, s[4:7], s16 offen offset:2048 sc1 lds
 v_pk_mul_f32 v[100:101], v[100:101], s[64:65] op_sel:[0,1] op_sel_hi:[1,1]
 v_pk_mul_f32 v[102:103], v[102:103], s[64:65] op_sel:[0,1] op_sel_hi:[1,1]
 v_pk_mul_f32 v[104:105], v[104:105], s[64:65] op_sel:[0,1] op_sel_hi:[1,1]
 v_pk_mul_f32 v[106:107], v[106:107], s[64:65] op_sel:[0,1] op_sel_hi:[1,1]
 v_pk_mul_f32 v[98:99], v[98:99], s[64:65] op_sel:[0,1] op_sel_hi:[1,1]
 v_cvt_pk_bf16_f32 v7, v100, v101
 v_lshlrev_b32 v100, 16, v7
 buffer_load_dwordx4 v1, s[4:7], s16 offen offset:3072 sc1 lds
 v_and_b32 v101, 0xffff0000, v7
 v_cvt_pk_bf16_f32 v7, v102, v103
 v_lshlrev_b32 v102, 16, v7
 v_and_b32 v103, 0xffff0000, v7
 v_cvt_pk_bf16_f32 v7, v104, v105
 v_lshlrev_b32 v104, 16, v7
 v_and_b32 v105, 0xffff0000, v7
 s_add_u32 m0, s69, 4096
 s_nop 0
 buffer_load_dwordx4 v6, s[4:7], s16 offen offset:0 sc1 lds
 v_cvt_pk_bf16_f32 v7, v106, v107
 v_lshlrev_b32 v106, 16, v7
 v_and_b32 v107, 0xffff0000, v7
 v_cvt_pk_bf16_f32 v7, v98, v99
 v_lshlrev_b32 v98, 16, v7
 v_and_b32 v99, 0xffff0000, v7
 v_max_f32 v20, v100, v101
 buffer_load_dwordx4 v6, s[4:7], s16 offen offset:1024 sc1 lds
 v_max3_f32 v20, v20, v102, v103
 v_max3_f32 v20, v20, v104, v105
 v_max3_f32 v20, v20, v106, v107
 v_max3_f32 v20, v20, v98, v99
 v_mov_b32 v22, v20
 s_nop 1
 v_permlane16_swap_b32 v20, v22
 buffer_load_dwordx4 v6, s[4:7], s16 offen offset:2048 sc1 lds
 v_max_f32 v20, v20, v22
 v_mov_b32 v22, v20
 s_nop 1
 v_permlane32_swap_b32 v20, v22
 v_max_f32 v20, v20, v22
 v_mul_f32 v22, s66, v20
 v_fma_f32 v100, v100, s66, -v22
 buffer_load_dwordx4 v6, s[4:7], s16 offen offset:3072 sc1 lds
 v_fma_f32 v101, v101, s66, -v22
 v_fma_f32 v102, v102, s66, -v22
 v_fma_f32 v103, v103, s66, -v22
 v_fma_f32 v104, v104, s66, -v22
 v_fma_f32 v105, v105, s66, -v22
 v_fma_f32 v106, v106, s66, -v22
 v_fma_f32 v107, v107, s66, -v22
 buffer_store_dwordx4 v[32:35], v18, s[4:7], s63 offen sc1
 v_fma_f32 v98, v98, s66, -v22
 v_fma_f32 v99, v99, s66, -v22
 v_exp_f32 v100, v100
 v_exp_f32 v101, v101
 v_exp_f32 v102, v102
 v_exp_f32 v103, v103
 v_exp_f32 v104, v104
 buffer_load_dwordx4 v[124:127], v1, s[4:7], s60 offen offset:0 sc1
 v_exp_f32 v105, v105
 v_exp_f32 v106, v106
 v_exp_f32 v107, v107
 v_exp_f32 v98, v98
 v_exp_f32 v99, v99
 v_add_f32 v28, v100, v101
 v_add_f32 v28, v28, v102
 buffer_load_dwordx4 v[128:131], v1, s[4:7], s60 offen offset:1024 sc1
 v_add_f32 v28, v28, v103
 v_add_f32 v28, v28, v104
 v_add_f32 v28, v28, v105
 v_add_f32 v28, v28, v106
 v_add_f32 v28, v28, v107
 v_add_f32 v28, v28, v98
 v_add_f32 v28, v28, v99
 buffer_load_dwordx4 v[132:135], v1, s[4:7], s60 offen offset:2048 sc1
 v_mov_b32 v22, v28
 s_nop 1
 v_permlane16_swap_b32 v28, v22
 v_add_f32 v28, v28, v22
 v_mov_b32 v22, v28
 s_nop 1
 v_permlane32_swap_b32 v28, v22
 buffer_load_dwordx4 v[136:139], v1, s[4:7], s60 offen offset:3072 sc1
 v_add_f32 v28, v28, v22
 v_rcp_f32 v28, v28
 s_nop 0
 v_pk_mul_f32 v[100:101], v[100:101], v[28:29] op_sel_hi:[1,0]
 v_pk_mul_f32 v[102:103], v[102:103], v[28:29] op_sel_hi:[1,0]
 v_pk_mul_f32 v[104:105], v[104:105], v[28:29] op_sel_hi:[1,0]
 v_pk_mul_f32 v[106:107], v[106:107], v[28:29] op_sel_hi:[1,0]
 v_pk_mul_f32 v[98:99], v[98:99], v[28:29] op_sel_hi:[1,0]
 v_cvt_pk_bf16_f32 v116, v100, v101
 v_cvt_pk_bf16_f32 v117, v102, v103
 v_cvt_pk_bf16_f32 v118, v104, v105
 v_cvt_pk_bf16_f32 v119, v106, v107
 v_cvt_pk_bf16_f32 v120, v98, v99
 v_cvt_pk_bf16_f32 v123, v98, v99
 s_waitcnt lgkmcnt(0)
 v_mfma_f32_16x16x32_bf16 v[148:151], v[56:59], v[116:119], 0
 v_mfma_f32_16x16x32_bf16 v[152:155], v[60:63], v[116:119], 0
 v_mfma_f32_16x16x16_bf16 v[148:151], v[140:141], v[120:121], v[148:151]
 v_mfma_f32_16x16x32_bf16 v[156:159], v[64:67], v[116:119], 0
 v_mfma_f32_16x16x16_bf16 v[152:155], v[140:141], v[122:123], v[152:155]
 v_mfma_f32_16x16x32_bf16 v[160:163], v[68:71], v[116:119], 0
 v_mfma_f32_16x16x16_bf16 v[156:159], v[142:143], v[120:121], v[156:159]
 v_mfma_f32_16x16x32_bf16 v[164:167], v[72:75], v[116:119], 0
 v_mfma_f32_16x16x16_bf16 v[160:163], v[142:143], v[122:123], v[160:163]
 v_cvt_pk_bf16_f32 v40, v148, v149
 v_cvt_pk_bf16_f32 v41, v150, v151
 v_cvt_pk_bf16_f32 v42, v152, v153
 v_cvt_pk_bf16_f32 v43, v154, v155
 buffer_store_dwordx4 v[40:43], v11, s[4:7], s33 offen offset:0 sc1
 v_mfma_f32_16x16x32_bf16 v[168:171], v[76:79], v[116:119], 0
 v_mfma_f32_16x16x16_bf16 v[164:167], v[144:145], v[120:121], v[164:167]
 v_mfma_f32_16x16x32_bf16 v[172:175], v[180:183], v[116:119], 0
 v_mfma_f32_16x16x16_bf16 v[168:171], v[144:145], v[122:123], v[168:171]
 v_cvt_pk_bf16_f32 v44, v156, v157
 v_cvt_pk_bf16_f32 v45, v158, v159
 v_cvt_pk_bf16_f32 v46, v160, v161
 v_cvt_pk_bf16_f32 v47, v162, v163
 buffer_store_dwordx4 v[44:47], v11, s[4:7], s33 offen offset:2048 sc1
 s_add_u32 s33, s33, 4096
 v_mfma_f32_16x16x32_bf16 v[176:179], v[184:187], v[116:119], 0
 v_mfma_f32_16x16x16_bf16 v[172:175], v[146:147], v[120:121], v[172:175]
 v_mfma_f32_16x16x16_bf16 v[176:179], v[146:147], v[122:123], v[176:179]
 v_cvt_pk_bf16_f32 v48, v164, v165
 v_cvt_pk_bf16_f32 v49, v166, v167
 v_cvt_pk_bf16_f32 v50, v168, v169
 v_cvt_pk_bf16_f32 v51, v170, v171
 buffer_store_dwordx4 v[48:51], v11, s[4:7], s33 offen offset:0 sc1
 s_nop 3
 v_cvt_pk_bf16_f32 v52, v172, v173
 v_cvt_pk_bf16_f32 v53, v174, v175
 v_cvt_pk_bf16_f32 v54, v176, v177
 v_cvt_pk_bf16_f32 v55, v178, v179
 buffer_store_dwordx4 v[52:55], v11, s[4:7], s33 offen offset:2048 sc1
 s_cmp_ge_u32 s33, 268435456
 s_cselect_b32 s34, 268435456, s67
 s_add_u32 s67, s67, 4
 s_lshl_b32 s33, s53, 19
 s_add_u32 s33, s33, s54
 s_xor_b32 s33, s33, 8192
 s_add_u32 s33, s33, 67108864
 s_add_u32 s53, s53, 1
 v_mov_b32 v10, s53
 s_mov_b64 exec, 1
 buffer_store_dword v10, off, s[4:7], s35 sc1
 s_mov_b64 exec, -1
 s_waitcnt vmcnt(5)
L_pk_339:
 v_max3_u32 v7, v124, v128, v132
 v_max_u32 v7, v7, v136
 v_cmp_eq_u32 vcc, -1, v7
 s_cbranch_vccnz L_rt_340
 s_mov_b32 s51, 0
 buffer_load_dword v7, off, s[4:7], s17 sc1
 s_waitcnt vmcnt(0)
L_go_341:
 v_cmp_gt_u32 vcc, s53, v7
 s_cbranch_vccnz L_rt_342
 s_mov_b32 s51, 0
 s_nop 15
 s_nop 7
 buffer_load_dwordx4 v[40:43], v2, s[4:7], s57 offen offset:0 sc1
 buffer_load_dwordx4 v[44:47], v2, s[4:7], s57 offen offset:128 sc1
 buffer_load_dwordx4 v[48:51], v2, s[4:7], s57 offen offset:1024 sc1
 buffer_load_dwordx4 v[52:55], v2, s[4:7], s57 offen offset:1152 sc1
 buffer_load_dwordx4 v[56:59], v3, s[4:7], s57 offen offset:0 sc1
L_xm_343:
 s_waitcnt vmcnt(4)
 v_mfma_f32_16x16x32_bf16 v[60:63], v[24:27], v[40:43], 0
 s_waitcnt vmcnt(3)
 v_mfma_f32_16x16x32_bf16 v[64:67], v[24:27], v[44:47], 0
 s_waitcnt vmcnt(2)
 v_mfma_f32_16x16x32_bf16 v[68:71], v[24:27], v[48:51], 0
 v_max3_u32 v7, v40, v44, v48
 v_cvt_pk_bf16_f32 v60, v60, v61
 v_cvt_pk_bf16_f32 v61, v62, v63
 ds_write_b64 v4, v[60:61] offset:0
 s_waitcnt vmcnt(1)
 v_mfma_f32_16x16x32_bf16 v[72:75], v[24:27], v[52:55], 0
 v_cvt_pk_bf16_f32 v64, v64, v65
 v_cvt_pk_bf16_f32 v65, v66, v67
 ds_write_b64 v4, v[64:65] offset:8
 s_waitcnt vmcnt(0)
 v_mfma_f32_16x16x32_bf16 v[76:79], v[24:27], v[56:59], 0
 v_max3_u32 v7, v7, v52, v56
 v_cmp_eq_u32 vcc, -1, v7
 v_cvt_pk_bf16_f32 v68, v68, v69
 v_cvt_pk_bf16_f32 v69, v70, v71
 ds_write_b64 v4, v[68:69] offset:1024
 s_cbranch_vccnz L_rt_344
 v_cvt_pk_bf16_f32 v72, v72, v73
 v_cvt_pk_bf16_f32 v73, v74, v75
 ds_write_b64 v4, v[72:73] offset:1032
 s_nop 0
 v_cvt_pk_bf16_f32 v76, v76, v77
 v_cvt_pk_bf16_f32 v77, v78, v79
 ds_write_b64 v5, v[76:77] offset:0
 s_waitcnt lgkmcnt(0)
 s_barrier
 ds_read_b128 v[56:59], v23 offset:0
 ds_read_b128 v[60:63], v23 offset:32
 ds_read_b128 v[64:67], v23 offset:1024
 s_cmp_ge_u32 s34, 268435456
 s_cbranch_scc1 L_ns_345
 v_mov_b32 v10, 1
 s_mov_b64 exec, 31
 buffer_atomic_add v10, v12, s[4:7], s34 offen
 s_mov_b64 exec, -1
 L_ns_345:
 buffer_load_dword v13, off, s[4:7], s32 sc1
 s_waitcnt lgkmcnt(2)
 v_smfmac_f32_16x16x64_bf16 v[80:83], v[56:59], v[192:199], v8
 ds_read_b128 v[68:71], v23 offset:1056
 v_smfmac_f32_16x16x64_bf16 v[84:87], v[56:59], v[200:207], v8
 ds_read_b128 v[72:75], v23 offset:2048
 s_waitcnt lgkmcnt(3)
 v_smfmac_f32_16x16x64_bf16 v[80:83], v[60:63], v[208:215], v8
 ds_read_b128 v[76:79], v23 offset:2080
 v_smfmac_f32_16x16x64_bf16 v[84:87], v[60:63], v[216:223], v8
 ds_read_b128 v[180:183], v23 offset:3072
 s_waitcnt lgkmcnt(4)
 v_smfmac_f32_16x16x64_bf16 v[80:83], v[64:67], v[224:231], v8
 ds_read_b128 v[40:43], v14 offset:0
 v_smfmac_f32_16x16x64_bf16 v[84:87], v[64:67], v[232:239], v8
 ds_read_b128 v[184:187], v23 offset:3104
 s_waitcnt lgkmcnt(5)
 v_smfmac_f32_16x16x64_bf16 v[80:83], v[68:71], v[240:247], v8
 ds_read_b128 v[44:47], v14 offset:1024
 v_smfmac_f32_16x16x64_bf16 v[84:87], v[68:71], v[248:255], v8
 ds_read_b128 v[56:59], v23 offset:4096
 s_waitcnt lgkmcnt(6)
 v_smfmac_f32_16x16x64_bf16 v[80:83], v[72:75], a[0:7], v8
 ds_read_b128 v[48:51], v14 offset:2048
 v_smfmac_f32_16x16x64_bf16 v[84:87], v[72:75], a[8:15], v8
 ds_read_b128 v[60:63], v23 offset:4128
 s_waitcnt lgkmcnt(7)
 v_smfmac_f32_16x16x64_bf16 v[80:83], v[76:79], a[16:23], v8
 ds_read_b128 v[52:55], v14 offset:3072
 v_smfmac_f32_16x16x64_bf16 v[84:87], v[76:79], a[24:31], v8
 ds_read_b128 v[64:67], v23 offset:5120
 s_waitcnt lgkmcnt(8)
 v_smfmac_f32_16x16x64_bf16 v[80:83], v[180:183], a[32:39], v8
 ds_read_b128 v[148:151], v15 offset:0
 v_smfmac_f32_16x16x64_bf16 v[84:87], v[180:183], a[40:47], v8
 ds_read_b128 v[68:71], v23 offset:5152
 s_waitcnt lgkmcnt(8)
 v_smfmac_f32_16x16x64_bf16 v[80:83], v[184:187], a[48:55], v8
 ds_read_b128 v[152:155], v15 offset:1024
 v_smfmac_f32_16x16x64_bf16 v[84:87], v[184:187], a[56:63], v8
 ds_read_b128 v[72:75], v23 offset:6144
 s_waitcnt lgkmcnt(8)
 v_smfmac_f32_16x16x64_bf16 v[80:83], v[56:59], a[64:71], v8
 ds_read_b128 v[156:159], v15 offset:2048
 v_smfmac_f32_16x16x64_bf16 v[84:87], v[56:59], a[72:79], v8
 ds_read_b128 v[76:79], v23 offset:6176
 s_waitcnt lgkmcnt(8)
 v_smfmac_f32_16x16x64_bf16 v[80:83], v[60:63], a[80:87], v8
 ds_read_b128 v[160:163], v15 offset:3072
 v_smfmac_f32_16x16x64_bf16 v[84:87], v[60:63], a[88:95], v8
 ds_read_b128 v[180:183], v23 offset:7168
 s_waitcnt lgkmcnt(8)
 v_smfmac_f32_16x16x64_bf16 v[80:83], v[64:67], a[96:103], v8
 ds_read_b128 v[164:167], v15 offset:4096
 v_smfmac_f32_16x16x64_bf16 v[84:87], v[64:67], a[104:111], v8
 ds_read_b128 v[184:187], v23 offset:7200
 s_waitcnt lgkmcnt(8)
 v_smfmac_f32_16x16x64_bf16 v[80:83], v[68:71], a[112:119], v8
 ds_read_b128 v[168:171], v15 offset:5120
 v_smfmac_f32_16x16x64_bf16 v[84:87], v[68:71], a[120:127], v8
 ds_read_b128 v[56:59], v23 offset:8192
 s_waitcnt lgkmcnt(8)
 v_smfmac_f32_16x16x64_bf16 v[80:83], v[72:75], a[128:135], v8
 ds_read_b128 v[172:175], v15 offset:6144
 v_smfmac_f32_16x16x64_bf16 v[84:87], v[72:75], a[136:143], v8
 ds_read_b128 v[60:63], v23 offset:8224
 s_waitcnt lgkmcnt(8)
 v_smfmac_f32_16x16x64_bf16 v[80:83], v[76:79], a[144:151], v8
 ds_read_b128 v[176:179], v15 offset:7168
 v_smfmac_f32_16x16x64_bf16 v[84:87], v[76:79], a[152:159], v8
 ds_read_b128 v[64:67], v23 offset:9216
 s_waitcnt lgkmcnt(8)
 v_smfmac_f32_16x16x64_bf16 v[80:83], v[180:183], a[160:167], v8
 ds_read_b128 v[140:143], v17 offset:10240
 v_smfmac_f32_16x16x64_bf16 v[84:87], v[180:183], a[168:175], v8
 ds_read_b128 v[68:71], v23 offset:9248
 s_waitcnt lgkmcnt(8)
 v_smfmac_f32_16x16x64_bf16 v[80:83], v[184:187], a[176:183], v8
 ds_read_b128 v[144:147], v17 offset:11264
 v_smfmac_f32_16x16x64_bf16 v[84:87], v[184:187], a[184:191], v8
 s_waitcnt lgkmcnt(7)
 v_smfmac_f32_16x16x64_bf16 v[80:83], v[56:59], a[192:199], v8
 v_smfmac_f32_16x16x64_bf16 v[84:87], v[56:59], a[200:207], v8
 s_waitcnt lgkmcnt(5)
 v_smfmac_f32_16x16x64_bf16 v[80:83], v[60:63], a[208:215], v8
 v_smfmac_f32_16x16x64_bf16 v[84:87], v[60:63], a[216:223], v8
 s_waitcnt lgkmcnt(3)
 v_smfmac_f32_16x16x64_bf16 v[80:83], v[64:67], a[224:231], v8
 v_smfmac_f32_16x16x64_bf16 v[84:87], v[64:67], a[232:239], v8
 s_waitcnt lgkmcnt(1)
 v_smfmac_f32_16x16x64_bf16 v[80:83], v[68:71], a[240:247], v8
 v_smfmac_f32_16x16x64_bf16 v[84:87], v[68:71], a[248:255], v8
 s_lshl_b32 s16, s53, 19
 s_add_u32 s16, s16, s54
 s_xor_b32 s72, s16, 8192
 s_add_u32 s72, s72, s71
 s_add_u32 s16, s16, s70
 v_cvt_pk_bf16_f32 v36, v80, v81
 v_cvt_pk_bf16_f32 v37, v82, v83
 s_nop 2
 v_cvt_pk_bf16_f32 v38, v84, v85
 v_cvt_pk_bf16_f32 v39, v86, v87
 buffer_store_dwordx4 v[36:39], v18, s[4:7], s61 offen sc1
 ds_write_b128 v16, v[36:39] offset:14336
 s_waitcnt vmcnt(1) lgkmcnt(1)
L_wf_346:
 v_cmp_ge_u32 vcc, s53, v13
 s_cbranch_vccnz L_rt_347
 v_mfma_f32_16x16x32_bf16 v[100:103], v[148:151], v[40:43], v[108:111]
 s_add_u32 m0, s68, 49152
 s_nop 0
 buffer_load_dwordx4 v1, s[4:7], s72 offen offset:0 sc1 nt lds
 ds_read_b128 v[56:59], v19 offset:0
 v_mfma_f32_16x16x32_bf16 v[104:107], v[164:167], v[40:43], v[112:115]
 ds_read_b128 v[60:63], v19 offset:1024
 v_mfma_f32_16x16x32_bf16 v[96:99], v[124:127], v[40:43], 0
 ds_read_b128 v[64:67], v19 offset:2048
 v_mfma_f32_16x16x32_bf16 v[100:103], v[152:155], v[44:47], v[100:103]
 ds_read_b128 v[68:71], v19 offset:3072
 buffer_load_dwordx4 v1, s[4:7], s72 offen offset:1024 sc1 nt lds
 v_mfma_f32_16x16x32_bf16 v[104:107], v[168:171], v[44:47], v[104:107]
 ds_read_b128 v[72:75], v19 offset:4096
 v_mfma_f32_16x16x32_bf16 v[96:99], v[128:131], v[44:47], v[96:99]
 ds_read_b128 v[76:79], v19 offset:5120
 v_mfma_f32_16x16x32_bf16 v[100:103], v[156:159], v[48:51], v[100:103]
 ds_read_b128 v[180:183], v19 offset:6144
 v_mfma_f32_16x16x32_bf16 v[104:107], v[172:175], v[48:51], v[104:107]
 buffer_load_dwordx4 v1, s[4:7], s72 offen offset:2048 sc1 nt lds
 ds_read_b128 v[184:187], v19 offset:7168
 v_mfma_f32_16x16x32_bf16 v[96:99], v[132:135], v[48:51], v[96:99]
 v_mfma_f32_16x16x32_bf16 v[100:103], v[160:163], v[52:55], v[100:103]
 v_mfma_f32_16x16x32_bf16 v[104:107], v[176:179], v[52:55], v[104:107]
 v_mfma_f32_16x16x32_bf16 v[96:99], v[136:139], v[52:55], v[96:99]
 v_mov_b32 v80, 0
 v_mov_b32 v81, 0
 buffer_load_dwordx4 v1, s[4:7], s72 offen offset:3072 sc1 nt lds
 v_mov_b32 v82, 0
 v_mov_b32 v83, 0
 v_mov_b32 v84, 0
 v_mov_b32 v85, 0
 v_mov_b32 v86, 0
 v_mov_b32 v87, 0
 v_cvt_pk_bf16_f32 v7, v100, v101
 s_add_u32 m0, s69, 49152
 s_nop 0
 buffer_load_dwordx4 v1, s[4:7], s16 offen offset:0 sc1 lds
 v_lshlrev_b32 v100, 16, v7
 v_and_b32 v101, 0xffff0000, v7
 v_cvt_pk_bf16_f32 v7, v102, v103
 v_lshlrev_b32 v102, 16, v7
 v_and_b32 v103, 0xffff0000, v7
 v_cvt_pk_bf16_f32 v7, v104, v105
 v_lshlrev_b32 v104, 16, v7
 buffer_load_dwordx4 v1, s[4:7], s16 offen offset:1024 sc1 lds
 v_and_b32 v105, 0xffff0000, v7
 v_cvt_pk_bf16_f32 v7, v106, v107
 v_lshlrev_b32 v106, 16, v7
 v_and_b32 v107, 0xffff0000, v7
 v_cvt_pk_bf16_f32 v7, v98, v99
 v_lshlrev_b32 v98, 16, v7
 v_and_b32 v99, 0xffff0000, v7
 buffer_load_dwordx4 v1, s[4:7], s16 offen offset:2048 sc1 lds
 v_pk_mul_f32 v[100:101], v[100:101], s[64:65] op_sel:[0,1] op_sel_hi:[1,1]
 v_pk_mul_f32 v[102:103], v[102:103], s[64:65] op_sel:[0,1] op_sel_hi:[1,1]
 v_pk_mul_f32 v[104:105], v[104:105], s[64:65] op_sel:[0,1] op_sel_hi:[1,1]
 v_pk_mul_f32 v[106:107], v[106:107], s[64:65] op_sel:[0,1] op_sel_hi:[1,1]
 v_pk_mul_f32 v[98:99], v[98:99], s[64:65] op_sel:[0,1] op_sel_hi:[1,1]
 v_cvt_pk_bf16_f32 v7, v100, v101
 v_lshlrev_b32 v100, 16, v7
 buffer_load_dwordx4 v1, s[4:7], s16 offen offset:3072 sc1 lds
 v_and_b32 v101, 0xffff0000, v7
 v_cvt_pk_bf16_f32 v7, v102, v103
 v_lshlrev_b32 v102, 16, v7
 v_and_b32 v103, 0xffff0000, v7
 v_cvt_pk_bf16_f32 v7, v104, v105
 v_lshlrev_b32 v104, 16, v7
 v_and_b32 v105, 0xffff0000, v7
 s_add_u32 m0, s69, 53248
 s_nop 0
 buffer_load_dwordx4 v6, s[4:7], s16 offen offset:0 sc1 lds
 v_cvt_pk_bf16_f32 v7, v106, v107
 v_lshlrev_b32 v106, 16, v7
 v_and_b32 v107, 0xffff0000, v7
 v_cvt_pk_bf16_f32 v7, v98, v99
 v_lshlrev_b32 v98, 16, v7
 v_and_b32 v99, 0xffff0000, v7
 v_max_f32 v20, v100, v101
 buffer_load_dwordx4 v6, s[4:7], s16 offen offset:1024 sc1 lds
 v_max3_f32 v20, v20, v102, v103
 v_max3_f32 v20, v20, v104, v105
 v_max3_f32 v20, v20, v106, v107
 v_max3_f32 v20, v20, v98, v99
 v_mov_b32 v22, v20
 s_nop 1
 v_permlane16_swap_b32 v20, v22
 buffer_load_dwordx4 v6, s[4:7], s16 offen offset:2048 sc1 lds
 v_max_f32 v20, v20, v22
 v_mov_b32 v22, v20
 s_nop 1
 v_permlane32_swap_b32 v20, v22
 v_max_f32 v20, v20, v22
 v_mul_f32 v22, s66, v20
 v_fma_f32 v100, v100, s66, -v22
 buffer_load_dwordx4 v6, s[4:7], s16 offen offset:3072 sc1 lds
 v_fma_f32 v101, v101, s66, -v22
 v_fma_f32 v102, v102, s66, -v22
 v_fma_f32 v103, v103, s66, -v22
 v_fma_f32 v104, v104, s66, -v22
 v_fma_f32 v105, v105, s66, -v22
 v_fma_f32 v106, v106, s66, -v22
 v_fma_f32 v107, v107, s66, -v22
 buffer_store_dwordx4 v[32:35], v18, s[4:7], s60 offen sc1
 v_fma_f32 v98, v98, s66, -v22
 v_fma_f32 v99, v99, s66, -v22
 v_exp_f32 v100, v100
 v_exp_f32 v101, v101
 v_exp_f32 v102, v102
 v_exp_f32 v103, v103
 v_exp_f32 v104, v104
 buffer_load_dwordx4 v[124:127], v1, s[4:7], s61 offen offset:0 sc1
 v_exp_f32 v105, v105
 v_exp_f32 v106, v106
 v_exp_f32 v107, v107
 v_exp_f32 v98, v98
 v_exp_f32 v99, v99
 v_add_f32 v28, v100, v101
 v_add_f32 v28, v28, v102
 buffer_load_dwordx4 v[128:131], v1, s[4:7], s61 offen offset:1024 sc1
 v_add_f32 v28, v28, v103
 v_add_f32 v28, v28, v104
 v_add_f32 v28, v28, v105
 v_add_f32 v28, v28, v106
 v_add_f32 v28, v28, v107
 v_add_f32 v28, v28, v98
 v_add_f32 v28, v28, v99
 buffer_load_dwordx4 v[132:135], v1, s[4:7], s61 offen offset:2048 sc1
 v_mov_b32 v22, v28
 s_nop 1
 v_permlane16_swap_b32 v28, v22
 v_add_f32 v28, v28, v22
 v_mov_b32 v22, v28
 s_nop 1
 v_permlane32_swap_b32 v28, v22
 buffer_load_dwordx4 v[136:139], v1, s[4:7], s61 offen offset:3072 sc1
 v_add_f32 v28, v28, v22
 v_rcp_f32 v28, v28
 s_nop 0
 v_pk_mul_f32 v[100:101], v[100:101], v[28:29] op_sel_hi:[1,0]
 v_pk_mul_f32 v[102:103], v[102:103], v[28:29] op_sel_hi:[1,0]
 v_pk_mul_f32 v[104:105], v[104:105], v[28:29] op_sel_hi:[1,0]
 v_pk_mul_f32 v[106:107], v[106:107], v[28:29] op_sel_hi:[1,0]
 v_pk_mul_f32 v[98:99], v[98:99], v[28:29] op_sel_hi:[1,0]
 v_cvt_pk_bf16_f32 v116, v100, v101
 v_cvt_pk_bf16_f32 v117, v102, v103
 v_cvt_pk_bf16_f32 v118, v104, v105
 v_cvt_pk_bf16_f32 v119, v106, v107
 v_cvt_pk_bf16_f32 v120, v98, v99
 v_cvt_pk_bf16_f32 v123, v98, v99
 s_waitcnt lgkmcnt(0)
 v_mfma_f32_16x16x32_bf16 v[148:151], v[56:59], v[116:119], 0
 v_mfma_f32_16x16x32_bf16 v[152:155], v[60:63], v[116:119], 0
 v_mfma_f32_16x16x16_bf16 v[148:151], v[140:141], v[120:121], v[148:151]
 v_mfma_f32_16x16x32_bf16 v[156:159], v[64:67], v[116:119], 0
 v_mfma_f32_16x16x16_bf16 v[152:155], v[140:141], v[122:123], v[152:155]
 v_mfma_f32_16x16x32_bf16 v[160:163], v[68:71], v[116:119], 0
 v_mfma_f32_16x16x16_bf16 v[156:159], v[142:143], v[120:121], v[156:159]
 v_mfma_f32_16x16x32_bf16 v[164:167], v[72:75], v[116:119], 0
 v_mfma_f32_16x16x16_bf16 v[160:163], v[142:143], v[122:123], v[160:163]
 v_cvt_pk_bf16_f32 v40, v148, v149
 v_cvt_pk_bf16_f32 v41, v150, v151
 v_cvt_pk_bf16_f32 v42, v152, v153
 v_cvt_pk_bf16_f32 v43, v154, v155
 buffer_store_dwordx4 v[40:43], v11, s[4:7], s33 offen offset:0 sc1
 v_mfma_f32_16x16x32_bf16 v[168:171], v[76:79], v[116:119], 0
 v_mfma_f32_16x16x16_bf16 v[164:167], v[144:145], v[120:121], v[164:167]
 v_mfma_f32_16x16x32_bf16 v[172:175], v[180:183], v[116:119], 0
 v_mfma_f32_16x16x16_bf16 v[168:171], v[144:145], v[122:123], v[168:171]
 v_cvt_pk_bf16_f32 v44, v156, v157
 v_cvt_pk_bf16_f32 v45, v158, v159
 v_cvt_pk_bf16_f32 v46, v160, v161
 v_cvt_pk_bf16_f32 v47, v162, v163
 buffer_store_dwordx4 v[44:47], v11, s[4:7], s33 offen offset:2048 sc1
 s_add_u32 s33, s33, 4096
 v_mfma_f32_16x16x32_bf16 v[176:179], v[184:187], v[116:119], 0
 v_mfma_f32_16x16x16_bf16 v[172:175], v[146:147], v[120:121], v[172:175]
 v_mfma_f32_16x16x16_bf16 v[176:179], v[146:147], v[122:123], v[176:179]
 v_cvt_pk_bf16_f32 v48, v164, v165
 v_cvt_pk_bf16_f32 v49, v166, v167
 v_cvt_pk_bf16_f32 v50, v168, v169
 v_cvt_pk_bf16_f32 v51, v170, v171
 buffer_store_dwordx4 v[48:51], v11, s[4:7], s33 offen offset:0 sc1
 s_nop 3
 v_cvt_pk_bf16_f32 v52, v172, v173
 v_cvt_pk_bf16_f32 v53, v174, v175
 v_cvt_pk_bf16_f32 v54, v176, v177
 v_cvt_pk_bf16_f32 v55, v178, v179
 buffer_store_dwordx4 v[52:55], v11, s[4:7], s33 offen offset:2048 sc1
 s_cmp_ge_u32 s33, 268435456
 s_cselect_b32 s34, 268435456, s67
 s_add_u32 s67, s67, 4
 s_lshl_b32 s33, s53, 19
 s_add_u32 s33, s33, s54
 s_xor_b32 s33, s33, 8192
 s_add_u32 s33, s33, 67108864
 s_add_u32 s53, s53, 1
 v_mov_b32 v10, s53
 s_mov_b64 exec, 1
 buffer_store_dword v10, off, s[4:7], s35 sc1
 s_mov_b64 exec, -1
 s_waitcnt vmcnt(5)
L_pk_348:
 v_max3_u32 v7, v124, v128, v132
 v_max_u32 v7, v7, v136
 v_cmp_eq_u32 vcc, -1, v7
 s_cbranch_vccnz L_rt_349
 s_mov_b32 s51, 0
 buffer_load_dword v7, off, s[4:7], s17 sc1
 s_waitcnt vmcnt(0)
L_go_350:
 v_cmp_gt_u32 vcc, s53, v7
 s_cbranch_vccnz L_rt_351
 s_mov_b32 s51, 0
 s_nop 15
 s_nop 7
 buffer_load_dwordx4 v[40:43], v2, s[4:7], s58 offen offset:0 sc1
 buffer_load_dwordx4 v[44:47], v2, s[4:7], s58 offen offset:128 sc1
 buffer_load_dwordx4 v[48:51], v2, s[4:7], s58 offen offset:1024 sc1
 buffer_load_dwordx4 v[52:55], v2, s[4:7], s58 offen offset:1152 sc1
 buffer_load_dwordx4 v[56:59], v3, s[4:7], s58 offen offset:0 sc1
L_xm_352:
 s_waitcnt vmcnt(4)
 v_mfma_f32_16x16x32_bf16 v[60:63], v[24:27], v[40:43], 0
 s_waitcnt vmcnt(3)
 v_mfma_f32_16x16x32_bf16 v[64:67], v[24:27], v[44:47], 0
 s_waitcnt vmcnt(2)
 v_mfma_f32_16x16x32_bf16 v[68:71], v[24:27], v[48:51], 0
 v_max3_u32 v7, v40, v44, v48
 v_cvt_pk_bf16_f32 v60, v60, v61
 v_cvt_pk_bf16_f32 v61, v62, v63
 ds_write_b64 v4, v[60:61] offset:0
 s_waitcnt vmcnt(1)
 v_mfma_f32_16x16x32_bf16 v[72:75], v[24:27], v[52:55], 0
 v_cvt_pk_bf16_f32 v64, v64, v65
 v_cvt_pk_bf16_f32 v65, v66, v67
 ds_write_b64 v4, v[64:65] offset:8
 s_waitcnt vmcnt(0)
 v_mfma_f32_16x16x32_bf16 v[76:79], v[24:27], v[56:59], 0
 v_max3_u32 v7, v7, v52, v56
 v_cmp_eq_u32 vcc, -1, v7
 v_cvt_pk_bf16_f32 v68, v68, v69
 v_cvt_pk_bf16_f32 v69, v70, v71
 ds_write_b64 v4, v[68:69] offset:1024
 s_cbranch_vccnz L_rt_353
 v_cvt_pk_bf16_f32 v72, v72, v73
 v_cvt_pk_bf16_f32 v73, v74, v75
 ds_write_b64 v4, v[72:73] offset:1032
 s_nop 0
 v_cvt_pk_bf16_f32 v76, v76, v77
 v_cvt_pk_bf16_f32 v77, v78, v79
 ds_write_b64 v5, v[76:77] offset:0
 s_waitcnt lgkmcnt(0)
 s_barrier
 ds_read_b128 v[56:59], v23 offset:0
 ds_read_b128 v[60:63], v23 offset:32
 ds_read_b128 v[64:67], v23 offset:1024
 s_cmp_ge_u32 s34, 268435456
 s_cbranch_scc1 L_ns_354
 v_mov_b32 v10, 1
 s_mov_b64 exec, 31
 buffer_atomic_add v10, v12, s[4:7], s34 offen
 s_mov_b64 exec, -1
 L_ns_354:
 buffer_load_dword v13, off, s[4:7], s32 sc1
 s_waitcnt lgkmcnt(2)
 v_smfmac_f32_16x16x64_bf16 v[80:83], v[56:59], v[192:199], v8
 ds_read_b128 v[68:71], v23 offset:1056
 v_smfmac_f32_16x16x64_bf16 v[84:87], v[56:59], v[200:207], v8
 ds_read_b128 v[72:75], v23 offset:2048
 s_waitcnt lgkmcnt(3)
 v_smfmac_f32_16x16x64_bf16 v[80:83], v[60:63], v[208:215], v8
 ds_read_b128 v[76:79], v23 offset:2080
 v_smfmac_f32_16x16x64_bf16 v[84:87], v[60:63], v[216:223], v8
 ds_read_b128 v[180:183], v23 offset:3072
 s_waitcnt lgkmcnt(4)
 v_smfmac_f32_16x16x64_bf16 v[80:83], v[64:67], v[224:231], v8
 ds_read_b128 v[40:43], v14 offset:49152
 v_smfmac_f32_16x16x64_bf16 v[84:87], v[64:67], v[232:239], v8
 ds_read_b128 v[184:187], v23 offset:3104
 s_waitcnt lgkmcnt(5)
 v_smfmac_f32_16x16x64_bf16 v[80:83], v[68:71], v[240:247], v8
 ds_read_b128 v[44:47], v14 offset:50176
 v_smfmac_f32_16x16x64_bf16 v[84:87], v[68:71], v[248:255], v8
 ds_read_b128 v[56:59], v23 offset:4096
 s_waitcnt lgkmcnt(6)
 v_smfmac_f32_16x16x64_bf16 v[80:83], v[72:75], a[0:7], v8
 ds_read_b128 v[48:51], v14 offset:51200
 v_smfmac_f32_16x16x64_bf16 v[84:87], v[72:75], a[8:15], v8
 ds_read_b128 v[60:63], v23 offset:4128
 s_waitcnt lgkmcnt(7)
 v_smfmac_f32_16x16x64_bf16 v[80:83], v[76:79], a[16:23], v8
 ds_read_b128 v[52:55], v14 offset:52224
 v_smfmac_f32_16x16x64_bf16 v[84:87], v[76:79], a[24:31], v8
 ds_read_b128 v[64:67], v23 offset:5120
 s_waitcnt lgkmcnt(8)
 v_smfmac_f32_16x16x64_bf16 v[80:83], v[180:183], a[32:39], v8
 ds_read_b128 v[148:151], v15 offset:49152
 v_smfmac_f32_16x16x64_bf16 v[84:87], v[180:183], a[40:47], v8
 ds_read_b128 v[68:71], v23 offset:5152
 s_waitcnt lgkmcnt(8)
 v_smfmac_f32_16x16x64_bf16 v[80:83], v[184:187], a[48:55], v8
 ds_read_b128 v[152:155], v15 offset:50176
 v_smfmac_f32_16x16x64_bf16 v[84:87], v[184:187], a[56:63], v8
 ds_read_b128 v[72:75], v23 offset:6144
 s_waitcnt lgkmcnt(8)
 v_smfmac_f32_16x16x64_bf16 v[80:83], v[56:59], a[64:71], v8
 ds_read_b128 v[156:159], v15 offset:51200
 v_smfmac_f32_16x16x64_bf16 v[84:87], v[56:59], a[72:79], v8
 ds_read_b128 v[76:79], v23 offset:6176
 s_waitcnt lgkmcnt(8)
 v_smfmac_f32_16x16x64_bf16 v[80:83], v[60:63], a[80:87], v8
 ds_read_b128 v[160:163], v15 offset:52224
 v_smfmac_f32_16x16x64_bf16 v[84:87], v[60:63], a[88:95], v8
 ds_read_b128 v[180:183], v23 offset:7168
 s_waitcnt lgkmcnt(8)
 v_smfmac_f32_16x16x64_bf16 v[80:83], v[64:67], a[96:103], v8
 ds_read_b128 v[164:167], v15 offset:53248
 v_smfmac_f32_16x16x64_bf16 v[84:87], v[64:67], a[104:111], v8
 ds_read_b128 v[184:187], v23 offset:7200
 s_waitcnt lgkmcnt(8)
 v_smfmac_f32_16x16x64_bf16 v[80:83], v[68:71], a[112:119], v8
 ds_read_b128 v[168:171], v15 offset:54272
 v_smfmac_f32_16x16x64_bf16 v[84:87], v[68:71], a[120:127], v8
 ds_read_b128 v[56:59], v23 offset:8192
 s_waitcnt lgkmcnt(8)
 v_smfmac_f32_16x16x64_bf16 v[80:83], v[72:75], a[128:135], v8
 ds_read_b128 v[172:175], v15 offset:55296
 v_smfmac_f32_16x16x64_bf16 v[84:87], v[72:75], a[136:143], v8
 ds_read_b128 v[60:63], v23 offset:8224
 s_waitcnt lgkmcnt(8)
 v_smfmac_f32_16x16x64_bf16 v[80:83], v[76:79], a[144:151], v8
 ds_read_b128 v[176:179], v15 offset:56320
 v_smfmac_f32_16x16x64_bf16 v[84:87], v[76:79], a[152:159], v8
 ds_read_b128 v[64:67], v23 offset:9216
 s_waitcnt lgkmcnt(8)
 v_smfmac_f32_16x16x64_bf16 v[80:83], v[180:183], a[160:167], v8
 ds_read_b128 v[140:143], v17 offset:14336
 v_smfmac_f32_16x16x64_bf16 v[84:87], v[180:183], a[168:175], v8
 ds_read_b128 v[68:71], v23 offset:9248
 s_waitcnt lgkmcnt(8)
 v_smfmac_f32_16x16x64_bf16 v[80:83], v[184:187], a[176:183], v8
 ds_read_b128 v[144:147], v17 offset:15360
 v_smfmac_f32_16x16x64_bf16 v[84:87], v[184:187], a[184:191], v8
 s_waitcnt lgkmcnt(7)
 v_smfmac_f32_16x16x64_bf16 v[80:83], v[56:59], a[192:199], v8
 v_smfmac_f32_16x16x64_bf16 v[84:87], v[56:59], a[200:207], v8
 s_waitcnt lgkmcnt(5)
 v_smfmac_f32_16x16x64_bf16 v[80:83], v[60:63], a[208:215], v8
 v_smfmac_f32_16x16x64_bf16 v[84:87], v[60:63], a[216:223], v8
 s_waitcnt lgkmcnt(3)
 v_smfmac_f32_16x16x64_bf16 v[80:83], v[64:67], a[224:231], v8
 v_smfmac_f32_16x16x64_bf16 v[84:87], v[64:67], a[232:239], v8
 s_waitcnt lgkmcnt(1)
 v_smfmac_f32_16x16x64_bf16 v[80:83], v[68:71], a[240:247], v8
 v_smfmac_f32_16x16x64_bf16 v[84:87], v[68:71], a[248:255], v8
 s_lshl_b32 s16, s53, 19
 s_add_u32 s16, s16, s54
 s_xor_b32 s72, s16, 8192
 s_add_u32 s72, s72, s71
 s_add_u32 s16, s16, s70
 v_cvt_pk_bf16_f32 v36, v80, v81
 v_cvt_pk_bf16_f32 v37, v82, v83
 s_nop 2
 v_cvt_pk_bf16_f32 v38, v84, v85
 v_cvt_pk_bf16_f32 v39, v86, v87
 buffer_store_dwordx4 v[36:39], v18, s[4:7], s62 offen sc1
 ds_write_b128 v16, v[36:39] offset:10240
 s_waitcnt vmcnt(1) lgkmcnt(1)
L_wf_355:
 v_cmp_ge_u32 vcc, s53, v13
 s_cbranch_vccnz L_rt_356
 v_mfma_f32_16x16x32_bf16 v[100:103], v[148:151], v[40:43], v[108:111]
 s_add_u32 m0, s68, 0
 s_nop 0
 buffer_load_dwordx4 v1, s[4:7], s72 offen offset:0 sc1 nt lds
 ds_read_b128 v[56:59], v19 offset:49152
 v_mfma_f32_16x16x32_bf16 v[104:107], v[164:167], v[40:43], v[112:115]
 ds_read_b128 v[60:63], v19 offset:50176
 v_mfma_f32_16x16x32_bf16 v[96:99], v[124:127], v[40:43], 0
 ds_read_b128 v[64:67], v19 offset:51200
 v_mfma_f32_16x16x32_bf16 v[100:103], v[152:155], v[44:47], v[100:103]
 ds_read_b128 v[68:71], v19 offset:52224
 buffer_load_dwordx4 v1, s[4:7], s72 offen offset:1024 sc1 nt lds
 v_mfma_f32_16x16x32_bf16 v[104:107], v[168:171], v[44:47], v[104:107]
 ds_read_b128 v[72:75], v19 offset:53248
 v_mfma_f32_16x16x32_bf16 v[96:99], v[128:131], v[44:47], v[96:99]
 ds_read_b128 v[76:79], v19 offset:54272
 v_mfma_f32_16x16x32_bf16 v[100:103], v[156:159], v[48:51], v[100:103]
 ds_read_b128 v[180:183], v19 offset:55296
 v_mfma_f32_16x16x32_bf16 v[104:107], v[172:175], v[48:51], v[104:107]
 buffer_load_dwordx4 v1, s[4:7], s72 offen offset:2048 sc1 nt lds
 ds_read_b128 v[184:187], v19 offset:56320
 v_mfma_f32_16x16x32_bf16 v[96:99], v[132:135], v[48:51], v[96:99]
 v_mfma_f32_16x16x32_bf16 v[100:103], v[160:163], v[52:55], v[100:103]
 v_mfma_f32_16x16x32_bf16 v[104:107], v[176:179], v[52:55], v[104:107]
 v_mfma_f32_16x16x32_bf16 v[96:99], v[136:139], v[52:55], v[96:99]
 v_mov_b32 v80, 0
 v_mov_b32 v81, 0
 buffer_load_dwordx4 v1, s[4:7], s72 offen offset:3072 sc1 nt lds
 v_mov_b32 v82, 0
 v_mov_b32 v83, 0
 v_mov_b32 v84, 0
 v_mov_b32 v85, 0
 v_mov_b32 v86, 0
 v_mov_b32 v87, 0
 v_cvt_pk_bf16_f32 v7, v100, v101
 s_add_u32 m0, s69, 0
 s_nop 0
 buffer_load_dwordx4 v1, s[4:7], s16 offen offset:0 sc1 lds
 v_lshlrev_b32 v100, 16, v7
 v_and_b32 v101, 0xffff0000, v7
 v_cvt_pk_bf16_f32 v7, v102, v103
 v_lshlrev_b32 v102, 16, v7
 v_and_b32 v103, 0xffff0000, v7
 v_cvt_pk_bf16_f32 v7, v104, v105
 v_lshlrev_b32 v104, 16, v7
 buffer_load_dwordx4 v1, s[4:7], s16 offen offset:1024 sc1 lds
 v_and_b32 v105, 0xffff0000, v7
 v_cvt_pk_bf16_f32 v7, v106, v107
 v_lshlrev_b32 v106, 16, v7
 v_and_b32 v107, 0xffff0000, v7
 v_cvt_pk_bf16_f32 v7, v98, v99
 v_lshlrev_b32 v98, 16, v7
 v_and_b32 v99, 0xffff0000, v7
 buffer_load_dwordx4 v1, s[4:7], s16 offen offset:2048 sc1 lds
 v_pk_mul_f32 v[100:101], v[100:101], s[64:65] op_sel:[0,1] op_sel_hi:[1,1]
 v_pk_mul_f32 v[102:103], v[102:103], s[64:65] op_sel:[0,1] op_sel_hi:[1,1]
 v_pk_mul_f32 v[104:105], v[104:105], s[64:65] op_sel:[0,1] op_sel_hi:[1,1]
 v_pk_mul_f32 v[106:107], v[106:107], s[64:65] op_sel:[0,1] op_sel_hi:[1,1]
 v_pk_mul_f32 v[98:99], v[98:99], s[64:65] op_sel:[0,1] op_sel_hi:[1,1]
 v_cvt_pk_bf16_f32 v7, v100, v101
 v_lshlrev_b32 v100, 16, v7
 buffer_load_dwordx4 v1, s[4:7], s16 offen offset:3072 sc1 lds
 v_and_b32 v101, 0xffff0000, v7
 v_cvt_pk_bf16_f32 v7, v102, v103
 v_lshlrev_b32 v102, 16, v7
 v_and_b32 v103, 0xffff0000, v7
 v_cvt_pk_bf16_f32 v7, v104, v105
 v_lshlrev_b32 v104, 16, v7
 v_and_b32 v105, 0xffff0000, v7
 s_add_u32 m0, s69, 4096
 s_nop 0
 buffer_load_dwordx4 v6, s[4:7], s16 offen offset:0 sc1 lds
 v_cvt_pk_bf16_f32 v7, v106, v107
 v_lshlrev_b32 v106, 16, v7
 v_and_b32 v107, 0xffff0000, v7
 v_cvt_pk_bf16_f32 v7, v98, v99
 v_lshlrev_b32 v98, 16, v7
 v_and_b32 v99, 0xffff0000, v7
 v_max_f32 v20, v100, v101
 buffer_load_dwordx4 v6, s[4:7], s16 offen offset:1024 sc1 lds
 v_max3_f32 v20, v20, v102, v103
 v_max3_f32 v20, v20, v104, v105
 v_max3_f32 v20, v20, v106, v107
 v_max3_f32 v20, v20, v98, v99
 v_mov_b32 v22, v20
 s_nop 1
 v_permlane16_swap_b32 v20, v22
 buffer_load_dwordx4 v6, s[4:7], s16 offen offset:2048 sc1 lds
 v_max_f32 v20, v20, v22
 v_mov_b32 v22, v20
 s_nop 1
 v_permlane32_swap_b32 v20, v22
 v_max_f32 v20, v20, v22
 v_mul_f32 v22, s66, v20
 v_fma_f32 v100, v100, s66, -v22
 buffer_load_dwordx4 v6, s[4:7], s16 offen offset:3072 sc1 lds
 v_fma_f32 v101, v101, s66, -v22
 v_fma_f32 v102, v102, s66, -v22
 v_fma_f32 v103, v103, s66, -v22
 v_fma_f32 v104, v104, s66, -v22
 v_fma_f32 v105, v105, s66, -v22
 v_fma_f32 v106, v106, s66, -v22
 v_fma_f32 v107, v107, s66, -v22
 buffer_store_dwordx4 v[32:35], v18, s[4:7], s61 offen sc1
 v_fma_f32 v98, v98, s66, -v22
 v_fma_f32 v99, v99, s66, -v22
 v_exp_f32 v100, v100
 v_exp_f32 v101, v101
 v_exp_f32 v102, v102
 v_exp_f32 v103, v103
 v_exp_f32 v104, v104
 buffer_load_dwordx4 v[124:127], v1, s[4:7], s62 offen offset:0 sc1
 v_exp_f32 v105, v105
 v_exp_f32 v106, v106
 v_exp_f32 v107, v107
 v_exp_f32 v98, v98
 v_exp_f32 v99, v99
 v_add_f32 v28, v100, v101
 v_add_f32 v28, v28, v102
 buffer_load_dwordx4 v[128:131], v1, s[4:7], s62 offen offset:1024 sc1
 v_add_f32 v28, v28, v103
 v_add_f32 v28, v28, v104
 v_add_f32 v28, v28, v105
 v_add_f32 v28, v28, v106
 v_add_f32 v28, v28, v107
 v_add_f32 v28, v28, v98
 v_add_f32 v28, v28, v99
 buffer_load_dwordx4 v[132:135], v1, s[4:7], s62 offen offset:2048 sc1
 v_mov_b32 v22, v28
 s_nop 1
 v_permlane16_swap_b32 v28, v22
 v_add_f32 v28, v28, v22
 v_mov_b32 v22, v28
 s_nop 1
 v_permlane32_swap_b32 v28, v22
 buffer_load_dwordx4 v[136:139], v1, s[4:7], s62 offen offset:3072 sc1
 v_add_f32 v28, v28, v22
 v_rcp_f32 v28, v28
 s_nop 0
 v_pk_mul_f32 v[100:101], v[100:101], v[28:29] op_sel_hi:[1,0]
 v_pk_mul_f32 v[102:103], v[102:103], v[28:29] op_sel_hi:[1,0]
 v_pk_mul_f32 v[104:105], v[104:105], v[28:29] op_sel_hi:[1,0]
 v_pk_mul_f32 v[106:107], v[106:107], v[28:29] op_sel_hi:[1,0]
 v_pk_mul_f32 v[98:99], v[98:99], v[28:29] op_sel_hi:[1,0]
 v_cvt_pk_bf16_f32 v116, v100, v101
 v_cvt_pk_bf16_f32 v117, v102, v103
 v_cvt_pk_bf16_f32 v118, v104, v105
 v_cvt_pk_bf16_f32 v119, v106, v107
 v_cvt_pk_bf16_f32 v120, v98, v99
 v_cvt_pk_bf16_f32 v123, v98, v99
 s_waitcnt lgkmcnt(0)
 v_mfma_f32_16x16x32_bf16 v[148:151], v[56:59], v[116:119], 0
 v_mfma_f32_16x16x32_bf16 v[152:155], v[60:63], v[116:119], 0
 v_mfma_f32_16x16x16_bf16 v[148:151], v[140:141], v[120:121], v[148:151]
 v_mfma_f32_16x16x32_bf16 v[156:159], v[64:67], v[116:119], 0
 v_mfma_f32_16x16x16_bf16 v[152:155], v[140:141], v[122:123], v[152:155]
 v_mfma_f32_16x16x32_bf16 v[160:163], v[68:71], v[116:119], 0
 v_mfma_f32_16x16x16_bf16 v[156:159], v[142:143], v[120:121], v[156:159]
 v_mfma_f32_16x16x32_bf16 v[164:167], v[72:75], v[116:119], 0
 v_mfma_f32_16x16x16_bf16 v[160:163], v[142:143], v[122:123], v[160:163]
 v_cvt_pk_bf16_f32 v40, v148, v149
 v_cvt_pk_bf16_f32 v41, v150, v151
 v_cvt_pk_bf16_f32 v42, v152, v153
 v_cvt_pk_bf16_f32 v43, v154, v155
 buffer_store_dwordx4 v[40:43], v11, s[4:7], s33 offen offset:0 sc1
 v_mfma_f32_16x16x32_bf16 v[168:171], v[76:79], v[116:119], 0
 v_mfma_f32_16x16x16_bf16 v[164:167], v[144:145], v[120:121], v[164:167]
 v_mfma_f32_16x16x32_bf16 v[172:175], v[180:183], v[116:119], 0
 v_mfma_f32_16x16x16_bf16 v[168:171], v[144:145], v[122:123], v[168:171]
 v_cvt_pk_bf16_f32 v44, v156, v157
 v_cvt_pk_bf16_f32 v45, v158, v159
 v_cvt_pk_bf16_f32 v46, v160, v161
 v_cvt_pk_bf16_f32 v47, v162, v163
 buffer_store_dwordx4 v[44:47], v11, s[4:7], s33 offen offset:2048 sc1
 s_add_u32 s33, s33, 4096
 v_mfma_f32_16x16x32_bf16 v[176:179], v[184:187], v[116:119], 0
 v_mfma_f32_16x16x16_bf16 v[172:175], v[146:147], v[120:121], v[172:175]
 v_mfma_f32_16x16x16_bf16 v[176:179], v[146:147], v[122:123], v[176:179]
 v_cvt_pk_bf16_f32 v48, v164, v165
 v_cvt_pk_bf16_f32 v49, v166, v167
 v_cvt_pk_bf16_f32 v50, v168, v169
 v_cvt_pk_bf16_f32 v51, v170, v171
 buffer_store_dwordx4 v[48:51], v11, s[4:7], s33 offen offset:0 sc1
 s_nop 3
 v_cvt_pk_bf16_f32 v52, v172, v173
 v_cvt_pk_bf16_f32 v53, v174, v175
 v_cvt_pk_bf16_f32 v54, v176, v177
 v_cvt_pk_bf16_f32 v55, v178, v179
 buffer_store_dwordx4 v[52:55], v11, s[4:7], s33 offen offset:2048 sc1
 s_cmp_ge_u32 s33, 268435456
 s_cselect_b32 s34, 268435456, s67
 s_add_u32 s67, s67, 4
 s_lshl_b32 s33, s53, 19
 s_add_u32 s33, s33, s54
 s_xor_b32 s33, s33, 8192
 s_add_u32 s33, s33, 67108864
 s_add_u32 s53, s53, 1
 v_mov_b32 v10, s53
 s_mov_b64 exec, 1
 buffer_store_dword v10, off, s[4:7], s35 sc1
 s_mov_b64 exec, -1
 s_waitcnt vmcnt(5)
L_pk_357:
 v_max3_u32 v7, v124, v128, v132
 v_max_u32 v7, v7, v136
 v_cmp_eq_u32 vcc, -1, v7
 s_cbranch_vccnz L_rt_358
 s_mov_b32 s51, 0
 buffer_load_dword v7, off, s[4:7], s17 sc1
 s_waitcnt vmcnt(0)
L_go_359:
 v_cmp_gt_u32 vcc, s53, v7
 s_cbranch_vccnz L_rt_360
 s_mov_b32 s51, 0
 s_nop 15
 s_nop 7
 buffer_load_dwordx4 v[40:43], v2, s[4:7], s59 offen offset:0 sc1
 buffer_load_dwordx4 v[44:47], v2, s[4:7], s59 offen offset:128 sc1
 buffer_load_dwordx4 v[48:51], v2, s[4:7], s59 offen offset:1024 sc1
 buffer_load_dwordx4 v[52:55], v2, s[4:7], s59 offen offset:1152 sc1
 buffer_load_dwordx4 v[56:59], v3, s[4:7], s59 offen offset:0 sc1
L_xm_361:
 s_waitcnt vmcnt(4)
 v_mfma_f32_16x16x32_bf16 v[60:63], v[24:27], v[40:43], 0
 s_waitcnt vmcnt(3)
 v_mfma_f32_16x16x32_bf16 v[64:67], v[24:27], v[44:47], 0
 s_waitcnt vmcnt(2)
 v_mfma_f32_16x16x32_bf16 v[68:71], v[24:27], v[48:51], 0
 v_max3_u32 v7, v40, v44, v48
 v_cvt_pk_bf16_f32 v60, v60, v61
 v_cvt_pk_bf16_f32 v61, v62, v63
 ds_write_b64 v4, v[60:61] offset:0
 s_waitcnt vmcnt(1)
 v_mfma_f32_16x16x32_bf16 v[72:75], v[24:27], v[52:55], 0
 v_cvt_pk_bf16_f32 v64, v64, v65
 v_cvt_pk_bf16_f32 v65, v66, v67
 ds_write_b64 v4, v[64:65] offset:8
 s_waitcnt vmcnt(0)
 v_mfma_f32_16x16x32_bf16 v[76:79], v[24:27], v[56:59], 0
 v_max3_u32 v7, v7, v52, v56
 v_cmp_eq_u32 vcc, -1, v7
 v_cvt_pk_bf16_f32 v68, v68, v69
 v_cvt_pk_bf16_f32 v69, v70, v71
 ds_write_b64 v4, v[68:69] offset:1024
 s_cbranch_vccnz L_rt_362
 v_cvt_pk_bf16_f32 v72, v72, v73
 v_cvt_pk_bf16_f32 v73, v74, v75
 ds_write_b64 v4, v[72:73] offset:1032
 s_nop 0
 v_cvt_pk_bf16_f32 v76, v76, v77
 v_cvt_pk_bf16_f32 v77, v78, v79
 ds_write_b64 v5, v[76:77] offset:0
 s_waitcnt lgkmcnt(0)
 s_barrier
 ds_read_b128 v[56:59], v23 offset:0
 ds_read_b128 v[60:63], v23 offset:32
 ds_read_b128 v[64:67], v23 offset:1024
 s_cmp_ge_u32 s34, 268435456
 s_cbranch_scc1 L_ns_363
 v_mov_b32 v10, 1
 s_mov_b64 exec, 31
 buffer_atomic_add v10, v12, s[4:7], s34 offen
 s_mov_b64 exec, -1
 L_ns_363:
 buffer_load_dword v13, off, s[4:7], s32 sc1
 s_waitcnt lgkmcnt(2)
 v_smfmac_f32_16x16x64_bf16 v[80:83], v[56:59], v[192:199], v8
 ds_read_b128 v[68:71], v23 offset:1056
 v_smfmac_f32_16x16x64_bf16 v[84:87], v[56:59], v[200:207], v8
 ds_read_b128 v[72:75], v23 offset:2048
 s_waitcnt lgkmcnt(3)
 v_smfmac_f32_16x16x64_bf16 v[80:83], v[60:63], v[208:215], v8
 ds_read_b128 v[76:79], v23 offset:2080
 v_smfmac_f32_16x16x64_bf16 v[84:87], v[60:63], v[216:223], v8
 ds_read_b128 v[180:183], v23 offset:3072
 s_waitcnt lgkmcnt(4)
 v_smfmac_f32_16x16x64_bf16 v[80:83], v[64:67], v[224:231], v8
 ds_read_b128 v[40:43], v14 offset:0
 v_smfmac_f32_16x16x64_bf16 v[84:87], v[64:67], v[232:239], v8
 ds_read_b128 v[184:187], v23 offset:3104
 s_waitcnt lgkmcnt(5)
 v_smfmac_f32_16x16x64_bf16 v[80:83], v[68:71], v[240:247], v8
 ds_read_b128 v[44:47], v14 offset:1024
 v_smfmac_f32_16x16x64_bf16 v[84:87], v[68:71], v[248:255], v8
 ds_read_b128 v[56:59], v23 offset:4096
 s_waitcnt lgkmcnt(6)
 v_smfmac_f32_16x16x64_bf16 v[80:83], v[72:75], a[0:7], v8
 ds_read_b128 v[48:51], v14 offset:2048
 v_smfmac_f32_16x16x64_bf16 v[84:87], v[72:75], a[8:15], v8
 ds_read_b128 v[60:63], v23 offset:4128
 s_waitcnt lgkmcnt(7)
 v_smfmac_f32_16x16x64_bf16 v[80:83], v[76:79], a[16:23], v8
 ds_read_b128 v[52:55], v14 offset:3072
 v_smfmac_f32_16x16x64_bf16 v[84:87], v[76:79], a[24:31], v8
 ds_read_b128 v[64:67], v23 offset:5120
 s_waitcnt lgkmcnt(8)
 v_smfmac_f32_16x16x64_bf16 v[80:83], v[180:183], a[32:39], v8
 ds_read_b128 v[148:151], v15 offset:0
 v_smfmac_f32_16x16x64_bf16 v[84:87], v[180:183], a[40:47], v8
 ds_read_b128 v[68:71], v23 offset:5152
 s_waitcnt lgkmcnt(8)
 v_smfmac_f32_16x16x64_bf16 v[80:83], v[184:187], a[48:55], v8
 ds_read_b128 v[152:155], v15 offset:1024
 v_smfmac_f32_16x16x64_bf16 v[84:87], v[184:187], a[56:63], v8
 ds_read_b128 v[72:75], v23 offset:6144
 s_waitcnt lgkmcnt(8)
 v_smfmac_f32_16x16x64_bf16 v[80:83], v[56:59], a[64:71], v8
 ds_read_b128 v[156:159], v15 offset:2048
 v_smfmac_f32_16x16x64_bf16 v[84:87], v[56:59], a[72:79], v8
 ds_read_b128 v[76:79], v23 offset:6176
 s_waitcnt lgkmcnt(8)
 v_smfmac_f32_16x16x64_bf16 v[80:83], v[60:63], a[80:87], v8
 ds_read_b128 v[160:163], v15 offset:3072
 v_smfmac_f32_16x16x64_bf16 v[84:87], v[60:63], a[88:95], v8
 ds_read_b128 v[180:183], v23 offset:7168
 s_waitcnt lgkmcnt(8)
 v_smfmac_f32_16x16x64_bf16 v[80:83], v[64:67], a[96:103], v8
 ds_read_b128 v[164:167], v15 offset:4096
 v_smfmac_f32_16x16x64_bf16 v[84:87], v[64:67], a[104:111], v8
 ds_read_b128 v[184:187], v23 offset:7200
 s_waitcnt lgkmcnt(8)
 v_smfmac_f32_16x16x64_bf16 v[80:83], v[68:71], a[112:119], v8
 ds_read_b128 v[168:171], v15 offset:5120
 v_smfmac_f32_16x16x64_bf16 v[84:87], v[68:71], a[120:127], v8
 ds_read_b128 v[56:59], v23 offset:8192
 s_waitcnt lgkmcnt(8)
 v_smfmac_f32_16x16x64_bf16 v[80:83], v[72:75], a[128:135], v8
 ds_read_b128 v[172:175], v15 offset:6144
 v_smfmac_f32_16x16x64_bf16 v[84:87], v[72:75], a[136:143], v8
 ds_read_b128 v[60:63], v23 offset:8224
 s_waitcnt lgkmcnt(8)
 v_smfmac_f32_16x16x64_bf16 v[80:83], v[76:79], a[144:151], v8
 ds_read_b128 v[176:179], v15 offset:7168
 v_smfmac_f32_16x16x64_bf16 v[84:87], v[76:79], a[152:159], v8
 ds_read_b128 v[64:67], v23 offset:9216
 s_waitcnt lgkmcnt(8)
 v_smfmac_f32_16x16x64_bf16 v[80:83], v[180:183], a[160:167], v8
 ds_read_b128 v[140:143], v17 offset:10240
 v_smfmac_f32_16x16x64_bf16 v[84:87], v[180:183], a[168:175], v8
 ds_read_b128 v[68:71], v23 offset:9248
 s_waitcnt lgkmcnt(8)
 v_smfmac_f32_16x16x64_bf16 v[80:83], v[184:187], a[176:183], v8
 ds_read_b128 v[144:147], v17 offset:11264
 v_smfmac_f32_16x16x64_bf16 v[84:87], v[184:187], a[184:191], v8
 s_waitcnt lgkmcnt(7)
 v_smfmac_f32_16x16x64_bf16 v[80:83], v[56:59], a[192:199], v8
 v_smfmac_f32_16x16x64_bf16 v[84:87], v[56:59], a[200:207], v8
 s_waitcnt lgkmcnt(5)
 v_smfmac_f32_16x16x64_bf16 v[80:83], v[60:63], a[208:215], v8
 v_smfmac_f32_16x16x64_bf16 v[84:87], v[60:63], a[216:223], v8
 s_waitcnt lgkmcnt(3)
 v_smfmac_f32_16x16x64_bf16 v[80:83], v[64:67], a[224:231], v8
 v_smfmac_f32_16x16x64_bf16 v[84:87], v[64:67], a[232:239], v8
 s_waitcnt lgkmcnt(1)
 v_smfmac_f32_16x16x64_bf16 v[80:83], v[68:71], a[240:247], v8
 v_smfmac_f32_16x16x64_bf16 v[84:87], v[68:71], a[248:255], v8
 s_lshl_b32 s16, s53, 19
 s_add_u32 s16, s16, s54
 s_xor_b32 s72, s16, 8192
 s_add_u32 s72, s72, s71
 s_add_u32 s16, s16, s70
 v_cvt_pk_bf16_f32 v36, v80, v81
 v_cvt_pk_bf16_f32 v37, v82, v83
 s_nop 2
 v_cvt_pk_bf16_f32 v38, v84, v85
 v_cvt_pk_bf16_f32 v39, v86, v87
 buffer_store_dwordx4 v[36:39], v18, s[4:7], s63 offen sc1
 ds_write_b128 v16, v[36:39] offset:14336
 s_waitcnt vmcnt(1) lgkmcnt(1)
L_wf_364:
 v_cmp_ge_u32 vcc, s53, v13
 s_cbranch_vccnz L_rt_365
 v_mfma_f32_16x16x32_bf16 v[100:103], v[148:151], v[40:43], v[108:111]
 s_add_u32 m0, s68, 49152
 s_nop 0
 buffer_load_dwordx4 v1, s[4:7], s72 offen offset:0 sc1 nt lds
 ds_read_b128 v[56:59], v19 offset:0
 v_mfma_f32_16x16x32_bf16 v[104:107], v[164:167], v[40:43], v[112:115]
 ds_read_b128 v[60:63], v19 offset:1024
 v_mfma_f32_16x16x32_bf16 v[96:99], v[124:127], v[40:43], 0
 ds_read_b128 v[64:67], v19 offset:2048
 v_mfma_f32_16x16x32_bf16 v[100:103], v[152:155], v[44:47], v[100:103]
 ds_read_b128 v[68:71], v19 offset:3072
 buffer_load_dwordx4 v1, s[4:7], s72 offen offset:1024 sc1 nt lds
 v_mfma_f32_16x16x32_bf16 v[104:107], v[168:171], v[44:47], v[104:107]
 ds_read_b128 v[72:75], v19 offset:4096
 v_mfma_f32_16x16x32_bf16 v[96:99], v[128:131], v[44:47], v[96:99]
 ds_read_b128 v[76:79], v19 offset:5120
 v_mfma_f32_16x16x32_bf16 v[100:103], v[156:159], v[48:51], v[100:103]
 ds_read_b128 v[180:183], v19 offset:6144
 v_mfma_f32_16x16x32_bf16 v[104:107], v[172:175], v[48:51], v[104:107]
 buffer_load_dwordx4 v1, s[4:7], s72 offen offset:2048 sc1 nt lds
 ds_read_b128 v[184:187], v19 offset:7168
 v_mfma_f32_16x16x32_bf16 v[96:99], v[132:135], v[48:51], v[96:99]
 v_mfma_f32_16x16x32_bf16 v[100:103], v[160:163], v[52:55], v[100:103]
 v_mfma_f32_16x16x32_bf16 v[104:107], v[176:179], v[52:55], v[104:107]
 v_mfma_f32_16x16x32_bf16 v[96:99], v[136:139], v[52:55], v[96:99]
 v_mov_b32 v80, 0
 v_mov_b32 v81, 0
 buffer_load_dwordx4 v1, s[4:7], s72 offen offset:3072 sc1 nt lds
 v_mov_b32 v82, 0
 v_mov_b32 v83, 0
 v_mov_b32 v84, 0
 v_mov_b32 v85, 0
 v_mov_b32 v86, 0
 v_mov_b32 v87, 0
 v_cvt_pk_bf16_f32 v7, v100, v101
 s_add_u32 m0, s69, 49152
 s_nop 0
 buffer_load_dwordx4 v1, s[4:7], s16 offen offset:0 sc1 lds
 v_lshlrev_b32 v100, 16, v7
 v_and_b32 v101, 0xffff0000, v7
 v_cvt_pk_bf16_f32 v7, v102, v103
 v_lshlrev_b32 v102, 16, v7
 v_and_b32 v103, 0xffff0000, v7
 v_cvt_pk_bf16_f32 v7, v104, v105
 v_lshlrev_b32 v104, 16, v7
 buffer_load_dwordx4 v1, s[4:7], s16 offen offset:1024 sc1 lds
 v_and_b32 v105, 0xffff0000, v7
 v_cvt_pk_bf16_f32 v7, v106, v107
 v_lshlrev_b32 v106, 16, v7
 v_and_b32 v107, 0xffff0000, v7
 v_cvt_pk_bf16_f32 v7, v98, v99
 v_lshlrev_b32 v98, 16, v7
 v_and_b32 v99, 0xffff0000, v7
 buffer_load_dwordx4 v1, s[4:7], s16 offen offset:2048 sc1 lds
 v_pk_mul_f32 v[100:101], v[100:101], s[64:65] op_sel:[0,1] op_sel_hi:[1,1]
 v_pk_mul_f32 v[102:103], v[102:103], s[64:65] op_sel:[0,1] op_sel_hi:[1,1]
 v_pk_mul_f32 v[104:105], v[104:105], s[64:65] op_sel:[0,1] op_sel_hi:[1,1]
 v_pk_mul_f32 v[106:107], v[106:107], s[64:65] op_sel:[0,1] op_sel_hi:[1,1]
 v_pk_mul_f32 v[98:99], v[98:99], s[64:65] op_sel:[0,1] op_sel_hi:[1,1]
 v_cvt_pk_bf16_f32 v7, v100, v101
 v_lshlrev_b32 v100, 16, v7
 buffer_load_dwordx4 v1, s[4:7], s16 offen offset:3072 sc1 lds
 v_and_b32 v101, 0xffff0000, v7
 v_cvt_pk_bf16_f32 v7, v102, v103
 v_lshlrev_b32 v102, 16, v7
 v_and_b32 v103, 0xffff0000, v7
 v_cvt_pk_bf16_f32 v7, v104, v105
 v_lshlrev_b32 v104, 16, v7
 v_and_b32 v105, 0xffff0000, v7
 s_add_u32 m0, s69, 53248
 s_nop 0
 buffer_load_dwordx4 v6, s[4:7], s16 offen offset:0 sc1 lds
 v_cvt_pk_bf16_f32 v7, v106, v107
 v_lshlrev_b32 v106, 16, v7
 v_and_b32 v107, 0xffff0000, v7
 v_cvt_pk_bf16_f32 v7, v98, v99
 v_lshlrev_b32 v98, 16, v7
 v_and_b32 v99, 0xffff0000, v7
 v_max_f32 v20, v100, v101
 buffer_load_dwordx4 v6, s[4:7], s16 offen offset:1024 sc1 lds
 v_max3_f32 v20, v20, v102, v103
 v_max3_f32 v20, v20, v104, v105
 v_max3_f32 v20, v20, v106, v107
 v_max3_f32 v20, v20, v98, v99
 v_mov_b32 v22, v20
 s_nop 1
 v_permlane16_swap_b32 v20, v22
 buffer_load_dwordx4 v6, s[4:7], s16 offen offset:2048 sc1 lds
 v_max_f32 v20, v20, v22
 v_mov_b32 v22, v20
 s_nop 1
 v_permlane32_swap_b32 v20, v22
 v_max_f32 v20, v20, v22
 v_mul_f32 v22, s66, v20
 v_fma_f32 v100, v100, s66, -v22
 buffer_load_dwordx4 v6, s[4:7], s16 offen offset:3072 sc1 lds
 v_fma_f32 v101, v101, s66, -v22
 v_fma_f32 v102, v102, s66, -v22
 v_fma_f32 v103, v103, s66, -v22
 v_fma_f32 v104, v104, s66, -v22
 v_fma_f32 v105, v105, s66, -v22
 v_fma_f32 v106, v106, s66, -v22
 v_fma_f32 v107, v107, s66, -v22
 buffer_store_dwordx4 v[32:35], v18, s[4:7], s62 offen sc1
 v_fma_f32 v98, v98, s66, -v22
 v_fma_f32 v99, v99, s66, -v22
 v_exp_f32 v100, v100
 v_exp_f32 v101, v101
 v_exp_f32 v102, v102
 v_exp_f32 v103, v103
 v_exp_f32 v104, v104
 buffer_load_dwordx4 v[124:127], v1, s[4:7], s63 offen offset:0 sc1
 v_exp_f32 v105, v105
 v_exp_f32 v106, v106
 v_exp_f32 v107, v107
 v_exp_f32 v98, v98
 v_exp_f32 v99, v99
 v_add_f32 v28, v100, v101
 v_add_f32 v28, v28, v102
 buffer_load_dwordx4 v[128:131], v1, s[4:7], s63 offen offset:1024 sc1
 v_add_f32 v28, v28, v103
 v_add_f32 v28, v28, v104
 v_add_f32 v28, v28, v105
 v_add_f32 v28, v28, v106
 v_add_f32 v28, v28, v107
 v_add_f32 v28, v28, v98
 v_add_f32 v28, v28, v99
 buffer_load_dwordx4 v[132:135], v1, s[4:7], s63 offen offset:2048 sc1
 v_mov_b32 v22, v28
 s_nop 1
 v_permlane16_swap_b32 v28, v22
 v_add_f32 v28, v28, v22
 v_mov_b32 v22, v28
 s_nop 1
 v_permlane32_swap_b32 v28, v22
 buffer_load_dwordx4 v[136:139], v1, s[4:7], s63 offen offset:3072 sc1
 v_add_f32 v28, v28, v22
 v_rcp_f32 v28, v28
 s_nop 0
 v_pk_mul_f32 v[100:101], v[100:101], v[28:29] op_sel_hi:[1,0]
 v_pk_mul_f32 v[102:103], v[102:103], v[28:29] op_sel_hi:[1,0]
 v_pk_mul_f32 v[104:105], v[104:105], v[28:29] op_sel_hi:[1,0]
 v_pk_mul_f32 v[106:107], v[106:107], v[28:29] op_sel_hi:[1,0]
 v_pk_mul_f32 v[98:99], v[98:99], v[28:29] op_sel_hi:[1,0]
 v_cvt_pk_bf16_f32 v116, v100, v101
 v_cvt_pk_bf16_f32 v117, v102, v103
 v_cvt_pk_bf16_f32 v118, v104, v105
 v_cvt_pk_bf16_f32 v119, v106, v107
 v_cvt_pk_bf16_f32 v120, v98, v99
 v_cvt_pk_bf16_f32 v123, v98, v99
 s_waitcnt lgkmcnt(0)
 v_mfma_f32_16x16x32_bf16 v[148:151], v[56:59], v[116:119], 0
 v_mfma_f32_16x16x32_bf16 v[152:155], v[60:63], v[116:119], 0
 v_mfma_f32_16x16x16_bf16 v[148:151], v[140:141], v[120:121], v[148:151]
 v_mfma_f32_16x16x32_bf16 v[156:159], v[64:67], v[116:119], 0
 v_mfma_f32_16x16x16_bf16 v[152:155], v[140:141], v[122:123], v[152:155]
 v_mfma_f32_16x16x32_bf16 v[160:163], v[68:71], v[116:119], 0
 v_mfma_f32_16x16x16_bf16 v[156:159], v[142:143], v[120:121], v[156:159]
 v_mfma_f32_16x16x32_bf16 v[164:167], v[72:75], v[116:119], 0
 v_mfma_f32_16x16x16_bf16 v[160:163], v[142:143], v[122:123], v[160:163]
 v_cvt_pk_bf16_f32 v40, v148, v149
 v_cvt_pk_bf16_f32 v41, v150, v151
 v_cvt_pk_bf16_f32 v42, v152, v153
 v_cvt_pk_bf16_f32 v43, v154, v155
 buffer_store_dwordx4 v[40:43], v11, s[4:7], s33 offen offset:0 sc1
 v_mfma_f32_16x16x32_bf16 v[168:171], v[76:79], v[116:119], 0
 v_mfma_f32_16x16x16_bf16 v[164:167], v[144:145], v[120:121], v[164:167]
 v_mfma_f32_16x16x32_bf16 v[172:175], v[180:183], v[116:119], 0
 v_mfma_f32_16x16x16_bf16 v[168:171], v[144:145], v[122:123], v[168:171]
 v_cvt_pk_bf16_f32 v44, v156, v157
 v_cvt_pk_bf16_f32 v45, v158, v159
 v_cvt_pk_bf16_f32 v46, v160, v161
 v_cvt_pk_bf16_f32 v47, v162, v163
 buffer_store_dwordx4 v[44:47], v11, s[4:7], s33 offen offset:2048 sc1
 s_add_u32 s33, s33, 4096
 v_mfma_f32_16x16x32_bf16 v[176:179], v[184:187], v[116:119], 0
 v_mfma_f32_16x16x16_bf16 v[172:175], v[146:147], v[120:121], v[172:175]
 v_mfma_f32_16x16x16_bf16 v[176:179], v[146:147], v[122:123], v[176:179]
 v_cvt_pk_bf16_f32 v48, v164, v165
 v_cvt_pk_bf16_f32 v49, v166, v167
 v_cvt_pk_bf16_f32 v50, v168, v169
 v_cvt_pk_bf16_f32 v51, v170, v171
 buffer_store_dwordx4 v[48:51], v11, s[4:7], s33 offen offset:0 sc1
 s_nop 3
 v_cvt_pk_bf16_f32 v52, v172, v173
 v_cvt_pk_bf16_f32 v53, v174, v175
 v_cvt_pk_bf16_f32 v54, v176, v177
 v_cvt_pk_bf16_f32 v55, v178, v179
 buffer_store_dwordx4 v[52:55], v11, s[4:7], s33 offen offset:2048 sc1
 s_cmp_ge_u32 s33, 268435456
 s_cselect_b32 s34, 268435456, s67
 s_add_u32 s67, s67, 4
 s_lshl_b32 s33, s53, 19
 s_add_u32 s33, s33, s54
 s_xor_b32 s33, s33, 8192
 s_add_u32 s33, s33, 67108864
 s_add_u32 s53, s53, 1
 v_mov_b32 v10, s53
 s_mov_b64 exec, 1
 buffer_store_dword v10, off, s[4:7], s35 sc1
 s_mov_b64 exec, -1
 s_waitcnt vmcnt(5)
L_pk_366:
 v_max3_u32 v7, v124, v128, v132
 v_max_u32 v7, v7, v136
 v_cmp_eq_u32 vcc, -1, v7
 s_cbranch_vccnz L_rt_367
 s_cmp_eq_u32 s53, 64
 s_cbranch_scc1 L_vr_last
 s_branch L_vr_loops
L_rt_333:
 s_nop 7
 buffer_load_dword v7, off, s[4:7], s17 sc1
 s_waitcnt vmcnt(0)
 s_add_u32 s51, s51, 1
 s_cmp_lt_u32 s51, 131072
 s_cbranch_scc1 L_go_332
 s_branch L_bail
L_rt_335:
 s_nop 7
 buffer_load_dwordx4 v[40:43], v2, s[4:7], s56 offen offset:0 sc1
 buffer_load_dwordx4 v[44:47], v2, s[4:7], s56 offen offset:128 sc1
 buffer_load_dwordx4 v[48:51], v2, s[4:7], s56 offen offset:1024 sc1
 buffer_load_dwordx4 v[52:55], v2, s[4:7], s56 offen offset:1152 sc1
 buffer_load_dwordx4 v[56:59], v3, s[4:7], s56 offen offset:0 sc1
 s_add_u32 s51, s51, 1
 s_cmp_lt_u32 s51, 131072
 s_cbranch_scc1 L_xm_334
 s_branch L_bail
L_rt_338:
 s_sleep 1
 buffer_load_dword v13, off, s[4:7], s32 sc1
 s_waitcnt vmcnt(0)
 s_add_u32 s51, s51, 1
 s_cmp_lt_u32 s51, 131072
 s_cbranch_scc1 L_wf_337
 s_branch L_bail
L_rt_340:
 s_nop 7
 buffer_load_dwordx4 v[124:127], v1, s[4:7], s60 offen offset:0 sc1
 buffer_load_dwordx4 v[128:131], v1, s[4:7], s60 offen offset:1024 sc1
 buffer_load_dwordx4 v[132:135], v1, s[4:7], s60 offen offset:2048 sc1
 buffer_load_dwordx4 v[136:139], v1, s[4:7], s60 offen offset:3072 sc1
 s_waitcnt vmcnt(0)
 s_add_u32 s51, s51, 1
 s_cmp_lt_u32 s51, 131072
 s_cbranch_scc1 L_pk_339
 s_branch L_bail
L_rt_342:
 s_nop 7
 buffer_load_dword v7, off, s[4:7], s17 sc1
 s_waitcnt vmcnt(0)
 s_add_u32 s51, s51, 1
 s_cmp_lt_u32 s51, 131072
 s_cbranch_scc1 L_go_341
 s_branch L_bail
L_rt_344:
 s_nop 7
 buffer_load_dwordx4 v[40:43], v2, s[4:7], s57 offen offset:0 sc1
 buffer_load_dwordx4 v[44:47], v2, s[4:7], s57 offen offset:128 sc1
 buffer_load_dwordx4 v[48:51], v2, s[4:7], s57 offen offset:1024 sc1
 buffer_load_dwordx4 v[52:55], v2, s[4:7], s57 offen offset:1152 sc1
 buffer_load_dwordx4 v[56:59], v3, s[4:7], s57 offen offset:0 sc1
 s_add_u32 s51, s51, 1
 s_cmp_lt_u32 s51, 131072
 s_cbranch_scc1 L_xm_343
 s_branch L_bail
L_rt_347:
 s_sleep 1
 buffer_load_dword v13, off, s[4:7], s32 sc1
 s_waitcnt vmcnt(0)
 s_add_u32 s51, s51, 1
 s_cmp_lt_u32 s51, 131072
 s_cbranch_scc1 L_wf_346
 s_branch L_bail
L_rt_349:
 s_nop 7
 buffer_load_dwordx4 v[124:127], v1, s[4:7], s61 offen offset:0 sc1
 buffer_load_dwordx4 v[128:131], v1, s[4:7], s61 offen offset:1024 sc1
 buffer_load_dwordx4 v[132:135], v1, s[4:7], s61 offen offset:2048 sc1
 buffer_load_dwordx4 v[136:139], v1, s[4:7], s61 offen offset:3072 sc1
 s_waitcnt vmcnt(0)
 s_add_u32 s51, s51, 1
 s_cmp_lt_u32 s51, 131072
 s_cbranch_scc1 L_pk_348
 s_branch L_bail
L_rt_351:
 s_nop 7
 buffer_load_dword v7, off, s[4:7], s17 sc1
 s_waitcnt vmcnt(0)
 s_add_u32 s51, s51, 1
 s_cmp_lt_u32 s51, 131072
 s_cbranch_scc1 L_go_350
 s_branch L_bail
L_rt_353:
 s_nop 7
 buffer_load_dwordx4 v[40:43], v2, s[4:7], s58 offen offset:0 sc1
 buffer_load_dwordx4 v[44:47], v2, s[4:7], s58 offen offset:128 sc1
 buffer_load_dwordx4 v[48:51], v2, s[4:7], s58 offen offset:1024 sc1
 buffer_load_dwordx4 v[52:55], v2, s[4:7], s58 offen offset:1152 sc1
 buffer_load_dwordx4 v[56:59], v3, s[4:7], s58 offen offset:0 sc1
 s_add_u32 s51, s51, 1
 s_cmp_lt_u32 s51, 131072
 s_cbranch_scc1 L_xm_352
 s_branch L_bail
L_rt_356:
 s_sleep 1
 buffer_load_dword v13, off, s[4:7], s32 sc1
 s_waitcnt vmcnt(0)
 s_add_u32 s51, s51, 1
 s_cmp_lt_u32 s51, 131072
 s_cbranch_scc1 L_wf_355
 s_branch L_bail
L_rt_358:
 s_nop 7
 buffer_load_dwordx4 v[124:127], v1, s[4:7], s62 offen offset:0 sc1
 buffer_load_dwordx4 v[128:131], v1, s[4:7], s62 offen offset:1024 sc1
 buffer_load_dwordx4 v[132:135], v1, s[4:7], s62 offen offset:2048 sc1
 buffer_load_dwordx4 v[136:139], v1, s[4:7], s62 offen offset:3072 sc1
 s_waitcnt vmcnt(0)
 s_add_u32 s51, s51, 1
 s_cmp_lt_u32 s51, 131072
 s_cbranch_scc1 L_pk_357
 s_branch L_bail
L_rt_360:
 s_nop 7
 buffer_load_dword v7, off, s[4:7], s17 sc1
 s_waitcnt vmcnt(0)
 s_add_u32 s51, s51, 1
 s_cmp_lt_u32 s51, 131072
 s_cbranch_scc1 L_go_359
 s_branch L_bail
L_rt_362:
 s_nop 7
 buffer_load_dwordx4 v[40:43], v2, s[4:7], s59 offen offset:0 sc1
 buffer_load_dwordx4 v[44:47], v2, s[4:7], s59 offen offset:128 sc1
 buffer_load_dwordx4 v[48:51], v2, s[4:7], s59 offen offset:1024 sc1
 buffer_load_dwordx4 v[52:55], v2, s[4:7], s59 offen offset:1152 sc1
 buffer_load_dwordx4 v[56:59], v3, s[4:7], s59 offen offset:0 sc1
 s_add_u32 s51, s51, 1
 s_cmp_lt_u32 s51, 131072
 s_cbranch_scc1 L_xm_361
 s_branch L_bail
L_rt_365:
 s_sleep 1
 buffer_load_dword v13, off, s[4:7], s32 sc1
 s_waitcnt vmcnt(0)
 s_add_u32 s51, s51, 1
 s_cmp_lt_u32 s51, 131072
 s_cbranch_scc1 L_wf_364
 s_branch L_bail
L_rt_367:
 s_nop 7
 buffer_load_dwordx4 v[124:127], v1, s[4:7], s63 offen offset:0 sc1
 buffer_load_dwordx4 v[128:131], v1, s[4:7], s63 offen offset:1024 sc1
 buffer_load_dwordx4 v[132:135], v1, s[4:7], s63 offen offset:2048 sc1
 buffer_load_dwordx4 v[136:139], v1, s[4:7], s63 offen offset:3072 sc1
 s_waitcnt vmcnt(0)
 s_add_u32 s51, s51, 1
 s_cmp_lt_u32 s51, 131072
 s_cbranch_scc1 L_pk_366
 s_branch L_bail
L_vr_last:
 s_barrier
 ds_read_b128 v[148:151], v15 offset:49152
 ds_read_b128 v[152:155], v15 offset:50176
 ds_read_b128 v[156:159], v15 offset:51200
 ds_read_b128 v[160:163], v15 offset:52224
 ds_read_b128 v[164:167], v15 offset:53248
 ds_read_b128 v[168:171], v15 offset:54272
 ds_read_b128 v[172:175], v15 offset:55296
 ds_read_b128 v[176:179], v15 offset:56320
 ds_read_b128 v[140:143], v17 offset:14336
 ds_read_b128 v[144:147], v17 offset:15360
 s_waitcnt vmcnt(0)
 ds_read_b128 v[40:43], v14 offset:49152
 ds_read_b128 v[44:47], v14 offset:50176
 ds_read_b128 v[48:51], v14 offset:51200
 ds_read_b128 v[52:55], v14 offset:52224
 v_mov_b32 v10, 1
 s_mov_b64 exec, 31
 buffer_atomic_add v10, v12, s[4:7], s34 offen
 s_mov_b64 exec, -1
 s_waitcnt lgkmcnt(0)
 v_mfma_f32_16x16x32_bf16 v[100:103], v[148:151], v[40:43], v[108:111]
 ds_read_b128 v[56:59], v19 offset:49152
 v_mfma_f32_16x16x32_bf16 v[104:107], v[164:167], v[40:43], v[112:115]
 ds_read_b128 v[60:63], v19 offset:50176
 v_mfma_f32_16x16x32_bf16 v[96:99], v[124:127], v[40:43], 0
 ds_read_b128 v[64:67], v19 offset:51200
 v_mfma_f32_16x16x32_bf16 v[100:103], v[152:155], v[44:47], v[100:103]
 ds_read_b128 v[68:71], v19 offset:52224
 v_mfma_f32_16x16x32_bf16 v[104:107], v[168:171], v[44:47], v[104:107]
 ds_read_b128 v[72:75], v19 offset:53248
 v_mfma_f32_16x16x32_bf16 v[96:99], v[128:131], v[44:47], v[96:99]
 ds_read_b128 v[76:79], v19 offset:54272
 v_mfma_f32_16x16x32_bf16 v[100:103], v[156:159], v[48:51], v[100:103]
 ds_read_b128 v[180:183], v19 offset:55296
 v_mfma_f32_16x16x32_bf16 v[104:107], v[172:175], v[48:51], v[104:107]
 ds_read_b128 v[184:187], v19 offset:56320
 v_mfma_f32_16x16x32_bf16 v[96:99], v[132:135], v[48:51], v[96:99]
 v_mfma_f32_16x16x32_bf16 v[100:103], v[160:163], v[52:55], v[100:103]
 v_mfma_f32_16x16x32_bf16 v[104:107], v[176:179], v[52:55], v[104:107]
 v_mfma_f32_16x16x32_bf16 v[96:99], v[136:139], v[52:55], v[96:99]
 v_mov_b32 v80, 0
 v_mov_b32 v81, 0
 v_mov_b32 v82, 0
 v_mov_b32 v83, 0
 v_mov_b32 v84, 0
 v_mov_b32 v85, 0
 v_mov_b32 v86, 0
 v_mov_b32 v87, 0
 v_cvt_pk_bf16_f32 v7, v100, v101
 v_lshlrev_b32 v100, 16, v7
 v_and_b32 v101, 0xffff0000, v7
 v_cvt_pk_bf16_f32 v7, v102, v103
 v_lshlrev_b32 v102, 16, v7
 v_and_b32 v103, 0xffff0000, v7
 v_cvt_pk_bf16_f32 v7, v104, v105
 v_lshlrev_b32 v104, 16, v7
 v_and_b32 v105, 0xffff0000, v7
 v_cvt_pk_bf16_f32 v7, v106, v107
 v_lshlrev_b32 v106, 16, v7
 v_and_b32 v107, 0xffff0000, v7
 v_cvt_pk_bf16_f32 v7, v98, v99
 v_lshlrev_b32 v98, 16, v7
 v_and_b32 v99, 0xffff0000, v7
 v_pk_mul_f32 v[100:101], v[100:101], s[64:65] op_sel:[0,1] op_sel_hi:[1,1]
 v_pk_mul_f32 v[102:103], v[102:103], s[64:65] op_sel:[0,1] op_sel_hi:[1,1]
 v_pk_mul_f32 v[104:105], v[104:105], s[64:65] op_sel:[0,1] op_sel_hi:[1,1]
 v_pk_mul_f32 v[106:107], v[106:107], s[64:65] op_sel:[0,1] op_sel_hi:[1,1]
 v_pk_mul_f32 v[98:99], v[98:99], s[64:65] op_sel:[0,1] op_sel_hi:[1,1]
 v_cvt_pk_bf16_f32 v7, v100, v101
 v_lshlrev_b32 v100, 16, v7
 v_and_b32 v101, 0xffff0000, v7
 v_cvt_pk_bf16_f32 v7, v102, v103
 v_lshlrev_b32 v102, 16, v7
 v_and_b32 v103, 0xffff0000, v7
 v_cvt_pk_bf16_f32 v7, v104, v105
 v_lshlrev_b32 v104, 16, v7
 v_and_b32 v105, 0xffff0000, v7
 v_cvt_pk_bf16_f32 v7, v106, v107
 v_lshlrev_b32 v106, 16, v7
 v_and_b32 v107, 0xffff0000, v7
 v_cvt_pk_bf16_f32 v7, v98, v99
 v_lshlrev_b32 v98, 16, v7
 v_and_b32 v99, 0xffff0000, v7
 v_max_f32 v20, v100, v101
 v_max3_f32 v20, v20, v102, v103
 v_max3_f32 v20, v20, v104, v105
 v_max3_f32 v20, v20, v106, v107
 v_max3_f32 v20, v20, v98, v99
 v_mov_b32 v22, v20
 s_nop 1
 v_permlane16_swap_b32 v20, v22
 v_max_f32 v20, v20, v22
 v_mov_b32 v22, v20
 s_nop 1
 v_permlane32_swap_b32 v20, v22
 v_max_f32 v20, v20, v22
 v_mul_f32 v22, s66, v20
 v_fma_f32 v100, v100, s66, -v22
 v_fma_f32 v101, v101, s66, -v22
 v_fma_f32 v102, v102, s66, -v22
 v_fma_f32 v103, v103, s66, -v22
 v_fma_f32 v104, v104, s66, -v22
 v_fma_f32 v105, v105, s66, -v22
 v_fma_f32 v106, v106, s66, -v22
 v_fma_f32 v107, v107, s66, -v22
 v_fma_f32 v98, v98, s66, -v22
 v_fma_f32 v99, v99, s66, -v22
 v_exp_f32 v100, v100
 v_exp_f32 v101, v101
 v_exp_f32 v102, v102
 v_exp_f32 v103, v103
 v_exp_f32 v104, v104
 v_exp_f32 v105, v105
 v_exp_f32 v106, v106
 v_exp_f32 v107, v107
 v_exp_f32 v98, v98
 v_exp_f32 v99, v99
 v_add_f32 v28, v100, v101
 v_add_f32 v28, v28, v102
 v_add_f32 v28, v28, v103
 v_add_f32 v28, v28, v104
 v_add_f32 v28, v28, v105
 v_add_f32 v28, v28, v106
 v_add_f32 v28, v28, v107
 v_add_f32 v28, v28, v98
 v_add_f32 v28, v28, v99
 v_mov_b32 v22, v28
 s_nop 1
 v_permlane16_swap_b32 v28, v22
 v_add_f32 v28, v28, v22
 v_mov_b32 v22, v28
 s_nop 1
 v_permlane32_swap_b32 v28, v22
 v_add_f32 v28, v28, v22
 v_rcp_f32 v28, v28
 s_nop 0
 v_pk_mul_f32 v[100:101], v[100:101], v[28:29] op_sel_hi:[1,0]
 v_pk_mul_f32 v[102:103], v[102:103], v[28:29] op_sel_hi:[1,0]
 v_pk_mul_f32 v[104:105], v[104:105], v[28:29] op_sel_hi:[1,0]
 v_pk_mul_f32 v[106:107], v[106:107], v[28:29] op_sel_hi:[1,0]
 v_pk_mul_f32 v[98:99], v[98:99], v[28:29] op_sel_hi:[1,0]
 v_cvt_pk_bf16_f32 v116, v100, v101
 v_cvt_pk_bf16_f32 v117, v102, v103
 v_cvt_pk_bf16_f32 v118, v104, v105
 v_cvt_pk_bf16_f32 v119, v106, v107
 v_cvt_pk_bf16_f32 v120, v98, v99
 v_cvt_pk_bf16_f32 v123, v98, v99
 s_waitcnt lgkmcnt(0)
 v_mfma_f32_16x16x32_bf16 v[148:151], v[56:59], v[116:119], 0
 v_mfma_f32_16x16x32_bf16 v[152:155], v[60:63], v[116:119], 0
 v_mfma_f32_16x16x16_bf16 v[148:151], v[140:141], v[120:121], v[148:151]
 v_mfma_f32_16x16x32_bf16 v[156:159], v[64:67], v[116:119], 0
 v_mfma_f32_16x16x16_bf16 v[152:155], v[140:141], v[122:123], v[152:155]
 v_mfma_f32_16x16x32_bf16 v[160:163], v[68:71], v[116:119], 0
 v_mfma_f32_16x16x16_bf16 v[156:159], v[142:143], v[120:121], v[156:159]
 v_mfma_f32_16x16x32_bf16 v[164:167], v[72:75], v[116:119], 0
 v_mfma_f32_16x16x16_bf16 v[160:163], v[142:143], v[122:123], v[160:163]
 v_cvt_pk_bf16_f32 v40, v148, v149
 v_cvt_pk_bf16_f32 v41, v150, v151
 v_cvt_pk_bf16_f32 v42, v152, v153
 v_cvt_pk_bf16_f32 v43, v154, v155
 buffer_store_dwordx4 v[40:43], v11, s[4:7], s33 offen offset:0 sc1
 v_mfma_f32_16x16x32_bf16 v[168:171], v[76:79], v[116:119], 0
 v_mfma_f32_16x16x16_bf16 v[164:167], v[144:145], v[120:121], v[164:167]
 v_mfma_f32_16x16x32_bf16 v[172:175], v[180:183], v[116:119], 0
 v_mfma_f32_16x16x16_bf16 v[168:171], v[144:145], v[122:123], v[168:171]
 v_cvt_pk_bf16_f32 v44, v156, v157
 v_cvt_pk_bf16_f32 v45, v158, v159
 v_cvt_pk_bf16_f32 v46, v160, v161
 v_cvt_pk_bf16_f32 v47, v162, v163
 buffer_store_dwordx4 v[44:47], v11, s[4:7], s33 offen offset:2048 sc1
 s_add_u32 s33, s33, 4096
 v_mfma_f32_16x16x32_bf16 v[176:179], v[184:187], v[116:119], 0
 v_mfma_f32_16x16x16_bf16 v[172:175], v[146:147], v[120:121], v[172:175]
 v_mfma_f32_16x16x16_bf16 v[176:179], v[146:147], v[122:123], v[176:179]
 v_cvt_pk_bf16_f32 v48, v164, v165
 v_cvt_pk_bf16_f32 v49, v166, v167
 v_cvt_pk_bf16_f32 v50, v168, v169
 v_cvt_pk_bf16_f32 v51, v170, v171
 buffer_store_dwordx4 v[48:51], v11, s[4:7], s33 offen offset:0 sc1
 s_nop 3
 v_cvt_pk_bf16_f32 v52, v172, v173
 v_cvt_pk_bf16_f32 v53, v174, v175
 v_cvt_pk_bf16_f32 v54, v176, v177
 v_cvt_pk_bf16_f32 v55, v178, v179
 buffer_store_dwordx4 v[52:55], v11, s[4:7], s33 offen offset:2048 sc1
 s_waitcnt vmcnt(0)
 v_mov_b32 v10, 1
 s_mov_b64 exec, 31
 buffer_atomic_add v10, v12, s[4:7], s67 offen
 s_mov_b64 exec, -1
 s_endpgm
L_code_end:
 s_endpgm
.section .rodata,"a"
.p2align 6
.amdhsa_kernel interleave_layers__memory_aug_recurrent_mem_tr__ssm_conv_h3__prompt_kernel
  .amdhsa_next_free_vgpr 512
  .amdhsa_next_free_sgpr 102
  .amdhsa_accum_offset 256
  .amdhsa_group_segment_fixed_size 0
  .amdhsa_kernarg_size 128
  .amdhsa_user_sgpr_count 2
  .amdhsa_user_sgpr_kernarg_segment_ptr 1
  .amdhsa_system_sgpr_workgroup_id_x 1
  .amdhsa_float_denorm_mode_32 3
.end_amdhsa_kernel
.text
```
